```python
import torch

def _softmax(x, axis=-1):
    return torch.softmax(x, dim=axis)
def _gelu(x):
    return torch.nn.functional.gelu(x, approximate="tanh")
def _silu(x):
    return torch.nn.functional.silu(x)
def _sigmoid(x):
    return torch.sigmoid(x)
def _layernorm(x, axis=-1, eps=1e-5):
    m = x.mean(dim=axis, keepdim=True)
    v = x.var(dim=axis, keepdim=True, unbiased=False)
    return (x - m) / torch.sqrt(v + eps)
def _scatter_add(tgt, idx, src, axis=0):
    return tgt.clone().index_add_(axis, idx, src)
def _segment_sum(src, seg, n):
    out = torch.zeros((n,) + src.shape[1:], dtype=src.dtype)
    return out.index_add_(0, seg, src)
def _pad(x, pw):
    flat = tuple(v for pair in reversed(pw) for v in pair)
    return torch.nn.functional.pad(x, flat)

kernel_name = 'standalone__cross_network_dcn__recsys'

def setup_inputs():

    _w = (lambda a: (lambda t: t.to(torch.bfloat16) if t.is_floating_point() else t)(torch.as_tensor(a)))
    B, F, D, L = 16384, 100, 16, 6
    Din = min(F * D, 1024)
    return {
        "x0": _w((lambda *s: torch.randn(*s, dtype=torch.bfloat16) * 0.05)(B, Din)),
        "ws": _w((lambda *s: torch.randn(*s, dtype=torch.bfloat16) * 0.8)(L, Din, Din) * (Din ** -0.5)),
        "bs": _w((lambda *s: torch.randn(*s, dtype=torch.bfloat16) * 3.2)(L, Din) * 0.01),
    }

def reference(x0, ws, bs):
    x = x0
    L = ws.shape[0]
    for l in range(L):
        proj = torch.einsum('bd,de->be', x, ws[l]) + bs[l]
        x = x0 * proj + x
    return x
```

```asm
; @launch kernel=dcn_prep_kernel grid=(384,1,1) block=(256,1,1) lds=0
; @launch kernel=standalone__cross_network_dcn__recsys_kernel grid=(256,1,1) block=(256,1,1) lds=155648
.amdgcn_target "amdgcn-amd-amdhsa--gfx950"
.text
.globl standalone__cross_network_dcn__recsys_kernel
.p2align 8
.type standalone__cross_network_dcn__recsys_kernel,@function
standalone__cross_network_dcn__recsys_kernel:
 s_cmp_ge_u32 s2, 256
 s_cbranch_scc1 Lend
 s_load_dwordx2 s[4:5], s[0:1], 0
 s_load_dwordx2 s[6:7], s[0:1], 16
 s_load_dwordx2 s[32:33], s[0:1], 24
 s_load_dwordx2 s[34:35], s[0:1], 40
 v_lshrrev_b32 v9, 6, v0
 v_and_b32 v10, 63, v0
 v_lshlrev_b32 v11, 4, v10
 v_lshl_add_u32 v1, v9, 13, v11
 v_add_u32 v2, 4096, v1
 v_mov_b32 v3, v11
 v_add_u32 v4, 65536, v11
 v_lshl_add_u32 v5, v9, 14, v11
 v_add_u32 v6, 65536, v5
 v_lshrrev_b32 v12, 4, v10
 v_and_b32 v13, 15, v10
 v_lshlrev_b32 v7, 9, v9
 v_lshl_add_u32 v7, v12, 5, v7
 v_add_u32 v7, 131072, v7
 v_lshlrev_b32 v8, 11, v13
 v_lshl_add_u32 v8, v9, 8, v8
 v_lshl_add_u32 v8, v12, 4, v8
 s_lshl_b32 s28, s2, 17
 s_add_u32 s29, s28, 32768
 s_add_u32 s30, s28, 65536
 s_add_u32 s31, s28, 98304
 s_mov_b32 s26, 0xffff0000
 s_mov_b32 s24, 0
 s_mov_b32 s25, 0
 v_lshlrev_b32 v14, 4, v0
 s_waitcnt lgkmcnt(0)
 s_mov_b32 s8, s4
 s_mov_b32 s9, s5
 s_mov_b32 s10, 0x2000000
 s_mov_b32 s11, 0x20000
 s_mov_b32 s20, s6
 s_mov_b32 s21, s7
 s_mov_b32 s22, 0x3000
 s_mov_b32 s23, 0x20000
 s_mov_b32 s16, s32
 s_mov_b32 s17, s33
 s_mov_b32 s18, 0x2000000
 s_mov_b32 s19, 0x20000
 s_mov_b32 s12, s34
 s_mov_b32 s13, s35
 s_mov_b32 s14, 0xc00000
 s_mov_b32 s15, 0x20000
 s_mov_b32 s3, 0
 buffer_load_dwordx4 v[16:19], v14, s[20:23], s3 offen
 s_mov_b32 s3, 4096
 buffer_load_dwordx4 v[20:23], v14, s[20:23], s3 offen
 s_mov_b32 s3, 8192
 buffer_load_dwordx4 v[24:27], v14, s[20:23], s3 offen
 buffer_load_dwordx4 a[0:3], v8, s[8:11], s28 offen
 buffer_load_dwordx4 a[4:7], v8, s[8:11], s29 offen
 buffer_load_dwordx4 a[8:11], v8, s[8:11], s30 offen
 buffer_load_dwordx4 a[12:15], v8, s[8:11], s31 offen
 buffer_load_dwordx4 a[16:19], v8, s[8:11], s28 offen offset:64
 buffer_load_dwordx4 a[20:23], v8, s[8:11], s29 offen offset:64
 buffer_load_dwordx4 a[24:27], v8, s[8:11], s30 offen offset:64
 buffer_load_dwordx4 a[28:31], v8, s[8:11], s31 offen offset:64
 buffer_load_dwordx4 a[32:35], v8, s[8:11], s28 offen offset:128
 buffer_load_dwordx4 a[36:39], v8, s[8:11], s29 offen offset:128
 buffer_load_dwordx4 a[40:43], v8, s[8:11], s30 offen offset:128
 buffer_load_dwordx4 a[44:47], v8, s[8:11], s31 offen offset:128
 buffer_load_dwordx4 a[48:51], v8, s[8:11], s28 offen offset:192
 buffer_load_dwordx4 a[52:55], v8, s[8:11], s29 offen offset:192
 buffer_load_dwordx4 a[56:59], v8, s[8:11], s30 offen offset:192
 buffer_load_dwordx4 a[60:63], v8, s[8:11], s31 offen offset:192
 buffer_load_dwordx4 a[160:163], v1, s[12:15], s24 offen
 buffer_load_dwordx4 a[164:167], v1, s[12:15], s24 offen offset:1024
 buffer_load_dwordx4 a[168:171], v1, s[12:15], s24 offen offset:2048
 buffer_load_dwordx4 a[172:175], v1, s[12:15], s24 offen offset:3072
 buffer_load_dwordx4 a[176:179], v2, s[12:15], s24 offen
 buffer_load_dwordx4 a[180:183], v2, s[12:15], s24 offen offset:1024
 buffer_load_dwordx4 a[184:187], v2, s[12:15], s24 offen offset:2048
 buffer_load_dwordx4 a[188:191], v2, s[12:15], s24 offen offset:3072
 s_add_u32 s24, s24, 32768
 buffer_load_dwordx4 a[192:195], v1, s[12:15], s24 offen
 buffer_load_dwordx4 a[196:199], v1, s[12:15], s24 offen offset:1024
 buffer_load_dwordx4 a[200:203], v1, s[12:15], s24 offen offset:2048
 buffer_load_dwordx4 a[204:207], v1, s[12:15], s24 offen offset:3072
 buffer_load_dwordx4 a[208:211], v2, s[12:15], s24 offen
 buffer_load_dwordx4 a[212:215], v2, s[12:15], s24 offen offset:1024
 buffer_load_dwordx4 a[216:219], v2, s[12:15], s24 offen offset:2048
 buffer_load_dwordx4 a[220:223], v2, s[12:15], s24 offen offset:3072
 s_add_u32 s24, s24, 32768
 buffer_load_dwordx4 a[64:67], v8, s[8:11], s28 offen offset:1024
 buffer_load_dwordx4 a[68:71], v8, s[8:11], s29 offen offset:1024
 buffer_load_dwordx4 a[72:75], v8, s[8:11], s30 offen offset:1024
 buffer_load_dwordx4 a[76:79], v8, s[8:11], s31 offen offset:1024
 buffer_load_dwordx4 a[80:83], v8, s[8:11], s28 offen offset:1088
 buffer_load_dwordx4 a[84:87], v8, s[8:11], s29 offen offset:1088
 buffer_load_dwordx4 a[88:91], v8, s[8:11], s30 offen offset:1088
 buffer_load_dwordx4 a[92:95], v8, s[8:11], s31 offen offset:1088
 buffer_load_dwordx4 a[96:99], v8, s[8:11], s28 offen offset:1152
 buffer_load_dwordx4 a[100:103], v8, s[8:11], s29 offen offset:1152
 buffer_load_dwordx4 a[104:107], v8, s[8:11], s30 offen offset:1152
 buffer_load_dwordx4 a[108:111], v8, s[8:11], s31 offen offset:1152
 buffer_load_dwordx4 a[112:115], v8, s[8:11], s28 offen offset:1216
 buffer_load_dwordx4 a[116:119], v8, s[8:11], s29 offen offset:1216
 buffer_load_dwordx4 a[120:123], v8, s[8:11], s30 offen offset:1216
 buffer_load_dwordx4 a[124:127], v8, s[8:11], s31 offen offset:1216
 v_mov_b32 v32, 1.0
 v_mov_b32 v33, 1.0
 v_mov_b32 v34, 1.0
 v_mov_b32 v35, 1.0
 v_mov_b32 v36, 1.0
 v_mov_b32 v37, 1.0
 v_mov_b32 v38, 1.0
 v_mov_b32 v39, 1.0
 v_mov_b32 v40, 1.0
 v_mov_b32 v41, 1.0
 v_mov_b32 v42, 1.0
 v_mov_b32 v43, 1.0
 v_mov_b32 v44, 1.0
 v_mov_b32 v45, 1.0
 v_mov_b32 v46, 1.0
 v_mov_b32 v47, 1.0
 v_mov_b32 v48, 1.0
 v_mov_b32 v49, 1.0
 v_mov_b32 v50, 1.0
 v_mov_b32 v51, 1.0
 v_mov_b32 v52, 1.0
 v_mov_b32 v53, 1.0
 v_mov_b32 v54, 1.0
 v_mov_b32 v55, 1.0
 v_mov_b32 v56, 1.0
 v_mov_b32 v57, 1.0
 v_mov_b32 v58, 1.0
 v_mov_b32 v59, 1.0
 v_mov_b32 v60, 1.0
 v_mov_b32 v61, 1.0
 v_mov_b32 v62, 1.0
 v_mov_b32 v63, 1.0
 v_mov_b32 v64, 1.0
 v_mov_b32 v65, 1.0
 v_mov_b32 v66, 1.0
 v_mov_b32 v67, 1.0
 v_mov_b32 v68, 1.0
 v_mov_b32 v69, 1.0
 v_mov_b32 v70, 1.0
 v_mov_b32 v71, 1.0
 v_mov_b32 v72, 1.0
 v_mov_b32 v73, 1.0
 v_mov_b32 v74, 1.0
 v_mov_b32 v75, 1.0
 v_mov_b32 v76, 1.0
 v_mov_b32 v77, 1.0
 v_mov_b32 v78, 1.0
 v_mov_b32 v79, 1.0
 v_mov_b32 v80, 1.0
 v_mov_b32 v81, 1.0
 v_mov_b32 v82, 1.0
 v_mov_b32 v83, 1.0
 v_mov_b32 v84, 1.0
 v_mov_b32 v85, 1.0
 v_mov_b32 v86, 1.0
 v_mov_b32 v87, 1.0
 v_mov_b32 v88, 1.0
 v_mov_b32 v89, 1.0
 v_mov_b32 v90, 1.0
 v_mov_b32 v91, 1.0
 v_mov_b32 v92, 1.0
 v_mov_b32 v93, 1.0
 v_mov_b32 v94, 1.0
 v_mov_b32 v95, 1.0
 v_mov_b32 v96, 1.0
 v_mov_b32 v97, 1.0
 v_mov_b32 v98, 1.0
 v_mov_b32 v99, 1.0
 v_mov_b32 v100, 1.0
 v_mov_b32 v101, 1.0
 v_mov_b32 v102, 1.0
 v_mov_b32 v103, 1.0
 v_mov_b32 v104, 1.0
 v_mov_b32 v105, 1.0
 v_mov_b32 v106, 1.0
 v_mov_b32 v107, 1.0
 v_mov_b32 v108, 1.0
 v_mov_b32 v109, 1.0
 v_mov_b32 v110, 1.0
 v_mov_b32 v111, 1.0
 v_mov_b32 v112, 1.0
 v_mov_b32 v113, 1.0
 v_mov_b32 v114, 1.0
 v_mov_b32 v115, 1.0
 v_mov_b32 v116, 1.0
 v_mov_b32 v117, 1.0
 v_mov_b32 v118, 1.0
 v_mov_b32 v119, 1.0
 v_mov_b32 v120, 1.0
 v_mov_b32 v121, 1.0
 v_mov_b32 v122, 1.0
 v_mov_b32 v123, 1.0
 v_mov_b32 v124, 1.0
 v_mov_b32 v125, 1.0
 v_mov_b32 v126, 1.0
 v_mov_b32 v127, 1.0
 v_mov_b32 v128, 1.0
 v_mov_b32 v129, 1.0
 v_mov_b32 v130, 1.0
 v_mov_b32 v131, 1.0
 v_mov_b32 v132, 1.0
 v_mov_b32 v133, 1.0
 v_mov_b32 v134, 1.0
 v_mov_b32 v135, 1.0
 v_mov_b32 v136, 1.0
 v_mov_b32 v137, 1.0
 v_mov_b32 v138, 1.0
 v_mov_b32 v139, 1.0
 v_mov_b32 v140, 1.0
 v_mov_b32 v141, 1.0
 v_mov_b32 v142, 1.0
 v_mov_b32 v143, 1.0
 v_accvgpr_write_b32 a224, 1.0
 v_accvgpr_write_b32 a225, 1.0
 v_accvgpr_write_b32 a226, 1.0
 v_accvgpr_write_b32 a227, 1.0
 v_accvgpr_write_b32 a228, 1.0
 v_accvgpr_write_b32 a229, 1.0
 v_accvgpr_write_b32 a230, 1.0
 v_accvgpr_write_b32 a231, 1.0
 v_accvgpr_write_b32 a232, 1.0
 v_accvgpr_write_b32 a233, 1.0
 v_accvgpr_write_b32 a234, 1.0
 v_accvgpr_write_b32 a235, 1.0
 v_accvgpr_write_b32 a236, 1.0
 v_accvgpr_write_b32 a237, 1.0
 v_accvgpr_write_b32 a238, 1.0
 v_accvgpr_write_b32 a239, 1.0
 v_mov_b32 v144, 1.0
 v_mov_b32 v145, 1.0
 v_mov_b32 v146, 1.0
 v_mov_b32 v147, 1.0
 v_mov_b32 v148, 1.0
 v_mov_b32 v149, 1.0
 v_mov_b32 v150, 1.0
 v_mov_b32 v151, 1.0
 v_mov_b32 v152, 1.0
 v_mov_b32 v153, 1.0
 v_mov_b32 v154, 1.0
 v_mov_b32 v155, 1.0
 v_mov_b32 v156, 1.0
 v_mov_b32 v157, 1.0
 v_mov_b32 v158, 1.0
 v_mov_b32 v159, 1.0
 v_mov_b32 v160, 1.0
 v_mov_b32 v161, 1.0
 v_mov_b32 v162, 1.0
 v_mov_b32 v163, 1.0
 v_mov_b32 v164, 1.0
 v_mov_b32 v165, 1.0
 v_mov_b32 v166, 1.0
 v_mov_b32 v167, 1.0
 v_mov_b32 v168, 1.0
 v_mov_b32 v169, 1.0
 v_mov_b32 v170, 1.0
 v_mov_b32 v171, 1.0
 v_mov_b32 v172, 1.0
 v_mov_b32 v173, 1.0
 v_mov_b32 v174, 1.0
 v_mov_b32 v175, 1.0
 v_mov_b32 v176, 1.0
 v_mov_b32 v177, 1.0
 v_mov_b32 v178, 1.0
 v_mov_b32 v179, 1.0
 v_mov_b32 v180, 1.0
 v_mov_b32 v181, 1.0
 v_mov_b32 v182, 1.0
 v_mov_b32 v183, 1.0
 v_mov_b32 v184, 1.0
 v_mov_b32 v185, 1.0
 v_mov_b32 v186, 1.0
 v_mov_b32 v187, 1.0
 v_mov_b32 v188, 1.0
 v_mov_b32 v189, 1.0
 v_mov_b32 v190, 1.0
 v_mov_b32 v191, 1.0
 v_mov_b32 v192, 1.0
 v_mov_b32 v193, 1.0
 v_mov_b32 v194, 1.0
 v_mov_b32 v195, 1.0
 v_mov_b32 v196, 1.0
 v_mov_b32 v197, 1.0
 v_mov_b32 v198, 1.0
 v_mov_b32 v199, 1.0
 v_mov_b32 v200, 1.0
 v_mov_b32 v201, 1.0
 v_mov_b32 v202, 1.0
 v_mov_b32 v203, 1.0
 v_mov_b32 v204, 1.0
 v_mov_b32 v205, 1.0
 v_mov_b32 v206, 1.0
 v_mov_b32 v207, 1.0
 v_mov_b32 v208, 1.0
 v_mov_b32 v209, 1.0
 v_mov_b32 v210, 1.0
 v_mov_b32 v211, 1.0
 v_mov_b32 v212, 1.0
 v_mov_b32 v213, 1.0
 v_mov_b32 v214, 1.0
 v_mov_b32 v215, 1.0
 v_mov_b32 v216, 1.0
 v_mov_b32 v217, 1.0
 v_mov_b32 v218, 1.0
 v_mov_b32 v219, 1.0
 v_mov_b32 v220, 1.0
 v_mov_b32 v221, 1.0
 v_mov_b32 v222, 1.0
 v_mov_b32 v223, 1.0
 v_mov_b32 v224, 1.0
 v_mov_b32 v225, 1.0
 v_mov_b32 v226, 1.0
 v_mov_b32 v227, 1.0
 v_mov_b32 v228, 1.0
 v_mov_b32 v229, 1.0
 v_mov_b32 v230, 1.0
 v_mov_b32 v231, 1.0
 v_mov_b32 v232, 1.0
 v_mov_b32 v233, 1.0
 v_mov_b32 v234, 1.0
 v_mov_b32 v235, 1.0
 v_mov_b32 v236, 1.0
 v_mov_b32 v237, 1.0
 v_mov_b32 v238, 1.0
 v_mov_b32 v239, 1.0
 v_mov_b32 v240, 1.0
 v_mov_b32 v241, 1.0
 v_mov_b32 v242, 1.0
 v_mov_b32 v243, 1.0
 v_mov_b32 v244, 1.0
 v_mov_b32 v245, 1.0
 v_mov_b32 v246, 1.0
 v_mov_b32 v247, 1.0
 v_mov_b32 v248, 1.0
 v_mov_b32 v249, 1.0
 v_mov_b32 v250, 1.0
 v_mov_b32 v251, 1.0
 v_mov_b32 v252, 1.0
 v_mov_b32 v253, 1.0
 v_mov_b32 v254, 1.0
 v_mov_b32 v255, 1.0
 v_accvgpr_write_b32 a240, 1.0
 v_accvgpr_write_b32 a241, 1.0
 v_accvgpr_write_b32 a242, 1.0
 v_accvgpr_write_b32 a243, 1.0
 v_accvgpr_write_b32 a244, 1.0
 v_accvgpr_write_b32 a245, 1.0
 v_accvgpr_write_b32 a246, 1.0
 v_accvgpr_write_b32 a247, 1.0
 v_accvgpr_write_b32 a248, 1.0
 v_accvgpr_write_b32 a249, 1.0
 v_accvgpr_write_b32 a250, 1.0
 v_accvgpr_write_b32 a251, 1.0
 v_accvgpr_write_b32 a252, 1.0
 v_accvgpr_write_b32 a253, 1.0
 v_accvgpr_write_b32 a254, 1.0
 v_accvgpr_write_b32 a255, 1.0
 v_lshlrev_b32 v14, 5, v0
 v_add_u32 v14, 131072, v14
 s_waitcnt vmcnt(50)
 v_lshlrev_b32 v28, 16, v16
 v_and_b32 v29, s26, v16
 v_lshlrev_b32 v30, 16, v17
 v_and_b32 v31, s26, v17
 ds_write_b128 v14, v[28:31]
 s_waitcnt lgkmcnt(0)
 v_lshlrev_b32 v28, 16, v18
 v_and_b32 v29, s26, v18
 v_lshlrev_b32 v30, 16, v19
 v_and_b32 v31, s26, v19
 ds_write_b128 v14, v[28:31] offset:16
 s_waitcnt lgkmcnt(0)
 s_waitcnt vmcnt(49)
 v_lshlrev_b32 v28, 16, v20
 v_and_b32 v29, s26, v20
 v_lshlrev_b32 v30, 16, v21
 v_and_b32 v31, s26, v21
 ds_write_b128 v14, v[28:31] offset:8192
 s_waitcnt lgkmcnt(0)
 v_lshlrev_b32 v28, 16, v22
 v_and_b32 v29, s26, v22
 v_lshlrev_b32 v30, 16, v23
 v_and_b32 v31, s26, v23
 ds_write_b128 v14, v[28:31] offset:8208
 s_waitcnt lgkmcnt(0)
 s_waitcnt vmcnt(48)
 v_lshlrev_b32 v28, 16, v24
 v_and_b32 v29, s26, v24
 v_lshlrev_b32 v30, 16, v25
 v_and_b32 v31, s26, v25
 ds_write_b128 v14, v[28:31] offset:16384
 s_waitcnt lgkmcnt(0)
 v_lshlrev_b32 v28, 16, v26
 v_and_b32 v29, s26, v26
 v_lshlrev_b32 v30, 16, v27
 v_and_b32 v31, s26, v27
 ds_write_b128 v14, v[28:31] offset:16400
 s_waitcnt lgkmcnt(0)
 s_waitcnt vmcnt(47)
 ds_write_b128 v5, a[0:3]
 s_waitcnt vmcnt(46)
 ds_write_b128 v5, a[4:7] offset:1024
 s_waitcnt vmcnt(45)
 ds_write_b128 v5, a[8:11] offset:2048
 s_waitcnt vmcnt(44)
 ds_write_b128 v5, a[12:15] offset:3072
 s_waitcnt vmcnt(43)
 ds_write_b128 v5, a[16:19] offset:4096
 s_waitcnt vmcnt(42)
 ds_write_b128 v5, a[20:23] offset:5120
 s_waitcnt vmcnt(41)
 ds_write_b128 v5, a[24:27] offset:6144
 s_waitcnt vmcnt(40)
 ds_write_b128 v5, a[28:31] offset:7168
 s_waitcnt vmcnt(39)
 ds_write_b128 v5, a[32:35] offset:8192
 s_waitcnt vmcnt(38)
 ds_write_b128 v5, a[36:39] offset:9216
 s_waitcnt vmcnt(37)
 ds_write_b128 v5, a[40:43] offset:10240
 s_waitcnt vmcnt(36)
 ds_write_b128 v5, a[44:47] offset:11264
 s_waitcnt vmcnt(35)
 ds_write_b128 v5, a[48:51] offset:12288
 s_waitcnt vmcnt(34)
 ds_write_b128 v5, a[52:55] offset:13312
 s_waitcnt vmcnt(33)
 ds_write_b128 v5, a[56:59] offset:14336
 s_waitcnt vmcnt(32)
 ds_write_b128 v5, a[60:63] offset:15360
 s_waitcnt lgkmcnt(0)
 s_barrier
 ds_read_b128 a[128:131], v3
 ds_read_b128 a[132:135], v3 offset:1024
 ds_read_b128 a[136:139], v3 offset:2048
 ds_read_b128 a[140:143], v3 offset:3072
 s_waitcnt vmcnt(30) lgkmcnt(0)
 v_mfma_f32_16x16x32_bf16 v[32:35], a[160:163], a[128:131], v[32:35]
 v_mfma_f32_16x16x32_bf16 v[36:39], a[160:163], a[132:135], v[36:39]
 ds_read_b128 a[144:147], v3 offset:4096
 v_mfma_f32_16x16x32_bf16 v[40:43], a[160:163], a[136:139], v[40:43]
 v_mfma_f32_16x16x32_bf16 v[44:47], a[160:163], a[140:143], v[44:47]
 buffer_load_dwordx4 a[160:163], v1, s[12:15], s24 offen
 v_mfma_f32_16x16x32_bf16 v[48:51], a[164:167], a[128:131], v[48:51]
 v_mfma_f32_16x16x32_bf16 v[52:55], a[164:167], a[132:135], v[52:55]
 ds_read_b128 a[148:151], v3 offset:5120
 v_mfma_f32_16x16x32_bf16 v[56:59], a[164:167], a[136:139], v[56:59]
 v_mfma_f32_16x16x32_bf16 v[60:63], a[164:167], a[140:143], v[60:63]
 buffer_load_dwordx4 a[164:167], v1, s[12:15], s24 offen offset:1024
 s_waitcnt vmcnt(30)
 v_mfma_f32_16x16x32_bf16 v[64:67], a[168:171], a[128:131], v[64:67]
 v_mfma_f32_16x16x32_bf16 v[68:71], a[168:171], a[132:135], v[68:71]
 ds_read_b128 a[152:155], v3 offset:6144
 v_mfma_f32_16x16x32_bf16 v[72:75], a[168:171], a[136:139], v[72:75]
 v_mfma_f32_16x16x32_bf16 v[76:79], a[168:171], a[140:143], v[76:79]
 buffer_load_dwordx4 a[168:171], v1, s[12:15], s24 offen offset:2048
 v_mfma_f32_16x16x32_bf16 v[80:83], a[172:175], a[128:131], v[80:83]
 v_mfma_f32_16x16x32_bf16 v[84:87], a[172:175], a[132:135], v[84:87]
 ds_read_b128 a[156:159], v3 offset:7168
 v_mfma_f32_16x16x32_bf16 v[88:91], a[172:175], a[136:139], v[88:91]
 v_mfma_f32_16x16x32_bf16 v[92:95], a[172:175], a[140:143], v[92:95]
 buffer_load_dwordx4 a[172:175], v1, s[12:15], s24 offen offset:3072
 s_waitcnt vmcnt(30)
 v_mfma_f32_16x16x32_bf16 v[96:99], a[176:179], a[128:131], v[96:99]
 v_mfma_f32_16x16x32_bf16 v[100:103], a[176:179], a[132:135], v[100:103]
 v_mfma_f32_16x16x32_bf16 v[104:107], a[176:179], a[136:139], v[104:107]
 v_mfma_f32_16x16x32_bf16 v[108:111], a[176:179], a[140:143], v[108:111]
 buffer_load_dwordx4 a[176:179], v2, s[12:15], s24 offen
 v_mfma_f32_16x16x32_bf16 v[112:115], a[180:183], a[128:131], v[112:115]
 v_mfma_f32_16x16x32_bf16 v[116:119], a[180:183], a[132:135], v[116:119]
 v_mfma_f32_16x16x32_bf16 v[120:123], a[180:183], a[136:139], v[120:123]
 v_mfma_f32_16x16x32_bf16 v[124:127], a[180:183], a[140:143], v[124:127]
 buffer_load_dwordx4 a[180:183], v2, s[12:15], s24 offen offset:1024
 s_waitcnt vmcnt(30)
 v_mfma_f32_16x16x32_bf16 v[128:131], a[184:187], a[128:131], v[128:131]
 v_mfma_f32_16x16x32_bf16 v[132:135], a[184:187], a[132:135], v[132:135]
 v_mfma_f32_16x16x32_bf16 v[136:139], a[184:187], a[136:139], v[136:139]
 v_mfma_f32_16x16x32_bf16 v[140:143], a[184:187], a[140:143], v[140:143]
 buffer_load_dwordx4 a[184:187], v2, s[12:15], s24 offen offset:2048
 v_mfma_f32_16x16x32_bf16 a[224:227], a[188:191], a[128:131], a[224:227]
 v_mfma_f32_16x16x32_bf16 a[228:231], a[188:191], a[132:135], a[228:231]
 v_mfma_f32_16x16x32_bf16 a[232:235], a[188:191], a[136:139], a[232:235]
 v_mfma_f32_16x16x32_bf16 a[236:239], a[188:191], a[140:143], a[236:239]
 buffer_load_dwordx4 a[188:191], v2, s[12:15], s24 offen offset:3072
 s_add_u32 s24, s24, 32768
 s_waitcnt vmcnt(30)
 s_waitcnt lgkmcnt(0)
 v_mfma_f32_16x16x32_bf16 v[32:35], a[192:195], a[144:147], v[32:35]
 v_mfma_f32_16x16x32_bf16 v[36:39], a[192:195], a[148:151], v[36:39]
 ds_read_b128 a[128:131], v3 offset:8192
 v_mfma_f32_16x16x32_bf16 v[40:43], a[192:195], a[152:155], v[40:43]
 v_mfma_f32_16x16x32_bf16 v[44:47], a[192:195], a[156:159], v[44:47]
 buffer_load_dwordx4 a[192:195], v1, s[12:15], s24 offen
 v_mfma_f32_16x16x32_bf16 v[48:51], a[196:199], a[144:147], v[48:51]
 v_mfma_f32_16x16x32_bf16 v[52:55], a[196:199], a[148:151], v[52:55]
 ds_read_b128 a[132:135], v3 offset:9216
 v_mfma_f32_16x16x32_bf16 v[56:59], a[196:199], a[152:155], v[56:59]
 v_mfma_f32_16x16x32_bf16 v[60:63], a[196:199], a[156:159], v[60:63]
 buffer_load_dwordx4 a[196:199], v1, s[12:15], s24 offen offset:1024
 s_waitcnt vmcnt(30)
 v_mfma_f32_16x16x32_bf16 v[64:67], a[200:203], a[144:147], v[64:67]
 v_mfma_f32_16x16x32_bf16 v[68:71], a[200:203], a[148:151], v[68:71]
 ds_read_b128 a[136:139], v3 offset:10240
 v_mfma_f32_16x16x32_bf16 v[72:75], a[200:203], a[152:155], v[72:75]
 v_mfma_f32_16x16x32_bf16 v[76:79], a[200:203], a[156:159], v[76:79]
 buffer_load_dwordx4 a[200:203], v1, s[12:15], s24 offen offset:2048
 v_mfma_f32_16x16x32_bf16 v[80:83], a[204:207], a[144:147], v[80:83]
 v_mfma_f32_16x16x32_bf16 v[84:87], a[204:207], a[148:151], v[84:87]
 ds_read_b128 a[140:143], v3 offset:11264
 v_mfma_f32_16x16x32_bf16 v[88:91], a[204:207], a[152:155], v[88:91]
 v_mfma_f32_16x16x32_bf16 v[92:95], a[204:207], a[156:159], v[92:95]
 buffer_load_dwordx4 a[204:207], v1, s[12:15], s24 offen offset:3072
 s_waitcnt vmcnt(30)
 v_mfma_f32_16x16x32_bf16 v[96:99], a[208:211], a[144:147], v[96:99]
 v_mfma_f32_16x16x32_bf16 v[100:103], a[208:211], a[148:151], v[100:103]
 v_mfma_f32_16x16x32_bf16 v[104:107], a[208:211], a[152:155], v[104:107]
 v_mfma_f32_16x16x32_bf16 v[108:111], a[208:211], a[156:159], v[108:111]
 buffer_load_dwordx4 a[208:211], v2, s[12:15], s24 offen
 v_mfma_f32_16x16x32_bf16 v[112:115], a[212:215], a[144:147], v[112:115]
 v_mfma_f32_16x16x32_bf16 v[116:119], a[212:215], a[148:151], v[116:119]
 v_mfma_f32_16x16x32_bf16 v[120:123], a[212:215], a[152:155], v[120:123]
 v_mfma_f32_16x16x32_bf16 v[124:127], a[212:215], a[156:159], v[124:127]
 buffer_load_dwordx4 a[212:215], v2, s[12:15], s24 offen offset:1024
 s_waitcnt vmcnt(30)
 v_mfma_f32_16x16x32_bf16 v[128:131], a[216:219], a[144:147], v[128:131]
 v_mfma_f32_16x16x32_bf16 v[132:135], a[216:219], a[148:151], v[132:135]
 v_mfma_f32_16x16x32_bf16 v[136:139], a[216:219], a[152:155], v[136:139]
 v_mfma_f32_16x16x32_bf16 v[140:143], a[216:219], a[156:159], v[140:143]
 buffer_load_dwordx4 a[216:219], v2, s[12:15], s24 offen offset:2048
 v_mfma_f32_16x16x32_bf16 a[224:227], a[220:223], a[144:147], a[224:227]
 v_mfma_f32_16x16x32_bf16 a[228:231], a[220:223], a[148:151], a[228:231]
 v_mfma_f32_16x16x32_bf16 a[232:235], a[220:223], a[152:155], a[232:235]
 v_mfma_f32_16x16x32_bf16 a[236:239], a[220:223], a[156:159], a[236:239]
 buffer_load_dwordx4 a[220:223], v2, s[12:15], s24 offen offset:3072
 s_add_u32 s24, s24, 32768
 s_waitcnt vmcnt(14)
 s_waitcnt lgkmcnt(0)
 v_mfma_f32_16x16x32_bf16 v[32:35], a[160:163], a[128:131], v[32:35]
 v_mfma_f32_16x16x32_bf16 v[36:39], a[160:163], a[132:135], v[36:39]
 ds_read_b128 a[144:147], v3 offset:12288
 v_mfma_f32_16x16x32_bf16 v[40:43], a[160:163], a[136:139], v[40:43]
 v_mfma_f32_16x16x32_bf16 v[44:47], a[160:163], a[140:143], v[44:47]
 buffer_load_dwordx4 a[160:163], v1, s[12:15], s24 offen
 v_mfma_f32_16x16x32_bf16 v[48:51], a[164:167], a[128:131], v[48:51]
 v_mfma_f32_16x16x32_bf16 v[52:55], a[164:167], a[132:135], v[52:55]
 ds_read_b128 a[148:151], v3 offset:13312
 v_mfma_f32_16x16x32_bf16 v[56:59], a[164:167], a[136:139], v[56:59]
 v_mfma_f32_16x16x32_bf16 v[60:63], a[164:167], a[140:143], v[60:63]
 buffer_load_dwordx4 a[164:167], v1, s[12:15], s24 offen offset:1024
 s_waitcnt vmcnt(14)
 v_mfma_f32_16x16x32_bf16 v[64:67], a[168:171], a[128:131], v[64:67]
 v_mfma_f32_16x16x32_bf16 v[68:71], a[168:171], a[132:135], v[68:71]
 ds_read_b128 a[152:155], v3 offset:14336
 v_mfma_f32_16x16x32_bf16 v[72:75], a[168:171], a[136:139], v[72:75]
 v_mfma_f32_16x16x32_bf16 v[76:79], a[168:171], a[140:143], v[76:79]
 buffer_load_dwordx4 a[168:171], v1, s[12:15], s24 offen offset:2048
 v_mfma_f32_16x16x32_bf16 v[80:83], a[172:175], a[128:131], v[80:83]
 v_mfma_f32_16x16x32_bf16 v[84:87], a[172:175], a[132:135], v[84:87]
 ds_read_b128 a[156:159], v3 offset:15360
 v_mfma_f32_16x16x32_bf16 v[88:91], a[172:175], a[136:139], v[88:91]
 v_mfma_f32_16x16x32_bf16 v[92:95], a[172:175], a[140:143], v[92:95]
 buffer_load_dwordx4 a[172:175], v1, s[12:15], s24 offen offset:3072
 s_waitcnt vmcnt(14)
 v_mfma_f32_16x16x32_bf16 v[96:99], a[176:179], a[128:131], v[96:99]
 v_mfma_f32_16x16x32_bf16 v[100:103], a[176:179], a[132:135], v[100:103]
 v_mfma_f32_16x16x32_bf16 v[104:107], a[176:179], a[136:139], v[104:107]
 v_mfma_f32_16x16x32_bf16 v[108:111], a[176:179], a[140:143], v[108:111]
 buffer_load_dwordx4 a[176:179], v2, s[12:15], s24 offen
 v_mfma_f32_16x16x32_bf16 v[112:115], a[180:183], a[128:131], v[112:115]
 v_mfma_f32_16x16x32_bf16 v[116:119], a[180:183], a[132:135], v[116:119]
 v_mfma_f32_16x16x32_bf16 v[120:123], a[180:183], a[136:139], v[120:123]
 v_mfma_f32_16x16x32_bf16 v[124:127], a[180:183], a[140:143], v[124:127]
 buffer_load_dwordx4 a[180:183], v2, s[12:15], s24 offen offset:1024
 s_waitcnt vmcnt(14)
 v_mfma_f32_16x16x32_bf16 v[128:131], a[184:187], a[128:131], v[128:131]
 v_mfma_f32_16x16x32_bf16 v[132:135], a[184:187], a[132:135], v[132:135]
 v_mfma_f32_16x16x32_bf16 v[136:139], a[184:187], a[136:139], v[136:139]
 v_mfma_f32_16x16x32_bf16 v[140:143], a[184:187], a[140:143], v[140:143]
 buffer_load_dwordx4 a[184:187], v2, s[12:15], s24 offen offset:2048
 v_mfma_f32_16x16x32_bf16 a[224:227], a[188:191], a[128:131], a[224:227]
 v_mfma_f32_16x16x32_bf16 a[228:231], a[188:191], a[132:135], a[228:231]
 v_mfma_f32_16x16x32_bf16 a[232:235], a[188:191], a[136:139], a[232:235]
 v_mfma_f32_16x16x32_bf16 a[236:239], a[188:191], a[140:143], a[236:239]
 buffer_load_dwordx4 a[188:191], v2, s[12:15], s24 offen offset:3072
 s_add_u32 s24, s24, 32768
 s_waitcnt vmcnt(14)
 s_waitcnt lgkmcnt(0)
 v_mfma_f32_16x16x32_bf16 v[32:35], a[192:195], a[144:147], v[32:35]
 v_mfma_f32_16x16x32_bf16 v[36:39], a[192:195], a[148:151], v[36:39]
 ds_read_b128 a[128:131], v3 offset:16384
 v_mfma_f32_16x16x32_bf16 v[40:43], a[192:195], a[152:155], v[40:43]
 v_mfma_f32_16x16x32_bf16 v[44:47], a[192:195], a[156:159], v[44:47]
 buffer_load_dwordx4 a[192:195], v1, s[12:15], s24 offen
 v_mfma_f32_16x16x32_bf16 v[48:51], a[196:199], a[144:147], v[48:51]
 v_mfma_f32_16x16x32_bf16 v[52:55], a[196:199], a[148:151], v[52:55]
 ds_read_b128 a[132:135], v3 offset:17408
 v_mfma_f32_16x16x32_bf16 v[56:59], a[196:199], a[152:155], v[56:59]
 v_mfma_f32_16x16x32_bf16 v[60:63], a[196:199], a[156:159], v[60:63]
 buffer_load_dwordx4 a[196:199], v1, s[12:15], s24 offen offset:1024
 s_waitcnt vmcnt(14)
 v_mfma_f32_16x16x32_bf16 v[64:67], a[200:203], a[144:147], v[64:67]
 v_mfma_f32_16x16x32_bf16 v[68:71], a[200:203], a[148:151], v[68:71]
 ds_read_b128 a[136:139], v3 offset:18432
 v_mfma_f32_16x16x32_bf16 v[72:75], a[200:203], a[152:155], v[72:75]
 v_mfma_f32_16x16x32_bf16 v[76:79], a[200:203], a[156:159], v[76:79]
 buffer_load_dwordx4 a[200:203], v1, s[12:15], s24 offen offset:2048
 v_mfma_f32_16x16x32_bf16 v[80:83], a[204:207], a[144:147], v[80:83]
 v_mfma_f32_16x16x32_bf16 v[84:87], a[204:207], a[148:151], v[84:87]
 ds_read_b128 a[140:143], v3 offset:19456
 v_mfma_f32_16x16x32_bf16 v[88:91], a[204:207], a[152:155], v[88:91]
 v_mfma_f32_16x16x32_bf16 v[92:95], a[204:207], a[156:159], v[92:95]
 buffer_load_dwordx4 a[204:207], v1, s[12:15], s24 offen offset:3072
 s_waitcnt vmcnt(14)
 v_mfma_f32_16x16x32_bf16 v[96:99], a[208:211], a[144:147], v[96:99]
 v_mfma_f32_16x16x32_bf16 v[100:103], a[208:211], a[148:151], v[100:103]
 v_mfma_f32_16x16x32_bf16 v[104:107], a[208:211], a[152:155], v[104:107]
 v_mfma_f32_16x16x32_bf16 v[108:111], a[208:211], a[156:159], v[108:111]
 buffer_load_dwordx4 a[208:211], v2, s[12:15], s24 offen
 v_mfma_f32_16x16x32_bf16 v[112:115], a[212:215], a[144:147], v[112:115]
 v_mfma_f32_16x16x32_bf16 v[116:119], a[212:215], a[148:151], v[116:119]
 v_mfma_f32_16x16x32_bf16 v[120:123], a[212:215], a[152:155], v[120:123]
 v_mfma_f32_16x16x32_bf16 v[124:127], a[212:215], a[156:159], v[124:127]
 buffer_load_dwordx4 a[212:215], v2, s[12:15], s24 offen offset:1024
 s_waitcnt vmcnt(14)
 v_mfma_f32_16x16x32_bf16 v[128:131], a[216:219], a[144:147], v[128:131]
 v_mfma_f32_16x16x32_bf16 v[132:135], a[216:219], a[148:151], v[132:135]
 v_mfma_f32_16x16x32_bf16 v[136:139], a[216:219], a[152:155], v[136:139]
 v_mfma_f32_16x16x32_bf16 v[140:143], a[216:219], a[156:159], v[140:143]
 buffer_load_dwordx4 a[216:219], v2, s[12:15], s24 offen offset:2048
 v_mfma_f32_16x16x32_bf16 a[224:227], a[220:223], a[144:147], a[224:227]
 v_mfma_f32_16x16x32_bf16 a[228:231], a[220:223], a[148:151], a[228:231]
 v_mfma_f32_16x16x32_bf16 a[232:235], a[220:223], a[152:155], a[232:235]
 v_mfma_f32_16x16x32_bf16 a[236:239], a[220:223], a[156:159], a[236:239]
 buffer_load_dwordx4 a[220:223], v2, s[12:15], s24 offen offset:3072
 s_add_u32 s24, s24, 32768
 s_waitcnt vmcnt(14)
 s_waitcnt lgkmcnt(0)
 v_mfma_f32_16x16x32_bf16 v[32:35], a[160:163], a[128:131], v[32:35]
 v_mfma_f32_16x16x32_bf16 v[36:39], a[160:163], a[132:135], v[36:39]
 ds_read_b128 a[144:147], v3 offset:20480
 v_mfma_f32_16x16x32_bf16 v[40:43], a[160:163], a[136:139], v[40:43]
 v_mfma_f32_16x16x32_bf16 v[44:47], a[160:163], a[140:143], v[44:47]
 buffer_load_dwordx4 a[160:163], v1, s[12:15], s24 offen
 v_mfma_f32_16x16x32_bf16 v[48:51], a[164:167], a[128:131], v[48:51]
 v_mfma_f32_16x16x32_bf16 v[52:55], a[164:167], a[132:135], v[52:55]
 ds_read_b128 a[148:151], v3 offset:21504
 v_mfma_f32_16x16x32_bf16 v[56:59], a[164:167], a[136:139], v[56:59]
 v_mfma_f32_16x16x32_bf16 v[60:63], a[164:167], a[140:143], v[60:63]
 buffer_load_dwordx4 a[164:167], v1, s[12:15], s24 offen offset:1024
 s_waitcnt vmcnt(14)
 v_mfma_f32_16x16x32_bf16 v[64:67], a[168:171], a[128:131], v[64:67]
 v_mfma_f32_16x16x32_bf16 v[68:71], a[168:171], a[132:135], v[68:71]
 ds_read_b128 a[152:155], v3 offset:22528
 v_mfma_f32_16x16x32_bf16 v[72:75], a[168:171], a[136:139], v[72:75]
 v_mfma_f32_16x16x32_bf16 v[76:79], a[168:171], a[140:143], v[76:79]
 buffer_load_dwordx4 a[168:171], v1, s[12:15], s24 offen offset:2048
 v_mfma_f32_16x16x32_bf16 v[80:83], a[172:175], a[128:131], v[80:83]
 ds_write_b128 v6, a[64:67]
 v_mfma_f32_16x16x32_bf16 v[84:87], a[172:175], a[132:135], v[84:87]
 ds_read_b128 a[156:159], v3 offset:23552
 v_mfma_f32_16x16x32_bf16 v[88:91], a[172:175], a[136:139], v[88:91]
 v_mfma_f32_16x16x32_bf16 v[92:95], a[172:175], a[140:143], v[92:95]
 buffer_load_dwordx4 a[172:175], v1, s[12:15], s24 offen offset:3072
 s_waitcnt vmcnt(14)
 v_mfma_f32_16x16x32_bf16 v[96:99], a[176:179], a[128:131], v[96:99]
 v_mfma_f32_16x16x32_bf16 v[100:103], a[176:179], a[132:135], v[100:103]
 v_mfma_f32_16x16x32_bf16 v[104:107], a[176:179], a[136:139], v[104:107]
 v_mfma_f32_16x16x32_bf16 v[108:111], a[176:179], a[140:143], v[108:111]
 buffer_load_dwordx4 a[176:179], v2, s[12:15], s24 offen
 v_mfma_f32_16x16x32_bf16 v[112:115], a[180:183], a[128:131], v[112:115]
 v_mfma_f32_16x16x32_bf16 v[116:119], a[180:183], a[132:135], v[116:119]
 v_mfma_f32_16x16x32_bf16 v[120:123], a[180:183], a[136:139], v[120:123]
 v_mfma_f32_16x16x32_bf16 v[124:127], a[180:183], a[140:143], v[124:127]
 buffer_load_dwordx4 a[180:183], v2, s[12:15], s24 offen offset:1024
 s_waitcnt vmcnt(14)
 v_mfma_f32_16x16x32_bf16 v[128:131], a[184:187], a[128:131], v[128:131]
 v_mfma_f32_16x16x32_bf16 v[132:135], a[184:187], a[132:135], v[132:135]
 v_mfma_f32_16x16x32_bf16 v[136:139], a[184:187], a[136:139], v[136:139]
 v_mfma_f32_16x16x32_bf16 v[140:143], a[184:187], a[140:143], v[140:143]
 buffer_load_dwordx4 a[184:187], v2, s[12:15], s24 offen offset:2048
 v_mfma_f32_16x16x32_bf16 a[224:227], a[188:191], a[128:131], a[224:227]
 v_mfma_f32_16x16x32_bf16 a[228:231], a[188:191], a[132:135], a[228:231]
 v_mfma_f32_16x16x32_bf16 a[232:235], a[188:191], a[136:139], a[232:235]
 v_mfma_f32_16x16x32_bf16 a[236:239], a[188:191], a[140:143], a[236:239]
 buffer_load_dwordx4 a[188:191], v2, s[12:15], s24 offen offset:3072
 s_add_u32 s24, s24, 32768
 s_waitcnt vmcnt(14)
 s_waitcnt lgkmcnt(0)
 v_mfma_f32_16x16x32_bf16 v[32:35], a[192:195], a[144:147], v[32:35]
 ds_write_b128 v6, a[68:71] offset:1024
 v_mfma_f32_16x16x32_bf16 v[36:39], a[192:195], a[148:151], v[36:39]
 ds_read_b128 a[128:131], v3 offset:24576
 v_mfma_f32_16x16x32_bf16 v[40:43], a[192:195], a[152:155], v[40:43]
 v_mfma_f32_16x16x32_bf16 v[44:47], a[192:195], a[156:159], v[44:47]
 buffer_load_dwordx4 a[192:195], v1, s[12:15], s24 offen
 v_mfma_f32_16x16x32_bf16 v[48:51], a[196:199], a[144:147], v[48:51]
 v_mfma_f32_16x16x32_bf16 v[52:55], a[196:199], a[148:151], v[52:55]
 ds_read_b128 a[132:135], v3 offset:25600
 v_mfma_f32_16x16x32_bf16 v[56:59], a[196:199], a[152:155], v[56:59]
 v_mfma_f32_16x16x32_bf16 v[60:63], a[196:199], a[156:159], v[60:63]
 buffer_load_dwordx4 a[196:199], v1, s[12:15], s24 offen offset:1024
 s_waitcnt vmcnt(14)
 v_mfma_f32_16x16x32_bf16 v[64:67], a[200:203], a[144:147], v[64:67]
 v_mfma_f32_16x16x32_bf16 v[68:71], a[200:203], a[148:151], v[68:71]
 ds_read_b128 a[136:139], v3 offset:26624
 v_mfma_f32_16x16x32_bf16 v[72:75], a[200:203], a[152:155], v[72:75]
 v_mfma_f32_16x16x32_bf16 v[76:79], a[200:203], a[156:159], v[76:79]
 buffer_load_dwordx4 a[200:203], v1, s[12:15], s24 offen offset:2048
 v_mfma_f32_16x16x32_bf16 v[80:83], a[204:207], a[144:147], v[80:83]
 v_mfma_f32_16x16x32_bf16 v[84:87], a[204:207], a[148:151], v[84:87]
 ds_read_b128 a[140:143], v3 offset:27648
 v_mfma_f32_16x16x32_bf16 v[88:91], a[204:207], a[152:155], v[88:91]
 v_mfma_f32_16x16x32_bf16 v[92:95], a[204:207], a[156:159], v[92:95]
 buffer_load_dwordx4 a[204:207], v1, s[12:15], s24 offen offset:3072
 s_waitcnt vmcnt(14)
 v_mfma_f32_16x16x32_bf16 v[96:99], a[208:211], a[144:147], v[96:99]
 v_mfma_f32_16x16x32_bf16 v[100:103], a[208:211], a[148:151], v[100:103]
 v_mfma_f32_16x16x32_bf16 v[104:107], a[208:211], a[152:155], v[104:107]
 v_mfma_f32_16x16x32_bf16 v[108:111], a[208:211], a[156:159], v[108:111]
 buffer_load_dwordx4 a[208:211], v2, s[12:15], s24 offen
 v_mfma_f32_16x16x32_bf16 v[112:115], a[212:215], a[144:147], v[112:115]
 v_mfma_f32_16x16x32_bf16 v[116:119], a[212:215], a[148:151], v[116:119]
 v_mfma_f32_16x16x32_bf16 v[120:123], a[212:215], a[152:155], v[120:123]
 v_mfma_f32_16x16x32_bf16 v[124:127], a[212:215], a[156:159], v[124:127]
 buffer_load_dwordx4 a[212:215], v2, s[12:15], s24 offen offset:1024
 s_waitcnt vmcnt(14)
 v_mfma_f32_16x16x32_bf16 v[128:131], a[216:219], a[144:147], v[128:131]
 ds_write_b128 v6, a[72:75] offset:2048
 v_mfma_f32_16x16x32_bf16 v[132:135], a[216:219], a[148:151], v[132:135]
 v_mfma_f32_16x16x32_bf16 v[136:139], a[216:219], a[152:155], v[136:139]
 v_mfma_f32_16x16x32_bf16 v[140:143], a[216:219], a[156:159], v[140:143]
 buffer_load_dwordx4 a[216:219], v2, s[12:15], s24 offen offset:2048
 v_mfma_f32_16x16x32_bf16 a[224:227], a[220:223], a[144:147], a[224:227]
 v_mfma_f32_16x16x32_bf16 a[228:231], a[220:223], a[148:151], a[228:231]
 v_mfma_f32_16x16x32_bf16 a[232:235], a[220:223], a[152:155], a[232:235]
 v_mfma_f32_16x16x32_bf16 a[236:239], a[220:223], a[156:159], a[236:239]
 buffer_load_dwordx4 a[220:223], v2, s[12:15], s24 offen offset:3072
 s_add_u32 s24, s24, 32768
 s_waitcnt vmcnt(14)
 s_waitcnt lgkmcnt(1)
 v_mfma_f32_16x16x32_bf16 v[32:35], a[160:163], a[128:131], v[32:35]
 v_mfma_f32_16x16x32_bf16 v[36:39], a[160:163], a[132:135], v[36:39]
 ds_read_b128 a[144:147], v3 offset:28672
 v_mfma_f32_16x16x32_bf16 v[40:43], a[160:163], a[136:139], v[40:43]
 v_mfma_f32_16x16x32_bf16 v[44:47], a[160:163], a[140:143], v[44:47]
 buffer_load_dwordx4 a[160:163], v1, s[12:15], s24 offen
 v_mfma_f32_16x16x32_bf16 v[48:51], a[164:167], a[128:131], v[48:51]
 v_mfma_f32_16x16x32_bf16 v[52:55], a[164:167], a[132:135], v[52:55]
 ds_read_b128 a[148:151], v3 offset:29696
 v_mfma_f32_16x16x32_bf16 v[56:59], a[164:167], a[136:139], v[56:59]
 v_mfma_f32_16x16x32_bf16 v[60:63], a[164:167], a[140:143], v[60:63]
 buffer_load_dwordx4 a[164:167], v1, s[12:15], s24 offen offset:1024
 s_waitcnt vmcnt(14)
 v_mfma_f32_16x16x32_bf16 v[64:67], a[168:171], a[128:131], v[64:67]
 v_mfma_f32_16x16x32_bf16 v[68:71], a[168:171], a[132:135], v[68:71]
 ds_read_b128 a[152:155], v3 offset:30720
 v_mfma_f32_16x16x32_bf16 v[72:75], a[168:171], a[136:139], v[72:75]
 v_mfma_f32_16x16x32_bf16 v[76:79], a[168:171], a[140:143], v[76:79]
 buffer_load_dwordx4 a[168:171], v1, s[12:15], s24 offen offset:2048
 v_mfma_f32_16x16x32_bf16 v[80:83], a[172:175], a[128:131], v[80:83]
 v_mfma_f32_16x16x32_bf16 v[84:87], a[172:175], a[132:135], v[84:87]
 ds_read_b128 a[156:159], v3 offset:31744
 v_mfma_f32_16x16x32_bf16 v[88:91], a[172:175], a[136:139], v[88:91]
 v_mfma_f32_16x16x32_bf16 v[92:95], a[172:175], a[140:143], v[92:95]
 buffer_load_dwordx4 a[172:175], v1, s[12:15], s24 offen offset:3072
 s_waitcnt vmcnt(14)
 v_mfma_f32_16x16x32_bf16 v[96:99], a[176:179], a[128:131], v[96:99]
 ds_write_b128 v6, a[76:79] offset:3072
 v_mfma_f32_16x16x32_bf16 v[100:103], a[176:179], a[132:135], v[100:103]
 v_mfma_f32_16x16x32_bf16 v[104:107], a[176:179], a[136:139], v[104:107]
 v_mfma_f32_16x16x32_bf16 v[108:111], a[176:179], a[140:143], v[108:111]
 buffer_load_dwordx4 a[176:179], v2, s[12:15], s24 offen
 v_mfma_f32_16x16x32_bf16 v[112:115], a[180:183], a[128:131], v[112:115]
 v_mfma_f32_16x16x32_bf16 v[116:119], a[180:183], a[132:135], v[116:119]
 v_mfma_f32_16x16x32_bf16 v[120:123], a[180:183], a[136:139], v[120:123]
 v_mfma_f32_16x16x32_bf16 v[124:127], a[180:183], a[140:143], v[124:127]
 buffer_load_dwordx4 a[180:183], v2, s[12:15], s24 offen offset:1024
 s_waitcnt vmcnt(14)
 v_mfma_f32_16x16x32_bf16 v[128:131], a[184:187], a[128:131], v[128:131]
 v_mfma_f32_16x16x32_bf16 v[132:135], a[184:187], a[132:135], v[132:135]
 v_mfma_f32_16x16x32_bf16 v[136:139], a[184:187], a[136:139], v[136:139]
 v_mfma_f32_16x16x32_bf16 v[140:143], a[184:187], a[140:143], v[140:143]
 buffer_load_dwordx4 a[184:187], v2, s[12:15], s24 offen offset:2048
 v_mfma_f32_16x16x32_bf16 a[224:227], a[188:191], a[128:131], a[224:227]
 v_mfma_f32_16x16x32_bf16 a[228:231], a[188:191], a[132:135], a[228:231]
 v_mfma_f32_16x16x32_bf16 a[232:235], a[188:191], a[136:139], a[232:235]
 v_mfma_f32_16x16x32_bf16 a[236:239], a[188:191], a[140:143], a[236:239]
 buffer_load_dwordx4 a[188:191], v2, s[12:15], s24 offen offset:3072
 s_add_u32 s24, s24, 32768
 s_waitcnt vmcnt(14)
 s_waitcnt lgkmcnt(1)
 v_mfma_f32_16x16x32_bf16 v[32:35], a[192:195], a[144:147], v[32:35]
 v_mfma_f32_16x16x32_bf16 v[36:39], a[192:195], a[148:151], v[36:39]
 ds_read_b128 a[128:131], v3 offset:32768
 v_mfma_f32_16x16x32_bf16 v[40:43], a[192:195], a[152:155], v[40:43]
 ds_write_b128 v6, a[80:83] offset:4096
 v_mfma_f32_16x16x32_bf16 v[44:47], a[192:195], a[156:159], v[44:47]
 buffer_load_dwordx4 a[192:195], v1, s[12:15], s24 offen
 v_mfma_f32_16x16x32_bf16 v[48:51], a[196:199], a[144:147], v[48:51]
 v_mfma_f32_16x16x32_bf16 v[52:55], a[196:199], a[148:151], v[52:55]
 ds_read_b128 a[132:135], v3 offset:33792
 v_mfma_f32_16x16x32_bf16 v[56:59], a[196:199], a[152:155], v[56:59]
 v_mfma_f32_16x16x32_bf16 v[60:63], a[196:199], a[156:159], v[60:63]
 buffer_load_dwordx4 a[196:199], v1, s[12:15], s24 offen offset:1024
 s_waitcnt vmcnt(14)
 v_mfma_f32_16x16x32_bf16 v[64:67], a[200:203], a[144:147], v[64:67]
 v_mfma_f32_16x16x32_bf16 v[68:71], a[200:203], a[148:151], v[68:71]
 ds_read_b128 a[136:139], v3 offset:34816
 v_mfma_f32_16x16x32_bf16 v[72:75], a[200:203], a[152:155], v[72:75]
 v_mfma_f32_16x16x32_bf16 v[76:79], a[200:203], a[156:159], v[76:79]
 buffer_load_dwordx4 a[200:203], v1, s[12:15], s24 offen offset:2048
 v_mfma_f32_16x16x32_bf16 v[80:83], a[204:207], a[144:147], v[80:83]
 v_mfma_f32_16x16x32_bf16 v[84:87], a[204:207], a[148:151], v[84:87]
 ds_read_b128 a[140:143], v3 offset:35840
 v_mfma_f32_16x16x32_bf16 v[88:91], a[204:207], a[152:155], v[88:91]
 v_mfma_f32_16x16x32_bf16 v[92:95], a[204:207], a[156:159], v[92:95]
 buffer_load_dwordx4 a[204:207], v1, s[12:15], s24 offen offset:3072
 s_waitcnt vmcnt(14)
 v_mfma_f32_16x16x32_bf16 v[96:99], a[208:211], a[144:147], v[96:99]
 v_mfma_f32_16x16x32_bf16 v[100:103], a[208:211], a[148:151], v[100:103]
 v_mfma_f32_16x16x32_bf16 v[104:107], a[208:211], a[152:155], v[104:107]
 v_mfma_f32_16x16x32_bf16 v[108:111], a[208:211], a[156:159], v[108:111]
 buffer_load_dwordx4 a[208:211], v2, s[12:15], s24 offen
 v_mfma_f32_16x16x32_bf16 v[112:115], a[212:215], a[144:147], v[112:115]
 v_mfma_f32_16x16x32_bf16 v[116:119], a[212:215], a[148:151], v[116:119]
 v_mfma_f32_16x16x32_bf16 v[120:123], a[212:215], a[152:155], v[120:123]
 v_mfma_f32_16x16x32_bf16 v[124:127], a[212:215], a[156:159], v[124:127]
 buffer_load_dwordx4 a[212:215], v2, s[12:15], s24 offen offset:1024
 s_waitcnt vmcnt(14)
 v_mfma_f32_16x16x32_bf16 v[128:131], a[216:219], a[144:147], v[128:131]
 v_mfma_f32_16x16x32_bf16 v[132:135], a[216:219], a[148:151], v[132:135]
 ds_write_b128 v6, a[84:87] offset:5120
 v_mfma_f32_16x16x32_bf16 v[136:139], a[216:219], a[152:155], v[136:139]
 v_mfma_f32_16x16x32_bf16 v[140:143], a[216:219], a[156:159], v[140:143]
 buffer_load_dwordx4 a[216:219], v2, s[12:15], s24 offen offset:2048
 v_mfma_f32_16x16x32_bf16 a[224:227], a[220:223], a[144:147], a[224:227]
 v_mfma_f32_16x16x32_bf16 a[228:231], a[220:223], a[148:151], a[228:231]
 v_mfma_f32_16x16x32_bf16 a[232:235], a[220:223], a[152:155], a[232:235]
 v_mfma_f32_16x16x32_bf16 a[236:239], a[220:223], a[156:159], a[236:239]
 buffer_load_dwordx4 a[220:223], v2, s[12:15], s24 offen offset:3072
 s_add_u32 s24, s24, 32768
 s_waitcnt vmcnt(14)
 s_waitcnt lgkmcnt(1)
 v_mfma_f32_16x16x32_bf16 v[32:35], a[160:163], a[128:131], v[32:35]
 v_mfma_f32_16x16x32_bf16 v[36:39], a[160:163], a[132:135], v[36:39]
 ds_read_b128 a[144:147], v3 offset:36864
 v_mfma_f32_16x16x32_bf16 v[40:43], a[160:163], a[136:139], v[40:43]
 v_mfma_f32_16x16x32_bf16 v[44:47], a[160:163], a[140:143], v[44:47]
 buffer_load_dwordx4 a[160:163], v1, s[12:15], s24 offen
 v_mfma_f32_16x16x32_bf16 v[48:51], a[164:167], a[128:131], v[48:51]
 v_mfma_f32_16x16x32_bf16 v[52:55], a[164:167], a[132:135], v[52:55]
 ds_read_b128 a[148:151], v3 offset:37888
 v_mfma_f32_16x16x32_bf16 v[56:59], a[164:167], a[136:139], v[56:59]
 v_mfma_f32_16x16x32_bf16 v[60:63], a[164:167], a[140:143], v[60:63]
 buffer_load_dwordx4 a[164:167], v1, s[12:15], s24 offen offset:1024
 s_waitcnt vmcnt(14)
 v_mfma_f32_16x16x32_bf16 v[64:67], a[168:171], a[128:131], v[64:67]
 v_mfma_f32_16x16x32_bf16 v[68:71], a[168:171], a[132:135], v[68:71]
 ds_read_b128 a[152:155], v3 offset:38912
 v_mfma_f32_16x16x32_bf16 v[72:75], a[168:171], a[136:139], v[72:75]
 v_mfma_f32_16x16x32_bf16 v[76:79], a[168:171], a[140:143], v[76:79]
 buffer_load_dwordx4 a[168:171], v1, s[12:15], s24 offen offset:2048
 v_mfma_f32_16x16x32_bf16 v[80:83], a[172:175], a[128:131], v[80:83]
 v_mfma_f32_16x16x32_bf16 v[84:87], a[172:175], a[132:135], v[84:87]
 ds_read_b128 a[156:159], v3 offset:39936
 v_mfma_f32_16x16x32_bf16 v[88:91], a[172:175], a[136:139], v[88:91]
 v_mfma_f32_16x16x32_bf16 v[92:95], a[172:175], a[140:143], v[92:95]
 buffer_load_dwordx4 a[172:175], v1, s[12:15], s24 offen offset:3072
 s_waitcnt vmcnt(14)
 v_mfma_f32_16x16x32_bf16 v[96:99], a[176:179], a[128:131], v[96:99]
 v_mfma_f32_16x16x32_bf16 v[100:103], a[176:179], a[132:135], v[100:103]
 ds_write_b128 v6, a[88:91] offset:6144
 v_mfma_f32_16x16x32_bf16 v[104:107], a[176:179], a[136:139], v[104:107]
 v_mfma_f32_16x16x32_bf16 v[108:111], a[176:179], a[140:143], v[108:111]
 buffer_load_dwordx4 a[176:179], v2, s[12:15], s24 offen
 v_mfma_f32_16x16x32_bf16 v[112:115], a[180:183], a[128:131], v[112:115]
 v_mfma_f32_16x16x32_bf16 v[116:119], a[180:183], a[132:135], v[116:119]
 v_mfma_f32_16x16x32_bf16 v[120:123], a[180:183], a[136:139], v[120:123]
 v_mfma_f32_16x16x32_bf16 v[124:127], a[180:183], a[140:143], v[124:127]
 buffer_load_dwordx4 a[180:183], v2, s[12:15], s24 offen offset:1024
 s_waitcnt vmcnt(14)
 v_mfma_f32_16x16x32_bf16 v[128:131], a[184:187], a[128:131], v[128:131]
 v_mfma_f32_16x16x32_bf16 v[132:135], a[184:187], a[132:135], v[132:135]
 v_mfma_f32_16x16x32_bf16 v[136:139], a[184:187], a[136:139], v[136:139]
 v_mfma_f32_16x16x32_bf16 v[140:143], a[184:187], a[140:143], v[140:143]
 buffer_load_dwordx4 a[184:187], v2, s[12:15], s24 offen offset:2048
 v_mfma_f32_16x16x32_bf16 a[224:227], a[188:191], a[128:131], a[224:227]
 v_mfma_f32_16x16x32_bf16 a[228:231], a[188:191], a[132:135], a[228:231]
 v_mfma_f32_16x16x32_bf16 a[232:235], a[188:191], a[136:139], a[232:235]
 v_mfma_f32_16x16x32_bf16 a[236:239], a[188:191], a[140:143], a[236:239]
 buffer_load_dwordx4 a[188:191], v2, s[12:15], s24 offen offset:3072
 s_add_u32 s24, s24, 32768
 s_waitcnt vmcnt(14)
 s_waitcnt lgkmcnt(1)
 v_mfma_f32_16x16x32_bf16 v[32:35], a[192:195], a[144:147], v[32:35]
 v_mfma_f32_16x16x32_bf16 v[36:39], a[192:195], a[148:151], v[36:39]
 ds_read_b128 a[128:131], v3 offset:40960
 v_mfma_f32_16x16x32_bf16 v[40:43], a[192:195], a[152:155], v[40:43]
 v_mfma_f32_16x16x32_bf16 v[44:47], a[192:195], a[156:159], v[44:47]
 buffer_load_dwordx4 a[192:195], v1, s[12:15], s24 offen
 v_mfma_f32_16x16x32_bf16 v[48:51], a[196:199], a[144:147], v[48:51]
 v_mfma_f32_16x16x32_bf16 v[52:55], a[196:199], a[148:151], v[52:55]
 ds_read_b128 a[132:135], v3 offset:41984
 v_mfma_f32_16x16x32_bf16 v[56:59], a[196:199], a[152:155], v[56:59]
 ds_write_b128 v6, a[92:95] offset:7168
 v_mfma_f32_16x16x32_bf16 v[60:63], a[196:199], a[156:159], v[60:63]
 buffer_load_dwordx4 a[196:199], v1, s[12:15], s24 offen offset:1024
 s_waitcnt vmcnt(14)
 v_mfma_f32_16x16x32_bf16 v[64:67], a[200:203], a[144:147], v[64:67]
 v_mfma_f32_16x16x32_bf16 v[68:71], a[200:203], a[148:151], v[68:71]
 ds_read_b128 a[136:139], v3 offset:43008
 v_mfma_f32_16x16x32_bf16 v[72:75], a[200:203], a[152:155], v[72:75]
 v_mfma_f32_16x16x32_bf16 v[76:79], a[200:203], a[156:159], v[76:79]
 buffer_load_dwordx4 a[200:203], v1, s[12:15], s24 offen offset:2048
 v_mfma_f32_16x16x32_bf16 v[80:83], a[204:207], a[144:147], v[80:83]
 v_mfma_f32_16x16x32_bf16 v[84:87], a[204:207], a[148:151], v[84:87]
 ds_read_b128 a[140:143], v3 offset:44032
 v_mfma_f32_16x16x32_bf16 v[88:91], a[204:207], a[152:155], v[88:91]
 v_mfma_f32_16x16x32_bf16 v[92:95], a[204:207], a[156:159], v[92:95]
 buffer_load_dwordx4 a[204:207], v1, s[12:15], s24 offen offset:3072
 s_waitcnt vmcnt(14)
 v_mfma_f32_16x16x32_bf16 v[96:99], a[208:211], a[144:147], v[96:99]
 v_mfma_f32_16x16x32_bf16 v[100:103], a[208:211], a[148:151], v[100:103]
 v_mfma_f32_16x16x32_bf16 v[104:107], a[208:211], a[152:155], v[104:107]
 v_mfma_f32_16x16x32_bf16 v[108:111], a[208:211], a[156:159], v[108:111]
 buffer_load_dwordx4 a[208:211], v2, s[12:15], s24 offen
 v_mfma_f32_16x16x32_bf16 v[112:115], a[212:215], a[144:147], v[112:115]
 v_mfma_f32_16x16x32_bf16 v[116:119], a[212:215], a[148:151], v[116:119]
 v_mfma_f32_16x16x32_bf16 v[120:123], a[212:215], a[152:155], v[120:123]
 v_mfma_f32_16x16x32_bf16 v[124:127], a[212:215], a[156:159], v[124:127]
 buffer_load_dwordx4 a[212:215], v2, s[12:15], s24 offen offset:1024
 s_waitcnt vmcnt(14)
 v_mfma_f32_16x16x32_bf16 v[128:131], a[216:219], a[144:147], v[128:131]
 v_mfma_f32_16x16x32_bf16 v[132:135], a[216:219], a[148:151], v[132:135]
 v_mfma_f32_16x16x32_bf16 v[136:139], a[216:219], a[152:155], v[136:139]
 ds_write_b128 v6, a[96:99] offset:8192
 v_mfma_f32_16x16x32_bf16 v[140:143], a[216:219], a[156:159], v[140:143]
 buffer_load_dwordx4 a[216:219], v2, s[12:15], s24 offen offset:2048
 v_mfma_f32_16x16x32_bf16 a[224:227], a[220:223], a[144:147], a[224:227]
 v_mfma_f32_16x16x32_bf16 a[228:231], a[220:223], a[148:151], a[228:231]
 v_mfma_f32_16x16x32_bf16 a[232:235], a[220:223], a[152:155], a[232:235]
 v_mfma_f32_16x16x32_bf16 a[236:239], a[220:223], a[156:159], a[236:239]
 buffer_load_dwordx4 a[220:223], v2, s[12:15], s24 offen offset:3072
 s_add_u32 s24, s24, 32768
 s_waitcnt vmcnt(14)
 s_waitcnt lgkmcnt(1)
 v_mfma_f32_16x16x32_bf16 v[32:35], a[160:163], a[128:131], v[32:35]
 v_mfma_f32_16x16x32_bf16 v[36:39], a[160:163], a[132:135], v[36:39]
 ds_read_b128 a[144:147], v3 offset:45056
 v_mfma_f32_16x16x32_bf16 v[40:43], a[160:163], a[136:139], v[40:43]
 v_mfma_f32_16x16x32_bf16 v[44:47], a[160:163], a[140:143], v[44:47]
 buffer_load_dwordx4 a[160:163], v1, s[12:15], s24 offen
 v_mfma_f32_16x16x32_bf16 v[48:51], a[164:167], a[128:131], v[48:51]
 v_mfma_f32_16x16x32_bf16 v[52:55], a[164:167], a[132:135], v[52:55]
 ds_read_b128 a[148:151], v3 offset:46080
 v_mfma_f32_16x16x32_bf16 v[56:59], a[164:167], a[136:139], v[56:59]
 v_mfma_f32_16x16x32_bf16 v[60:63], a[164:167], a[140:143], v[60:63]
 buffer_load_dwordx4 a[164:167], v1, s[12:15], s24 offen offset:1024
 s_waitcnt vmcnt(14)
 v_mfma_f32_16x16x32_bf16 v[64:67], a[168:171], a[128:131], v[64:67]
 v_mfma_f32_16x16x32_bf16 v[68:71], a[168:171], a[132:135], v[68:71]
 ds_read_b128 a[152:155], v3 offset:47104
 v_mfma_f32_16x16x32_bf16 v[72:75], a[168:171], a[136:139], v[72:75]
 v_mfma_f32_16x16x32_bf16 v[76:79], a[168:171], a[140:143], v[76:79]
 buffer_load_dwordx4 a[168:171], v1, s[12:15], s24 offen offset:2048
 v_mfma_f32_16x16x32_bf16 v[80:83], a[172:175], a[128:131], v[80:83]
 v_mfma_f32_16x16x32_bf16 v[84:87], a[172:175], a[132:135], v[84:87]
 ds_read_b128 a[156:159], v3 offset:48128
 v_mfma_f32_16x16x32_bf16 v[88:91], a[172:175], a[136:139], v[88:91]
 v_mfma_f32_16x16x32_bf16 v[92:95], a[172:175], a[140:143], v[92:95]
 buffer_load_dwordx4 a[172:175], v1, s[12:15], s24 offen offset:3072
 s_waitcnt vmcnt(14)
 v_mfma_f32_16x16x32_bf16 v[96:99], a[176:179], a[128:131], v[96:99]
 v_mfma_f32_16x16x32_bf16 v[100:103], a[176:179], a[132:135], v[100:103]
 v_mfma_f32_16x16x32_bf16 v[104:107], a[176:179], a[136:139], v[104:107]
 ds_write_b128 v6, a[100:103] offset:9216
 v_mfma_f32_16x16x32_bf16 v[108:111], a[176:179], a[140:143], v[108:111]
 buffer_load_dwordx4 a[176:179], v2, s[12:15], s24 offen
 v_mfma_f32_16x16x32_bf16 v[112:115], a[180:183], a[128:131], v[112:115]
 v_mfma_f32_16x16x32_bf16 v[116:119], a[180:183], a[132:135], v[116:119]
 v_mfma_f32_16x16x32_bf16 v[120:123], a[180:183], a[136:139], v[120:123]
 v_mfma_f32_16x16x32_bf16 v[124:127], a[180:183], a[140:143], v[124:127]
 buffer_load_dwordx4 a[180:183], v2, s[12:15], s24 offen offset:1024
 s_waitcnt vmcnt(14)
 v_mfma_f32_16x16x32_bf16 v[128:131], a[184:187], a[128:131], v[128:131]
 v_mfma_f32_16x16x32_bf16 v[132:135], a[184:187], a[132:135], v[132:135]
 v_mfma_f32_16x16x32_bf16 v[136:139], a[184:187], a[136:139], v[136:139]
 v_mfma_f32_16x16x32_bf16 v[140:143], a[184:187], a[140:143], v[140:143]
 buffer_load_dwordx4 a[184:187], v2, s[12:15], s24 offen offset:2048
 v_mfma_f32_16x16x32_bf16 a[224:227], a[188:191], a[128:131], a[224:227]
 v_mfma_f32_16x16x32_bf16 a[228:231], a[188:191], a[132:135], a[228:231]
 v_mfma_f32_16x16x32_bf16 a[232:235], a[188:191], a[136:139], a[232:235]
 v_mfma_f32_16x16x32_bf16 a[236:239], a[188:191], a[140:143], a[236:239]
 buffer_load_dwordx4 a[188:191], v2, s[12:15], s24 offen offset:3072
 s_add_u32 s24, s24, 32768
 s_waitcnt vmcnt(14)
 s_waitcnt lgkmcnt(1)
 v_mfma_f32_16x16x32_bf16 v[32:35], a[192:195], a[144:147], v[32:35]
 v_mfma_f32_16x16x32_bf16 v[36:39], a[192:195], a[148:151], v[36:39]
 ds_read_b128 a[128:131], v3 offset:49152
 v_mfma_f32_16x16x32_bf16 v[40:43], a[192:195], a[152:155], v[40:43]
 v_mfma_f32_16x16x32_bf16 v[44:47], a[192:195], a[156:159], v[44:47]
 buffer_load_dwordx4 a[192:195], v1, s[12:15], s24 offen
 v_mfma_f32_16x16x32_bf16 v[48:51], a[196:199], a[144:147], v[48:51]
 v_mfma_f32_16x16x32_bf16 v[52:55], a[196:199], a[148:151], v[52:55]
 ds_read_b128 a[132:135], v3 offset:50176
 v_mfma_f32_16x16x32_bf16 v[56:59], a[196:199], a[152:155], v[56:59]
 v_mfma_f32_16x16x32_bf16 v[60:63], a[196:199], a[156:159], v[60:63]
 buffer_load_dwordx4 a[196:199], v1, s[12:15], s24 offen offset:1024
 s_waitcnt vmcnt(14)
 v_mfma_f32_16x16x32_bf16 v[64:67], a[200:203], a[144:147], v[64:67]
 ds_write_b128 v6, a[104:107] offset:10240
 v_mfma_f32_16x16x32_bf16 v[68:71], a[200:203], a[148:151], v[68:71]
 ds_read_b128 a[136:139], v3 offset:51200
 v_mfma_f32_16x16x32_bf16 v[72:75], a[200:203], a[152:155], v[72:75]
 v_mfma_f32_16x16x32_bf16 v[76:79], a[200:203], a[156:159], v[76:79]
 buffer_load_dwordx4 a[200:203], v1, s[12:15], s24 offen offset:2048
 v_mfma_f32_16x16x32_bf16 v[80:83], a[204:207], a[144:147], v[80:83]
 v_mfma_f32_16x16x32_bf16 v[84:87], a[204:207], a[148:151], v[84:87]
 ds_read_b128 a[140:143], v3 offset:52224
 v_mfma_f32_16x16x32_bf16 v[88:91], a[204:207], a[152:155], v[88:91]
 v_mfma_f32_16x16x32_bf16 v[92:95], a[204:207], a[156:159], v[92:95]
 buffer_load_dwordx4 a[204:207], v1, s[12:15], s24 offen offset:3072
 s_waitcnt vmcnt(14)
 v_mfma_f32_16x16x32_bf16 v[96:99], a[208:211], a[144:147], v[96:99]
 v_mfma_f32_16x16x32_bf16 v[100:103], a[208:211], a[148:151], v[100:103]
 v_mfma_f32_16x16x32_bf16 v[104:107], a[208:211], a[152:155], v[104:107]
 v_mfma_f32_16x16x32_bf16 v[108:111], a[208:211], a[156:159], v[108:111]
 buffer_load_dwordx4 a[208:211], v2, s[12:15], s24 offen
 v_mfma_f32_16x16x32_bf16 v[112:115], a[212:215], a[144:147], v[112:115]
 v_mfma_f32_16x16x32_bf16 v[116:119], a[212:215], a[148:151], v[116:119]
 v_mfma_f32_16x16x32_bf16 v[120:123], a[212:215], a[152:155], v[120:123]
 v_mfma_f32_16x16x32_bf16 v[124:127], a[212:215], a[156:159], v[124:127]
 buffer_load_dwordx4 a[212:215], v2, s[12:15], s24 offen offset:1024
 s_waitcnt vmcnt(14)
 v_mfma_f32_16x16x32_bf16 v[128:131], a[216:219], a[144:147], v[128:131]
 v_mfma_f32_16x16x32_bf16 v[132:135], a[216:219], a[148:151], v[132:135]
 v_mfma_f32_16x16x32_bf16 v[136:139], a[216:219], a[152:155], v[136:139]
 v_mfma_f32_16x16x32_bf16 v[140:143], a[216:219], a[156:159], v[140:143]
 buffer_load_dwordx4 a[216:219], v2, s[12:15], s24 offen offset:2048
 v_mfma_f32_16x16x32_bf16 a[224:227], a[220:223], a[144:147], a[224:227]
 v_mfma_f32_16x16x32_bf16 a[228:231], a[220:223], a[148:151], a[228:231]
 ds_write_b128 v6, a[108:111] offset:11264
 v_mfma_f32_16x16x32_bf16 a[232:235], a[220:223], a[152:155], a[232:235]
 v_mfma_f32_16x16x32_bf16 a[236:239], a[220:223], a[156:159], a[236:239]
 buffer_load_dwordx4 a[220:223], v2, s[12:15], s24 offen offset:3072
 s_add_u32 s24, s24, 32768
 s_waitcnt vmcnt(14)
 s_waitcnt lgkmcnt(1)
 v_mfma_f32_16x16x32_bf16 v[32:35], a[160:163], a[128:131], v[32:35]
 v_mfma_f32_16x16x32_bf16 v[36:39], a[160:163], a[132:135], v[36:39]
 ds_read_b128 a[144:147], v3 offset:53248
 v_mfma_f32_16x16x32_bf16 v[40:43], a[160:163], a[136:139], v[40:43]
 v_mfma_f32_16x16x32_bf16 v[44:47], a[160:163], a[140:143], v[44:47]
 buffer_load_dwordx4 a[160:163], v1, s[12:15], s24 offen
 v_mfma_f32_16x16x32_bf16 v[48:51], a[164:167], a[128:131], v[48:51]
 v_mfma_f32_16x16x32_bf16 v[52:55], a[164:167], a[132:135], v[52:55]
 ds_read_b128 a[148:151], v3 offset:54272
 v_mfma_f32_16x16x32_bf16 v[56:59], a[164:167], a[136:139], v[56:59]
 v_mfma_f32_16x16x32_bf16 v[60:63], a[164:167], a[140:143], v[60:63]
 buffer_load_dwordx4 a[164:167], v1, s[12:15], s24 offen offset:1024
 s_waitcnt vmcnt(14)
 v_mfma_f32_16x16x32_bf16 v[64:67], a[168:171], a[128:131], v[64:67]
 v_mfma_f32_16x16x32_bf16 v[68:71], a[168:171], a[132:135], v[68:71]
 ds_read_b128 a[152:155], v3 offset:55296
 v_mfma_f32_16x16x32_bf16 v[72:75], a[168:171], a[136:139], v[72:75]
 v_mfma_f32_16x16x32_bf16 v[76:79], a[168:171], a[140:143], v[76:79]
 buffer_load_dwordx4 a[168:171], v1, s[12:15], s24 offen offset:2048
 v_mfma_f32_16x16x32_bf16 v[80:83], a[172:175], a[128:131], v[80:83]
 v_mfma_f32_16x16x32_bf16 v[84:87], a[172:175], a[132:135], v[84:87]
 ds_read_b128 a[156:159], v3 offset:56320
 v_mfma_f32_16x16x32_bf16 v[88:91], a[172:175], a[136:139], v[88:91]
 v_mfma_f32_16x16x32_bf16 v[92:95], a[172:175], a[140:143], v[92:95]
 buffer_load_dwordx4 a[172:175], v1, s[12:15], s24 offen offset:3072
 s_waitcnt vmcnt(14)
 v_mfma_f32_16x16x32_bf16 v[96:99], a[176:179], a[128:131], v[96:99]
 v_mfma_f32_16x16x32_bf16 v[100:103], a[176:179], a[132:135], v[100:103]
 v_mfma_f32_16x16x32_bf16 v[104:107], a[176:179], a[136:139], v[104:107]
 v_mfma_f32_16x16x32_bf16 v[108:111], a[176:179], a[140:143], v[108:111]
 buffer_load_dwordx4 a[176:179], v2, s[12:15], s24 offen
 v_mfma_f32_16x16x32_bf16 v[112:115], a[180:183], a[128:131], v[112:115]
 ds_write_b128 v6, a[112:115] offset:12288
 v_mfma_f32_16x16x32_bf16 v[116:119], a[180:183], a[132:135], v[116:119]
 v_mfma_f32_16x16x32_bf16 v[120:123], a[180:183], a[136:139], v[120:123]
 v_mfma_f32_16x16x32_bf16 v[124:127], a[180:183], a[140:143], v[124:127]
 buffer_load_dwordx4 a[180:183], v2, s[12:15], s24 offen offset:1024
 s_waitcnt vmcnt(14)
 v_mfma_f32_16x16x32_bf16 v[128:131], a[184:187], a[128:131], v[128:131]
 v_mfma_f32_16x16x32_bf16 v[132:135], a[184:187], a[132:135], v[132:135]
 v_mfma_f32_16x16x32_bf16 v[136:139], a[184:187], a[136:139], v[136:139]
 v_mfma_f32_16x16x32_bf16 v[140:143], a[184:187], a[140:143], v[140:143]
 buffer_load_dwordx4 a[184:187], v2, s[12:15], s24 offen offset:2048
 v_mfma_f32_16x16x32_bf16 a[224:227], a[188:191], a[128:131], a[224:227]
 v_mfma_f32_16x16x32_bf16 a[228:231], a[188:191], a[132:135], a[228:231]
 v_mfma_f32_16x16x32_bf16 a[232:235], a[188:191], a[136:139], a[232:235]
 v_mfma_f32_16x16x32_bf16 a[236:239], a[188:191], a[140:143], a[236:239]
 buffer_load_dwordx4 a[188:191], v2, s[12:15], s24 offen offset:3072
 s_add_u32 s24, s24, 32768
 s_waitcnt vmcnt(14)
 s_waitcnt lgkmcnt(1)
 v_mfma_f32_16x16x32_bf16 v[32:35], a[192:195], a[144:147], v[32:35]
 v_mfma_f32_16x16x32_bf16 v[36:39], a[192:195], a[148:151], v[36:39]
 ds_read_b128 a[128:131], v3 offset:57344
 v_mfma_f32_16x16x32_bf16 v[40:43], a[192:195], a[152:155], v[40:43]
 v_mfma_f32_16x16x32_bf16 v[44:47], a[192:195], a[156:159], v[44:47]
 buffer_load_dwordx4 a[192:195], v1, s[12:15], s24 offen
 v_mfma_f32_16x16x32_bf16 v[48:51], a[196:199], a[144:147], v[48:51]
 v_mfma_f32_16x16x32_bf16 v[52:55], a[196:199], a[148:151], v[52:55]
 ds_read_b128 a[132:135], v3 offset:58368
 v_mfma_f32_16x16x32_bf16 v[56:59], a[196:199], a[152:155], v[56:59]
 v_mfma_f32_16x16x32_bf16 v[60:63], a[196:199], a[156:159], v[60:63]
 buffer_load_dwordx4 a[196:199], v1, s[12:15], s24 offen offset:1024
 s_waitcnt vmcnt(14)
 v_mfma_f32_16x16x32_bf16 v[64:67], a[200:203], a[144:147], v[64:67]
 v_mfma_f32_16x16x32_bf16 v[68:71], a[200:203], a[148:151], v[68:71]
 ds_read_b128 a[136:139], v3 offset:59392
 v_mfma_f32_16x16x32_bf16 v[72:75], a[200:203], a[152:155], v[72:75]
 ds_write_b128 v6, a[116:119] offset:13312
 v_mfma_f32_16x16x32_bf16 v[76:79], a[200:203], a[156:159], v[76:79]
 buffer_load_dwordx4 a[200:203], v1, s[12:15], s24 offen offset:2048
 v_mfma_f32_16x16x32_bf16 v[80:83], a[204:207], a[144:147], v[80:83]
 v_mfma_f32_16x16x32_bf16 v[84:87], a[204:207], a[148:151], v[84:87]
 ds_read_b128 a[140:143], v3 offset:60416
 v_mfma_f32_16x16x32_bf16 v[88:91], a[204:207], a[152:155], v[88:91]
 v_mfma_f32_16x16x32_bf16 v[92:95], a[204:207], a[156:159], v[92:95]
 buffer_load_dwordx4 a[204:207], v1, s[12:15], s24 offen offset:3072
 s_waitcnt vmcnt(14)
 v_mfma_f32_16x16x32_bf16 v[96:99], a[208:211], a[144:147], v[96:99]
 v_mfma_f32_16x16x32_bf16 v[100:103], a[208:211], a[148:151], v[100:103]
 v_mfma_f32_16x16x32_bf16 v[104:107], a[208:211], a[152:155], v[104:107]
 v_mfma_f32_16x16x32_bf16 v[108:111], a[208:211], a[156:159], v[108:111]
 buffer_load_dwordx4 a[208:211], v2, s[12:15], s24 offen
 v_mfma_f32_16x16x32_bf16 v[112:115], a[212:215], a[144:147], v[112:115]
 v_mfma_f32_16x16x32_bf16 v[116:119], a[212:215], a[148:151], v[116:119]
 v_mfma_f32_16x16x32_bf16 v[120:123], a[212:215], a[152:155], v[120:123]
 v_mfma_f32_16x16x32_bf16 v[124:127], a[212:215], a[156:159], v[124:127]
 buffer_load_dwordx4 a[212:215], v2, s[12:15], s24 offen offset:1024
 s_waitcnt vmcnt(14)
 v_mfma_f32_16x16x32_bf16 v[128:131], a[216:219], a[144:147], v[128:131]
 v_mfma_f32_16x16x32_bf16 v[132:135], a[216:219], a[148:151], v[132:135]
 v_mfma_f32_16x16x32_bf16 v[136:139], a[216:219], a[152:155], v[136:139]
 v_mfma_f32_16x16x32_bf16 v[140:143], a[216:219], a[156:159], v[140:143]
 buffer_load_dwordx4 a[216:219], v2, s[12:15], s24 offen offset:2048
 v_mfma_f32_16x16x32_bf16 a[224:227], a[220:223], a[144:147], a[224:227]
 v_mfma_f32_16x16x32_bf16 a[228:231], a[220:223], a[148:151], a[228:231]
 v_mfma_f32_16x16x32_bf16 a[232:235], a[220:223], a[152:155], a[232:235]
 ds_write_b128 v6, a[120:123] offset:14336
 v_mfma_f32_16x16x32_bf16 a[236:239], a[220:223], a[156:159], a[236:239]
 buffer_load_dwordx4 a[220:223], v2, s[12:15], s24 offen offset:3072
 s_add_u32 s24, s24, 32768
 s_waitcnt vmcnt(14)
 s_waitcnt lgkmcnt(1)
 v_mfma_f32_16x16x32_bf16 v[32:35], a[160:163], a[128:131], v[32:35]
 v_mfma_f32_16x16x32_bf16 v[36:39], a[160:163], a[132:135], v[36:39]
 ds_read_b128 a[144:147], v3 offset:61440
 v_mfma_f32_16x16x32_bf16 v[40:43], a[160:163], a[136:139], v[40:43]
 v_mfma_f32_16x16x32_bf16 v[44:47], a[160:163], a[140:143], v[44:47]
 buffer_load_dwordx4 a[160:163], v1, s[12:15], s24 offen
 v_mfma_f32_16x16x32_bf16 v[48:51], a[164:167], a[128:131], v[48:51]
 v_mfma_f32_16x16x32_bf16 v[52:55], a[164:167], a[132:135], v[52:55]
 ds_read_b128 a[148:151], v3 offset:62464
 v_mfma_f32_16x16x32_bf16 v[56:59], a[164:167], a[136:139], v[56:59]
 v_mfma_f32_16x16x32_bf16 v[60:63], a[164:167], a[140:143], v[60:63]
 buffer_load_dwordx4 a[164:167], v1, s[12:15], s24 offen offset:1024
 s_waitcnt vmcnt(14)
 v_mfma_f32_16x16x32_bf16 v[64:67], a[168:171], a[128:131], v[64:67]
 v_mfma_f32_16x16x32_bf16 v[68:71], a[168:171], a[132:135], v[68:71]
 ds_read_b128 a[152:155], v3 offset:63488
 v_mfma_f32_16x16x32_bf16 v[72:75], a[168:171], a[136:139], v[72:75]
 v_mfma_f32_16x16x32_bf16 v[76:79], a[168:171], a[140:143], v[76:79]
 buffer_load_dwordx4 a[168:171], v1, s[12:15], s24 offen offset:2048
 v_mfma_f32_16x16x32_bf16 v[80:83], a[172:175], a[128:131], v[80:83]
 v_mfma_f32_16x16x32_bf16 v[84:87], a[172:175], a[132:135], v[84:87]
 ds_read_b128 a[156:159], v3 offset:64512
 v_mfma_f32_16x16x32_bf16 v[88:91], a[172:175], a[136:139], v[88:91]
 v_mfma_f32_16x16x32_bf16 v[92:95], a[172:175], a[140:143], v[92:95]
 buffer_load_dwordx4 a[172:175], v1, s[12:15], s24 offen offset:3072
 s_waitcnt vmcnt(14)
 v_mfma_f32_16x16x32_bf16 v[96:99], a[176:179], a[128:131], v[96:99]
 v_mfma_f32_16x16x32_bf16 v[100:103], a[176:179], a[132:135], v[100:103]
 v_mfma_f32_16x16x32_bf16 v[104:107], a[176:179], a[136:139], v[104:107]
 v_mfma_f32_16x16x32_bf16 v[108:111], a[176:179], a[140:143], v[108:111]
 buffer_load_dwordx4 a[176:179], v2, s[12:15], s24 offen
 v_mfma_f32_16x16x32_bf16 v[112:115], a[180:183], a[128:131], v[112:115]
 v_mfma_f32_16x16x32_bf16 v[116:119], a[180:183], a[132:135], v[116:119]
 v_mfma_f32_16x16x32_bf16 v[120:123], a[180:183], a[136:139], v[120:123]
 ds_write_b128 v6, a[124:127] offset:15360
 v_mfma_f32_16x16x32_bf16 v[124:127], a[180:183], a[140:143], v[124:127]
 buffer_load_dwordx4 a[180:183], v2, s[12:15], s24 offen offset:1024
 s_waitcnt vmcnt(14)
 v_mfma_f32_16x16x32_bf16 v[128:131], a[184:187], a[128:131], v[128:131]
 v_mfma_f32_16x16x32_bf16 v[132:135], a[184:187], a[132:135], v[132:135]
 v_mfma_f32_16x16x32_bf16 v[136:139], a[184:187], a[136:139], v[136:139]
 v_mfma_f32_16x16x32_bf16 v[140:143], a[184:187], a[140:143], v[140:143]
 buffer_load_dwordx4 a[184:187], v2, s[12:15], s24 offen offset:2048
 v_mfma_f32_16x16x32_bf16 a[224:227], a[188:191], a[128:131], a[224:227]
 v_mfma_f32_16x16x32_bf16 a[228:231], a[188:191], a[132:135], a[228:231]
 v_mfma_f32_16x16x32_bf16 a[232:235], a[188:191], a[136:139], a[232:235]
 v_mfma_f32_16x16x32_bf16 a[236:239], a[188:191], a[140:143], a[236:239]
 buffer_load_dwordx4 a[188:191], v2, s[12:15], s24 offen offset:3072
 s_add_u32 s24, s24, 32768
 s_waitcnt vmcnt(14)
 s_waitcnt lgkmcnt(0)
 s_barrier
 v_mfma_f32_16x16x32_bf16 v[32:35], a[192:195], a[144:147], v[32:35]
 v_mfma_f32_16x16x32_bf16 v[36:39], a[192:195], a[148:151], v[36:39]
 ds_read_b128 a[128:131], v4
 v_mfma_f32_16x16x32_bf16 v[40:43], a[192:195], a[152:155], v[40:43]
 v_mfma_f32_16x16x32_bf16 v[44:47], a[192:195], a[156:159], v[44:47]
 buffer_load_dwordx4 a[192:195], v1, s[12:15], s24 offen
 v_mfma_f32_16x16x32_bf16 v[48:51], a[196:199], a[144:147], v[48:51]
 v_mfma_f32_16x16x32_bf16 v[52:55], a[196:199], a[148:151], v[52:55]
 ds_read_b128 a[132:135], v4 offset:1024
 v_mfma_f32_16x16x32_bf16 v[56:59], a[196:199], a[152:155], v[56:59]
 v_mfma_f32_16x16x32_bf16 v[60:63], a[196:199], a[156:159], v[60:63]
 buffer_load_dwordx4 a[196:199], v1, s[12:15], s24 offen offset:1024
 s_waitcnt vmcnt(14)
 v_mfma_f32_16x16x32_bf16 v[64:67], a[200:203], a[144:147], v[64:67]
 v_mfma_f32_16x16x32_bf16 v[68:71], a[200:203], a[148:151], v[68:71]
 ds_read_b128 a[136:139], v4 offset:2048
 v_mfma_f32_16x16x32_bf16 v[72:75], a[200:203], a[152:155], v[72:75]
 v_mfma_f32_16x16x32_bf16 v[76:79], a[200:203], a[156:159], v[76:79]
 buffer_load_dwordx4 a[200:203], v1, s[12:15], s24 offen offset:2048
 v_mfma_f32_16x16x32_bf16 v[80:83], a[204:207], a[144:147], v[80:83]
 v_mfma_f32_16x16x32_bf16 v[84:87], a[204:207], a[148:151], v[84:87]
 ds_read_b128 a[140:143], v4 offset:3072
 v_mfma_f32_16x16x32_bf16 v[88:91], a[204:207], a[152:155], v[88:91]
 v_mfma_f32_16x16x32_bf16 v[92:95], a[204:207], a[156:159], v[92:95]
 buffer_load_dwordx4 a[204:207], v1, s[12:15], s24 offen offset:3072
 s_waitcnt vmcnt(14)
 v_mfma_f32_16x16x32_bf16 v[96:99], a[208:211], a[144:147], v[96:99]
 v_mfma_f32_16x16x32_bf16 v[100:103], a[208:211], a[148:151], v[100:103]
 v_mfma_f32_16x16x32_bf16 v[104:107], a[208:211], a[152:155], v[104:107]
 v_mfma_f32_16x16x32_bf16 v[108:111], a[208:211], a[156:159], v[108:111]
 buffer_load_dwordx4 a[208:211], v2, s[12:15], s24 offen
 v_mfma_f32_16x16x32_bf16 v[112:115], a[212:215], a[144:147], v[112:115]
 v_mfma_f32_16x16x32_bf16 v[116:119], a[212:215], a[148:151], v[116:119]
 v_mfma_f32_16x16x32_bf16 v[120:123], a[212:215], a[152:155], v[120:123]
 v_mfma_f32_16x16x32_bf16 v[124:127], a[212:215], a[156:159], v[124:127]
 buffer_load_dwordx4 a[212:215], v2, s[12:15], s24 offen offset:1024
 s_waitcnt vmcnt(14)
 v_mfma_f32_16x16x32_bf16 v[128:131], a[216:219], a[144:147], v[128:131]
 v_mfma_f32_16x16x32_bf16 v[132:135], a[216:219], a[148:151], v[132:135]
 v_mfma_f32_16x16x32_bf16 v[136:139], a[216:219], a[152:155], v[136:139]
 v_mfma_f32_16x16x32_bf16 v[140:143], a[216:219], a[156:159], v[140:143]
 buffer_load_dwordx4 a[216:219], v2, s[12:15], s24 offen offset:2048
 v_mfma_f32_16x16x32_bf16 a[224:227], a[220:223], a[144:147], a[224:227]
 v_mfma_f32_16x16x32_bf16 a[228:231], a[220:223], a[148:151], a[228:231]
 v_mfma_f32_16x16x32_bf16 a[232:235], a[220:223], a[152:155], a[232:235]
 v_mfma_f32_16x16x32_bf16 a[236:239], a[220:223], a[156:159], a[236:239]
 buffer_load_dwordx4 a[220:223], v2, s[12:15], s24 offen offset:3072
 s_add_u32 s24, s24, 32768
 s_waitcnt vmcnt(14)
 s_waitcnt lgkmcnt(0)
Lloop:
 v_mfma_f32_16x16x32_bf16 v[32:35], a[160:163], a[128:131], v[32:35]
 ds_read_b128 v[12:15], v7 offset:2048
 v_mfma_f32_16x16x32_bf16 v[36:39], a[160:163], a[132:135], v[36:39]
 ds_read_b128 a[144:147], v4 offset:4096
 v_mfma_f32_16x16x32_bf16 v[40:43], a[160:163], a[136:139], v[40:43]
 ds_read_b128 v[16:19], v7 offset:2064
 v_mfma_f32_16x16x32_bf16 v[44:47], a[160:163], a[140:143], v[44:47]
 buffer_load_dwordx4 a[160:163], v1, s[12:15], s24 offen
 v_mfma_f32_16x16x32_bf16 v[48:51], a[164:167], a[128:131], v[48:51]
 v_mfma_f32_16x16x32_bf16 v[52:55], a[164:167], a[132:135], v[52:55]
 ds_read_b128 a[148:151], v4 offset:5120
 v_mfma_f32_16x16x32_bf16 v[56:59], a[164:167], a[136:139], v[56:59]
 s_waitcnt lgkmcnt(1)
 v_mfma_f32_16x16x32_bf16 v[60:63], a[164:167], a[140:143], v[60:63]
 buffer_load_dwordx4 a[164:167], v1, s[12:15], s24 offen offset:1024
 s_waitcnt vmcnt(14)
 v_mfma_f32_16x16x32_bf16 v[64:67], a[168:171], a[128:131], v[64:67]
 v_mfma_f32_16x16x32_bf16 v[68:71], a[168:171], a[132:135], v[68:71]
 ds_read_b128 a[152:155], v4 offset:6144
 v_mfma_f32_16x16x32_bf16 v[72:75], a[168:171], a[136:139], v[72:75]
 v_add_f32 v144, v144, v12
 v_mfma_f32_16x16x32_bf16 v[76:79], a[168:171], a[140:143], v[76:79]
 buffer_load_dwordx4 a[168:171], v1, s[12:15], s24 offen offset:2048
 v_mfma_f32_16x16x32_bf16 v[80:83], a[172:175], a[128:131], v[80:83]
 v_mfma_f32_16x16x32_bf16 v[84:87], a[172:175], a[132:135], v[84:87]
 ds_read_b128 a[156:159], v4 offset:7168
 v_mfma_f32_16x16x32_bf16 v[88:91], a[172:175], a[136:139], v[88:91]
 v_add_f32 v145, v145, v13
 v_mfma_f32_16x16x32_bf16 v[92:95], a[172:175], a[140:143], v[92:95]
 buffer_load_dwordx4 a[172:175], v1, s[12:15], s24 offen offset:3072
 s_waitcnt vmcnt(14)
 v_mfma_f32_16x16x32_bf16 v[96:99], a[176:179], a[128:131], v[96:99]
 v_mfma_f32_16x16x32_bf16 v[100:103], a[176:179], a[132:135], v[100:103]
 ds_read_b128 v[20:23], v7 offset:2176
 v_mfma_f32_16x16x32_bf16 v[104:107], a[176:179], a[136:139], v[104:107]
 v_mfma_f32_16x16x32_bf16 v[108:111], a[176:179], a[140:143], v[108:111]
 buffer_load_dwordx4 a[176:179], v2, s[12:15], s24 offen
 v_mfma_f32_16x16x32_bf16 v[112:115], a[180:183], a[128:131], v[112:115]
 ds_read_b128 v[24:27], v7 offset:2192
 v_mfma_f32_16x16x32_bf16 v[116:119], a[180:183], a[132:135], v[116:119]
 v_mfma_f32_16x16x32_bf16 v[120:123], a[180:183], a[136:139], v[120:123]
 v_add_f32 v146, v146, v14
 v_mfma_f32_16x16x32_bf16 v[124:127], a[180:183], a[140:143], v[124:127]
 buffer_load_dwordx4 a[180:183], v2, s[12:15], s24 offen offset:1024
 s_waitcnt vmcnt(14)
 v_mfma_f32_16x16x32_bf16 v[128:131], a[184:187], a[128:131], v[128:131]
 v_add_f32 v147, v147, v15
 v_mfma_f32_16x16x32_bf16 v[132:135], a[184:187], a[132:135], v[132:135]
 v_mfma_f32_16x16x32_bf16 v[136:139], a[184:187], a[136:139], v[136:139]
 v_add_f32 v160, v160, v16
 v_mfma_f32_16x16x32_bf16 v[140:143], a[184:187], a[140:143], v[140:143]
 buffer_load_dwordx4 a[184:187], v2, s[12:15], s24 offen offset:2048
 v_mfma_f32_16x16x32_bf16 a[224:227], a[188:191], a[128:131], a[224:227]
 v_mfma_f32_16x16x32_bf16 a[228:231], a[188:191], a[132:135], a[228:231]
 v_add_f32 v161, v161, v17
 v_mfma_f32_16x16x32_bf16 a[232:235], a[188:191], a[136:139], a[232:235]
 v_mfma_f32_16x16x32_bf16 a[236:239], a[188:191], a[140:143], a[236:239]
 buffer_load_dwordx4 a[188:191], v2, s[12:15], s24 offen offset:3072
 s_add_u32 s24, s24, 32768
 s_waitcnt vmcnt(14)
 s_waitcnt lgkmcnt(2)
 v_mfma_f32_16x16x32_bf16 v[32:35], a[192:195], a[144:147], v[32:35]
 v_add_f32 v162, v162, v18
 v_mfma_f32_16x16x32_bf16 v[36:39], a[192:195], a[148:151], v[36:39]
 ds_read_b128 a[128:131], v4 offset:8192
 v_mfma_f32_16x16x32_bf16 v[40:43], a[192:195], a[152:155], v[40:43]
 v_mfma_f32_16x16x32_bf16 v[44:47], a[192:195], a[156:159], v[44:47]
 buffer_load_dwordx4 a[192:195], v1, s[12:15], s24 offen
 v_mfma_f32_16x16x32_bf16 v[48:51], a[196:199], a[144:147], v[48:51]
 v_add_f32 v163, v163, v19
 v_mfma_f32_16x16x32_bf16 v[52:55], a[196:199], a[148:151], v[52:55]
 ds_read_b128 a[132:135], v4 offset:9216
 v_mfma_f32_16x16x32_bf16 v[56:59], a[196:199], a[152:155], v[56:59]
 v_mfma_f32_16x16x32_bf16 v[60:63], a[196:199], a[156:159], v[60:63]
 buffer_load_dwordx4 a[196:199], v1, s[12:15], s24 offen offset:1024
 s_waitcnt vmcnt(14)
 v_mfma_f32_16x16x32_bf16 v[64:67], a[200:203], a[144:147], v[64:67]
 v_add_f32 v148, v148, v12
 v_mfma_f32_16x16x32_bf16 v[68:71], a[200:203], a[148:151], v[68:71]
 ds_read_b128 a[136:139], v4 offset:10240
 v_mfma_f32_16x16x32_bf16 v[72:75], a[200:203], a[152:155], v[72:75]
 v_mfma_f32_16x16x32_bf16 v[76:79], a[200:203], a[156:159], v[76:79]
 buffer_load_dwordx4 a[200:203], v1, s[12:15], s24 offen offset:2048
 v_mfma_f32_16x16x32_bf16 v[80:83], a[204:207], a[144:147], v[80:83]
 v_add_f32 v149, v149, v13
 v_mfma_f32_16x16x32_bf16 v[84:87], a[204:207], a[148:151], v[84:87]
 ds_read_b128 a[140:143], v4 offset:11264
 v_mfma_f32_16x16x32_bf16 v[88:91], a[204:207], a[152:155], v[88:91]
 v_add_f32 v150, v150, v14
 v_mfma_f32_16x16x32_bf16 v[92:95], a[204:207], a[156:159], v[92:95]
 buffer_load_dwordx4 a[204:207], v1, s[12:15], s24 offen offset:3072
 s_waitcnt vmcnt(14)
 v_mfma_f32_16x16x32_bf16 v[96:99], a[208:211], a[144:147], v[96:99]
 v_mfma_f32_16x16x32_bf16 v[100:103], a[208:211], a[148:151], v[100:103]
 v_add_f32 v151, v151, v15
 v_mfma_f32_16x16x32_bf16 v[104:107], a[208:211], a[152:155], v[104:107]
 v_mfma_f32_16x16x32_bf16 v[108:111], a[208:211], a[156:159], v[108:111]
 buffer_load_dwordx4 a[208:211], v2, s[12:15], s24 offen
 v_mfma_f32_16x16x32_bf16 v[112:115], a[212:215], a[144:147], v[112:115]
 v_add_f32 v164, v164, v16
 v_mfma_f32_16x16x32_bf16 v[116:119], a[212:215], a[148:151], v[116:119]
 v_mfma_f32_16x16x32_bf16 v[120:123], a[212:215], a[152:155], v[120:123]
 v_add_f32 v165, v165, v17
 v_mfma_f32_16x16x32_bf16 v[124:127], a[212:215], a[156:159], v[124:127]
 buffer_load_dwordx4 a[212:215], v2, s[12:15], s24 offen offset:1024
 s_waitcnt vmcnt(14)
 v_mfma_f32_16x16x32_bf16 v[128:131], a[216:219], a[144:147], v[128:131]
 v_mfma_f32_16x16x32_bf16 v[132:135], a[216:219], a[148:151], v[132:135]
 v_add_f32 v166, v166, v18
 v_mfma_f32_16x16x32_bf16 v[136:139], a[216:219], a[152:155], v[136:139]
 v_mfma_f32_16x16x32_bf16 v[140:143], a[216:219], a[156:159], v[140:143]
 buffer_load_dwordx4 a[216:219], v2, s[12:15], s24 offen offset:2048
 v_mfma_f32_16x16x32_bf16 a[224:227], a[220:223], a[144:147], a[224:227]
 v_add_f32 v167, v167, v19
 v_mfma_f32_16x16x32_bf16 a[228:231], a[220:223], a[148:151], a[228:231]
 v_mfma_f32_16x16x32_bf16 a[232:235], a[220:223], a[152:155], a[232:235]
 v_add_f32 v152, v152, v12
 v_mfma_f32_16x16x32_bf16 a[236:239], a[220:223], a[156:159], a[236:239]
 buffer_load_dwordx4 a[220:223], v2, s[12:15], s24 offen offset:3072
 s_add_u32 s24, s24, 32768
 s_waitcnt vmcnt(14)
 s_waitcnt lgkmcnt(0)
 v_mfma_f32_16x16x32_bf16 v[32:35], a[160:163], a[128:131], v[32:35]
 v_add_f32 v153, v153, v13
 v_mfma_f32_16x16x32_bf16 v[36:39], a[160:163], a[132:135], v[36:39]
 ds_read_b128 a[144:147], v4 offset:12288
 v_mfma_f32_16x16x32_bf16 v[40:43], a[160:163], a[136:139], v[40:43]
 v_mfma_f32_16x16x32_bf16 v[44:47], a[160:163], a[140:143], v[44:47]
 buffer_load_dwordx4 a[160:163], v1, s[12:15], s24 offen
 v_mfma_f32_16x16x32_bf16 v[48:51], a[164:167], a[128:131], v[48:51]
 v_add_f32 v154, v154, v14
 v_mfma_f32_16x16x32_bf16 v[52:55], a[164:167], a[132:135], v[52:55]
 ds_read_b128 a[148:151], v4 offset:13312
 v_mfma_f32_16x16x32_bf16 v[56:59], a[164:167], a[136:139], v[56:59]
 v_mfma_f32_16x16x32_bf16 v[60:63], a[164:167], a[140:143], v[60:63]
 buffer_load_dwordx4 a[164:167], v1, s[12:15], s24 offen offset:1024
 s_waitcnt vmcnt(14)
 v_mfma_f32_16x16x32_bf16 v[64:67], a[168:171], a[128:131], v[64:67]
 v_add_f32 v155, v155, v15
 v_mfma_f32_16x16x32_bf16 v[68:71], a[168:171], a[132:135], v[68:71]
 ds_read_b128 a[152:155], v4 offset:14336
 v_mfma_f32_16x16x32_bf16 v[72:75], a[168:171], a[136:139], v[72:75]
 v_mfma_f32_16x16x32_bf16 v[76:79], a[168:171], a[140:143], v[76:79]
 buffer_load_dwordx4 a[168:171], v1, s[12:15], s24 offen offset:2048
 v_mfma_f32_16x16x32_bf16 v[80:83], a[172:175], a[128:131], v[80:83]
 v_add_f32 v168, v168, v16
 v_mfma_f32_16x16x32_bf16 v[84:87], a[172:175], a[132:135], v[84:87]
 ds_read_b128 a[156:159], v4 offset:15360
 v_mfma_f32_16x16x32_bf16 v[88:91], a[172:175], a[136:139], v[88:91]
 v_mfma_f32_16x16x32_bf16 v[92:95], a[172:175], a[140:143], v[92:95]
 buffer_load_dwordx4 a[172:175], v1, s[12:15], s24 offen offset:3072
 s_waitcnt vmcnt(14)
 v_mfma_f32_16x16x32_bf16 v[96:99], a[176:179], a[128:131], v[96:99]
 v_add_f32 v169, v169, v17
 v_mfma_f32_16x16x32_bf16 v[100:103], a[176:179], a[132:135], v[100:103]
 v_mfma_f32_16x16x32_bf16 v[104:107], a[176:179], a[136:139], v[104:107]
 v_add_f32 v170, v170, v18
 v_mfma_f32_16x16x32_bf16 v[108:111], a[176:179], a[140:143], v[108:111]
 buffer_load_dwordx4 a[176:179], v2, s[12:15], s24 offen
 v_mfma_f32_16x16x32_bf16 v[112:115], a[180:183], a[128:131], v[112:115]
 v_mfma_f32_16x16x32_bf16 v[116:119], a[180:183], a[132:135], v[116:119]
 v_add_f32 v171, v171, v19
 v_mfma_f32_16x16x32_bf16 v[120:123], a[180:183], a[136:139], v[120:123]
 v_add_f32 v156, v156, v12
 v_mfma_f32_16x16x32_bf16 v[124:127], a[180:183], a[140:143], v[124:127]
 buffer_load_dwordx4 a[180:183], v2, s[12:15], s24 offen offset:1024
 s_waitcnt vmcnt(14)
 v_mfma_f32_16x16x32_bf16 v[128:131], a[184:187], a[128:131], v[128:131]
 v_mfma_f32_16x16x32_bf16 v[132:135], a[184:187], a[132:135], v[132:135]
 v_add_f32 v157, v157, v13
 v_mfma_f32_16x16x32_bf16 v[136:139], a[184:187], a[136:139], v[136:139]
 v_mfma_f32_16x16x32_bf16 v[140:143], a[184:187], a[140:143], v[140:143]
 buffer_load_dwordx4 a[184:187], v2, s[12:15], s24 offen offset:2048
 v_mfma_f32_16x16x32_bf16 a[224:227], a[188:191], a[128:131], a[224:227]
 v_add_f32 v158, v158, v14
 v_mfma_f32_16x16x32_bf16 a[228:231], a[188:191], a[132:135], a[228:231]
 v_mfma_f32_16x16x32_bf16 a[232:235], a[188:191], a[136:139], a[232:235]
 v_add_f32 v159, v159, v15
 v_mfma_f32_16x16x32_bf16 a[236:239], a[188:191], a[140:143], a[236:239]
 buffer_load_dwordx4 a[188:191], v2, s[12:15], s24 offen offset:3072
 s_add_u32 s24, s24, 32768
 s_waitcnt vmcnt(14)
 s_waitcnt lgkmcnt(0)
 v_mfma_f32_16x16x32_bf16 v[32:35], a[192:195], a[144:147], v[32:35]
 v_mfma_f32_16x16x32_bf16 v[36:39], a[192:195], a[148:151], v[36:39]
 ds_read_b128 a[128:131], v4 offset:16384
 v_mfma_f32_16x16x32_bf16 v[40:43], a[192:195], a[152:155], v[40:43]
 v_add_f32 v172, v172, v16
 v_mfma_f32_16x16x32_bf16 v[44:47], a[192:195], a[156:159], v[44:47]
 buffer_load_dwordx4 a[192:195], v1, s[12:15], s24 offen
 v_mfma_f32_16x16x32_bf16 v[48:51], a[196:199], a[144:147], v[48:51]
 v_mfma_f32_16x16x32_bf16 v[52:55], a[196:199], a[148:151], v[52:55]
 ds_read_b128 a[132:135], v4 offset:17408
 v_mfma_f32_16x16x32_bf16 v[56:59], a[196:199], a[152:155], v[56:59]
 v_add_f32 v173, v173, v17
 v_mfma_f32_16x16x32_bf16 v[60:63], a[196:199], a[156:159], v[60:63]
 buffer_load_dwordx4 a[196:199], v1, s[12:15], s24 offen offset:1024
 s_waitcnt vmcnt(14)
 v_mfma_f32_16x16x32_bf16 v[64:67], a[200:203], a[144:147], v[64:67]
 v_mfma_f32_16x16x32_bf16 v[68:71], a[200:203], a[148:151], v[68:71]
 ds_read_b128 a[136:139], v4 offset:18432
 v_mfma_f32_16x16x32_bf16 v[72:75], a[200:203], a[152:155], v[72:75]
 v_add_f32 v174, v174, v18
 v_mfma_f32_16x16x32_bf16 v[76:79], a[200:203], a[156:159], v[76:79]
 buffer_load_dwordx4 a[200:203], v1, s[12:15], s24 offen offset:2048
 v_mfma_f32_16x16x32_bf16 v[80:83], a[204:207], a[144:147], v[80:83]
 v_add_f32 v175, v175, v19
 v_mfma_f32_16x16x32_bf16 v[84:87], a[204:207], a[148:151], v[84:87]
 ds_read_b128 a[140:143], v4 offset:19456
 v_mfma_f32_16x16x32_bf16 v[88:91], a[204:207], a[152:155], v[88:91]
 v_mfma_f32_16x16x32_bf16 v[92:95], a[204:207], a[156:159], v[92:95]
 buffer_load_dwordx4 a[204:207], v1, s[12:15], s24 offen offset:3072
 s_waitcnt vmcnt(14)
 v_mfma_f32_16x16x32_bf16 v[96:99], a[208:211], a[144:147], v[96:99]
 v_mfma_f32_16x16x32_bf16 v[100:103], a[208:211], a[148:151], v[100:103]
 v_mfma_f32_16x16x32_bf16 v[104:107], a[208:211], a[152:155], v[104:107]
 v_add_f32 v176, v176, v20
 v_mfma_f32_16x16x32_bf16 v[108:111], a[208:211], a[156:159], v[108:111]
 buffer_load_dwordx4 a[208:211], v2, s[12:15], s24 offen
 v_mfma_f32_16x16x32_bf16 v[112:115], a[212:215], a[144:147], v[112:115]
 v_mfma_f32_16x16x32_bf16 v[116:119], a[212:215], a[148:151], v[116:119]
 v_add_f32 v177, v177, v21
 v_mfma_f32_16x16x32_bf16 v[120:123], a[212:215], a[152:155], v[120:123]
 v_mfma_f32_16x16x32_bf16 v[124:127], a[212:215], a[156:159], v[124:127]
 buffer_load_dwordx4 a[212:215], v2, s[12:15], s24 offen offset:1024
 s_waitcnt vmcnt(14)
 v_mfma_f32_16x16x32_bf16 v[128:131], a[216:219], a[144:147], v[128:131]
 ds_read_b128 v[12:15], v7 offset:2304
 v_mfma_f32_16x16x32_bf16 v[132:135], a[216:219], a[148:151], v[132:135]
 v_mfma_f32_16x16x32_bf16 v[136:139], a[216:219], a[152:155], v[136:139]
 ds_read_b128 v[16:19], v7 offset:2320
 v_mfma_f32_16x16x32_bf16 v[140:143], a[216:219], a[156:159], v[140:143]
 buffer_load_dwordx4 a[216:219], v2, s[12:15], s24 offen offset:2048
 v_mfma_f32_16x16x32_bf16 a[224:227], a[220:223], a[144:147], a[224:227]
 v_mfma_f32_16x16x32_bf16 a[228:231], a[220:223], a[148:151], a[228:231]
 v_add_f32 v178, v178, v22
 v_mfma_f32_16x16x32_bf16 a[232:235], a[220:223], a[152:155], a[232:235]
 v_mfma_f32_16x16x32_bf16 a[236:239], a[220:223], a[156:159], a[236:239]
 buffer_load_dwordx4 a[220:223], v2, s[12:15], s24 offen offset:3072
 s_add_u32 s24, s24, 32768
 s_waitcnt vmcnt(14)
 s_waitcnt lgkmcnt(2)
 v_mfma_f32_16x16x32_bf16 v[32:35], a[160:163], a[128:131], v[32:35]
 v_add_f32 v179, v179, v23
 v_mfma_f32_16x16x32_bf16 v[36:39], a[160:163], a[132:135], v[36:39]
 ds_read_b128 a[144:147], v4 offset:20480
 v_mfma_f32_16x16x32_bf16 v[40:43], a[160:163], a[136:139], v[40:43]
 v_add_f32 v192, v192, v24
 v_mfma_f32_16x16x32_bf16 v[44:47], a[160:163], a[140:143], v[44:47]
 buffer_load_dwordx4 a[160:163], v1, s[12:15], s24 offen
 v_mfma_f32_16x16x32_bf16 v[48:51], a[164:167], a[128:131], v[48:51]
 v_mfma_f32_16x16x32_bf16 v[52:55], a[164:167], a[132:135], v[52:55]
 ds_read_b128 a[148:151], v4 offset:21504
 v_mfma_f32_16x16x32_bf16 v[56:59], a[164:167], a[136:139], v[56:59]
 v_add_f32 v193, v193, v25
 v_mfma_f32_16x16x32_bf16 v[60:63], a[164:167], a[140:143], v[60:63]
 buffer_load_dwordx4 a[164:167], v1, s[12:15], s24 offen offset:1024
 s_waitcnt vmcnt(14)
 v_mfma_f32_16x16x32_bf16 v[64:67], a[168:171], a[128:131], v[64:67]
 v_mfma_f32_16x16x32_bf16 v[68:71], a[168:171], a[132:135], v[68:71]
 ds_read_b128 a[152:155], v4 offset:22528
 v_mfma_f32_16x16x32_bf16 v[72:75], a[168:171], a[136:139], v[72:75]
 v_add_f32 v194, v194, v26
 v_mfma_f32_16x16x32_bf16 v[76:79], a[168:171], a[140:143], v[76:79]
 buffer_load_dwordx4 a[168:171], v1, s[12:15], s24 offen offset:2048
 v_mfma_f32_16x16x32_bf16 v[80:83], a[172:175], a[128:131], v[80:83]
 v_mfma_f32_16x16x32_bf16 v[84:87], a[172:175], a[132:135], v[84:87]
 ds_read_b128 a[156:159], v4 offset:23552
 v_mfma_f32_16x16x32_bf16 v[88:91], a[172:175], a[136:139], v[88:91]
 v_add_f32 v195, v195, v27
 v_mfma_f32_16x16x32_bf16 v[92:95], a[172:175], a[140:143], v[92:95]
 buffer_load_dwordx4 a[172:175], v1, s[12:15], s24 offen offset:3072
 s_waitcnt vmcnt(14)
 v_mfma_f32_16x16x32_bf16 v[96:99], a[176:179], a[128:131], v[96:99]
 v_mfma_f32_16x16x32_bf16 v[100:103], a[176:179], a[132:135], v[100:103]
 v_add_f32 v180, v180, v20
 v_mfma_f32_16x16x32_bf16 v[104:107], a[176:179], a[136:139], v[104:107]
 v_mfma_f32_16x16x32_bf16 v[108:111], a[176:179], a[140:143], v[108:111]
 buffer_load_dwordx4 a[176:179], v2, s[12:15], s24 offen
 v_mfma_f32_16x16x32_bf16 v[112:115], a[180:183], a[128:131], v[112:115]
 v_add_f32 v181, v181, v21
 v_mfma_f32_16x16x32_bf16 v[116:119], a[180:183], a[132:135], v[116:119]
 v_mfma_f32_16x16x32_bf16 v[120:123], a[180:183], a[136:139], v[120:123]
 v_add_f32 v182, v182, v22
 v_mfma_f32_16x16x32_bf16 v[124:127], a[180:183], a[140:143], v[124:127]
 buffer_load_dwordx4 a[180:183], v2, s[12:15], s24 offen offset:1024
 s_waitcnt vmcnt(14)
 v_mfma_f32_16x16x32_bf16 v[128:131], a[184:187], a[128:131], v[128:131]
 v_add_f32 v183, v183, v23
 v_mfma_f32_16x16x32_bf16 v[132:135], a[184:187], a[132:135], v[132:135]
 v_mfma_f32_16x16x32_bf16 v[136:139], a[184:187], a[136:139], v[136:139]
 v_add_f32 v196, v196, v24
 v_mfma_f32_16x16x32_bf16 v[140:143], a[184:187], a[140:143], v[140:143]
 buffer_load_dwordx4 a[184:187], v2, s[12:15], s24 offen offset:2048
 v_mfma_f32_16x16x32_bf16 a[224:227], a[188:191], a[128:131], a[224:227]
 v_mfma_f32_16x16x32_bf16 a[228:231], a[188:191], a[132:135], a[228:231]
 v_add_f32 v197, v197, v25
 v_mfma_f32_16x16x32_bf16 a[232:235], a[188:191], a[136:139], a[232:235]
 v_mfma_f32_16x16x32_bf16 a[236:239], a[188:191], a[140:143], a[236:239]
 buffer_load_dwordx4 a[188:191], v2, s[12:15], s24 offen offset:3072
 s_add_u32 s24, s24, 32768
 s_waitcnt vmcnt(14)
 s_waitcnt lgkmcnt(0)
 v_mfma_f32_16x16x32_bf16 v[32:35], a[192:195], a[144:147], v[32:35]
 v_add_f32 v198, v198, v26
 v_mfma_f32_16x16x32_bf16 v[36:39], a[192:195], a[148:151], v[36:39]
 ds_read_b128 a[128:131], v4 offset:24576
 v_mfma_f32_16x16x32_bf16 v[40:43], a[192:195], a[152:155], v[40:43]
 v_mfma_f32_16x16x32_bf16 v[44:47], a[192:195], a[156:159], v[44:47]
 buffer_load_dwordx4 a[192:195], v1, s[12:15], s24 offen
 v_mfma_f32_16x16x32_bf16 v[48:51], a[196:199], a[144:147], v[48:51]
 v_add_f32 v199, v199, v27
 v_mfma_f32_16x16x32_bf16 v[52:55], a[196:199], a[148:151], v[52:55]
 ds_read_b128 a[132:135], v4 offset:25600
 v_mfma_f32_16x16x32_bf16 v[56:59], a[196:199], a[152:155], v[56:59]
 v_mfma_f32_16x16x32_bf16 v[60:63], a[196:199], a[156:159], v[60:63]
 buffer_load_dwordx4 a[196:199], v1, s[12:15], s24 offen offset:1024
 s_waitcnt vmcnt(14)
 v_mfma_f32_16x16x32_bf16 v[64:67], a[200:203], a[144:147], v[64:67]
 v_add_f32 v184, v184, v20
 v_mfma_f32_16x16x32_bf16 v[68:71], a[200:203], a[148:151], v[68:71]
 ds_read_b128 a[136:139], v4 offset:26624
 v_mfma_f32_16x16x32_bf16 v[72:75], a[200:203], a[152:155], v[72:75]
 v_mfma_f32_16x16x32_bf16 v[76:79], a[200:203], a[156:159], v[76:79]
 buffer_load_dwordx4 a[200:203], v1, s[12:15], s24 offen offset:2048
 v_mfma_f32_16x16x32_bf16 v[80:83], a[204:207], a[144:147], v[80:83]
 v_add_f32 v185, v185, v21
 v_mfma_f32_16x16x32_bf16 v[84:87], a[204:207], a[148:151], v[84:87]
 ds_read_b128 a[140:143], v4 offset:27648
 v_mfma_f32_16x16x32_bf16 v[88:91], a[204:207], a[152:155], v[88:91]
 v_add_f32 v186, v186, v22
 v_mfma_f32_16x16x32_bf16 v[92:95], a[204:207], a[156:159], v[92:95]
 buffer_load_dwordx4 a[204:207], v1, s[12:15], s24 offen offset:3072
 s_waitcnt vmcnt(14)
 v_mfma_f32_16x16x32_bf16 v[96:99], a[208:211], a[144:147], v[96:99]
 v_mfma_f32_16x16x32_bf16 v[100:103], a[208:211], a[148:151], v[100:103]
 v_add_f32 v187, v187, v23
 v_mfma_f32_16x16x32_bf16 v[104:107], a[208:211], a[152:155], v[104:107]
 v_mfma_f32_16x16x32_bf16 v[108:111], a[208:211], a[156:159], v[108:111]
 buffer_load_dwordx4 a[208:211], v2, s[12:15], s24 offen
 v_mfma_f32_16x16x32_bf16 v[112:115], a[212:215], a[144:147], v[112:115]
 v_add_f32 v200, v200, v24
 v_mfma_f32_16x16x32_bf16 v[116:119], a[212:215], a[148:151], v[116:119]
 v_mfma_f32_16x16x32_bf16 v[120:123], a[212:215], a[152:155], v[120:123]
 v_add_f32 v201, v201, v25
 v_mfma_f32_16x16x32_bf16 v[124:127], a[212:215], a[156:159], v[124:127]
 buffer_load_dwordx4 a[212:215], v2, s[12:15], s24 offen offset:1024
 s_waitcnt vmcnt(14)
 v_mfma_f32_16x16x32_bf16 v[128:131], a[216:219], a[144:147], v[128:131]
 v_mfma_f32_16x16x32_bf16 v[132:135], a[216:219], a[148:151], v[132:135]
 v_add_f32 v202, v202, v26
 v_mfma_f32_16x16x32_bf16 v[136:139], a[216:219], a[152:155], v[136:139]
 v_mfma_f32_16x16x32_bf16 v[140:143], a[216:219], a[156:159], v[140:143]
 buffer_load_dwordx4 a[216:219], v2, s[12:15], s24 offen offset:2048
 v_mfma_f32_16x16x32_bf16 a[224:227], a[220:223], a[144:147], a[224:227]
 v_add_f32 v203, v203, v27
 v_mfma_f32_16x16x32_bf16 a[228:231], a[220:223], a[148:151], a[228:231]
 v_mfma_f32_16x16x32_bf16 a[232:235], a[220:223], a[152:155], a[232:235]
 v_add_f32 v188, v188, v20
 v_mfma_f32_16x16x32_bf16 a[236:239], a[220:223], a[156:159], a[236:239]
 buffer_load_dwordx4 a[220:223], v2, s[12:15], s24 offen offset:3072
 s_add_u32 s24, s24, 32768
 s_waitcnt vmcnt(14)
 s_waitcnt lgkmcnt(0)
 v_mfma_f32_16x16x32_bf16 v[32:35], a[160:163], a[128:131], v[32:35]
 v_add_f32 v189, v189, v21
 v_mfma_f32_16x16x32_bf16 v[36:39], a[160:163], a[132:135], v[36:39]
 ds_read_b128 a[144:147], v4 offset:28672
 v_mfma_f32_16x16x32_bf16 v[40:43], a[160:163], a[136:139], v[40:43]
 v_mfma_f32_16x16x32_bf16 v[44:47], a[160:163], a[140:143], v[44:47]
 buffer_load_dwordx4 a[160:163], v1, s[12:15], s24 offen
 v_mfma_f32_16x16x32_bf16 v[48:51], a[164:167], a[128:131], v[48:51]
 v_add_f32 v190, v190, v22
 v_mfma_f32_16x16x32_bf16 v[52:55], a[164:167], a[132:135], v[52:55]
 ds_read_b128 a[148:151], v4 offset:29696
 v_mfma_f32_16x16x32_bf16 v[56:59], a[164:167], a[136:139], v[56:59]
 v_mfma_f32_16x16x32_bf16 v[60:63], a[164:167], a[140:143], v[60:63]
 buffer_load_dwordx4 a[164:167], v1, s[12:15], s24 offen offset:1024
 s_waitcnt vmcnt(14)
 v_mfma_f32_16x16x32_bf16 v[64:67], a[168:171], a[128:131], v[64:67]
 v_add_f32 v191, v191, v23
 v_mfma_f32_16x16x32_bf16 v[68:71], a[168:171], a[132:135], v[68:71]
 ds_read_b128 a[152:155], v4 offset:30720
 v_mfma_f32_16x16x32_bf16 v[72:75], a[168:171], a[136:139], v[72:75]
 v_mfma_f32_16x16x32_bf16 v[76:79], a[168:171], a[140:143], v[76:79]
 buffer_load_dwordx4 a[168:171], v1, s[12:15], s24 offen offset:2048
 v_mfma_f32_16x16x32_bf16 v[80:83], a[172:175], a[128:131], v[80:83]
 v_add_f32 v204, v204, v24
 v_mfma_f32_16x16x32_bf16 v[84:87], a[172:175], a[132:135], v[84:87]
 ds_read_b128 a[156:159], v4 offset:31744
 v_mfma_f32_16x16x32_bf16 v[88:91], a[172:175], a[136:139], v[88:91]
 v_mfma_f32_16x16x32_bf16 v[92:95], a[172:175], a[140:143], v[92:95]
 buffer_load_dwordx4 a[172:175], v1, s[12:15], s24 offen offset:3072
 s_waitcnt vmcnt(14)
 v_mfma_f32_16x16x32_bf16 v[96:99], a[176:179], a[128:131], v[96:99]
 v_add_f32 v205, v205, v25
 v_mfma_f32_16x16x32_bf16 v[100:103], a[176:179], a[132:135], v[100:103]
 v_mfma_f32_16x16x32_bf16 v[104:107], a[176:179], a[136:139], v[104:107]
 v_add_f32 v206, v206, v26
 v_mfma_f32_16x16x32_bf16 v[108:111], a[176:179], a[140:143], v[108:111]
 buffer_load_dwordx4 a[176:179], v2, s[12:15], s24 offen
 v_mfma_f32_16x16x32_bf16 v[112:115], a[180:183], a[128:131], v[112:115]
 v_mfma_f32_16x16x32_bf16 v[116:119], a[180:183], a[132:135], v[116:119]
 v_add_f32 v207, v207, v27
 v_mfma_f32_16x16x32_bf16 v[120:123], a[180:183], a[136:139], v[120:123]
 v_mfma_f32_16x16x32_bf16 v[124:127], a[180:183], a[140:143], v[124:127]
 buffer_load_dwordx4 a[180:183], v2, s[12:15], s24 offen offset:1024
 s_waitcnt vmcnt(14)
 v_mfma_f32_16x16x32_bf16 v[128:131], a[184:187], a[128:131], v[128:131]
 v_mfma_f32_16x16x32_bf16 v[132:135], a[184:187], a[132:135], v[132:135]
 v_add_f32 v208, v208, v12
 v_mfma_f32_16x16x32_bf16 v[136:139], a[184:187], a[136:139], v[136:139]
 v_mfma_f32_16x16x32_bf16 v[140:143], a[184:187], a[140:143], v[140:143]
 buffer_load_dwordx4 a[184:187], v2, s[12:15], s24 offen offset:2048
 v_mfma_f32_16x16x32_bf16 a[224:227], a[188:191], a[128:131], a[224:227]
 v_add_f32 v209, v209, v13
 v_mfma_f32_16x16x32_bf16 a[228:231], a[188:191], a[132:135], a[228:231]
 v_mfma_f32_16x16x32_bf16 a[232:235], a[188:191], a[136:139], a[232:235]
 ds_read_b128 v[20:23], v7 offset:2432
 v_mfma_f32_16x16x32_bf16 a[236:239], a[188:191], a[140:143], a[236:239]
 buffer_load_dwordx4 a[188:191], v2, s[12:15], s24 offen offset:3072
 s_add_u32 s24, s24, 32768
 s_waitcnt vmcnt(14)
 s_waitcnt lgkmcnt(1)
 v_mfma_f32_16x16x32_bf16 v[32:35], a[192:195], a[144:147], v[32:35]
 v_mfma_f32_16x16x32_bf16 v[36:39], a[192:195], a[148:151], v[36:39]
 ds_read_b128 a[128:131], v4 offset:32768
 v_mfma_f32_16x16x32_bf16 v[40:43], a[192:195], a[152:155], v[40:43]
 ds_read_b128 v[24:27], v7 offset:2448
 v_mfma_f32_16x16x32_bf16 v[44:47], a[192:195], a[156:159], v[44:47]
 buffer_load_dwordx4 a[192:195], v1, s[12:15], s24 offen
 v_mfma_f32_16x16x32_bf16 v[48:51], a[196:199], a[144:147], v[48:51]
 v_mfma_f32_16x16x32_bf16 v[52:55], a[196:199], a[148:151], v[52:55]
 ds_read_b128 a[132:135], v4 offset:33792
 v_mfma_f32_16x16x32_bf16 v[56:59], a[196:199], a[152:155], v[56:59]
 v_add_f32 v210, v210, v14
 v_mfma_f32_16x16x32_bf16 v[60:63], a[196:199], a[156:159], v[60:63]
 buffer_load_dwordx4 a[196:199], v1, s[12:15], s24 offen offset:1024
 s_waitcnt vmcnt(14)
 v_mfma_f32_16x16x32_bf16 v[64:67], a[200:203], a[144:147], v[64:67]
 v_mfma_f32_16x16x32_bf16 v[68:71], a[200:203], a[148:151], v[68:71]
 ds_read_b128 a[136:139], v4 offset:34816
 v_mfma_f32_16x16x32_bf16 v[72:75], a[200:203], a[152:155], v[72:75]
 v_add_f32 v211, v211, v15
 v_mfma_f32_16x16x32_bf16 v[76:79], a[200:203], a[156:159], v[76:79]
 buffer_load_dwordx4 a[200:203], v1, s[12:15], s24 offen offset:2048
 v_mfma_f32_16x16x32_bf16 v[80:83], a[204:207], a[144:147], v[80:83]
 v_add_f32 v224, v224, v16
 v_mfma_f32_16x16x32_bf16 v[84:87], a[204:207], a[148:151], v[84:87]
 ds_read_b128 a[140:143], v4 offset:35840
 v_mfma_f32_16x16x32_bf16 v[88:91], a[204:207], a[152:155], v[88:91]
 v_mfma_f32_16x16x32_bf16 v[92:95], a[204:207], a[156:159], v[92:95]
 buffer_load_dwordx4 a[204:207], v1, s[12:15], s24 offen offset:3072
 s_waitcnt vmcnt(14)
 v_mfma_f32_16x16x32_bf16 v[96:99], a[208:211], a[144:147], v[96:99]
 v_add_f32 v225, v225, v17
 v_mfma_f32_16x16x32_bf16 v[100:103], a[208:211], a[148:151], v[100:103]
 v_mfma_f32_16x16x32_bf16 v[104:107], a[208:211], a[152:155], v[104:107]
 v_add_f32 v226, v226, v18
 v_mfma_f32_16x16x32_bf16 v[108:111], a[208:211], a[156:159], v[108:111]
 buffer_load_dwordx4 a[208:211], v2, s[12:15], s24 offen
 v_mfma_f32_16x16x32_bf16 v[112:115], a[212:215], a[144:147], v[112:115]
 v_mfma_f32_16x16x32_bf16 v[116:119], a[212:215], a[148:151], v[116:119]
 v_add_f32 v227, v227, v19
 v_mfma_f32_16x16x32_bf16 v[120:123], a[212:215], a[152:155], v[120:123]
 v_mfma_f32_16x16x32_bf16 v[124:127], a[212:215], a[156:159], v[124:127]
 buffer_load_dwordx4 a[212:215], v2, s[12:15], s24 offen offset:1024
 s_waitcnt vmcnt(14)
 v_mfma_f32_16x16x32_bf16 v[128:131], a[216:219], a[144:147], v[128:131]
 v_add_f32 v212, v212, v12
 v_mfma_f32_16x16x32_bf16 v[132:135], a[216:219], a[148:151], v[132:135]
 v_mfma_f32_16x16x32_bf16 v[136:139], a[216:219], a[152:155], v[136:139]
 v_add_f32 v213, v213, v13
 v_mfma_f32_16x16x32_bf16 v[140:143], a[216:219], a[156:159], v[140:143]
 buffer_load_dwordx4 a[216:219], v2, s[12:15], s24 offen offset:2048
 v_mfma_f32_16x16x32_bf16 a[224:227], a[220:223], a[144:147], a[224:227]
 v_mfma_f32_16x16x32_bf16 a[228:231], a[220:223], a[148:151], a[228:231]
 v_add_f32 v214, v214, v14
 v_mfma_f32_16x16x32_bf16 a[232:235], a[220:223], a[152:155], a[232:235]
 v_mfma_f32_16x16x32_bf16 a[236:239], a[220:223], a[156:159], a[236:239]
 buffer_load_dwordx4 a[220:223], v2, s[12:15], s24 offen offset:3072
 s_add_u32 s24, s24, 32768
 s_waitcnt vmcnt(14)
 s_waitcnt lgkmcnt(0)
 v_mfma_f32_16x16x32_bf16 v[32:35], a[160:163], a[128:131], v[32:35]
 v_add_f32 v215, v215, v15
 v_mfma_f32_16x16x32_bf16 v[36:39], a[160:163], a[132:135], v[36:39]
 ds_read_b128 a[144:147], v4 offset:36864
 v_mfma_f32_16x16x32_bf16 v[40:43], a[160:163], a[136:139], v[40:43]
 v_add_f32 v228, v228, v16
 v_mfma_f32_16x16x32_bf16 v[44:47], a[160:163], a[140:143], v[44:47]
 buffer_load_dwordx4 a[160:163], v1, s[12:15], s24 offen
 v_mfma_f32_16x16x32_bf16 v[48:51], a[164:167], a[128:131], v[48:51]
 v_mfma_f32_16x16x32_bf16 v[52:55], a[164:167], a[132:135], v[52:55]
 ds_read_b128 a[148:151], v4 offset:37888
 v_mfma_f32_16x16x32_bf16 v[56:59], a[164:167], a[136:139], v[56:59]
 v_add_f32 v229, v229, v17
 v_mfma_f32_16x16x32_bf16 v[60:63], a[164:167], a[140:143], v[60:63]
 buffer_load_dwordx4 a[164:167], v1, s[12:15], s24 offen offset:1024
 s_waitcnt vmcnt(14)
 v_mfma_f32_16x16x32_bf16 v[64:67], a[168:171], a[128:131], v[64:67]
 v_mfma_f32_16x16x32_bf16 v[68:71], a[168:171], a[132:135], v[68:71]
 ds_read_b128 a[152:155], v4 offset:38912
 v_mfma_f32_16x16x32_bf16 v[72:75], a[168:171], a[136:139], v[72:75]
 v_add_f32 v230, v230, v18
 v_mfma_f32_16x16x32_bf16 v[76:79], a[168:171], a[140:143], v[76:79]
 buffer_load_dwordx4 a[168:171], v1, s[12:15], s24 offen offset:2048
 v_mfma_f32_16x16x32_bf16 v[80:83], a[172:175], a[128:131], v[80:83]
 v_mfma_f32_16x16x32_bf16 v[84:87], a[172:175], a[132:135], v[84:87]
 ds_read_b128 a[156:159], v4 offset:39936
 v_mfma_f32_16x16x32_bf16 v[88:91], a[172:175], a[136:139], v[88:91]
 v_add_f32 v231, v231, v19
 v_mfma_f32_16x16x32_bf16 v[92:95], a[172:175], a[140:143], v[92:95]
 buffer_load_dwordx4 a[172:175], v1, s[12:15], s24 offen offset:3072
 s_waitcnt vmcnt(14)
 v_mfma_f32_16x16x32_bf16 v[96:99], a[176:179], a[128:131], v[96:99]
 v_mfma_f32_16x16x32_bf16 v[100:103], a[176:179], a[132:135], v[100:103]
 v_add_f32 v216, v216, v12
 v_mfma_f32_16x16x32_bf16 v[104:107], a[176:179], a[136:139], v[104:107]
 v_mfma_f32_16x16x32_bf16 v[108:111], a[176:179], a[140:143], v[108:111]
 buffer_load_dwordx4 a[176:179], v2, s[12:15], s24 offen
 v_mfma_f32_16x16x32_bf16 v[112:115], a[180:183], a[128:131], v[112:115]
 v_add_f32 v217, v217, v13
 v_mfma_f32_16x16x32_bf16 v[116:119], a[180:183], a[132:135], v[116:119]
 v_mfma_f32_16x16x32_bf16 v[120:123], a[180:183], a[136:139], v[120:123]
 v_add_f32 v218, v218, v14
 v_mfma_f32_16x16x32_bf16 v[124:127], a[180:183], a[140:143], v[124:127]
 buffer_load_dwordx4 a[180:183], v2, s[12:15], s24 offen offset:1024
 s_waitcnt vmcnt(14)
 v_mfma_f32_16x16x32_bf16 v[128:131], a[184:187], a[128:131], v[128:131]
 v_add_f32 v219, v219, v15
 v_mfma_f32_16x16x32_bf16 v[132:135], a[184:187], a[132:135], v[132:135]
 v_mfma_f32_16x16x32_bf16 v[136:139], a[184:187], a[136:139], v[136:139]
 v_add_f32 v232, v232, v16
 v_mfma_f32_16x16x32_bf16 v[140:143], a[184:187], a[140:143], v[140:143]
 buffer_load_dwordx4 a[184:187], v2, s[12:15], s24 offen offset:2048
 v_mfma_f32_16x16x32_bf16 a[224:227], a[188:191], a[128:131], a[224:227]
 v_mfma_f32_16x16x32_bf16 a[228:231], a[188:191], a[132:135], a[228:231]
 v_add_f32 v233, v233, v17
 v_mfma_f32_16x16x32_bf16 a[232:235], a[188:191], a[136:139], a[232:235]
 v_mfma_f32_16x16x32_bf16 a[236:239], a[188:191], a[140:143], a[236:239]
 buffer_load_dwordx4 a[188:191], v2, s[12:15], s24 offen offset:3072
 s_add_u32 s24, s24, 32768
 s_waitcnt vmcnt(14)
 s_waitcnt lgkmcnt(0)
 v_mfma_f32_16x16x32_bf16 v[32:35], a[192:195], a[144:147], v[32:35]
 v_add_f32 v234, v234, v18
 v_mfma_f32_16x16x32_bf16 v[36:39], a[192:195], a[148:151], v[36:39]
 ds_read_b128 a[128:131], v4 offset:40960
 v_mfma_f32_16x16x32_bf16 v[40:43], a[192:195], a[152:155], v[40:43]
 v_mfma_f32_16x16x32_bf16 v[44:47], a[192:195], a[156:159], v[44:47]
 buffer_load_dwordx4 a[192:195], v1, s[12:15], s24 offen
 v_mfma_f32_16x16x32_bf16 v[48:51], a[196:199], a[144:147], v[48:51]
 v_add_f32 v235, v235, v19
 v_mfma_f32_16x16x32_bf16 v[52:55], a[196:199], a[148:151], v[52:55]
 ds_read_b128 a[132:135], v4 offset:41984
 v_mfma_f32_16x16x32_bf16 v[56:59], a[196:199], a[152:155], v[56:59]
 v_mfma_f32_16x16x32_bf16 v[60:63], a[196:199], a[156:159], v[60:63]
 buffer_load_dwordx4 a[196:199], v1, s[12:15], s24 offen offset:1024
 s_waitcnt vmcnt(14)
 v_mfma_f32_16x16x32_bf16 v[64:67], a[200:203], a[144:147], v[64:67]
 v_add_f32 v220, v220, v12
 v_mfma_f32_16x16x32_bf16 v[68:71], a[200:203], a[148:151], v[68:71]
 ds_read_b128 a[136:139], v4 offset:43008
 v_mfma_f32_16x16x32_bf16 v[72:75], a[200:203], a[152:155], v[72:75]
 v_mfma_f32_16x16x32_bf16 v[76:79], a[200:203], a[156:159], v[76:79]
 buffer_load_dwordx4 a[200:203], v1, s[12:15], s24 offen offset:2048
 v_mfma_f32_16x16x32_bf16 v[80:83], a[204:207], a[144:147], v[80:83]
 v_add_f32 v221, v221, v13
 v_mfma_f32_16x16x32_bf16 v[84:87], a[204:207], a[148:151], v[84:87]
 ds_read_b128 a[140:143], v4 offset:44032
 v_mfma_f32_16x16x32_bf16 v[88:91], a[204:207], a[152:155], v[88:91]
 v_add_f32 v222, v222, v14
 v_mfma_f32_16x16x32_bf16 v[92:95], a[204:207], a[156:159], v[92:95]
 buffer_load_dwordx4 a[204:207], v1, s[12:15], s24 offen offset:3072
 s_waitcnt vmcnt(14)
 v_mfma_f32_16x16x32_bf16 v[96:99], a[208:211], a[144:147], v[96:99]
 v_mfma_f32_16x16x32_bf16 v[100:103], a[208:211], a[148:151], v[100:103]
 v_add_f32 v223, v223, v15
 v_mfma_f32_16x16x32_bf16 v[104:107], a[208:211], a[152:155], v[104:107]
 v_mfma_f32_16x16x32_bf16 v[108:111], a[208:211], a[156:159], v[108:111]
 buffer_load_dwordx4 a[208:211], v2, s[12:15], s24 offen
 v_mfma_f32_16x16x32_bf16 v[112:115], a[212:215], a[144:147], v[112:115]
 v_add_f32 v236, v236, v16
 v_mfma_f32_16x16x32_bf16 v[116:119], a[212:215], a[148:151], v[116:119]
 v_mfma_f32_16x16x32_bf16 v[120:123], a[212:215], a[152:155], v[120:123]
 v_add_f32 v237, v237, v17
 v_mfma_f32_16x16x32_bf16 v[124:127], a[212:215], a[156:159], v[124:127]
 buffer_load_dwordx4 a[212:215], v2, s[12:15], s24 offen offset:1024
 s_waitcnt vmcnt(14)
 v_mfma_f32_16x16x32_bf16 v[128:131], a[216:219], a[144:147], v[128:131]
 v_mfma_f32_16x16x32_bf16 v[132:135], a[216:219], a[148:151], v[132:135]
 v_add_f32 v238, v238, v18
 v_mfma_f32_16x16x32_bf16 v[136:139], a[216:219], a[152:155], v[136:139]
 v_mfma_f32_16x16x32_bf16 v[140:143], a[216:219], a[156:159], v[140:143]
 buffer_load_dwordx4 a[216:219], v2, s[12:15], s24 offen offset:2048
 v_mfma_f32_16x16x32_bf16 a[224:227], a[220:223], a[144:147], a[224:227]
 v_add_f32 v239, v239, v19
 v_mfma_f32_16x16x32_bf16 a[228:231], a[220:223], a[148:151], a[228:231]
 v_mfma_f32_16x16x32_bf16 a[232:235], a[220:223], a[152:155], a[232:235]
 v_mfma_f32_16x16x32_bf16 a[236:239], a[220:223], a[156:159], a[236:239]
 buffer_load_dwordx4 a[220:223], v2, s[12:15], s24 offen offset:3072
 s_add_u32 s24, s24, 32768
 s_waitcnt vmcnt(14)
 s_waitcnt lgkmcnt(0)
 v_mfma_f32_16x16x32_bf16 v[32:35], a[160:163], a[128:131], v[32:35]
 v_add_f32 v240, v240, v20
 v_mfma_f32_16x16x32_bf16 v[36:39], a[160:163], a[132:135], v[36:39]
 ds_read_b128 a[144:147], v4 offset:45056
 v_mfma_f32_16x16x32_bf16 v[40:43], a[160:163], a[136:139], v[40:43]
 v_mfma_f32_16x16x32_bf16 v[44:47], a[160:163], a[140:143], v[44:47]
 buffer_load_dwordx4 a[160:163], v1, s[12:15], s24 offen
 v_mfma_f32_16x16x32_bf16 v[48:51], a[164:167], a[128:131], v[48:51]
 v_add_f32 v241, v241, v21
 v_mfma_f32_16x16x32_bf16 v[52:55], a[164:167], a[132:135], v[52:55]
 ds_read_b128 a[148:151], v4 offset:46080
 v_mfma_f32_16x16x32_bf16 v[56:59], a[164:167], a[136:139], v[56:59]
 v_mfma_f32_16x16x32_bf16 v[60:63], a[164:167], a[140:143], v[60:63]
 buffer_load_dwordx4 a[164:167], v1, s[12:15], s24 offen offset:1024
 s_waitcnt vmcnt(14)
 v_mfma_f32_16x16x32_bf16 v[64:67], a[168:171], a[128:131], v[64:67]
 v_add_f32 v242, v242, v22
 v_mfma_f32_16x16x32_bf16 v[68:71], a[168:171], a[132:135], v[68:71]
 ds_read_b128 a[152:155], v4 offset:47104
 v_mfma_f32_16x16x32_bf16 v[72:75], a[168:171], a[136:139], v[72:75]
 v_mfma_f32_16x16x32_bf16 v[76:79], a[168:171], a[140:143], v[76:79]
 buffer_load_dwordx4 a[168:171], v1, s[12:15], s24 offen offset:2048
 v_mfma_f32_16x16x32_bf16 v[80:83], a[172:175], a[128:131], v[80:83]
 v_add_f32 v243, v243, v23
 v_mfma_f32_16x16x32_bf16 v[84:87], a[172:175], a[132:135], v[84:87]
 ds_read_b128 a[156:159], v4 offset:48128
 v_mfma_f32_16x16x32_bf16 v[88:91], a[172:175], a[136:139], v[88:91]
 v_mfma_f32_16x16x32_bf16 v[92:95], a[172:175], a[140:143], v[92:95]
 buffer_load_dwordx4 a[172:175], v1, s[12:15], s24 offen offset:3072
 s_waitcnt vmcnt(14)
 v_mfma_f32_16x16x32_bf16 v[96:99], a[176:179], a[128:131], v[96:99]
 v_accvgpr_read_b32 v28, a240
 v_mfma_f32_16x16x32_bf16 v[100:103], a[176:179], a[132:135], v[100:103]
 v_mfma_f32_16x16x32_bf16 v[104:107], a[176:179], a[136:139], v[104:107]
 v_add_f32 v28, v28, v24
 v_mfma_f32_16x16x32_bf16 v[108:111], a[176:179], a[140:143], v[108:111]
 buffer_load_dwordx4 a[176:179], v2, s[12:15], s24 offen
 v_mfma_f32_16x16x32_bf16 v[112:115], a[180:183], a[128:131], v[112:115]
 v_mfma_f32_16x16x32_bf16 v[116:119], a[180:183], a[132:135], v[116:119]
 v_accvgpr_write_b32 a240, v28
 v_mfma_f32_16x16x32_bf16 v[120:123], a[180:183], a[136:139], v[120:123]
 v_accvgpr_read_b32 v29, a241
 v_mfma_f32_16x16x32_bf16 v[124:127], a[180:183], a[140:143], v[124:127]
 buffer_load_dwordx4 a[180:183], v2, s[12:15], s24 offen offset:1024
 s_waitcnt vmcnt(14)
 v_mfma_f32_16x16x32_bf16 v[128:131], a[184:187], a[128:131], v[128:131]
 v_mfma_f32_16x16x32_bf16 v[132:135], a[184:187], a[132:135], v[132:135]
 v_add_f32 v29, v29, v25
 v_mfma_f32_16x16x32_bf16 v[136:139], a[184:187], a[136:139], v[136:139]
 v_mfma_f32_16x16x32_bf16 v[140:143], a[184:187], a[140:143], v[140:143]
 buffer_load_dwordx4 a[184:187], v2, s[12:15], s24 offen offset:2048
 v_mfma_f32_16x16x32_bf16 a[224:227], a[188:191], a[128:131], a[224:227]
 v_accvgpr_write_b32 a241, v29
 v_mfma_f32_16x16x32_bf16 a[228:231], a[188:191], a[132:135], a[228:231]
 v_mfma_f32_16x16x32_bf16 a[232:235], a[188:191], a[136:139], a[232:235]
 v_accvgpr_read_b32 v28, a242
 v_mfma_f32_16x16x32_bf16 a[236:239], a[188:191], a[140:143], a[236:239]
 buffer_load_dwordx4 a[188:191], v2, s[12:15], s24 offen offset:3072
 s_add_u32 s24, s24, 32768
 s_waitcnt vmcnt(14)
 s_waitcnt lgkmcnt(0)
 v_mfma_f32_16x16x32_bf16 v[32:35], a[192:195], a[144:147], v[32:35]
 v_mfma_f32_16x16x32_bf16 v[36:39], a[192:195], a[148:151], v[36:39]
 ds_read_b128 a[128:131], v4 offset:49152
 v_mfma_f32_16x16x32_bf16 v[40:43], a[192:195], a[152:155], v[40:43]
 v_add_f32 v28, v28, v26
 v_mfma_f32_16x16x32_bf16 v[44:47], a[192:195], a[156:159], v[44:47]
 buffer_load_dwordx4 a[192:195], v1, s[12:15], s24 offen
 v_mfma_f32_16x16x32_bf16 v[48:51], a[196:199], a[144:147], v[48:51]
 v_mfma_f32_16x16x32_bf16 v[52:55], a[196:199], a[148:151], v[52:55]
 ds_read_b128 a[132:135], v4 offset:50176
 v_mfma_f32_16x16x32_bf16 v[56:59], a[196:199], a[152:155], v[56:59]
 v_accvgpr_write_b32 a242, v28
 v_mfma_f32_16x16x32_bf16 v[60:63], a[196:199], a[156:159], v[60:63]
 buffer_load_dwordx4 a[196:199], v1, s[12:15], s24 offen offset:1024
 s_waitcnt vmcnt(14)
 v_mfma_f32_16x16x32_bf16 v[64:67], a[200:203], a[144:147], v[64:67]
 v_mfma_f32_16x16x32_bf16 v[68:71], a[200:203], a[148:151], v[68:71]
 ds_read_b128 a[136:139], v4 offset:51200
 v_mfma_f32_16x16x32_bf16 v[72:75], a[200:203], a[152:155], v[72:75]
 v_accvgpr_read_b32 v29, a243
 v_mfma_f32_16x16x32_bf16 v[76:79], a[200:203], a[156:159], v[76:79]
 buffer_load_dwordx4 a[200:203], v1, s[12:15], s24 offen offset:2048
 v_mfma_f32_16x16x32_bf16 v[80:83], a[204:207], a[144:147], v[80:83]
 v_add_f32 v29, v29, v27
 v_mfma_f32_16x16x32_bf16 v[84:87], a[204:207], a[148:151], v[84:87]
 ds_read_b128 a[140:143], v4 offset:52224
 v_mfma_f32_16x16x32_bf16 v[88:91], a[204:207], a[152:155], v[88:91]
 v_mfma_f32_16x16x32_bf16 v[92:95], a[204:207], a[156:159], v[92:95]
 buffer_load_dwordx4 a[204:207], v1, s[12:15], s24 offen offset:3072
 s_waitcnt vmcnt(14)
 v_mfma_f32_16x16x32_bf16 v[96:99], a[208:211], a[144:147], v[96:99]
 v_accvgpr_write_b32 a243, v29
 v_mfma_f32_16x16x32_bf16 v[100:103], a[208:211], a[148:151], v[100:103]
 v_mfma_f32_16x16x32_bf16 v[104:107], a[208:211], a[152:155], v[104:107]
 v_add_f32 v244, v244, v20
 v_mfma_f32_16x16x32_bf16 v[108:111], a[208:211], a[156:159], v[108:111]
 buffer_load_dwordx4 a[208:211], v2, s[12:15], s24 offen
 v_mfma_f32_16x16x32_bf16 v[112:115], a[212:215], a[144:147], v[112:115]
 v_mfma_f32_16x16x32_bf16 v[116:119], a[212:215], a[148:151], v[116:119]
 v_add_f32 v245, v245, v21
 v_mfma_f32_16x16x32_bf16 v[120:123], a[212:215], a[152:155], v[120:123]
 v_mfma_f32_16x16x32_bf16 v[124:127], a[212:215], a[156:159], v[124:127]
 buffer_load_dwordx4 a[212:215], v2, s[12:15], s24 offen offset:1024
 s_waitcnt vmcnt(14)
 v_mfma_f32_16x16x32_bf16 v[128:131], a[216:219], a[144:147], v[128:131]
 v_add_f32 v246, v246, v22
 v_mfma_f32_16x16x32_bf16 v[132:135], a[216:219], a[148:151], v[132:135]
 v_mfma_f32_16x16x32_bf16 v[136:139], a[216:219], a[152:155], v[136:139]
 v_add_f32 v247, v247, v23
 v_mfma_f32_16x16x32_bf16 v[140:143], a[216:219], a[156:159], v[140:143]
 buffer_load_dwordx4 a[216:219], v2, s[12:15], s24 offen offset:2048
 v_mfma_f32_16x16x32_bf16 a[224:227], a[220:223], a[144:147], a[224:227]
 v_mfma_f32_16x16x32_bf16 a[228:231], a[220:223], a[148:151], a[228:231]
 v_accvgpr_read_b32 v28, a244
 v_mfma_f32_16x16x32_bf16 a[232:235], a[220:223], a[152:155], a[232:235]
 v_mfma_f32_16x16x32_bf16 a[236:239], a[220:223], a[156:159], a[236:239]
 buffer_load_dwordx4 a[220:223], v2, s[12:15], s24 offen offset:3072
 s_add_u32 s24, s24, 32768
 s_waitcnt vmcnt(14)
 s_waitcnt lgkmcnt(0)
 v_mfma_f32_16x16x32_bf16 v[32:35], a[160:163], a[128:131], v[32:35]
 v_add_f32 v28, v28, v24
 v_mfma_f32_16x16x32_bf16 v[36:39], a[160:163], a[132:135], v[36:39]
 ds_read_b128 a[144:147], v4 offset:53248
 v_mfma_f32_16x16x32_bf16 v[40:43], a[160:163], a[136:139], v[40:43]
 v_accvgpr_write_b32 a244, v28
 v_mfma_f32_16x16x32_bf16 v[44:47], a[160:163], a[140:143], v[44:47]
 buffer_load_dwordx4 a[160:163], v1, s[12:15], s24 offen
 v_mfma_f32_16x16x32_bf16 v[48:51], a[164:167], a[128:131], v[48:51]
 v_mfma_f32_16x16x32_bf16 v[52:55], a[164:167], a[132:135], v[52:55]
 ds_read_b128 a[148:151], v4 offset:54272
 v_mfma_f32_16x16x32_bf16 v[56:59], a[164:167], a[136:139], v[56:59]
 v_accvgpr_read_b32 v29, a245
 v_mfma_f32_16x16x32_bf16 v[60:63], a[164:167], a[140:143], v[60:63]
 buffer_load_dwordx4 a[164:167], v1, s[12:15], s24 offen offset:1024
 s_waitcnt vmcnt(14)
 v_mfma_f32_16x16x32_bf16 v[64:67], a[168:171], a[128:131], v[64:67]
 v_mfma_f32_16x16x32_bf16 v[68:71], a[168:171], a[132:135], v[68:71]
 ds_read_b128 a[152:155], v4 offset:55296
 v_mfma_f32_16x16x32_bf16 v[72:75], a[168:171], a[136:139], v[72:75]
 v_add_f32 v29, v29, v25
 v_mfma_f32_16x16x32_bf16 v[76:79], a[168:171], a[140:143], v[76:79]
 buffer_load_dwordx4 a[168:171], v1, s[12:15], s24 offen offset:2048
 v_mfma_f32_16x16x32_bf16 v[80:83], a[172:175], a[128:131], v[80:83]
 v_mfma_f32_16x16x32_bf16 v[84:87], a[172:175], a[132:135], v[84:87]
 ds_read_b128 a[156:159], v4 offset:56320
 v_mfma_f32_16x16x32_bf16 v[88:91], a[172:175], a[136:139], v[88:91]
 v_accvgpr_write_b32 a245, v29
 v_mfma_f32_16x16x32_bf16 v[92:95], a[172:175], a[140:143], v[92:95]
 buffer_load_dwordx4 a[172:175], v1, s[12:15], s24 offen offset:3072
 s_waitcnt vmcnt(14)
 v_mfma_f32_16x16x32_bf16 v[96:99], a[176:179], a[128:131], v[96:99]
 v_mfma_f32_16x16x32_bf16 v[100:103], a[176:179], a[132:135], v[100:103]
 v_accvgpr_read_b32 v28, a246
 v_mfma_f32_16x16x32_bf16 v[104:107], a[176:179], a[136:139], v[104:107]
 v_mfma_f32_16x16x32_bf16 v[108:111], a[176:179], a[140:143], v[108:111]
 buffer_load_dwordx4 a[176:179], v2, s[12:15], s24 offen
 v_mfma_f32_16x16x32_bf16 v[112:115], a[180:183], a[128:131], v[112:115]
 v_add_f32 v28, v28, v26
 v_mfma_f32_16x16x32_bf16 v[116:119], a[180:183], a[132:135], v[116:119]
 v_mfma_f32_16x16x32_bf16 v[120:123], a[180:183], a[136:139], v[120:123]
 v_accvgpr_write_b32 a246, v28
 v_mfma_f32_16x16x32_bf16 v[124:127], a[180:183], a[140:143], v[124:127]
 buffer_load_dwordx4 a[180:183], v2, s[12:15], s24 offen offset:1024
 s_waitcnt vmcnt(14)
 v_mfma_f32_16x16x32_bf16 v[128:131], a[184:187], a[128:131], v[128:131]
 v_accvgpr_read_b32 v29, a247
 v_mfma_f32_16x16x32_bf16 v[132:135], a[184:187], a[132:135], v[132:135]
 v_mfma_f32_16x16x32_bf16 v[136:139], a[184:187], a[136:139], v[136:139]
 v_add_f32 v29, v29, v27
 v_mfma_f32_16x16x32_bf16 v[140:143], a[184:187], a[140:143], v[140:143]
 buffer_load_dwordx4 a[184:187], v2, s[12:15], s24 offen offset:2048
 v_mfma_f32_16x16x32_bf16 a[224:227], a[188:191], a[128:131], a[224:227]
 v_mfma_f32_16x16x32_bf16 a[228:231], a[188:191], a[132:135], a[228:231]
 v_accvgpr_write_b32 a247, v29
 v_mfma_f32_16x16x32_bf16 a[232:235], a[188:191], a[136:139], a[232:235]
 v_mfma_f32_16x16x32_bf16 a[236:239], a[188:191], a[140:143], a[236:239]
 buffer_load_dwordx4 a[188:191], v2, s[12:15], s24 offen offset:3072
 s_add_u32 s24, s24, 32768
 s_waitcnt vmcnt(14)
 s_waitcnt lgkmcnt(0)
 v_mfma_f32_16x16x32_bf16 v[32:35], a[192:195], a[144:147], v[32:35]
 v_add_f32 v248, v248, v20
 v_mfma_f32_16x16x32_bf16 v[36:39], a[192:195], a[148:151], v[36:39]
 ds_read_b128 a[128:131], v4 offset:57344
 v_mfma_f32_16x16x32_bf16 v[40:43], a[192:195], a[152:155], v[40:43]
 v_mfma_f32_16x16x32_bf16 v[44:47], a[192:195], a[156:159], v[44:47]
 buffer_load_dwordx4 a[192:195], v1, s[12:15], s24 offen
 v_mfma_f32_16x16x32_bf16 v[48:51], a[196:199], a[144:147], v[48:51]
 v_add_f32 v249, v249, v21
 v_mfma_f32_16x16x32_bf16 v[52:55], a[196:199], a[148:151], v[52:55]
 ds_read_b128 a[132:135], v4 offset:58368
 v_mfma_f32_16x16x32_bf16 v[56:59], a[196:199], a[152:155], v[56:59]
 v_mfma_f32_16x16x32_bf16 v[60:63], a[196:199], a[156:159], v[60:63]
 buffer_load_dwordx4 a[196:199], v1, s[12:15], s24 offen offset:1024
 s_waitcnt vmcnt(14)
 v_mfma_f32_16x16x32_bf16 v[64:67], a[200:203], a[144:147], v[64:67]
 v_add_f32 v250, v250, v22
 v_mfma_f32_16x16x32_bf16 v[68:71], a[200:203], a[148:151], v[68:71]
 ds_read_b128 a[136:139], v4 offset:59392
 v_mfma_f32_16x16x32_bf16 v[72:75], a[200:203], a[152:155], v[72:75]
 v_mfma_f32_16x16x32_bf16 v[76:79], a[200:203], a[156:159], v[76:79]
 buffer_load_dwordx4 a[200:203], v1, s[12:15], s24 offen offset:2048
 v_mfma_f32_16x16x32_bf16 v[80:83], a[204:207], a[144:147], v[80:83]
 v_add_f32 v251, v251, v23
 v_mfma_f32_16x16x32_bf16 v[84:87], a[204:207], a[148:151], v[84:87]
 ds_read_b128 a[140:143], v4 offset:60416
 v_mfma_f32_16x16x32_bf16 v[88:91], a[204:207], a[152:155], v[88:91]
 v_accvgpr_read_b32 v28, a248
 v_mfma_f32_16x16x32_bf16 v[92:95], a[204:207], a[156:159], v[92:95]
 buffer_load_dwordx4 a[204:207], v1, s[12:15], s24 offen offset:3072
 s_waitcnt vmcnt(14)
 v_mfma_f32_16x16x32_bf16 v[96:99], a[208:211], a[144:147], v[96:99]
 v_mfma_f32_16x16x32_bf16 v[100:103], a[208:211], a[148:151], v[100:103]
 v_add_f32 v28, v28, v24
 v_mfma_f32_16x16x32_bf16 v[104:107], a[208:211], a[152:155], v[104:107]
 v_mfma_f32_16x16x32_bf16 v[108:111], a[208:211], a[156:159], v[108:111]
 buffer_load_dwordx4 a[208:211], v2, s[12:15], s24 offen
 v_mfma_f32_16x16x32_bf16 v[112:115], a[212:215], a[144:147], v[112:115]
 v_accvgpr_write_b32 a248, v28
 v_mfma_f32_16x16x32_bf16 v[116:119], a[212:215], a[148:151], v[116:119]
 v_mfma_f32_16x16x32_bf16 v[120:123], a[212:215], a[152:155], v[120:123]
 v_accvgpr_read_b32 v29, a249
 v_mfma_f32_16x16x32_bf16 v[124:127], a[212:215], a[156:159], v[124:127]
 buffer_load_dwordx4 a[212:215], v2, s[12:15], s24 offen offset:1024
 s_waitcnt vmcnt(14)
 v_mfma_f32_16x16x32_bf16 v[128:131], a[216:219], a[144:147], v[128:131]
 v_mfma_f32_16x16x32_bf16 v[132:135], a[216:219], a[148:151], v[132:135]
 v_add_f32 v29, v29, v25
 v_mfma_f32_16x16x32_bf16 v[136:139], a[216:219], a[152:155], v[136:139]
 v_mfma_f32_16x16x32_bf16 v[140:143], a[216:219], a[156:159], v[140:143]
 buffer_load_dwordx4 a[216:219], v2, s[12:15], s24 offen offset:2048
 v_mfma_f32_16x16x32_bf16 a[224:227], a[220:223], a[144:147], a[224:227]
 v_accvgpr_write_b32 a249, v29
 v_mfma_f32_16x16x32_bf16 a[228:231], a[220:223], a[148:151], a[228:231]
 v_mfma_f32_16x16x32_bf16 a[232:235], a[220:223], a[152:155], a[232:235]
 v_accvgpr_read_b32 v28, a250
 v_mfma_f32_16x16x32_bf16 a[236:239], a[220:223], a[156:159], a[236:239]
 buffer_load_dwordx4 a[220:223], v2, s[12:15], s24 offen offset:3072
 s_add_u32 s24, s24, 32768
 s_waitcnt vmcnt(14)
 s_waitcnt lgkmcnt(0)
 v_mfma_f32_16x16x32_bf16 v[32:35], a[160:163], a[128:131], v[32:35]
 v_add_f32 v28, v28, v26
 v_mfma_f32_16x16x32_bf16 v[36:39], a[160:163], a[132:135], v[36:39]
 ds_read_b128 a[144:147], v4 offset:61440
 v_mfma_f32_16x16x32_bf16 v[40:43], a[160:163], a[136:139], v[40:43]
 v_mfma_f32_16x16x32_bf16 v[44:47], a[160:163], a[140:143], v[44:47]
 buffer_load_dwordx4 a[160:163], v1, s[12:15], s24 offen
 v_mfma_f32_16x16x32_bf16 v[48:51], a[164:167], a[128:131], v[48:51]
 v_accvgpr_write_b32 a250, v28
 v_mfma_f32_16x16x32_bf16 v[52:55], a[164:167], a[132:135], v[52:55]
 ds_read_b128 a[148:151], v4 offset:62464
 v_mfma_f32_16x16x32_bf16 v[56:59], a[164:167], a[136:139], v[56:59]
 v_mfma_f32_16x16x32_bf16 v[60:63], a[164:167], a[140:143], v[60:63]
 buffer_load_dwordx4 a[164:167], v1, s[12:15], s24 offen offset:1024
 s_waitcnt vmcnt(14)
 v_mfma_f32_16x16x32_bf16 v[64:67], a[168:171], a[128:131], v[64:67]
 v_accvgpr_read_b32 v29, a251
 v_mfma_f32_16x16x32_bf16 v[68:71], a[168:171], a[132:135], v[68:71]
 ds_read_b128 a[152:155], v4 offset:63488
 v_mfma_f32_16x16x32_bf16 v[72:75], a[168:171], a[136:139], v[72:75]
 v_mfma_f32_16x16x32_bf16 v[76:79], a[168:171], a[140:143], v[76:79]
 buffer_load_dwordx4 a[168:171], v1, s[12:15], s24 offen offset:2048
 v_mfma_f32_16x16x32_bf16 v[80:83], a[172:175], a[128:131], v[80:83]
 v_add_f32 v29, v29, v27
 v_mfma_f32_16x16x32_bf16 v[84:87], a[172:175], a[132:135], v[84:87]
 ds_read_b128 a[156:159], v4 offset:64512
 v_mfma_f32_16x16x32_bf16 v[88:91], a[172:175], a[136:139], v[88:91]
 v_mfma_f32_16x16x32_bf16 v[92:95], a[172:175], a[140:143], v[92:95]
 buffer_load_dwordx4 a[172:175], v1, s[12:15], s24 offen offset:3072
 s_waitcnt vmcnt(14)
 v_mfma_f32_16x16x32_bf16 v[96:99], a[176:179], a[128:131], v[96:99]
 v_accvgpr_write_b32 a251, v29
 v_mfma_f32_16x16x32_bf16 v[100:103], a[176:179], a[132:135], v[100:103]
 v_mfma_f32_16x16x32_bf16 v[104:107], a[176:179], a[136:139], v[104:107]
 v_add_f32 v252, v252, v20
 v_mfma_f32_16x16x32_bf16 v[108:111], a[176:179], a[140:143], v[108:111]
 buffer_load_dwordx4 a[176:179], v2, s[12:15], s24 offen
 v_mfma_f32_16x16x32_bf16 v[112:115], a[180:183], a[128:131], v[112:115]
 v_mfma_f32_16x16x32_bf16 v[116:119], a[180:183], a[132:135], v[116:119]
 v_add_f32 v253, v253, v21
 v_mfma_f32_16x16x32_bf16 v[120:123], a[180:183], a[136:139], v[120:123]
 v_add_f32 v254, v254, v22
 v_mfma_f32_16x16x32_bf16 v[124:127], a[180:183], a[140:143], v[124:127]
 buffer_load_dwordx4 a[180:183], v2, s[12:15], s24 offen offset:1024
 s_waitcnt vmcnt(14)
 v_mfma_f32_16x16x32_bf16 v[128:131], a[184:187], a[128:131], v[128:131]
 v_mfma_f32_16x16x32_bf16 v[132:135], a[184:187], a[132:135], v[132:135]
 v_add_f32 v255, v255, v23
 v_mfma_f32_16x16x32_bf16 v[136:139], a[184:187], a[136:139], v[136:139]
 v_mfma_f32_16x16x32_bf16 v[140:143], a[184:187], a[140:143], v[140:143]
 buffer_load_dwordx4 a[184:187], v2, s[12:15], s24 offen offset:2048
 v_mfma_f32_16x16x32_bf16 a[224:227], a[188:191], a[128:131], a[224:227]
 v_accvgpr_read_b32 v28, a252
 v_mfma_f32_16x16x32_bf16 a[228:231], a[188:191], a[132:135], a[228:231]
 v_mfma_f32_16x16x32_bf16 a[232:235], a[188:191], a[136:139], a[232:235]
 v_add_f32 v28, v28, v24
 v_mfma_f32_16x16x32_bf16 a[236:239], a[188:191], a[140:143], a[236:239]
 buffer_load_dwordx4 a[188:191], v2, s[12:15], s24 offen offset:3072
 s_add_u32 s24, s24, 32768
 s_waitcnt vmcnt(14)
 s_waitcnt lgkmcnt(0)
 v_mfma_f32_16x16x32_bf16 v[32:35], a[192:195], a[144:147], v[32:35]
 v_mfma_f32_16x16x32_bf16 v[36:39], a[192:195], a[148:151], v[36:39]
 ds_read_b128 a[128:131], v3
 v_mfma_f32_16x16x32_bf16 v[40:43], a[192:195], a[152:155], v[40:43]
 v_accvgpr_write_b32 a252, v28
 v_mfma_f32_16x16x32_bf16 v[44:47], a[192:195], a[156:159], v[44:47]
 buffer_load_dwordx4 a[192:195], v1, s[12:15], s24 offen
 v_mfma_f32_16x16x32_bf16 v[48:51], a[196:199], a[144:147], v[48:51]
 v_mfma_f32_16x16x32_bf16 v[52:55], a[196:199], a[148:151], v[52:55]
 ds_read_b128 a[132:135], v3 offset:1024
 v_mfma_f32_16x16x32_bf16 v[56:59], a[196:199], a[152:155], v[56:59]
 v_accvgpr_read_b32 v29, a253
 v_mfma_f32_16x16x32_bf16 v[60:63], a[196:199], a[156:159], v[60:63]
 buffer_load_dwordx4 a[196:199], v1, s[12:15], s24 offen offset:1024
 s_waitcnt vmcnt(14)
 v_mfma_f32_16x16x32_bf16 v[64:67], a[200:203], a[144:147], v[64:67]
 v_mfma_f32_16x16x32_bf16 v[68:71], a[200:203], a[148:151], v[68:71]
 ds_read_b128 a[136:139], v3 offset:2048
 v_mfma_f32_16x16x32_bf16 v[72:75], a[200:203], a[152:155], v[72:75]
 v_add_f32 v29, v29, v25
 v_mfma_f32_16x16x32_bf16 v[76:79], a[200:203], a[156:159], v[76:79]
 buffer_load_dwordx4 a[200:203], v1, s[12:15], s24 offen offset:2048
 v_mfma_f32_16x16x32_bf16 v[80:83], a[204:207], a[144:147], v[80:83]
 v_accvgpr_write_b32 a253, v29
 v_mfma_f32_16x16x32_bf16 v[84:87], a[204:207], a[148:151], v[84:87]
 ds_read_b128 a[140:143], v3 offset:3072
 v_mfma_f32_16x16x32_bf16 v[88:91], a[204:207], a[152:155], v[88:91]
 v_mfma_f32_16x16x32_bf16 v[92:95], a[204:207], a[156:159], v[92:95]
 buffer_load_dwordx4 a[204:207], v1, s[12:15], s24 offen offset:3072
 s_waitcnt vmcnt(14)
 v_mfma_f32_16x16x32_bf16 v[96:99], a[208:211], a[144:147], v[96:99]
 v_accvgpr_read_b32 v28, a254
 v_mfma_f32_16x16x32_bf16 v[100:103], a[208:211], a[148:151], v[100:103]
 v_mfma_f32_16x16x32_bf16 v[104:107], a[208:211], a[152:155], v[104:107]
 v_add_f32 v28, v28, v26
 v_mfma_f32_16x16x32_bf16 v[108:111], a[208:211], a[156:159], v[108:111]
 buffer_load_dwordx4 a[208:211], v2, s[12:15], s24 offen
 v_mfma_f32_16x16x32_bf16 v[112:115], a[212:215], a[144:147], v[112:115]
 v_mfma_f32_16x16x32_bf16 v[116:119], a[212:215], a[148:151], v[116:119]
 v_accvgpr_write_b32 a254, v28
 v_mfma_f32_16x16x32_bf16 v[120:123], a[212:215], a[152:155], v[120:123]
 v_mfma_f32_16x16x32_bf16 v[124:127], a[212:215], a[156:159], v[124:127]
 buffer_load_dwordx4 a[212:215], v2, s[12:15], s24 offen offset:1024
 s_waitcnt vmcnt(14)
 v_mfma_f32_16x16x32_bf16 v[128:131], a[216:219], a[144:147], v[128:131]
 v_accvgpr_read_b32 v29, a255
 v_mfma_f32_16x16x32_bf16 v[132:135], a[216:219], a[148:151], v[132:135]
 v_mfma_f32_16x16x32_bf16 v[136:139], a[216:219], a[152:155], v[136:139]
 v_add_f32 v29, v29, v27
 v_mfma_f32_16x16x32_bf16 v[140:143], a[216:219], a[156:159], v[140:143]
 buffer_load_dwordx4 a[216:219], v2, s[12:15], s24 offen offset:2048
 v_mfma_f32_16x16x32_bf16 a[224:227], a[220:223], a[144:147], a[224:227]
 v_mfma_f32_16x16x32_bf16 a[228:231], a[220:223], a[148:151], a[228:231]
 v_accvgpr_write_b32 a255, v29
 v_mfma_f32_16x16x32_bf16 a[232:235], a[220:223], a[152:155], a[232:235]
 v_mfma_f32_16x16x32_bf16 a[236:239], a[220:223], a[156:159], a[236:239]
 buffer_load_dwordx4 a[220:223], v2, s[12:15], s24 offen offset:3072
 s_add_u32 s24, s24, 32768
 s_waitcnt vmcnt(14)
 s_waitcnt lgkmcnt(0)
 v_mfma_f32_16x16x32_bf16 v[144:147], a[160:163], a[128:131], v[144:147]
 ds_read_b128 v[12:15], v7
 v_mfma_f32_16x16x32_bf16 v[148:151], a[160:163], a[132:135], v[148:151]
 ds_read_b128 a[144:147], v3 offset:4096
 v_mfma_f32_16x16x32_bf16 v[152:155], a[160:163], a[136:139], v[152:155]
 ds_read_b128 v[16:19], v7 offset:16
 v_mfma_f32_16x16x32_bf16 v[156:159], a[160:163], a[140:143], v[156:159]
 buffer_load_dwordx4 a[160:163], v1, s[12:15], s24 offen
 v_mfma_f32_16x16x32_bf16 v[160:163], a[164:167], a[128:131], v[160:163]
 v_mfma_f32_16x16x32_bf16 v[164:167], a[164:167], a[132:135], v[164:167]
 ds_read_b128 a[148:151], v3 offset:5120
 v_mfma_f32_16x16x32_bf16 v[168:171], a[164:167], a[136:139], v[168:171]
 s_waitcnt lgkmcnt(1)
 v_mfma_f32_16x16x32_bf16 v[172:175], a[164:167], a[140:143], v[172:175]
 buffer_load_dwordx4 a[164:167], v1, s[12:15], s24 offen offset:1024
 s_waitcnt vmcnt(14)
 v_mfma_f32_16x16x32_bf16 v[176:179], a[168:171], a[128:131], v[176:179]
 v_mfma_f32_16x16x32_bf16 v[180:183], a[168:171], a[132:135], v[180:183]
 ds_read_b128 a[152:155], v3 offset:6144
 v_mfma_f32_16x16x32_bf16 v[184:187], a[168:171], a[136:139], v[184:187]
 v_add_f32 v32, v32, v12
 v_mfma_f32_16x16x32_bf16 v[188:191], a[168:171], a[140:143], v[188:191]
 buffer_load_dwordx4 a[168:171], v1, s[12:15], s24 offen offset:2048
 v_mfma_f32_16x16x32_bf16 v[192:195], a[172:175], a[128:131], v[192:195]
 v_add_f32 v33, v33, v13
 v_mfma_f32_16x16x32_bf16 v[196:199], a[172:175], a[132:135], v[196:199]
 ds_read_b128 a[156:159], v3 offset:7168
 v_mfma_f32_16x16x32_bf16 v[200:203], a[172:175], a[136:139], v[200:203]
 v_mfma_f32_16x16x32_bf16 v[204:207], a[172:175], a[140:143], v[204:207]
 buffer_load_dwordx4 a[172:175], v1, s[12:15], s24 offen offset:3072
 s_waitcnt vmcnt(14)
 v_mfma_f32_16x16x32_bf16 v[208:211], a[176:179], a[128:131], v[208:211]
 ds_read_b128 v[20:23], v7 offset:128
 v_mfma_f32_16x16x32_bf16 v[212:215], a[176:179], a[132:135], v[212:215]
 v_mfma_f32_16x16x32_bf16 v[216:219], a[176:179], a[136:139], v[216:219]
 ds_read_b128 v[24:27], v7 offset:144
 v_mfma_f32_16x16x32_bf16 v[220:223], a[176:179], a[140:143], v[220:223]
 buffer_load_dwordx4 a[176:179], v2, s[12:15], s24 offen
 v_mfma_f32_16x16x32_bf16 v[224:227], a[180:183], a[128:131], v[224:227]
 v_mfma_f32_16x16x32_bf16 v[228:231], a[180:183], a[132:135], v[228:231]
 v_add_f32 v34, v34, v14
 v_mfma_f32_16x16x32_bf16 v[232:235], a[180:183], a[136:139], v[232:235]
 v_add_f32 v35, v35, v15
 v_mfma_f32_16x16x32_bf16 v[236:239], a[180:183], a[140:143], v[236:239]
 buffer_load_dwordx4 a[180:183], v2, s[12:15], s24 offen offset:1024
 s_waitcnt vmcnt(14)
 v_mfma_f32_16x16x32_bf16 v[240:243], a[184:187], a[128:131], v[240:243]
 v_mfma_f32_16x16x32_bf16 v[244:247], a[184:187], a[132:135], v[244:247]
 v_add_f32 v48, v48, v16
 v_mfma_f32_16x16x32_bf16 v[248:251], a[184:187], a[136:139], v[248:251]
 v_mfma_f32_16x16x32_bf16 v[252:255], a[184:187], a[140:143], v[252:255]
 buffer_load_dwordx4 a[184:187], v2, s[12:15], s24 offen offset:2048
 v_mfma_f32_16x16x32_bf16 a[240:243], a[188:191], a[128:131], a[240:243]
 v_add_f32 v49, v49, v17
 v_mfma_f32_16x16x32_bf16 a[244:247], a[188:191], a[132:135], a[244:247]
 v_mfma_f32_16x16x32_bf16 a[248:251], a[188:191], a[136:139], a[248:251]
 v_add_f32 v50, v50, v18
 v_mfma_f32_16x16x32_bf16 a[252:255], a[188:191], a[140:143], a[252:255]
 buffer_load_dwordx4 a[188:191], v2, s[12:15], s24 offen offset:3072
 s_add_u32 s24, s24, 32768
 s_waitcnt vmcnt(14)
 s_waitcnt lgkmcnt(2)
 v_mfma_f32_16x16x32_bf16 v[144:147], a[192:195], a[144:147], v[144:147]
 v_add_f32 v51, v51, v19
 v_mfma_f32_16x16x32_bf16 v[148:151], a[192:195], a[148:151], v[148:151]
 ds_read_b128 a[128:131], v3 offset:8192
 v_mfma_f32_16x16x32_bf16 v[152:155], a[192:195], a[152:155], v[152:155]
 v_mfma_f32_16x16x32_bf16 v[156:159], a[192:195], a[156:159], v[156:159]
 buffer_load_dwordx4 a[192:195], v1, s[12:15], s24 offen
 v_mfma_f32_16x16x32_bf16 v[160:163], a[196:199], a[144:147], v[160:163]
 v_add_f32 v36, v36, v12
 v_mfma_f32_16x16x32_bf16 v[164:167], a[196:199], a[148:151], v[164:167]
 ds_read_b128 a[132:135], v3 offset:9216
 v_mfma_f32_16x16x32_bf16 v[168:171], a[196:199], a[152:155], v[168:171]
 v_mfma_f32_16x16x32_bf16 v[172:175], a[196:199], a[156:159], v[172:175]
 buffer_load_dwordx4 a[196:199], v1, s[12:15], s24 offen offset:1024
 s_waitcnt vmcnt(14)
 v_mfma_f32_16x16x32_bf16 v[176:179], a[200:203], a[144:147], v[176:179]
 v_add_f32 v37, v37, v13
 v_mfma_f32_16x16x32_bf16 v[180:183], a[200:203], a[148:151], v[180:183]
 ds_read_b128 a[136:139], v3 offset:10240
 v_mfma_f32_16x16x32_bf16 v[184:187], a[200:203], a[152:155], v[184:187]
 v_mfma_f32_16x16x32_bf16 v[188:191], a[200:203], a[156:159], v[188:191]
 buffer_load_dwordx4 a[200:203], v1, s[12:15], s24 offen offset:2048
 v_mfma_f32_16x16x32_bf16 v[192:195], a[204:207], a[144:147], v[192:195]
 v_add_f32 v38, v38, v14
 v_mfma_f32_16x16x32_bf16 v[196:199], a[204:207], a[148:151], v[196:199]
 ds_read_b128 a[140:143], v3 offset:11264
 v_mfma_f32_16x16x32_bf16 v[200:203], a[204:207], a[152:155], v[200:203]
 v_add_f32 v39, v39, v15
 v_mfma_f32_16x16x32_bf16 v[204:207], a[204:207], a[156:159], v[204:207]
 buffer_load_dwordx4 a[204:207], v1, s[12:15], s24 offen offset:3072
 s_waitcnt vmcnt(14)
 v_mfma_f32_16x16x32_bf16 v[208:211], a[208:211], a[144:147], v[208:211]
 v_mfma_f32_16x16x32_bf16 v[212:215], a[208:211], a[148:151], v[212:215]
 v_add_f32 v52, v52, v16
 v_mfma_f32_16x16x32_bf16 v[216:219], a[208:211], a[152:155], v[216:219]
 v_mfma_f32_16x16x32_bf16 v[220:223], a[208:211], a[156:159], v[220:223]
 buffer_load_dwordx4 a[208:211], v2, s[12:15], s24 offen
 v_mfma_f32_16x16x32_bf16 v[224:227], a[212:215], a[144:147], v[224:227]
 v_add_f32 v53, v53, v17
 v_mfma_f32_16x16x32_bf16 v[228:231], a[212:215], a[148:151], v[228:231]
 v_mfma_f32_16x16x32_bf16 v[232:235], a[212:215], a[152:155], v[232:235]
 v_add_f32 v54, v54, v18
 v_mfma_f32_16x16x32_bf16 v[236:239], a[212:215], a[156:159], v[236:239]
 buffer_load_dwordx4 a[212:215], v2, s[12:15], s24 offen offset:1024
 s_waitcnt vmcnt(14)
 v_mfma_f32_16x16x32_bf16 v[240:243], a[216:219], a[144:147], v[240:243]
 v_add_f32 v55, v55, v19
 v_mfma_f32_16x16x32_bf16 v[244:247], a[216:219], a[148:151], v[244:247]
 v_mfma_f32_16x16x32_bf16 v[248:251], a[216:219], a[152:155], v[248:251]
 v_add_f32 v40, v40, v12
 v_mfma_f32_16x16x32_bf16 v[252:255], a[216:219], a[156:159], v[252:255]
 buffer_load_dwordx4 a[216:219], v2, s[12:15], s24 offen offset:2048
 v_mfma_f32_16x16x32_bf16 a[240:243], a[220:223], a[144:147], a[240:243]
 v_mfma_f32_16x16x32_bf16 a[244:247], a[220:223], a[148:151], a[244:247]
 v_add_f32 v41, v41, v13
 v_mfma_f32_16x16x32_bf16 a[248:251], a[220:223], a[152:155], a[248:251]
 v_mfma_f32_16x16x32_bf16 a[252:255], a[220:223], a[156:159], a[252:255]
 buffer_load_dwordx4 a[220:223], v2, s[12:15], s24 offen offset:3072
 s_add_u32 s24, s24, 32768
 s_waitcnt vmcnt(14)
 s_waitcnt lgkmcnt(0)
 v_mfma_f32_16x16x32_bf16 v[144:147], a[160:163], a[128:131], v[144:147]
 v_add_f32 v42, v42, v14
 v_mfma_f32_16x16x32_bf16 v[148:151], a[160:163], a[132:135], v[148:151]
 ds_read_b128 a[144:147], v3 offset:12288
 v_mfma_f32_16x16x32_bf16 v[152:155], a[160:163], a[136:139], v[152:155]
 v_add_f32 v43, v43, v15
 v_mfma_f32_16x16x32_bf16 v[156:159], a[160:163], a[140:143], v[156:159]
 buffer_load_dwordx4 a[160:163], v1, s[12:15], s24 offen
 v_mfma_f32_16x16x32_bf16 v[160:163], a[164:167], a[128:131], v[160:163]
 v_mfma_f32_16x16x32_bf16 v[164:167], a[164:167], a[132:135], v[164:167]
 ds_read_b128 a[148:151], v3 offset:13312
 v_mfma_f32_16x16x32_bf16 v[168:171], a[164:167], a[136:139], v[168:171]
 v_add_f32 v56, v56, v16
 v_mfma_f32_16x16x32_bf16 v[172:175], a[164:167], a[140:143], v[172:175]
 buffer_load_dwordx4 a[164:167], v1, s[12:15], s24 offen offset:1024
 s_waitcnt vmcnt(14)
 v_mfma_f32_16x16x32_bf16 v[176:179], a[168:171], a[128:131], v[176:179]
 v_mfma_f32_16x16x32_bf16 v[180:183], a[168:171], a[132:135], v[180:183]
 ds_read_b128 a[152:155], v3 offset:14336
 v_mfma_f32_16x16x32_bf16 v[184:187], a[168:171], a[136:139], v[184:187]
 v_add_f32 v57, v57, v17
 v_mfma_f32_16x16x32_bf16 v[188:191], a[168:171], a[140:143], v[188:191]
 buffer_load_dwordx4 a[168:171], v1, s[12:15], s24 offen offset:2048
 v_mfma_f32_16x16x32_bf16 v[192:195], a[172:175], a[128:131], v[192:195]
 v_mfma_f32_16x16x32_bf16 v[196:199], a[172:175], a[132:135], v[196:199]
 ds_read_b128 a[156:159], v3 offset:15360
 v_mfma_f32_16x16x32_bf16 v[200:203], a[172:175], a[136:139], v[200:203]
 v_add_f32 v58, v58, v18
 v_mfma_f32_16x16x32_bf16 v[204:207], a[172:175], a[140:143], v[204:207]
 buffer_load_dwordx4 a[172:175], v1, s[12:15], s24 offen offset:3072
 s_waitcnt vmcnt(14)
 v_mfma_f32_16x16x32_bf16 v[208:211], a[176:179], a[128:131], v[208:211]
 v_add_f32 v59, v59, v19
 v_mfma_f32_16x16x32_bf16 v[212:215], a[176:179], a[132:135], v[212:215]
 v_mfma_f32_16x16x32_bf16 v[216:219], a[176:179], a[136:139], v[216:219]
 v_add_f32 v44, v44, v12
 v_mfma_f32_16x16x32_bf16 v[220:223], a[176:179], a[140:143], v[220:223]
 buffer_load_dwordx4 a[176:179], v2, s[12:15], s24 offen
 v_mfma_f32_16x16x32_bf16 v[224:227], a[180:183], a[128:131], v[224:227]
 v_mfma_f32_16x16x32_bf16 v[228:231], a[180:183], a[132:135], v[228:231]
 v_add_f32 v45, v45, v13
 v_mfma_f32_16x16x32_bf16 v[232:235], a[180:183], a[136:139], v[232:235]
 v_mfma_f32_16x16x32_bf16 v[236:239], a[180:183], a[140:143], v[236:239]
 buffer_load_dwordx4 a[180:183], v2, s[12:15], s24 offen offset:1024
 s_waitcnt vmcnt(14)
 v_mfma_f32_16x16x32_bf16 v[240:243], a[184:187], a[128:131], v[240:243]
 v_add_f32 v46, v46, v14
 v_mfma_f32_16x16x32_bf16 v[244:247], a[184:187], a[132:135], v[244:247]
 v_add_f32 v47, v47, v15
 v_mfma_f32_16x16x32_bf16 v[248:251], a[184:187], a[136:139], v[248:251]
 v_mfma_f32_16x16x32_bf16 v[252:255], a[184:187], a[140:143], v[252:255]
 buffer_load_dwordx4 a[184:187], v2, s[12:15], s24 offen offset:2048
 v_mfma_f32_16x16x32_bf16 a[240:243], a[188:191], a[128:131], a[240:243]
 v_add_f32 v60, v60, v16
 v_mfma_f32_16x16x32_bf16 a[244:247], a[188:191], a[132:135], a[244:247]
 v_mfma_f32_16x16x32_bf16 a[248:251], a[188:191], a[136:139], a[248:251]
 v_add_f32 v61, v61, v17
 v_mfma_f32_16x16x32_bf16 a[252:255], a[188:191], a[140:143], a[252:255]
 buffer_load_dwordx4 a[188:191], v2, s[12:15], s24 offen offset:3072
 s_add_u32 s24, s24, 32768
 s_waitcnt vmcnt(14)
 s_waitcnt lgkmcnt(0)
 v_mfma_f32_16x16x32_bf16 v[144:147], a[192:195], a[144:147], v[144:147]
 v_mfma_f32_16x16x32_bf16 v[148:151], a[192:195], a[148:151], v[148:151]
 ds_read_b128 a[128:131], v3 offset:16384
 v_mfma_f32_16x16x32_bf16 v[152:155], a[192:195], a[152:155], v[152:155]
 v_add_f32 v62, v62, v18
 v_mfma_f32_16x16x32_bf16 v[156:159], a[192:195], a[156:159], v[156:159]
 buffer_load_dwordx4 a[192:195], v1, s[12:15], s24 offen
 v_mfma_f32_16x16x32_bf16 v[160:163], a[196:199], a[144:147], v[160:163]
 v_add_f32 v63, v63, v19
 v_mfma_f32_16x16x32_bf16 v[164:167], a[196:199], a[148:151], v[164:167]
 ds_read_b128 a[132:135], v3 offset:17408
 v_mfma_f32_16x16x32_bf16 v[168:171], a[196:199], a[152:155], v[168:171]
 v_mfma_f32_16x16x32_bf16 v[172:175], a[196:199], a[156:159], v[172:175]
 buffer_load_dwordx4 a[196:199], v1, s[12:15], s24 offen offset:1024
 s_waitcnt vmcnt(14)
 v_mfma_f32_16x16x32_bf16 v[176:179], a[200:203], a[144:147], v[176:179]
 v_mfma_f32_16x16x32_bf16 v[180:183], a[200:203], a[148:151], v[180:183]
 ds_read_b128 a[136:139], v3 offset:18432
 v_mfma_f32_16x16x32_bf16 v[184:187], a[200:203], a[152:155], v[184:187]
 v_mfma_f32_16x16x32_bf16 v[188:191], a[200:203], a[156:159], v[188:191]
 buffer_load_dwordx4 a[200:203], v1, s[12:15], s24 offen offset:2048
 v_mfma_f32_16x16x32_bf16 v[192:195], a[204:207], a[144:147], v[192:195]
 v_add_f32 v64, v64, v20
 v_mfma_f32_16x16x32_bf16 v[196:199], a[204:207], a[148:151], v[196:199]
 ds_read_b128 a[140:143], v3 offset:19456
 v_mfma_f32_16x16x32_bf16 v[200:203], a[204:207], a[152:155], v[200:203]
 v_mfma_f32_16x16x32_bf16 v[204:207], a[204:207], a[156:159], v[204:207]
 buffer_load_dwordx4 a[204:207], v1, s[12:15], s24 offen offset:3072
 s_waitcnt vmcnt(14)
 v_mfma_f32_16x16x32_bf16 v[208:211], a[208:211], a[144:147], v[208:211]
 v_add_f32 v65, v65, v21
 v_mfma_f32_16x16x32_bf16 v[212:215], a[208:211], a[148:151], v[212:215]
 ds_read_b128 v[12:15], v7 offset:256
 v_mfma_f32_16x16x32_bf16 v[216:219], a[208:211], a[152:155], v[216:219]
 v_mfma_f32_16x16x32_bf16 v[220:223], a[208:211], a[156:159], v[220:223]
 buffer_load_dwordx4 a[208:211], v2, s[12:15], s24 offen
 v_mfma_f32_16x16x32_bf16 v[224:227], a[212:215], a[144:147], v[224:227]
 ds_read_b128 v[16:19], v7 offset:272
 v_mfma_f32_16x16x32_bf16 v[228:231], a[212:215], a[148:151], v[228:231]
 v_mfma_f32_16x16x32_bf16 v[232:235], a[212:215], a[152:155], v[232:235]
 v_add_f32 v66, v66, v22
 v_mfma_f32_16x16x32_bf16 v[236:239], a[212:215], a[156:159], v[236:239]
 buffer_load_dwordx4 a[212:215], v2, s[12:15], s24 offen offset:1024
 s_waitcnt vmcnt(14)
 v_mfma_f32_16x16x32_bf16 v[240:243], a[216:219], a[144:147], v[240:243]
 v_mfma_f32_16x16x32_bf16 v[244:247], a[216:219], a[148:151], v[244:247]
 v_add_f32 v67, v67, v23
 v_mfma_f32_16x16x32_bf16 v[248:251], a[216:219], a[152:155], v[248:251]
 v_add_f32 v80, v80, v24
 v_mfma_f32_16x16x32_bf16 v[252:255], a[216:219], a[156:159], v[252:255]
 buffer_load_dwordx4 a[216:219], v2, s[12:15], s24 offen offset:2048
 v_mfma_f32_16x16x32_bf16 a[240:243], a[220:223], a[144:147], a[240:243]
 v_mfma_f32_16x16x32_bf16 a[244:247], a[220:223], a[148:151], a[244:247]
 v_add_f32 v81, v81, v25
 v_mfma_f32_16x16x32_bf16 a[248:251], a[220:223], a[152:155], a[248:251]
 v_mfma_f32_16x16x32_bf16 a[252:255], a[220:223], a[156:159], a[252:255]
 buffer_load_dwordx4 a[220:223], v2, s[12:15], s24 offen offset:3072
 s_add_u32 s24, s24, 32768
 s_waitcnt vmcnt(14)
 s_waitcnt lgkmcnt(2)
 v_mfma_f32_16x16x32_bf16 v[144:147], a[160:163], a[128:131], v[144:147]
 v_add_f32 v82, v82, v26
 v_mfma_f32_16x16x32_bf16 v[148:151], a[160:163], a[132:135], v[148:151]
 ds_read_b128 a[144:147], v3 offset:20480
 v_mfma_f32_16x16x32_bf16 v[152:155], a[160:163], a[136:139], v[152:155]
 v_add_f32 v83, v83, v27
 v_mfma_f32_16x16x32_bf16 v[156:159], a[160:163], a[140:143], v[156:159]
 buffer_load_dwordx4 a[160:163], v1, s[12:15], s24 offen
 v_mfma_f32_16x16x32_bf16 v[160:163], a[164:167], a[128:131], v[160:163]
 v_mfma_f32_16x16x32_bf16 v[164:167], a[164:167], a[132:135], v[164:167]
 ds_read_b128 a[148:151], v3 offset:21504
 v_mfma_f32_16x16x32_bf16 v[168:171], a[164:167], a[136:139], v[168:171]
 v_add_f32 v68, v68, v20
 v_mfma_f32_16x16x32_bf16 v[172:175], a[164:167], a[140:143], v[172:175]
 buffer_load_dwordx4 a[164:167], v1, s[12:15], s24 offen offset:1024
 s_waitcnt vmcnt(14)
 v_mfma_f32_16x16x32_bf16 v[176:179], a[168:171], a[128:131], v[176:179]
 v_mfma_f32_16x16x32_bf16 v[180:183], a[168:171], a[132:135], v[180:183]
 ds_read_b128 a[152:155], v3 offset:22528
 v_mfma_f32_16x16x32_bf16 v[184:187], a[168:171], a[136:139], v[184:187]
 v_add_f32 v69, v69, v21
 v_mfma_f32_16x16x32_bf16 v[188:191], a[168:171], a[140:143], v[188:191]
 buffer_load_dwordx4 a[168:171], v1, s[12:15], s24 offen offset:2048
 v_mfma_f32_16x16x32_bf16 v[192:195], a[172:175], a[128:131], v[192:195]
 v_mfma_f32_16x16x32_bf16 v[196:199], a[172:175], a[132:135], v[196:199]
 ds_read_b128 a[156:159], v3 offset:23552
 v_mfma_f32_16x16x32_bf16 v[200:203], a[172:175], a[136:139], v[200:203]
 v_add_f32 v70, v70, v22
 v_mfma_f32_16x16x32_bf16 v[204:207], a[172:175], a[140:143], v[204:207]
 buffer_load_dwordx4 a[172:175], v1, s[12:15], s24 offen offset:3072
 s_waitcnt vmcnt(14)
 v_mfma_f32_16x16x32_bf16 v[208:211], a[176:179], a[128:131], v[208:211]
 v_add_f32 v71, v71, v23
 v_mfma_f32_16x16x32_bf16 v[212:215], a[176:179], a[132:135], v[212:215]
 v_mfma_f32_16x16x32_bf16 v[216:219], a[176:179], a[136:139], v[216:219]
 v_add_f32 v84, v84, v24
 v_mfma_f32_16x16x32_bf16 v[220:223], a[176:179], a[140:143], v[220:223]
 buffer_load_dwordx4 a[176:179], v2, s[12:15], s24 offen
 v_mfma_f32_16x16x32_bf16 v[224:227], a[180:183], a[128:131], v[224:227]
 v_mfma_f32_16x16x32_bf16 v[228:231], a[180:183], a[132:135], v[228:231]
 v_add_f32 v85, v85, v25
 v_mfma_f32_16x16x32_bf16 v[232:235], a[180:183], a[136:139], v[232:235]
 v_mfma_f32_16x16x32_bf16 v[236:239], a[180:183], a[140:143], v[236:239]
 buffer_load_dwordx4 a[180:183], v2, s[12:15], s24 offen offset:1024
 s_waitcnt vmcnt(14)
 v_mfma_f32_16x16x32_bf16 v[240:243], a[184:187], a[128:131], v[240:243]
 v_add_f32 v86, v86, v26
 v_mfma_f32_16x16x32_bf16 v[244:247], a[184:187], a[132:135], v[244:247]
 v_add_f32 v87, v87, v27
 v_mfma_f32_16x16x32_bf16 v[248:251], a[184:187], a[136:139], v[248:251]
 v_mfma_f32_16x16x32_bf16 v[252:255], a[184:187], a[140:143], v[252:255]
 buffer_load_dwordx4 a[184:187], v2, s[12:15], s24 offen offset:2048
 v_mfma_f32_16x16x32_bf16 a[240:243], a[188:191], a[128:131], a[240:243]
 v_add_f32 v72, v72, v20
 v_mfma_f32_16x16x32_bf16 a[244:247], a[188:191], a[132:135], a[244:247]
 v_mfma_f32_16x16x32_bf16 a[248:251], a[188:191], a[136:139], a[248:251]
 v_add_f32 v73, v73, v21
 v_mfma_f32_16x16x32_bf16 a[252:255], a[188:191], a[140:143], a[252:255]
 buffer_load_dwordx4 a[188:191], v2, s[12:15], s24 offen offset:3072
 s_add_u32 s24, s24, 32768
 s_waitcnt vmcnt(14)
 s_waitcnt lgkmcnt(0)
 v_mfma_f32_16x16x32_bf16 v[144:147], a[192:195], a[144:147], v[144:147]
 v_mfma_f32_16x16x32_bf16 v[148:151], a[192:195], a[148:151], v[148:151]
 ds_read_b128 a[128:131], v3 offset:24576
 v_mfma_f32_16x16x32_bf16 v[152:155], a[192:195], a[152:155], v[152:155]
 v_add_f32 v74, v74, v22
 v_mfma_f32_16x16x32_bf16 v[156:159], a[192:195], a[156:159], v[156:159]
 buffer_load_dwordx4 a[192:195], v1, s[12:15], s24 offen
 v_mfma_f32_16x16x32_bf16 v[160:163], a[196:199], a[144:147], v[160:163]
 v_add_f32 v75, v75, v23
 v_mfma_f32_16x16x32_bf16 v[164:167], a[196:199], a[148:151], v[164:167]
 ds_read_b128 a[132:135], v3 offset:25600
 v_mfma_f32_16x16x32_bf16 v[168:171], a[196:199], a[152:155], v[168:171]
 v_mfma_f32_16x16x32_bf16 v[172:175], a[196:199], a[156:159], v[172:175]
 buffer_load_dwordx4 a[196:199], v1, s[12:15], s24 offen offset:1024
 s_waitcnt vmcnt(14)
 v_mfma_f32_16x16x32_bf16 v[176:179], a[200:203], a[144:147], v[176:179]
 v_add_f32 v88, v88, v24
 v_mfma_f32_16x16x32_bf16 v[180:183], a[200:203], a[148:151], v[180:183]
 ds_read_b128 a[136:139], v3 offset:26624
 v_mfma_f32_16x16x32_bf16 v[184:187], a[200:203], a[152:155], v[184:187]
 v_mfma_f32_16x16x32_bf16 v[188:191], a[200:203], a[156:159], v[188:191]
 buffer_load_dwordx4 a[200:203], v1, s[12:15], s24 offen offset:2048
 v_mfma_f32_16x16x32_bf16 v[192:195], a[204:207], a[144:147], v[192:195]
 v_add_f32 v89, v89, v25
 v_mfma_f32_16x16x32_bf16 v[196:199], a[204:207], a[148:151], v[196:199]
 ds_read_b128 a[140:143], v3 offset:27648
 v_mfma_f32_16x16x32_bf16 v[200:203], a[204:207], a[152:155], v[200:203]
 v_mfma_f32_16x16x32_bf16 v[204:207], a[204:207], a[156:159], v[204:207]
 buffer_load_dwordx4 a[204:207], v1, s[12:15], s24 offen offset:3072
 s_waitcnt vmcnt(14)
 v_mfma_f32_16x16x32_bf16 v[208:211], a[208:211], a[144:147], v[208:211]
 v_add_f32 v90, v90, v26
 v_mfma_f32_16x16x32_bf16 v[212:215], a[208:211], a[148:151], v[212:215]
 v_add_f32 v91, v91, v27
 v_mfma_f32_16x16x32_bf16 v[216:219], a[208:211], a[152:155], v[216:219]
 v_mfma_f32_16x16x32_bf16 v[220:223], a[208:211], a[156:159], v[220:223]
 buffer_load_dwordx4 a[208:211], v2, s[12:15], s24 offen
 v_mfma_f32_16x16x32_bf16 v[224:227], a[212:215], a[144:147], v[224:227]
 v_add_f32 v76, v76, v20
 v_mfma_f32_16x16x32_bf16 v[228:231], a[212:215], a[148:151], v[228:231]
 v_mfma_f32_16x16x32_bf16 v[232:235], a[212:215], a[152:155], v[232:235]
 v_add_f32 v77, v77, v21
 v_mfma_f32_16x16x32_bf16 v[236:239], a[212:215], a[156:159], v[236:239]
 buffer_load_dwordx4 a[212:215], v2, s[12:15], s24 offen offset:1024
 s_waitcnt vmcnt(14)
 v_mfma_f32_16x16x32_bf16 v[240:243], a[216:219], a[144:147], v[240:243]
 v_mfma_f32_16x16x32_bf16 v[244:247], a[216:219], a[148:151], v[244:247]
 v_add_f32 v78, v78, v22
 v_mfma_f32_16x16x32_bf16 v[248:251], a[216:219], a[152:155], v[248:251]
 v_add_f32 v79, v79, v23
 v_mfma_f32_16x16x32_bf16 v[252:255], a[216:219], a[156:159], v[252:255]
 buffer_load_dwordx4 a[216:219], v2, s[12:15], s24 offen offset:2048
 v_mfma_f32_16x16x32_bf16 a[240:243], a[220:223], a[144:147], a[240:243]
 v_mfma_f32_16x16x32_bf16 a[244:247], a[220:223], a[148:151], a[244:247]
 v_add_f32 v92, v92, v24
 v_mfma_f32_16x16x32_bf16 a[248:251], a[220:223], a[152:155], a[248:251]
 v_mfma_f32_16x16x32_bf16 a[252:255], a[220:223], a[156:159], a[252:255]
 buffer_load_dwordx4 a[220:223], v2, s[12:15], s24 offen offset:3072
 s_add_u32 s24, s24, 32768
 s_waitcnt vmcnt(14)
 s_waitcnt lgkmcnt(0)
 v_mfma_f32_16x16x32_bf16 v[144:147], a[160:163], a[128:131], v[144:147]
 v_add_f32 v93, v93, v25
 v_mfma_f32_16x16x32_bf16 v[148:151], a[160:163], a[132:135], v[148:151]
 ds_read_b128 a[144:147], v3 offset:28672
 v_mfma_f32_16x16x32_bf16 v[152:155], a[160:163], a[136:139], v[152:155]
 v_mfma_f32_16x16x32_bf16 v[156:159], a[160:163], a[140:143], v[156:159]
 buffer_load_dwordx4 a[160:163], v1, s[12:15], s24 offen
 v_mfma_f32_16x16x32_bf16 v[160:163], a[164:167], a[128:131], v[160:163]
 v_add_f32 v94, v94, v26
 v_mfma_f32_16x16x32_bf16 v[164:167], a[164:167], a[132:135], v[164:167]
 ds_read_b128 a[148:151], v3 offset:29696
 v_mfma_f32_16x16x32_bf16 v[168:171], a[164:167], a[136:139], v[168:171]
 v_add_f32 v95, v95, v27
 v_mfma_f32_16x16x32_bf16 v[172:175], a[164:167], a[140:143], v[172:175]
 buffer_load_dwordx4 a[164:167], v1, s[12:15], s24 offen offset:1024
 s_waitcnt vmcnt(14)
 v_mfma_f32_16x16x32_bf16 v[176:179], a[168:171], a[128:131], v[176:179]
 v_mfma_f32_16x16x32_bf16 v[180:183], a[168:171], a[132:135], v[180:183]
 ds_read_b128 a[152:155], v3 offset:30720
 v_mfma_f32_16x16x32_bf16 v[184:187], a[168:171], a[136:139], v[184:187]
 v_mfma_f32_16x16x32_bf16 v[188:191], a[168:171], a[140:143], v[188:191]
 buffer_load_dwordx4 a[168:171], v1, s[12:15], s24 offen offset:2048
 v_mfma_f32_16x16x32_bf16 v[192:195], a[172:175], a[128:131], v[192:195]
 v_mfma_f32_16x16x32_bf16 v[196:199], a[172:175], a[132:135], v[196:199]
 ds_read_b128 a[156:159], v3 offset:31744
 v_mfma_f32_16x16x32_bf16 v[200:203], a[172:175], a[136:139], v[200:203]
 v_add_f32 v96, v96, v12
 v_mfma_f32_16x16x32_bf16 v[204:207], a[172:175], a[140:143], v[204:207]
 buffer_load_dwordx4 a[172:175], v1, s[12:15], s24 offen offset:3072
 s_waitcnt vmcnt(14)
 v_mfma_f32_16x16x32_bf16 v[208:211], a[176:179], a[128:131], v[208:211]
 v_mfma_f32_16x16x32_bf16 v[212:215], a[176:179], a[132:135], v[212:215]
 v_add_f32 v97, v97, v13
 v_mfma_f32_16x16x32_bf16 v[216:219], a[176:179], a[136:139], v[216:219]
 ds_read_b128 v[20:23], v7 offset:384
 v_mfma_f32_16x16x32_bf16 v[220:223], a[176:179], a[140:143], v[220:223]
 buffer_load_dwordx4 a[176:179], v2, s[12:15], s24 offen
 v_mfma_f32_16x16x32_bf16 v[224:227], a[180:183], a[128:131], v[224:227]
 v_mfma_f32_16x16x32_bf16 v[228:231], a[180:183], a[132:135], v[228:231]
 ds_read_b128 v[24:27], v7 offset:400
 v_mfma_f32_16x16x32_bf16 v[232:235], a[180:183], a[136:139], v[232:235]
 v_mfma_f32_16x16x32_bf16 v[236:239], a[180:183], a[140:143], v[236:239]
 buffer_load_dwordx4 a[180:183], v2, s[12:15], s24 offen offset:1024
 s_waitcnt vmcnt(14)
 v_mfma_f32_16x16x32_bf16 v[240:243], a[184:187], a[128:131], v[240:243]
 v_add_f32 v98, v98, v14
 v_mfma_f32_16x16x32_bf16 v[244:247], a[184:187], a[132:135], v[244:247]
 v_mfma_f32_16x16x32_bf16 v[248:251], a[184:187], a[136:139], v[248:251]
 v_add_f32 v99, v99, v15
 v_mfma_f32_16x16x32_bf16 v[252:255], a[184:187], a[140:143], v[252:255]
 buffer_load_dwordx4 a[184:187], v2, s[12:15], s24 offen offset:2048
 v_mfma_f32_16x16x32_bf16 a[240:243], a[188:191], a[128:131], a[240:243]
 v_add_f32 v112, v112, v16
 v_mfma_f32_16x16x32_bf16 a[244:247], a[188:191], a[132:135], a[244:247]
 v_mfma_f32_16x16x32_bf16 a[248:251], a[188:191], a[136:139], a[248:251]
 v_add_f32 v113, v113, v17
 v_mfma_f32_16x16x32_bf16 a[252:255], a[188:191], a[140:143], a[252:255]
 buffer_load_dwordx4 a[188:191], v2, s[12:15], s24 offen offset:3072
 s_add_u32 s24, s24, 32768
 s_waitcnt vmcnt(14)
 s_waitcnt lgkmcnt(2)
 v_mfma_f32_16x16x32_bf16 v[144:147], a[192:195], a[144:147], v[144:147]
 v_mfma_f32_16x16x32_bf16 v[148:151], a[192:195], a[148:151], v[148:151]
 ds_read_b128 a[128:131], v3 offset:32768
 v_mfma_f32_16x16x32_bf16 v[152:155], a[192:195], a[152:155], v[152:155]
 v_add_f32 v114, v114, v18
 v_mfma_f32_16x16x32_bf16 v[156:159], a[192:195], a[156:159], v[156:159]
 buffer_load_dwordx4 a[192:195], v1, s[12:15], s24 offen
 v_mfma_f32_16x16x32_bf16 v[160:163], a[196:199], a[144:147], v[160:163]
 v_mfma_f32_16x16x32_bf16 v[164:167], a[196:199], a[148:151], v[164:167]
 ds_read_b128 a[132:135], v3 offset:33792
 v_mfma_f32_16x16x32_bf16 v[168:171], a[196:199], a[152:155], v[168:171]
 v_add_f32 v115, v115, v19
 v_mfma_f32_16x16x32_bf16 v[172:175], a[196:199], a[156:159], v[172:175]
 buffer_load_dwordx4 a[196:199], v1, s[12:15], s24 offen offset:1024
 s_waitcnt vmcnt(14)
 v_mfma_f32_16x16x32_bf16 v[176:179], a[200:203], a[144:147], v[176:179]
 v_add_f32 v100, v100, v12
 v_mfma_f32_16x16x32_bf16 v[180:183], a[200:203], a[148:151], v[180:183]
 ds_read_b128 a[136:139], v3 offset:34816
 v_mfma_f32_16x16x32_bf16 v[184:187], a[200:203], a[152:155], v[184:187]
 v_mfma_f32_16x16x32_bf16 v[188:191], a[200:203], a[156:159], v[188:191]
 buffer_load_dwordx4 a[200:203], v1, s[12:15], s24 offen offset:2048
 v_mfma_f32_16x16x32_bf16 v[192:195], a[204:207], a[144:147], v[192:195]
 v_add_f32 v101, v101, v13
 v_mfma_f32_16x16x32_bf16 v[196:199], a[204:207], a[148:151], v[196:199]
 ds_read_b128 a[140:143], v3 offset:35840
 v_mfma_f32_16x16x32_bf16 v[200:203], a[204:207], a[152:155], v[200:203]
 v_mfma_f32_16x16x32_bf16 v[204:207], a[204:207], a[156:159], v[204:207]
 buffer_load_dwordx4 a[204:207], v1, s[12:15], s24 offen offset:3072
 s_waitcnt vmcnt(14)
 v_mfma_f32_16x16x32_bf16 v[208:211], a[208:211], a[144:147], v[208:211]
 v_add_f32 v102, v102, v14
 v_mfma_f32_16x16x32_bf16 v[212:215], a[208:211], a[148:151], v[212:215]
 v_mfma_f32_16x16x32_bf16 v[216:219], a[208:211], a[152:155], v[216:219]
 v_add_f32 v103, v103, v15
 v_mfma_f32_16x16x32_bf16 v[220:223], a[208:211], a[156:159], v[220:223]
 buffer_load_dwordx4 a[208:211], v2, s[12:15], s24 offen
 v_mfma_f32_16x16x32_bf16 v[224:227], a[212:215], a[144:147], v[224:227]
 v_add_f32 v116, v116, v16
 v_mfma_f32_16x16x32_bf16 v[228:231], a[212:215], a[148:151], v[228:231]
 v_mfma_f32_16x16x32_bf16 v[232:235], a[212:215], a[152:155], v[232:235]
 v_add_f32 v117, v117, v17
 v_mfma_f32_16x16x32_bf16 v[236:239], a[212:215], a[156:159], v[236:239]
 buffer_load_dwordx4 a[212:215], v2, s[12:15], s24 offen offset:1024
 s_waitcnt vmcnt(14)
 v_mfma_f32_16x16x32_bf16 v[240:243], a[216:219], a[144:147], v[240:243]
 v_mfma_f32_16x16x32_bf16 v[244:247], a[216:219], a[148:151], v[244:247]
 v_add_f32 v118, v118, v18
 v_mfma_f32_16x16x32_bf16 v[248:251], a[216:219], a[152:155], v[248:251]
 v_add_f32 v119, v119, v19
 v_mfma_f32_16x16x32_bf16 v[252:255], a[216:219], a[156:159], v[252:255]
 buffer_load_dwordx4 a[216:219], v2, s[12:15], s24 offen offset:2048
 v_mfma_f32_16x16x32_bf16 a[240:243], a[220:223], a[144:147], a[240:243]
 v_mfma_f32_16x16x32_bf16 a[244:247], a[220:223], a[148:151], a[244:247]
 v_add_f32 v104, v104, v12
 v_mfma_f32_16x16x32_bf16 a[248:251], a[220:223], a[152:155], a[248:251]
 v_mfma_f32_16x16x32_bf16 a[252:255], a[220:223], a[156:159], a[252:255]
 buffer_load_dwordx4 a[220:223], v2, s[12:15], s24 offen offset:3072
 s_add_u32 s24, s24, 32768
 s_waitcnt vmcnt(14)
 s_waitcnt lgkmcnt(0)
 v_mfma_f32_16x16x32_bf16 v[144:147], a[160:163], a[128:131], v[144:147]
 v_add_f32 v105, v105, v13
 v_mfma_f32_16x16x32_bf16 v[148:151], a[160:163], a[132:135], v[148:151]
 ds_read_b128 a[144:147], v3 offset:36864
 v_mfma_f32_16x16x32_bf16 v[152:155], a[160:163], a[136:139], v[152:155]
 v_mfma_f32_16x16x32_bf16 v[156:159], a[160:163], a[140:143], v[156:159]
 buffer_load_dwordx4 a[160:163], v1, s[12:15], s24 offen
 v_mfma_f32_16x16x32_bf16 v[160:163], a[164:167], a[128:131], v[160:163]
 v_add_f32 v106, v106, v14
 v_mfma_f32_16x16x32_bf16 v[164:167], a[164:167], a[132:135], v[164:167]
 ds_read_b128 a[148:151], v3 offset:37888
 v_mfma_f32_16x16x32_bf16 v[168:171], a[164:167], a[136:139], v[168:171]
 v_add_f32 v107, v107, v15
 v_mfma_f32_16x16x32_bf16 v[172:175], a[164:167], a[140:143], v[172:175]
 buffer_load_dwordx4 a[164:167], v1, s[12:15], s24 offen offset:1024
 s_waitcnt vmcnt(14)
 v_mfma_f32_16x16x32_bf16 v[176:179], a[168:171], a[128:131], v[176:179]
 v_mfma_f32_16x16x32_bf16 v[180:183], a[168:171], a[132:135], v[180:183]
 ds_read_b128 a[152:155], v3 offset:38912
 v_mfma_f32_16x16x32_bf16 v[184:187], a[168:171], a[136:139], v[184:187]
 v_add_f32 v120, v120, v16
 v_mfma_f32_16x16x32_bf16 v[188:191], a[168:171], a[140:143], v[188:191]
 buffer_load_dwordx4 a[168:171], v1, s[12:15], s24 offen offset:2048
 v_mfma_f32_16x16x32_bf16 v[192:195], a[172:175], a[128:131], v[192:195]
 v_mfma_f32_16x16x32_bf16 v[196:199], a[172:175], a[132:135], v[196:199]
 ds_read_b128 a[156:159], v3 offset:39936
 v_mfma_f32_16x16x32_bf16 v[200:203], a[172:175], a[136:139], v[200:203]
 v_add_f32 v121, v121, v17
 v_mfma_f32_16x16x32_bf16 v[204:207], a[172:175], a[140:143], v[204:207]
 buffer_load_dwordx4 a[172:175], v1, s[12:15], s24 offen offset:3072
 s_waitcnt vmcnt(14)
 v_mfma_f32_16x16x32_bf16 v[208:211], a[176:179], a[128:131], v[208:211]
 v_mfma_f32_16x16x32_bf16 v[212:215], a[176:179], a[132:135], v[212:215]
 v_add_f32 v122, v122, v18
 v_mfma_f32_16x16x32_bf16 v[216:219], a[176:179], a[136:139], v[216:219]
 v_add_f32 v123, v123, v19
 v_mfma_f32_16x16x32_bf16 v[220:223], a[176:179], a[140:143], v[220:223]
 buffer_load_dwordx4 a[176:179], v2, s[12:15], s24 offen
 v_mfma_f32_16x16x32_bf16 v[224:227], a[180:183], a[128:131], v[224:227]
 v_mfma_f32_16x16x32_bf16 v[228:231], a[180:183], a[132:135], v[228:231]
 v_add_f32 v108, v108, v12
 v_mfma_f32_16x16x32_bf16 v[232:235], a[180:183], a[136:139], v[232:235]
 v_mfma_f32_16x16x32_bf16 v[236:239], a[180:183], a[140:143], v[236:239]
 buffer_load_dwordx4 a[180:183], v2, s[12:15], s24 offen offset:1024
 s_waitcnt vmcnt(14)
 v_mfma_f32_16x16x32_bf16 v[240:243], a[184:187], a[128:131], v[240:243]
 v_add_f32 v109, v109, v13
 v_mfma_f32_16x16x32_bf16 v[244:247], a[184:187], a[132:135], v[244:247]
 v_mfma_f32_16x16x32_bf16 v[248:251], a[184:187], a[136:139], v[248:251]
 v_add_f32 v110, v110, v14
 v_mfma_f32_16x16x32_bf16 v[252:255], a[184:187], a[140:143], v[252:255]
 buffer_load_dwordx4 a[184:187], v2, s[12:15], s24 offen offset:2048
 v_mfma_f32_16x16x32_bf16 a[240:243], a[188:191], a[128:131], a[240:243]
 v_add_f32 v111, v111, v15
 v_mfma_f32_16x16x32_bf16 a[244:247], a[188:191], a[132:135], a[244:247]
 v_mfma_f32_16x16x32_bf16 a[248:251], a[188:191], a[136:139], a[248:251]
 v_add_f32 v124, v124, v16
 v_mfma_f32_16x16x32_bf16 a[252:255], a[188:191], a[140:143], a[252:255]
 buffer_load_dwordx4 a[188:191], v2, s[12:15], s24 offen offset:3072
 s_add_u32 s24, s24, 32768
 s_waitcnt vmcnt(14)
 s_waitcnt lgkmcnt(0)
 v_mfma_f32_16x16x32_bf16 v[144:147], a[192:195], a[144:147], v[144:147]
 v_mfma_f32_16x16x32_bf16 v[148:151], a[192:195], a[148:151], v[148:151]
 ds_read_b128 a[128:131], v3 offset:40960
 v_mfma_f32_16x16x32_bf16 v[152:155], a[192:195], a[152:155], v[152:155]
 v_add_f32 v125, v125, v17
 v_mfma_f32_16x16x32_bf16 v[156:159], a[192:195], a[156:159], v[156:159]
 buffer_load_dwordx4 a[192:195], v1, s[12:15], s24 offen
 v_mfma_f32_16x16x32_bf16 v[160:163], a[196:199], a[144:147], v[160:163]
 v_mfma_f32_16x16x32_bf16 v[164:167], a[196:199], a[148:151], v[164:167]
 ds_read_b128 a[132:135], v3 offset:41984
 v_mfma_f32_16x16x32_bf16 v[168:171], a[196:199], a[152:155], v[168:171]
 v_add_f32 v126, v126, v18
 v_mfma_f32_16x16x32_bf16 v[172:175], a[196:199], a[156:159], v[172:175]
 buffer_load_dwordx4 a[196:199], v1, s[12:15], s24 offen offset:1024
 s_waitcnt vmcnt(14)
 v_mfma_f32_16x16x32_bf16 v[176:179], a[200:203], a[144:147], v[176:179]
 v_add_f32 v127, v127, v19
 v_mfma_f32_16x16x32_bf16 v[180:183], a[200:203], a[148:151], v[180:183]
 ds_read_b128 a[136:139], v3 offset:43008
 v_mfma_f32_16x16x32_bf16 v[184:187], a[200:203], a[152:155], v[184:187]
 v_mfma_f32_16x16x32_bf16 v[188:191], a[200:203], a[156:159], v[188:191]
 buffer_load_dwordx4 a[200:203], v1, s[12:15], s24 offen offset:2048
 v_mfma_f32_16x16x32_bf16 v[192:195], a[204:207], a[144:147], v[192:195]
 v_mfma_f32_16x16x32_bf16 v[196:199], a[204:207], a[148:151], v[196:199]
 ds_read_b128 a[140:143], v3 offset:44032
 v_mfma_f32_16x16x32_bf16 v[200:203], a[204:207], a[152:155], v[200:203]
 v_mfma_f32_16x16x32_bf16 v[204:207], a[204:207], a[156:159], v[204:207]
 buffer_load_dwordx4 a[204:207], v1, s[12:15], s24 offen offset:3072
 s_waitcnt vmcnt(14)
 v_mfma_f32_16x16x32_bf16 v[208:211], a[208:211], a[144:147], v[208:211]
 v_add_f32 v128, v128, v20
 v_mfma_f32_16x16x32_bf16 v[212:215], a[208:211], a[148:151], v[212:215]
 v_mfma_f32_16x16x32_bf16 v[216:219], a[208:211], a[152:155], v[216:219]
 v_add_f32 v129, v129, v21
 v_mfma_f32_16x16x32_bf16 v[220:223], a[208:211], a[156:159], v[220:223]
 buffer_load_dwordx4 a[208:211], v2, s[12:15], s24 offen
 v_mfma_f32_16x16x32_bf16 v[224:227], a[212:215], a[144:147], v[224:227]
 v_add_f32 v130, v130, v22
 v_mfma_f32_16x16x32_bf16 v[228:231], a[212:215], a[148:151], v[228:231]
 v_mfma_f32_16x16x32_bf16 v[232:235], a[212:215], a[152:155], v[232:235]
 v_add_f32 v131, v131, v23
 v_mfma_f32_16x16x32_bf16 v[236:239], a[212:215], a[156:159], v[236:239]
 buffer_load_dwordx4 a[212:215], v2, s[12:15], s24 offen offset:1024
 s_waitcnt vmcnt(14)
 v_mfma_f32_16x16x32_bf16 v[240:243], a[216:219], a[144:147], v[240:243]
 v_mfma_f32_16x16x32_bf16 v[244:247], a[216:219], a[148:151], v[244:247]
 v_accvgpr_read_b32 v28, a224
 v_mfma_f32_16x16x32_bf16 v[248:251], a[216:219], a[152:155], v[248:251]
 v_mfma_f32_16x16x32_bf16 v[252:255], a[216:219], a[156:159], v[252:255]
 buffer_load_dwordx4 a[216:219], v2, s[12:15], s24 offen offset:2048
 v_mfma_f32_16x16x32_bf16 a[240:243], a[220:223], a[144:147], a[240:243]
 v_add_f32 v28, v28, v24
 v_mfma_f32_16x16x32_bf16 a[244:247], a[220:223], a[148:151], a[244:247]
 v_accvgpr_write_b32 a224, v28
 v_mfma_f32_16x16x32_bf16 a[248:251], a[220:223], a[152:155], a[248:251]
 v_mfma_f32_16x16x32_bf16 a[252:255], a[220:223], a[156:159], a[252:255]
 buffer_load_dwordx4 a[220:223], v2, s[12:15], s24 offen offset:3072
 s_add_u32 s24, s24, 32768
 s_waitcnt vmcnt(14)
 s_waitcnt lgkmcnt(0)
 v_mfma_f32_16x16x32_bf16 v[144:147], a[160:163], a[128:131], v[144:147]
 v_accvgpr_read_b32 v29, a225
 v_mfma_f32_16x16x32_bf16 v[148:151], a[160:163], a[132:135], v[148:151]
 ds_read_b128 a[144:147], v3 offset:45056
 v_mfma_f32_16x16x32_bf16 v[152:155], a[160:163], a[136:139], v[152:155]
 v_mfma_f32_16x16x32_bf16 v[156:159], a[160:163], a[140:143], v[156:159]
 buffer_load_dwordx4 a[160:163], v1, s[12:15], s24 offen
 v_mfma_f32_16x16x32_bf16 v[160:163], a[164:167], a[128:131], v[160:163]
 v_add_f32 v29, v29, v25
 v_mfma_f32_16x16x32_bf16 v[164:167], a[164:167], a[132:135], v[164:167]
 ds_read_b128 a[148:151], v3 offset:46080
 v_mfma_f32_16x16x32_bf16 v[168:171], a[164:167], a[136:139], v[168:171]
 v_mfma_f32_16x16x32_bf16 v[172:175], a[164:167], a[140:143], v[172:175]
 buffer_load_dwordx4 a[164:167], v1, s[12:15], s24 offen offset:1024
 s_waitcnt vmcnt(14)
 v_mfma_f32_16x16x32_bf16 v[176:179], a[168:171], a[128:131], v[176:179]
 v_accvgpr_write_b32 a225, v29
 v_mfma_f32_16x16x32_bf16 v[180:183], a[168:171], a[132:135], v[180:183]
 ds_read_b128 a[152:155], v3 offset:47104
 v_mfma_f32_16x16x32_bf16 v[184:187], a[168:171], a[136:139], v[184:187]
 v_accvgpr_read_b32 v28, a226
 v_mfma_f32_16x16x32_bf16 v[188:191], a[168:171], a[140:143], v[188:191]
 buffer_load_dwordx4 a[168:171], v1, s[12:15], s24 offen offset:2048
 v_mfma_f32_16x16x32_bf16 v[192:195], a[172:175], a[128:131], v[192:195]
 v_mfma_f32_16x16x32_bf16 v[196:199], a[172:175], a[132:135], v[196:199]
 ds_read_b128 a[156:159], v3 offset:48128
 v_mfma_f32_16x16x32_bf16 v[200:203], a[172:175], a[136:139], v[200:203]
 v_add_f32 v28, v28, v26
 v_mfma_f32_16x16x32_bf16 v[204:207], a[172:175], a[140:143], v[204:207]
 buffer_load_dwordx4 a[172:175], v1, s[12:15], s24 offen offset:3072
 s_waitcnt vmcnt(14)
 v_mfma_f32_16x16x32_bf16 v[208:211], a[176:179], a[128:131], v[208:211]
 v_mfma_f32_16x16x32_bf16 v[212:215], a[176:179], a[132:135], v[212:215]
 v_accvgpr_write_b32 a226, v28
 v_mfma_f32_16x16x32_bf16 v[216:219], a[176:179], a[136:139], v[216:219]
 v_mfma_f32_16x16x32_bf16 v[220:223], a[176:179], a[140:143], v[220:223]
 buffer_load_dwordx4 a[176:179], v2, s[12:15], s24 offen
 v_mfma_f32_16x16x32_bf16 v[224:227], a[180:183], a[128:131], v[224:227]
 v_accvgpr_read_b32 v29, a227
 v_mfma_f32_16x16x32_bf16 v[228:231], a[180:183], a[132:135], v[228:231]
 v_add_f32 v29, v29, v27
 v_mfma_f32_16x16x32_bf16 v[232:235], a[180:183], a[136:139], v[232:235]
 v_mfma_f32_16x16x32_bf16 v[236:239], a[180:183], a[140:143], v[236:239]
 buffer_load_dwordx4 a[180:183], v2, s[12:15], s24 offen offset:1024
 s_waitcnt vmcnt(14)
 v_mfma_f32_16x16x32_bf16 v[240:243], a[184:187], a[128:131], v[240:243]
 v_accvgpr_write_b32 a227, v29
 v_mfma_f32_16x16x32_bf16 v[244:247], a[184:187], a[132:135], v[244:247]
 v_mfma_f32_16x16x32_bf16 v[248:251], a[184:187], a[136:139], v[248:251]
 v_add_f32 v132, v132, v20
 v_mfma_f32_16x16x32_bf16 v[252:255], a[184:187], a[140:143], v[252:255]
 buffer_load_dwordx4 a[184:187], v2, s[12:15], s24 offen offset:2048
 v_mfma_f32_16x16x32_bf16 a[240:243], a[188:191], a[128:131], a[240:243]
 v_mfma_f32_16x16x32_bf16 a[244:247], a[188:191], a[132:135], a[244:247]
 v_add_f32 v133, v133, v21
 v_mfma_f32_16x16x32_bf16 a[248:251], a[188:191], a[136:139], a[248:251]
 v_add_f32 v134, v134, v22
 v_mfma_f32_16x16x32_bf16 a[252:255], a[188:191], a[140:143], a[252:255]
 buffer_load_dwordx4 a[188:191], v2, s[12:15], s24 offen offset:3072
 s_add_u32 s24, s24, 32768
 s_waitcnt vmcnt(14)
 s_waitcnt lgkmcnt(0)
 v_mfma_f32_16x16x32_bf16 v[144:147], a[192:195], a[144:147], v[144:147]
 v_mfma_f32_16x16x32_bf16 v[148:151], a[192:195], a[148:151], v[148:151]
 ds_read_b128 a[128:131], v3 offset:49152
 v_mfma_f32_16x16x32_bf16 v[152:155], a[192:195], a[152:155], v[152:155]
 v_add_f32 v135, v135, v23
 v_mfma_f32_16x16x32_bf16 v[156:159], a[192:195], a[156:159], v[156:159]
 buffer_load_dwordx4 a[192:195], v1, s[12:15], s24 offen
 v_mfma_f32_16x16x32_bf16 v[160:163], a[196:199], a[144:147], v[160:163]
 v_mfma_f32_16x16x32_bf16 v[164:167], a[196:199], a[148:151], v[164:167]
 ds_read_b128 a[132:135], v3 offset:50176
 v_mfma_f32_16x16x32_bf16 v[168:171], a[196:199], a[152:155], v[168:171]
 v_accvgpr_read_b32 v28, a228
 v_mfma_f32_16x16x32_bf16 v[172:175], a[196:199], a[156:159], v[172:175]
 buffer_load_dwordx4 a[196:199], v1, s[12:15], s24 offen offset:1024
 s_waitcnt vmcnt(14)
 v_mfma_f32_16x16x32_bf16 v[176:179], a[200:203], a[144:147], v[176:179]
 v_mfma_f32_16x16x32_bf16 v[180:183], a[200:203], a[148:151], v[180:183]
 ds_read_b128 a[136:139], v3 offset:51200
 v_mfma_f32_16x16x32_bf16 v[184:187], a[200:203], a[152:155], v[184:187]
 v_add_f32 v28, v28, v24
 v_mfma_f32_16x16x32_bf16 v[188:191], a[200:203], a[156:159], v[188:191]
 buffer_load_dwordx4 a[200:203], v1, s[12:15], s24 offen offset:2048
 v_mfma_f32_16x16x32_bf16 v[192:195], a[204:207], a[144:147], v[192:195]
 v_accvgpr_write_b32 a228, v28
 v_mfma_f32_16x16x32_bf16 v[196:199], a[204:207], a[148:151], v[196:199]
 ds_read_b128 a[140:143], v3 offset:52224
 v_mfma_f32_16x16x32_bf16 v[200:203], a[204:207], a[152:155], v[200:203]
 v_mfma_f32_16x16x32_bf16 v[204:207], a[204:207], a[156:159], v[204:207]
 buffer_load_dwordx4 a[204:207], v1, s[12:15], s24 offen offset:3072
 s_waitcnt vmcnt(14)
 v_mfma_f32_16x16x32_bf16 v[208:211], a[208:211], a[144:147], v[208:211]
 v_accvgpr_read_b32 v29, a229
 v_mfma_f32_16x16x32_bf16 v[212:215], a[208:211], a[148:151], v[212:215]
 v_mfma_f32_16x16x32_bf16 v[216:219], a[208:211], a[152:155], v[216:219]
 v_add_f32 v29, v29, v25
 v_mfma_f32_16x16x32_bf16 v[220:223], a[208:211], a[156:159], v[220:223]
 buffer_load_dwordx4 a[208:211], v2, s[12:15], s24 offen
 v_mfma_f32_16x16x32_bf16 v[224:227], a[212:215], a[144:147], v[224:227]
 v_accvgpr_write_b32 a229, v29
 v_mfma_f32_16x16x32_bf16 v[228:231], a[212:215], a[148:151], v[228:231]
 v_mfma_f32_16x16x32_bf16 v[232:235], a[212:215], a[152:155], v[232:235]
 v_accvgpr_read_b32 v28, a230
 v_mfma_f32_16x16x32_bf16 v[236:239], a[212:215], a[156:159], v[236:239]
 buffer_load_dwordx4 a[212:215], v2, s[12:15], s24 offen offset:1024
 s_waitcnt vmcnt(14)
 v_mfma_f32_16x16x32_bf16 v[240:243], a[216:219], a[144:147], v[240:243]
 v_mfma_f32_16x16x32_bf16 v[244:247], a[216:219], a[148:151], v[244:247]
 v_add_f32 v28, v28, v26
 v_mfma_f32_16x16x32_bf16 v[248:251], a[216:219], a[152:155], v[248:251]
 v_mfma_f32_16x16x32_bf16 v[252:255], a[216:219], a[156:159], v[252:255]
 buffer_load_dwordx4 a[216:219], v2, s[12:15], s24 offen offset:2048
 v_mfma_f32_16x16x32_bf16 a[240:243], a[220:223], a[144:147], a[240:243]
 v_accvgpr_write_b32 a230, v28
 v_mfma_f32_16x16x32_bf16 a[244:247], a[220:223], a[148:151], a[244:247]
 v_accvgpr_read_b32 v29, a231
 v_mfma_f32_16x16x32_bf16 a[248:251], a[220:223], a[152:155], a[248:251]
 v_mfma_f32_16x16x32_bf16 a[252:255], a[220:223], a[156:159], a[252:255]
 buffer_load_dwordx4 a[220:223], v2, s[12:15], s24 offen offset:3072
 s_add_u32 s24, s24, 32768
 s_waitcnt vmcnt(14)
 s_waitcnt lgkmcnt(0)
 v_mfma_f32_16x16x32_bf16 v[144:147], a[160:163], a[128:131], v[144:147]
 v_add_f32 v29, v29, v27
 v_mfma_f32_16x16x32_bf16 v[148:151], a[160:163], a[132:135], v[148:151]
 ds_read_b128 a[144:147], v3 offset:53248
 v_mfma_f32_16x16x32_bf16 v[152:155], a[160:163], a[136:139], v[152:155]
 v_mfma_f32_16x16x32_bf16 v[156:159], a[160:163], a[140:143], v[156:159]
 buffer_load_dwordx4 a[160:163], v1, s[12:15], s24 offen
 v_mfma_f32_16x16x32_bf16 v[160:163], a[164:167], a[128:131], v[160:163]
 v_accvgpr_write_b32 a231, v29
 v_mfma_f32_16x16x32_bf16 v[164:167], a[164:167], a[132:135], v[164:167]
 ds_read_b128 a[148:151], v3 offset:54272
 v_mfma_f32_16x16x32_bf16 v[168:171], a[164:167], a[136:139], v[168:171]
 v_mfma_f32_16x16x32_bf16 v[172:175], a[164:167], a[140:143], v[172:175]
 buffer_load_dwordx4 a[164:167], v1, s[12:15], s24 offen offset:1024
 s_waitcnt vmcnt(14)
 v_mfma_f32_16x16x32_bf16 v[176:179], a[168:171], a[128:131], v[176:179]
 v_add_f32 v136, v136, v20
 v_mfma_f32_16x16x32_bf16 v[180:183], a[168:171], a[132:135], v[180:183]
 ds_read_b128 a[152:155], v3 offset:55296
 v_mfma_f32_16x16x32_bf16 v[184:187], a[168:171], a[136:139], v[184:187]
 v_add_f32 v137, v137, v21
 v_mfma_f32_16x16x32_bf16 v[188:191], a[168:171], a[140:143], v[188:191]
 buffer_load_dwordx4 a[168:171], v1, s[12:15], s24 offen offset:2048
 v_mfma_f32_16x16x32_bf16 v[192:195], a[172:175], a[128:131], v[192:195]
 v_mfma_f32_16x16x32_bf16 v[196:199], a[172:175], a[132:135], v[196:199]
 ds_read_b128 a[156:159], v3 offset:56320
 v_mfma_f32_16x16x32_bf16 v[200:203], a[172:175], a[136:139], v[200:203]
 v_add_f32 v138, v138, v22
 v_mfma_f32_16x16x32_bf16 v[204:207], a[172:175], a[140:143], v[204:207]
 buffer_load_dwordx4 a[172:175], v1, s[12:15], s24 offen offset:3072
 s_waitcnt vmcnt(14)
 v_mfma_f32_16x16x32_bf16 v[208:211], a[176:179], a[128:131], v[208:211]
 v_mfma_f32_16x16x32_bf16 v[212:215], a[176:179], a[132:135], v[212:215]
 v_add_f32 v139, v139, v23
 v_mfma_f32_16x16x32_bf16 v[216:219], a[176:179], a[136:139], v[216:219]
 v_mfma_f32_16x16x32_bf16 v[220:223], a[176:179], a[140:143], v[220:223]
 buffer_load_dwordx4 a[176:179], v2, s[12:15], s24 offen
 v_mfma_f32_16x16x32_bf16 v[224:227], a[180:183], a[128:131], v[224:227]
 v_accvgpr_read_b32 v28, a232
 v_mfma_f32_16x16x32_bf16 v[228:231], a[180:183], a[132:135], v[228:231]
 v_add_f32 v28, v28, v24
 v_mfma_f32_16x16x32_bf16 v[232:235], a[180:183], a[136:139], v[232:235]
 v_mfma_f32_16x16x32_bf16 v[236:239], a[180:183], a[140:143], v[236:239]
 buffer_load_dwordx4 a[180:183], v2, s[12:15], s24 offen offset:1024
 s_waitcnt vmcnt(14)
 v_mfma_f32_16x16x32_bf16 v[240:243], a[184:187], a[128:131], v[240:243]
 v_accvgpr_write_b32 a232, v28
 v_mfma_f32_16x16x32_bf16 v[244:247], a[184:187], a[132:135], v[244:247]
 v_mfma_f32_16x16x32_bf16 v[248:251], a[184:187], a[136:139], v[248:251]
 v_accvgpr_read_b32 v29, a233
 v_mfma_f32_16x16x32_bf16 v[252:255], a[184:187], a[140:143], v[252:255]
 buffer_load_dwordx4 a[184:187], v2, s[12:15], s24 offen offset:2048
 v_mfma_f32_16x16x32_bf16 a[240:243], a[188:191], a[128:131], a[240:243]
 v_mfma_f32_16x16x32_bf16 a[244:247], a[188:191], a[132:135], a[244:247]
 v_add_f32 v29, v29, v25
 v_mfma_f32_16x16x32_bf16 a[248:251], a[188:191], a[136:139], a[248:251]
 v_accvgpr_write_b32 a233, v29
 v_mfma_f32_16x16x32_bf16 a[252:255], a[188:191], a[140:143], a[252:255]
 buffer_load_dwordx4 a[188:191], v2, s[12:15], s24 offen offset:3072
 s_add_u32 s24, s24, 32768
 s_waitcnt vmcnt(14)
 s_waitcnt lgkmcnt(0)
 v_mfma_f32_16x16x32_bf16 v[144:147], a[192:195], a[144:147], v[144:147]
 v_mfma_f32_16x16x32_bf16 v[148:151], a[192:195], a[148:151], v[148:151]
 ds_read_b128 a[128:131], v3 offset:57344
 v_mfma_f32_16x16x32_bf16 v[152:155], a[192:195], a[152:155], v[152:155]
 v_accvgpr_read_b32 v28, a234
 v_mfma_f32_16x16x32_bf16 v[156:159], a[192:195], a[156:159], v[156:159]
 buffer_load_dwordx4 a[192:195], v1, s[12:15], s24 offen
 v_mfma_f32_16x16x32_bf16 v[160:163], a[196:199], a[144:147], v[160:163]
 v_mfma_f32_16x16x32_bf16 v[164:167], a[196:199], a[148:151], v[164:167]
 ds_read_b128 a[132:135], v3 offset:58368
 v_mfma_f32_16x16x32_bf16 v[168:171], a[196:199], a[152:155], v[168:171]
 v_add_f32 v28, v28, v26
 v_mfma_f32_16x16x32_bf16 v[172:175], a[196:199], a[156:159], v[172:175]
 buffer_load_dwordx4 a[196:199], v1, s[12:15], s24 offen offset:1024
 s_waitcnt vmcnt(14)
 v_mfma_f32_16x16x32_bf16 v[176:179], a[200:203], a[144:147], v[176:179]
 v_mfma_f32_16x16x32_bf16 v[180:183], a[200:203], a[148:151], v[180:183]
 ds_read_b128 a[136:139], v3 offset:59392
 v_mfma_f32_16x16x32_bf16 v[184:187], a[200:203], a[152:155], v[184:187]
 v_accvgpr_write_b32 a234, v28
 v_mfma_f32_16x16x32_bf16 v[188:191], a[200:203], a[156:159], v[188:191]
 buffer_load_dwordx4 a[200:203], v1, s[12:15], s24 offen offset:2048
 v_mfma_f32_16x16x32_bf16 v[192:195], a[204:207], a[144:147], v[192:195]
 v_accvgpr_read_b32 v29, a235
 v_mfma_f32_16x16x32_bf16 v[196:199], a[204:207], a[148:151], v[196:199]
 ds_read_b128 a[140:143], v3 offset:60416
 v_mfma_f32_16x16x32_bf16 v[200:203], a[204:207], a[152:155], v[200:203]
 v_mfma_f32_16x16x32_bf16 v[204:207], a[204:207], a[156:159], v[204:207]
 buffer_load_dwordx4 a[204:207], v1, s[12:15], s24 offen offset:3072
 s_waitcnt vmcnt(14)
 v_mfma_f32_16x16x32_bf16 v[208:211], a[208:211], a[144:147], v[208:211]
 v_add_f32 v29, v29, v27
 v_mfma_f32_16x16x32_bf16 v[212:215], a[208:211], a[148:151], v[212:215]
 v_mfma_f32_16x16x32_bf16 v[216:219], a[208:211], a[152:155], v[216:219]
 v_accvgpr_write_b32 a235, v29
 v_mfma_f32_16x16x32_bf16 v[220:223], a[208:211], a[156:159], v[220:223]
 buffer_load_dwordx4 a[208:211], v2, s[12:15], s24 offen
 v_mfma_f32_16x16x32_bf16 v[224:227], a[212:215], a[144:147], v[224:227]
 v_mfma_f32_16x16x32_bf16 v[228:231], a[212:215], a[148:151], v[228:231]
 v_add_f32 v140, v140, v20
 v_mfma_f32_16x16x32_bf16 v[232:235], a[212:215], a[152:155], v[232:235]
 v_add_f32 v141, v141, v21
 v_mfma_f32_16x16x32_bf16 v[236:239], a[212:215], a[156:159], v[236:239]
 buffer_load_dwordx4 a[212:215], v2, s[12:15], s24 offen offset:1024
 s_waitcnt vmcnt(14)
 v_mfma_f32_16x16x32_bf16 v[240:243], a[216:219], a[144:147], v[240:243]
 v_mfma_f32_16x16x32_bf16 v[244:247], a[216:219], a[148:151], v[244:247]
 v_add_f32 v142, v142, v22
 v_mfma_f32_16x16x32_bf16 v[248:251], a[216:219], a[152:155], v[248:251]
 v_mfma_f32_16x16x32_bf16 v[252:255], a[216:219], a[156:159], v[252:255]
 buffer_load_dwordx4 a[216:219], v2, s[12:15], s24 offen offset:2048
 v_mfma_f32_16x16x32_bf16 a[240:243], a[220:223], a[144:147], a[240:243]
 v_add_f32 v143, v143, v23
 v_mfma_f32_16x16x32_bf16 a[244:247], a[220:223], a[148:151], a[244:247]
 v_mfma_f32_16x16x32_bf16 a[248:251], a[220:223], a[152:155], a[248:251]
 v_accvgpr_read_b32 v28, a236
 v_mfma_f32_16x16x32_bf16 a[252:255], a[220:223], a[156:159], a[252:255]
 buffer_load_dwordx4 a[220:223], v2, s[12:15], s24 offen offset:3072
 s_add_u32 s24, s24, 32768
 s_waitcnt vmcnt(14)
 s_waitcnt lgkmcnt(0)
 v_mfma_f32_16x16x32_bf16 v[144:147], a[160:163], a[128:131], v[144:147]
 v_add_f32 v28, v28, v24
 v_mfma_f32_16x16x32_bf16 v[148:151], a[160:163], a[132:135], v[148:151]
 ds_read_b128 a[144:147], v3 offset:61440
 v_mfma_f32_16x16x32_bf16 v[152:155], a[160:163], a[136:139], v[152:155]
 v_mfma_f32_16x16x32_bf16 v[156:159], a[160:163], a[140:143], v[156:159]
 buffer_load_dwordx4 a[160:163], v1, s[12:15], s24 offen
 v_mfma_f32_16x16x32_bf16 v[160:163], a[164:167], a[128:131], v[160:163]
 v_accvgpr_write_b32 a236, v28
 v_mfma_f32_16x16x32_bf16 v[164:167], a[164:167], a[132:135], v[164:167]
 ds_read_b128 a[148:151], v3 offset:62464
 v_mfma_f32_16x16x32_bf16 v[168:171], a[164:167], a[136:139], v[168:171]
 v_mfma_f32_16x16x32_bf16 v[172:175], a[164:167], a[140:143], v[172:175]
 buffer_load_dwordx4 a[164:167], v1, s[12:15], s24 offen offset:1024
 s_waitcnt vmcnt(14)
 v_mfma_f32_16x16x32_bf16 v[176:179], a[168:171], a[128:131], v[176:179]
 v_accvgpr_read_b32 v29, a237
 v_mfma_f32_16x16x32_bf16 v[180:183], a[168:171], a[132:135], v[180:183]
 ds_read_b128 a[152:155], v3 offset:63488
 v_mfma_f32_16x16x32_bf16 v[184:187], a[168:171], a[136:139], v[184:187]
 v_mfma_f32_16x16x32_bf16 v[188:191], a[168:171], a[140:143], v[188:191]
 buffer_load_dwordx4 a[168:171], v1, s[12:15], s24 offen offset:2048
 v_mfma_f32_16x16x32_bf16 v[192:195], a[172:175], a[128:131], v[192:195]
 v_add_f32 v29, v29, v25
 v_mfma_f32_16x16x32_bf16 v[196:199], a[172:175], a[132:135], v[196:199]
 ds_read_b128 a[156:159], v3 offset:64512
 v_mfma_f32_16x16x32_bf16 v[200:203], a[172:175], a[136:139], v[200:203]
 v_accvgpr_write_b32 a237, v29
 v_mfma_f32_16x16x32_bf16 v[204:207], a[172:175], a[140:143], v[204:207]
 buffer_load_dwordx4 a[172:175], v1, s[12:15], s24 offen offset:3072
 s_waitcnt vmcnt(14)
 v_mfma_f32_16x16x32_bf16 v[208:211], a[176:179], a[128:131], v[208:211]
 v_mfma_f32_16x16x32_bf16 v[212:215], a[176:179], a[132:135], v[212:215]
 v_accvgpr_read_b32 v28, a238
 v_mfma_f32_16x16x32_bf16 v[216:219], a[176:179], a[136:139], v[216:219]
 v_mfma_f32_16x16x32_bf16 v[220:223], a[176:179], a[140:143], v[220:223]
 buffer_load_dwordx4 a[176:179], v2, s[12:15], s24 offen
 v_mfma_f32_16x16x32_bf16 v[224:227], a[180:183], a[128:131], v[224:227]
 v_add_f32 v28, v28, v26
 v_mfma_f32_16x16x32_bf16 v[228:231], a[180:183], a[132:135], v[228:231]
 v_mfma_f32_16x16x32_bf16 v[232:235], a[180:183], a[136:139], v[232:235]
 v_accvgpr_write_b32 a238, v28
 v_mfma_f32_16x16x32_bf16 v[236:239], a[180:183], a[140:143], v[236:239]
 buffer_load_dwordx4 a[180:183], v2, s[12:15], s24 offen offset:1024
 s_waitcnt vmcnt(14)
 v_mfma_f32_16x16x32_bf16 v[240:243], a[184:187], a[128:131], v[240:243]
 v_accvgpr_read_b32 v29, a239
 v_mfma_f32_16x16x32_bf16 v[244:247], a[184:187], a[132:135], v[244:247]
 v_mfma_f32_16x16x32_bf16 v[248:251], a[184:187], a[136:139], v[248:251]
 v_add_f32 v29, v29, v27
 v_mfma_f32_16x16x32_bf16 v[252:255], a[184:187], a[140:143], v[252:255]
 buffer_load_dwordx4 a[184:187], v2, s[12:15], s24 offen offset:2048
 v_mfma_f32_16x16x32_bf16 a[240:243], a[188:191], a[128:131], a[240:243]
 v_mfma_f32_16x16x32_bf16 a[244:247], a[188:191], a[132:135], a[244:247]
 v_accvgpr_write_b32 a239, v29
 v_mfma_f32_16x16x32_bf16 a[248:251], a[188:191], a[136:139], a[248:251]
 v_mfma_f32_16x16x32_bf16 a[252:255], a[188:191], a[140:143], a[252:255]
 buffer_load_dwordx4 a[188:191], v2, s[12:15], s24 offen offset:3072
 s_add_u32 s24, s24, 32768
 s_waitcnt vmcnt(14)
 s_waitcnt lgkmcnt(0)
 s_barrier
 v_mfma_f32_16x16x32_bf16 v[144:147], a[192:195], a[144:147], v[144:147]
 v_mfma_f32_16x16x32_bf16 v[148:151], a[192:195], a[148:151], v[148:151]
 ds_read_b128 a[128:131], v4
 v_mfma_f32_16x16x32_bf16 v[152:155], a[192:195], a[152:155], v[152:155]
 v_mfma_f32_16x16x32_bf16 v[156:159], a[192:195], a[156:159], v[156:159]
 buffer_load_dwordx4 a[192:195], v1, s[12:15], s24 offen
 v_mfma_f32_16x16x32_bf16 v[160:163], a[196:199], a[144:147], v[160:163]
 v_mfma_f32_16x16x32_bf16 v[164:167], a[196:199], a[148:151], v[164:167]
 ds_read_b128 a[132:135], v4 offset:1024
 v_mfma_f32_16x16x32_bf16 v[168:171], a[196:199], a[152:155], v[168:171]
 v_mfma_f32_16x16x32_bf16 v[172:175], a[196:199], a[156:159], v[172:175]
 buffer_load_dwordx4 a[196:199], v1, s[12:15], s24 offen offset:1024
 s_waitcnt vmcnt(14)
 v_mfma_f32_16x16x32_bf16 v[176:179], a[200:203], a[144:147], v[176:179]
 v_mfma_f32_16x16x32_bf16 v[180:183], a[200:203], a[148:151], v[180:183]
 ds_read_b128 a[136:139], v4 offset:2048
 v_mfma_f32_16x16x32_bf16 v[184:187], a[200:203], a[152:155], v[184:187]
 v_mfma_f32_16x16x32_bf16 v[188:191], a[200:203], a[156:159], v[188:191]
 buffer_load_dwordx4 a[200:203], v1, s[12:15], s24 offen offset:2048
 v_mfma_f32_16x16x32_bf16 v[192:195], a[204:207], a[144:147], v[192:195]
 v_mfma_f32_16x16x32_bf16 v[196:199], a[204:207], a[148:151], v[196:199]
 ds_read_b128 a[140:143], v4 offset:3072
 v_mfma_f32_16x16x32_bf16 v[200:203], a[204:207], a[152:155], v[200:203]
 v_mfma_f32_16x16x32_bf16 v[204:207], a[204:207], a[156:159], v[204:207]
 buffer_load_dwordx4 a[204:207], v1, s[12:15], s24 offen offset:3072
 s_waitcnt vmcnt(14)
 v_mfma_f32_16x16x32_bf16 v[208:211], a[208:211], a[144:147], v[208:211]
 v_mfma_f32_16x16x32_bf16 v[212:215], a[208:211], a[148:151], v[212:215]
 v_mfma_f32_16x16x32_bf16 v[216:219], a[208:211], a[152:155], v[216:219]
 v_mfma_f32_16x16x32_bf16 v[220:223], a[208:211], a[156:159], v[220:223]
 buffer_load_dwordx4 a[208:211], v2, s[12:15], s24 offen
 v_mfma_f32_16x16x32_bf16 v[224:227], a[212:215], a[144:147], v[224:227]
 v_mfma_f32_16x16x32_bf16 v[228:231], a[212:215], a[148:151], v[228:231]
 v_mfma_f32_16x16x32_bf16 v[232:235], a[212:215], a[152:155], v[232:235]
 v_mfma_f32_16x16x32_bf16 v[236:239], a[212:215], a[156:159], v[236:239]
 buffer_load_dwordx4 a[212:215], v2, s[12:15], s24 offen offset:1024
 s_waitcnt vmcnt(14)
 v_mfma_f32_16x16x32_bf16 v[240:243], a[216:219], a[144:147], v[240:243]
 v_mfma_f32_16x16x32_bf16 v[244:247], a[216:219], a[148:151], v[244:247]
 v_mfma_f32_16x16x32_bf16 v[248:251], a[216:219], a[152:155], v[248:251]
 v_mfma_f32_16x16x32_bf16 v[252:255], a[216:219], a[156:159], v[252:255]
 buffer_load_dwordx4 a[216:219], v2, s[12:15], s24 offen offset:2048
 v_mfma_f32_16x16x32_bf16 a[240:243], a[220:223], a[144:147], a[240:243]
 v_mfma_f32_16x16x32_bf16 a[244:247], a[220:223], a[148:151], a[244:247]
 v_mfma_f32_16x16x32_bf16 a[248:251], a[220:223], a[152:155], a[248:251]
 v_mfma_f32_16x16x32_bf16 a[252:255], a[220:223], a[156:159], a[252:255]
 buffer_load_dwordx4 a[220:223], v2, s[12:15], s24 offen offset:3072
 s_add_u32 s24, s24, 32768
 s_waitcnt vmcnt(14)
 s_waitcnt lgkmcnt(0)
 v_add_u32 v7, 4096, v7
 s_add_u32 s25, s25, 1
 s_cmp_eq_u32 s25, 6
 s_cbranch_scc1 Llast
 v_mfma_f32_16x16x32_bf16 v[144:147], a[160:163], a[128:131], v[144:147]
 v_accvgpr_read_b32 v20, a0
 v_lshlrev_b32 v21, 16, v20
 v_mfma_f32_16x16x32_bf16 v[148:151], a[160:163], a[132:135], v[148:151]
 ds_read_b128 a[144:147], v4 offset:4096
 v_mfma_f32_16x16x32_bf16 v[152:155], a[160:163], a[136:139], v[152:155]
 v_and_b32 v20, s26, v20
 v_mfma_f32_16x16x32_bf16 v[156:159], a[160:163], a[140:143], v[156:159]
 v_mul_f32 v22, v21, v32
 buffer_load_dwordx4 a[160:163], v1, s[12:15], s24 offen
 v_mfma_f32_16x16x32_bf16 v[160:163], a[164:167], a[128:131], v[160:163]
 v_mul_f32 v23, v20, v33
 v_mfma_f32_16x16x32_bf16 v[164:167], a[164:167], a[132:135], v[164:167]
 ds_read_b128 a[148:151], v4 offset:5120
 v_mfma_f32_16x16x32_bf16 v[168:171], a[164:167], a[136:139], v[168:171]
 v_cvt_pk_bf16_f32 v12, v22, v23
 v_mfma_f32_16x16x32_bf16 v[172:175], a[164:167], a[140:143], v[172:175]
 buffer_load_dwordx4 a[164:167], v1, s[12:15], s24 offen offset:1024
 s_waitcnt vmcnt(14)
 v_mfma_f32_16x16x32_bf16 v[176:179], a[168:171], a[128:131], v[176:179]
 v_accvgpr_read_b32 v24, a1
 v_lshlrev_b32 v25, 16, v24
 v_mfma_f32_16x16x32_bf16 v[180:183], a[168:171], a[132:135], v[180:183]
 ds_read_b128 a[152:155], v4 offset:6144
 v_mfma_f32_16x16x32_bf16 v[184:187], a[168:171], a[136:139], v[184:187]
 v_and_b32 v24, s26, v24
 v_mfma_f32_16x16x32_bf16 v[188:191], a[168:171], a[140:143], v[188:191]
 v_mul_f32 v26, v25, v34
 buffer_load_dwordx4 a[168:171], v1, s[12:15], s24 offen offset:2048
 v_mfma_f32_16x16x32_bf16 v[192:195], a[172:175], a[128:131], v[192:195]
 v_mul_f32 v27, v24, v35
 v_mfma_f32_16x16x32_bf16 v[196:199], a[172:175], a[132:135], v[196:199]
 ds_read_b128 a[156:159], v4 offset:7168
 v_mfma_f32_16x16x32_bf16 v[200:203], a[172:175], a[136:139], v[200:203]
 v_cvt_pk_bf16_f32 v13, v26, v27
 v_mfma_f32_16x16x32_bf16 v[204:207], a[172:175], a[140:143], v[204:207]
 buffer_load_dwordx4 a[172:175], v1, s[12:15], s24 offen offset:3072
 s_waitcnt vmcnt(14)
 v_mfma_f32_16x16x32_bf16 v[208:211], a[176:179], a[128:131], v[208:211]
 v_accvgpr_read_b32 v20, a2
 v_lshlrev_b32 v21, 16, v20
 v_mfma_f32_16x16x32_bf16 v[212:215], a[176:179], a[132:135], v[212:215]
 v_and_b32 v20, s26, v20
 v_mfma_f32_16x16x32_bf16 v[216:219], a[176:179], a[136:139], v[216:219]
 v_mul_f32 v22, v21, v48
 v_mfma_f32_16x16x32_bf16 v[220:223], a[176:179], a[140:143], v[220:223]
 buffer_load_dwordx4 a[176:179], v2, s[12:15], s24 offen
 v_mfma_f32_16x16x32_bf16 v[224:227], a[180:183], a[128:131], v[224:227]
 v_mul_f32 v23, v20, v49
 v_cvt_pk_bf16_f32 v14, v22, v23
 v_mfma_f32_16x16x32_bf16 v[228:231], a[180:183], a[132:135], v[228:231]
 v_accvgpr_read_b32 v24, a3
 v_mfma_f32_16x16x32_bf16 v[232:235], a[180:183], a[136:139], v[232:235]
 v_lshlrev_b32 v25, 16, v24
 v_mfma_f32_16x16x32_bf16 v[236:239], a[180:183], a[140:143], v[236:239]
 buffer_load_dwordx4 a[180:183], v2, s[12:15], s24 offen offset:1024
 s_waitcnt vmcnt(14)
 v_mfma_f32_16x16x32_bf16 v[240:243], a[184:187], a[128:131], v[240:243]
 v_and_b32 v24, s26, v24
 v_mul_f32 v26, v25, v50
 v_mfma_f32_16x16x32_bf16 v[244:247], a[184:187], a[132:135], v[244:247]
 v_mul_f32 v27, v24, v51
 v_mfma_f32_16x16x32_bf16 v[248:251], a[184:187], a[136:139], v[248:251]
 v_cvt_pk_bf16_f32 v15, v26, v27
 v_mfma_f32_16x16x32_bf16 v[252:255], a[184:187], a[140:143], v[252:255]
 buffer_load_dwordx4 a[184:187], v2, s[12:15], s24 offen offset:2048
 v_mfma_f32_16x16x32_bf16 a[240:243], a[188:191], a[128:131], a[240:243]
 ds_write_b128 v5, v[12:15]
 v_accvgpr_read_b32 v20, a4
 v_mfma_f32_16x16x32_bf16 a[244:247], a[188:191], a[132:135], a[244:247]
 v_lshlrev_b32 v21, 16, v20
 v_mfma_f32_16x16x32_bf16 a[248:251], a[188:191], a[136:139], a[248:251]
 v_and_b32 v20, s26, v20
 v_mfma_f32_16x16x32_bf16 a[252:255], a[188:191], a[140:143], a[252:255]
 buffer_load_dwordx4 a[188:191], v2, s[12:15], s24 offen offset:3072
 s_add_u32 s24, s24, 32768
 s_waitcnt vmcnt(14)
 s_waitcnt lgkmcnt(1)
 v_mfma_f32_16x16x32_bf16 v[144:147], a[192:195], a[144:147], v[144:147]
 v_mul_f32 v22, v21, v36
 v_mul_f32 v23, v20, v37
 v_mfma_f32_16x16x32_bf16 v[148:151], a[192:195], a[148:151], v[148:151]
 ds_read_b128 a[128:131], v4 offset:8192
 v_mfma_f32_16x16x32_bf16 v[152:155], a[192:195], a[152:155], v[152:155]
 v_cvt_pk_bf16_f32 v16, v22, v23
 v_mfma_f32_16x16x32_bf16 v[156:159], a[192:195], a[156:159], v[156:159]
 buffer_load_dwordx4 a[192:195], v1, s[12:15], s24 offen
 v_mfma_f32_16x16x32_bf16 v[160:163], a[196:199], a[144:147], v[160:163]
 v_accvgpr_read_b32 v24, a5
 v_lshlrev_b32 v25, 16, v24
 v_mfma_f32_16x16x32_bf16 v[164:167], a[196:199], a[148:151], v[164:167]
 ds_read_b128 a[132:135], v4 offset:9216
 v_mfma_f32_16x16x32_bf16 v[168:171], a[196:199], a[152:155], v[168:171]
 v_and_b32 v24, s26, v24
 v_mfma_f32_16x16x32_bf16 v[172:175], a[196:199], a[156:159], v[172:175]
 buffer_load_dwordx4 a[196:199], v1, s[12:15], s24 offen offset:1024
 s_waitcnt vmcnt(14)
 v_mfma_f32_16x16x32_bf16 v[176:179], a[200:203], a[144:147], v[176:179]
 v_mul_f32 v26, v25, v38
 v_mfma_f32_16x16x32_bf16 v[180:183], a[200:203], a[148:151], v[180:183]
 v_mul_f32 v27, v24, v39
 ds_read_b128 a[136:139], v4 offset:10240
 v_mfma_f32_16x16x32_bf16 v[184:187], a[200:203], a[152:155], v[184:187]
 v_cvt_pk_bf16_f32 v17, v26, v27
 v_mfma_f32_16x16x32_bf16 v[188:191], a[200:203], a[156:159], v[188:191]
 buffer_load_dwordx4 a[200:203], v1, s[12:15], s24 offen offset:2048
 v_mfma_f32_16x16x32_bf16 v[192:195], a[204:207], a[144:147], v[192:195]
 v_accvgpr_read_b32 v20, a6
 v_lshlrev_b32 v21, 16, v20
 v_mfma_f32_16x16x32_bf16 v[196:199], a[204:207], a[148:151], v[196:199]
 ds_read_b128 a[140:143], v4 offset:11264
 v_mfma_f32_16x16x32_bf16 v[200:203], a[204:207], a[152:155], v[200:203]
 v_and_b32 v20, s26, v20
 v_mfma_f32_16x16x32_bf16 v[204:207], a[204:207], a[156:159], v[204:207]
 buffer_load_dwordx4 a[204:207], v1, s[12:15], s24 offen offset:3072
 s_waitcnt vmcnt(14)
 v_mfma_f32_16x16x32_bf16 v[208:211], a[208:211], a[144:147], v[208:211]
 v_mul_f32 v22, v21, v52
 v_mfma_f32_16x16x32_bf16 v[212:215], a[208:211], a[148:151], v[212:215]
 v_mul_f32 v23, v20, v53
 v_cvt_pk_bf16_f32 v18, v22, v23
 v_mfma_f32_16x16x32_bf16 v[216:219], a[208:211], a[152:155], v[216:219]
 v_accvgpr_read_b32 v24, a7
 v_mfma_f32_16x16x32_bf16 v[220:223], a[208:211], a[156:159], v[220:223]
 buffer_load_dwordx4 a[208:211], v2, s[12:15], s24 offen
 v_mfma_f32_16x16x32_bf16 v[224:227], a[212:215], a[144:147], v[224:227]
 v_lshlrev_b32 v25, 16, v24
 v_mfma_f32_16x16x32_bf16 v[228:231], a[212:215], a[148:151], v[228:231]
 v_and_b32 v24, s26, v24
 v_mul_f32 v26, v25, v54
 v_mfma_f32_16x16x32_bf16 v[232:235], a[212:215], a[152:155], v[232:235]
 v_mul_f32 v27, v24, v55
 v_mfma_f32_16x16x32_bf16 v[236:239], a[212:215], a[156:159], v[236:239]
 buffer_load_dwordx4 a[212:215], v2, s[12:15], s24 offen offset:1024
 s_waitcnt vmcnt(14)
 v_mfma_f32_16x16x32_bf16 v[240:243], a[216:219], a[144:147], v[240:243]
 v_cvt_pk_bf16_f32 v19, v26, v27
 v_mfma_f32_16x16x32_bf16 v[244:247], a[216:219], a[148:151], v[244:247]
 ds_write_b128 v5, v[16:19] offset:1024
 v_accvgpr_read_b32 v20, a8
 v_mfma_f32_16x16x32_bf16 v[248:251], a[216:219], a[152:155], v[248:251]
 v_lshlrev_b32 v21, 16, v20
 v_mfma_f32_16x16x32_bf16 v[252:255], a[216:219], a[156:159], v[252:255]
 buffer_load_dwordx4 a[216:219], v2, s[12:15], s24 offen offset:2048
 v_mfma_f32_16x16x32_bf16 a[240:243], a[220:223], a[144:147], a[240:243]
 v_and_b32 v20, s26, v20
 v_mfma_f32_16x16x32_bf16 a[244:247], a[220:223], a[148:151], a[244:247]
 v_mul_f32 v22, v21, v40
 v_mul_f32 v23, v20, v41
 v_mfma_f32_16x16x32_bf16 a[248:251], a[220:223], a[152:155], a[248:251]
 v_cvt_pk_bf16_f32 v12, v22, v23
 v_mfma_f32_16x16x32_bf16 a[252:255], a[220:223], a[156:159], a[252:255]
 buffer_load_dwordx4 a[220:223], v2, s[12:15], s24 offen offset:3072
 s_add_u32 s24, s24, 32768
 s_waitcnt vmcnt(14)
 s_waitcnt lgkmcnt(1)
 v_mfma_f32_16x16x32_bf16 v[144:147], a[160:163], a[128:131], v[144:147]
 v_accvgpr_read_b32 v24, a9
 v_mfma_f32_16x16x32_bf16 v[148:151], a[160:163], a[132:135], v[148:151]
 v_lshlrev_b32 v25, 16, v24
 ds_read_b128 a[144:147], v4 offset:12288
 v_mfma_f32_16x16x32_bf16 v[152:155], a[160:163], a[136:139], v[152:155]
 v_and_b32 v24, s26, v24
 v_mfma_f32_16x16x32_bf16 v[156:159], a[160:163], a[140:143], v[156:159]
 buffer_load_dwordx4 a[160:163], v1, s[12:15], s24 offen
 v_mfma_f32_16x16x32_bf16 v[160:163], a[164:167], a[128:131], v[160:163]
 v_mul_f32 v26, v25, v42
 v_mfma_f32_16x16x32_bf16 v[164:167], a[164:167], a[132:135], v[164:167]
 v_mul_f32 v27, v24, v43
 ds_read_b128 a[148:151], v4 offset:13312
 v_mfma_f32_16x16x32_bf16 v[168:171], a[164:167], a[136:139], v[168:171]
 v_cvt_pk_bf16_f32 v13, v26, v27
 v_mfma_f32_16x16x32_bf16 v[172:175], a[164:167], a[140:143], v[172:175]
 buffer_load_dwordx4 a[164:167], v1, s[12:15], s24 offen offset:1024
 s_waitcnt vmcnt(14)
 v_mfma_f32_16x16x32_bf16 v[176:179], a[168:171], a[128:131], v[176:179]
 v_accvgpr_read_b32 v20, a10
 v_mfma_f32_16x16x32_bf16 v[180:183], a[168:171], a[132:135], v[180:183]
 ds_read_b128 a[152:155], v4 offset:14336
 v_mfma_f32_16x16x32_bf16 v[184:187], a[168:171], a[136:139], v[184:187]
 v_lshlrev_b32 v21, 16, v20
 v_and_b32 v20, s26, v20
 v_mfma_f32_16x16x32_bf16 v[188:191], a[168:171], a[140:143], v[188:191]
 buffer_load_dwordx4 a[168:171], v1, s[12:15], s24 offen offset:2048
 v_mfma_f32_16x16x32_bf16 v[192:195], a[172:175], a[128:131], v[192:195]
 v_mul_f32 v22, v21, v56
 v_mfma_f32_16x16x32_bf16 v[196:199], a[172:175], a[132:135], v[196:199]
 v_mul_f32 v23, v20, v57
 ds_read_b128 a[156:159], v4 offset:15360
 v_mfma_f32_16x16x32_bf16 v[200:203], a[172:175], a[136:139], v[200:203]
 v_cvt_pk_bf16_f32 v14, v22, v23
 v_mfma_f32_16x16x32_bf16 v[204:207], a[172:175], a[140:143], v[204:207]
 buffer_load_dwordx4 a[172:175], v1, s[12:15], s24 offen offset:3072
 s_waitcnt vmcnt(14)
 v_mfma_f32_16x16x32_bf16 v[208:211], a[176:179], a[128:131], v[208:211]
 v_accvgpr_read_b32 v24, a11
 v_mfma_f32_16x16x32_bf16 v[212:215], a[176:179], a[132:135], v[212:215]
 v_lshlrev_b32 v25, 16, v24
 v_mfma_f32_16x16x32_bf16 v[216:219], a[176:179], a[136:139], v[216:219]
 v_and_b32 v24, s26, v24
 v_mul_f32 v26, v25, v58
 v_mfma_f32_16x16x32_bf16 v[220:223], a[176:179], a[140:143], v[220:223]
 buffer_load_dwordx4 a[176:179], v2, s[12:15], s24 offen
 v_mfma_f32_16x16x32_bf16 v[224:227], a[180:183], a[128:131], v[224:227]
 v_mul_f32 v27, v24, v59
 v_mfma_f32_16x16x32_bf16 v[228:231], a[180:183], a[132:135], v[228:231]
 v_cvt_pk_bf16_f32 v15, v26, v27
 v_mfma_f32_16x16x32_bf16 v[232:235], a[180:183], a[136:139], v[232:235]
 ds_write_b128 v5, v[12:15] offset:2048
 v_accvgpr_read_b32 v20, a12
 v_mfma_f32_16x16x32_bf16 v[236:239], a[180:183], a[140:143], v[236:239]
 buffer_load_dwordx4 a[180:183], v2, s[12:15], s24 offen offset:1024
 s_waitcnt vmcnt(14)
 v_mfma_f32_16x16x32_bf16 v[240:243], a[184:187], a[128:131], v[240:243]
 v_lshlrev_b32 v21, 16, v20
 v_mfma_f32_16x16x32_bf16 v[244:247], a[184:187], a[132:135], v[244:247]
 v_and_b32 v20, s26, v20
 v_mfma_f32_16x16x32_bf16 v[248:251], a[184:187], a[136:139], v[248:251]
 v_mul_f32 v22, v21, v44
 v_mul_f32 v23, v20, v45
 v_mfma_f32_16x16x32_bf16 v[252:255], a[184:187], a[140:143], v[252:255]
 buffer_load_dwordx4 a[184:187], v2, s[12:15], s24 offen offset:2048
 v_mfma_f32_16x16x32_bf16 a[240:243], a[188:191], a[128:131], a[240:243]
 v_cvt_pk_bf16_f32 v16, v22, v23
 v_mfma_f32_16x16x32_bf16 a[244:247], a[188:191], a[132:135], a[244:247]
 v_accvgpr_read_b32 v24, a13
 v_mfma_f32_16x16x32_bf16 a[248:251], a[188:191], a[136:139], a[248:251]
 v_lshlrev_b32 v25, 16, v24
 v_and_b32 v24, s26, v24
 v_mfma_f32_16x16x32_bf16 a[252:255], a[188:191], a[140:143], a[252:255]
 buffer_load_dwordx4 a[188:191], v2, s[12:15], s24 offen offset:3072
 s_add_u32 s24, s24, 32768
 s_waitcnt vmcnt(14)
 s_waitcnt lgkmcnt(1)
 v_mfma_f32_16x16x32_bf16 v[144:147], a[192:195], a[144:147], v[144:147]
 v_mul_f32 v26, v25, v46
 v_mfma_f32_16x16x32_bf16 v[148:151], a[192:195], a[148:151], v[148:151]
 ds_read_b128 a[128:131], v4 offset:16384
 v_mfma_f32_16x16x32_bf16 v[152:155], a[192:195], a[152:155], v[152:155]
 v_mul_f32 v27, v24, v47
 v_cvt_pk_bf16_f32 v17, v26, v27
 v_mfma_f32_16x16x32_bf16 v[156:159], a[192:195], a[156:159], v[156:159]
 buffer_load_dwordx4 a[192:195], v1, s[12:15], s24 offen
 v_mfma_f32_16x16x32_bf16 v[160:163], a[196:199], a[144:147], v[160:163]
 v_accvgpr_read_b32 v20, a14
 v_mfma_f32_16x16x32_bf16 v[164:167], a[196:199], a[148:151], v[164:167]
 ds_read_b128 a[132:135], v4 offset:17408
 v_mfma_f32_16x16x32_bf16 v[168:171], a[196:199], a[152:155], v[168:171]
 v_lshlrev_b32 v21, 16, v20
 v_and_b32 v20, s26, v20
 v_mfma_f32_16x16x32_bf16 v[172:175], a[196:199], a[156:159], v[172:175]
 buffer_load_dwordx4 a[196:199], v1, s[12:15], s24 offen offset:1024
 s_waitcnt vmcnt(14)
 v_mfma_f32_16x16x32_bf16 v[176:179], a[200:203], a[144:147], v[176:179]
 v_mul_f32 v22, v21, v60
 v_mfma_f32_16x16x32_bf16 v[180:183], a[200:203], a[148:151], v[180:183]
 ds_read_b128 a[136:139], v4 offset:18432
 v_mfma_f32_16x16x32_bf16 v[184:187], a[200:203], a[152:155], v[184:187]
 v_mul_f32 v23, v20, v61
 v_mfma_f32_16x16x32_bf16 v[188:191], a[200:203], a[156:159], v[188:191]
 v_cvt_pk_bf16_f32 v18, v22, v23
 buffer_load_dwordx4 a[200:203], v1, s[12:15], s24 offen offset:2048
 v_mfma_f32_16x16x32_bf16 v[192:195], a[204:207], a[144:147], v[192:195]
 v_accvgpr_read_b32 v24, a15
 v_mfma_f32_16x16x32_bf16 v[196:199], a[204:207], a[148:151], v[196:199]
 ds_read_b128 a[140:143], v4 offset:19456
 v_mfma_f32_16x16x32_bf16 v[200:203], a[204:207], a[152:155], v[200:203]
 v_lshlrev_b32 v25, 16, v24
 v_and_b32 v24, s26, v24
 v_mfma_f32_16x16x32_bf16 v[204:207], a[204:207], a[156:159], v[204:207]
 buffer_load_dwordx4 a[204:207], v1, s[12:15], s24 offen offset:3072
 s_waitcnt vmcnt(14)
 v_mfma_f32_16x16x32_bf16 v[208:211], a[208:211], a[144:147], v[208:211]
 v_mul_f32 v26, v25, v62
 v_mfma_f32_16x16x32_bf16 v[212:215], a[208:211], a[148:151], v[212:215]
 v_mul_f32 v27, v24, v63
 v_mfma_f32_16x16x32_bf16 v[216:219], a[208:211], a[152:155], v[216:219]
 v_cvt_pk_bf16_f32 v19, v26, v27
 v_mfma_f32_16x16x32_bf16 v[220:223], a[208:211], a[156:159], v[220:223]
 ds_write_b128 v5, v[16:19] offset:3072
 buffer_load_dwordx4 a[208:211], v2, s[12:15], s24 offen
 v_mfma_f32_16x16x32_bf16 v[224:227], a[212:215], a[144:147], v[224:227]
 v_accvgpr_read_b32 v20, a16
 v_mfma_f32_16x16x32_bf16 v[228:231], a[212:215], a[148:151], v[228:231]
 v_lshlrev_b32 v21, 16, v20
 v_mfma_f32_16x16x32_bf16 v[232:235], a[212:215], a[152:155], v[232:235]
 v_and_b32 v20, s26, v20
 v_mfma_f32_16x16x32_bf16 v[236:239], a[212:215], a[156:159], v[236:239]
 buffer_load_dwordx4 a[212:215], v2, s[12:15], s24 offen offset:1024
 s_waitcnt vmcnt(14)
 v_mfma_f32_16x16x32_bf16 v[240:243], a[216:219], a[144:147], v[240:243]
 v_mul_f32 v22, v21, v64
 v_mul_f32 v23, v20, v65
 v_mfma_f32_16x16x32_bf16 v[244:247], a[216:219], a[148:151], v[244:247]
 v_cvt_pk_bf16_f32 v12, v22, v23
 v_mfma_f32_16x16x32_bf16 v[248:251], a[216:219], a[152:155], v[248:251]
 v_accvgpr_read_b32 v24, a17
 v_mfma_f32_16x16x32_bf16 v[252:255], a[216:219], a[156:159], v[252:255]
 v_lshlrev_b32 v25, 16, v24
 buffer_load_dwordx4 a[216:219], v2, s[12:15], s24 offen offset:2048
 v_mfma_f32_16x16x32_bf16 a[240:243], a[220:223], a[144:147], a[240:243]
 v_and_b32 v24, s26, v24
 v_mfma_f32_16x16x32_bf16 a[244:247], a[220:223], a[148:151], a[244:247]
 v_mul_f32 v26, v25, v66
 v_mfma_f32_16x16x32_bf16 a[248:251], a[220:223], a[152:155], a[248:251]
 v_mul_f32 v27, v24, v67
 v_mfma_f32_16x16x32_bf16 a[252:255], a[220:223], a[156:159], a[252:255]
 buffer_load_dwordx4 a[220:223], v2, s[12:15], s24 offen offset:3072
 s_add_u32 s24, s24, 32768
 s_waitcnt vmcnt(14)
 s_waitcnt lgkmcnt(1)
 v_mfma_f32_16x16x32_bf16 v[144:147], a[160:163], a[128:131], v[144:147]
 v_cvt_pk_bf16_f32 v13, v26, v27
 v_accvgpr_read_b32 v20, a18
 v_mfma_f32_16x16x32_bf16 v[148:151], a[160:163], a[132:135], v[148:151]
 ds_read_b128 a[144:147], v4 offset:20480
 v_mfma_f32_16x16x32_bf16 v[152:155], a[160:163], a[136:139], v[152:155]
 v_lshlrev_b32 v21, 16, v20
 v_mfma_f32_16x16x32_bf16 v[156:159], a[160:163], a[140:143], v[156:159]
 v_and_b32 v20, s26, v20
 buffer_load_dwordx4 a[160:163], v1, s[12:15], s24 offen
 v_mfma_f32_16x16x32_bf16 v[160:163], a[164:167], a[128:131], v[160:163]
 v_mul_f32 v22, v21, v80
 v_mfma_f32_16x16x32_bf16 v[164:167], a[164:167], a[132:135], v[164:167]
 ds_read_b128 a[148:151], v4 offset:21504
 v_mfma_f32_16x16x32_bf16 v[168:171], a[164:167], a[136:139], v[168:171]
 v_mul_f32 v23, v20, v81
 v_mfma_f32_16x16x32_bf16 v[172:175], a[164:167], a[140:143], v[172:175]
 buffer_load_dwordx4 a[164:167], v1, s[12:15], s24 offen offset:1024
 s_waitcnt vmcnt(14)
 v_mfma_f32_16x16x32_bf16 v[176:179], a[168:171], a[128:131], v[176:179]
 v_cvt_pk_bf16_f32 v14, v22, v23
 v_accvgpr_read_b32 v24, a19
 v_mfma_f32_16x16x32_bf16 v[180:183], a[168:171], a[132:135], v[180:183]
 ds_read_b128 a[152:155], v4 offset:22528
 v_mfma_f32_16x16x32_bf16 v[184:187], a[168:171], a[136:139], v[184:187]
 v_lshlrev_b32 v25, 16, v24
 v_mfma_f32_16x16x32_bf16 v[188:191], a[168:171], a[140:143], v[188:191]
 buffer_load_dwordx4 a[168:171], v1, s[12:15], s24 offen offset:2048
 v_mfma_f32_16x16x32_bf16 v[192:195], a[172:175], a[128:131], v[192:195]
 v_and_b32 v24, s26, v24
 v_mul_f32 v26, v25, v82
 v_mfma_f32_16x16x32_bf16 v[196:199], a[172:175], a[132:135], v[196:199]
 ds_read_b128 a[156:159], v4 offset:23552
 v_mfma_f32_16x16x32_bf16 v[200:203], a[172:175], a[136:139], v[200:203]
 v_mul_f32 v27, v24, v83
 v_mfma_f32_16x16x32_bf16 v[204:207], a[172:175], a[140:143], v[204:207]
 buffer_load_dwordx4 a[172:175], v1, s[12:15], s24 offen offset:3072
 s_waitcnt vmcnt(14)
 v_mfma_f32_16x16x32_bf16 v[208:211], a[176:179], a[128:131], v[208:211]
 v_cvt_pk_bf16_f32 v15, v26, v27
 ds_write_b128 v5, v[12:15] offset:4096
 v_mfma_f32_16x16x32_bf16 v[212:215], a[176:179], a[132:135], v[212:215]
 v_accvgpr_read_b32 v20, a20
 v_mfma_f32_16x16x32_bf16 v[216:219], a[176:179], a[136:139], v[216:219]
 v_lshlrev_b32 v21, 16, v20
 v_mfma_f32_16x16x32_bf16 v[220:223], a[176:179], a[140:143], v[220:223]
 buffer_load_dwordx4 a[176:179], v2, s[12:15], s24 offen
 v_mfma_f32_16x16x32_bf16 v[224:227], a[180:183], a[128:131], v[224:227]
 v_and_b32 v20, s26, v20
 v_mul_f32 v22, v21, v68
 v_mfma_f32_16x16x32_bf16 v[228:231], a[180:183], a[132:135], v[228:231]
 v_mul_f32 v23, v20, v69
 v_mfma_f32_16x16x32_bf16 v[232:235], a[180:183], a[136:139], v[232:235]
 v_cvt_pk_bf16_f32 v16, v22, v23
 v_mfma_f32_16x16x32_bf16 v[236:239], a[180:183], a[140:143], v[236:239]
 buffer_load_dwordx4 a[180:183], v2, s[12:15], s24 offen offset:1024
 s_waitcnt vmcnt(14)
 v_mfma_f32_16x16x32_bf16 v[240:243], a[184:187], a[128:131], v[240:243]
 v_accvgpr_read_b32 v24, a21
 v_lshlrev_b32 v25, 16, v24
 v_mfma_f32_16x16x32_bf16 v[244:247], a[184:187], a[132:135], v[244:247]
 v_and_b32 v24, s26, v24
 v_mfma_f32_16x16x32_bf16 v[248:251], a[184:187], a[136:139], v[248:251]
 v_mul_f32 v26, v25, v70
 v_mfma_f32_16x16x32_bf16 v[252:255], a[184:187], a[140:143], v[252:255]
 buffer_load_dwordx4 a[184:187], v2, s[12:15], s24 offen offset:2048
 v_mfma_f32_16x16x32_bf16 a[240:243], a[188:191], a[128:131], a[240:243]
 v_mul_f32 v27, v24, v71
 v_cvt_pk_bf16_f32 v17, v26, v27
 v_mfma_f32_16x16x32_bf16 a[244:247], a[188:191], a[132:135], a[244:247]
 v_accvgpr_read_b32 v20, a22
 v_mfma_f32_16x16x32_bf16 a[248:251], a[188:191], a[136:139], a[248:251]
 v_lshlrev_b32 v21, 16, v20
 v_mfma_f32_16x16x32_bf16 a[252:255], a[188:191], a[140:143], a[252:255]
 buffer_load_dwordx4 a[188:191], v2, s[12:15], s24 offen offset:3072
 s_add_u32 s24, s24, 32768
 s_waitcnt vmcnt(14)
 s_waitcnt lgkmcnt(1)
 v_mfma_f32_16x16x32_bf16 v[144:147], a[192:195], a[144:147], v[144:147]
 v_and_b32 v20, s26, v20
 v_mfma_f32_16x16x32_bf16 v[148:151], a[192:195], a[148:151], v[148:151]
 v_mul_f32 v22, v21, v84
 ds_read_b128 a[128:131], v4 offset:24576
 v_mfma_f32_16x16x32_bf16 v[152:155], a[192:195], a[152:155], v[152:155]
 v_mul_f32 v23, v20, v85
 v_mfma_f32_16x16x32_bf16 v[156:159], a[192:195], a[156:159], v[156:159]
 buffer_load_dwordx4 a[192:195], v1, s[12:15], s24 offen
 v_mfma_f32_16x16x32_bf16 v[160:163], a[196:199], a[144:147], v[160:163]
 v_cvt_pk_bf16_f32 v18, v22, v23
 v_accvgpr_read_b32 v24, a23
 v_mfma_f32_16x16x32_bf16 v[164:167], a[196:199], a[148:151], v[164:167]
 ds_read_b128 a[132:135], v4 offset:25600
 v_mfma_f32_16x16x32_bf16 v[168:171], a[196:199], a[152:155], v[168:171]
 v_lshlrev_b32 v25, 16, v24
 v_mfma_f32_16x16x32_bf16 v[172:175], a[196:199], a[156:159], v[172:175]
 buffer_load_dwordx4 a[196:199], v1, s[12:15], s24 offen offset:1024
 s_waitcnt vmcnt(14)
 v_mfma_f32_16x16x32_bf16 v[176:179], a[200:203], a[144:147], v[176:179]
 v_and_b32 v24, s26, v24
 v_mfma_f32_16x16x32_bf16 v[180:183], a[200:203], a[148:151], v[180:183]
 v_mul_f32 v26, v25, v86
 ds_read_b128 a[136:139], v4 offset:26624
 v_mfma_f32_16x16x32_bf16 v[184:187], a[200:203], a[152:155], v[184:187]
 v_mul_f32 v27, v24, v87
 v_mfma_f32_16x16x32_bf16 v[188:191], a[200:203], a[156:159], v[188:191]
 buffer_load_dwordx4 a[200:203], v1, s[12:15], s24 offen offset:2048
 v_mfma_f32_16x16x32_bf16 v[192:195], a[204:207], a[144:147], v[192:195]
 v_cvt_pk_bf16_f32 v19, v26, v27
 v_mfma_f32_16x16x32_bf16 v[196:199], a[204:207], a[148:151], v[196:199]
 ds_write_b128 v5, v[16:19] offset:5120
 ds_read_b128 a[140:143], v4 offset:27648
 v_mfma_f32_16x16x32_bf16 v[200:203], a[204:207], a[152:155], v[200:203]
 v_accvgpr_read_b32 v20, a24
 v_mfma_f32_16x16x32_bf16 v[204:207], a[204:207], a[156:159], v[204:207]
 buffer_load_dwordx4 a[204:207], v1, s[12:15], s24 offen offset:3072
 s_waitcnt vmcnt(14)
 v_mfma_f32_16x16x32_bf16 v[208:211], a[208:211], a[144:147], v[208:211]
 v_lshlrev_b32 v21, 16, v20
 v_mfma_f32_16x16x32_bf16 v[212:215], a[208:211], a[148:151], v[212:215]
 v_and_b32 v20, s26, v20
 v_mul_f32 v22, v21, v72
 v_mfma_f32_16x16x32_bf16 v[216:219], a[208:211], a[152:155], v[216:219]
 v_mul_f32 v23, v20, v73
 v_mfma_f32_16x16x32_bf16 v[220:223], a[208:211], a[156:159], v[220:223]
 buffer_load_dwordx4 a[208:211], v2, s[12:15], s24 offen
 v_mfma_f32_16x16x32_bf16 v[224:227], a[212:215], a[144:147], v[224:227]
 v_cvt_pk_bf16_f32 v12, v22, v23
 v_mfma_f32_16x16x32_bf16 v[228:231], a[212:215], a[148:151], v[228:231]
 v_accvgpr_read_b32 v24, a25
 v_lshlrev_b32 v25, 16, v24
 v_mfma_f32_16x16x32_bf16 v[232:235], a[212:215], a[152:155], v[232:235]
 v_and_b32 v24, s26, v24
 v_mfma_f32_16x16x32_bf16 v[236:239], a[212:215], a[156:159], v[236:239]
 buffer_load_dwordx4 a[212:215], v2, s[12:15], s24 offen offset:1024
 s_waitcnt vmcnt(14)
 v_mfma_f32_16x16x32_bf16 v[240:243], a[216:219], a[144:147], v[240:243]
 v_mul_f32 v26, v25, v74
 v_mfma_f32_16x16x32_bf16 v[244:247], a[216:219], a[148:151], v[244:247]
 v_mul_f32 v27, v24, v75
 v_cvt_pk_bf16_f32 v13, v26, v27
 v_mfma_f32_16x16x32_bf16 v[248:251], a[216:219], a[152:155], v[248:251]
 v_accvgpr_read_b32 v20, a26
 v_mfma_f32_16x16x32_bf16 v[252:255], a[216:219], a[156:159], v[252:255]
 buffer_load_dwordx4 a[216:219], v2, s[12:15], s24 offen offset:2048
 v_mfma_f32_16x16x32_bf16 a[240:243], a[220:223], a[144:147], a[240:243]
 v_lshlrev_b32 v21, 16, v20
 v_mfma_f32_16x16x32_bf16 a[244:247], a[220:223], a[148:151], a[244:247]
 v_and_b32 v20, s26, v20
 v_mul_f32 v22, v21, v88
 v_mfma_f32_16x16x32_bf16 a[248:251], a[220:223], a[152:155], a[248:251]
 v_mul_f32 v23, v20, v89
 v_mfma_f32_16x16x32_bf16 a[252:255], a[220:223], a[156:159], a[252:255]
 buffer_load_dwordx4 a[220:223], v2, s[12:15], s24 offen offset:3072
 s_add_u32 s24, s24, 32768
 s_waitcnt vmcnt(14)
 s_waitcnt lgkmcnt(0)
 v_mfma_f32_16x16x32_bf16 v[144:147], a[160:163], a[128:131], v[144:147]
 v_cvt_pk_bf16_f32 v14, v22, v23
 v_mfma_f32_16x16x32_bf16 v[148:151], a[160:163], a[132:135], v[148:151]
 ds_read_b128 a[144:147], v4 offset:28672
 v_mfma_f32_16x16x32_bf16 v[152:155], a[160:163], a[136:139], v[152:155]
 v_accvgpr_read_b32 v24, a27
 v_lshlrev_b32 v25, 16, v24
 v_mfma_f32_16x16x32_bf16 v[156:159], a[160:163], a[140:143], v[156:159]
 buffer_load_dwordx4 a[160:163], v1, s[12:15], s24 offen
 v_mfma_f32_16x16x32_bf16 v[160:163], a[164:167], a[128:131], v[160:163]
 v_and_b32 v24, s26, v24
 v_mfma_f32_16x16x32_bf16 v[164:167], a[164:167], a[132:135], v[164:167]
 v_mul_f32 v26, v25, v90
 ds_read_b128 a[148:151], v4 offset:29696
 v_mfma_f32_16x16x32_bf16 v[168:171], a[164:167], a[136:139], v[168:171]
 v_mul_f32 v27, v24, v91
 v_mfma_f32_16x16x32_bf16 v[172:175], a[164:167], a[140:143], v[172:175]
 buffer_load_dwordx4 a[164:167], v1, s[12:15], s24 offen offset:1024
 s_waitcnt vmcnt(14)
 v_mfma_f32_16x16x32_bf16 v[176:179], a[168:171], a[128:131], v[176:179]
 v_cvt_pk_bf16_f32 v15, v26, v27
 v_mfma_f32_16x16x32_bf16 v[180:183], a[168:171], a[132:135], v[180:183]
 ds_read_b128 a[152:155], v4 offset:30720
 v_mfma_f32_16x16x32_bf16 v[184:187], a[168:171], a[136:139], v[184:187]
 ds_write_b128 v5, v[12:15] offset:6144
 v_accvgpr_read_b32 v20, a28
 v_mfma_f32_16x16x32_bf16 v[188:191], a[168:171], a[140:143], v[188:191]
 buffer_load_dwordx4 a[168:171], v1, s[12:15], s24 offen offset:2048
 v_mfma_f32_16x16x32_bf16 v[192:195], a[172:175], a[128:131], v[192:195]
 v_lshlrev_b32 v21, 16, v20
 v_mfma_f32_16x16x32_bf16 v[196:199], a[172:175], a[132:135], v[196:199]
 ds_read_b128 a[156:159], v4 offset:31744
 v_mfma_f32_16x16x32_bf16 v[200:203], a[172:175], a[136:139], v[200:203]
 v_and_b32 v20, s26, v20
 v_mul_f32 v22, v21, v76
 v_mfma_f32_16x16x32_bf16 v[204:207], a[172:175], a[140:143], v[204:207]
 buffer_load_dwordx4 a[172:175], v1, s[12:15], s24 offen offset:3072
 s_waitcnt vmcnt(14)
 v_mfma_f32_16x16x32_bf16 v[208:211], a[176:179], a[128:131], v[208:211]
 v_mul_f32 v23, v20, v77
 v_mfma_f32_16x16x32_bf16 v[212:215], a[176:179], a[132:135], v[212:215]
 v_cvt_pk_bf16_f32 v16, v22, v23
 v_mfma_f32_16x16x32_bf16 v[216:219], a[176:179], a[136:139], v[216:219]
 v_accvgpr_read_b32 v24, a29
 v_lshlrev_b32 v25, 16, v24
 v_mfma_f32_16x16x32_bf16 v[220:223], a[176:179], a[140:143], v[220:223]
 buffer_load_dwordx4 a[176:179], v2, s[12:15], s24 offen
 v_mfma_f32_16x16x32_bf16 v[224:227], a[180:183], a[128:131], v[224:227]
 v_and_b32 v24, s26, v24
 v_mfma_f32_16x16x32_bf16 v[228:231], a[180:183], a[132:135], v[228:231]
 v_mul_f32 v26, v25, v78
 v_mfma_f32_16x16x32_bf16 v[232:235], a[180:183], a[136:139], v[232:235]
 v_mul_f32 v27, v24, v79
 v_cvt_pk_bf16_f32 v17, v26, v27
 v_mfma_f32_16x16x32_bf16 v[236:239], a[180:183], a[140:143], v[236:239]
 buffer_load_dwordx4 a[180:183], v2, s[12:15], s24 offen offset:1024
 s_waitcnt vmcnt(14)
 v_mfma_f32_16x16x32_bf16 v[240:243], a[184:187], a[128:131], v[240:243]
 v_accvgpr_read_b32 v20, a30
 v_mfma_f32_16x16x32_bf16 v[244:247], a[184:187], a[132:135], v[244:247]
 v_lshlrev_b32 v21, 16, v20
 v_mfma_f32_16x16x32_bf16 v[248:251], a[184:187], a[136:139], v[248:251]
 v_and_b32 v20, s26, v20
 v_mul_f32 v22, v21, v92
 v_mfma_f32_16x16x32_bf16 v[252:255], a[184:187], a[140:143], v[252:255]
 buffer_load_dwordx4 a[184:187], v2, s[12:15], s24 offen offset:2048
 v_mfma_f32_16x16x32_bf16 a[240:243], a[188:191], a[128:131], a[240:243]
 v_mul_f32 v23, v20, v93
 v_mfma_f32_16x16x32_bf16 a[244:247], a[188:191], a[132:135], a[244:247]
 v_cvt_pk_bf16_f32 v18, v22, v23
 v_mfma_f32_16x16x32_bf16 a[248:251], a[188:191], a[136:139], a[248:251]
 v_accvgpr_read_b32 v24, a31
 v_lshlrev_b32 v25, 16, v24
 v_mfma_f32_16x16x32_bf16 a[252:255], a[188:191], a[140:143], a[252:255]
 buffer_load_dwordx4 a[188:191], v2, s[12:15], s24 offen offset:3072
 s_add_u32 s24, s24, 32768
 s_waitcnt vmcnt(14)
 s_waitcnt lgkmcnt(0)
 v_mfma_f32_16x16x32_bf16 v[144:147], a[192:195], a[144:147], v[144:147]
 v_and_b32 v24, s26, v24
 v_mfma_f32_16x16x32_bf16 v[148:151], a[192:195], a[148:151], v[148:151]
 ds_read_b128 a[128:131], v4 offset:32768
 v_mfma_f32_16x16x32_bf16 v[152:155], a[192:195], a[152:155], v[152:155]
 v_mul_f32 v26, v25, v94
 v_mfma_f32_16x16x32_bf16 v[156:159], a[192:195], a[156:159], v[156:159]
 v_mul_f32 v27, v24, v95
 buffer_load_dwordx4 a[192:195], v1, s[12:15], s24 offen
 v_mfma_f32_16x16x32_bf16 v[160:163], a[196:199], a[144:147], v[160:163]
 v_cvt_pk_bf16_f32 v19, v26, v27
 v_mfma_f32_16x16x32_bf16 v[164:167], a[196:199], a[148:151], v[164:167]
 ds_read_b128 a[132:135], v4 offset:33792
 v_mfma_f32_16x16x32_bf16 v[168:171], a[196:199], a[152:155], v[168:171]
 ds_write_b128 v5, v[16:19] offset:7168
 v_accvgpr_read_b32 v20, a32
 v_mfma_f32_16x16x32_bf16 v[172:175], a[196:199], a[156:159], v[172:175]
 buffer_load_dwordx4 a[196:199], v1, s[12:15], s24 offen offset:1024
 s_waitcnt vmcnt(14)
 v_mfma_f32_16x16x32_bf16 v[176:179], a[200:203], a[144:147], v[176:179]
 v_lshlrev_b32 v21, 16, v20
 v_mfma_f32_16x16x32_bf16 v[180:183], a[200:203], a[148:151], v[180:183]
 ds_read_b128 a[136:139], v4 offset:34816
 v_mfma_f32_16x16x32_bf16 v[184:187], a[200:203], a[152:155], v[184:187]
 v_and_b32 v20, s26, v20
 v_mfma_f32_16x16x32_bf16 v[188:191], a[200:203], a[156:159], v[188:191]
 v_mul_f32 v22, v21, v96
 buffer_load_dwordx4 a[200:203], v1, s[12:15], s24 offen offset:2048
 v_mfma_f32_16x16x32_bf16 v[192:195], a[204:207], a[144:147], v[192:195]
 v_mul_f32 v23, v20, v97
 v_mfma_f32_16x16x32_bf16 v[196:199], a[204:207], a[148:151], v[196:199]
 ds_read_b128 a[140:143], v4 offset:35840
 v_mfma_f32_16x16x32_bf16 v[200:203], a[204:207], a[152:155], v[200:203]
 v_cvt_pk_bf16_f32 v12, v22, v23
 v_mfma_f32_16x16x32_bf16 v[204:207], a[204:207], a[156:159], v[204:207]
 buffer_load_dwordx4 a[204:207], v1, s[12:15], s24 offen offset:3072
 s_waitcnt vmcnt(14)
 v_mfma_f32_16x16x32_bf16 v[208:211], a[208:211], a[144:147], v[208:211]
 v_accvgpr_read_b32 v24, a33
 v_lshlrev_b32 v25, 16, v24
 v_mfma_f32_16x16x32_bf16 v[212:215], a[208:211], a[148:151], v[212:215]
 v_and_b32 v24, s26, v24
 v_mfma_f32_16x16x32_bf16 v[216:219], a[208:211], a[152:155], v[216:219]
 v_mul_f32 v26, v25, v98
 v_mfma_f32_16x16x32_bf16 v[220:223], a[208:211], a[156:159], v[220:223]
 v_mul_f32 v27, v24, v99
 buffer_load_dwordx4 a[208:211], v2, s[12:15], s24 offen
 v_mfma_f32_16x16x32_bf16 v[224:227], a[212:215], a[144:147], v[224:227]
 v_cvt_pk_bf16_f32 v13, v26, v27
 v_mfma_f32_16x16x32_bf16 v[228:231], a[212:215], a[148:151], v[228:231]
 v_accvgpr_read_b32 v20, a34
 v_mfma_f32_16x16x32_bf16 v[232:235], a[212:215], a[152:155], v[232:235]
 v_lshlrev_b32 v21, 16, v20
 v_mfma_f32_16x16x32_bf16 v[236:239], a[212:215], a[156:159], v[236:239]
 buffer_load_dwordx4 a[212:215], v2, s[12:15], s24 offen offset:1024
 s_waitcnt vmcnt(14)
 v_mfma_f32_16x16x32_bf16 v[240:243], a[216:219], a[144:147], v[240:243]
 v_and_b32 v20, s26, v20
 v_mul_f32 v22, v21, v112
 v_mfma_f32_16x16x32_bf16 v[244:247], a[216:219], a[148:151], v[244:247]
 v_mul_f32 v23, v20, v113
 v_mfma_f32_16x16x32_bf16 v[248:251], a[216:219], a[152:155], v[248:251]
 v_cvt_pk_bf16_f32 v14, v22, v23
 v_mfma_f32_16x16x32_bf16 v[252:255], a[216:219], a[156:159], v[252:255]
 v_accvgpr_read_b32 v24, a35
 buffer_load_dwordx4 a[216:219], v2, s[12:15], s24 offen offset:2048
 v_mfma_f32_16x16x32_bf16 a[240:243], a[220:223], a[144:147], a[240:243]
 v_lshlrev_b32 v25, 16, v24
 v_mfma_f32_16x16x32_bf16 a[244:247], a[220:223], a[148:151], a[244:247]
 v_and_b32 v24, s26, v24
 v_mfma_f32_16x16x32_bf16 a[248:251], a[220:223], a[152:155], a[248:251]
 v_mul_f32 v26, v25, v114
 v_mfma_f32_16x16x32_bf16 a[252:255], a[220:223], a[156:159], a[252:255]
 buffer_load_dwordx4 a[220:223], v2, s[12:15], s24 offen offset:3072
 s_add_u32 s24, s24, 32768
 s_waitcnt vmcnt(14)
 s_waitcnt lgkmcnt(0)
 v_mfma_f32_16x16x32_bf16 v[144:147], a[160:163], a[128:131], v[144:147]
 v_mul_f32 v27, v24, v115
 v_cvt_pk_bf16_f32 v15, v26, v27
 v_mfma_f32_16x16x32_bf16 v[148:151], a[160:163], a[132:135], v[148:151]
 ds_read_b128 a[144:147], v4 offset:36864
 v_mfma_f32_16x16x32_bf16 v[152:155], a[160:163], a[136:139], v[152:155]
 ds_write_b128 v5, v[12:15] offset:8192
 v_mfma_f32_16x16x32_bf16 v[156:159], a[160:163], a[140:143], v[156:159]
 buffer_load_dwordx4 a[160:163], v1, s[12:15], s24 offen
 v_mfma_f32_16x16x32_bf16 v[160:163], a[164:167], a[128:131], v[160:163]
 v_accvgpr_read_b32 v20, a36
 v_lshlrev_b32 v21, 16, v20
 v_mfma_f32_16x16x32_bf16 v[164:167], a[164:167], a[132:135], v[164:167]
 ds_read_b128 a[148:151], v4 offset:37888
 v_mfma_f32_16x16x32_bf16 v[168:171], a[164:167], a[136:139], v[168:171]
 v_and_b32 v20, s26, v20
 v_mfma_f32_16x16x32_bf16 v[172:175], a[164:167], a[140:143], v[172:175]
 buffer_load_dwordx4 a[164:167], v1, s[12:15], s24 offen offset:1024
 s_waitcnt vmcnt(14)
 v_mfma_f32_16x16x32_bf16 v[176:179], a[168:171], a[128:131], v[176:179]
 v_mul_f32 v22, v21, v100
 v_mul_f32 v23, v20, v101
 v_mfma_f32_16x16x32_bf16 v[180:183], a[168:171], a[132:135], v[180:183]
 ds_read_b128 a[152:155], v4 offset:38912
 v_mfma_f32_16x16x32_bf16 v[184:187], a[168:171], a[136:139], v[184:187]
 v_cvt_pk_bf16_f32 v16, v22, v23
 v_mfma_f32_16x16x32_bf16 v[188:191], a[168:171], a[140:143], v[188:191]
 buffer_load_dwordx4 a[168:171], v1, s[12:15], s24 offen offset:2048
 v_mfma_f32_16x16x32_bf16 v[192:195], a[172:175], a[128:131], v[192:195]
 v_accvgpr_read_b32 v24, a37
 v_lshlrev_b32 v25, 16, v24
 v_mfma_f32_16x16x32_bf16 v[196:199], a[172:175], a[132:135], v[196:199]
 ds_read_b128 a[156:159], v4 offset:39936
 v_mfma_f32_16x16x32_bf16 v[200:203], a[172:175], a[136:139], v[200:203]
 v_and_b32 v24, s26, v24
 v_mfma_f32_16x16x32_bf16 v[204:207], a[172:175], a[140:143], v[204:207]
 buffer_load_dwordx4 a[172:175], v1, s[12:15], s24 offen offset:3072
 s_waitcnt vmcnt(14)
 v_mfma_f32_16x16x32_bf16 v[208:211], a[176:179], a[128:131], v[208:211]
 v_mul_f32 v26, v25, v102
 v_mul_f32 v27, v24, v103
 v_mfma_f32_16x16x32_bf16 v[212:215], a[176:179], a[132:135], v[212:215]
 v_cvt_pk_bf16_f32 v17, v26, v27
 v_mfma_f32_16x16x32_bf16 v[216:219], a[176:179], a[136:139], v[216:219]
 v_accvgpr_read_b32 v20, a38
 v_mfma_f32_16x16x32_bf16 v[220:223], a[176:179], a[140:143], v[220:223]
 buffer_load_dwordx4 a[176:179], v2, s[12:15], s24 offen
 v_mfma_f32_16x16x32_bf16 v[224:227], a[180:183], a[128:131], v[224:227]
 v_lshlrev_b32 v21, 16, v20
 v_and_b32 v20, s26, v20
 v_mfma_f32_16x16x32_bf16 v[228:231], a[180:183], a[132:135], v[228:231]
 v_mul_f32 v22, v21, v116
 v_mfma_f32_16x16x32_bf16 v[232:235], a[180:183], a[136:139], v[232:235]
 v_mul_f32 v23, v20, v117
 v_mfma_f32_16x16x32_bf16 v[236:239], a[180:183], a[140:143], v[236:239]
 buffer_load_dwordx4 a[180:183], v2, s[12:15], s24 offen offset:1024
 s_waitcnt vmcnt(14)
 v_mfma_f32_16x16x32_bf16 v[240:243], a[184:187], a[128:131], v[240:243]
 v_cvt_pk_bf16_f32 v18, v22, v23
 v_mfma_f32_16x16x32_bf16 v[244:247], a[184:187], a[132:135], v[244:247]
 v_accvgpr_read_b32 v24, a39
 v_lshlrev_b32 v25, 16, v24
 v_mfma_f32_16x16x32_bf16 v[248:251], a[184:187], a[136:139], v[248:251]
 v_and_b32 v24, s26, v24
 v_mfma_f32_16x16x32_bf16 v[252:255], a[184:187], a[140:143], v[252:255]
 buffer_load_dwordx4 a[184:187], v2, s[12:15], s24 offen offset:2048
 v_mfma_f32_16x16x32_bf16 a[240:243], a[188:191], a[128:131], a[240:243]
 v_mul_f32 v26, v25, v118
 v_mul_f32 v27, v24, v119
 v_mfma_f32_16x16x32_bf16 a[244:247], a[188:191], a[132:135], a[244:247]
 v_cvt_pk_bf16_f32 v19, v26, v27
 v_mfma_f32_16x16x32_bf16 a[248:251], a[188:191], a[136:139], a[248:251]
 ds_write_b128 v5, v[16:19] offset:9216
 v_mfma_f32_16x16x32_bf16 a[252:255], a[188:191], a[140:143], a[252:255]
 buffer_load_dwordx4 a[188:191], v2, s[12:15], s24 offen offset:3072
 s_add_u32 s24, s24, 32768
 s_waitcnt vmcnt(14)
 s_waitcnt lgkmcnt(1)
 v_mfma_f32_16x16x32_bf16 v[144:147], a[192:195], a[144:147], v[144:147]
 v_accvgpr_read_b32 v20, a40
 v_mfma_f32_16x16x32_bf16 v[148:151], a[192:195], a[148:151], v[148:151]
 v_lshlrev_b32 v21, 16, v20
 ds_read_b128 a[128:131], v4 offset:40960
 v_mfma_f32_16x16x32_bf16 v[152:155], a[192:195], a[152:155], v[152:155]
 v_and_b32 v20, s26, v20
 v_mfma_f32_16x16x32_bf16 v[156:159], a[192:195], a[156:159], v[156:159]
 buffer_load_dwordx4 a[192:195], v1, s[12:15], s24 offen
 v_mfma_f32_16x16x32_bf16 v[160:163], a[196:199], a[144:147], v[160:163]
 v_mul_f32 v22, v21, v104
 v_mfma_f32_16x16x32_bf16 v[164:167], a[196:199], a[148:151], v[164:167]
 v_mul_f32 v23, v20, v105
 ds_read_b128 a[132:135], v4 offset:41984
 v_mfma_f32_16x16x32_bf16 v[168:171], a[196:199], a[152:155], v[168:171]
 v_cvt_pk_bf16_f32 v12, v22, v23
 v_mfma_f32_16x16x32_bf16 v[172:175], a[196:199], a[156:159], v[172:175]
 buffer_load_dwordx4 a[196:199], v1, s[12:15], s24 offen offset:1024
 s_waitcnt vmcnt(14)
 v_mfma_f32_16x16x32_bf16 v[176:179], a[200:203], a[144:147], v[176:179]
 v_accvgpr_read_b32 v24, a41
 v_mfma_f32_16x16x32_bf16 v[180:183], a[200:203], a[148:151], v[180:183]
 v_lshlrev_b32 v25, 16, v24
 ds_read_b128 a[136:139], v4 offset:43008
 v_mfma_f32_16x16x32_bf16 v[184:187], a[200:203], a[152:155], v[184:187]
 v_and_b32 v24, s26, v24
 v_mfma_f32_16x16x32_bf16 v[188:191], a[200:203], a[156:159], v[188:191]
 buffer_load_dwordx4 a[200:203], v1, s[12:15], s24 offen offset:2048
 v_mfma_f32_16x16x32_bf16 v[192:195], a[204:207], a[144:147], v[192:195]
 v_mul_f32 v26, v25, v106
 v_mfma_f32_16x16x32_bf16 v[196:199], a[204:207], a[148:151], v[196:199]
 v_mul_f32 v27, v24, v107
 ds_read_b128 a[140:143], v4 offset:44032
 v_mfma_f32_16x16x32_bf16 v[200:203], a[204:207], a[152:155], v[200:203]
 v_cvt_pk_bf16_f32 v13, v26, v27
 v_mfma_f32_16x16x32_bf16 v[204:207], a[204:207], a[156:159], v[204:207]
 buffer_load_dwordx4 a[204:207], v1, s[12:15], s24 offen offset:3072
 s_waitcnt vmcnt(14)
 v_mfma_f32_16x16x32_bf16 v[208:211], a[208:211], a[144:147], v[208:211]
 v_accvgpr_read_b32 v20, a42
 v_mfma_f32_16x16x32_bf16 v[212:215], a[208:211], a[148:151], v[212:215]
 v_lshlrev_b32 v21, 16, v20
 v_and_b32 v20, s26, v20
 v_mfma_f32_16x16x32_bf16 v[216:219], a[208:211], a[152:155], v[216:219]
 v_mul_f32 v22, v21, v120
 v_mfma_f32_16x16x32_bf16 v[220:223], a[208:211], a[156:159], v[220:223]
 buffer_load_dwordx4 a[208:211], v2, s[12:15], s24 offen
 v_mfma_f32_16x16x32_bf16 v[224:227], a[212:215], a[144:147], v[224:227]
 v_mul_f32 v23, v20, v121
 v_mfma_f32_16x16x32_bf16 v[228:231], a[212:215], a[148:151], v[228:231]
 v_cvt_pk_bf16_f32 v14, v22, v23
 v_accvgpr_read_b32 v24, a43
 v_mfma_f32_16x16x32_bf16 v[232:235], a[212:215], a[152:155], v[232:235]
 v_lshlrev_b32 v25, 16, v24
 v_mfma_f32_16x16x32_bf16 v[236:239], a[212:215], a[156:159], v[236:239]
 buffer_load_dwordx4 a[212:215], v2, s[12:15], s24 offen offset:1024
 s_waitcnt vmcnt(14)
 v_mfma_f32_16x16x32_bf16 v[240:243], a[216:219], a[144:147], v[240:243]
 v_and_b32 v24, s26, v24
 v_mfma_f32_16x16x32_bf16 v[244:247], a[216:219], a[148:151], v[244:247]
 v_mul_f32 v26, v25, v122
 v_mfma_f32_16x16x32_bf16 v[248:251], a[216:219], a[152:155], v[248:251]
 v_mul_f32 v27, v24, v123
 v_cvt_pk_bf16_f32 v15, v26, v27
 v_mfma_f32_16x16x32_bf16 v[252:255], a[216:219], a[156:159], v[252:255]
 buffer_load_dwordx4 a[216:219], v2, s[12:15], s24 offen offset:2048
 v_mfma_f32_16x16x32_bf16 a[240:243], a[220:223], a[144:147], a[240:243]
 ds_write_b128 v5, v[12:15] offset:10240
 v_mfma_f32_16x16x32_bf16 a[244:247], a[220:223], a[148:151], a[244:247]
 v_accvgpr_read_b32 v20, a44
 v_lshlrev_b32 v21, 16, v20
 v_mfma_f32_16x16x32_bf16 a[248:251], a[220:223], a[152:155], a[248:251]
 v_and_b32 v20, s26, v20
 v_mfma_f32_16x16x32_bf16 a[252:255], a[220:223], a[156:159], a[252:255]
 buffer_load_dwordx4 a[220:223], v2, s[12:15], s24 offen offset:3072
 s_add_u32 s24, s24, 32768
 s_waitcnt vmcnt(14)
 s_waitcnt lgkmcnt(1)
 v_mfma_f32_16x16x32_bf16 v[144:147], a[160:163], a[128:131], v[144:147]
 v_mul_f32 v22, v21, v108
 v_mfma_f32_16x16x32_bf16 v[148:151], a[160:163], a[132:135], v[148:151]
 ds_read_b128 a[144:147], v4 offset:45056
 v_mfma_f32_16x16x32_bf16 v[152:155], a[160:163], a[136:139], v[152:155]
 v_mul_f32 v23, v20, v109
 v_cvt_pk_bf16_f32 v16, v22, v23
 v_mfma_f32_16x16x32_bf16 v[156:159], a[160:163], a[140:143], v[156:159]
 buffer_load_dwordx4 a[160:163], v1, s[12:15], s24 offen
 v_mfma_f32_16x16x32_bf16 v[160:163], a[164:167], a[128:131], v[160:163]
 v_accvgpr_read_b32 v24, a45
 v_mfma_f32_16x16x32_bf16 v[164:167], a[164:167], a[132:135], v[164:167]
 ds_read_b128 a[148:151], v4 offset:46080
 v_mfma_f32_16x16x32_bf16 v[168:171], a[164:167], a[136:139], v[168:171]
 v_lshlrev_b32 v25, 16, v24
 v_and_b32 v24, s26, v24
 v_mfma_f32_16x16x32_bf16 v[172:175], a[164:167], a[140:143], v[172:175]
 buffer_load_dwordx4 a[164:167], v1, s[12:15], s24 offen offset:1024
 s_waitcnt vmcnt(14)
 v_mfma_f32_16x16x32_bf16 v[176:179], a[168:171], a[128:131], v[176:179]
 v_mul_f32 v26, v25, v110
 v_mfma_f32_16x16x32_bf16 v[180:183], a[168:171], a[132:135], v[180:183]
 ds_read_b128 a[152:155], v4 offset:47104
 v_mfma_f32_16x16x32_bf16 v[184:187], a[168:171], a[136:139], v[184:187]
 v_mul_f32 v27, v24, v111
 v_cvt_pk_bf16_f32 v17, v26, v27
 v_mfma_f32_16x16x32_bf16 v[188:191], a[168:171], a[140:143], v[188:191]
 buffer_load_dwordx4 a[168:171], v1, s[12:15], s24 offen offset:2048
 v_mfma_f32_16x16x32_bf16 v[192:195], a[172:175], a[128:131], v[192:195]
 v_accvgpr_read_b32 v20, a46
 v_mfma_f32_16x16x32_bf16 v[196:199], a[172:175], a[132:135], v[196:199]
 ds_read_b128 a[156:159], v4 offset:48128
 v_mfma_f32_16x16x32_bf16 v[200:203], a[172:175], a[136:139], v[200:203]
 v_lshlrev_b32 v21, 16, v20
 v_and_b32 v20, s26, v20
 v_mfma_f32_16x16x32_bf16 v[204:207], a[172:175], a[140:143], v[204:207]
 buffer_load_dwordx4 a[172:175], v1, s[12:15], s24 offen offset:3072
 s_waitcnt vmcnt(14)
 v_mfma_f32_16x16x32_bf16 v[208:211], a[176:179], a[128:131], v[208:211]
 v_mul_f32 v22, v21, v124
 v_mfma_f32_16x16x32_bf16 v[212:215], a[176:179], a[132:135], v[212:215]
 v_mul_f32 v23, v20, v125
 v_mfma_f32_16x16x32_bf16 v[216:219], a[176:179], a[136:139], v[216:219]
 v_cvt_pk_bf16_f32 v18, v22, v23
 v_accvgpr_read_b32 v24, a47
 v_mfma_f32_16x16x32_bf16 v[220:223], a[176:179], a[140:143], v[220:223]
 buffer_load_dwordx4 a[176:179], v2, s[12:15], s24 offen
 v_mfma_f32_16x16x32_bf16 v[224:227], a[180:183], a[128:131], v[224:227]
 v_lshlrev_b32 v25, 16, v24
 v_mfma_f32_16x16x32_bf16 v[228:231], a[180:183], a[132:135], v[228:231]
 v_and_b32 v24, s26, v24
 v_mfma_f32_16x16x32_bf16 v[232:235], a[180:183], a[136:139], v[232:235]
 v_mul_f32 v26, v25, v126
 v_mul_f32 v27, v24, v127
 v_mfma_f32_16x16x32_bf16 v[236:239], a[180:183], a[140:143], v[236:239]
 buffer_load_dwordx4 a[180:183], v2, s[12:15], s24 offen offset:1024
 s_waitcnt vmcnt(14)
 v_mfma_f32_16x16x32_bf16 v[240:243], a[184:187], a[128:131], v[240:243]
 v_cvt_pk_bf16_f32 v19, v26, v27
 v_mfma_f32_16x16x32_bf16 v[244:247], a[184:187], a[132:135], v[244:247]
 ds_write_b128 v5, v[16:19] offset:11264
 v_mfma_f32_16x16x32_bf16 v[248:251], a[184:187], a[136:139], v[248:251]
 v_accvgpr_read_b32 v20, a48
 v_mfma_f32_16x16x32_bf16 v[252:255], a[184:187], a[140:143], v[252:255]
 v_lshlrev_b32 v21, 16, v20
 buffer_load_dwordx4 a[184:187], v2, s[12:15], s24 offen offset:2048
 v_mfma_f32_16x16x32_bf16 a[240:243], a[188:191], a[128:131], a[240:243]
 v_and_b32 v20, s26, v20
 v_mfma_f32_16x16x32_bf16 a[244:247], a[188:191], a[132:135], a[244:247]
 v_mul_f32 v22, v21, v128
 v_mfma_f32_16x16x32_bf16 a[248:251], a[188:191], a[136:139], a[248:251]
 v_mul_f32 v23, v20, v129
 v_cvt_pk_bf16_f32 v12, v22, v23
 v_mfma_f32_16x16x32_bf16 a[252:255], a[188:191], a[140:143], a[252:255]
 buffer_load_dwordx4 a[188:191], v2, s[12:15], s24 offen offset:3072
 s_add_u32 s24, s24, 32768
 s_waitcnt vmcnt(14)
 s_waitcnt lgkmcnt(1)
 v_mfma_f32_16x16x32_bf16 v[144:147], a[192:195], a[144:147], v[144:147]
 v_accvgpr_read_b32 v24, a49
 v_mfma_f32_16x16x32_bf16 v[148:151], a[192:195], a[148:151], v[148:151]
 ds_read_b128 a[128:131], v4 offset:49152
 v_mfma_f32_16x16x32_bf16 v[152:155], a[192:195], a[152:155], v[152:155]
 v_lshlrev_b32 v25, 16, v24
 v_mfma_f32_16x16x32_bf16 v[156:159], a[192:195], a[156:159], v[156:159]
 v_and_b32 v24, s26, v24
 buffer_load_dwordx4 a[192:195], v1, s[12:15], s24 offen
 v_mfma_f32_16x16x32_bf16 v[160:163], a[196:199], a[144:147], v[160:163]
 v_mul_f32 v26, v25, v130
 v_mfma_f32_16x16x32_bf16 v[164:167], a[196:199], a[148:151], v[164:167]
 ds_read_b128 a[132:135], v4 offset:50176
 v_mfma_f32_16x16x32_bf16 v[168:171], a[196:199], a[152:155], v[168:171]
 v_mul_f32 v27, v24, v131
 v_mfma_f32_16x16x32_bf16 v[172:175], a[196:199], a[156:159], v[172:175]
 buffer_load_dwordx4 a[196:199], v1, s[12:15], s24 offen offset:1024
 s_waitcnt vmcnt(14)
 v_mfma_f32_16x16x32_bf16 v[176:179], a[200:203], a[144:147], v[176:179]
 v_cvt_pk_bf16_f32 v13, v26, v27
 v_accvgpr_read_b32 v20, a50
 v_mfma_f32_16x16x32_bf16 v[180:183], a[200:203], a[148:151], v[180:183]
 ds_read_b128 a[136:139], v4 offset:51200
 v_mfma_f32_16x16x32_bf16 v[184:187], a[200:203], a[152:155], v[184:187]
 v_accvgpr_read_b32 v22, a224
 v_mfma_f32_16x16x32_bf16 v[188:191], a[200:203], a[156:159], v[188:191]
 v_accvgpr_read_b32 v23, a225
 buffer_load_dwordx4 a[200:203], v1, s[12:15], s24 offen offset:2048
 v_mfma_f32_16x16x32_bf16 v[192:195], a[204:207], a[144:147], v[192:195]
 v_lshlrev_b32 v21, 16, v20
 v_mfma_f32_16x16x32_bf16 v[196:199], a[204:207], a[148:151], v[196:199]
 ds_read_b128 a[140:143], v4 offset:52224
 v_mfma_f32_16x16x32_bf16 v[200:203], a[204:207], a[152:155], v[200:203]
 v_and_b32 v20, s26, v20
 v_mfma_f32_16x16x32_bf16 v[204:207], a[204:207], a[156:159], v[204:207]
 buffer_load_dwordx4 a[204:207], v1, s[12:15], s24 offen offset:3072
 s_waitcnt vmcnt(14)
 v_mfma_f32_16x16x32_bf16 v[208:211], a[208:211], a[144:147], v[208:211]
 v_mul_f32 v22, v21, v22
 v_mul_f32 v23, v20, v23
 v_mfma_f32_16x16x32_bf16 v[212:215], a[208:211], a[148:151], v[212:215]
 v_cvt_pk_bf16_f32 v14, v22, v23
 v_mfma_f32_16x16x32_bf16 v[216:219], a[208:211], a[152:155], v[216:219]
 v_accvgpr_read_b32 v24, a51
 v_mfma_f32_16x16x32_bf16 v[220:223], a[208:211], a[156:159], v[220:223]
 v_accvgpr_read_b32 v26, a226
 buffer_load_dwordx4 a[208:211], v2, s[12:15], s24 offen
 v_mfma_f32_16x16x32_bf16 v[224:227], a[212:215], a[144:147], v[224:227]
 v_accvgpr_read_b32 v27, a227
 v_mfma_f32_16x16x32_bf16 v[228:231], a[212:215], a[148:151], v[228:231]
 v_lshlrev_b32 v25, 16, v24
 v_mfma_f32_16x16x32_bf16 v[232:235], a[212:215], a[152:155], v[232:235]
 v_and_b32 v24, s26, v24
 v_mfma_f32_16x16x32_bf16 v[236:239], a[212:215], a[156:159], v[236:239]
 buffer_load_dwordx4 a[212:215], v2, s[12:15], s24 offen offset:1024
 s_waitcnt vmcnt(14)
 v_mfma_f32_16x16x32_bf16 v[240:243], a[216:219], a[144:147], v[240:243]
 v_mul_f32 v26, v25, v26
 v_mul_f32 v27, v24, v27
 v_mfma_f32_16x16x32_bf16 v[244:247], a[216:219], a[148:151], v[244:247]
 v_cvt_pk_bf16_f32 v15, v26, v27
 v_mfma_f32_16x16x32_bf16 v[248:251], a[216:219], a[152:155], v[248:251]
 ds_write_b128 v5, v[12:15] offset:12288
 v_mfma_f32_16x16x32_bf16 v[252:255], a[216:219], a[156:159], v[252:255]
 buffer_load_dwordx4 a[216:219], v2, s[12:15], s24 offen offset:2048
 v_mfma_f32_16x16x32_bf16 a[240:243], a[220:223], a[144:147], a[240:243]
 v_accvgpr_read_b32 v20, a52
 v_lshlrev_b32 v21, 16, v20
 v_mfma_f32_16x16x32_bf16 a[244:247], a[220:223], a[148:151], a[244:247]
 v_and_b32 v20, s26, v20
 v_mfma_f32_16x16x32_bf16 a[248:251], a[220:223], a[152:155], a[248:251]
 v_mul_f32 v22, v21, v132
 v_mfma_f32_16x16x32_bf16 a[252:255], a[220:223], a[156:159], a[252:255]
 buffer_load_dwordx4 a[220:223], v2, s[12:15], s24 offen offset:3072
 s_add_u32 s24, s24, 32768
 s_waitcnt vmcnt(14)
 s_waitcnt lgkmcnt(1)
 v_mfma_f32_16x16x32_bf16 v[144:147], a[160:163], a[128:131], v[144:147]
 v_mul_f32 v23, v20, v133
 v_cvt_pk_bf16_f32 v16, v22, v23
 v_mfma_f32_16x16x32_bf16 v[148:151], a[160:163], a[132:135], v[148:151]
 ds_read_b128 a[144:147], v4 offset:53248
 v_mfma_f32_16x16x32_bf16 v[152:155], a[160:163], a[136:139], v[152:155]
 v_accvgpr_read_b32 v24, a53
 v_mfma_f32_16x16x32_bf16 v[156:159], a[160:163], a[140:143], v[156:159]
 buffer_load_dwordx4 a[160:163], v1, s[12:15], s24 offen
 v_mfma_f32_16x16x32_bf16 v[160:163], a[164:167], a[128:131], v[160:163]
 v_lshlrev_b32 v25, 16, v24
 v_and_b32 v24, s26, v24
 v_mfma_f32_16x16x32_bf16 v[164:167], a[164:167], a[132:135], v[164:167]
 ds_read_b128 a[148:151], v4 offset:54272
 v_mfma_f32_16x16x32_bf16 v[168:171], a[164:167], a[136:139], v[168:171]
 v_mul_f32 v26, v25, v134
 v_mfma_f32_16x16x32_bf16 v[172:175], a[164:167], a[140:143], v[172:175]
 buffer_load_dwordx4 a[164:167], v1, s[12:15], s24 offen offset:1024
 s_waitcnt vmcnt(14)
 v_mfma_f32_16x16x32_bf16 v[176:179], a[168:171], a[128:131], v[176:179]
 v_mul_f32 v27, v24, v135
 v_cvt_pk_bf16_f32 v17, v26, v27
 v_mfma_f32_16x16x32_bf16 v[180:183], a[168:171], a[132:135], v[180:183]
 ds_read_b128 a[152:155], v4 offset:55296
 v_mfma_f32_16x16x32_bf16 v[184:187], a[168:171], a[136:139], v[184:187]
 v_accvgpr_read_b32 v20, a54
 v_mfma_f32_16x16x32_bf16 v[188:191], a[168:171], a[140:143], v[188:191]
 buffer_load_dwordx4 a[168:171], v1, s[12:15], s24 offen offset:2048
 v_mfma_f32_16x16x32_bf16 v[192:195], a[172:175], a[128:131], v[192:195]
 v_accvgpr_read_b32 v22, a228
 v_accvgpr_read_b32 v23, a229
 v_mfma_f32_16x16x32_bf16 v[196:199], a[172:175], a[132:135], v[196:199]
 ds_read_b128 a[156:159], v4 offset:56320
 v_mfma_f32_16x16x32_bf16 v[200:203], a[172:175], a[136:139], v[200:203]
 v_lshlrev_b32 v21, 16, v20
 v_mfma_f32_16x16x32_bf16 v[204:207], a[172:175], a[140:143], v[204:207]
 buffer_load_dwordx4 a[172:175], v1, s[12:15], s24 offen offset:3072
 s_waitcnt vmcnt(14)
 v_mfma_f32_16x16x32_bf16 v[208:211], a[176:179], a[128:131], v[208:211]
 v_and_b32 v20, s26, v20
 v_mfma_f32_16x16x32_bf16 v[212:215], a[176:179], a[132:135], v[212:215]
 v_mul_f32 v22, v21, v22
 v_mul_f32 v23, v20, v23
 v_mfma_f32_16x16x32_bf16 v[216:219], a[176:179], a[136:139], v[216:219]
 v_cvt_pk_bf16_f32 v18, v22, v23
 v_mfma_f32_16x16x32_bf16 v[220:223], a[176:179], a[140:143], v[220:223]
 buffer_load_dwordx4 a[176:179], v2, s[12:15], s24 offen
 v_mfma_f32_16x16x32_bf16 v[224:227], a[180:183], a[128:131], v[224:227]
 v_accvgpr_read_b32 v24, a55
 v_accvgpr_read_b32 v26, a230
 v_mfma_f32_16x16x32_bf16 v[228:231], a[180:183], a[132:135], v[228:231]
 v_accvgpr_read_b32 v27, a231
 v_mfma_f32_16x16x32_bf16 v[232:235], a[180:183], a[136:139], v[232:235]
 v_lshlrev_b32 v25, 16, v24
 v_mfma_f32_16x16x32_bf16 v[236:239], a[180:183], a[140:143], v[236:239]
 buffer_load_dwordx4 a[180:183], v2, s[12:15], s24 offen offset:1024
 s_waitcnt vmcnt(14)
 v_mfma_f32_16x16x32_bf16 v[240:243], a[184:187], a[128:131], v[240:243]
 v_and_b32 v24, s26, v24
 v_mfma_f32_16x16x32_bf16 v[244:247], a[184:187], a[132:135], v[244:247]
 v_mul_f32 v26, v25, v26
 v_mul_f32 v27, v24, v27
 v_mfma_f32_16x16x32_bf16 v[248:251], a[184:187], a[136:139], v[248:251]
 v_cvt_pk_bf16_f32 v19, v26, v27
 v_mfma_f32_16x16x32_bf16 v[252:255], a[184:187], a[140:143], v[252:255]
 buffer_load_dwordx4 a[184:187], v2, s[12:15], s24 offen offset:2048
 v_mfma_f32_16x16x32_bf16 a[240:243], a[188:191], a[128:131], a[240:243]
 ds_write_b128 v5, v[16:19] offset:13312
 v_mfma_f32_16x16x32_bf16 a[244:247], a[188:191], a[132:135], a[244:247]
 v_accvgpr_read_b32 v20, a56
 v_lshlrev_b32 v21, 16, v20
 v_mfma_f32_16x16x32_bf16 a[248:251], a[188:191], a[136:139], a[248:251]
 v_and_b32 v20, s26, v20
 v_mfma_f32_16x16x32_bf16 a[252:255], a[188:191], a[140:143], a[252:255]
 buffer_load_dwordx4 a[188:191], v2, s[12:15], s24 offen offset:3072
 s_add_u32 s24, s24, 32768
 s_waitcnt vmcnt(14)
 s_waitcnt lgkmcnt(1)
 v_mfma_f32_16x16x32_bf16 v[144:147], a[192:195], a[144:147], v[144:147]
 v_mul_f32 v22, v21, v136
 v_mfma_f32_16x16x32_bf16 v[148:151], a[192:195], a[148:151], v[148:151]
 v_mul_f32 v23, v20, v137
 ds_read_b128 a[128:131], v4 offset:57344
 v_mfma_f32_16x16x32_bf16 v[152:155], a[192:195], a[152:155], v[152:155]
 v_cvt_pk_bf16_f32 v12, v22, v23
 v_mfma_f32_16x16x32_bf16 v[156:159], a[192:195], a[156:159], v[156:159]
 buffer_load_dwordx4 a[192:195], v1, s[12:15], s24 offen
 v_mfma_f32_16x16x32_bf16 v[160:163], a[196:199], a[144:147], v[160:163]
 v_accvgpr_read_b32 v24, a57
 v_mfma_f32_16x16x32_bf16 v[164:167], a[196:199], a[148:151], v[164:167]
 v_lshlrev_b32 v25, 16, v24
 ds_read_b128 a[132:135], v4 offset:58368
 v_mfma_f32_16x16x32_bf16 v[168:171], a[196:199], a[152:155], v[168:171]
 v_and_b32 v24, s26, v24
 v_mfma_f32_16x16x32_bf16 v[172:175], a[196:199], a[156:159], v[172:175]
 buffer_load_dwordx4 a[196:199], v1, s[12:15], s24 offen offset:1024
 s_waitcnt vmcnt(14)
 v_mfma_f32_16x16x32_bf16 v[176:179], a[200:203], a[144:147], v[176:179]
 v_mul_f32 v26, v25, v138
 v_mfma_f32_16x16x32_bf16 v[180:183], a[200:203], a[148:151], v[180:183]
 v_mul_f32 v27, v24, v139
 ds_read_b128 a[136:139], v4 offset:59392
 v_mfma_f32_16x16x32_bf16 v[184:187], a[200:203], a[152:155], v[184:187]
 v_cvt_pk_bf16_f32 v13, v26, v27
 v_mfma_f32_16x16x32_bf16 v[188:191], a[200:203], a[156:159], v[188:191]
 buffer_load_dwordx4 a[200:203], v1, s[12:15], s24 offen offset:2048
 v_mfma_f32_16x16x32_bf16 v[192:195], a[204:207], a[144:147], v[192:195]
 v_accvgpr_read_b32 v20, a58
 v_mfma_f32_16x16x32_bf16 v[196:199], a[204:207], a[148:151], v[196:199]
 v_accvgpr_read_b32 v22, a232
 ds_read_b128 a[140:143], v4 offset:60416
 v_mfma_f32_16x16x32_bf16 v[200:203], a[204:207], a[152:155], v[200:203]
 v_accvgpr_read_b32 v23, a233
 v_mfma_f32_16x16x32_bf16 v[204:207], a[204:207], a[156:159], v[204:207]
 buffer_load_dwordx4 a[204:207], v1, s[12:15], s24 offen offset:3072
 s_waitcnt vmcnt(14)
 v_mfma_f32_16x16x32_bf16 v[208:211], a[208:211], a[144:147], v[208:211]
 v_lshlrev_b32 v21, 16, v20
 v_mfma_f32_16x16x32_bf16 v[212:215], a[208:211], a[148:151], v[212:215]
 v_and_b32 v20, s26, v20
 v_mfma_f32_16x16x32_bf16 v[216:219], a[208:211], a[152:155], v[216:219]
 v_mul_f32 v22, v21, v22
 v_mul_f32 v23, v20, v23
 v_mfma_f32_16x16x32_bf16 v[220:223], a[208:211], a[156:159], v[220:223]
 buffer_load_dwordx4 a[208:211], v2, s[12:15], s24 offen
 v_mfma_f32_16x16x32_bf16 v[224:227], a[212:215], a[144:147], v[224:227]
 v_cvt_pk_bf16_f32 v14, v22, v23
 v_mfma_f32_16x16x32_bf16 v[228:231], a[212:215], a[148:151], v[228:231]
 v_accvgpr_read_b32 v24, a59
 v_accvgpr_read_b32 v26, a234
 v_mfma_f32_16x16x32_bf16 v[232:235], a[212:215], a[152:155], v[232:235]
 v_accvgpr_read_b32 v27, a235
 v_mfma_f32_16x16x32_bf16 v[236:239], a[212:215], a[156:159], v[236:239]
 buffer_load_dwordx4 a[212:215], v2, s[12:15], s24 offen offset:1024
 s_waitcnt vmcnt(14)
 v_mfma_f32_16x16x32_bf16 v[240:243], a[216:219], a[144:147], v[240:243]
 v_lshlrev_b32 v25, 16, v24
 v_mfma_f32_16x16x32_bf16 v[244:247], a[216:219], a[148:151], v[244:247]
 v_and_b32 v24, s26, v24
 v_mfma_f32_16x16x32_bf16 v[248:251], a[216:219], a[152:155], v[248:251]
 v_mul_f32 v26, v25, v26
 v_mul_f32 v27, v24, v27
 v_mfma_f32_16x16x32_bf16 v[252:255], a[216:219], a[156:159], v[252:255]
 buffer_load_dwordx4 a[216:219], v2, s[12:15], s24 offen offset:2048
 v_mfma_f32_16x16x32_bf16 a[240:243], a[220:223], a[144:147], a[240:243]
 v_cvt_pk_bf16_f32 v15, v26, v27
 v_mfma_f32_16x16x32_bf16 a[244:247], a[220:223], a[148:151], a[244:247]
 ds_write_b128 v5, v[12:15] offset:14336
 v_mfma_f32_16x16x32_bf16 a[248:251], a[220:223], a[152:155], a[248:251]
 v_accvgpr_read_b32 v20, a60
 v_lshlrev_b32 v21, 16, v20
 v_mfma_f32_16x16x32_bf16 a[252:255], a[220:223], a[156:159], a[252:255]
 buffer_load_dwordx4 a[220:223], v2, s[12:15], s24 offen offset:3072
 s_add_u32 s24, s24, 32768
 s_waitcnt vmcnt(14)
 s_waitcnt lgkmcnt(1)
 v_mfma_f32_16x16x32_bf16 v[144:147], a[160:163], a[128:131], v[144:147]
 v_and_b32 v20, s26, v20
 v_mfma_f32_16x16x32_bf16 v[148:151], a[160:163], a[132:135], v[148:151]
 ds_read_b128 a[144:147], v4 offset:61440
 v_mfma_f32_16x16x32_bf16 v[152:155], a[160:163], a[136:139], v[152:155]
 v_mul_f32 v22, v21, v140
 v_mul_f32 v23, v20, v141
 v_mfma_f32_16x16x32_bf16 v[156:159], a[160:163], a[140:143], v[156:159]
 buffer_load_dwordx4 a[160:163], v1, s[12:15], s24 offen
 v_mfma_f32_16x16x32_bf16 v[160:163], a[164:167], a[128:131], v[160:163]
 v_cvt_pk_bf16_f32 v16, v22, v23
 v_mfma_f32_16x16x32_bf16 v[164:167], a[164:167], a[132:135], v[164:167]
 ds_read_b128 a[148:151], v4 offset:62464
 v_mfma_f32_16x16x32_bf16 v[168:171], a[164:167], a[136:139], v[168:171]
 v_accvgpr_read_b32 v24, a61
 v_lshlrev_b32 v25, 16, v24
 v_mfma_f32_16x16x32_bf16 v[172:175], a[164:167], a[140:143], v[172:175]
 buffer_load_dwordx4 a[164:167], v1, s[12:15], s24 offen offset:1024
 s_waitcnt vmcnt(14)
 v_mfma_f32_16x16x32_bf16 v[176:179], a[168:171], a[128:131], v[176:179]
 v_and_b32 v24, s26, v24
 v_mfma_f32_16x16x32_bf16 v[180:183], a[168:171], a[132:135], v[180:183]
 ds_read_b128 a[152:155], v4 offset:63488
 v_mfma_f32_16x16x32_bf16 v[184:187], a[168:171], a[136:139], v[184:187]
 v_mul_f32 v26, v25, v142
 v_mul_f32 v27, v24, v143
 v_mfma_f32_16x16x32_bf16 v[188:191], a[168:171], a[140:143], v[188:191]
 buffer_load_dwordx4 a[168:171], v1, s[12:15], s24 offen offset:2048
 v_mfma_f32_16x16x32_bf16 v[192:195], a[172:175], a[128:131], v[192:195]
 v_cvt_pk_bf16_f32 v17, v26, v27
 v_mfma_f32_16x16x32_bf16 v[196:199], a[172:175], a[132:135], v[196:199]
 ds_read_b128 a[156:159], v4 offset:64512
 v_mfma_f32_16x16x32_bf16 v[200:203], a[172:175], a[136:139], v[200:203]
 v_accvgpr_read_b32 v20, a62
 v_accvgpr_read_b32 v22, a236
 v_mfma_f32_16x16x32_bf16 v[204:207], a[172:175], a[140:143], v[204:207]
 buffer_load_dwordx4 a[172:175], v1, s[12:15], s24 offen offset:3072
 s_waitcnt vmcnt(14)
 v_mfma_f32_16x16x32_bf16 v[208:211], a[176:179], a[128:131], v[208:211]
 v_accvgpr_read_b32 v23, a237
 v_mfma_f32_16x16x32_bf16 v[212:215], a[176:179], a[132:135], v[212:215]
 v_lshlrev_b32 v21, 16, v20
 v_mfma_f32_16x16x32_bf16 v[216:219], a[176:179], a[136:139], v[216:219]
 v_and_b32 v20, s26, v20
 v_mfma_f32_16x16x32_bf16 v[220:223], a[176:179], a[140:143], v[220:223]
 v_mul_f32 v22, v21, v22
 buffer_load_dwordx4 a[176:179], v2, s[12:15], s24 offen
 v_mfma_f32_16x16x32_bf16 v[224:227], a[180:183], a[128:131], v[224:227]
 v_mul_f32 v23, v20, v23
 v_mfma_f32_16x16x32_bf16 v[228:231], a[180:183], a[132:135], v[228:231]
 v_cvt_pk_bf16_f32 v18, v22, v23
 v_mfma_f32_16x16x32_bf16 v[232:235], a[180:183], a[136:139], v[232:235]
 v_accvgpr_read_b32 v24, a63
 v_accvgpr_read_b32 v26, a238
 v_mfma_f32_16x16x32_bf16 v[236:239], a[180:183], a[140:143], v[236:239]
 buffer_load_dwordx4 a[180:183], v2, s[12:15], s24 offen offset:1024
 s_waitcnt vmcnt(14)
 v_mfma_f32_16x16x32_bf16 v[240:243], a[184:187], a[128:131], v[240:243]
 v_accvgpr_read_b32 v27, a239
 v_mfma_f32_16x16x32_bf16 v[244:247], a[184:187], a[132:135], v[244:247]
 v_lshlrev_b32 v25, 16, v24
 v_mfma_f32_16x16x32_bf16 v[248:251], a[184:187], a[136:139], v[248:251]
 v_and_b32 v24, s26, v24
 v_mfma_f32_16x16x32_bf16 v[252:255], a[184:187], a[140:143], v[252:255]
 v_mul_f32 v26, v25, v26
 buffer_load_dwordx4 a[184:187], v2, s[12:15], s24 offen offset:2048
 v_mfma_f32_16x16x32_bf16 a[240:243], a[188:191], a[128:131], a[240:243]
 v_mul_f32 v27, v24, v27
 v_mfma_f32_16x16x32_bf16 a[244:247], a[188:191], a[132:135], a[244:247]
 v_cvt_pk_bf16_f32 v19, v26, v27
 v_mfma_f32_16x16x32_bf16 a[248:251], a[188:191], a[136:139], a[248:251]
 ds_write_b128 v5, v[16:19] offset:15360
 v_mfma_f32_16x16x32_bf16 a[252:255], a[188:191], a[140:143], a[252:255]
 buffer_load_dwordx4 a[188:191], v2, s[12:15], s24 offen offset:3072
 s_add_u32 s24, s24, 32768
 s_waitcnt vmcnt(14)
 s_waitcnt lgkmcnt(0)
 s_barrier
 v_mfma_f32_16x16x32_bf16 v[144:147], a[192:195], a[144:147], v[144:147]
 v_mfma_f32_16x16x32_bf16 v[148:151], a[192:195], a[148:151], v[148:151]
 ds_read_b128 a[128:131], v3
 v_mfma_f32_16x16x32_bf16 v[152:155], a[192:195], a[152:155], v[152:155]
 v_mfma_f32_16x16x32_bf16 v[156:159], a[192:195], a[156:159], v[156:159]
 buffer_load_dwordx4 a[192:195], v1, s[12:15], s24 offen
 v_mfma_f32_16x16x32_bf16 v[160:163], a[196:199], a[144:147], v[160:163]
 v_mfma_f32_16x16x32_bf16 v[164:167], a[196:199], a[148:151], v[164:167]
 ds_read_b128 a[132:135], v3 offset:1024
 v_mfma_f32_16x16x32_bf16 v[168:171], a[196:199], a[152:155], v[168:171]
 v_mfma_f32_16x16x32_bf16 v[172:175], a[196:199], a[156:159], v[172:175]
 buffer_load_dwordx4 a[196:199], v1, s[12:15], s24 offen offset:1024
 s_waitcnt vmcnt(14)
 v_mfma_f32_16x16x32_bf16 v[176:179], a[200:203], a[144:147], v[176:179]
 v_mfma_f32_16x16x32_bf16 v[180:183], a[200:203], a[148:151], v[180:183]
 ds_read_b128 a[136:139], v3 offset:2048
 v_mfma_f32_16x16x32_bf16 v[184:187], a[200:203], a[152:155], v[184:187]
 v_mfma_f32_16x16x32_bf16 v[188:191], a[200:203], a[156:159], v[188:191]
 buffer_load_dwordx4 a[200:203], v1, s[12:15], s24 offen offset:2048
 v_mfma_f32_16x16x32_bf16 v[192:195], a[204:207], a[144:147], v[192:195]
 v_mfma_f32_16x16x32_bf16 v[196:199], a[204:207], a[148:151], v[196:199]
 ds_read_b128 a[140:143], v3 offset:3072
 v_mfma_f32_16x16x32_bf16 v[200:203], a[204:207], a[152:155], v[200:203]
 v_mfma_f32_16x16x32_bf16 v[204:207], a[204:207], a[156:159], v[204:207]
 buffer_load_dwordx4 a[204:207], v1, s[12:15], s24 offen offset:3072
 s_waitcnt vmcnt(14)
 v_mfma_f32_16x16x32_bf16 v[208:211], a[208:211], a[144:147], v[208:211]
 v_mfma_f32_16x16x32_bf16 v[212:215], a[208:211], a[148:151], v[212:215]
 v_mfma_f32_16x16x32_bf16 v[216:219], a[208:211], a[152:155], v[216:219]
 v_mfma_f32_16x16x32_bf16 v[220:223], a[208:211], a[156:159], v[220:223]
 buffer_load_dwordx4 a[208:211], v2, s[12:15], s24 offen
 v_mfma_f32_16x16x32_bf16 v[224:227], a[212:215], a[144:147], v[224:227]
 v_mfma_f32_16x16x32_bf16 v[228:231], a[212:215], a[148:151], v[228:231]
 v_mfma_f32_16x16x32_bf16 v[232:235], a[212:215], a[152:155], v[232:235]
 v_mfma_f32_16x16x32_bf16 v[236:239], a[212:215], a[156:159], v[236:239]
 buffer_load_dwordx4 a[212:215], v2, s[12:15], s24 offen offset:1024
 s_waitcnt vmcnt(14)
 v_mfma_f32_16x16x32_bf16 v[240:243], a[216:219], a[144:147], v[240:243]
 v_mfma_f32_16x16x32_bf16 v[244:247], a[216:219], a[148:151], v[244:247]
 v_mfma_f32_16x16x32_bf16 v[248:251], a[216:219], a[152:155], v[248:251]
 v_mfma_f32_16x16x32_bf16 v[252:255], a[216:219], a[156:159], v[252:255]
 buffer_load_dwordx4 a[216:219], v2, s[12:15], s24 offen offset:2048
 v_mfma_f32_16x16x32_bf16 a[240:243], a[220:223], a[144:147], a[240:243]
 v_mfma_f32_16x16x32_bf16 a[244:247], a[220:223], a[148:151], a[244:247]
 v_mfma_f32_16x16x32_bf16 a[248:251], a[220:223], a[152:155], a[248:251]
 v_mfma_f32_16x16x32_bf16 a[252:255], a[220:223], a[156:159], a[252:255]
 buffer_load_dwordx4 a[220:223], v2, s[12:15], s24 offen offset:3072
 s_add_u32 s24, s24, 32768
 s_waitcnt vmcnt(14)
 s_waitcnt lgkmcnt(0)
 v_mfma_f32_16x16x32_bf16 v[32:35], a[160:163], a[128:131], v[32:35]
 v_accvgpr_read_b32 v20, a64
 v_lshlrev_b32 v21, 16, v20
 v_mfma_f32_16x16x32_bf16 v[36:39], a[160:163], a[132:135], v[36:39]
 ds_read_b128 a[144:147], v3 offset:4096
 v_mfma_f32_16x16x32_bf16 v[40:43], a[160:163], a[136:139], v[40:43]
 v_and_b32 v20, s26, v20
 v_mfma_f32_16x16x32_bf16 v[44:47], a[160:163], a[140:143], v[44:47]
 v_mul_f32 v22, v21, v144
 buffer_load_dwordx4 a[160:163], v1, s[12:15], s24 offen
 v_mfma_f32_16x16x32_bf16 v[48:51], a[164:167], a[128:131], v[48:51]
 v_mul_f32 v23, v20, v145
 v_mfma_f32_16x16x32_bf16 v[52:55], a[164:167], a[132:135], v[52:55]
 ds_read_b128 a[148:151], v3 offset:5120
 v_mfma_f32_16x16x32_bf16 v[56:59], a[164:167], a[136:139], v[56:59]
 v_cvt_pk_bf16_f32 v12, v22, v23
 v_mfma_f32_16x16x32_bf16 v[60:63], a[164:167], a[140:143], v[60:63]
 buffer_load_dwordx4 a[164:167], v1, s[12:15], s24 offen offset:1024
 s_waitcnt vmcnt(14)
 v_mfma_f32_16x16x32_bf16 v[64:67], a[168:171], a[128:131], v[64:67]
 v_accvgpr_read_b32 v24, a65
 v_lshlrev_b32 v25, 16, v24
 v_mfma_f32_16x16x32_bf16 v[68:71], a[168:171], a[132:135], v[68:71]
 ds_read_b128 a[152:155], v3 offset:6144
 v_mfma_f32_16x16x32_bf16 v[72:75], a[168:171], a[136:139], v[72:75]
 v_and_b32 v24, s26, v24
 v_mfma_f32_16x16x32_bf16 v[76:79], a[168:171], a[140:143], v[76:79]
 v_mul_f32 v26, v25, v146
 buffer_load_dwordx4 a[168:171], v1, s[12:15], s24 offen offset:2048
 v_mfma_f32_16x16x32_bf16 v[80:83], a[172:175], a[128:131], v[80:83]
 v_mul_f32 v27, v24, v147
 v_mfma_f32_16x16x32_bf16 v[84:87], a[172:175], a[132:135], v[84:87]
 ds_read_b128 a[156:159], v3 offset:7168
 v_mfma_f32_16x16x32_bf16 v[88:91], a[172:175], a[136:139], v[88:91]
 v_cvt_pk_bf16_f32 v13, v26, v27
 v_mfma_f32_16x16x32_bf16 v[92:95], a[172:175], a[140:143], v[92:95]
 buffer_load_dwordx4 a[172:175], v1, s[12:15], s24 offen offset:3072
 s_waitcnt vmcnt(14)
 v_mfma_f32_16x16x32_bf16 v[96:99], a[176:179], a[128:131], v[96:99]
 v_accvgpr_read_b32 v20, a66
 v_lshlrev_b32 v21, 16, v20
 v_mfma_f32_16x16x32_bf16 v[100:103], a[176:179], a[132:135], v[100:103]
 v_and_b32 v20, s26, v20
 v_mfma_f32_16x16x32_bf16 v[104:107], a[176:179], a[136:139], v[104:107]
 v_mul_f32 v22, v21, v160
 v_mfma_f32_16x16x32_bf16 v[108:111], a[176:179], a[140:143], v[108:111]
 buffer_load_dwordx4 a[176:179], v2, s[12:15], s24 offen
 v_mfma_f32_16x16x32_bf16 v[112:115], a[180:183], a[128:131], v[112:115]
 v_mul_f32 v23, v20, v161
 v_cvt_pk_bf16_f32 v14, v22, v23
 v_mfma_f32_16x16x32_bf16 v[116:119], a[180:183], a[132:135], v[116:119]
 v_accvgpr_read_b32 v24, a67
 v_mfma_f32_16x16x32_bf16 v[120:123], a[180:183], a[136:139], v[120:123]
 v_lshlrev_b32 v25, 16, v24
 v_mfma_f32_16x16x32_bf16 v[124:127], a[180:183], a[140:143], v[124:127]
 buffer_load_dwordx4 a[180:183], v2, s[12:15], s24 offen offset:1024
 s_waitcnt vmcnt(14)
 v_mfma_f32_16x16x32_bf16 v[128:131], a[184:187], a[128:131], v[128:131]
 v_and_b32 v24, s26, v24
 v_mul_f32 v26, v25, v162
 v_mfma_f32_16x16x32_bf16 v[132:135], a[184:187], a[132:135], v[132:135]
 v_mul_f32 v27, v24, v163
 v_mfma_f32_16x16x32_bf16 v[136:139], a[184:187], a[136:139], v[136:139]
 v_cvt_pk_bf16_f32 v15, v26, v27
 v_mfma_f32_16x16x32_bf16 v[140:143], a[184:187], a[140:143], v[140:143]
 buffer_load_dwordx4 a[184:187], v2, s[12:15], s24 offen offset:2048
 v_mfma_f32_16x16x32_bf16 a[224:227], a[188:191], a[128:131], a[224:227]
 ds_write_b128 v6, v[12:15]
 v_accvgpr_read_b32 v20, a68
 v_mfma_f32_16x16x32_bf16 a[228:231], a[188:191], a[132:135], a[228:231]
 v_lshlrev_b32 v21, 16, v20
 v_mfma_f32_16x16x32_bf16 a[232:235], a[188:191], a[136:139], a[232:235]
 v_and_b32 v20, s26, v20
 v_mfma_f32_16x16x32_bf16 a[236:239], a[188:191], a[140:143], a[236:239]
 buffer_load_dwordx4 a[188:191], v2, s[12:15], s24 offen offset:3072
 s_add_u32 s24, s24, 32768
 s_waitcnt vmcnt(14)
 s_waitcnt lgkmcnt(1)
 v_mfma_f32_16x16x32_bf16 v[32:35], a[192:195], a[144:147], v[32:35]
 v_mul_f32 v22, v21, v148
 v_mul_f32 v23, v20, v149
 v_mfma_f32_16x16x32_bf16 v[36:39], a[192:195], a[148:151], v[36:39]
 ds_read_b128 a[128:131], v3 offset:8192
 v_mfma_f32_16x16x32_bf16 v[40:43], a[192:195], a[152:155], v[40:43]
 v_cvt_pk_bf16_f32 v16, v22, v23
 v_mfma_f32_16x16x32_bf16 v[44:47], a[192:195], a[156:159], v[44:47]
 buffer_load_dwordx4 a[192:195], v1, s[12:15], s24 offen
 v_mfma_f32_16x16x32_bf16 v[48:51], a[196:199], a[144:147], v[48:51]
 v_accvgpr_read_b32 v24, a69
 v_lshlrev_b32 v25, 16, v24
 v_mfma_f32_16x16x32_bf16 v[52:55], a[196:199], a[148:151], v[52:55]
 ds_read_b128 a[132:135], v3 offset:9216
 v_mfma_f32_16x16x32_bf16 v[56:59], a[196:199], a[152:155], v[56:59]
 v_and_b32 v24, s26, v24
 v_mfma_f32_16x16x32_bf16 v[60:63], a[196:199], a[156:159], v[60:63]
 buffer_load_dwordx4 a[196:199], v1, s[12:15], s24 offen offset:1024
 s_waitcnt vmcnt(14)
 v_mfma_f32_16x16x32_bf16 v[64:67], a[200:203], a[144:147], v[64:67]
 v_mul_f32 v26, v25, v150
 v_mfma_f32_16x16x32_bf16 v[68:71], a[200:203], a[148:151], v[68:71]
 v_mul_f32 v27, v24, v151
 ds_read_b128 a[136:139], v3 offset:10240
 v_mfma_f32_16x16x32_bf16 v[72:75], a[200:203], a[152:155], v[72:75]
 v_cvt_pk_bf16_f32 v17, v26, v27
 v_mfma_f32_16x16x32_bf16 v[76:79], a[200:203], a[156:159], v[76:79]
 buffer_load_dwordx4 a[200:203], v1, s[12:15], s24 offen offset:2048
 v_mfma_f32_16x16x32_bf16 v[80:83], a[204:207], a[144:147], v[80:83]
 v_accvgpr_read_b32 v20, a70
 v_lshlrev_b32 v21, 16, v20
 v_mfma_f32_16x16x32_bf16 v[84:87], a[204:207], a[148:151], v[84:87]
 ds_read_b128 a[140:143], v3 offset:11264
 v_mfma_f32_16x16x32_bf16 v[88:91], a[204:207], a[152:155], v[88:91]
 v_and_b32 v20, s26, v20
 v_mfma_f32_16x16x32_bf16 v[92:95], a[204:207], a[156:159], v[92:95]
 buffer_load_dwordx4 a[204:207], v1, s[12:15], s24 offen offset:3072
 s_waitcnt vmcnt(14)
 v_mfma_f32_16x16x32_bf16 v[96:99], a[208:211], a[144:147], v[96:99]
 v_mul_f32 v22, v21, v164
 v_mfma_f32_16x16x32_bf16 v[100:103], a[208:211], a[148:151], v[100:103]
 v_mul_f32 v23, v20, v165
 v_cvt_pk_bf16_f32 v18, v22, v23
 v_mfma_f32_16x16x32_bf16 v[104:107], a[208:211], a[152:155], v[104:107]
 v_accvgpr_read_b32 v24, a71
 v_mfma_f32_16x16x32_bf16 v[108:111], a[208:211], a[156:159], v[108:111]
 buffer_load_dwordx4 a[208:211], v2, s[12:15], s24 offen
 v_mfma_f32_16x16x32_bf16 v[112:115], a[212:215], a[144:147], v[112:115]
 v_lshlrev_b32 v25, 16, v24
 v_mfma_f32_16x16x32_bf16 v[116:119], a[212:215], a[148:151], v[116:119]
 v_and_b32 v24, s26, v24
 v_mul_f32 v26, v25, v166
 v_mfma_f32_16x16x32_bf16 v[120:123], a[212:215], a[152:155], v[120:123]
 v_mul_f32 v27, v24, v167
 v_mfma_f32_16x16x32_bf16 v[124:127], a[212:215], a[156:159], v[124:127]
 buffer_load_dwordx4 a[212:215], v2, s[12:15], s24 offen offset:1024
 s_waitcnt vmcnt(14)
 v_mfma_f32_16x16x32_bf16 v[128:131], a[216:219], a[144:147], v[128:131]
 v_cvt_pk_bf16_f32 v19, v26, v27
 v_mfma_f32_16x16x32_bf16 v[132:135], a[216:219], a[148:151], v[132:135]
 ds_write_b128 v6, v[16:19] offset:1024
 v_accvgpr_read_b32 v20, a72
 v_mfma_f32_16x16x32_bf16 v[136:139], a[216:219], a[152:155], v[136:139]
 v_lshlrev_b32 v21, 16, v20
 v_mfma_f32_16x16x32_bf16 v[140:143], a[216:219], a[156:159], v[140:143]
 buffer_load_dwordx4 a[216:219], v2, s[12:15], s24 offen offset:2048
 v_mfma_f32_16x16x32_bf16 a[224:227], a[220:223], a[144:147], a[224:227]
 v_and_b32 v20, s26, v20
 v_mfma_f32_16x16x32_bf16 a[228:231], a[220:223], a[148:151], a[228:231]
 v_mul_f32 v22, v21, v152
 v_mul_f32 v23, v20, v153
 v_mfma_f32_16x16x32_bf16 a[232:235], a[220:223], a[152:155], a[232:235]
 v_cvt_pk_bf16_f32 v12, v22, v23
 v_mfma_f32_16x16x32_bf16 a[236:239], a[220:223], a[156:159], a[236:239]
 buffer_load_dwordx4 a[220:223], v2, s[12:15], s24 offen offset:3072
 s_add_u32 s24, s24, 32768
 s_waitcnt vmcnt(14)
 s_waitcnt lgkmcnt(1)
 v_mfma_f32_16x16x32_bf16 v[32:35], a[160:163], a[128:131], v[32:35]
 v_accvgpr_read_b32 v24, a73
 v_mfma_f32_16x16x32_bf16 v[36:39], a[160:163], a[132:135], v[36:39]
 v_lshlrev_b32 v25, 16, v24
 ds_read_b128 a[144:147], v3 offset:12288
 v_mfma_f32_16x16x32_bf16 v[40:43], a[160:163], a[136:139], v[40:43]
 v_and_b32 v24, s26, v24
 v_mfma_f32_16x16x32_bf16 v[44:47], a[160:163], a[140:143], v[44:47]
 buffer_load_dwordx4 a[160:163], v1, s[12:15], s24 offen
 v_mfma_f32_16x16x32_bf16 v[48:51], a[164:167], a[128:131], v[48:51]
 v_mul_f32 v26, v25, v154
 v_mfma_f32_16x16x32_bf16 v[52:55], a[164:167], a[132:135], v[52:55]
 v_mul_f32 v27, v24, v155
 ds_read_b128 a[148:151], v3 offset:13312
 v_mfma_f32_16x16x32_bf16 v[56:59], a[164:167], a[136:139], v[56:59]
 v_cvt_pk_bf16_f32 v13, v26, v27
 v_mfma_f32_16x16x32_bf16 v[60:63], a[164:167], a[140:143], v[60:63]
 buffer_load_dwordx4 a[164:167], v1, s[12:15], s24 offen offset:1024
 s_waitcnt vmcnt(14)
 v_mfma_f32_16x16x32_bf16 v[64:67], a[168:171], a[128:131], v[64:67]
 v_accvgpr_read_b32 v20, a74
 v_mfma_f32_16x16x32_bf16 v[68:71], a[168:171], a[132:135], v[68:71]
 ds_read_b128 a[152:155], v3 offset:14336
 v_mfma_f32_16x16x32_bf16 v[72:75], a[168:171], a[136:139], v[72:75]
 v_lshlrev_b32 v21, 16, v20
 v_and_b32 v20, s26, v20
 v_mfma_f32_16x16x32_bf16 v[76:79], a[168:171], a[140:143], v[76:79]
 buffer_load_dwordx4 a[168:171], v1, s[12:15], s24 offen offset:2048
 v_mfma_f32_16x16x32_bf16 v[80:83], a[172:175], a[128:131], v[80:83]
 v_mul_f32 v22, v21, v168
 v_mfma_f32_16x16x32_bf16 v[84:87], a[172:175], a[132:135], v[84:87]
 v_mul_f32 v23, v20, v169
 ds_read_b128 a[156:159], v3 offset:15360
 v_mfma_f32_16x16x32_bf16 v[88:91], a[172:175], a[136:139], v[88:91]
 v_cvt_pk_bf16_f32 v14, v22, v23
 v_mfma_f32_16x16x32_bf16 v[92:95], a[172:175], a[140:143], v[92:95]
 buffer_load_dwordx4 a[172:175], v1, s[12:15], s24 offen offset:3072
 s_waitcnt vmcnt(14)
 v_mfma_f32_16x16x32_bf16 v[96:99], a[176:179], a[128:131], v[96:99]
 v_accvgpr_read_b32 v24, a75
 v_mfma_f32_16x16x32_bf16 v[100:103], a[176:179], a[132:135], v[100:103]
 v_lshlrev_b32 v25, 16, v24
 v_mfma_f32_16x16x32_bf16 v[104:107], a[176:179], a[136:139], v[104:107]
 v_and_b32 v24, s26, v24
 v_mul_f32 v26, v25, v170
 v_mfma_f32_16x16x32_bf16 v[108:111], a[176:179], a[140:143], v[108:111]
 buffer_load_dwordx4 a[176:179], v2, s[12:15], s24 offen
 v_mfma_f32_16x16x32_bf16 v[112:115], a[180:183], a[128:131], v[112:115]
 v_mul_f32 v27, v24, v171
 v_mfma_f32_16x16x32_bf16 v[116:119], a[180:183], a[132:135], v[116:119]
 v_cvt_pk_bf16_f32 v15, v26, v27
 v_mfma_f32_16x16x32_bf16 v[120:123], a[180:183], a[136:139], v[120:123]
 ds_write_b128 v6, v[12:15] offset:2048
 v_accvgpr_read_b32 v20, a76
 v_mfma_f32_16x16x32_bf16 v[124:127], a[180:183], a[140:143], v[124:127]
 buffer_load_dwordx4 a[180:183], v2, s[12:15], s24 offen offset:1024
 s_waitcnt vmcnt(14)
 v_mfma_f32_16x16x32_bf16 v[128:131], a[184:187], a[128:131], v[128:131]
 v_lshlrev_b32 v21, 16, v20
 v_mfma_f32_16x16x32_bf16 v[132:135], a[184:187], a[132:135], v[132:135]
 v_and_b32 v20, s26, v20
 v_mfma_f32_16x16x32_bf16 v[136:139], a[184:187], a[136:139], v[136:139]
 v_mul_f32 v22, v21, v156
 v_mul_f32 v23, v20, v157
 v_mfma_f32_16x16x32_bf16 v[140:143], a[184:187], a[140:143], v[140:143]
 buffer_load_dwordx4 a[184:187], v2, s[12:15], s24 offen offset:2048
 v_mfma_f32_16x16x32_bf16 a[224:227], a[188:191], a[128:131], a[224:227]
 v_cvt_pk_bf16_f32 v16, v22, v23
 v_mfma_f32_16x16x32_bf16 a[228:231], a[188:191], a[132:135], a[228:231]
 v_accvgpr_read_b32 v24, a77
 v_mfma_f32_16x16x32_bf16 a[232:235], a[188:191], a[136:139], a[232:235]
 v_lshlrev_b32 v25, 16, v24
 v_and_b32 v24, s26, v24
 v_mfma_f32_16x16x32_bf16 a[236:239], a[188:191], a[140:143], a[236:239]
 buffer_load_dwordx4 a[188:191], v2, s[12:15], s24 offen offset:3072
 s_add_u32 s24, s24, 32768
 s_waitcnt vmcnt(14)
 s_waitcnt lgkmcnt(1)
 v_mfma_f32_16x16x32_bf16 v[32:35], a[192:195], a[144:147], v[32:35]
 v_mul_f32 v26, v25, v158
 v_mfma_f32_16x16x32_bf16 v[36:39], a[192:195], a[148:151], v[36:39]
 ds_read_b128 a[128:131], v3 offset:16384
 v_mfma_f32_16x16x32_bf16 v[40:43], a[192:195], a[152:155], v[40:43]
 v_mul_f32 v27, v24, v159
 v_cvt_pk_bf16_f32 v17, v26, v27
 v_mfma_f32_16x16x32_bf16 v[44:47], a[192:195], a[156:159], v[44:47]
 buffer_load_dwordx4 a[192:195], v1, s[12:15], s24 offen
 v_mfma_f32_16x16x32_bf16 v[48:51], a[196:199], a[144:147], v[48:51]
 v_accvgpr_read_b32 v20, a78
 v_mfma_f32_16x16x32_bf16 v[52:55], a[196:199], a[148:151], v[52:55]
 ds_read_b128 a[132:135], v3 offset:17408
 v_mfma_f32_16x16x32_bf16 v[56:59], a[196:199], a[152:155], v[56:59]
 v_lshlrev_b32 v21, 16, v20
 v_and_b32 v20, s26, v20
 v_mfma_f32_16x16x32_bf16 v[60:63], a[196:199], a[156:159], v[60:63]
 buffer_load_dwordx4 a[196:199], v1, s[12:15], s24 offen offset:1024
 s_waitcnt vmcnt(14)
 v_mfma_f32_16x16x32_bf16 v[64:67], a[200:203], a[144:147], v[64:67]
 v_mul_f32 v22, v21, v172
 v_mfma_f32_16x16x32_bf16 v[68:71], a[200:203], a[148:151], v[68:71]
 ds_read_b128 a[136:139], v3 offset:18432
 v_mfma_f32_16x16x32_bf16 v[72:75], a[200:203], a[152:155], v[72:75]
 v_mul_f32 v23, v20, v173
 v_mfma_f32_16x16x32_bf16 v[76:79], a[200:203], a[156:159], v[76:79]
 v_cvt_pk_bf16_f32 v18, v22, v23
 buffer_load_dwordx4 a[200:203], v1, s[12:15], s24 offen offset:2048
 v_mfma_f32_16x16x32_bf16 v[80:83], a[204:207], a[144:147], v[80:83]
 v_accvgpr_read_b32 v24, a79
 v_mfma_f32_16x16x32_bf16 v[84:87], a[204:207], a[148:151], v[84:87]
 ds_read_b128 a[140:143], v3 offset:19456
 v_mfma_f32_16x16x32_bf16 v[88:91], a[204:207], a[152:155], v[88:91]
 v_lshlrev_b32 v25, 16, v24
 v_and_b32 v24, s26, v24
 v_mfma_f32_16x16x32_bf16 v[92:95], a[204:207], a[156:159], v[92:95]
 buffer_load_dwordx4 a[204:207], v1, s[12:15], s24 offen offset:3072
 s_waitcnt vmcnt(14)
 v_mfma_f32_16x16x32_bf16 v[96:99], a[208:211], a[144:147], v[96:99]
 v_mul_f32 v26, v25, v174
 v_mfma_f32_16x16x32_bf16 v[100:103], a[208:211], a[148:151], v[100:103]
 v_mul_f32 v27, v24, v175
 v_mfma_f32_16x16x32_bf16 v[104:107], a[208:211], a[152:155], v[104:107]
 v_cvt_pk_bf16_f32 v19, v26, v27
 v_mfma_f32_16x16x32_bf16 v[108:111], a[208:211], a[156:159], v[108:111]
 ds_write_b128 v6, v[16:19] offset:3072
 buffer_load_dwordx4 a[208:211], v2, s[12:15], s24 offen
 v_mfma_f32_16x16x32_bf16 v[112:115], a[212:215], a[144:147], v[112:115]
 v_accvgpr_read_b32 v20, a80
 v_mfma_f32_16x16x32_bf16 v[116:119], a[212:215], a[148:151], v[116:119]
 v_lshlrev_b32 v21, 16, v20
 v_mfma_f32_16x16x32_bf16 v[120:123], a[212:215], a[152:155], v[120:123]
 v_and_b32 v20, s26, v20
 v_mfma_f32_16x16x32_bf16 v[124:127], a[212:215], a[156:159], v[124:127]
 buffer_load_dwordx4 a[212:215], v2, s[12:15], s24 offen offset:1024
 s_waitcnt vmcnt(14)
 v_mfma_f32_16x16x32_bf16 v[128:131], a[216:219], a[144:147], v[128:131]
 v_mul_f32 v22, v21, v176
 v_mul_f32 v23, v20, v177
 v_mfma_f32_16x16x32_bf16 v[132:135], a[216:219], a[148:151], v[132:135]
 v_cvt_pk_bf16_f32 v12, v22, v23
 v_mfma_f32_16x16x32_bf16 v[136:139], a[216:219], a[152:155], v[136:139]
 v_accvgpr_read_b32 v24, a81
 v_mfma_f32_16x16x32_bf16 v[140:143], a[216:219], a[156:159], v[140:143]
 v_lshlrev_b32 v25, 16, v24
 buffer_load_dwordx4 a[216:219], v2, s[12:15], s24 offen offset:2048
 v_mfma_f32_16x16x32_bf16 a[224:227], a[220:223], a[144:147], a[224:227]
 v_and_b32 v24, s26, v24
 v_mfma_f32_16x16x32_bf16 a[228:231], a[220:223], a[148:151], a[228:231]
 v_mul_f32 v26, v25, v178
 v_mfma_f32_16x16x32_bf16 a[232:235], a[220:223], a[152:155], a[232:235]
 v_mul_f32 v27, v24, v179
 v_mfma_f32_16x16x32_bf16 a[236:239], a[220:223], a[156:159], a[236:239]
 buffer_load_dwordx4 a[220:223], v2, s[12:15], s24 offen offset:3072
 s_add_u32 s24, s24, 32768
 s_waitcnt vmcnt(14)
 s_waitcnt lgkmcnt(1)
 v_mfma_f32_16x16x32_bf16 v[32:35], a[160:163], a[128:131], v[32:35]
 v_cvt_pk_bf16_f32 v13, v26, v27
 v_accvgpr_read_b32 v20, a82
 v_mfma_f32_16x16x32_bf16 v[36:39], a[160:163], a[132:135], v[36:39]
 ds_read_b128 a[144:147], v3 offset:20480
 v_mfma_f32_16x16x32_bf16 v[40:43], a[160:163], a[136:139], v[40:43]
 v_lshlrev_b32 v21, 16, v20
 v_mfma_f32_16x16x32_bf16 v[44:47], a[160:163], a[140:143], v[44:47]
 v_and_b32 v20, s26, v20
 buffer_load_dwordx4 a[160:163], v1, s[12:15], s24 offen
 v_mfma_f32_16x16x32_bf16 v[48:51], a[164:167], a[128:131], v[48:51]
 v_mul_f32 v22, v21, v192
 v_mfma_f32_16x16x32_bf16 v[52:55], a[164:167], a[132:135], v[52:55]
 ds_read_b128 a[148:151], v3 offset:21504
 v_mfma_f32_16x16x32_bf16 v[56:59], a[164:167], a[136:139], v[56:59]
 v_mul_f32 v23, v20, v193
 v_mfma_f32_16x16x32_bf16 v[60:63], a[164:167], a[140:143], v[60:63]
 buffer_load_dwordx4 a[164:167], v1, s[12:15], s24 offen offset:1024
 s_waitcnt vmcnt(14)
 v_mfma_f32_16x16x32_bf16 v[64:67], a[168:171], a[128:131], v[64:67]
 v_cvt_pk_bf16_f32 v14, v22, v23
 v_accvgpr_read_b32 v24, a83
 v_mfma_f32_16x16x32_bf16 v[68:71], a[168:171], a[132:135], v[68:71]
 ds_read_b128 a[152:155], v3 offset:22528
 v_mfma_f32_16x16x32_bf16 v[72:75], a[168:171], a[136:139], v[72:75]
 v_lshlrev_b32 v25, 16, v24
 v_mfma_f32_16x16x32_bf16 v[76:79], a[168:171], a[140:143], v[76:79]
 buffer_load_dwordx4 a[168:171], v1, s[12:15], s24 offen offset:2048
 v_mfma_f32_16x16x32_bf16 v[80:83], a[172:175], a[128:131], v[80:83]
 v_and_b32 v24, s26, v24
 v_mul_f32 v26, v25, v194
 v_mfma_f32_16x16x32_bf16 v[84:87], a[172:175], a[132:135], v[84:87]
 ds_read_b128 a[156:159], v3 offset:23552
 v_mfma_f32_16x16x32_bf16 v[88:91], a[172:175], a[136:139], v[88:91]
 v_mul_f32 v27, v24, v195
 v_mfma_f32_16x16x32_bf16 v[92:95], a[172:175], a[140:143], v[92:95]
 buffer_load_dwordx4 a[172:175], v1, s[12:15], s24 offen offset:3072
 s_waitcnt vmcnt(14)
 v_mfma_f32_16x16x32_bf16 v[96:99], a[176:179], a[128:131], v[96:99]
 v_cvt_pk_bf16_f32 v15, v26, v27
 ds_write_b128 v6, v[12:15] offset:4096
 v_mfma_f32_16x16x32_bf16 v[100:103], a[176:179], a[132:135], v[100:103]
 v_accvgpr_read_b32 v20, a84
 v_mfma_f32_16x16x32_bf16 v[104:107], a[176:179], a[136:139], v[104:107]
 v_lshlrev_b32 v21, 16, v20
 v_mfma_f32_16x16x32_bf16 v[108:111], a[176:179], a[140:143], v[108:111]
 buffer_load_dwordx4 a[176:179], v2, s[12:15], s24 offen
 v_mfma_f32_16x16x32_bf16 v[112:115], a[180:183], a[128:131], v[112:115]
 v_and_b32 v20, s26, v20
 v_mul_f32 v22, v21, v180
 v_mfma_f32_16x16x32_bf16 v[116:119], a[180:183], a[132:135], v[116:119]
 v_mul_f32 v23, v20, v181
 v_mfma_f32_16x16x32_bf16 v[120:123], a[180:183], a[136:139], v[120:123]
 v_cvt_pk_bf16_f32 v16, v22, v23
 v_mfma_f32_16x16x32_bf16 v[124:127], a[180:183], a[140:143], v[124:127]
 buffer_load_dwordx4 a[180:183], v2, s[12:15], s24 offen offset:1024
 s_waitcnt vmcnt(14)
 v_mfma_f32_16x16x32_bf16 v[128:131], a[184:187], a[128:131], v[128:131]
 v_accvgpr_read_b32 v24, a85
 v_lshlrev_b32 v25, 16, v24
 v_mfma_f32_16x16x32_bf16 v[132:135], a[184:187], a[132:135], v[132:135]
 v_and_b32 v24, s26, v24
 v_mfma_f32_16x16x32_bf16 v[136:139], a[184:187], a[136:139], v[136:139]
 v_mul_f32 v26, v25, v182
 v_mfma_f32_16x16x32_bf16 v[140:143], a[184:187], a[140:143], v[140:143]
 buffer_load_dwordx4 a[184:187], v2, s[12:15], s24 offen offset:2048
 v_mfma_f32_16x16x32_bf16 a[224:227], a[188:191], a[128:131], a[224:227]
 v_mul_f32 v27, v24, v183
 v_cvt_pk_bf16_f32 v17, v26, v27
 v_mfma_f32_16x16x32_bf16 a[228:231], a[188:191], a[132:135], a[228:231]
 v_accvgpr_read_b32 v20, a86
 v_mfma_f32_16x16x32_bf16 a[232:235], a[188:191], a[136:139], a[232:235]
 v_lshlrev_b32 v21, 16, v20
 v_mfma_f32_16x16x32_bf16 a[236:239], a[188:191], a[140:143], a[236:239]
 buffer_load_dwordx4 a[188:191], v2, s[12:15], s24 offen offset:3072
 s_add_u32 s24, s24, 32768
 s_waitcnt vmcnt(14)
 s_waitcnt lgkmcnt(1)
 v_mfma_f32_16x16x32_bf16 v[32:35], a[192:195], a[144:147], v[32:35]
 v_and_b32 v20, s26, v20
 v_mfma_f32_16x16x32_bf16 v[36:39], a[192:195], a[148:151], v[36:39]
 v_mul_f32 v22, v21, v196
 ds_read_b128 a[128:131], v3 offset:24576
 v_mfma_f32_16x16x32_bf16 v[40:43], a[192:195], a[152:155], v[40:43]
 v_mul_f32 v23, v20, v197
 v_mfma_f32_16x16x32_bf16 v[44:47], a[192:195], a[156:159], v[44:47]
 buffer_load_dwordx4 a[192:195], v1, s[12:15], s24 offen
 v_mfma_f32_16x16x32_bf16 v[48:51], a[196:199], a[144:147], v[48:51]
 v_cvt_pk_bf16_f32 v18, v22, v23
 v_accvgpr_read_b32 v24, a87
 v_mfma_f32_16x16x32_bf16 v[52:55], a[196:199], a[148:151], v[52:55]
 ds_read_b128 a[132:135], v3 offset:25600
 v_mfma_f32_16x16x32_bf16 v[56:59], a[196:199], a[152:155], v[56:59]
 v_lshlrev_b32 v25, 16, v24
 v_mfma_f32_16x16x32_bf16 v[60:63], a[196:199], a[156:159], v[60:63]
 buffer_load_dwordx4 a[196:199], v1, s[12:15], s24 offen offset:1024
 s_waitcnt vmcnt(14)
 v_mfma_f32_16x16x32_bf16 v[64:67], a[200:203], a[144:147], v[64:67]
 v_and_b32 v24, s26, v24
 v_mfma_f32_16x16x32_bf16 v[68:71], a[200:203], a[148:151], v[68:71]
 v_mul_f32 v26, v25, v198
 ds_read_b128 a[136:139], v3 offset:26624
 v_mfma_f32_16x16x32_bf16 v[72:75], a[200:203], a[152:155], v[72:75]
 v_mul_f32 v27, v24, v199
 v_mfma_f32_16x16x32_bf16 v[76:79], a[200:203], a[156:159], v[76:79]
 buffer_load_dwordx4 a[200:203], v1, s[12:15], s24 offen offset:2048
 v_mfma_f32_16x16x32_bf16 v[80:83], a[204:207], a[144:147], v[80:83]
 v_cvt_pk_bf16_f32 v19, v26, v27
 v_mfma_f32_16x16x32_bf16 v[84:87], a[204:207], a[148:151], v[84:87]
 ds_write_b128 v6, v[16:19] offset:5120
 ds_read_b128 a[140:143], v3 offset:27648
 v_mfma_f32_16x16x32_bf16 v[88:91], a[204:207], a[152:155], v[88:91]
 v_accvgpr_read_b32 v20, a88
 v_mfma_f32_16x16x32_bf16 v[92:95], a[204:207], a[156:159], v[92:95]
 buffer_load_dwordx4 a[204:207], v1, s[12:15], s24 offen offset:3072
 s_waitcnt vmcnt(14)
 v_mfma_f32_16x16x32_bf16 v[96:99], a[208:211], a[144:147], v[96:99]
 v_lshlrev_b32 v21, 16, v20
 v_mfma_f32_16x16x32_bf16 v[100:103], a[208:211], a[148:151], v[100:103]
 v_and_b32 v20, s26, v20
 v_mul_f32 v22, v21, v184
 v_mfma_f32_16x16x32_bf16 v[104:107], a[208:211], a[152:155], v[104:107]
 v_mul_f32 v23, v20, v185
 v_mfma_f32_16x16x32_bf16 v[108:111], a[208:211], a[156:159], v[108:111]
 buffer_load_dwordx4 a[208:211], v2, s[12:15], s24 offen
 v_mfma_f32_16x16x32_bf16 v[112:115], a[212:215], a[144:147], v[112:115]
 v_cvt_pk_bf16_f32 v12, v22, v23
 v_mfma_f32_16x16x32_bf16 v[116:119], a[212:215], a[148:151], v[116:119]
 v_accvgpr_read_b32 v24, a89
 v_lshlrev_b32 v25, 16, v24
 v_mfma_f32_16x16x32_bf16 v[120:123], a[212:215], a[152:155], v[120:123]
 v_and_b32 v24, s26, v24
 v_mfma_f32_16x16x32_bf16 v[124:127], a[212:215], a[156:159], v[124:127]
 buffer_load_dwordx4 a[212:215], v2, s[12:15], s24 offen offset:1024
 s_waitcnt vmcnt(14)
 v_mfma_f32_16x16x32_bf16 v[128:131], a[216:219], a[144:147], v[128:131]
 v_mul_f32 v26, v25, v186
 v_mfma_f32_16x16x32_bf16 v[132:135], a[216:219], a[148:151], v[132:135]
 v_mul_f32 v27, v24, v187
 v_cvt_pk_bf16_f32 v13, v26, v27
 v_mfma_f32_16x16x32_bf16 v[136:139], a[216:219], a[152:155], v[136:139]
 v_accvgpr_read_b32 v20, a90
 v_mfma_f32_16x16x32_bf16 v[140:143], a[216:219], a[156:159], v[140:143]
 buffer_load_dwordx4 a[216:219], v2, s[12:15], s24 offen offset:2048
 v_mfma_f32_16x16x32_bf16 a[224:227], a[220:223], a[144:147], a[224:227]
 v_lshlrev_b32 v21, 16, v20
 v_mfma_f32_16x16x32_bf16 a[228:231], a[220:223], a[148:151], a[228:231]
 v_and_b32 v20, s26, v20
 v_mul_f32 v22, v21, v200
 v_mfma_f32_16x16x32_bf16 a[232:235], a[220:223], a[152:155], a[232:235]
 v_mul_f32 v23, v20, v201
 v_mfma_f32_16x16x32_bf16 a[236:239], a[220:223], a[156:159], a[236:239]
 buffer_load_dwordx4 a[220:223], v2, s[12:15], s24 offen offset:3072
 s_add_u32 s24, s24, 32768
 s_waitcnt vmcnt(14)
 s_waitcnt lgkmcnt(0)
 v_mfma_f32_16x16x32_bf16 v[32:35], a[160:163], a[128:131], v[32:35]
 v_cvt_pk_bf16_f32 v14, v22, v23
 v_mfma_f32_16x16x32_bf16 v[36:39], a[160:163], a[132:135], v[36:39]
 ds_read_b128 a[144:147], v3 offset:28672
 v_mfma_f32_16x16x32_bf16 v[40:43], a[160:163], a[136:139], v[40:43]
 v_accvgpr_read_b32 v24, a91
 v_lshlrev_b32 v25, 16, v24
 v_mfma_f32_16x16x32_bf16 v[44:47], a[160:163], a[140:143], v[44:47]
 buffer_load_dwordx4 a[160:163], v1, s[12:15], s24 offen
 v_mfma_f32_16x16x32_bf16 v[48:51], a[164:167], a[128:131], v[48:51]
 v_and_b32 v24, s26, v24
 v_mfma_f32_16x16x32_bf16 v[52:55], a[164:167], a[132:135], v[52:55]
 v_mul_f32 v26, v25, v202
 ds_read_b128 a[148:151], v3 offset:29696
 v_mfma_f32_16x16x32_bf16 v[56:59], a[164:167], a[136:139], v[56:59]
 v_mul_f32 v27, v24, v203
 v_mfma_f32_16x16x32_bf16 v[60:63], a[164:167], a[140:143], v[60:63]
 buffer_load_dwordx4 a[164:167], v1, s[12:15], s24 offen offset:1024
 s_waitcnt vmcnt(14)
 v_mfma_f32_16x16x32_bf16 v[64:67], a[168:171], a[128:131], v[64:67]
 v_cvt_pk_bf16_f32 v15, v26, v27
 v_mfma_f32_16x16x32_bf16 v[68:71], a[168:171], a[132:135], v[68:71]
 ds_read_b128 a[152:155], v3 offset:30720
 v_mfma_f32_16x16x32_bf16 v[72:75], a[168:171], a[136:139], v[72:75]
 ds_write_b128 v6, v[12:15] offset:6144
 v_accvgpr_read_b32 v20, a92
 v_mfma_f32_16x16x32_bf16 v[76:79], a[168:171], a[140:143], v[76:79]
 buffer_load_dwordx4 a[168:171], v1, s[12:15], s24 offen offset:2048
 v_mfma_f32_16x16x32_bf16 v[80:83], a[172:175], a[128:131], v[80:83]
 v_lshlrev_b32 v21, 16, v20
 v_mfma_f32_16x16x32_bf16 v[84:87], a[172:175], a[132:135], v[84:87]
 ds_read_b128 a[156:159], v3 offset:31744
 v_mfma_f32_16x16x32_bf16 v[88:91], a[172:175], a[136:139], v[88:91]
 v_and_b32 v20, s26, v20
 v_mul_f32 v22, v21, v188
 v_mfma_f32_16x16x32_bf16 v[92:95], a[172:175], a[140:143], v[92:95]
 buffer_load_dwordx4 a[172:175], v1, s[12:15], s24 offen offset:3072
 s_waitcnt vmcnt(14)
 v_mfma_f32_16x16x32_bf16 v[96:99], a[176:179], a[128:131], v[96:99]
 v_mul_f32 v23, v20, v189
 v_mfma_f32_16x16x32_bf16 v[100:103], a[176:179], a[132:135], v[100:103]
 v_cvt_pk_bf16_f32 v16, v22, v23
 v_mfma_f32_16x16x32_bf16 v[104:107], a[176:179], a[136:139], v[104:107]
 v_accvgpr_read_b32 v24, a93
 v_lshlrev_b32 v25, 16, v24
 v_mfma_f32_16x16x32_bf16 v[108:111], a[176:179], a[140:143], v[108:111]
 buffer_load_dwordx4 a[176:179], v2, s[12:15], s24 offen
 v_mfma_f32_16x16x32_bf16 v[112:115], a[180:183], a[128:131], v[112:115]
 v_and_b32 v24, s26, v24
 v_mfma_f32_16x16x32_bf16 v[116:119], a[180:183], a[132:135], v[116:119]
 v_mul_f32 v26, v25, v190
 v_mfma_f32_16x16x32_bf16 v[120:123], a[180:183], a[136:139], v[120:123]
 v_mul_f32 v27, v24, v191
 v_cvt_pk_bf16_f32 v17, v26, v27
 v_mfma_f32_16x16x32_bf16 v[124:127], a[180:183], a[140:143], v[124:127]
 buffer_load_dwordx4 a[180:183], v2, s[12:15], s24 offen offset:1024
 s_waitcnt vmcnt(14)
 v_mfma_f32_16x16x32_bf16 v[128:131], a[184:187], a[128:131], v[128:131]
 v_accvgpr_read_b32 v20, a94
 v_mfma_f32_16x16x32_bf16 v[132:135], a[184:187], a[132:135], v[132:135]
 v_lshlrev_b32 v21, 16, v20
 v_mfma_f32_16x16x32_bf16 v[136:139], a[184:187], a[136:139], v[136:139]
 v_and_b32 v20, s26, v20
 v_mul_f32 v22, v21, v204
 v_mfma_f32_16x16x32_bf16 v[140:143], a[184:187], a[140:143], v[140:143]
 buffer_load_dwordx4 a[184:187], v2, s[12:15], s24 offen offset:2048
 v_mfma_f32_16x16x32_bf16 a[224:227], a[188:191], a[128:131], a[224:227]
 v_mul_f32 v23, v20, v205
 v_mfma_f32_16x16x32_bf16 a[228:231], a[188:191], a[132:135], a[228:231]
 v_cvt_pk_bf16_f32 v18, v22, v23
 v_mfma_f32_16x16x32_bf16 a[232:235], a[188:191], a[136:139], a[232:235]
 v_accvgpr_read_b32 v24, a95
 v_lshlrev_b32 v25, 16, v24
 v_mfma_f32_16x16x32_bf16 a[236:239], a[188:191], a[140:143], a[236:239]
 buffer_load_dwordx4 a[188:191], v2, s[12:15], s24 offen offset:3072
 s_add_u32 s24, s24, 32768
 s_waitcnt vmcnt(14)
 s_waitcnt lgkmcnt(0)
 v_mfma_f32_16x16x32_bf16 v[32:35], a[192:195], a[144:147], v[32:35]
 v_and_b32 v24, s26, v24
 v_mfma_f32_16x16x32_bf16 v[36:39], a[192:195], a[148:151], v[36:39]
 ds_read_b128 a[128:131], v3 offset:32768
 v_mfma_f32_16x16x32_bf16 v[40:43], a[192:195], a[152:155], v[40:43]
 v_mul_f32 v26, v25, v206
 v_mfma_f32_16x16x32_bf16 v[44:47], a[192:195], a[156:159], v[44:47]
 v_mul_f32 v27, v24, v207
 buffer_load_dwordx4 a[192:195], v1, s[12:15], s24 offen
 v_mfma_f32_16x16x32_bf16 v[48:51], a[196:199], a[144:147], v[48:51]
 v_cvt_pk_bf16_f32 v19, v26, v27
 v_mfma_f32_16x16x32_bf16 v[52:55], a[196:199], a[148:151], v[52:55]
 ds_read_b128 a[132:135], v3 offset:33792
 v_mfma_f32_16x16x32_bf16 v[56:59], a[196:199], a[152:155], v[56:59]
 ds_write_b128 v6, v[16:19] offset:7168
 v_accvgpr_read_b32 v20, a96
 v_mfma_f32_16x16x32_bf16 v[60:63], a[196:199], a[156:159], v[60:63]
 buffer_load_dwordx4 a[196:199], v1, s[12:15], s24 offen offset:1024
 s_waitcnt vmcnt(14)
 v_mfma_f32_16x16x32_bf16 v[64:67], a[200:203], a[144:147], v[64:67]
 v_lshlrev_b32 v21, 16, v20
 v_mfma_f32_16x16x32_bf16 v[68:71], a[200:203], a[148:151], v[68:71]
 ds_read_b128 a[136:139], v3 offset:34816
 v_mfma_f32_16x16x32_bf16 v[72:75], a[200:203], a[152:155], v[72:75]
 v_and_b32 v20, s26, v20
 v_mfma_f32_16x16x32_bf16 v[76:79], a[200:203], a[156:159], v[76:79]
 v_mul_f32 v22, v21, v208
 buffer_load_dwordx4 a[200:203], v1, s[12:15], s24 offen offset:2048
 v_mfma_f32_16x16x32_bf16 v[80:83], a[204:207], a[144:147], v[80:83]
 v_mul_f32 v23, v20, v209
 v_mfma_f32_16x16x32_bf16 v[84:87], a[204:207], a[148:151], v[84:87]
 ds_read_b128 a[140:143], v3 offset:35840
 v_mfma_f32_16x16x32_bf16 v[88:91], a[204:207], a[152:155], v[88:91]
 v_cvt_pk_bf16_f32 v12, v22, v23
 v_mfma_f32_16x16x32_bf16 v[92:95], a[204:207], a[156:159], v[92:95]
 buffer_load_dwordx4 a[204:207], v1, s[12:15], s24 offen offset:3072
 s_waitcnt vmcnt(14)
 v_mfma_f32_16x16x32_bf16 v[96:99], a[208:211], a[144:147], v[96:99]
 v_accvgpr_read_b32 v24, a97
 v_lshlrev_b32 v25, 16, v24
 v_mfma_f32_16x16x32_bf16 v[100:103], a[208:211], a[148:151], v[100:103]
 v_and_b32 v24, s26, v24
 v_mfma_f32_16x16x32_bf16 v[104:107], a[208:211], a[152:155], v[104:107]
 v_mul_f32 v26, v25, v210
 v_mfma_f32_16x16x32_bf16 v[108:111], a[208:211], a[156:159], v[108:111]
 v_mul_f32 v27, v24, v211
 buffer_load_dwordx4 a[208:211], v2, s[12:15], s24 offen
 v_mfma_f32_16x16x32_bf16 v[112:115], a[212:215], a[144:147], v[112:115]
 v_cvt_pk_bf16_f32 v13, v26, v27
 v_mfma_f32_16x16x32_bf16 v[116:119], a[212:215], a[148:151], v[116:119]
 v_accvgpr_read_b32 v20, a98
 v_mfma_f32_16x16x32_bf16 v[120:123], a[212:215], a[152:155], v[120:123]
 v_lshlrev_b32 v21, 16, v20
 v_mfma_f32_16x16x32_bf16 v[124:127], a[212:215], a[156:159], v[124:127]
 buffer_load_dwordx4 a[212:215], v2, s[12:15], s24 offen offset:1024
 s_waitcnt vmcnt(14)
 v_mfma_f32_16x16x32_bf16 v[128:131], a[216:219], a[144:147], v[128:131]
 v_and_b32 v20, s26, v20
 v_mul_f32 v22, v21, v224
 v_mfma_f32_16x16x32_bf16 v[132:135], a[216:219], a[148:151], v[132:135]
 v_mul_f32 v23, v20, v225
 v_mfma_f32_16x16x32_bf16 v[136:139], a[216:219], a[152:155], v[136:139]
 v_cvt_pk_bf16_f32 v14, v22, v23
 v_mfma_f32_16x16x32_bf16 v[140:143], a[216:219], a[156:159], v[140:143]
 v_accvgpr_read_b32 v24, a99
 buffer_load_dwordx4 a[216:219], v2, s[12:15], s24 offen offset:2048
 v_mfma_f32_16x16x32_bf16 a[224:227], a[220:223], a[144:147], a[224:227]
 v_lshlrev_b32 v25, 16, v24
 v_mfma_f32_16x16x32_bf16 a[228:231], a[220:223], a[148:151], a[228:231]
 v_and_b32 v24, s26, v24
 v_mfma_f32_16x16x32_bf16 a[232:235], a[220:223], a[152:155], a[232:235]
 v_mul_f32 v26, v25, v226
 v_mfma_f32_16x16x32_bf16 a[236:239], a[220:223], a[156:159], a[236:239]
 buffer_load_dwordx4 a[220:223], v2, s[12:15], s24 offen offset:3072
 s_add_u32 s24, s24, 32768
 s_waitcnt vmcnt(14)
 s_waitcnt lgkmcnt(0)
 v_mfma_f32_16x16x32_bf16 v[32:35], a[160:163], a[128:131], v[32:35]
 v_mul_f32 v27, v24, v227
 v_cvt_pk_bf16_f32 v15, v26, v27
 v_mfma_f32_16x16x32_bf16 v[36:39], a[160:163], a[132:135], v[36:39]
 ds_read_b128 a[144:147], v3 offset:36864
 v_mfma_f32_16x16x32_bf16 v[40:43], a[160:163], a[136:139], v[40:43]
 ds_write_b128 v6, v[12:15] offset:8192
 v_mfma_f32_16x16x32_bf16 v[44:47], a[160:163], a[140:143], v[44:47]
 buffer_load_dwordx4 a[160:163], v1, s[12:15], s24 offen
 v_mfma_f32_16x16x32_bf16 v[48:51], a[164:167], a[128:131], v[48:51]
 v_accvgpr_read_b32 v20, a100
 v_lshlrev_b32 v21, 16, v20
 v_mfma_f32_16x16x32_bf16 v[52:55], a[164:167], a[132:135], v[52:55]
 ds_read_b128 a[148:151], v3 offset:37888
 v_mfma_f32_16x16x32_bf16 v[56:59], a[164:167], a[136:139], v[56:59]
 v_and_b32 v20, s26, v20
 v_mfma_f32_16x16x32_bf16 v[60:63], a[164:167], a[140:143], v[60:63]
 buffer_load_dwordx4 a[164:167], v1, s[12:15], s24 offen offset:1024
 s_waitcnt vmcnt(14)
 v_mfma_f32_16x16x32_bf16 v[64:67], a[168:171], a[128:131], v[64:67]
 v_mul_f32 v22, v21, v212
 v_mul_f32 v23, v20, v213
 v_mfma_f32_16x16x32_bf16 v[68:71], a[168:171], a[132:135], v[68:71]
 ds_read_b128 a[152:155], v3 offset:38912
 v_mfma_f32_16x16x32_bf16 v[72:75], a[168:171], a[136:139], v[72:75]
 v_cvt_pk_bf16_f32 v16, v22, v23
 v_mfma_f32_16x16x32_bf16 v[76:79], a[168:171], a[140:143], v[76:79]
 buffer_load_dwordx4 a[168:171], v1, s[12:15], s24 offen offset:2048
 v_mfma_f32_16x16x32_bf16 v[80:83], a[172:175], a[128:131], v[80:83]
 v_accvgpr_read_b32 v24, a101
 v_lshlrev_b32 v25, 16, v24
 v_mfma_f32_16x16x32_bf16 v[84:87], a[172:175], a[132:135], v[84:87]
 ds_read_b128 a[156:159], v3 offset:39936
 v_mfma_f32_16x16x32_bf16 v[88:91], a[172:175], a[136:139], v[88:91]
 v_and_b32 v24, s26, v24
 v_mfma_f32_16x16x32_bf16 v[92:95], a[172:175], a[140:143], v[92:95]
 buffer_load_dwordx4 a[172:175], v1, s[12:15], s24 offen offset:3072
 s_waitcnt vmcnt(14)
 v_mfma_f32_16x16x32_bf16 v[96:99], a[176:179], a[128:131], v[96:99]
 v_mul_f32 v26, v25, v214
 v_mul_f32 v27, v24, v215
 v_mfma_f32_16x16x32_bf16 v[100:103], a[176:179], a[132:135], v[100:103]
 v_cvt_pk_bf16_f32 v17, v26, v27
 v_mfma_f32_16x16x32_bf16 v[104:107], a[176:179], a[136:139], v[104:107]
 v_accvgpr_read_b32 v20, a102
 v_mfma_f32_16x16x32_bf16 v[108:111], a[176:179], a[140:143], v[108:111]
 buffer_load_dwordx4 a[176:179], v2, s[12:15], s24 offen
 v_mfma_f32_16x16x32_bf16 v[112:115], a[180:183], a[128:131], v[112:115]
 v_lshlrev_b32 v21, 16, v20
 v_and_b32 v20, s26, v20
 v_mfma_f32_16x16x32_bf16 v[116:119], a[180:183], a[132:135], v[116:119]
 v_mul_f32 v22, v21, v228
 v_mfma_f32_16x16x32_bf16 v[120:123], a[180:183], a[136:139], v[120:123]
 v_mul_f32 v23, v20, v229
 v_mfma_f32_16x16x32_bf16 v[124:127], a[180:183], a[140:143], v[124:127]
 buffer_load_dwordx4 a[180:183], v2, s[12:15], s24 offen offset:1024
 s_waitcnt vmcnt(14)
 v_mfma_f32_16x16x32_bf16 v[128:131], a[184:187], a[128:131], v[128:131]
 v_cvt_pk_bf16_f32 v18, v22, v23
 v_mfma_f32_16x16x32_bf16 v[132:135], a[184:187], a[132:135], v[132:135]
 v_accvgpr_read_b32 v24, a103
 v_lshlrev_b32 v25, 16, v24
 v_mfma_f32_16x16x32_bf16 v[136:139], a[184:187], a[136:139], v[136:139]
 v_and_b32 v24, s26, v24
 v_mfma_f32_16x16x32_bf16 v[140:143], a[184:187], a[140:143], v[140:143]
 buffer_load_dwordx4 a[184:187], v2, s[12:15], s24 offen offset:2048
 v_mfma_f32_16x16x32_bf16 a[224:227], a[188:191], a[128:131], a[224:227]
 v_mul_f32 v26, v25, v230
 v_mul_f32 v27, v24, v231
 v_mfma_f32_16x16x32_bf16 a[228:231], a[188:191], a[132:135], a[228:231]
 v_cvt_pk_bf16_f32 v19, v26, v27
 v_mfma_f32_16x16x32_bf16 a[232:235], a[188:191], a[136:139], a[232:235]
 ds_write_b128 v6, v[16:19] offset:9216
 v_mfma_f32_16x16x32_bf16 a[236:239], a[188:191], a[140:143], a[236:239]
 buffer_load_dwordx4 a[188:191], v2, s[12:15], s24 offen offset:3072
 s_add_u32 s24, s24, 32768
 s_waitcnt vmcnt(14)
 s_waitcnt lgkmcnt(1)
 v_mfma_f32_16x16x32_bf16 v[32:35], a[192:195], a[144:147], v[32:35]
 v_accvgpr_read_b32 v20, a104
 v_mfma_f32_16x16x32_bf16 v[36:39], a[192:195], a[148:151], v[36:39]
 v_lshlrev_b32 v21, 16, v20
 ds_read_b128 a[128:131], v3 offset:40960
 v_mfma_f32_16x16x32_bf16 v[40:43], a[192:195], a[152:155], v[40:43]
 v_and_b32 v20, s26, v20
 v_mfma_f32_16x16x32_bf16 v[44:47], a[192:195], a[156:159], v[44:47]
 buffer_load_dwordx4 a[192:195], v1, s[12:15], s24 offen
 v_mfma_f32_16x16x32_bf16 v[48:51], a[196:199], a[144:147], v[48:51]
 v_mul_f32 v22, v21, v216
 v_mfma_f32_16x16x32_bf16 v[52:55], a[196:199], a[148:151], v[52:55]
 v_mul_f32 v23, v20, v217
 ds_read_b128 a[132:135], v3 offset:41984
 v_mfma_f32_16x16x32_bf16 v[56:59], a[196:199], a[152:155], v[56:59]
 v_cvt_pk_bf16_f32 v12, v22, v23
 v_mfma_f32_16x16x32_bf16 v[60:63], a[196:199], a[156:159], v[60:63]
 buffer_load_dwordx4 a[196:199], v1, s[12:15], s24 offen offset:1024
 s_waitcnt vmcnt(14)
 v_mfma_f32_16x16x32_bf16 v[64:67], a[200:203], a[144:147], v[64:67]
 v_accvgpr_read_b32 v24, a105
 v_mfma_f32_16x16x32_bf16 v[68:71], a[200:203], a[148:151], v[68:71]
 v_lshlrev_b32 v25, 16, v24
 ds_read_b128 a[136:139], v3 offset:43008
 v_mfma_f32_16x16x32_bf16 v[72:75], a[200:203], a[152:155], v[72:75]
 v_and_b32 v24, s26, v24
 v_mfma_f32_16x16x32_bf16 v[76:79], a[200:203], a[156:159], v[76:79]
 buffer_load_dwordx4 a[200:203], v1, s[12:15], s24 offen offset:2048
 v_mfma_f32_16x16x32_bf16 v[80:83], a[204:207], a[144:147], v[80:83]
 v_mul_f32 v26, v25, v218
 v_mfma_f32_16x16x32_bf16 v[84:87], a[204:207], a[148:151], v[84:87]
 v_mul_f32 v27, v24, v219
 ds_read_b128 a[140:143], v3 offset:44032
 v_mfma_f32_16x16x32_bf16 v[88:91], a[204:207], a[152:155], v[88:91]
 v_cvt_pk_bf16_f32 v13, v26, v27
 v_mfma_f32_16x16x32_bf16 v[92:95], a[204:207], a[156:159], v[92:95]
 buffer_load_dwordx4 a[204:207], v1, s[12:15], s24 offen offset:3072
 s_waitcnt vmcnt(14)
 v_mfma_f32_16x16x32_bf16 v[96:99], a[208:211], a[144:147], v[96:99]
 v_accvgpr_read_b32 v20, a106
 v_mfma_f32_16x16x32_bf16 v[100:103], a[208:211], a[148:151], v[100:103]
 v_lshlrev_b32 v21, 16, v20
 v_and_b32 v20, s26, v20
 v_mfma_f32_16x16x32_bf16 v[104:107], a[208:211], a[152:155], v[104:107]
 v_mul_f32 v22, v21, v232
 v_mfma_f32_16x16x32_bf16 v[108:111], a[208:211], a[156:159], v[108:111]
 buffer_load_dwordx4 a[208:211], v2, s[12:15], s24 offen
 v_mfma_f32_16x16x32_bf16 v[112:115], a[212:215], a[144:147], v[112:115]
 v_mul_f32 v23, v20, v233
 v_mfma_f32_16x16x32_bf16 v[116:119], a[212:215], a[148:151], v[116:119]
 v_cvt_pk_bf16_f32 v14, v22, v23
 v_accvgpr_read_b32 v24, a107
 v_mfma_f32_16x16x32_bf16 v[120:123], a[212:215], a[152:155], v[120:123]
 v_lshlrev_b32 v25, 16, v24
 v_mfma_f32_16x16x32_bf16 v[124:127], a[212:215], a[156:159], v[124:127]
 buffer_load_dwordx4 a[212:215], v2, s[12:15], s24 offen offset:1024
 s_waitcnt vmcnt(14)
 v_mfma_f32_16x16x32_bf16 v[128:131], a[216:219], a[144:147], v[128:131]
 v_and_b32 v24, s26, v24
 v_mfma_f32_16x16x32_bf16 v[132:135], a[216:219], a[148:151], v[132:135]
 v_mul_f32 v26, v25, v234
 v_mfma_f32_16x16x32_bf16 v[136:139], a[216:219], a[152:155], v[136:139]
 v_mul_f32 v27, v24, v235
 v_cvt_pk_bf16_f32 v15, v26, v27
 v_mfma_f32_16x16x32_bf16 v[140:143], a[216:219], a[156:159], v[140:143]
 buffer_load_dwordx4 a[216:219], v2, s[12:15], s24 offen offset:2048
 v_mfma_f32_16x16x32_bf16 a[224:227], a[220:223], a[144:147], a[224:227]
 ds_write_b128 v6, v[12:15] offset:10240
 v_mfma_f32_16x16x32_bf16 a[228:231], a[220:223], a[148:151], a[228:231]
 v_accvgpr_read_b32 v20, a108
 v_lshlrev_b32 v21, 16, v20
 v_mfma_f32_16x16x32_bf16 a[232:235], a[220:223], a[152:155], a[232:235]
 v_and_b32 v20, s26, v20
 v_mfma_f32_16x16x32_bf16 a[236:239], a[220:223], a[156:159], a[236:239]
 buffer_load_dwordx4 a[220:223], v2, s[12:15], s24 offen offset:3072
 s_add_u32 s24, s24, 32768
 s_waitcnt vmcnt(14)
 s_waitcnt lgkmcnt(1)
 v_mfma_f32_16x16x32_bf16 v[32:35], a[160:163], a[128:131], v[32:35]
 v_mul_f32 v22, v21, v220
 v_mfma_f32_16x16x32_bf16 v[36:39], a[160:163], a[132:135], v[36:39]
 ds_read_b128 a[144:147], v3 offset:45056
 v_mfma_f32_16x16x32_bf16 v[40:43], a[160:163], a[136:139], v[40:43]
 v_mul_f32 v23, v20, v221
 v_cvt_pk_bf16_f32 v16, v22, v23
 v_mfma_f32_16x16x32_bf16 v[44:47], a[160:163], a[140:143], v[44:47]
 buffer_load_dwordx4 a[160:163], v1, s[12:15], s24 offen
 v_mfma_f32_16x16x32_bf16 v[48:51], a[164:167], a[128:131], v[48:51]
 v_accvgpr_read_b32 v24, a109
 v_mfma_f32_16x16x32_bf16 v[52:55], a[164:167], a[132:135], v[52:55]
 ds_read_b128 a[148:151], v3 offset:46080
 v_mfma_f32_16x16x32_bf16 v[56:59], a[164:167], a[136:139], v[56:59]
 v_lshlrev_b32 v25, 16, v24
 v_and_b32 v24, s26, v24
 v_mfma_f32_16x16x32_bf16 v[60:63], a[164:167], a[140:143], v[60:63]
 buffer_load_dwordx4 a[164:167], v1, s[12:15], s24 offen offset:1024
 s_waitcnt vmcnt(14)
 v_mfma_f32_16x16x32_bf16 v[64:67], a[168:171], a[128:131], v[64:67]
 v_mul_f32 v26, v25, v222
 v_mfma_f32_16x16x32_bf16 v[68:71], a[168:171], a[132:135], v[68:71]
 ds_read_b128 a[152:155], v3 offset:47104
 v_mfma_f32_16x16x32_bf16 v[72:75], a[168:171], a[136:139], v[72:75]
 v_mul_f32 v27, v24, v223
 v_cvt_pk_bf16_f32 v17, v26, v27
 v_mfma_f32_16x16x32_bf16 v[76:79], a[168:171], a[140:143], v[76:79]
 buffer_load_dwordx4 a[168:171], v1, s[12:15], s24 offen offset:2048
 v_mfma_f32_16x16x32_bf16 v[80:83], a[172:175], a[128:131], v[80:83]
 v_accvgpr_read_b32 v20, a110
 v_mfma_f32_16x16x32_bf16 v[84:87], a[172:175], a[132:135], v[84:87]
 ds_read_b128 a[156:159], v3 offset:48128
 v_mfma_f32_16x16x32_bf16 v[88:91], a[172:175], a[136:139], v[88:91]
 v_lshlrev_b32 v21, 16, v20
 v_and_b32 v20, s26, v20
 v_mfma_f32_16x16x32_bf16 v[92:95], a[172:175], a[140:143], v[92:95]
 buffer_load_dwordx4 a[172:175], v1, s[12:15], s24 offen offset:3072
 s_waitcnt vmcnt(14)
 v_mfma_f32_16x16x32_bf16 v[96:99], a[176:179], a[128:131], v[96:99]
 v_mul_f32 v22, v21, v236
 v_mfma_f32_16x16x32_bf16 v[100:103], a[176:179], a[132:135], v[100:103]
 v_mul_f32 v23, v20, v237
 v_mfma_f32_16x16x32_bf16 v[104:107], a[176:179], a[136:139], v[104:107]
 v_cvt_pk_bf16_f32 v18, v22, v23
 v_accvgpr_read_b32 v24, a111
 v_mfma_f32_16x16x32_bf16 v[108:111], a[176:179], a[140:143], v[108:111]
 buffer_load_dwordx4 a[176:179], v2, s[12:15], s24 offen
 v_mfma_f32_16x16x32_bf16 v[112:115], a[180:183], a[128:131], v[112:115]
 v_lshlrev_b32 v25, 16, v24
 v_mfma_f32_16x16x32_bf16 v[116:119], a[180:183], a[132:135], v[116:119]
 v_and_b32 v24, s26, v24
 v_mfma_f32_16x16x32_bf16 v[120:123], a[180:183], a[136:139], v[120:123]
 v_mul_f32 v26, v25, v238
 v_mul_f32 v27, v24, v239
 v_mfma_f32_16x16x32_bf16 v[124:127], a[180:183], a[140:143], v[124:127]
 buffer_load_dwordx4 a[180:183], v2, s[12:15], s24 offen offset:1024
 s_waitcnt vmcnt(14)
 v_mfma_f32_16x16x32_bf16 v[128:131], a[184:187], a[128:131], v[128:131]
 v_cvt_pk_bf16_f32 v19, v26, v27
 v_mfma_f32_16x16x32_bf16 v[132:135], a[184:187], a[132:135], v[132:135]
 ds_write_b128 v6, v[16:19] offset:11264
 v_mfma_f32_16x16x32_bf16 v[136:139], a[184:187], a[136:139], v[136:139]
 v_accvgpr_read_b32 v20, a112
 v_mfma_f32_16x16x32_bf16 v[140:143], a[184:187], a[140:143], v[140:143]
 v_lshlrev_b32 v21, 16, v20
 buffer_load_dwordx4 a[184:187], v2, s[12:15], s24 offen offset:2048
 v_mfma_f32_16x16x32_bf16 a[224:227], a[188:191], a[128:131], a[224:227]
 v_and_b32 v20, s26, v20
 v_mfma_f32_16x16x32_bf16 a[228:231], a[188:191], a[132:135], a[228:231]
 v_mul_f32 v22, v21, v240
 v_mfma_f32_16x16x32_bf16 a[232:235], a[188:191], a[136:139], a[232:235]
 v_mul_f32 v23, v20, v241
 v_cvt_pk_bf16_f32 v12, v22, v23
 v_mfma_f32_16x16x32_bf16 a[236:239], a[188:191], a[140:143], a[236:239]
 buffer_load_dwordx4 a[188:191], v2, s[12:15], s24 offen offset:3072
 s_add_u32 s24, s24, 32768
 s_waitcnt vmcnt(14)
 s_waitcnt lgkmcnt(1)
 v_mfma_f32_16x16x32_bf16 v[32:35], a[192:195], a[144:147], v[32:35]
 v_accvgpr_read_b32 v24, a113
 v_mfma_f32_16x16x32_bf16 v[36:39], a[192:195], a[148:151], v[36:39]
 ds_read_b128 a[128:131], v3 offset:49152
 v_mfma_f32_16x16x32_bf16 v[40:43], a[192:195], a[152:155], v[40:43]
 v_lshlrev_b32 v25, 16, v24
 v_mfma_f32_16x16x32_bf16 v[44:47], a[192:195], a[156:159], v[44:47]
 v_and_b32 v24, s26, v24
 buffer_load_dwordx4 a[192:195], v1, s[12:15], s24 offen
 v_mfma_f32_16x16x32_bf16 v[48:51], a[196:199], a[144:147], v[48:51]
 v_mul_f32 v26, v25, v242
 v_mfma_f32_16x16x32_bf16 v[52:55], a[196:199], a[148:151], v[52:55]
 ds_read_b128 a[132:135], v3 offset:50176
 v_mfma_f32_16x16x32_bf16 v[56:59], a[196:199], a[152:155], v[56:59]
 v_mul_f32 v27, v24, v243
 v_mfma_f32_16x16x32_bf16 v[60:63], a[196:199], a[156:159], v[60:63]
 buffer_load_dwordx4 a[196:199], v1, s[12:15], s24 offen offset:1024
 s_waitcnt vmcnt(14)
 v_mfma_f32_16x16x32_bf16 v[64:67], a[200:203], a[144:147], v[64:67]
 v_cvt_pk_bf16_f32 v13, v26, v27
 v_accvgpr_read_b32 v20, a114
 v_mfma_f32_16x16x32_bf16 v[68:71], a[200:203], a[148:151], v[68:71]
 ds_read_b128 a[136:139], v3 offset:51200
 v_mfma_f32_16x16x32_bf16 v[72:75], a[200:203], a[152:155], v[72:75]
 v_accvgpr_read_b32 v22, a240
 v_mfma_f32_16x16x32_bf16 v[76:79], a[200:203], a[156:159], v[76:79]
 v_accvgpr_read_b32 v23, a241
 buffer_load_dwordx4 a[200:203], v1, s[12:15], s24 offen offset:2048
 v_mfma_f32_16x16x32_bf16 v[80:83], a[204:207], a[144:147], v[80:83]
 v_lshlrev_b32 v21, 16, v20
 v_mfma_f32_16x16x32_bf16 v[84:87], a[204:207], a[148:151], v[84:87]
 ds_read_b128 a[140:143], v3 offset:52224
 v_mfma_f32_16x16x32_bf16 v[88:91], a[204:207], a[152:155], v[88:91]
 v_and_b32 v20, s26, v20
 v_mfma_f32_16x16x32_bf16 v[92:95], a[204:207], a[156:159], v[92:95]
 buffer_load_dwordx4 a[204:207], v1, s[12:15], s24 offen offset:3072
 s_waitcnt vmcnt(14)
 v_mfma_f32_16x16x32_bf16 v[96:99], a[208:211], a[144:147], v[96:99]
 v_mul_f32 v22, v21, v22
 v_mul_f32 v23, v20, v23
 v_mfma_f32_16x16x32_bf16 v[100:103], a[208:211], a[148:151], v[100:103]
 v_cvt_pk_bf16_f32 v14, v22, v23
 v_mfma_f32_16x16x32_bf16 v[104:107], a[208:211], a[152:155], v[104:107]
 v_accvgpr_read_b32 v24, a115
 v_mfma_f32_16x16x32_bf16 v[108:111], a[208:211], a[156:159], v[108:111]
 v_accvgpr_read_b32 v26, a242
 buffer_load_dwordx4 a[208:211], v2, s[12:15], s24 offen
 v_mfma_f32_16x16x32_bf16 v[112:115], a[212:215], a[144:147], v[112:115]
 v_accvgpr_read_b32 v27, a243
 v_mfma_f32_16x16x32_bf16 v[116:119], a[212:215], a[148:151], v[116:119]
 v_lshlrev_b32 v25, 16, v24
 v_mfma_f32_16x16x32_bf16 v[120:123], a[212:215], a[152:155], v[120:123]
 v_and_b32 v24, s26, v24
 v_mfma_f32_16x16x32_bf16 v[124:127], a[212:215], a[156:159], v[124:127]
 buffer_load_dwordx4 a[212:215], v2, s[12:15], s24 offen offset:1024
 s_waitcnt vmcnt(14)
 v_mfma_f32_16x16x32_bf16 v[128:131], a[216:219], a[144:147], v[128:131]
 v_mul_f32 v26, v25, v26
 v_mul_f32 v27, v24, v27
 v_mfma_f32_16x16x32_bf16 v[132:135], a[216:219], a[148:151], v[132:135]
 v_cvt_pk_bf16_f32 v15, v26, v27
 v_mfma_f32_16x16x32_bf16 v[136:139], a[216:219], a[152:155], v[136:139]
 ds_write_b128 v6, v[12:15] offset:12288
 v_mfma_f32_16x16x32_bf16 v[140:143], a[216:219], a[156:159], v[140:143]
 buffer_load_dwordx4 a[216:219], v2, s[12:15], s24 offen offset:2048
 v_mfma_f32_16x16x32_bf16 a[224:227], a[220:223], a[144:147], a[224:227]
 v_accvgpr_read_b32 v20, a116
 v_lshlrev_b32 v21, 16, v20
 v_mfma_f32_16x16x32_bf16 a[228:231], a[220:223], a[148:151], a[228:231]
 v_and_b32 v20, s26, v20
 v_mfma_f32_16x16x32_bf16 a[232:235], a[220:223], a[152:155], a[232:235]
 v_mul_f32 v22, v21, v244
 v_mfma_f32_16x16x32_bf16 a[236:239], a[220:223], a[156:159], a[236:239]
 buffer_load_dwordx4 a[220:223], v2, s[12:15], s24 offen offset:3072
 s_add_u32 s24, s24, 32768
 s_waitcnt vmcnt(14)
 s_waitcnt lgkmcnt(1)
 v_mfma_f32_16x16x32_bf16 v[32:35], a[160:163], a[128:131], v[32:35]
 v_mul_f32 v23, v20, v245
 v_cvt_pk_bf16_f32 v16, v22, v23
 v_mfma_f32_16x16x32_bf16 v[36:39], a[160:163], a[132:135], v[36:39]
 ds_read_b128 a[144:147], v3 offset:53248
 v_mfma_f32_16x16x32_bf16 v[40:43], a[160:163], a[136:139], v[40:43]
 v_accvgpr_read_b32 v24, a117
 v_mfma_f32_16x16x32_bf16 v[44:47], a[160:163], a[140:143], v[44:47]
 buffer_load_dwordx4 a[160:163], v1, s[12:15], s24 offen
 v_mfma_f32_16x16x32_bf16 v[48:51], a[164:167], a[128:131], v[48:51]
 v_lshlrev_b32 v25, 16, v24
 v_and_b32 v24, s26, v24
 v_mfma_f32_16x16x32_bf16 v[52:55], a[164:167], a[132:135], v[52:55]
 ds_read_b128 a[148:151], v3 offset:54272
 v_mfma_f32_16x16x32_bf16 v[56:59], a[164:167], a[136:139], v[56:59]
 v_mul_f32 v26, v25, v246
 v_mfma_f32_16x16x32_bf16 v[60:63], a[164:167], a[140:143], v[60:63]
 buffer_load_dwordx4 a[164:167], v1, s[12:15], s24 offen offset:1024
 s_waitcnt vmcnt(14)
 v_mfma_f32_16x16x32_bf16 v[64:67], a[168:171], a[128:131], v[64:67]
 v_mul_f32 v27, v24, v247
 v_cvt_pk_bf16_f32 v17, v26, v27
 v_mfma_f32_16x16x32_bf16 v[68:71], a[168:171], a[132:135], v[68:71]
 ds_read_b128 a[152:155], v3 offset:55296
 v_mfma_f32_16x16x32_bf16 v[72:75], a[168:171], a[136:139], v[72:75]
 v_accvgpr_read_b32 v20, a118
 v_mfma_f32_16x16x32_bf16 v[76:79], a[168:171], a[140:143], v[76:79]
 buffer_load_dwordx4 a[168:171], v1, s[12:15], s24 offen offset:2048
 v_mfma_f32_16x16x32_bf16 v[80:83], a[172:175], a[128:131], v[80:83]
 v_accvgpr_read_b32 v22, a244
 v_accvgpr_read_b32 v23, a245
 v_mfma_f32_16x16x32_bf16 v[84:87], a[172:175], a[132:135], v[84:87]
 ds_read_b128 a[156:159], v3 offset:56320
 v_mfma_f32_16x16x32_bf16 v[88:91], a[172:175], a[136:139], v[88:91]
 v_lshlrev_b32 v21, 16, v20
 v_mfma_f32_16x16x32_bf16 v[92:95], a[172:175], a[140:143], v[92:95]
 buffer_load_dwordx4 a[172:175], v1, s[12:15], s24 offen offset:3072
 s_waitcnt vmcnt(14)
 v_mfma_f32_16x16x32_bf16 v[96:99], a[176:179], a[128:131], v[96:99]
 v_and_b32 v20, s26, v20
 v_mfma_f32_16x16x32_bf16 v[100:103], a[176:179], a[132:135], v[100:103]
 v_mul_f32 v22, v21, v22
 v_mul_f32 v23, v20, v23
 v_mfma_f32_16x16x32_bf16 v[104:107], a[176:179], a[136:139], v[104:107]
 v_cvt_pk_bf16_f32 v18, v22, v23
 v_mfma_f32_16x16x32_bf16 v[108:111], a[176:179], a[140:143], v[108:111]
 buffer_load_dwordx4 a[176:179], v2, s[12:15], s24 offen
 v_mfma_f32_16x16x32_bf16 v[112:115], a[180:183], a[128:131], v[112:115]
 v_accvgpr_read_b32 v24, a119
 v_accvgpr_read_b32 v26, a246
 v_mfma_f32_16x16x32_bf16 v[116:119], a[180:183], a[132:135], v[116:119]
 v_accvgpr_read_b32 v27, a247
 v_mfma_f32_16x16x32_bf16 v[120:123], a[180:183], a[136:139], v[120:123]
 v_lshlrev_b32 v25, 16, v24
 v_mfma_f32_16x16x32_bf16 v[124:127], a[180:183], a[140:143], v[124:127]
 buffer_load_dwordx4 a[180:183], v2, s[12:15], s24 offen offset:1024
 s_waitcnt vmcnt(14)
 v_mfma_f32_16x16x32_bf16 v[128:131], a[184:187], a[128:131], v[128:131]
 v_and_b32 v24, s26, v24
 v_mfma_f32_16x16x32_bf16 v[132:135], a[184:187], a[132:135], v[132:135]
 v_mul_f32 v26, v25, v26
 v_mul_f32 v27, v24, v27
 v_mfma_f32_16x16x32_bf16 v[136:139], a[184:187], a[136:139], v[136:139]
 v_cvt_pk_bf16_f32 v19, v26, v27
 v_mfma_f32_16x16x32_bf16 v[140:143], a[184:187], a[140:143], v[140:143]
 buffer_load_dwordx4 a[184:187], v2, s[12:15], s24 offen offset:2048
 v_mfma_f32_16x16x32_bf16 a[224:227], a[188:191], a[128:131], a[224:227]
 ds_write_b128 v6, v[16:19] offset:13312
 v_mfma_f32_16x16x32_bf16 a[228:231], a[188:191], a[132:135], a[228:231]
 v_accvgpr_read_b32 v20, a120
 v_lshlrev_b32 v21, 16, v20
 v_mfma_f32_16x16x32_bf16 a[232:235], a[188:191], a[136:139], a[232:235]
 v_and_b32 v20, s26, v20
 v_mfma_f32_16x16x32_bf16 a[236:239], a[188:191], a[140:143], a[236:239]
 buffer_load_dwordx4 a[188:191], v2, s[12:15], s24 offen offset:3072
 s_add_u32 s24, s24, 32768
 s_waitcnt vmcnt(14)
 s_waitcnt lgkmcnt(1)
 v_mfma_f32_16x16x32_bf16 v[32:35], a[192:195], a[144:147], v[32:35]
 v_mul_f32 v22, v21, v248
 v_mfma_f32_16x16x32_bf16 v[36:39], a[192:195], a[148:151], v[36:39]
 v_mul_f32 v23, v20, v249
 ds_read_b128 a[128:131], v3 offset:57344
 v_mfma_f32_16x16x32_bf16 v[40:43], a[192:195], a[152:155], v[40:43]
 v_cvt_pk_bf16_f32 v12, v22, v23
 v_mfma_f32_16x16x32_bf16 v[44:47], a[192:195], a[156:159], v[44:47]
 buffer_load_dwordx4 a[192:195], v1, s[12:15], s24 offen
 v_mfma_f32_16x16x32_bf16 v[48:51], a[196:199], a[144:147], v[48:51]
 v_accvgpr_read_b32 v24, a121
 v_mfma_f32_16x16x32_bf16 v[52:55], a[196:199], a[148:151], v[52:55]
 v_lshlrev_b32 v25, 16, v24
 ds_read_b128 a[132:135], v3 offset:58368
 v_mfma_f32_16x16x32_bf16 v[56:59], a[196:199], a[152:155], v[56:59]
 v_and_b32 v24, s26, v24
 v_mfma_f32_16x16x32_bf16 v[60:63], a[196:199], a[156:159], v[60:63]
 buffer_load_dwordx4 a[196:199], v1, s[12:15], s24 offen offset:1024
 s_waitcnt vmcnt(14)
 v_mfma_f32_16x16x32_bf16 v[64:67], a[200:203], a[144:147], v[64:67]
 v_mul_f32 v26, v25, v250
 v_mfma_f32_16x16x32_bf16 v[68:71], a[200:203], a[148:151], v[68:71]
 v_mul_f32 v27, v24, v251
 ds_read_b128 a[136:139], v3 offset:59392
 v_mfma_f32_16x16x32_bf16 v[72:75], a[200:203], a[152:155], v[72:75]
 v_cvt_pk_bf16_f32 v13, v26, v27
 v_mfma_f32_16x16x32_bf16 v[76:79], a[200:203], a[156:159], v[76:79]
 buffer_load_dwordx4 a[200:203], v1, s[12:15], s24 offen offset:2048
 v_mfma_f32_16x16x32_bf16 v[80:83], a[204:207], a[144:147], v[80:83]
 v_accvgpr_read_b32 v20, a122
 v_mfma_f32_16x16x32_bf16 v[84:87], a[204:207], a[148:151], v[84:87]
 v_accvgpr_read_b32 v22, a248
 ds_read_b128 a[140:143], v3 offset:60416
 v_mfma_f32_16x16x32_bf16 v[88:91], a[204:207], a[152:155], v[88:91]
 v_accvgpr_read_b32 v23, a249
 v_mfma_f32_16x16x32_bf16 v[92:95], a[204:207], a[156:159], v[92:95]
 buffer_load_dwordx4 a[204:207], v1, s[12:15], s24 offen offset:3072
 s_waitcnt vmcnt(14)
 v_mfma_f32_16x16x32_bf16 v[96:99], a[208:211], a[144:147], v[96:99]
 v_lshlrev_b32 v21, 16, v20
 v_mfma_f32_16x16x32_bf16 v[100:103], a[208:211], a[148:151], v[100:103]
 v_and_b32 v20, s26, v20
 v_mfma_f32_16x16x32_bf16 v[104:107], a[208:211], a[152:155], v[104:107]
 v_mul_f32 v22, v21, v22
 v_mul_f32 v23, v20, v23
 v_mfma_f32_16x16x32_bf16 v[108:111], a[208:211], a[156:159], v[108:111]
 buffer_load_dwordx4 a[208:211], v2, s[12:15], s24 offen
 v_mfma_f32_16x16x32_bf16 v[112:115], a[212:215], a[144:147], v[112:115]
 v_cvt_pk_bf16_f32 v14, v22, v23
 v_mfma_f32_16x16x32_bf16 v[116:119], a[212:215], a[148:151], v[116:119]
 v_accvgpr_read_b32 v24, a123
 v_accvgpr_read_b32 v26, a250
 v_mfma_f32_16x16x32_bf16 v[120:123], a[212:215], a[152:155], v[120:123]
 v_accvgpr_read_b32 v27, a251
 v_mfma_f32_16x16x32_bf16 v[124:127], a[212:215], a[156:159], v[124:127]
 buffer_load_dwordx4 a[212:215], v2, s[12:15], s24 offen offset:1024
 s_waitcnt vmcnt(14)
 v_mfma_f32_16x16x32_bf16 v[128:131], a[216:219], a[144:147], v[128:131]
 v_lshlrev_b32 v25, 16, v24
 v_mfma_f32_16x16x32_bf16 v[132:135], a[216:219], a[148:151], v[132:135]
 v_and_b32 v24, s26, v24
 v_mfma_f32_16x16x32_bf16 v[136:139], a[216:219], a[152:155], v[136:139]
 v_mul_f32 v26, v25, v26
 v_mul_f32 v27, v24, v27
 v_mfma_f32_16x16x32_bf16 v[140:143], a[216:219], a[156:159], v[140:143]
 buffer_load_dwordx4 a[216:219], v2, s[12:15], s24 offen offset:2048
 v_mfma_f32_16x16x32_bf16 a[224:227], a[220:223], a[144:147], a[224:227]
 v_cvt_pk_bf16_f32 v15, v26, v27
 v_mfma_f32_16x16x32_bf16 a[228:231], a[220:223], a[148:151], a[228:231]
 ds_write_b128 v6, v[12:15] offset:14336
 v_mfma_f32_16x16x32_bf16 a[232:235], a[220:223], a[152:155], a[232:235]
 v_accvgpr_read_b32 v20, a124
 v_lshlrev_b32 v21, 16, v20
 v_mfma_f32_16x16x32_bf16 a[236:239], a[220:223], a[156:159], a[236:239]
 buffer_load_dwordx4 a[220:223], v2, s[12:15], s24 offen offset:3072
 s_add_u32 s24, s24, 32768
 s_waitcnt vmcnt(14)
 s_waitcnt lgkmcnt(1)
 v_mfma_f32_16x16x32_bf16 v[32:35], a[160:163], a[128:131], v[32:35]
 v_and_b32 v20, s26, v20
 v_mfma_f32_16x16x32_bf16 v[36:39], a[160:163], a[132:135], v[36:39]
 ds_read_b128 a[144:147], v3 offset:61440
 v_mfma_f32_16x16x32_bf16 v[40:43], a[160:163], a[136:139], v[40:43]
 v_mul_f32 v22, v21, v252
 v_mul_f32 v23, v20, v253
 v_mfma_f32_16x16x32_bf16 v[44:47], a[160:163], a[140:143], v[44:47]
 buffer_load_dwordx4 a[160:163], v1, s[12:15], s24 offen
 v_mfma_f32_16x16x32_bf16 v[48:51], a[164:167], a[128:131], v[48:51]
 v_cvt_pk_bf16_f32 v16, v22, v23
 v_mfma_f32_16x16x32_bf16 v[52:55], a[164:167], a[132:135], v[52:55]
 ds_read_b128 a[148:151], v3 offset:62464
 v_mfma_f32_16x16x32_bf16 v[56:59], a[164:167], a[136:139], v[56:59]
 v_accvgpr_read_b32 v24, a125
 v_lshlrev_b32 v25, 16, v24
 v_mfma_f32_16x16x32_bf16 v[60:63], a[164:167], a[140:143], v[60:63]
 buffer_load_dwordx4 a[164:167], v1, s[12:15], s24 offen offset:1024
 s_waitcnt vmcnt(14)
 v_mfma_f32_16x16x32_bf16 v[64:67], a[168:171], a[128:131], v[64:67]
 v_and_b32 v24, s26, v24
 v_mfma_f32_16x16x32_bf16 v[68:71], a[168:171], a[132:135], v[68:71]
 ds_read_b128 a[152:155], v3 offset:63488
 v_mfma_f32_16x16x32_bf16 v[72:75], a[168:171], a[136:139], v[72:75]
 v_mul_f32 v26, v25, v254
 v_mul_f32 v27, v24, v255
 v_mfma_f32_16x16x32_bf16 v[76:79], a[168:171], a[140:143], v[76:79]
 buffer_load_dwordx4 a[168:171], v1, s[12:15], s24 offen offset:2048
 v_mfma_f32_16x16x32_bf16 v[80:83], a[172:175], a[128:131], v[80:83]
 v_cvt_pk_bf16_f32 v17, v26, v27
 v_mfma_f32_16x16x32_bf16 v[84:87], a[172:175], a[132:135], v[84:87]
 ds_read_b128 a[156:159], v3 offset:64512
 v_mfma_f32_16x16x32_bf16 v[88:91], a[172:175], a[136:139], v[88:91]
 v_accvgpr_read_b32 v20, a126
 v_accvgpr_read_b32 v22, a252
 v_mfma_f32_16x16x32_bf16 v[92:95], a[172:175], a[140:143], v[92:95]
 buffer_load_dwordx4 a[172:175], v1, s[12:15], s24 offen offset:3072
 s_waitcnt vmcnt(14)
 v_mfma_f32_16x16x32_bf16 v[96:99], a[176:179], a[128:131], v[96:99]
 v_accvgpr_read_b32 v23, a253
 v_mfma_f32_16x16x32_bf16 v[100:103], a[176:179], a[132:135], v[100:103]
 v_lshlrev_b32 v21, 16, v20
 v_mfma_f32_16x16x32_bf16 v[104:107], a[176:179], a[136:139], v[104:107]
 v_and_b32 v20, s26, v20
 v_mfma_f32_16x16x32_bf16 v[108:111], a[176:179], a[140:143], v[108:111]
 v_mul_f32 v22, v21, v22
 buffer_load_dwordx4 a[176:179], v2, s[12:15], s24 offen
 v_mfma_f32_16x16x32_bf16 v[112:115], a[180:183], a[128:131], v[112:115]
 v_mul_f32 v23, v20, v23
 v_mfma_f32_16x16x32_bf16 v[116:119], a[180:183], a[132:135], v[116:119]
 v_cvt_pk_bf16_f32 v18, v22, v23
 v_mfma_f32_16x16x32_bf16 v[120:123], a[180:183], a[136:139], v[120:123]
 v_accvgpr_read_b32 v24, a127
 v_accvgpr_read_b32 v26, a254
 v_mfma_f32_16x16x32_bf16 v[124:127], a[180:183], a[140:143], v[124:127]
 buffer_load_dwordx4 a[180:183], v2, s[12:15], s24 offen offset:1024
 s_waitcnt vmcnt(14)
 v_mfma_f32_16x16x32_bf16 v[128:131], a[184:187], a[128:131], v[128:131]
 v_accvgpr_read_b32 v27, a255
 v_mfma_f32_16x16x32_bf16 v[132:135], a[184:187], a[132:135], v[132:135]
 v_lshlrev_b32 v25, 16, v24
 v_mfma_f32_16x16x32_bf16 v[136:139], a[184:187], a[136:139], v[136:139]
 v_and_b32 v24, s26, v24
 v_mfma_f32_16x16x32_bf16 v[140:143], a[184:187], a[140:143], v[140:143]
 v_mul_f32 v26, v25, v26
 buffer_load_dwordx4 a[184:187], v2, s[12:15], s24 offen offset:2048
 v_mfma_f32_16x16x32_bf16 a[224:227], a[188:191], a[128:131], a[224:227]
 v_mul_f32 v27, v24, v27
 v_mfma_f32_16x16x32_bf16 a[228:231], a[188:191], a[132:135], a[228:231]
 v_cvt_pk_bf16_f32 v19, v26, v27
 v_mfma_f32_16x16x32_bf16 a[232:235], a[188:191], a[136:139], a[232:235]
 ds_write_b128 v6, v[16:19] offset:15360
 v_mfma_f32_16x16x32_bf16 a[236:239], a[188:191], a[140:143], a[236:239]
 buffer_load_dwordx4 a[188:191], v2, s[12:15], s24 offen offset:3072
 s_add_u32 s24, s24, 32768
 s_waitcnt vmcnt(14)
 s_waitcnt lgkmcnt(0)
 s_barrier
 v_mfma_f32_16x16x32_bf16 v[32:35], a[192:195], a[144:147], v[32:35]
 v_mfma_f32_16x16x32_bf16 v[36:39], a[192:195], a[148:151], v[36:39]
 ds_read_b128 a[128:131], v4
 v_mfma_f32_16x16x32_bf16 v[40:43], a[192:195], a[152:155], v[40:43]
 v_mfma_f32_16x16x32_bf16 v[44:47], a[192:195], a[156:159], v[44:47]
 buffer_load_dwordx4 a[192:195], v1, s[12:15], s24 offen
 v_mfma_f32_16x16x32_bf16 v[48:51], a[196:199], a[144:147], v[48:51]
 v_mfma_f32_16x16x32_bf16 v[52:55], a[196:199], a[148:151], v[52:55]
 ds_read_b128 a[132:135], v4 offset:1024
 v_mfma_f32_16x16x32_bf16 v[56:59], a[196:199], a[152:155], v[56:59]
 v_mfma_f32_16x16x32_bf16 v[60:63], a[196:199], a[156:159], v[60:63]
 buffer_load_dwordx4 a[196:199], v1, s[12:15], s24 offen offset:1024
 s_waitcnt vmcnt(14)
 v_mfma_f32_16x16x32_bf16 v[64:67], a[200:203], a[144:147], v[64:67]
 v_mfma_f32_16x16x32_bf16 v[68:71], a[200:203], a[148:151], v[68:71]
 ds_read_b128 a[136:139], v4 offset:2048
 v_mfma_f32_16x16x32_bf16 v[72:75], a[200:203], a[152:155], v[72:75]
 v_mfma_f32_16x16x32_bf16 v[76:79], a[200:203], a[156:159], v[76:79]
 buffer_load_dwordx4 a[200:203], v1, s[12:15], s24 offen offset:2048
 v_mfma_f32_16x16x32_bf16 v[80:83], a[204:207], a[144:147], v[80:83]
 v_mfma_f32_16x16x32_bf16 v[84:87], a[204:207], a[148:151], v[84:87]
 ds_read_b128 a[140:143], v4 offset:3072
 v_mfma_f32_16x16x32_bf16 v[88:91], a[204:207], a[152:155], v[88:91]
 v_mfma_f32_16x16x32_bf16 v[92:95], a[204:207], a[156:159], v[92:95]
 buffer_load_dwordx4 a[204:207], v1, s[12:15], s24 offen offset:3072
 s_waitcnt vmcnt(14)
 v_mfma_f32_16x16x32_bf16 v[96:99], a[208:211], a[144:147], v[96:99]
 v_mfma_f32_16x16x32_bf16 v[100:103], a[208:211], a[148:151], v[100:103]
 v_mfma_f32_16x16x32_bf16 v[104:107], a[208:211], a[152:155], v[104:107]
 v_mfma_f32_16x16x32_bf16 v[108:111], a[208:211], a[156:159], v[108:111]
 buffer_load_dwordx4 a[208:211], v2, s[12:15], s24 offen
 v_mfma_f32_16x16x32_bf16 v[112:115], a[212:215], a[144:147], v[112:115]
 v_mfma_f32_16x16x32_bf16 v[116:119], a[212:215], a[148:151], v[116:119]
 v_mfma_f32_16x16x32_bf16 v[120:123], a[212:215], a[152:155], v[120:123]
 v_mfma_f32_16x16x32_bf16 v[124:127], a[212:215], a[156:159], v[124:127]
 buffer_load_dwordx4 a[212:215], v2, s[12:15], s24 offen offset:1024
 s_waitcnt vmcnt(14)
 v_mfma_f32_16x16x32_bf16 v[128:131], a[216:219], a[144:147], v[128:131]
 v_mfma_f32_16x16x32_bf16 v[132:135], a[216:219], a[148:151], v[132:135]
 v_mfma_f32_16x16x32_bf16 v[136:139], a[216:219], a[152:155], v[136:139]
 v_mfma_f32_16x16x32_bf16 v[140:143], a[216:219], a[156:159], v[140:143]
 buffer_load_dwordx4 a[216:219], v2, s[12:15], s24 offen offset:2048
 v_mfma_f32_16x16x32_bf16 a[224:227], a[220:223], a[144:147], a[224:227]
 v_mfma_f32_16x16x32_bf16 a[228:231], a[220:223], a[148:151], a[228:231]
 v_mfma_f32_16x16x32_bf16 a[232:235], a[220:223], a[152:155], a[232:235]
 v_mfma_f32_16x16x32_bf16 a[236:239], a[220:223], a[156:159], a[236:239]
 buffer_load_dwordx4 a[220:223], v2, s[12:15], s24 offen offset:3072
 s_add_u32 s24, s24, 32768
 s_waitcnt vmcnt(14)
 s_waitcnt lgkmcnt(0)
 s_branch Lloop
Llast:
 v_mfma_f32_16x16x32_bf16 v[144:147], a[160:163], a[128:131], v[144:147]
 v_accvgpr_read_b32 v20, a0
 v_lshlrev_b32 v21, 16, v20
 v_mfma_f32_16x16x32_bf16 v[148:151], a[160:163], a[132:135], v[148:151]
 ds_read_b128 a[144:147], v4 offset:4096
 v_mfma_f32_16x16x32_bf16 v[152:155], a[160:163], a[136:139], v[152:155]
 v_and_b32 v20, s26, v20
 v_mfma_f32_16x16x32_bf16 v[156:159], a[160:163], a[140:143], v[156:159]
 buffer_load_dwordx4 a[160:163], v1, s[12:15], s24 offen
 v_mfma_f32_16x16x32_bf16 v[160:163], a[164:167], a[128:131], v[160:163]
 v_mul_f32 v22, v21, v32
 v_mfma_f32_16x16x32_bf16 v[164:167], a[164:167], a[132:135], v[164:167]
 v_mul_f32 v23, v20, v33
 ds_read_b128 a[148:151], v4 offset:5120
 v_mfma_f32_16x16x32_bf16 v[168:171], a[164:167], a[136:139], v[168:171]
 v_cvt_pk_bf16_f32 v12, v22, v23
 v_mfma_f32_16x16x32_bf16 v[172:175], a[164:167], a[140:143], v[172:175]
 buffer_load_dwordx4 a[164:167], v1, s[12:15], s24 offen offset:1024
 s_waitcnt vmcnt(14)
 v_mfma_f32_16x16x32_bf16 v[176:179], a[168:171], a[128:131], v[176:179]
 v_accvgpr_read_b32 v24, a1
 v_mfma_f32_16x16x32_bf16 v[180:183], a[168:171], a[132:135], v[180:183]
 ds_read_b128 a[152:155], v4 offset:6144
 v_mfma_f32_16x16x32_bf16 v[184:187], a[168:171], a[136:139], v[184:187]
 v_lshlrev_b32 v25, 16, v24
 v_mfma_f32_16x16x32_bf16 v[188:191], a[168:171], a[140:143], v[188:191]
 v_and_b32 v24, s26, v24
 buffer_load_dwordx4 a[168:171], v1, s[12:15], s24 offen offset:2048
 v_mfma_f32_16x16x32_bf16 v[192:195], a[172:175], a[128:131], v[192:195]
 v_mul_f32 v26, v25, v34
 v_mfma_f32_16x16x32_bf16 v[196:199], a[172:175], a[132:135], v[196:199]
 ds_read_b128 a[156:159], v4 offset:7168
 v_mfma_f32_16x16x32_bf16 v[200:203], a[172:175], a[136:139], v[200:203]
 v_mul_f32 v27, v24, v35
 v_mfma_f32_16x16x32_bf16 v[204:207], a[172:175], a[140:143], v[204:207]
 buffer_load_dwordx4 a[172:175], v1, s[12:15], s24 offen offset:3072
 s_waitcnt vmcnt(14)
 v_mfma_f32_16x16x32_bf16 v[208:211], a[176:179], a[128:131], v[208:211]
 v_cvt_pk_bf16_f32 v13, v26, v27
 v_mfma_f32_16x16x32_bf16 v[212:215], a[176:179], a[132:135], v[212:215]
 v_accvgpr_read_b32 v20, a2
 v_mfma_f32_16x16x32_bf16 v[216:219], a[176:179], a[136:139], v[216:219]
 v_lshlrev_b32 v21, 16, v20
 v_and_b32 v20, s26, v20
 v_mfma_f32_16x16x32_bf16 v[220:223], a[176:179], a[140:143], v[220:223]
 buffer_load_dwordx4 a[176:179], v2, s[12:15], s24 offen
 v_mfma_f32_16x16x32_bf16 v[224:227], a[180:183], a[128:131], v[224:227]
 v_mul_f32 v22, v21, v48
 v_mfma_f32_16x16x32_bf16 v[228:231], a[180:183], a[132:135], v[228:231]
 v_mul_f32 v23, v20, v49
 v_mfma_f32_16x16x32_bf16 v[232:235], a[180:183], a[136:139], v[232:235]
 v_cvt_pk_bf16_f32 v14, v22, v23
 v_mfma_f32_16x16x32_bf16 v[236:239], a[180:183], a[140:143], v[236:239]
 buffer_load_dwordx4 a[180:183], v2, s[12:15], s24 offen offset:1024
 s_waitcnt vmcnt(14)
 v_mfma_f32_16x16x32_bf16 v[240:243], a[184:187], a[128:131], v[240:243]
 v_accvgpr_read_b32 v24, a3
 v_lshlrev_b32 v25, 16, v24
 v_mfma_f32_16x16x32_bf16 v[244:247], a[184:187], a[132:135], v[244:247]
 v_and_b32 v24, s26, v24
 v_mfma_f32_16x16x32_bf16 v[248:251], a[184:187], a[136:139], v[248:251]
 v_mul_f32 v26, v25, v50
 v_mfma_f32_16x16x32_bf16 v[252:255], a[184:187], a[140:143], v[252:255]
 buffer_load_dwordx4 a[184:187], v2, s[12:15], s24 offen offset:2048
 v_mfma_f32_16x16x32_bf16 a[240:243], a[188:191], a[128:131], a[240:243]
 v_mul_f32 v27, v24, v51
 v_mfma_f32_16x16x32_bf16 a[244:247], a[188:191], a[132:135], a[244:247]
 v_cvt_pk_bf16_f32 v15, v26, v27
 v_mfma_f32_16x16x32_bf16 a[248:251], a[188:191], a[136:139], a[248:251]
 buffer_store_dwordx4 v[12:15], v8, s[16:19], s28 offen
 v_accvgpr_read_b32 v20, a4
 v_mfma_f32_16x16x32_bf16 a[252:255], a[188:191], a[140:143], a[252:255]
 buffer_load_dwordx4 a[188:191], v2, s[12:15], s24 offen offset:3072
 s_add_u32 s24, s24, 32768
 s_waitcnt vmcnt(15)
 s_waitcnt lgkmcnt(0)
 v_mfma_f32_16x16x32_bf16 v[144:147], a[192:195], a[144:147], v[144:147]
 v_lshlrev_b32 v21, 16, v20
 v_mfma_f32_16x16x32_bf16 v[148:151], a[192:195], a[148:151], v[148:151]
 ds_read_b128 a[128:131], v4 offset:8192
 v_mfma_f32_16x16x32_bf16 v[152:155], a[192:195], a[152:155], v[152:155]
 v_and_b32 v20, s26, v20
 v_mfma_f32_16x16x32_bf16 v[156:159], a[192:195], a[156:159], v[156:159]
 buffer_load_dwordx4 a[192:195], v1, s[12:15], s24 offen
 v_mfma_f32_16x16x32_bf16 v[160:163], a[196:199], a[144:147], v[160:163]
 v_mul_f32 v22, v21, v36
 v_mul_f32 v23, v20, v37
 v_mfma_f32_16x16x32_bf16 v[164:167], a[196:199], a[148:151], v[164:167]
 ds_read_b128 a[132:135], v4 offset:9216
 v_mfma_f32_16x16x32_bf16 v[168:171], a[196:199], a[152:155], v[168:171]
 v_cvt_pk_bf16_f32 v16, v22, v23
 v_mfma_f32_16x16x32_bf16 v[172:175], a[196:199], a[156:159], v[172:175]
 buffer_load_dwordx4 a[196:199], v1, s[12:15], s24 offen offset:1024
 s_waitcnt vmcnt(15)
 v_mfma_f32_16x16x32_bf16 v[176:179], a[200:203], a[144:147], v[176:179]
 v_accvgpr_read_b32 v24, a5
 v_mfma_f32_16x16x32_bf16 v[180:183], a[200:203], a[148:151], v[180:183]
 ds_read_b128 a[136:139], v4 offset:10240
 v_mfma_f32_16x16x32_bf16 v[184:187], a[200:203], a[152:155], v[184:187]
 v_lshlrev_b32 v25, 16, v24
 v_and_b32 v24, s26, v24
 v_mfma_f32_16x16x32_bf16 v[188:191], a[200:203], a[156:159], v[188:191]
 buffer_load_dwordx4 a[200:203], v1, s[12:15], s24 offen offset:2048
 v_mfma_f32_16x16x32_bf16 v[192:195], a[204:207], a[144:147], v[192:195]
 v_mul_f32 v26, v25, v38
 v_mfma_f32_16x16x32_bf16 v[196:199], a[204:207], a[148:151], v[196:199]
 ds_read_b128 a[140:143], v4 offset:11264
 v_mfma_f32_16x16x32_bf16 v[200:203], a[204:207], a[152:155], v[200:203]
 v_mul_f32 v27, v24, v39
 v_mfma_f32_16x16x32_bf16 v[204:207], a[204:207], a[156:159], v[204:207]
 buffer_load_dwordx4 a[204:207], v1, s[12:15], s24 offen offset:3072
 s_waitcnt vmcnt(15)
 v_mfma_f32_16x16x32_bf16 v[208:211], a[208:211], a[144:147], v[208:211]
 v_cvt_pk_bf16_f32 v17, v26, v27
 v_mfma_f32_16x16x32_bf16 v[212:215], a[208:211], a[148:151], v[212:215]
 v_accvgpr_read_b32 v20, a6
 v_lshlrev_b32 v21, 16, v20
 v_mfma_f32_16x16x32_bf16 v[216:219], a[208:211], a[152:155], v[216:219]
 v_and_b32 v20, s26, v20
 v_mfma_f32_16x16x32_bf16 v[220:223], a[208:211], a[156:159], v[220:223]
 buffer_load_dwordx4 a[208:211], v2, s[12:15], s24 offen
 v_mfma_f32_16x16x32_bf16 v[224:227], a[212:215], a[144:147], v[224:227]
 v_mul_f32 v22, v21, v52
 v_mfma_f32_16x16x32_bf16 v[228:231], a[212:215], a[148:151], v[228:231]
 v_mul_f32 v23, v20, v53
 v_mfma_f32_16x16x32_bf16 v[232:235], a[212:215], a[152:155], v[232:235]
 v_cvt_pk_bf16_f32 v18, v22, v23
 v_accvgpr_read_b32 v24, a7
 v_mfma_f32_16x16x32_bf16 v[236:239], a[212:215], a[156:159], v[236:239]
 buffer_load_dwordx4 a[212:215], v2, s[12:15], s24 offen offset:1024
 s_waitcnt vmcnt(15)
 v_mfma_f32_16x16x32_bf16 v[240:243], a[216:219], a[144:147], v[240:243]
 v_lshlrev_b32 v25, 16, v24
 v_mfma_f32_16x16x32_bf16 v[244:247], a[216:219], a[148:151], v[244:247]
 v_and_b32 v24, s26, v24
 v_mfma_f32_16x16x32_bf16 v[248:251], a[216:219], a[152:155], v[248:251]
 v_mul_f32 v26, v25, v54
 v_mfma_f32_16x16x32_bf16 v[252:255], a[216:219], a[156:159], v[252:255]
 buffer_load_dwordx4 a[216:219], v2, s[12:15], s24 offen offset:2048
 v_mfma_f32_16x16x32_bf16 a[240:243], a[220:223], a[144:147], a[240:243]
 v_mul_f32 v27, v24, v55
 v_mfma_f32_16x16x32_bf16 a[244:247], a[220:223], a[148:151], a[244:247]
 v_cvt_pk_bf16_f32 v19, v26, v27
 buffer_store_dwordx4 v[16:19], v8, s[16:19], s29 offen
 v_mfma_f32_16x16x32_bf16 a[248:251], a[220:223], a[152:155], a[248:251]
 v_accvgpr_read_b32 v20, a8
 v_mfma_f32_16x16x32_bf16 a[252:255], a[220:223], a[156:159], a[252:255]
 buffer_load_dwordx4 a[220:223], v2, s[12:15], s24 offen offset:3072
 s_add_u32 s24, s24, 32768
 s_waitcnt vmcnt(16)
 s_waitcnt lgkmcnt(0)
 v_mfma_f32_16x16x32_bf16 v[144:147], a[160:163], a[128:131], v[144:147]
 v_lshlrev_b32 v21, 16, v20
 v_mfma_f32_16x16x32_bf16 v[148:151], a[160:163], a[132:135], v[148:151]
 ds_read_b128 a[144:147], v4 offset:12288
 v_mfma_f32_16x16x32_bf16 v[152:155], a[160:163], a[136:139], v[152:155]
 v_and_b32 v20, s26, v20
 v_mfma_f32_16x16x32_bf16 v[156:159], a[160:163], a[140:143], v[156:159]
 v_mul_f32 v22, v21, v40
 buffer_load_dwordx4 a[160:163], v1, s[12:15], s24 offen
 v_mfma_f32_16x16x32_bf16 v[160:163], a[164:167], a[128:131], v[160:163]
 v_mul_f32 v23, v20, v41
 v_mfma_f32_16x16x32_bf16 v[164:167], a[164:167], a[132:135], v[164:167]
 ds_read_b128 a[148:151], v4 offset:13312
 v_mfma_f32_16x16x32_bf16 v[168:171], a[164:167], a[136:139], v[168:171]
 v_cvt_pk_bf16_f32 v12, v22, v23
 v_mfma_f32_16x16x32_bf16 v[172:175], a[164:167], a[140:143], v[172:175]
 buffer_load_dwordx4 a[164:167], v1, s[12:15], s24 offen offset:1024
 s_waitcnt vmcnt(16)
 v_mfma_f32_16x16x32_bf16 v[176:179], a[168:171], a[128:131], v[176:179]
 v_accvgpr_read_b32 v24, a9
 v_mfma_f32_16x16x32_bf16 v[180:183], a[168:171], a[132:135], v[180:183]
 v_lshlrev_b32 v25, 16, v24
 ds_read_b128 a[152:155], v4 offset:14336
 v_mfma_f32_16x16x32_bf16 v[184:187], a[168:171], a[136:139], v[184:187]
 v_and_b32 v24, s26, v24
 v_mfma_f32_16x16x32_bf16 v[188:191], a[168:171], a[140:143], v[188:191]
 buffer_load_dwordx4 a[168:171], v1, s[12:15], s24 offen offset:2048
 v_mfma_f32_16x16x32_bf16 v[192:195], a[172:175], a[128:131], v[192:195]
 v_mul_f32 v26, v25, v42
 v_mfma_f32_16x16x32_bf16 v[196:199], a[172:175], a[132:135], v[196:199]
 ds_read_b128 a[156:159], v4 offset:15360
 v_mfma_f32_16x16x32_bf16 v[200:203], a[172:175], a[136:139], v[200:203]
 v_mul_f32 v27, v24, v43
 v_mfma_f32_16x16x32_bf16 v[204:207], a[172:175], a[140:143], v[204:207]
 buffer_load_dwordx4 a[172:175], v1, s[12:15], s24 offen offset:3072
 s_waitcnt vmcnt(16)
 v_mfma_f32_16x16x32_bf16 v[208:211], a[176:179], a[128:131], v[208:211]
 v_cvt_pk_bf16_f32 v13, v26, v27
 v_accvgpr_read_b32 v20, a10
 v_mfma_f32_16x16x32_bf16 v[212:215], a[176:179], a[132:135], v[212:215]
 v_lshlrev_b32 v21, 16, v20
 v_mfma_f32_16x16x32_bf16 v[216:219], a[176:179], a[136:139], v[216:219]
 v_and_b32 v20, s26, v20
 v_mfma_f32_16x16x32_bf16 v[220:223], a[176:179], a[140:143], v[220:223]
 buffer_load_dwordx4 a[176:179], v2, s[12:15], s24 offen
 v_mfma_f32_16x16x32_bf16 v[224:227], a[180:183], a[128:131], v[224:227]
 v_mul_f32 v22, v21, v56
 v_mfma_f32_16x16x32_bf16 v[228:231], a[180:183], a[132:135], v[228:231]
 v_mul_f32 v23, v20, v57
 v_cvt_pk_bf16_f32 v14, v22, v23
 v_mfma_f32_16x16x32_bf16 v[232:235], a[180:183], a[136:139], v[232:235]
 v_accvgpr_read_b32 v24, a11
 v_mfma_f32_16x16x32_bf16 v[236:239], a[180:183], a[140:143], v[236:239]
 buffer_load_dwordx4 a[180:183], v2, s[12:15], s24 offen offset:1024
 s_waitcnt vmcnt(15)
 v_mfma_f32_16x16x32_bf16 v[240:243], a[184:187], a[128:131], v[240:243]
 v_lshlrev_b32 v25, 16, v24
 v_mfma_f32_16x16x32_bf16 v[244:247], a[184:187], a[132:135], v[244:247]
 v_and_b32 v24, s26, v24
 v_mfma_f32_16x16x32_bf16 v[248:251], a[184:187], a[136:139], v[248:251]
 v_mul_f32 v26, v25, v58
 v_mfma_f32_16x16x32_bf16 v[252:255], a[184:187], a[140:143], v[252:255]
 buffer_load_dwordx4 a[184:187], v2, s[12:15], s24 offen offset:2048
 v_mfma_f32_16x16x32_bf16 a[240:243], a[188:191], a[128:131], a[240:243]
 v_mul_f32 v27, v24, v59
 v_cvt_pk_bf16_f32 v15, v26, v27
 v_mfma_f32_16x16x32_bf16 a[244:247], a[188:191], a[132:135], a[244:247]
 buffer_store_dwordx4 v[12:15], v8, s[16:19], s30 offen
 v_mfma_f32_16x16x32_bf16 a[248:251], a[188:191], a[136:139], a[248:251]
 v_accvgpr_read_b32 v20, a12
 v_mfma_f32_16x16x32_bf16 a[252:255], a[188:191], a[140:143], a[252:255]
 buffer_load_dwordx4 a[188:191], v2, s[12:15], s24 offen offset:3072
 s_add_u32 s24, s24, 32768
 s_waitcnt vmcnt(16)
 s_waitcnt lgkmcnt(0)
 v_mfma_f32_16x16x32_bf16 v[144:147], a[192:195], a[144:147], v[144:147]
 v_lshlrev_b32 v21, 16, v20
 v_mfma_f32_16x16x32_bf16 v[148:151], a[192:195], a[148:151], v[148:151]
 ds_read_b128 a[128:131], v4 offset:16384
 v_mfma_f32_16x16x32_bf16 v[152:155], a[192:195], a[152:155], v[152:155]
 v_and_b32 v20, s26, v20
 v_mul_f32 v22, v21, v44
 v_mfma_f32_16x16x32_bf16 v[156:159], a[192:195], a[156:159], v[156:159]
 buffer_load_dwordx4 a[192:195], v1, s[12:15], s24 offen
 v_mfma_f32_16x16x32_bf16 v[160:163], a[196:199], a[144:147], v[160:163]
 v_mul_f32 v23, v20, v45
 v_mfma_f32_16x16x32_bf16 v[164:167], a[196:199], a[148:151], v[164:167]
 ds_read_b128 a[132:135], v4 offset:17408
 v_mfma_f32_16x16x32_bf16 v[168:171], a[196:199], a[152:155], v[168:171]
 v_cvt_pk_bf16_f32 v16, v22, v23
 v_mfma_f32_16x16x32_bf16 v[172:175], a[196:199], a[156:159], v[172:175]
 buffer_load_dwordx4 a[196:199], v1, s[12:15], s24 offen offset:1024
 s_waitcnt vmcnt(16)
 v_mfma_f32_16x16x32_bf16 v[176:179], a[200:203], a[144:147], v[176:179]
 v_accvgpr_read_b32 v24, a13
 v_lshlrev_b32 v25, 16, v24
 v_mfma_f32_16x16x32_bf16 v[180:183], a[200:203], a[148:151], v[180:183]
 ds_read_b128 a[136:139], v4 offset:18432
 v_mfma_f32_16x16x32_bf16 v[184:187], a[200:203], a[152:155], v[184:187]
 v_and_b32 v24, s26, v24
 v_mfma_f32_16x16x32_bf16 v[188:191], a[200:203], a[156:159], v[188:191]
 buffer_load_dwordx4 a[200:203], v1, s[12:15], s24 offen offset:2048
 v_mfma_f32_16x16x32_bf16 v[192:195], a[204:207], a[144:147], v[192:195]
 v_mul_f32 v26, v25, v46
 v_mfma_f32_16x16x32_bf16 v[196:199], a[204:207], a[148:151], v[196:199]
 ds_read_b128 a[140:143], v4 offset:19456
 v_mfma_f32_16x16x32_bf16 v[200:203], a[204:207], a[152:155], v[200:203]
 v_mul_f32 v27, v24, v47
 v_cvt_pk_bf16_f32 v17, v26, v27
 v_mfma_f32_16x16x32_bf16 v[204:207], a[204:207], a[156:159], v[204:207]
 buffer_load_dwordx4 a[204:207], v1, s[12:15], s24 offen offset:3072
 s_waitcnt vmcnt(16)
 v_mfma_f32_16x16x32_bf16 v[208:211], a[208:211], a[144:147], v[208:211]
 v_accvgpr_read_b32 v20, a14
 v_mfma_f32_16x16x32_bf16 v[212:215], a[208:211], a[148:151], v[212:215]
 v_lshlrev_b32 v21, 16, v20
 v_mfma_f32_16x16x32_bf16 v[216:219], a[208:211], a[152:155], v[216:219]
 v_and_b32 v20, s26, v20
 v_mfma_f32_16x16x32_bf16 v[220:223], a[208:211], a[156:159], v[220:223]
 buffer_load_dwordx4 a[208:211], v2, s[12:15], s24 offen
 v_mfma_f32_16x16x32_bf16 v[224:227], a[212:215], a[144:147], v[224:227]
 v_mul_f32 v22, v21, v60
 v_mul_f32 v23, v20, v61
 v_mfma_f32_16x16x32_bf16 v[228:231], a[212:215], a[148:151], v[228:231]
 v_cvt_pk_bf16_f32 v18, v22, v23
 v_mfma_f32_16x16x32_bf16 v[232:235], a[212:215], a[152:155], v[232:235]
 v_accvgpr_read_b32 v24, a15
 v_mfma_f32_16x16x32_bf16 v[236:239], a[212:215], a[156:159], v[236:239]
 buffer_load_dwordx4 a[212:215], v2, s[12:15], s24 offen offset:1024
 s_waitcnt vmcnt(15)
 v_mfma_f32_16x16x32_bf16 v[240:243], a[216:219], a[144:147], v[240:243]
 v_lshlrev_b32 v25, 16, v24
 v_mfma_f32_16x16x32_bf16 v[244:247], a[216:219], a[148:151], v[244:247]
 v_and_b32 v24, s26, v24
 v_mfma_f32_16x16x32_bf16 v[248:251], a[216:219], a[152:155], v[248:251]
 v_mul_f32 v26, v25, v62
 v_mfma_f32_16x16x32_bf16 v[252:255], a[216:219], a[156:159], v[252:255]
 v_mul_f32 v27, v24, v63
 buffer_load_dwordx4 a[216:219], v2, s[12:15], s24 offen offset:2048
 v_mfma_f32_16x16x32_bf16 a[240:243], a[220:223], a[144:147], a[240:243]
 v_cvt_pk_bf16_f32 v19, v26, v27
 v_mfma_f32_16x16x32_bf16 a[244:247], a[220:223], a[148:151], a[244:247]
 buffer_store_dwordx4 v[16:19], v8, s[16:19], s31 offen
 v_mfma_f32_16x16x32_bf16 a[248:251], a[220:223], a[152:155], a[248:251]
 v_accvgpr_read_b32 v20, a16
 v_mfma_f32_16x16x32_bf16 a[252:255], a[220:223], a[156:159], a[252:255]
 buffer_load_dwordx4 a[220:223], v2, s[12:15], s24 offen offset:3072
 s_add_u32 s24, s24, 32768
 s_waitcnt vmcnt(16)
 s_waitcnt lgkmcnt(0)
 v_mfma_f32_16x16x32_bf16 v[144:147], a[160:163], a[128:131], v[144:147]
 v_lshlrev_b32 v21, 16, v20
 v_mfma_f32_16x16x32_bf16 v[148:151], a[160:163], a[132:135], v[148:151]
 v_and_b32 v20, s26, v20
 ds_read_b128 a[144:147], v4 offset:20480
 v_mfma_f32_16x16x32_bf16 v[152:155], a[160:163], a[136:139], v[152:155]
 v_mul_f32 v22, v21, v64
 v_mfma_f32_16x16x32_bf16 v[156:159], a[160:163], a[140:143], v[156:159]
 buffer_load_dwordx4 a[160:163], v1, s[12:15], s24 offen
 v_mfma_f32_16x16x32_bf16 v[160:163], a[164:167], a[128:131], v[160:163]
 v_mul_f32 v23, v20, v65
 v_mfma_f32_16x16x32_bf16 v[164:167], a[164:167], a[132:135], v[164:167]
 ds_read_b128 a[148:151], v4 offset:21504
 v_mfma_f32_16x16x32_bf16 v[168:171], a[164:167], a[136:139], v[168:171]
 v_cvt_pk_bf16_f32 v12, v22, v23
 v_accvgpr_read_b32 v24, a17
 v_mfma_f32_16x16x32_bf16 v[172:175], a[164:167], a[140:143], v[172:175]
 buffer_load_dwordx4 a[164:167], v1, s[12:15], s24 offen offset:1024
 s_waitcnt vmcnt(16)
 v_mfma_f32_16x16x32_bf16 v[176:179], a[168:171], a[128:131], v[176:179]
 v_lshlrev_b32 v25, 16, v24
 v_mfma_f32_16x16x32_bf16 v[180:183], a[168:171], a[132:135], v[180:183]
 ds_read_b128 a[152:155], v4 offset:22528
 v_mfma_f32_16x16x32_bf16 v[184:187], a[168:171], a[136:139], v[184:187]
 v_and_b32 v24, s26, v24
 v_mfma_f32_16x16x32_bf16 v[188:191], a[168:171], a[140:143], v[188:191]
 buffer_load_dwordx4 a[168:171], v1, s[12:15], s24 offen offset:2048
 v_mfma_f32_16x16x32_bf16 v[192:195], a[172:175], a[128:131], v[192:195]
 v_mul_f32 v26, v25, v66
 v_mfma_f32_16x16x32_bf16 v[196:199], a[172:175], a[132:135], v[196:199]
 v_mul_f32 v27, v24, v67
 ds_read_b128 a[156:159], v4 offset:23552
 v_mfma_f32_16x16x32_bf16 v[200:203], a[172:175], a[136:139], v[200:203]
 v_cvt_pk_bf16_f32 v13, v26, v27
 v_mfma_f32_16x16x32_bf16 v[204:207], a[172:175], a[140:143], v[204:207]
 buffer_load_dwordx4 a[172:175], v1, s[12:15], s24 offen offset:3072
 s_waitcnt vmcnt(16)
 v_mfma_f32_16x16x32_bf16 v[208:211], a[176:179], a[128:131], v[208:211]
 v_accvgpr_read_b32 v20, a18
 v_mfma_f32_16x16x32_bf16 v[212:215], a[176:179], a[132:135], v[212:215]
 v_lshlrev_b32 v21, 16, v20
 v_mfma_f32_16x16x32_bf16 v[216:219], a[176:179], a[136:139], v[216:219]
 v_and_b32 v20, s26, v20
 v_mfma_f32_16x16x32_bf16 v[220:223], a[176:179], a[140:143], v[220:223]
 v_mul_f32 v22, v21, v80
 buffer_load_dwordx4 a[176:179], v2, s[12:15], s24 offen
 v_mfma_f32_16x16x32_bf16 v[224:227], a[180:183], a[128:131], v[224:227]
 v_mul_f32 v23, v20, v81
 v_mfma_f32_16x16x32_bf16 v[228:231], a[180:183], a[132:135], v[228:231]
 v_cvt_pk_bf16_f32 v14, v22, v23
 v_mfma_f32_16x16x32_bf16 v[232:235], a[180:183], a[136:139], v[232:235]
 v_accvgpr_read_b32 v24, a19
 v_mfma_f32_16x16x32_bf16 v[236:239], a[180:183], a[140:143], v[236:239]
 buffer_load_dwordx4 a[180:183], v2, s[12:15], s24 offen offset:1024
 s_waitcnt vmcnt(15)
 v_mfma_f32_16x16x32_bf16 v[240:243], a[184:187], a[128:131], v[240:243]
 v_lshlrev_b32 v25, 16, v24
 v_mfma_f32_16x16x32_bf16 v[244:247], a[184:187], a[132:135], v[244:247]
 v_and_b32 v24, s26, v24
 v_mfma_f32_16x16x32_bf16 v[248:251], a[184:187], a[136:139], v[248:251]
 v_mul_f32 v26, v25, v82
 v_mul_f32 v27, v24, v83
 v_mfma_f32_16x16x32_bf16 v[252:255], a[184:187], a[140:143], v[252:255]
 buffer_load_dwordx4 a[184:187], v2, s[12:15], s24 offen offset:2048
 v_mfma_f32_16x16x32_bf16 a[240:243], a[188:191], a[128:131], a[240:243]
 v_cvt_pk_bf16_f32 v15, v26, v27
 v_mfma_f32_16x16x32_bf16 a[244:247], a[188:191], a[132:135], a[244:247]
 buffer_store_dwordx4 v[12:15], v8, s[16:19], s28 offen offset:64
 v_mfma_f32_16x16x32_bf16 a[248:251], a[188:191], a[136:139], a[248:251]
 v_accvgpr_read_b32 v20, a20
 v_mfma_f32_16x16x32_bf16 a[252:255], a[188:191], a[140:143], a[252:255]
 buffer_load_dwordx4 a[188:191], v2, s[12:15], s24 offen offset:3072
 s_add_u32 s24, s24, 32768
 s_waitcnt vmcnt(16)
 s_waitcnt lgkmcnt(0)
 v_mfma_f32_16x16x32_bf16 v[144:147], a[192:195], a[144:147], v[144:147]
 v_lshlrev_b32 v21, 16, v20
 v_and_b32 v20, s26, v20
 v_mfma_f32_16x16x32_bf16 v[148:151], a[192:195], a[148:151], v[148:151]
 ds_read_b128 a[128:131], v4 offset:24576
 v_mfma_f32_16x16x32_bf16 v[152:155], a[192:195], a[152:155], v[152:155]
 v_mul_f32 v22, v21, v68
 v_mfma_f32_16x16x32_bf16 v[156:159], a[192:195], a[156:159], v[156:159]
 buffer_load_dwordx4 a[192:195], v1, s[12:15], s24 offen
 v_mfma_f32_16x16x32_bf16 v[160:163], a[196:199], a[144:147], v[160:163]
 v_mul_f32 v23, v20, v69
 v_mfma_f32_16x16x32_bf16 v[164:167], a[196:199], a[148:151], v[164:167]
 v_cvt_pk_bf16_f32 v16, v22, v23
 ds_read_b128 a[132:135], v4 offset:25600
 v_mfma_f32_16x16x32_bf16 v[168:171], a[196:199], a[152:155], v[168:171]
 v_accvgpr_read_b32 v24, a21
 v_mfma_f32_16x16x32_bf16 v[172:175], a[196:199], a[156:159], v[172:175]
 buffer_load_dwordx4 a[196:199], v1, s[12:15], s24 offen offset:1024
 s_waitcnt vmcnt(16)
 v_mfma_f32_16x16x32_bf16 v[176:179], a[200:203], a[144:147], v[176:179]
 v_lshlrev_b32 v25, 16, v24
 v_mfma_f32_16x16x32_bf16 v[180:183], a[200:203], a[148:151], v[180:183]
 ds_read_b128 a[136:139], v4 offset:26624
 v_mfma_f32_16x16x32_bf16 v[184:187], a[200:203], a[152:155], v[184:187]
 v_and_b32 v24, s26, v24
 v_mfma_f32_16x16x32_bf16 v[188:191], a[200:203], a[156:159], v[188:191]
 buffer_load_dwordx4 a[200:203], v1, s[12:15], s24 offen offset:2048
 v_mfma_f32_16x16x32_bf16 v[192:195], a[204:207], a[144:147], v[192:195]
 v_mul_f32 v26, v25, v70
 v_mul_f32 v27, v24, v71
 v_mfma_f32_16x16x32_bf16 v[196:199], a[204:207], a[148:151], v[196:199]
 ds_read_b128 a[140:143], v4 offset:27648
 v_mfma_f32_16x16x32_bf16 v[200:203], a[204:207], a[152:155], v[200:203]
 v_cvt_pk_bf16_f32 v17, v26, v27
 v_mfma_f32_16x16x32_bf16 v[204:207], a[204:207], a[156:159], v[204:207]
 buffer_load_dwordx4 a[204:207], v1, s[12:15], s24 offen offset:3072
 s_waitcnt vmcnt(16)
 v_mfma_f32_16x16x32_bf16 v[208:211], a[208:211], a[144:147], v[208:211]
 v_accvgpr_read_b32 v20, a22
 v_mfma_f32_16x16x32_bf16 v[212:215], a[208:211], a[148:151], v[212:215]
 v_lshlrev_b32 v21, 16, v20
 v_mfma_f32_16x16x32_bf16 v[216:219], a[208:211], a[152:155], v[216:219]
 v_and_b32 v20, s26, v20
 v_mul_f32 v22, v21, v84
 v_mfma_f32_16x16x32_bf16 v[220:223], a[208:211], a[156:159], v[220:223]
 buffer_load_dwordx4 a[208:211], v2, s[12:15], s24 offen
 v_mfma_f32_16x16x32_bf16 v[224:227], a[212:215], a[144:147], v[224:227]
 v_mul_f32 v23, v20, v85
 v_mfma_f32_16x16x32_bf16 v[228:231], a[212:215], a[148:151], v[228:231]
 v_cvt_pk_bf16_f32 v18, v22, v23
 v_mfma_f32_16x16x32_bf16 v[232:235], a[212:215], a[152:155], v[232:235]
 v_accvgpr_read_b32 v24, a23
 v_mfma_f32_16x16x32_bf16 v[236:239], a[212:215], a[156:159], v[236:239]
 buffer_load_dwordx4 a[212:215], v2, s[12:15], s24 offen offset:1024
 s_waitcnt vmcnt(15)
 v_mfma_f32_16x16x32_bf16 v[240:243], a[216:219], a[144:147], v[240:243]
 v_lshlrev_b32 v25, 16, v24
 v_mfma_f32_16x16x32_bf16 v[244:247], a[216:219], a[148:151], v[244:247]
 v_and_b32 v24, s26, v24
 v_mul_f32 v26, v25, v86
 v_mfma_f32_16x16x32_bf16 v[248:251], a[216:219], a[152:155], v[248:251]
 v_mul_f32 v27, v24, v87
 v_mfma_f32_16x16x32_bf16 v[252:255], a[216:219], a[156:159], v[252:255]
 buffer_load_dwordx4 a[216:219], v2, s[12:15], s24 offen offset:2048
 v_mfma_f32_16x16x32_bf16 a[240:243], a[220:223], a[144:147], a[240:243]
 v_cvt_pk_bf16_f32 v19, v26, v27
 v_mfma_f32_16x16x32_bf16 a[244:247], a[220:223], a[148:151], a[244:247]
 buffer_store_dwordx4 v[16:19], v8, s[16:19], s29 offen offset:64
 v_mfma_f32_16x16x32_bf16 a[248:251], a[220:223], a[152:155], a[248:251]
 v_accvgpr_read_b32 v20, a24
 v_lshlrev_b32 v21, 16, v20
 v_mfma_f32_16x16x32_bf16 a[252:255], a[220:223], a[156:159], a[252:255]
 buffer_load_dwordx4 a[220:223], v2, s[12:15], s24 offen offset:3072
 s_add_u32 s24, s24, 32768
 s_waitcnt vmcnt(16)
 s_waitcnt lgkmcnt(0)
 v_mfma_f32_16x16x32_bf16 v[144:147], a[160:163], a[128:131], v[144:147]
 v_and_b32 v20, s26, v20
 v_mfma_f32_16x16x32_bf16 v[148:151], a[160:163], a[132:135], v[148:151]
 ds_read_b128 a[144:147], v4 offset:28672
 v_mfma_f32_16x16x32_bf16 v[152:155], a[160:163], a[136:139], v[152:155]
 v_mul_f32 v22, v21, v72
 v_mfma_f32_16x16x32_bf16 v[156:159], a[160:163], a[140:143], v[156:159]
 buffer_load_dwordx4 a[160:163], v1, s[12:15], s24 offen
 v_mfma_f32_16x16x32_bf16 v[160:163], a[164:167], a[128:131], v[160:163]
 v_mul_f32 v23, v20, v73
 v_cvt_pk_bf16_f32 v12, v22, v23
 v_mfma_f32_16x16x32_bf16 v[164:167], a[164:167], a[132:135], v[164:167]
 ds_read_b128 a[148:151], v4 offset:29696
 v_mfma_f32_16x16x32_bf16 v[168:171], a[164:167], a[136:139], v[168:171]
 v_accvgpr_read_b32 v24, a25
 v_mfma_f32_16x16x32_bf16 v[172:175], a[164:167], a[140:143], v[172:175]
 buffer_load_dwordx4 a[164:167], v1, s[12:15], s24 offen offset:1024
 s_waitcnt vmcnt(16)
 v_mfma_f32_16x16x32_bf16 v[176:179], a[168:171], a[128:131], v[176:179]
 v_lshlrev_b32 v25, 16, v24
 v_mfma_f32_16x16x32_bf16 v[180:183], a[168:171], a[132:135], v[180:183]
 ds_read_b128 a[152:155], v4 offset:30720
 v_mfma_f32_16x16x32_bf16 v[184:187], a[168:171], a[136:139], v[184:187]
 v_and_b32 v24, s26, v24
 v_mfma_f32_16x16x32_bf16 v[188:191], a[168:171], a[140:143], v[188:191]
 v_mul_f32 v26, v25, v74
 buffer_load_dwordx4 a[168:171], v1, s[12:15], s24 offen offset:2048
 v_mfma_f32_16x16x32_bf16 v[192:195], a[172:175], a[128:131], v[192:195]
 v_mul_f32 v27, v24, v75
 v_mfma_f32_16x16x32_bf16 v[196:199], a[172:175], a[132:135], v[196:199]
 ds_read_b128 a[156:159], v4 offset:31744
 v_mfma_f32_16x16x32_bf16 v[200:203], a[172:175], a[136:139], v[200:203]
 v_cvt_pk_bf16_f32 v13, v26, v27
 v_mfma_f32_16x16x32_bf16 v[204:207], a[172:175], a[140:143], v[204:207]
 buffer_load_dwordx4 a[172:175], v1, s[12:15], s24 offen offset:3072
 s_waitcnt vmcnt(16)
 v_mfma_f32_16x16x32_bf16 v[208:211], a[176:179], a[128:131], v[208:211]
 v_accvgpr_read_b32 v20, a26
 v_mfma_f32_16x16x32_bf16 v[212:215], a[176:179], a[132:135], v[212:215]
 v_lshlrev_b32 v21, 16, v20
 v_and_b32 v20, s26, v20
 v_mfma_f32_16x16x32_bf16 v[216:219], a[176:179], a[136:139], v[216:219]
 v_mul_f32 v22, v21, v88
 v_mfma_f32_16x16x32_bf16 v[220:223], a[176:179], a[140:143], v[220:223]
 buffer_load_dwordx4 a[176:179], v2, s[12:15], s24 offen
 v_mfma_f32_16x16x32_bf16 v[224:227], a[180:183], a[128:131], v[224:227]
 v_mul_f32 v23, v20, v89
 v_mfma_f32_16x16x32_bf16 v[228:231], a[180:183], a[132:135], v[228:231]
 v_cvt_pk_bf16_f32 v14, v22, v23
 v_mfma_f32_16x16x32_bf16 v[232:235], a[180:183], a[136:139], v[232:235]
 v_accvgpr_read_b32 v24, a27
 v_mfma_f32_16x16x32_bf16 v[236:239], a[180:183], a[140:143], v[236:239]
 buffer_load_dwordx4 a[180:183], v2, s[12:15], s24 offen offset:1024
 s_waitcnt vmcnt(15)
 v_mfma_f32_16x16x32_bf16 v[240:243], a[184:187], a[128:131], v[240:243]
 v_lshlrev_b32 v25, 16, v24
 v_and_b32 v24, s26, v24
 v_mfma_f32_16x16x32_bf16 v[244:247], a[184:187], a[132:135], v[244:247]
 v_mul_f32 v26, v25, v90
 v_mfma_f32_16x16x32_bf16 v[248:251], a[184:187], a[136:139], v[248:251]
 v_mul_f32 v27, v24, v91
 v_mfma_f32_16x16x32_bf16 v[252:255], a[184:187], a[140:143], v[252:255]
 buffer_load_dwordx4 a[184:187], v2, s[12:15], s24 offen offset:2048
 v_mfma_f32_16x16x32_bf16 a[240:243], a[188:191], a[128:131], a[240:243]
 v_cvt_pk_bf16_f32 v15, v26, v27
 v_mfma_f32_16x16x32_bf16 a[244:247], a[188:191], a[132:135], a[244:247]
 buffer_store_dwordx4 v[12:15], v8, s[16:19], s30 offen offset:64
 v_accvgpr_read_b32 v20, a28
 v_mfma_f32_16x16x32_bf16 a[248:251], a[188:191], a[136:139], a[248:251]
 v_lshlrev_b32 v21, 16, v20
 v_mfma_f32_16x16x32_bf16 a[252:255], a[188:191], a[140:143], a[252:255]
 buffer_load_dwordx4 a[188:191], v2, s[12:15], s24 offen offset:3072
 s_add_u32 s24, s24, 32768
 s_waitcnt vmcnt(16)
 s_waitcnt lgkmcnt(0)
 v_mfma_f32_16x16x32_bf16 v[144:147], a[192:195], a[144:147], v[144:147]
 v_and_b32 v20, s26, v20
 v_mfma_f32_16x16x32_bf16 v[148:151], a[192:195], a[148:151], v[148:151]
 ds_read_b128 a[128:131], v4 offset:32768
 v_mfma_f32_16x16x32_bf16 v[152:155], a[192:195], a[152:155], v[152:155]
 v_mul_f32 v22, v21, v76
 v_mfma_f32_16x16x32_bf16 v[156:159], a[192:195], a[156:159], v[156:159]
 v_mul_f32 v23, v20, v77
 buffer_load_dwordx4 a[192:195], v1, s[12:15], s24 offen
 v_mfma_f32_16x16x32_bf16 v[160:163], a[196:199], a[144:147], v[160:163]
 v_cvt_pk_bf16_f32 v16, v22, v23
 v_mfma_f32_16x16x32_bf16 v[164:167], a[196:199], a[148:151], v[164:167]
 ds_read_b128 a[132:135], v4 offset:33792
 v_mfma_f32_16x16x32_bf16 v[168:171], a[196:199], a[152:155], v[168:171]
 v_accvgpr_read_b32 v24, a29
 v_mfma_f32_16x16x32_bf16 v[172:175], a[196:199], a[156:159], v[172:175]
 buffer_load_dwordx4 a[196:199], v1, s[12:15], s24 offen offset:1024
 s_waitcnt vmcnt(16)
 v_mfma_f32_16x16x32_bf16 v[176:179], a[200:203], a[144:147], v[176:179]
 v_lshlrev_b32 v25, 16, v24
 v_mfma_f32_16x16x32_bf16 v[180:183], a[200:203], a[148:151], v[180:183]
 ds_read_b128 a[136:139], v4 offset:34816
 v_mfma_f32_16x16x32_bf16 v[184:187], a[200:203], a[152:155], v[184:187]
 v_and_b32 v24, s26, v24
 v_mul_f32 v26, v25, v78
 v_mfma_f32_16x16x32_bf16 v[188:191], a[200:203], a[156:159], v[188:191]
 buffer_load_dwordx4 a[200:203], v1, s[12:15], s24 offen offset:2048
 v_mfma_f32_16x16x32_bf16 v[192:195], a[204:207], a[144:147], v[192:195]
 v_mul_f32 v27, v24, v79
 v_mfma_f32_16x16x32_bf16 v[196:199], a[204:207], a[148:151], v[196:199]
 ds_read_b128 a[140:143], v4 offset:35840
 v_mfma_f32_16x16x32_bf16 v[200:203], a[204:207], a[152:155], v[200:203]
 v_cvt_pk_bf16_f32 v17, v26, v27
 v_mfma_f32_16x16x32_bf16 v[204:207], a[204:207], a[156:159], v[204:207]
 buffer_load_dwordx4 a[204:207], v1, s[12:15], s24 offen offset:3072
 s_waitcnt vmcnt(16)
 v_mfma_f32_16x16x32_bf16 v[208:211], a[208:211], a[144:147], v[208:211]
 v_accvgpr_read_b32 v20, a30
 v_lshlrev_b32 v21, 16, v20
 v_mfma_f32_16x16x32_bf16 v[212:215], a[208:211], a[148:151], v[212:215]
 v_and_b32 v20, s26, v20
 v_mfma_f32_16x16x32_bf16 v[216:219], a[208:211], a[152:155], v[216:219]
 v_mul_f32 v22, v21, v92
 v_mfma_f32_16x16x32_bf16 v[220:223], a[208:211], a[156:159], v[220:223]
 buffer_load_dwordx4 a[208:211], v2, s[12:15], s24 offen
 v_mfma_f32_16x16x32_bf16 v[224:227], a[212:215], a[144:147], v[224:227]
 v_mul_f32 v23, v20, v93
 v_mfma_f32_16x16x32_bf16 v[228:231], a[212:215], a[148:151], v[228:231]
 v_cvt_pk_bf16_f32 v18, v22, v23
 v_mfma_f32_16x16x32_bf16 v[232:235], a[212:215], a[152:155], v[232:235]
 v_accvgpr_read_b32 v24, a31
 v_lshlrev_b32 v25, 16, v24
 v_mfma_f32_16x16x32_bf16 v[236:239], a[212:215], a[156:159], v[236:239]
 buffer_load_dwordx4 a[212:215], v2, s[12:15], s24 offen offset:1024
 s_waitcnt vmcnt(15)
 v_mfma_f32_16x16x32_bf16 v[240:243], a[216:219], a[144:147], v[240:243]
 v_and_b32 v24, s26, v24
 v_mfma_f32_16x16x32_bf16 v[244:247], a[216:219], a[148:151], v[244:247]
 v_mul_f32 v26, v25, v94
 v_mfma_f32_16x16x32_bf16 v[248:251], a[216:219], a[152:155], v[248:251]
 v_mul_f32 v27, v24, v95
 v_mfma_f32_16x16x32_bf16 v[252:255], a[216:219], a[156:159], v[252:255]
 buffer_load_dwordx4 a[216:219], v2, s[12:15], s24 offen offset:2048
 v_mfma_f32_16x16x32_bf16 a[240:243], a[220:223], a[144:147], a[240:243]
 v_cvt_pk_bf16_f32 v19, v26, v27
 buffer_store_dwordx4 v[16:19], v8, s[16:19], s31 offen offset:64
 v_mfma_f32_16x16x32_bf16 a[244:247], a[220:223], a[148:151], a[244:247]
 v_accvgpr_read_b32 v20, a32
 v_mfma_f32_16x16x32_bf16 a[248:251], a[220:223], a[152:155], a[248:251]
 v_lshlrev_b32 v21, 16, v20
 v_mfma_f32_16x16x32_bf16 a[252:255], a[220:223], a[156:159], a[252:255]
 buffer_load_dwordx4 a[220:223], v2, s[12:15], s24 offen offset:3072
 s_add_u32 s24, s24, 32768
 s_waitcnt vmcnt(16)
 s_waitcnt lgkmcnt(0)
 v_mfma_f32_16x16x32_bf16 v[144:147], a[160:163], a[128:131], v[144:147]
 v_and_b32 v20, s26, v20
 v_mfma_f32_16x16x32_bf16 v[148:151], a[160:163], a[132:135], v[148:151]
 ds_read_b128 a[144:147], v4 offset:36864
 v_mfma_f32_16x16x32_bf16 v[152:155], a[160:163], a[136:139], v[152:155]
 v_mul_f32 v22, v21, v96
 v_mfma_f32_16x16x32_bf16 v[156:159], a[160:163], a[140:143], v[156:159]
 v_mul_f32 v23, v20, v97
 buffer_load_dwordx4 a[160:163], v1, s[12:15], s24 offen
 v_mfma_f32_16x16x32_bf16 v[160:163], a[164:167], a[128:131], v[160:163]
 v_cvt_pk_bf16_f32 v12, v22, v23
 v_mfma_f32_16x16x32_bf16 v[164:167], a[164:167], a[132:135], v[164:167]
 ds_read_b128 a[148:151], v4 offset:37888
 v_mfma_f32_16x16x32_bf16 v[168:171], a[164:167], a[136:139], v[168:171]
 v_accvgpr_read_b32 v24, a33
 v_mfma_f32_16x16x32_bf16 v[172:175], a[164:167], a[140:143], v[172:175]
 buffer_load_dwordx4 a[164:167], v1, s[12:15], s24 offen offset:1024
 s_waitcnt vmcnt(16)
 v_mfma_f32_16x16x32_bf16 v[176:179], a[168:171], a[128:131], v[176:179]
 v_lshlrev_b32 v25, 16, v24
 v_mfma_f32_16x16x32_bf16 v[180:183], a[168:171], a[132:135], v[180:183]
 v_and_b32 v24, s26, v24
 ds_read_b128 a[152:155], v4 offset:38912
 v_mfma_f32_16x16x32_bf16 v[184:187], a[168:171], a[136:139], v[184:187]
 v_mul_f32 v26, v25, v98
 v_mfma_f32_16x16x32_bf16 v[188:191], a[168:171], a[140:143], v[188:191]
 buffer_load_dwordx4 a[168:171], v1, s[12:15], s24 offen offset:2048
 v_mfma_f32_16x16x32_bf16 v[192:195], a[172:175], a[128:131], v[192:195]
 v_mul_f32 v27, v24, v99
 v_mfma_f32_16x16x32_bf16 v[196:199], a[172:175], a[132:135], v[196:199]
 ds_read_b128 a[156:159], v4 offset:39936
 v_mfma_f32_16x16x32_bf16 v[200:203], a[172:175], a[136:139], v[200:203]
 v_cvt_pk_bf16_f32 v13, v26, v27
 v_accvgpr_read_b32 v20, a34
 v_mfma_f32_16x16x32_bf16 v[204:207], a[172:175], a[140:143], v[204:207]
 buffer_load_dwordx4 a[172:175], v1, s[12:15], s24 offen offset:3072
 s_waitcnt vmcnt(16)
 v_mfma_f32_16x16x32_bf16 v[208:211], a[176:179], a[128:131], v[208:211]
 v_lshlrev_b32 v21, 16, v20
 v_mfma_f32_16x16x32_bf16 v[212:215], a[176:179], a[132:135], v[212:215]
 v_and_b32 v20, s26, v20
 v_mfma_f32_16x16x32_bf16 v[216:219], a[176:179], a[136:139], v[216:219]
 v_mul_f32 v22, v21, v112
 v_mfma_f32_16x16x32_bf16 v[220:223], a[176:179], a[140:143], v[220:223]
 buffer_load_dwordx4 a[176:179], v2, s[12:15], s24 offen
 v_mfma_f32_16x16x32_bf16 v[224:227], a[180:183], a[128:131], v[224:227]
 v_mul_f32 v23, v20, v113
 v_mfma_f32_16x16x32_bf16 v[228:231], a[180:183], a[132:135], v[228:231]
 v_cvt_pk_bf16_f32 v14, v22, v23
 v_accvgpr_read_b32 v24, a35
 v_mfma_f32_16x16x32_bf16 v[232:235], a[180:183], a[136:139], v[232:235]
 v_lshlrev_b32 v25, 16, v24
 v_mfma_f32_16x16x32_bf16 v[236:239], a[180:183], a[140:143], v[236:239]
 buffer_load_dwordx4 a[180:183], v2, s[12:15], s24 offen offset:1024
 s_waitcnt vmcnt(15)
 v_mfma_f32_16x16x32_bf16 v[240:243], a[184:187], a[128:131], v[240:243]
 v_and_b32 v24, s26, v24
 v_mfma_f32_16x16x32_bf16 v[244:247], a[184:187], a[132:135], v[244:247]
 v_mul_f32 v26, v25, v114
 v_mfma_f32_16x16x32_bf16 v[248:251], a[184:187], a[136:139], v[248:251]
 v_mul_f32 v27, v24, v115
 v_mfma_f32_16x16x32_bf16 v[252:255], a[184:187], a[140:143], v[252:255]
 v_cvt_pk_bf16_f32 v15, v26, v27
 buffer_load_dwordx4 a[184:187], v2, s[12:15], s24 offen offset:2048
 v_mfma_f32_16x16x32_bf16 a[240:243], a[188:191], a[128:131], a[240:243]
 buffer_store_dwordx4 v[12:15], v8, s[16:19], s28 offen offset:128
 v_mfma_f32_16x16x32_bf16 a[244:247], a[188:191], a[132:135], a[244:247]
 v_accvgpr_read_b32 v20, a36
 v_mfma_f32_16x16x32_bf16 a[248:251], a[188:191], a[136:139], a[248:251]
 v_lshlrev_b32 v21, 16, v20
 v_mfma_f32_16x16x32_bf16 a[252:255], a[188:191], a[140:143], a[252:255]
 buffer_load_dwordx4 a[188:191], v2, s[12:15], s24 offen offset:3072
 s_add_u32 s24, s24, 32768
 s_waitcnt vmcnt(16)
 s_waitcnt lgkmcnt(0)
 v_mfma_f32_16x16x32_bf16 v[144:147], a[192:195], a[144:147], v[144:147]
 v_and_b32 v20, s26, v20
 v_mfma_f32_16x16x32_bf16 v[148:151], a[192:195], a[148:151], v[148:151]
 ds_read_b128 a[128:131], v4 offset:40960
 v_mfma_f32_16x16x32_bf16 v[152:155], a[192:195], a[152:155], v[152:155]
 v_mul_f32 v22, v21, v100
 v_mul_f32 v23, v20, v101
 v_mfma_f32_16x16x32_bf16 v[156:159], a[192:195], a[156:159], v[156:159]
 buffer_load_dwordx4 a[192:195], v1, s[12:15], s24 offen
 v_mfma_f32_16x16x32_bf16 v[160:163], a[196:199], a[144:147], v[160:163]
 v_cvt_pk_bf16_f32 v16, v22, v23
 v_mfma_f32_16x16x32_bf16 v[164:167], a[196:199], a[148:151], v[164:167]
 ds_read_b128 a[132:135], v4 offset:41984
 v_mfma_f32_16x16x32_bf16 v[168:171], a[196:199], a[152:155], v[168:171]
 v_accvgpr_read_b32 v24, a37
 v_mfma_f32_16x16x32_bf16 v[172:175], a[196:199], a[156:159], v[172:175]
 buffer_load_dwordx4 a[196:199], v1, s[12:15], s24 offen offset:1024
 s_waitcnt vmcnt(16)
 v_mfma_f32_16x16x32_bf16 v[176:179], a[200:203], a[144:147], v[176:179]
 v_lshlrev_b32 v25, 16, v24
 v_and_b32 v24, s26, v24
 v_mfma_f32_16x16x32_bf16 v[180:183], a[200:203], a[148:151], v[180:183]
 ds_read_b128 a[136:139], v4 offset:43008
 v_mfma_f32_16x16x32_bf16 v[184:187], a[200:203], a[152:155], v[184:187]
 v_mul_f32 v26, v25, v102
 v_mfma_f32_16x16x32_bf16 v[188:191], a[200:203], a[156:159], v[188:191]
 buffer_load_dwordx4 a[200:203], v1, s[12:15], s24 offen offset:2048
 v_mfma_f32_16x16x32_bf16 v[192:195], a[204:207], a[144:147], v[192:195]
 v_mul_f32 v27, v24, v103
 v_mfma_f32_16x16x32_bf16 v[196:199], a[204:207], a[148:151], v[196:199]
 v_cvt_pk_bf16_f32 v17, v26, v27
 ds_read_b128 a[140:143], v4 offset:44032
 v_mfma_f32_16x16x32_bf16 v[200:203], a[204:207], a[152:155], v[200:203]
 v_accvgpr_read_b32 v20, a38
 v_mfma_f32_16x16x32_bf16 v[204:207], a[204:207], a[156:159], v[204:207]
 buffer_load_dwordx4 a[204:207], v1, s[12:15], s24 offen offset:3072
 s_waitcnt vmcnt(16)
 v_mfma_f32_16x16x32_bf16 v[208:211], a[208:211], a[144:147], v[208:211]
 v_lshlrev_b32 v21, 16, v20
 v_mfma_f32_16x16x32_bf16 v[212:215], a[208:211], a[148:151], v[212:215]
 v_and_b32 v20, s26, v20
 v_mfma_f32_16x16x32_bf16 v[216:219], a[208:211], a[152:155], v[216:219]
 v_mul_f32 v22, v21, v116
 v_mfma_f32_16x16x32_bf16 v[220:223], a[208:211], a[156:159], v[220:223]
 buffer_load_dwordx4 a[208:211], v2, s[12:15], s24 offen
 v_mfma_f32_16x16x32_bf16 v[224:227], a[212:215], a[144:147], v[224:227]
 v_mul_f32 v23, v20, v117
 v_cvt_pk_bf16_f32 v18, v22, v23
 v_mfma_f32_16x16x32_bf16 v[228:231], a[212:215], a[148:151], v[228:231]
 v_accvgpr_read_b32 v24, a39
 v_mfma_f32_16x16x32_bf16 v[232:235], a[212:215], a[152:155], v[232:235]
 v_lshlrev_b32 v25, 16, v24
 v_mfma_f32_16x16x32_bf16 v[236:239], a[212:215], a[156:159], v[236:239]
 buffer_load_dwordx4 a[212:215], v2, s[12:15], s24 offen offset:1024
 s_waitcnt vmcnt(15)
 v_mfma_f32_16x16x32_bf16 v[240:243], a[216:219], a[144:147], v[240:243]
 v_and_b32 v24, s26, v24
 v_mfma_f32_16x16x32_bf16 v[244:247], a[216:219], a[148:151], v[244:247]
 v_mul_f32 v26, v25, v118
 v_mfma_f32_16x16x32_bf16 v[248:251], a[216:219], a[152:155], v[248:251]
 v_mul_f32 v27, v24, v119
 v_cvt_pk_bf16_f32 v19, v26, v27
 v_mfma_f32_16x16x32_bf16 v[252:255], a[216:219], a[156:159], v[252:255]
 buffer_load_dwordx4 a[216:219], v2, s[12:15], s24 offen offset:2048
 v_mfma_f32_16x16x32_bf16 a[240:243], a[220:223], a[144:147], a[240:243]
 buffer_store_dwordx4 v[16:19], v8, s[16:19], s29 offen offset:128
 v_mfma_f32_16x16x32_bf16 a[244:247], a[220:223], a[148:151], a[244:247]
 v_accvgpr_read_b32 v20, a40
 v_mfma_f32_16x16x32_bf16 a[248:251], a[220:223], a[152:155], a[248:251]
 v_lshlrev_b32 v21, 16, v20
 v_mfma_f32_16x16x32_bf16 a[252:255], a[220:223], a[156:159], a[252:255]
 buffer_load_dwordx4 a[220:223], v2, s[12:15], s24 offen offset:3072
 s_add_u32 s24, s24, 32768
 s_waitcnt vmcnt(16)
 s_waitcnt lgkmcnt(0)
 v_mfma_f32_16x16x32_bf16 v[144:147], a[160:163], a[128:131], v[144:147]
 v_and_b32 v20, s26, v20
 v_mfma_f32_16x16x32_bf16 v[148:151], a[160:163], a[132:135], v[148:151]
 v_mul_f32 v22, v21, v104
 ds_read_b128 a[144:147], v4 offset:45056
 v_mfma_f32_16x16x32_bf16 v[152:155], a[160:163], a[136:139], v[152:155]
 v_mul_f32 v23, v20, v105
 v_mfma_f32_16x16x32_bf16 v[156:159], a[160:163], a[140:143], v[156:159]
 buffer_load_dwordx4 a[160:163], v1, s[12:15], s24 offen
 v_mfma_f32_16x16x32_bf16 v[160:163], a[164:167], a[128:131], v[160:163]
 v_cvt_pk_bf16_f32 v12, v22, v23
 v_mfma_f32_16x16x32_bf16 v[164:167], a[164:167], a[132:135], v[164:167]
 ds_read_b128 a[148:151], v4 offset:46080
 v_mfma_f32_16x16x32_bf16 v[168:171], a[164:167], a[136:139], v[168:171]
 v_accvgpr_read_b32 v24, a41
 v_lshlrev_b32 v25, 16, v24
 v_mfma_f32_16x16x32_bf16 v[172:175], a[164:167], a[140:143], v[172:175]
 buffer_load_dwordx4 a[164:167], v1, s[12:15], s24 offen offset:1024
 s_waitcnt vmcnt(16)
 v_mfma_f32_16x16x32_bf16 v[176:179], a[168:171], a[128:131], v[176:179]
 v_and_b32 v24, s26, v24
 v_mfma_f32_16x16x32_bf16 v[180:183], a[168:171], a[132:135], v[180:183]
 ds_read_b128 a[152:155], v4 offset:47104
 v_mfma_f32_16x16x32_bf16 v[184:187], a[168:171], a[136:139], v[184:187]
 v_mul_f32 v26, v25, v106
 v_mfma_f32_16x16x32_bf16 v[188:191], a[168:171], a[140:143], v[188:191]
 buffer_load_dwordx4 a[168:171], v1, s[12:15], s24 offen offset:2048
 v_mfma_f32_16x16x32_bf16 v[192:195], a[172:175], a[128:131], v[192:195]
 v_mul_f32 v27, v24, v107
 v_cvt_pk_bf16_f32 v13, v26, v27
 v_mfma_f32_16x16x32_bf16 v[196:199], a[172:175], a[132:135], v[196:199]
 ds_read_b128 a[156:159], v4 offset:48128
 v_mfma_f32_16x16x32_bf16 v[200:203], a[172:175], a[136:139], v[200:203]
 v_accvgpr_read_b32 v20, a42
 v_mfma_f32_16x16x32_bf16 v[204:207], a[172:175], a[140:143], v[204:207]
 buffer_load_dwordx4 a[172:175], v1, s[12:15], s24 offen offset:3072
 s_waitcnt vmcnt(16)
 v_mfma_f32_16x16x32_bf16 v[208:211], a[176:179], a[128:131], v[208:211]
 v_lshlrev_b32 v21, 16, v20
 v_mfma_f32_16x16x32_bf16 v[212:215], a[176:179], a[132:135], v[212:215]
 v_and_b32 v20, s26, v20
 v_mfma_f32_16x16x32_bf16 v[216:219], a[176:179], a[136:139], v[216:219]
 v_mul_f32 v22, v21, v120
 v_mfma_f32_16x16x32_bf16 v[220:223], a[176:179], a[140:143], v[220:223]
 v_mul_f32 v23, v20, v121
 buffer_load_dwordx4 a[176:179], v2, s[12:15], s24 offen
 v_mfma_f32_16x16x32_bf16 v[224:227], a[180:183], a[128:131], v[224:227]
 v_cvt_pk_bf16_f32 v14, v22, v23
 v_mfma_f32_16x16x32_bf16 v[228:231], a[180:183], a[132:135], v[228:231]
 v_accvgpr_read_b32 v24, a43
 v_mfma_f32_16x16x32_bf16 v[232:235], a[180:183], a[136:139], v[232:235]
 v_lshlrev_b32 v25, 16, v24
 v_mfma_f32_16x16x32_bf16 v[236:239], a[180:183], a[140:143], v[236:239]
 buffer_load_dwordx4 a[180:183], v2, s[12:15], s24 offen offset:1024
 s_waitcnt vmcnt(15)
 v_mfma_f32_16x16x32_bf16 v[240:243], a[184:187], a[128:131], v[240:243]
 v_and_b32 v24, s26, v24
 v_mfma_f32_16x16x32_bf16 v[244:247], a[184:187], a[132:135], v[244:247]
 v_mul_f32 v26, v25, v122
 v_mul_f32 v27, v24, v123
 v_mfma_f32_16x16x32_bf16 v[248:251], a[184:187], a[136:139], v[248:251]
 v_cvt_pk_bf16_f32 v15, v26, v27
 v_mfma_f32_16x16x32_bf16 v[252:255], a[184:187], a[140:143], v[252:255]
 buffer_load_dwordx4 a[184:187], v2, s[12:15], s24 offen offset:2048
 v_mfma_f32_16x16x32_bf16 a[240:243], a[188:191], a[128:131], a[240:243]
 buffer_store_dwordx4 v[12:15], v8, s[16:19], s30 offen offset:128
 v_mfma_f32_16x16x32_bf16 a[244:247], a[188:191], a[132:135], a[244:247]
 v_accvgpr_read_b32 v20, a44
 v_mfma_f32_16x16x32_bf16 a[248:251], a[188:191], a[136:139], a[248:251]
 v_lshlrev_b32 v21, 16, v20
 v_mfma_f32_16x16x32_bf16 a[252:255], a[188:191], a[140:143], a[252:255]
 buffer_load_dwordx4 a[188:191], v2, s[12:15], s24 offen offset:3072
 s_add_u32 s24, s24, 32768
 s_waitcnt vmcnt(16)
 s_waitcnt lgkmcnt(0)
 v_mfma_f32_16x16x32_bf16 v[144:147], a[192:195], a[144:147], v[144:147]
 v_and_b32 v20, s26, v20
 v_mul_f32 v22, v21, v108
 v_mfma_f32_16x16x32_bf16 v[148:151], a[192:195], a[148:151], v[148:151]
 ds_read_b128 a[128:131], v4 offset:49152
 v_mfma_f32_16x16x32_bf16 v[152:155], a[192:195], a[152:155], v[152:155]
 v_mul_f32 v23, v20, v109
 v_mfma_f32_16x16x32_bf16 v[156:159], a[192:195], a[156:159], v[156:159]
 buffer_load_dwordx4 a[192:195], v1, s[12:15], s24 offen
 v_mfma_f32_16x16x32_bf16 v[160:163], a[196:199], a[144:147], v[160:163]
 v_cvt_pk_bf16_f32 v16, v22, v23
 v_mfma_f32_16x16x32_bf16 v[164:167], a[196:199], a[148:151], v[164:167]
 v_accvgpr_read_b32 v24, a45
 ds_read_b128 a[132:135], v4 offset:50176
 v_mfma_f32_16x16x32_bf16 v[168:171], a[196:199], a[152:155], v[168:171]
 v_lshlrev_b32 v25, 16, v24
 v_mfma_f32_16x16x32_bf16 v[172:175], a[196:199], a[156:159], v[172:175]
 buffer_load_dwordx4 a[196:199], v1, s[12:15], s24 offen offset:1024
 s_waitcnt vmcnt(16)
 v_mfma_f32_16x16x32_bf16 v[176:179], a[200:203], a[144:147], v[176:179]
 v_and_b32 v24, s26, v24
 v_mfma_f32_16x16x32_bf16 v[180:183], a[200:203], a[148:151], v[180:183]
 ds_read_b128 a[136:139], v4 offset:51200
 v_mfma_f32_16x16x32_bf16 v[184:187], a[200:203], a[152:155], v[184:187]
 v_mul_f32 v26, v25, v110
 v_mfma_f32_16x16x32_bf16 v[188:191], a[200:203], a[156:159], v[188:191]
 v_mul_f32 v27, v24, v111
 buffer_load_dwordx4 a[200:203], v1, s[12:15], s24 offen offset:2048
 v_mfma_f32_16x16x32_bf16 v[192:195], a[204:207], a[144:147], v[192:195]
 v_cvt_pk_bf16_f32 v17, v26, v27
 v_mfma_f32_16x16x32_bf16 v[196:199], a[204:207], a[148:151], v[196:199]
 ds_read_b128 a[140:143], v4 offset:52224
 v_mfma_f32_16x16x32_bf16 v[200:203], a[204:207], a[152:155], v[200:203]
 v_accvgpr_read_b32 v20, a46
 v_mfma_f32_16x16x32_bf16 v[204:207], a[204:207], a[156:159], v[204:207]
 buffer_load_dwordx4 a[204:207], v1, s[12:15], s24 offen offset:3072
 s_waitcnt vmcnt(16)
 v_mfma_f32_16x16x32_bf16 v[208:211], a[208:211], a[144:147], v[208:211]
 v_lshlrev_b32 v21, 16, v20
 v_mfma_f32_16x16x32_bf16 v[212:215], a[208:211], a[148:151], v[212:215]
 v_and_b32 v20, s26, v20
 v_mfma_f32_16x16x32_bf16 v[216:219], a[208:211], a[152:155], v[216:219]
 v_mul_f32 v22, v21, v124
 v_mul_f32 v23, v20, v125
 v_mfma_f32_16x16x32_bf16 v[220:223], a[208:211], a[156:159], v[220:223]
 buffer_load_dwordx4 a[208:211], v2, s[12:15], s24 offen
 v_mfma_f32_16x16x32_bf16 v[224:227], a[212:215], a[144:147], v[224:227]
 v_cvt_pk_bf16_f32 v18, v22, v23
 v_mfma_f32_16x16x32_bf16 v[228:231], a[212:215], a[148:151], v[228:231]
 v_accvgpr_read_b32 v24, a47
 v_mfma_f32_16x16x32_bf16 v[232:235], a[212:215], a[152:155], v[232:235]
 v_lshlrev_b32 v25, 16, v24
 v_mfma_f32_16x16x32_bf16 v[236:239], a[212:215], a[156:159], v[236:239]
 buffer_load_dwordx4 a[212:215], v2, s[12:15], s24 offen offset:1024
 s_waitcnt vmcnt(15)
 v_mfma_f32_16x16x32_bf16 v[240:243], a[216:219], a[144:147], v[240:243]
 v_and_b32 v24, s26, v24
 v_mul_f32 v26, v25, v126
 v_mfma_f32_16x16x32_bf16 v[244:247], a[216:219], a[148:151], v[244:247]
 v_mul_f32 v27, v24, v127
 v_mfma_f32_16x16x32_bf16 v[248:251], a[216:219], a[152:155], v[248:251]
 v_cvt_pk_bf16_f32 v19, v26, v27
 v_mfma_f32_16x16x32_bf16 v[252:255], a[216:219], a[156:159], v[252:255]
 buffer_load_dwordx4 a[216:219], v2, s[12:15], s24 offen offset:2048
 v_mfma_f32_16x16x32_bf16 a[240:243], a[220:223], a[144:147], a[240:243]
 buffer_store_dwordx4 v[16:19], v8, s[16:19], s31 offen offset:128
 v_mfma_f32_16x16x32_bf16 a[244:247], a[220:223], a[148:151], a[244:247]
 v_accvgpr_read_b32 v20, a48
 v_mfma_f32_16x16x32_bf16 a[248:251], a[220:223], a[152:155], a[248:251]
 v_lshlrev_b32 v21, 16, v20
 v_and_b32 v20, s26, v20
 v_mfma_f32_16x16x32_bf16 a[252:255], a[220:223], a[156:159], a[252:255]
 buffer_load_dwordx4 a[220:223], v2, s[12:15], s24 offen offset:3072
 s_add_u32 s24, s24, 32768
 s_waitcnt vmcnt(16)
 s_waitcnt lgkmcnt(0)
 v_mfma_f32_16x16x32_bf16 v[144:147], a[160:163], a[128:131], v[144:147]
 v_mul_f32 v22, v21, v128
 v_mfma_f32_16x16x32_bf16 v[148:151], a[160:163], a[132:135], v[148:151]
 ds_read_b128 a[144:147], v4 offset:53248
 v_mfma_f32_16x16x32_bf16 v[152:155], a[160:163], a[136:139], v[152:155]
 v_mul_f32 v23, v20, v129
 v_mfma_f32_16x16x32_bf16 v[156:159], a[160:163], a[140:143], v[156:159]
 buffer_load_dwordx4 a[160:163], v1, s[12:15], s24 offen
 v_mfma_f32_16x16x32_bf16 v[160:163], a[164:167], a[128:131], v[160:163]
 v_cvt_pk_bf16_f32 v12, v22, v23
 v_accvgpr_read_b32 v24, a49
 v_mfma_f32_16x16x32_bf16 v[164:167], a[164:167], a[132:135], v[164:167]
 ds_read_b128 a[148:151], v4 offset:54272
 v_mfma_f32_16x16x32_bf16 v[168:171], a[164:167], a[136:139], v[168:171]
 v_lshlrev_b32 v25, 16, v24
 v_mfma_f32_16x16x32_bf16 v[172:175], a[164:167], a[140:143], v[172:175]
 buffer_load_dwordx4 a[164:167], v1, s[12:15], s24 offen offset:1024
 s_waitcnt vmcnt(16)
 v_mfma_f32_16x16x32_bf16 v[176:179], a[168:171], a[128:131], v[176:179]
 v_and_b32 v24, s26, v24
 v_mfma_f32_16x16x32_bf16 v[180:183], a[168:171], a[132:135], v[180:183]
 ds_read_b128 a[152:155], v4 offset:55296
 v_mfma_f32_16x16x32_bf16 v[184:187], a[168:171], a[136:139], v[184:187]
 v_mul_f32 v26, v25, v130
 v_mul_f32 v27, v24, v131
 v_mfma_f32_16x16x32_bf16 v[188:191], a[168:171], a[140:143], v[188:191]
 buffer_load_dwordx4 a[168:171], v1, s[12:15], s24 offen offset:2048
 v_mfma_f32_16x16x32_bf16 v[192:195], a[172:175], a[128:131], v[192:195]
 v_cvt_pk_bf16_f32 v13, v26, v27
 v_mfma_f32_16x16x32_bf16 v[196:199], a[172:175], a[132:135], v[196:199]
 ds_read_b128 a[156:159], v4 offset:56320
 v_mfma_f32_16x16x32_bf16 v[200:203], a[172:175], a[136:139], v[200:203]
 v_accvgpr_read_b32 v20, a50
 v_mfma_f32_16x16x32_bf16 v[204:207], a[172:175], a[140:143], v[204:207]
 buffer_load_dwordx4 a[172:175], v1, s[12:15], s24 offen offset:3072
 s_waitcnt vmcnt(16)
 v_mfma_f32_16x16x32_bf16 v[208:211], a[176:179], a[128:131], v[208:211]
 v_accvgpr_read_b32 v22, a224
 v_mfma_f32_16x16x32_bf16 v[212:215], a[176:179], a[132:135], v[212:215]
 v_accvgpr_read_b32 v23, a225
 v_lshlrev_b32 v21, 16, v20
 v_mfma_f32_16x16x32_bf16 v[216:219], a[176:179], a[136:139], v[216:219]
 v_and_b32 v20, s26, v20
 v_mfma_f32_16x16x32_bf16 v[220:223], a[176:179], a[140:143], v[220:223]
 buffer_load_dwordx4 a[176:179], v2, s[12:15], s24 offen
 v_mfma_f32_16x16x32_bf16 v[224:227], a[180:183], a[128:131], v[224:227]
 v_mul_f32 v22, v21, v22
 v_mfma_f32_16x16x32_bf16 v[228:231], a[180:183], a[132:135], v[228:231]
 v_mul_f32 v23, v20, v23
 v_mfma_f32_16x16x32_bf16 v[232:235], a[180:183], a[136:139], v[232:235]
 v_cvt_pk_bf16_f32 v14, v22, v23
 v_accvgpr_read_b32 v24, a51
 v_mfma_f32_16x16x32_bf16 v[236:239], a[180:183], a[140:143], v[236:239]
 buffer_load_dwordx4 a[180:183], v2, s[12:15], s24 offen offset:1024
 s_waitcnt vmcnt(15)
 v_mfma_f32_16x16x32_bf16 v[240:243], a[184:187], a[128:131], v[240:243]
 v_accvgpr_read_b32 v26, a226
 v_mfma_f32_16x16x32_bf16 v[244:247], a[184:187], a[132:135], v[244:247]
 v_accvgpr_read_b32 v27, a227
 v_mfma_f32_16x16x32_bf16 v[248:251], a[184:187], a[136:139], v[248:251]
 v_lshlrev_b32 v25, 16, v24
 v_mfma_f32_16x16x32_bf16 v[252:255], a[184:187], a[140:143], v[252:255]
 buffer_load_dwordx4 a[184:187], v2, s[12:15], s24 offen offset:2048
 v_mfma_f32_16x16x32_bf16 a[240:243], a[188:191], a[128:131], a[240:243]
 v_and_b32 v24, s26, v24
 v_mfma_f32_16x16x32_bf16 a[244:247], a[188:191], a[132:135], a[244:247]
 v_mul_f32 v26, v25, v26
 v_mul_f32 v27, v24, v27
 v_mfma_f32_16x16x32_bf16 a[248:251], a[188:191], a[136:139], a[248:251]
 v_cvt_pk_bf16_f32 v15, v26, v27
 v_mfma_f32_16x16x32_bf16 a[252:255], a[188:191], a[140:143], a[252:255]
 buffer_load_dwordx4 a[188:191], v2, s[12:15], s24 offen offset:3072
 s_add_u32 s24, s24, 32768
 s_waitcnt vmcnt(15)
 s_waitcnt lgkmcnt(0)
 v_mfma_f32_16x16x32_bf16 v[144:147], a[192:195], a[144:147], v[144:147]
 buffer_store_dwordx4 v[12:15], v8, s[16:19], s28 offen offset:192
 v_mfma_f32_16x16x32_bf16 v[148:151], a[192:195], a[148:151], v[148:151]
 ds_read_b128 a[128:131], v4 offset:57344
 v_mfma_f32_16x16x32_bf16 v[152:155], a[192:195], a[152:155], v[152:155]
 v_accvgpr_read_b32 v20, a52
 v_mfma_f32_16x16x32_bf16 v[156:159], a[192:195], a[156:159], v[156:159]
 v_lshlrev_b32 v21, 16, v20
 buffer_load_dwordx4 a[192:195], v1, s[12:15], s24 offen
 v_mfma_f32_16x16x32_bf16 v[160:163], a[196:199], a[144:147], v[160:163]
 v_and_b32 v20, s26, v20
 v_mfma_f32_16x16x32_bf16 v[164:167], a[196:199], a[148:151], v[164:167]
 ds_read_b128 a[132:135], v4 offset:58368
 v_mfma_f32_16x16x32_bf16 v[168:171], a[196:199], a[152:155], v[168:171]
 v_mul_f32 v22, v21, v132
 v_mfma_f32_16x16x32_bf16 v[172:175], a[196:199], a[156:159], v[172:175]
 buffer_load_dwordx4 a[196:199], v1, s[12:15], s24 offen offset:1024
 s_waitcnt vmcnt(16)
 v_mfma_f32_16x16x32_bf16 v[176:179], a[200:203], a[144:147], v[176:179]
 v_mul_f32 v23, v20, v133
 v_mfma_f32_16x16x32_bf16 v[180:183], a[200:203], a[148:151], v[180:183]
 v_cvt_pk_bf16_f32 v16, v22, v23
 ds_read_b128 a[136:139], v4 offset:59392
 v_mfma_f32_16x16x32_bf16 v[184:187], a[200:203], a[152:155], v[184:187]
 v_accvgpr_read_b32 v24, a53
 v_mfma_f32_16x16x32_bf16 v[188:191], a[200:203], a[156:159], v[188:191]
 buffer_load_dwordx4 a[200:203], v1, s[12:15], s24 offen offset:2048
 v_mfma_f32_16x16x32_bf16 v[192:195], a[204:207], a[144:147], v[192:195]
 v_lshlrev_b32 v25, 16, v24
 v_mfma_f32_16x16x32_bf16 v[196:199], a[204:207], a[148:151], v[196:199]
 ds_read_b128 a[140:143], v4 offset:60416
 v_mfma_f32_16x16x32_bf16 v[200:203], a[204:207], a[152:155], v[200:203]
 v_and_b32 v24, s26, v24
 v_mfma_f32_16x16x32_bf16 v[204:207], a[204:207], a[156:159], v[204:207]
 buffer_load_dwordx4 a[204:207], v1, s[12:15], s24 offen offset:3072
 s_waitcnt vmcnt(16)
 v_mfma_f32_16x16x32_bf16 v[208:211], a[208:211], a[144:147], v[208:211]
 v_mul_f32 v26, v25, v134
 v_mul_f32 v27, v24, v135
 v_mfma_f32_16x16x32_bf16 v[212:215], a[208:211], a[148:151], v[212:215]
 v_cvt_pk_bf16_f32 v17, v26, v27
 v_mfma_f32_16x16x32_bf16 v[216:219], a[208:211], a[152:155], v[216:219]
 v_accvgpr_read_b32 v20, a54
 v_mfma_f32_16x16x32_bf16 v[220:223], a[208:211], a[156:159], v[220:223]
 buffer_load_dwordx4 a[208:211], v2, s[12:15], s24 offen
 v_mfma_f32_16x16x32_bf16 v[224:227], a[212:215], a[144:147], v[224:227]
 v_accvgpr_read_b32 v22, a228
 v_mfma_f32_16x16x32_bf16 v[228:231], a[212:215], a[148:151], v[228:231]
 v_accvgpr_read_b32 v23, a229
 v_lshlrev_b32 v21, 16, v20
 v_mfma_f32_16x16x32_bf16 v[232:235], a[212:215], a[152:155], v[232:235]
 v_and_b32 v20, s26, v20
 v_mfma_f32_16x16x32_bf16 v[236:239], a[212:215], a[156:159], v[236:239]
 buffer_load_dwordx4 a[212:215], v2, s[12:15], s24 offen offset:1024
 s_waitcnt vmcnt(15)
 v_mfma_f32_16x16x32_bf16 v[240:243], a[216:219], a[144:147], v[240:243]
 v_mul_f32 v22, v21, v22
 v_mfma_f32_16x16x32_bf16 v[244:247], a[216:219], a[148:151], v[244:247]
 v_mul_f32 v23, v20, v23
 v_mfma_f32_16x16x32_bf16 v[248:251], a[216:219], a[152:155], v[248:251]
 v_cvt_pk_bf16_f32 v18, v22, v23
 v_mfma_f32_16x16x32_bf16 v[252:255], a[216:219], a[156:159], v[252:255]
 buffer_load_dwordx4 a[216:219], v2, s[12:15], s24 offen offset:2048
 v_mfma_f32_16x16x32_bf16 a[240:243], a[220:223], a[144:147], a[240:243]
 v_accvgpr_read_b32 v24, a55
 v_accvgpr_read_b32 v26, a230
 v_mfma_f32_16x16x32_bf16 a[244:247], a[220:223], a[148:151], a[244:247]
 v_accvgpr_read_b32 v27, a231
 v_mfma_f32_16x16x32_bf16 a[248:251], a[220:223], a[152:155], a[248:251]
 v_lshlrev_b32 v25, 16, v24
 v_mfma_f32_16x16x32_bf16 a[252:255], a[220:223], a[156:159], a[252:255]
 buffer_load_dwordx4 a[220:223], v2, s[12:15], s24 offen offset:3072
 s_add_u32 s24, s24, 32768
 s_waitcnt vmcnt(15)
 s_waitcnt lgkmcnt(0)
 v_mfma_f32_16x16x32_bf16 v[144:147], a[160:163], a[128:131], v[144:147]
 v_and_b32 v24, s26, v24
 v_mfma_f32_16x16x32_bf16 v[148:151], a[160:163], a[132:135], v[148:151]
 ds_read_b128 a[144:147], v4 offset:61440
 v_mfma_f32_16x16x32_bf16 v[152:155], a[160:163], a[136:139], v[152:155]
 v_mul_f32 v26, v25, v26
 v_mul_f32 v27, v24, v27
 v_mfma_f32_16x16x32_bf16 v[156:159], a[160:163], a[140:143], v[156:159]
 v_cvt_pk_bf16_f32 v19, v26, v27
 v_mfma_f32_16x16x32_bf16 v[160:163], a[164:167], a[128:131], v[160:163]
 buffer_store_dwordx4 v[16:19], v8, s[16:19], s29 offen offset:192
 v_mfma_f32_16x16x32_bf16 v[164:167], a[164:167], a[132:135], v[164:167]
 ds_read_b128 a[148:151], v4 offset:62464
 v_mfma_f32_16x16x32_bf16 v[168:171], a[164:167], a[136:139], v[168:171]
 v_accvgpr_read_b32 v20, a56
 v_mfma_f32_16x16x32_bf16 v[172:175], a[164:167], a[140:143], v[172:175]
 v_lshlrev_b32 v21, 16, v20
 s_waitcnt vmcnt(14)
 v_mfma_f32_16x16x32_bf16 v[176:179], a[168:171], a[128:131], v[176:179]
 v_and_b32 v20, s26, v20
 v_mfma_f32_16x16x32_bf16 v[180:183], a[168:171], a[132:135], v[180:183]
 ds_read_b128 a[152:155], v4 offset:63488
 v_mfma_f32_16x16x32_bf16 v[184:187], a[168:171], a[136:139], v[184:187]
 v_mul_f32 v22, v21, v136
 v_mfma_f32_16x16x32_bf16 v[188:191], a[168:171], a[140:143], v[188:191]
 v_mul_f32 v23, v20, v137
 v_mfma_f32_16x16x32_bf16 v[192:195], a[172:175], a[128:131], v[192:195]
 v_cvt_pk_bf16_f32 v12, v22, v23
 v_mfma_f32_16x16x32_bf16 v[196:199], a[172:175], a[132:135], v[196:199]
 v_accvgpr_read_b32 v24, a57
 ds_read_b128 a[156:159], v4 offset:64512
 v_mfma_f32_16x16x32_bf16 v[200:203], a[172:175], a[136:139], v[200:203]
 v_lshlrev_b32 v25, 16, v24
 v_mfma_f32_16x16x32_bf16 v[204:207], a[172:175], a[140:143], v[204:207]
 s_waitcnt vmcnt(12)
 v_mfma_f32_16x16x32_bf16 v[208:211], a[176:179], a[128:131], v[208:211]
 v_and_b32 v24, s26, v24
 v_mfma_f32_16x16x32_bf16 v[212:215], a[176:179], a[132:135], v[212:215]
 v_mul_f32 v26, v25, v138
 v_mfma_f32_16x16x32_bf16 v[216:219], a[176:179], a[136:139], v[216:219]
 v_mul_f32 v27, v24, v139
 v_cvt_pk_bf16_f32 v13, v26, v27
 v_mfma_f32_16x16x32_bf16 v[220:223], a[176:179], a[140:143], v[220:223]
 v_accvgpr_read_b32 v20, a58
 v_mfma_f32_16x16x32_bf16 v[224:227], a[180:183], a[128:131], v[224:227]
 v_accvgpr_read_b32 v22, a232
 v_mfma_f32_16x16x32_bf16 v[228:231], a[180:183], a[132:135], v[228:231]
 v_accvgpr_read_b32 v23, a233
 v_mfma_f32_16x16x32_bf16 v[232:235], a[180:183], a[136:139], v[232:235]
 v_lshlrev_b32 v21, 16, v20
 v_mfma_f32_16x16x32_bf16 v[236:239], a[180:183], a[140:143], v[236:239]
 s_waitcnt vmcnt(10)
 v_mfma_f32_16x16x32_bf16 v[240:243], a[184:187], a[128:131], v[240:243]
 v_and_b32 v20, s26, v20
 v_mul_f32 v22, v21, v22
 v_mfma_f32_16x16x32_bf16 v[244:247], a[184:187], a[132:135], v[244:247]
 v_mul_f32 v23, v20, v23
 v_mfma_f32_16x16x32_bf16 v[248:251], a[184:187], a[136:139], v[248:251]
 v_cvt_pk_bf16_f32 v14, v22, v23
 v_mfma_f32_16x16x32_bf16 v[252:255], a[184:187], a[140:143], v[252:255]
 v_accvgpr_read_b32 v24, a59
 v_mfma_f32_16x16x32_bf16 a[240:243], a[188:191], a[128:131], a[240:243]
 v_accvgpr_read_b32 v26, a234
 v_mfma_f32_16x16x32_bf16 a[244:247], a[188:191], a[132:135], a[244:247]
 v_accvgpr_read_b32 v27, a235
 v_lshlrev_b32 v25, 16, v24
 v_mfma_f32_16x16x32_bf16 a[248:251], a[188:191], a[136:139], a[248:251]
 v_and_b32 v24, s26, v24
 v_mfma_f32_16x16x32_bf16 a[252:255], a[188:191], a[140:143], a[252:255]
 s_waitcnt vmcnt(7)
 s_waitcnt lgkmcnt(0)
 v_mfma_f32_16x16x32_bf16 v[144:147], a[192:195], a[144:147], v[144:147]
 v_mul_f32 v26, v25, v26
 v_mfma_f32_16x16x32_bf16 v[148:151], a[192:195], a[148:151], v[148:151]
 v_mul_f32 v27, v24, v27
 v_mfma_f32_16x16x32_bf16 v[152:155], a[192:195], a[152:155], v[152:155]
 v_cvt_pk_bf16_f32 v15, v26, v27
 v_mfma_f32_16x16x32_bf16 v[156:159], a[192:195], a[156:159], v[156:159]
 buffer_store_dwordx4 v[12:15], v8, s[16:19], s30 offen offset:192
 v_accvgpr_read_b32 v20, a60
 v_mfma_f32_16x16x32_bf16 v[160:163], a[196:199], a[144:147], v[160:163]
 v_lshlrev_b32 v21, 16, v20
 v_mfma_f32_16x16x32_bf16 v[164:167], a[196:199], a[148:151], v[164:167]
 v_and_b32 v20, s26, v20
 v_mfma_f32_16x16x32_bf16 v[168:171], a[196:199], a[152:155], v[168:171]
 v_mul_f32 v22, v21, v140
 v_mfma_f32_16x16x32_bf16 v[172:175], a[196:199], a[156:159], v[172:175]
 s_waitcnt vmcnt(6)
 v_mfma_f32_16x16x32_bf16 v[176:179], a[200:203], a[144:147], v[176:179]
 v_mul_f32 v23, v20, v141
 v_mfma_f32_16x16x32_bf16 v[180:183], a[200:203], a[148:151], v[180:183]
 v_cvt_pk_bf16_f32 v16, v22, v23
 v_accvgpr_read_b32 v24, a61
 v_mfma_f32_16x16x32_bf16 v[184:187], a[200:203], a[152:155], v[184:187]
 v_lshlrev_b32 v25, 16, v24
 v_mfma_f32_16x16x32_bf16 v[188:191], a[200:203], a[156:159], v[188:191]
 v_and_b32 v24, s26, v24
 v_mfma_f32_16x16x32_bf16 v[192:195], a[204:207], a[144:147], v[192:195]
 v_mul_f32 v26, v25, v142
 v_mfma_f32_16x16x32_bf16 v[196:199], a[204:207], a[148:151], v[196:199]
 v_mul_f32 v27, v24, v143
 v_mfma_f32_16x16x32_bf16 v[200:203], a[204:207], a[152:155], v[200:203]
 v_cvt_pk_bf16_f32 v17, v26, v27
 v_accvgpr_read_b32 v20, a62
 v_mfma_f32_16x16x32_bf16 v[204:207], a[204:207], a[156:159], v[204:207]
 s_waitcnt vmcnt(4)
 v_mfma_f32_16x16x32_bf16 v[208:211], a[208:211], a[144:147], v[208:211]
 v_accvgpr_read_b32 v22, a236
 v_mfma_f32_16x16x32_bf16 v[212:215], a[208:211], a[148:151], v[212:215]
 v_accvgpr_read_b32 v23, a237
 v_mfma_f32_16x16x32_bf16 v[216:219], a[208:211], a[152:155], v[216:219]
 v_lshlrev_b32 v21, 16, v20
 v_mfma_f32_16x16x32_bf16 v[220:223], a[208:211], a[156:159], v[220:223]
 v_and_b32 v20, s26, v20
 v_mfma_f32_16x16x32_bf16 v[224:227], a[212:215], a[144:147], v[224:227]
 v_mul_f32 v22, v21, v22
 v_mul_f32 v23, v20, v23
 v_mfma_f32_16x16x32_bf16 v[228:231], a[212:215], a[148:151], v[228:231]
 v_cvt_pk_bf16_f32 v18, v22, v23
 v_mfma_f32_16x16x32_bf16 v[232:235], a[212:215], a[152:155], v[232:235]
 v_accvgpr_read_b32 v24, a63
 v_mfma_f32_16x16x32_bf16 v[236:239], a[212:215], a[156:159], v[236:239]
 s_waitcnt vmcnt(2)
 v_mfma_f32_16x16x32_bf16 v[240:243], a[216:219], a[144:147], v[240:243]
 v_accvgpr_read_b32 v26, a238
 v_mfma_f32_16x16x32_bf16 v[244:247], a[216:219], a[148:151], v[244:247]
 v_accvgpr_read_b32 v27, a239
 v_lshlrev_b32 v25, 16, v24
 v_mfma_f32_16x16x32_bf16 v[248:251], a[216:219], a[152:155], v[248:251]
 v_and_b32 v24, s26, v24
 v_mfma_f32_16x16x32_bf16 v[252:255], a[216:219], a[156:159], v[252:255]
 v_mul_f32 v26, v25, v26
 v_mfma_f32_16x16x32_bf16 a[240:243], a[220:223], a[144:147], a[240:243]
 v_mul_f32 v27, v24, v27
 v_mfma_f32_16x16x32_bf16 a[244:247], a[220:223], a[148:151], a[244:247]
 v_cvt_pk_bf16_f32 v19, v26, v27
 v_mfma_f32_16x16x32_bf16 a[248:251], a[220:223], a[152:155], a[248:251]
 buffer_store_dwordx4 v[16:19], v8, s[16:19], s31 offen offset:192
 v_mfma_f32_16x16x32_bf16 a[252:255], a[220:223], a[156:159], a[252:255]
 s_nop 7
 v_accvgpr_read_b32 v20, a64
 v_lshlrev_b32 v21, 16, v20
 v_and_b32 v20, s26, v20
 v_mul_f32 v22, v21, v144
 v_mul_f32 v23, v20, v145
 v_cvt_pk_bf16_f32 v12, v22, v23
 v_accvgpr_read_b32 v24, a65
 v_lshlrev_b32 v25, 16, v24
 v_and_b32 v24, s26, v24
 v_mul_f32 v26, v25, v146
 v_mul_f32 v27, v24, v147
 v_cvt_pk_bf16_f32 v13, v26, v27
 v_accvgpr_read_b32 v20, a66
 v_lshlrev_b32 v21, 16, v20
 v_and_b32 v20, s26, v20
 v_mul_f32 v22, v21, v160
 v_mul_f32 v23, v20, v161
 v_cvt_pk_bf16_f32 v14, v22, v23
 v_accvgpr_read_b32 v24, a67
 v_lshlrev_b32 v25, 16, v24
 v_and_b32 v24, s26, v24
 v_mul_f32 v26, v25, v162
 v_mul_f32 v27, v24, v163
 v_cvt_pk_bf16_f32 v15, v26, v27
 buffer_store_dwordx4 v[12:15], v8, s[16:19], s28 offen offset:1024
 v_accvgpr_read_b32 v20, a68
 v_lshlrev_b32 v21, 16, v20
 v_and_b32 v20, s26, v20
 v_mul_f32 v22, v21, v148
 v_mul_f32 v23, v20, v149
 v_cvt_pk_bf16_f32 v16, v22, v23
 v_accvgpr_read_b32 v24, a69
 v_lshlrev_b32 v25, 16, v24
 v_and_b32 v24, s26, v24
 v_mul_f32 v26, v25, v150
 v_mul_f32 v27, v24, v151
 v_cvt_pk_bf16_f32 v17, v26, v27
 v_accvgpr_read_b32 v20, a70
 v_lshlrev_b32 v21, 16, v20
 v_and_b32 v20, s26, v20
 v_mul_f32 v22, v21, v164
 v_mul_f32 v23, v20, v165
 v_cvt_pk_bf16_f32 v18, v22, v23
 v_accvgpr_read_b32 v24, a71
 v_lshlrev_b32 v25, 16, v24
 v_and_b32 v24, s26, v24
 v_mul_f32 v26, v25, v166
 v_mul_f32 v27, v24, v167
 v_cvt_pk_bf16_f32 v19, v26, v27
 buffer_store_dwordx4 v[16:19], v8, s[16:19], s29 offen offset:1024
 v_accvgpr_read_b32 v20, a72
 v_lshlrev_b32 v21, 16, v20
 v_and_b32 v20, s26, v20
 v_mul_f32 v22, v21, v152
 v_mul_f32 v23, v20, v153
 v_cvt_pk_bf16_f32 v12, v22, v23
 v_accvgpr_read_b32 v24, a73
 v_lshlrev_b32 v25, 16, v24
 v_and_b32 v24, s26, v24
 v_mul_f32 v26, v25, v154
 v_mul_f32 v27, v24, v155
 v_cvt_pk_bf16_f32 v13, v26, v27
 v_accvgpr_read_b32 v20, a74
 v_lshlrev_b32 v21, 16, v20
 v_and_b32 v20, s26, v20
 v_mul_f32 v22, v21, v168
 v_mul_f32 v23, v20, v169
 v_cvt_pk_bf16_f32 v14, v22, v23
 v_accvgpr_read_b32 v24, a75
 v_lshlrev_b32 v25, 16, v24
 v_and_b32 v24, s26, v24
 v_mul_f32 v26, v25, v170
 v_mul_f32 v27, v24, v171
 v_cvt_pk_bf16_f32 v15, v26, v27
 buffer_store_dwordx4 v[12:15], v8, s[16:19], s30 offen offset:1024
 v_accvgpr_read_b32 v20, a76
 v_lshlrev_b32 v21, 16, v20
 v_and_b32 v20, s26, v20
 v_mul_f32 v22, v21, v156
 v_mul_f32 v23, v20, v157
 v_cvt_pk_bf16_f32 v16, v22, v23
 v_accvgpr_read_b32 v24, a77
 v_lshlrev_b32 v25, 16, v24
 v_and_b32 v24, s26, v24
 v_mul_f32 v26, v25, v158
 v_mul_f32 v27, v24, v159
 v_cvt_pk_bf16_f32 v17, v26, v27
 v_accvgpr_read_b32 v20, a78
 v_lshlrev_b32 v21, 16, v20
 v_and_b32 v20, s26, v20
 v_mul_f32 v22, v21, v172
 v_mul_f32 v23, v20, v173
 v_cvt_pk_bf16_f32 v18, v22, v23
 v_accvgpr_read_b32 v24, a79
 v_lshlrev_b32 v25, 16, v24
 v_and_b32 v24, s26, v24
 v_mul_f32 v26, v25, v174
 v_mul_f32 v27, v24, v175
 v_cvt_pk_bf16_f32 v19, v26, v27
 buffer_store_dwordx4 v[16:19], v8, s[16:19], s31 offen offset:1024
 v_accvgpr_read_b32 v20, a80
 v_lshlrev_b32 v21, 16, v20
 v_and_b32 v20, s26, v20
 v_mul_f32 v22, v21, v176
 v_mul_f32 v23, v20, v177
 v_cvt_pk_bf16_f32 v12, v22, v23
 v_accvgpr_read_b32 v24, a81
 v_lshlrev_b32 v25, 16, v24
 v_and_b32 v24, s26, v24
 v_mul_f32 v26, v25, v178
 v_mul_f32 v27, v24, v179
 v_cvt_pk_bf16_f32 v13, v26, v27
 v_accvgpr_read_b32 v20, a82
 v_lshlrev_b32 v21, 16, v20
 v_and_b32 v20, s26, v20
 v_mul_f32 v22, v21, v192
 v_mul_f32 v23, v20, v193
 v_cvt_pk_bf16_f32 v14, v22, v23
 v_accvgpr_read_b32 v24, a83
 v_lshlrev_b32 v25, 16, v24
 v_and_b32 v24, s26, v24
 v_mul_f32 v26, v25, v194
 v_mul_f32 v27, v24, v195
 v_cvt_pk_bf16_f32 v15, v26, v27
 buffer_store_dwordx4 v[12:15], v8, s[16:19], s28 offen offset:1088
 v_accvgpr_read_b32 v20, a84
 v_lshlrev_b32 v21, 16, v20
 v_and_b32 v20, s26, v20
 v_mul_f32 v22, v21, v180
 v_mul_f32 v23, v20, v181
 v_cvt_pk_bf16_f32 v16, v22, v23
 v_accvgpr_read_b32 v24, a85
 v_lshlrev_b32 v25, 16, v24
 v_and_b32 v24, s26, v24
 v_mul_f32 v26, v25, v182
 v_mul_f32 v27, v24, v183
 v_cvt_pk_bf16_f32 v17, v26, v27
 v_accvgpr_read_b32 v20, a86
 v_lshlrev_b32 v21, 16, v20
 v_and_b32 v20, s26, v20
 v_mul_f32 v22, v21, v196
 v_mul_f32 v23, v20, v197
 v_cvt_pk_bf16_f32 v18, v22, v23
 v_accvgpr_read_b32 v24, a87
 v_lshlrev_b32 v25, 16, v24
 v_and_b32 v24, s26, v24
 v_mul_f32 v26, v25, v198
 v_mul_f32 v27, v24, v199
 v_cvt_pk_bf16_f32 v19, v26, v27
 buffer_store_dwordx4 v[16:19], v8, s[16:19], s29 offen offset:1088
 v_accvgpr_read_b32 v20, a88
 v_lshlrev_b32 v21, 16, v20
 v_and_b32 v20, s26, v20
 v_mul_f32 v22, v21, v184
 v_mul_f32 v23, v20, v185
 v_cvt_pk_bf16_f32 v12, v22, v23
 v_accvgpr_read_b32 v24, a89
 v_lshlrev_b32 v25, 16, v24
 v_and_b32 v24, s26, v24
 v_mul_f32 v26, v25, v186
 v_mul_f32 v27, v24, v187
 v_cvt_pk_bf16_f32 v13, v26, v27
 v_accvgpr_read_b32 v20, a90
 v_lshlrev_b32 v21, 16, v20
 v_and_b32 v20, s26, v20
 v_mul_f32 v22, v21, v200
 v_mul_f32 v23, v20, v201
 v_cvt_pk_bf16_f32 v14, v22, v23
 v_accvgpr_read_b32 v24, a91
 v_lshlrev_b32 v25, 16, v24
 v_and_b32 v24, s26, v24
 v_mul_f32 v26, v25, v202
 v_mul_f32 v27, v24, v203
 v_cvt_pk_bf16_f32 v15, v26, v27
 buffer_store_dwordx4 v[12:15], v8, s[16:19], s30 offen offset:1088
 v_accvgpr_read_b32 v20, a92
 v_lshlrev_b32 v21, 16, v20
 v_and_b32 v20, s26, v20
 v_mul_f32 v22, v21, v188
 v_mul_f32 v23, v20, v189
 v_cvt_pk_bf16_f32 v16, v22, v23
 v_accvgpr_read_b32 v24, a93
 v_lshlrev_b32 v25, 16, v24
 v_and_b32 v24, s26, v24
 v_mul_f32 v26, v25, v190
 v_mul_f32 v27, v24, v191
 v_cvt_pk_bf16_f32 v17, v26, v27
 v_accvgpr_read_b32 v20, a94
 v_lshlrev_b32 v21, 16, v20
 v_and_b32 v20, s26, v20
 v_mul_f32 v22, v21, v204
 v_mul_f32 v23, v20, v205
 v_cvt_pk_bf16_f32 v18, v22, v23
 v_accvgpr_read_b32 v24, a95
 v_lshlrev_b32 v25, 16, v24
 v_and_b32 v24, s26, v24
 v_mul_f32 v26, v25, v206
 v_mul_f32 v27, v24, v207
 v_cvt_pk_bf16_f32 v19, v26, v27
 buffer_store_dwordx4 v[16:19], v8, s[16:19], s31 offen offset:1088
 v_accvgpr_read_b32 v20, a96
 v_lshlrev_b32 v21, 16, v20
 v_and_b32 v20, s26, v20
 v_mul_f32 v22, v21, v208
 v_mul_f32 v23, v20, v209
 v_cvt_pk_bf16_f32 v12, v22, v23
 v_accvgpr_read_b32 v24, a97
 v_lshlrev_b32 v25, 16, v24
 v_and_b32 v24, s26, v24
 v_mul_f32 v26, v25, v210
 v_mul_f32 v27, v24, v211
 v_cvt_pk_bf16_f32 v13, v26, v27
 v_accvgpr_read_b32 v20, a98
 v_lshlrev_b32 v21, 16, v20
 v_and_b32 v20, s26, v20
 v_mul_f32 v22, v21, v224
 v_mul_f32 v23, v20, v225
 v_cvt_pk_bf16_f32 v14, v22, v23
 v_accvgpr_read_b32 v24, a99
 v_lshlrev_b32 v25, 16, v24
 v_and_b32 v24, s26, v24
 v_mul_f32 v26, v25, v226
 v_mul_f32 v27, v24, v227
 v_cvt_pk_bf16_f32 v15, v26, v27
 buffer_store_dwordx4 v[12:15], v8, s[16:19], s28 offen offset:1152
 v_accvgpr_read_b32 v20, a100
 v_lshlrev_b32 v21, 16, v20
 v_and_b32 v20, s26, v20
 v_mul_f32 v22, v21, v212
 v_mul_f32 v23, v20, v213
 v_cvt_pk_bf16_f32 v16, v22, v23
 v_accvgpr_read_b32 v24, a101
 v_lshlrev_b32 v25, 16, v24
 v_and_b32 v24, s26, v24
 v_mul_f32 v26, v25, v214
 v_mul_f32 v27, v24, v215
 v_cvt_pk_bf16_f32 v17, v26, v27
 v_accvgpr_read_b32 v20, a102
 v_lshlrev_b32 v21, 16, v20
 v_and_b32 v20, s26, v20
 v_mul_f32 v22, v21, v228
 v_mul_f32 v23, v20, v229
 v_cvt_pk_bf16_f32 v18, v22, v23
 v_accvgpr_read_b32 v24, a103
 v_lshlrev_b32 v25, 16, v24
 v_and_b32 v24, s26, v24
 v_mul_f32 v26, v25, v230
 v_mul_f32 v27, v24, v231
 v_cvt_pk_bf16_f32 v19, v26, v27
 buffer_store_dwordx4 v[16:19], v8, s[16:19], s29 offen offset:1152
 v_accvgpr_read_b32 v20, a104
 v_lshlrev_b32 v21, 16, v20
 v_and_b32 v20, s26, v20
 v_mul_f32 v22, v21, v216
 v_mul_f32 v23, v20, v217
 v_cvt_pk_bf16_f32 v12, v22, v23
 v_accvgpr_read_b32 v24, a105
 v_lshlrev_b32 v25, 16, v24
 v_and_b32 v24, s26, v24
 v_mul_f32 v26, v25, v218
 v_mul_f32 v27, v24, v219
 v_cvt_pk_bf16_f32 v13, v26, v27
 v_accvgpr_read_b32 v20, a106
 v_lshlrev_b32 v21, 16, v20
 v_and_b32 v20, s26, v20
 v_mul_f32 v22, v21, v232
 v_mul_f32 v23, v20, v233
 v_cvt_pk_bf16_f32 v14, v22, v23
 v_accvgpr_read_b32 v24, a107
 v_lshlrev_b32 v25, 16, v24
 v_and_b32 v24, s26, v24
 v_mul_f32 v26, v25, v234
 v_mul_f32 v27, v24, v235
 v_cvt_pk_bf16_f32 v15, v26, v27
 buffer_store_dwordx4 v[12:15], v8, s[16:19], s30 offen offset:1152
 v_accvgpr_read_b32 v20, a108
 v_lshlrev_b32 v21, 16, v20
 v_and_b32 v20, s26, v20
 v_mul_f32 v22, v21, v220
 v_mul_f32 v23, v20, v221
 v_cvt_pk_bf16_f32 v16, v22, v23
 v_accvgpr_read_b32 v24, a109
 v_lshlrev_b32 v25, 16, v24
 v_and_b32 v24, s26, v24
 v_mul_f32 v26, v25, v222
 v_mul_f32 v27, v24, v223
 v_cvt_pk_bf16_f32 v17, v26, v27
 v_accvgpr_read_b32 v20, a110
 v_lshlrev_b32 v21, 16, v20
 v_and_b32 v20, s26, v20
 v_mul_f32 v22, v21, v236
 v_mul_f32 v23, v20, v237
 v_cvt_pk_bf16_f32 v18, v22, v23
 v_accvgpr_read_b32 v24, a111
 v_lshlrev_b32 v25, 16, v24
 v_and_b32 v24, s26, v24
 v_mul_f32 v26, v25, v238
 v_mul_f32 v27, v24, v239
 v_cvt_pk_bf16_f32 v19, v26, v27
 buffer_store_dwordx4 v[16:19], v8, s[16:19], s31 offen offset:1152
 v_accvgpr_read_b32 v20, a112
 v_lshlrev_b32 v21, 16, v20
 v_and_b32 v20, s26, v20
 v_mul_f32 v22, v21, v240
 v_mul_f32 v23, v20, v241
 v_cvt_pk_bf16_f32 v12, v22, v23
 v_accvgpr_read_b32 v24, a113
 v_lshlrev_b32 v25, 16, v24
 v_and_b32 v24, s26, v24
 v_mul_f32 v26, v25, v242
 v_mul_f32 v27, v24, v243
 v_cvt_pk_bf16_f32 v13, v26, v27
 v_accvgpr_read_b32 v20, a114
 v_accvgpr_read_b32 v22, a240
 v_accvgpr_read_b32 v23, a241
 v_lshlrev_b32 v21, 16, v20
 v_and_b32 v20, s26, v20
 v_mul_f32 v22, v21, v22
 v_mul_f32 v23, v20, v23
 v_cvt_pk_bf16_f32 v14, v22, v23
 v_accvgpr_read_b32 v24, a115
 v_accvgpr_read_b32 v26, a242
 v_accvgpr_read_b32 v27, a243
 v_lshlrev_b32 v25, 16, v24
 v_and_b32 v24, s26, v24
 v_mul_f32 v26, v25, v26
 v_mul_f32 v27, v24, v27
 v_cvt_pk_bf16_f32 v15, v26, v27
 buffer_store_dwordx4 v[12:15], v8, s[16:19], s28 offen offset:1216
 v_accvgpr_read_b32 v20, a116
 v_lshlrev_b32 v21, 16, v20
 v_and_b32 v20, s26, v20
 v_mul_f32 v22, v21, v244
 v_mul_f32 v23, v20, v245
 v_cvt_pk_bf16_f32 v16, v22, v23
 v_accvgpr_read_b32 v24, a117
 v_lshlrev_b32 v25, 16, v24
 v_and_b32 v24, s26, v24
 v_mul_f32 v26, v25, v246
 v_mul_f32 v27, v24, v247
 v_cvt_pk_bf16_f32 v17, v26, v27
 v_accvgpr_read_b32 v20, a118
 v_accvgpr_read_b32 v22, a244
 v_accvgpr_read_b32 v23, a245
 v_lshlrev_b32 v21, 16, v20
 v_and_b32 v20, s26, v20
 v_mul_f32 v22, v21, v22
 v_mul_f32 v23, v20, v23
 v_cvt_pk_bf16_f32 v18, v22, v23
 v_accvgpr_read_b32 v24, a119
 v_accvgpr_read_b32 v26, a246
 v_accvgpr_read_b32 v27, a247
 v_lshlrev_b32 v25, 16, v24
 v_and_b32 v24, s26, v24
 v_mul_f32 v26, v25, v26
 v_mul_f32 v27, v24, v27
 v_cvt_pk_bf16_f32 v19, v26, v27
 buffer_store_dwordx4 v[16:19], v8, s[16:19], s29 offen offset:1216
 v_accvgpr_read_b32 v20, a120
 v_lshlrev_b32 v21, 16, v20
 v_and_b32 v20, s26, v20
 v_mul_f32 v22, v21, v248
 v_mul_f32 v23, v20, v249
 v_cvt_pk_bf16_f32 v12, v22, v23
 v_accvgpr_read_b32 v24, a121
 v_lshlrev_b32 v25, 16, v24
 v_and_b32 v24, s26, v24
 v_mul_f32 v26, v25, v250
 v_mul_f32 v27, v24, v251
 v_cvt_pk_bf16_f32 v13, v26, v27
 v_accvgpr_read_b32 v20, a122
 v_accvgpr_read_b32 v22, a248
 v_accvgpr_read_b32 v23, a249
 v_lshlrev_b32 v21, 16, v20
 v_and_b32 v20, s26, v20
 v_mul_f32 v22, v21, v22
 v_mul_f32 v23, v20, v23
 v_cvt_pk_bf16_f32 v14, v22, v23
 v_accvgpr_read_b32 v24, a123
 v_accvgpr_read_b32 v26, a250
 v_accvgpr_read_b32 v27, a251
 v_lshlrev_b32 v25, 16, v24
 v_and_b32 v24, s26, v24
 v_mul_f32 v26, v25, v26
 v_mul_f32 v27, v24, v27
 v_cvt_pk_bf16_f32 v15, v26, v27
 buffer_store_dwordx4 v[12:15], v8, s[16:19], s30 offen offset:1216
 v_accvgpr_read_b32 v20, a124
 v_lshlrev_b32 v21, 16, v20
 v_and_b32 v20, s26, v20
 v_mul_f32 v22, v21, v252
 v_mul_f32 v23, v20, v253
 v_cvt_pk_bf16_f32 v16, v22, v23
 v_accvgpr_read_b32 v24, a125
 v_lshlrev_b32 v25, 16, v24
 v_and_b32 v24, s26, v24
 v_mul_f32 v26, v25, v254
 v_mul_f32 v27, v24, v255
 v_cvt_pk_bf16_f32 v17, v26, v27
 v_accvgpr_read_b32 v20, a126
 v_accvgpr_read_b32 v22, a252
 v_accvgpr_read_b32 v23, a253
 v_lshlrev_b32 v21, 16, v20
 v_and_b32 v20, s26, v20
 v_mul_f32 v22, v21, v22
 v_mul_f32 v23, v20, v23
 v_cvt_pk_bf16_f32 v18, v22, v23
 v_accvgpr_read_b32 v24, a127
 v_accvgpr_read_b32 v26, a254
 v_accvgpr_read_b32 v27, a255
 v_lshlrev_b32 v25, 16, v24
 v_and_b32 v24, s26, v24
 v_mul_f32 v26, v25, v26
 v_mul_f32 v27, v24, v27
 v_cvt_pk_bf16_f32 v19, v26, v27
 buffer_store_dwordx4 v[16:19], v8, s[16:19], s31 offen offset:1216
Lend:
 s_endpgm
.globl dcn_prep_kernel
.p2align 8
.type dcn_prep_kernel,@function
dcn_prep_kernel:
 s_cmp_ge_u32 s2, 384
 s_cbranch_scc1 Lprep_end
 s_load_dwordx2 s[4:5], s[0:1], 8
 s_load_dwordx2 s[6:7], s[0:1], 40
 v_lshrrev_b32 v1, 6, v0
 v_and_b32 v2, 63, v0
 v_readfirstlane_b32 s3, v1
 v_and_b32 v3, 15, v2
 v_lshrrev_b32 v4, 4, v2
 s_nop 1
 s_lshl_b32 s16, s2, 2
 s_add_u32 s16, s16, s3
 s_and_b32 s17, s16, 7
 s_lshr_b32 s18, s16, 3
 s_lshl_b32 s19, s18, 16
 s_lshl_b32 s20, s17, 8
 s_add_u32 s19, s19, s20
 s_lshr_b32 s20, s18, 5
 s_and_b32 s21, s18, 31
 s_lshr_b32 s22, s17, 2
 s_and_b32 s23, s17, 3
 s_lshl_b32 s20, s20, 1
 s_add_u32 s20, s20, s22
 s_lshl_b32 s20, s20, 5
 s_add_u32 s20, s20, s21
 s_lshl_b32 s20, s20, 2
 s_add_u32 s20, s20, s23
 s_lshl_b32 s20, s20, 13
 v_lshlrev_b32 v5, 14, v4
 v_lshl_add_u32 v5, v3, 4, v5
 v_add_u32 v6, 4096, v5
 v_add_u32 v7, 8192, v5
 v_add_u32 v8, 12288, v5
 v_lshrrev_b32 v9, 2, v3
 v_and_b32 v10, 3, v3
 v_lshlrev_b32 v11, 11, v9
 v_lshl_add_u32 v11, v4, 8, v11
 v_lshl_add_u32 v11, v10, 6, v11
 s_mov_b32 s24, 0x05040100
 s_mov_b32 s25, 0x07060302
 s_waitcnt lgkmcnt(0)
 s_mov_b32 s8, s4
 s_mov_b32 s9, s5
 s_mov_b32 s10, 0xc00000
 s_mov_b32 s11, 0x20000
 s_mov_b32 s12, s6
 s_mov_b32 s13, s7
 s_mov_b32 s14, 0xc00000
 s_mov_b32 s15, 0x20000
 buffer_load_dwordx4 v[16:19], v5, s[8:11], s19 offen
 buffer_load_dwordx4 v[20:23], v5, s[8:11], s19 offen offset:2048
 buffer_load_dwordx4 v[24:27], v6, s[8:11], s19 offen
 buffer_load_dwordx4 v[28:31], v6, s[8:11], s19 offen offset:2048
 buffer_load_dwordx4 v[32:35], v7, s[8:11], s19 offen
 buffer_load_dwordx4 v[36:39], v7, s[8:11], s19 offen offset:2048
 buffer_load_dwordx4 v[40:43], v8, s[8:11], s19 offen
 buffer_load_dwordx4 v[44:47], v8, s[8:11], s19 offen offset:2048
 s_waitcnt vmcnt(6)
 v_perm_b32 v48, v20, v16, s24
 v_perm_b32 v52, v20, v16, s25
 v_perm_b32 v56, v21, v17, s24
 v_perm_b32 v60, v21, v17, s25
 v_perm_b32 v64, v22, v18, s24
 v_perm_b32 v68, v22, v18, s25
 v_perm_b32 v72, v23, v19, s24
 v_perm_b32 v76, v23, v19, s25
 s_waitcnt vmcnt(4)
 v_perm_b32 v49, v28, v24, s24
 v_perm_b32 v53, v28, v24, s25
 v_perm_b32 v57, v29, v25, s24
 v_perm_b32 v61, v29, v25, s25
 v_perm_b32 v65, v30, v26, s24
 v_perm_b32 v69, v30, v26, s25
 v_perm_b32 v73, v31, v27, s24
 v_perm_b32 v77, v31, v27, s25
 s_waitcnt vmcnt(2)
 v_perm_b32 v50, v36, v32, s24
 v_perm_b32 v54, v36, v32, s25
 v_perm_b32 v58, v37, v33, s24
 v_perm_b32 v62, v37, v33, s25
 v_perm_b32 v66, v38, v34, s24
 v_perm_b32 v70, v38, v34, s25
 v_perm_b32 v74, v39, v35, s24
 v_perm_b32 v78, v39, v35, s25
 s_waitcnt vmcnt(0)
 v_perm_b32 v51, v44, v40, s24
 v_perm_b32 v55, v44, v40, s25
 v_perm_b32 v59, v45, v41, s24
 v_perm_b32 v63, v45, v41, s25
 v_perm_b32 v67, v46, v42, s24
 v_perm_b32 v71, v46, v42, s25
 v_perm_b32 v75, v47, v43, s24
 v_perm_b32 v79, v47, v43, s25
 buffer_store_dwordx4 v[48:51], v11, s[12:15], s20 offen
 buffer_store_dwordx4 v[52:55], v11, s[12:15], s20 offen offset:16
 buffer_store_dwordx4 v[56:59], v11, s[12:15], s20 offen offset:32
 buffer_store_dwordx4 v[60:63], v11, s[12:15], s20 offen offset:48
 buffer_store_dwordx4 v[64:67], v11, s[12:15], s20 offen offset:1024
 buffer_store_dwordx4 v[68:71], v11, s[12:15], s20 offen offset:1040
 buffer_store_dwordx4 v[72:75], v11, s[12:15], s20 offen offset:1056
 buffer_store_dwordx4 v[76:79], v11, s[12:15], s20 offen offset:1072
Lprep_end:
 s_endpgm
.section .rodata,"a"
.p2align 6
.amdhsa_kernel standalone__cross_network_dcn__recsys_kernel
  .amdhsa_next_free_vgpr 512
  .amdhsa_next_free_sgpr 72
  .amdhsa_accum_offset 256
  .amdhsa_group_segment_fixed_size 0
  .amdhsa_kernarg_size 48
  .amdhsa_user_sgpr_count 2
  .amdhsa_user_sgpr_kernarg_segment_ptr 1
  .amdhsa_system_sgpr_workgroup_id_x 1
  .amdhsa_float_denorm_mode_32 3
.end_amdhsa_kernel
.section .rodata,"a"
.p2align 6
.amdhsa_kernel dcn_prep_kernel
  .amdhsa_next_free_vgpr 80
  .amdhsa_next_free_sgpr 32
  .amdhsa_accum_offset 80
  .amdhsa_group_segment_fixed_size 0
  .amdhsa_kernarg_size 48
  .amdhsa_user_sgpr_count 2
  .amdhsa_user_sgpr_kernarg_segment_ptr 1
  .amdhsa_system_sgpr_workgroup_id_x 1
  .amdhsa_float_denorm_mode_32 3
.end_amdhsa_kernel
```

```asm
; @launch grid=(256,1,1) block=(256,1,1) lds=163840
.amdgcn_target "amdgcn-amd-amdhsa--gfx950"
.text
.globl standalone__cross_network_dcn__recsys_kernel
.p2align 8
.type standalone__cross_network_dcn__recsys_kernel,@function
standalone__cross_network_dcn__recsys_kernel:
 s_cmp_ge_u32 s2, 256
 s_cbranch_scc1 Lend
 s_load_dwordx4 s[56:59], s[0:1], 0
 s_load_dwordx4 s[60:63], s[0:1], 16
 s_load_dwordx4 s[64:67], s[0:1], 32
 v_lshrrev_b32 v9, 6, v0
 v_and_b32 v10, 63, v0
 v_readfirstlane_b32 s54, v9
 v_lshlrev_b32 v1, 4, v10
 v_lshlrev_b32 v14, 4, v0
 v_lshlrev_b32 v15, 5, v0
 v_add_u32 v15, 131072, v15
 v_add_u32 v2, 65536, v1
 v_lshl_add_u32 v3, v9, 15, v1
 v_lshl_add_u32 v0, v9, 14, v1
 v_bfe_u32 v4, v1, 4, 4
 v_lshlrev_b32 v4, 11, v4
 v_lshrrev_b32 v5, 8, v1
 v_lshl_add_u32 v4, v5, 4, v4
 v_lshrrev_b32 v5, 14, v0
 v_lshl_add_u32 v4, v5, 8, v4
 s_lshl_b32 s28, s2, 17
 s_add_u32 s29, s28, 32768
 s_add_u32 s30, s28, 65536
 s_add_u32 s31, s28, 98304
 s_mov_b32 s26, 0xffff0000
 s_mov_b32 s24, 0
 s_mov_b32 s25, 0
 s_mov_b32 s53, 0
 s_mov_b32 s27, 64
 s_lshr_b32 s4, s2, 3
 s_and_b32 s5, s2, 7
 s_lshl_b32 s48, s4, 16
 s_lshl_b32 s6, s5, 8
 s_add_u32 s48, s48, s6
 s_lshl_b32 s6, s54, 6
 s_add_u32 s48, s48, s6
 s_lshr_b32 s6, s5, 2
 s_lshl_b32 s49, s6, 20
 s_lshr_b32 s6, s4, 1
 s_lshl_b32 s6, s6, 16
 s_add_u32 s49, s49, s6
 s_and_b32 s6, s5, 3
 s_lshl_b32 s6, s6, 14
 s_add_u32 s49, s49, s6
 s_lshl_b32 s6, s54, 12
 s_add_u32 s49, s49, s6
 s_and_b32 s6, s4, 1
 s_lshl_b32 s6, s6, 10
 s_add_u32 s49, s49, s6
 s_and_b32 s50, s2, 3
 s_lshl_b32 s50, s50, 6
 s_lshl_b32 s52, s54, 11
 s_add_u32 s52, s52, 155648
 s_lshl_b32 s51, s54, 9
 s_add_u32 s51, s51, 131072
 s_waitcnt lgkmcnt(0)
 s_mov_b32 s40, s58
 s_mov_b32 s41, s59
 s_mov_b32 s42, 0xc00000
 s_mov_b32 s43, 0x20000
 v_lshrrev_b32 v5, 6, v1
 v_and_b32 v6, 48, v1
 v_lshl_add_u32 v5, v5, 11, v6
 s_mov_b32 m0, s52
 s_add_u32 s3, s48, 31744
 buffer_load_dwordx4 v5, s[40:43], s48 offen lds
 buffer_load_dwordx4 v5, s[40:43], s3 offen offset:1024 lds
 s_add_u32 s48, s48, 2097152
 s_mov_b32 s8, s56
 s_mov_b32 s9, s57
 s_mov_b32 s10, 0x2000000
 s_mov_b32 s11, 0x20000
 s_mov_b32 s20, s60
 s_mov_b32 s21, s61
 s_mov_b32 s22, 0x3000
 s_mov_b32 s23, 0x20000
 s_mov_b32 s16, s62
 s_mov_b32 s17, s63
 s_mov_b32 s18, 0x2000000
 s_mov_b32 s19, 0x20000
 s_mov_b32 s12, s66
 s_mov_b32 s13, s67
 s_mov_b32 s14, 0xc00000
 s_mov_b32 s15, 0x20000
 s_mov_b32 s44, s64
 s_mov_b32 s45, s65
 s_mov_b32 s46, 0x100
 s_mov_b32 s47, 0x20000
 s_mov_b32 s3, 0
 buffer_load_dwordx4 v[16:19], v14, s[20:23], s3 offen
 s_mov_b32 s3, 4096
 buffer_load_dwordx4 v[20:23], v14, s[20:23], s3 offen
 s_mov_b32 s3, 8192
 buffer_load_dwordx4 v[24:27], v14, s[20:23], s3 offen
 v_mov_b32 v36, v15
 v_and_b32 v5, 768, v1
 v_add3_u32 v5, v5, v1, s52
 s_waitcnt vmcnt(3)
 ds_read_b64_tr_b16 v[8:9], v5 offset:0
 ds_read_b64_tr_b16 v[10:11], v5 offset:256
 ds_read_b64_tr_b16 v[12:13], v5 offset:8
 ds_read_b64_tr_b16 v[14:15], v5 offset:264
 s_waitcnt lgkmcnt(2)
 buffer_store_dwordx4 v[8:11], v1, s[12:15], s49 offen sc1
 s_waitcnt lgkmcnt(0)
 buffer_store_dwordx4 v[12:15], v1, s[12:15], s49 offen offset:2048 sc1
 s_add_u32 s49, s49, 2097152
 buffer_load_dwordx4 a[0:3], v4, s[8:11], s28 offen nt
 buffer_load_dwordx4 a[16:19], v4, s[8:11], s28 offen offset:64 nt
 buffer_load_dwordx4 a[32:35], v4, s[8:11], s28 offen offset:128 nt
 buffer_load_dwordx4 a[48:51], v4, s[8:11], s28 offen offset:192 nt
 buffer_load_dwordx4 a[4:7], v4, s[8:11], s29 offen nt
 buffer_load_dwordx4 a[20:23], v4, s[8:11], s29 offen offset:64 nt
 buffer_load_dwordx4 a[36:39], v4, s[8:11], s29 offen offset:128 nt
 buffer_load_dwordx4 a[52:55], v4, s[8:11], s29 offen offset:192 nt
 buffer_load_dwordx4 a[8:11], v4, s[8:11], s30 offen nt
 buffer_load_dwordx4 a[24:27], v4, s[8:11], s30 offen offset:64 nt
 buffer_load_dwordx4 a[40:43], v4, s[8:11], s30 offen offset:128 nt
 buffer_load_dwordx4 a[56:59], v4, s[8:11], s30 offen offset:192 nt
 buffer_load_dwordx4 a[12:15], v4, s[8:11], s31 offen nt
 buffer_load_dwordx4 a[28:31], v4, s[8:11], s31 offen offset:64 nt
 buffer_load_dwordx4 a[44:47], v4, s[8:11], s31 offen offset:128 nt
 buffer_load_dwordx4 a[60:63], v4, s[8:11], s31 offen offset:192 nt
 s_waitcnt vmcnt(16)
 s_barrier
 v_lshlrev_b32 v5, 4, v0
 v_mov_b32 v6, 1
 buffer_atomic_add v6, v5, s[44:47], s50 offen sc1
 s_cmp_eq_u32 s54, 0
 s_cbranch_scc1 Lseg1
 buffer_load_dwordx4 a[64:67], v4, s[8:11], s28 offen offset:1024 nt
 buffer_load_dwordx4 a[80:83], v4, s[8:11], s28 offen offset:1088 nt
 buffer_load_dwordx4 a[96:99], v4, s[8:11], s28 offen offset:1152 nt
 buffer_load_dwordx4 a[112:115], v4, s[8:11], s28 offen offset:1216 nt
 buffer_load_dwordx4 a[68:71], v4, s[8:11], s29 offen offset:1024 nt
 buffer_load_dwordx4 a[84:87], v4, s[8:11], s29 offen offset:1088 nt
 buffer_load_dwordx4 a[100:103], v4, s[8:11], s29 offen offset:1152 nt
 buffer_load_dwordx4 a[116:119], v4, s[8:11], s29 offen offset:1216 nt
 buffer_load_dwordx4 a[72:75], v4, s[8:11], s30 offen offset:1024 nt
 buffer_load_dwordx4 a[88:91], v4, s[8:11], s30 offen offset:1088 nt
 buffer_load_dwordx4 a[104:107], v4, s[8:11], s30 offen offset:1152 nt
 buffer_load_dwordx4 a[120:123], v4, s[8:11], s30 offen offset:1216 nt
 buffer_load_dwordx4 a[76:79], v4, s[8:11], s31 offen offset:1024 nt
 buffer_load_dwordx4 a[92:95], v4, s[8:11], s31 offen offset:1088 nt
 buffer_load_dwordx4 a[108:111], v4, s[8:11], s31 offen offset:1152 nt
 buffer_load_dwordx4 a[124:127], v4, s[8:11], s31 offen offset:1216 nt
Lseg1:
 v_lshlrev_b32 v28, 16, v16
 v_and_b32 v29, s26, v16
 v_lshlrev_b32 v30, 16, v17
 v_and_b32 v31, s26, v17
 ds_write_b128 v36, v[28:31]
 v_lshlrev_b32 v32, 16, v18
 v_and_b32 v33, s26, v18
 v_lshlrev_b32 v34, 16, v19
 v_and_b32 v35, s26, v19
 ds_write_b128 v36, v[32:35] offset:16
 s_waitcnt lgkmcnt(0)
 v_lshlrev_b32 v28, 16, v20
 v_and_b32 v29, s26, v20
 v_lshlrev_b32 v30, 16, v21
 v_and_b32 v31, s26, v21
 ds_write_b128 v36, v[28:31] offset:8192
 v_lshlrev_b32 v32, 16, v22
 v_and_b32 v33, s26, v22
 v_lshlrev_b32 v34, 16, v23
 v_and_b32 v35, s26, v23
 ds_write_b128 v36, v[32:35] offset:8208
 s_waitcnt lgkmcnt(0)
 v_lshlrev_b32 v28, 16, v24
 v_and_b32 v29, s26, v24
 v_lshlrev_b32 v30, 16, v25
 v_and_b32 v31, s26, v25
 ds_write_b128 v36, v[28:31] offset:16384
 v_lshlrev_b32 v32, 16, v26
 v_and_b32 v33, s26, v26
 v_lshlrev_b32 v34, 16, v27
 v_and_b32 v35, s26, v27
 ds_write_b128 v36, v[32:35] offset:16400
 s_waitcnt lgkmcnt(0)
 v_mov_b32 v16, 1.0
 v_mov_b32 v17, 1.0
 v_mov_b32 v18, 1.0
 v_mov_b32 v19, 1.0
 v_mov_b32 v20, 1.0
 v_mov_b32 v21, 1.0
 v_mov_b32 v22, 1.0
 v_mov_b32 v23, 1.0
 v_mov_b32 v24, 1.0
 v_mov_b32 v25, 1.0
 v_mov_b32 v26, 1.0
 v_mov_b32 v27, 1.0
 v_mov_b32 v28, 1.0
 v_mov_b32 v29, 1.0
 v_mov_b32 v30, 1.0
 v_mov_b32 v31, 1.0
 v_mov_b32 v32, 1.0
 v_mov_b32 v33, 1.0
 v_mov_b32 v34, 1.0
 v_mov_b32 v35, 1.0
 v_mov_b32 v36, 1.0
 v_mov_b32 v37, 1.0
 v_mov_b32 v38, 1.0
 v_mov_b32 v39, 1.0
 v_mov_b32 v40, 1.0
 v_mov_b32 v41, 1.0
 v_mov_b32 v42, 1.0
 v_mov_b32 v43, 1.0
 v_mov_b32 v44, 1.0
 v_mov_b32 v45, 1.0
 v_mov_b32 v46, 1.0
 v_mov_b32 v47, 1.0
 v_mov_b32 v48, 1.0
 v_mov_b32 v49, 1.0
 v_mov_b32 v50, 1.0
 v_mov_b32 v51, 1.0
 v_mov_b32 v52, 1.0
 v_mov_b32 v53, 1.0
 v_mov_b32 v54, 1.0
 v_mov_b32 v55, 1.0
 v_mov_b32 v56, 1.0
 v_mov_b32 v57, 1.0
 v_mov_b32 v58, 1.0
 v_mov_b32 v59, 1.0
 v_mov_b32 v60, 1.0
 v_mov_b32 v61, 1.0
 v_mov_b32 v62, 1.0
 v_mov_b32 v63, 1.0
 v_mov_b32 v64, 1.0
 v_mov_b32 v65, 1.0
 v_mov_b32 v66, 1.0
 v_mov_b32 v67, 1.0
 v_mov_b32 v68, 1.0
 v_mov_b32 v69, 1.0
 v_mov_b32 v70, 1.0
 v_mov_b32 v71, 1.0
 v_mov_b32 v72, 1.0
 v_mov_b32 v73, 1.0
 v_mov_b32 v74, 1.0
 v_mov_b32 v75, 1.0
 v_mov_b32 v76, 1.0
 v_mov_b32 v77, 1.0
 v_mov_b32 v78, 1.0
 v_mov_b32 v79, 1.0
 v_mov_b32 v80, 1.0
 v_mov_b32 v81, 1.0
 v_mov_b32 v82, 1.0
 v_mov_b32 v83, 1.0
 v_mov_b32 v84, 1.0
 v_mov_b32 v85, 1.0
 v_mov_b32 v86, 1.0
 v_mov_b32 v87, 1.0
 v_mov_b32 v88, 1.0
 v_mov_b32 v89, 1.0
 v_mov_b32 v90, 1.0
 v_mov_b32 v91, 1.0
 v_mov_b32 v92, 1.0
 v_mov_b32 v93, 1.0
 v_mov_b32 v94, 1.0
 v_mov_b32 v95, 1.0
 v_mov_b32 v96, 1.0
 v_mov_b32 v97, 1.0
 v_mov_b32 v98, 1.0
 v_mov_b32 v99, 1.0
 v_mov_b32 v100, 1.0
 v_mov_b32 v101, 1.0
 v_mov_b32 v102, 1.0
 v_mov_b32 v103, 1.0
 v_mov_b32 v104, 1.0
 v_mov_b32 v105, 1.0
 v_mov_b32 v106, 1.0
 v_mov_b32 v107, 1.0
 v_mov_b32 v108, 1.0
 v_mov_b32 v109, 1.0
 v_mov_b32 v110, 1.0
 v_mov_b32 v111, 1.0
 v_mov_b32 v112, 1.0
 v_mov_b32 v113, 1.0
 v_mov_b32 v114, 1.0
 v_mov_b32 v115, 1.0
 v_mov_b32 v116, 1.0
 v_mov_b32 v117, 1.0
 v_mov_b32 v118, 1.0
 v_mov_b32 v119, 1.0
 v_mov_b32 v120, 1.0
 v_mov_b32 v121, 1.0
 v_mov_b32 v122, 1.0
 v_mov_b32 v123, 1.0
 v_mov_b32 v124, 1.0
 v_mov_b32 v125, 1.0
 v_mov_b32 v126, 1.0
 v_mov_b32 v127, 1.0
 v_mov_b32 v128, 1.0
 v_mov_b32 v129, 1.0
 v_mov_b32 v130, 1.0
 v_mov_b32 v131, 1.0
 v_mov_b32 v132, 1.0
 v_mov_b32 v133, 1.0
 v_mov_b32 v134, 1.0
 v_mov_b32 v135, 1.0
 v_accvgpr_write_b32 a240, 1.0
 v_accvgpr_write_b32 a241, 1.0
 v_accvgpr_write_b32 a242, 1.0
 v_accvgpr_write_b32 a243, 1.0
 v_accvgpr_write_b32 a244, 1.0
 v_accvgpr_write_b32 a245, 1.0
 v_accvgpr_write_b32 a246, 1.0
 v_accvgpr_write_b32 a247, 1.0
 v_mov_b32 v136, 1.0
 v_mov_b32 v137, 1.0
 v_mov_b32 v138, 1.0
 v_mov_b32 v139, 1.0
 v_mov_b32 v140, 1.0
 v_mov_b32 v141, 1.0
 v_mov_b32 v142, 1.0
 v_mov_b32 v143, 1.0
 v_mov_b32 v144, 1.0
 v_mov_b32 v145, 1.0
 v_mov_b32 v146, 1.0
 v_mov_b32 v147, 1.0
 v_mov_b32 v148, 1.0
 v_mov_b32 v149, 1.0
 v_mov_b32 v150, 1.0
 v_mov_b32 v151, 1.0
 v_mov_b32 v152, 1.0
 v_mov_b32 v153, 1.0
 v_mov_b32 v154, 1.0
 v_mov_b32 v155, 1.0
 v_mov_b32 v156, 1.0
 v_mov_b32 v157, 1.0
 v_mov_b32 v158, 1.0
 v_mov_b32 v159, 1.0
 v_mov_b32 v160, 1.0
 v_mov_b32 v161, 1.0
 v_mov_b32 v162, 1.0
 v_mov_b32 v163, 1.0
 v_mov_b32 v164, 1.0
 v_mov_b32 v165, 1.0
 v_mov_b32 v166, 1.0
 v_mov_b32 v167, 1.0
 v_mov_b32 v168, 1.0
 v_mov_b32 v169, 1.0
 v_mov_b32 v170, 1.0
 v_mov_b32 v171, 1.0
 v_mov_b32 v172, 1.0
 v_mov_b32 v173, 1.0
 v_mov_b32 v174, 1.0
 v_mov_b32 v175, 1.0
 v_mov_b32 v176, 1.0
 v_mov_b32 v177, 1.0
 v_mov_b32 v178, 1.0
 v_mov_b32 v179, 1.0
 v_mov_b32 v180, 1.0
 v_mov_b32 v181, 1.0
 v_mov_b32 v182, 1.0
 v_mov_b32 v183, 1.0
 v_mov_b32 v184, 1.0
 v_mov_b32 v185, 1.0
 v_mov_b32 v186, 1.0
 v_mov_b32 v187, 1.0
 v_mov_b32 v188, 1.0
 v_mov_b32 v189, 1.0
 v_mov_b32 v190, 1.0
 v_mov_b32 v191, 1.0
 v_mov_b32 v192, 1.0
 v_mov_b32 v193, 1.0
 v_mov_b32 v194, 1.0
 v_mov_b32 v195, 1.0
 v_mov_b32 v196, 1.0
 v_mov_b32 v197, 1.0
 v_mov_b32 v198, 1.0
 v_mov_b32 v199, 1.0
 v_mov_b32 v200, 1.0
 v_mov_b32 v201, 1.0
 v_mov_b32 v202, 1.0
 v_mov_b32 v203, 1.0
 v_mov_b32 v204, 1.0
 v_mov_b32 v205, 1.0
 v_mov_b32 v206, 1.0
 v_mov_b32 v207, 1.0
 v_mov_b32 v208, 1.0
 v_mov_b32 v209, 1.0
 v_mov_b32 v210, 1.0
 v_mov_b32 v211, 1.0
 v_mov_b32 v212, 1.0
 v_mov_b32 v213, 1.0
 v_mov_b32 v214, 1.0
 v_mov_b32 v215, 1.0
 v_mov_b32 v216, 1.0
 v_mov_b32 v217, 1.0
 v_mov_b32 v218, 1.0
 v_mov_b32 v219, 1.0
 v_mov_b32 v220, 1.0
 v_mov_b32 v221, 1.0
 v_mov_b32 v222, 1.0
 v_mov_b32 v223, 1.0
 v_mov_b32 v224, 1.0
 v_mov_b32 v225, 1.0
 v_mov_b32 v226, 1.0
 v_mov_b32 v227, 1.0
 v_mov_b32 v228, 1.0
 v_mov_b32 v229, 1.0
 v_mov_b32 v230, 1.0
 v_mov_b32 v231, 1.0
 v_mov_b32 v232, 1.0
 v_mov_b32 v233, 1.0
 v_mov_b32 v234, 1.0
 v_mov_b32 v235, 1.0
 v_mov_b32 v236, 1.0
 v_mov_b32 v237, 1.0
 v_mov_b32 v238, 1.0
 v_mov_b32 v239, 1.0
 v_mov_b32 v240, 1.0
 v_mov_b32 v241, 1.0
 v_mov_b32 v242, 1.0
 v_mov_b32 v243, 1.0
 v_mov_b32 v244, 1.0
 v_mov_b32 v245, 1.0
 v_mov_b32 v246, 1.0
 v_mov_b32 v247, 1.0
 v_mov_b32 v248, 1.0
 v_mov_b32 v249, 1.0
 v_mov_b32 v250, 1.0
 v_mov_b32 v251, 1.0
 v_mov_b32 v252, 1.0
 v_mov_b32 v253, 1.0
 v_mov_b32 v254, 1.0
 v_mov_b32 v255, 1.0
 v_accvgpr_write_b32 a248, 1.0
 v_accvgpr_write_b32 a249, 1.0
 v_accvgpr_write_b32 a250, 1.0
 v_accvgpr_write_b32 a251, 1.0
 v_accvgpr_write_b32 a252, 1.0
 v_accvgpr_write_b32 a253, 1.0
 v_accvgpr_write_b32 a254, 1.0
 v_accvgpr_write_b32 a255, 1.0
 s_waitcnt vmcnt(16)
 ds_write_b128 v3, a[0:3]
 s_waitcnt vmcnt(15)
 ds_write_b128 v3, a[16:19] offset:4096
 s_waitcnt vmcnt(14)
 ds_write_b128 v3, a[32:35] offset:8192
 s_waitcnt vmcnt(13)
 ds_write_b128 v3, a[48:51] offset:12288
 s_waitcnt vmcnt(12)
 ds_write_b128 v3, a[4:7] offset:1024
 s_waitcnt vmcnt(11)
 ds_write_b128 v3, a[20:23] offset:5120
 s_waitcnt vmcnt(10)
 ds_write_b128 v3, a[36:39] offset:9216
 s_waitcnt vmcnt(9)
 ds_write_b128 v3, a[52:55] offset:13312
 s_waitcnt vmcnt(8)
 ds_write_b128 v3, a[8:11] offset:2048
 s_waitcnt vmcnt(7)
 ds_write_b128 v3, a[24:27] offset:6144
 s_waitcnt vmcnt(6)
 ds_write_b128 v3, a[40:43] offset:10240
 s_waitcnt vmcnt(5)
 ds_write_b128 v3, a[56:59] offset:14336
 s_waitcnt vmcnt(4)
 ds_write_b128 v3, a[12:15] offset:3072
 s_waitcnt vmcnt(3)
 ds_write_b128 v3, a[28:31] offset:7168
 s_waitcnt vmcnt(2)
 ds_write_b128 v3, a[44:47] offset:11264
 s_waitcnt vmcnt(1)
 ds_write_b128 v3, a[60:63] offset:15360
 v_mov_b32 v7, v4
 s_cmp_eq_u32 s54, 0
 s_cbranch_scc0 Lseg2
 v_lshlrev_b32 v4, 2, v1
 v_and_b32 v4, 192, v4
 buffer_load_dword v4, v4, s[44:47], 0 offen sc1
 s_waitcnt vmcnt(0)
 v_cmp_gt_u32 vcc, s27, v4
 s_cbranch_vccnz Lspin_pro
Lok_pro:
Lseg2:
 s_add_u32 s27, s27, 64
 s_waitcnt lgkmcnt(0)
 s_barrier
 buffer_load_dwordx4 a[180:183], v0, s[12:15], s24 offen offset:1024
 buffer_load_dwordx4 a[176:179], v0, s[12:15], s24 offen
 buffer_load_dwordx4 a[188:191], v0, s[12:15], s24 offen offset:3072
 buffer_load_dwordx4 a[184:187], v0, s[12:15], s24 offen offset:2048
 s_add_u32 s24, s24, 4096
 buffer_load_dwordx4 a[196:199], v0, s[12:15], s24 offen offset:1024
 buffer_load_dwordx4 a[192:195], v0, s[12:15], s24 offen
 buffer_load_dwordx4 a[204:207], v0, s[12:15], s24 offen offset:3072
 buffer_load_dwordx4 a[200:203], v0, s[12:15], s24 offen offset:2048
 s_add_u32 s24, s24, 4096
 buffer_load_dwordx4 a[212:215], v0, s[12:15], s24 offen offset:1024
 buffer_load_dwordx4 a[208:211], v0, s[12:15], s24 offen
 buffer_load_dwordx4 a[220:223], v0, s[12:15], s24 offen offset:3072
 buffer_load_dwordx4 a[216:219], v0, s[12:15], s24 offen offset:2048
 s_add_u32 s24, s24, 4096
 buffer_load_dwordx4 a[228:231], v0, s[12:15], s24 offen offset:1024
 buffer_load_dwordx4 a[224:227], v0, s[12:15], s24 offen
 buffer_load_dwordx4 a[236:239], v0, s[12:15], s24 offen offset:3072
 buffer_load_dwordx4 a[232:235], v0, s[12:15], s24 offen offset:2048
 s_add_u32 s24, s24, 53248
 ds_read_b128 a[128:131], v1
 ds_read_b128 a[132:135], v1 offset:4096
 ds_read_b128 a[136:139], v1 offset:1024
 ds_read_b128 a[140:143], v1 offset:5120
 ds_read_b128 a[144:147], v1 offset:2048
 ds_read_b128 a[148:151], v1 offset:6144
 ds_read_b128 a[152:155], v1 offset:3072
 ds_read_b128 a[156:159], v1 offset:7168
 v_mov_b32 v4, v7
 s_cmp_eq_u32 s54, 0
 s_cbranch_scc0 Lseg3
 buffer_load_dwordx4 a[64:67], v4, s[8:11], s28 offen offset:1024 nt
 buffer_load_dwordx4 a[80:83], v4, s[8:11], s28 offen offset:1088 nt
 buffer_load_dwordx4 a[96:99], v4, s[8:11], s28 offen offset:1152 nt
 buffer_load_dwordx4 a[112:115], v4, s[8:11], s28 offen offset:1216 nt
 buffer_load_dwordx4 a[68:71], v4, s[8:11], s29 offen offset:1024 nt
 buffer_load_dwordx4 a[84:87], v4, s[8:11], s29 offen offset:1088 nt
 buffer_load_dwordx4 a[100:103], v4, s[8:11], s29 offen offset:1152 nt
 buffer_load_dwordx4 a[116:119], v4, s[8:11], s29 offen offset:1216 nt
 buffer_load_dwordx4 a[72:75], v4, s[8:11], s30 offen offset:1024 nt
 buffer_load_dwordx4 a[88:91], v4, s[8:11], s30 offen offset:1088 nt
 buffer_load_dwordx4 a[104:107], v4, s[8:11], s30 offen offset:1152 nt
 buffer_load_dwordx4 a[120:123], v4, s[8:11], s30 offen offset:1216 nt
 buffer_load_dwordx4 a[76:79], v4, s[8:11], s31 offen offset:1024 nt
 buffer_load_dwordx4 a[92:95], v4, s[8:11], s31 offen offset:1088 nt
 buffer_load_dwordx4 a[108:111], v4, s[8:11], s31 offen offset:1152 nt
 buffer_load_dwordx4 a[124:127], v4, s[8:11], s31 offen offset:1216 nt
Lseg3:
 s_waitcnt vmcnt(14) lgkmcnt(0)
 v_mfma_f32_16x16x32_bf16 v[16:19], a[176:179], a[128:131], v[16:19]
 s_waitcnt vmcnt(15)
 v_mfma_f32_16x16x32_bf16 v[16:19], a[180:183], a[132:135], v[16:19]
 v_mfma_f32_16x16x32_bf16 v[20:23], a[180:183], a[140:143], v[20:23]
 v_mfma_f32_16x16x32_bf16 v[20:23], a[176:179], a[136:139], v[20:23]
 v_mfma_f32_16x16x32_bf16 v[24:27], a[176:179], a[144:147], v[24:27]
 v_mfma_f32_16x16x32_bf16 v[24:27], a[180:183], a[148:151], v[24:27]
 v_mfma_f32_16x16x32_bf16 v[28:31], a[180:183], a[156:159], v[28:31]
 buffer_load_dwordx4 a[180:183], v0, s[12:15], s24 offen offset:1024
 v_mfma_f32_16x16x32_bf16 v[28:31], a[176:179], a[152:155], v[28:31]
 buffer_load_dwordx4 a[176:179], v0, s[12:15], s24 offen
 s_waitcnt vmcnt(14)
 v_mfma_f32_16x16x32_bf16 v[44:47], a[184:187], a[152:155], v[44:47]
 v_mfma_f32_16x16x32_bf16 v[44:47], a[188:191], a[156:159], v[44:47]
 v_mfma_f32_16x16x32_bf16 v[40:43], a[188:191], a[148:151], v[40:43]
 ds_read_b128 a[160:163], v1 offset:8192
 v_mfma_f32_16x16x32_bf16 v[40:43], a[184:187], a[144:147], v[40:43]
 v_mfma_f32_16x16x32_bf16 v[36:39], a[184:187], a[136:139], v[36:39]
 ds_read_b128 a[164:167], v1 offset:12288
 v_mfma_f32_16x16x32_bf16 v[36:39], a[188:191], a[140:143], v[36:39]
 v_mfma_f32_16x16x32_bf16 v[32:35], a[188:191], a[132:135], v[32:35]
 buffer_load_dwordx4 a[188:191], v0, s[12:15], s24 offen offset:3072
 v_mfma_f32_16x16x32_bf16 v[32:35], a[184:187], a[128:131], v[32:35]
 buffer_load_dwordx4 a[184:187], v0, s[12:15], s24 offen offset:2048
 s_waitcnt vmcnt(14)
 v_mfma_f32_16x16x32_bf16 v[48:51], a[192:195], a[128:131], v[48:51]
 ds_read_b128 a[168:171], v1 offset:9216
 ds_read_b128 a[172:175], v1 offset:13312
 v_mfma_f32_16x16x32_bf16 v[48:51], a[196:199], a[132:135], v[48:51]
 s_add_u32 s24, s24, 4096
 v_mfma_f32_16x16x32_bf16 v[52:55], a[196:199], a[140:143], v[52:55]
 v_mfma_f32_16x16x32_bf16 v[52:55], a[192:195], a[136:139], v[52:55]
 ds_write_b128 v3, a[64:67] offset:16384
 v_mfma_f32_16x16x32_bf16 v[56:59], a[192:195], a[144:147], v[56:59]
 v_mfma_f32_16x16x32_bf16 v[56:59], a[196:199], a[148:151], v[56:59]
 v_mfma_f32_16x16x32_bf16 v[60:63], a[196:199], a[156:159], v[60:63]
 buffer_load_dwordx4 a[196:199], v0, s[12:15], s24 offen offset:1024
 v_mfma_f32_16x16x32_bf16 v[60:63], a[192:195], a[152:155], v[60:63]
 buffer_load_dwordx4 a[192:195], v0, s[12:15], s24 offen
 s_waitcnt vmcnt(14)
 v_mfma_f32_16x16x32_bf16 v[76:79], a[200:203], a[152:155], v[76:79]
 v_mfma_f32_16x16x32_bf16 v[76:79], a[204:207], a[156:159], v[76:79]
 v_mfma_f32_16x16x32_bf16 v[72:75], a[204:207], a[148:151], v[72:75]
 v_mfma_f32_16x16x32_bf16 v[72:75], a[200:203], a[144:147], v[72:75]
 v_mfma_f32_16x16x32_bf16 v[68:71], a[200:203], a[136:139], v[68:71]
 v_mfma_f32_16x16x32_bf16 v[68:71], a[204:207], a[140:143], v[68:71]
 s_waitcnt vmcnt(20)
 v_mfma_f32_16x16x32_bf16 v[64:67], a[204:207], a[132:135], v[64:67]
 buffer_load_dwordx4 a[204:207], v0, s[12:15], s24 offen offset:3072
 v_mfma_f32_16x16x32_bf16 v[64:67], a[200:203], a[128:131], v[64:67]
 buffer_load_dwordx4 a[200:203], v0, s[12:15], s24 offen offset:2048
 s_waitcnt vmcnt(14)
 v_mfma_f32_16x16x32_bf16 v[80:83], a[208:211], a[128:131], v[80:83]
 v_mfma_f32_16x16x32_bf16 v[80:83], a[212:215], a[132:135], v[80:83]
 s_add_u32 s24, s24, 4096
 v_mfma_f32_16x16x32_bf16 v[84:87], a[212:215], a[140:143], v[84:87]
 v_mfma_f32_16x16x32_bf16 v[84:87], a[208:211], a[136:139], v[84:87]
 v_mfma_f32_16x16x32_bf16 v[88:91], a[208:211], a[144:147], v[88:91]
 v_mfma_f32_16x16x32_bf16 v[88:91], a[212:215], a[148:151], v[88:91]
 v_mfma_f32_16x16x32_bf16 v[92:95], a[212:215], a[156:159], v[92:95]
 buffer_load_dwordx4 a[212:215], v0, s[12:15], s24 offen offset:1024
 v_mfma_f32_16x16x32_bf16 v[92:95], a[208:211], a[152:155], v[92:95]
 buffer_load_dwordx4 a[208:211], v0, s[12:15], s24 offen
 s_waitcnt vmcnt(14)
 v_mfma_f32_16x16x32_bf16 v[108:111], a[216:219], a[152:155], v[108:111]
 v_mfma_f32_16x16x32_bf16 v[108:111], a[220:223], a[156:159], v[108:111]
 v_mfma_f32_16x16x32_bf16 v[104:107], a[220:223], a[148:151], v[104:107]
 ds_write_b128 v3, a[80:83] offset:20480
 v_mfma_f32_16x16x32_bf16 v[104:107], a[216:219], a[144:147], v[104:107]
 v_mfma_f32_16x16x32_bf16 v[100:103], a[216:219], a[136:139], v[100:103]
 v_mfma_f32_16x16x32_bf16 v[100:103], a[220:223], a[140:143], v[100:103]
 v_mfma_f32_16x16x32_bf16 v[96:99], a[220:223], a[132:135], v[96:99]
 buffer_load_dwordx4 a[220:223], v0, s[12:15], s24 offen offset:3072
 v_mfma_f32_16x16x32_bf16 v[96:99], a[216:219], a[128:131], v[96:99]
 buffer_load_dwordx4 a[216:219], v0, s[12:15], s24 offen offset:2048
 s_waitcnt vmcnt(14)
 v_mfma_f32_16x16x32_bf16 v[112:115], a[224:227], a[128:131], v[112:115]
 v_mfma_f32_16x16x32_bf16 v[112:115], a[228:231], a[132:135], v[112:115]
 s_add_u32 s24, s24, 4096
 v_mfma_f32_16x16x32_bf16 v[116:119], a[228:231], a[140:143], v[116:119]
 v_mfma_f32_16x16x32_bf16 v[116:119], a[224:227], a[136:139], v[116:119]
 v_mfma_f32_16x16x32_bf16 v[120:123], a[224:227], a[144:147], v[120:123]
 v_mfma_f32_16x16x32_bf16 v[120:123], a[228:231], a[148:151], v[120:123]
 v_mfma_f32_16x16x32_bf16 v[124:127], a[228:231], a[156:159], v[124:127]
 buffer_load_dwordx4 a[228:231], v0, s[12:15], s24 offen offset:1024
 v_mfma_f32_16x16x32_bf16 v[124:127], a[224:227], a[152:155], v[124:127]
 buffer_load_dwordx4 a[224:227], v0, s[12:15], s24 offen
 s_waitcnt vmcnt(14)
 v_mfma_f32_16x16x32_bf16 a[244:247], a[232:235], a[152:155], a[244:247]
 ds_read_b128 a[152:155], v1 offset:11264
 v_mfma_f32_16x16x32_bf16 a[244:247], a[236:239], a[156:159], a[244:247]
 ds_read_b128 a[156:159], v1 offset:15360
 v_mfma_f32_16x16x32_bf16 a[240:243], a[236:239], a[148:151], a[240:243]
 ds_read_b128 a[148:151], v1 offset:14336
 v_mfma_f32_16x16x32_bf16 a[240:243], a[232:235], a[144:147], a[240:243]
 ds_read_b128 a[144:147], v1 offset:10240
 v_mfma_f32_16x16x32_bf16 v[132:135], a[232:235], a[136:139], v[132:135]
 s_waitcnt vmcnt(27)
 v_mfma_f32_16x16x32_bf16 v[132:135], a[236:239], a[140:143], v[132:135]
 v_mfma_f32_16x16x32_bf16 v[128:131], a[236:239], a[132:135], v[128:131]
 buffer_load_dwordx4 a[236:239], v0, s[12:15], s24 offen offset:3072
 v_mfma_f32_16x16x32_bf16 v[128:131], a[232:235], a[128:131], v[128:131]
 buffer_load_dwordx4 a[232:235], v0, s[12:15], s24 offen offset:2048
 s_waitcnt vmcnt(14) lgkmcnt(8)
 v_mfma_f32_16x16x32_bf16 v[16:19], a[176:179], a[160:163], v[16:19]
 v_mfma_f32_16x16x32_bf16 v[16:19], a[180:183], a[164:167], v[16:19]
 s_add_u32 s24, s24, 53248
 s_waitcnt lgkmcnt(6)
 v_mfma_f32_16x16x32_bf16 v[20:23], a[180:183], a[172:175], v[20:23]
 v_mfma_f32_16x16x32_bf16 v[20:23], a[176:179], a[168:171], v[20:23]
 s_waitcnt lgkmcnt(0)
 v_mfma_f32_16x16x32_bf16 v[24:27], a[176:179], a[144:147], v[24:27]
 v_mfma_f32_16x16x32_bf16 v[24:27], a[180:183], a[148:151], v[24:27]
 v_mfma_f32_16x16x32_bf16 v[28:31], a[180:183], a[156:159], v[28:31]
 buffer_load_dwordx4 a[180:183], v0, s[12:15], s24 offen offset:1024
 v_mfma_f32_16x16x32_bf16 v[28:31], a[176:179], a[152:155], v[28:31]
 buffer_load_dwordx4 a[176:179], v0, s[12:15], s24 offen
 s_waitcnt vmcnt(14)
 v_mfma_f32_16x16x32_bf16 v[44:47], a[184:187], a[152:155], v[44:47]
 v_mfma_f32_16x16x32_bf16 v[44:47], a[188:191], a[156:159], v[44:47]
 v_mfma_f32_16x16x32_bf16 v[40:43], a[188:191], a[148:151], v[40:43]
 ds_read_b128 a[128:131], v1 offset:32768
 v_mfma_f32_16x16x32_bf16 v[40:43], a[184:187], a[144:147], v[40:43]
 v_mfma_f32_16x16x32_bf16 v[36:39], a[184:187], a[168:171], v[36:39]
 ds_read_b128 a[132:135], v1 offset:36864
 v_mfma_f32_16x16x32_bf16 v[36:39], a[188:191], a[172:175], v[36:39]
 ds_write_b128 v3, a[96:99] offset:24576
 v_mfma_f32_16x16x32_bf16 v[32:35], a[188:191], a[164:167], v[32:35]
 buffer_load_dwordx4 a[188:191], v0, s[12:15], s24 offen offset:3072
 v_mfma_f32_16x16x32_bf16 v[32:35], a[184:187], a[160:163], v[32:35]
 buffer_load_dwordx4 a[184:187], v0, s[12:15], s24 offen offset:2048
 s_waitcnt vmcnt(14)
 v_mfma_f32_16x16x32_bf16 v[48:51], a[192:195], a[160:163], v[48:51]
 ds_read_b128 a[136:139], v1 offset:33792
 ds_read_b128 a[140:143], v1 offset:37888
 v_mfma_f32_16x16x32_bf16 v[48:51], a[196:199], a[164:167], v[48:51]
 s_add_u32 s24, s24, 4096
 v_mfma_f32_16x16x32_bf16 v[52:55], a[196:199], a[172:175], v[52:55]
 v_mfma_f32_16x16x32_bf16 v[52:55], a[192:195], a[168:171], v[52:55]
 v_mfma_f32_16x16x32_bf16 v[56:59], a[192:195], a[144:147], v[56:59]
 v_mfma_f32_16x16x32_bf16 v[56:59], a[196:199], a[148:151], v[56:59]
 v_mfma_f32_16x16x32_bf16 v[60:63], a[196:199], a[156:159], v[60:63]
 buffer_load_dwordx4 a[196:199], v0, s[12:15], s24 offen offset:1024
 v_mfma_f32_16x16x32_bf16 v[60:63], a[192:195], a[152:155], v[60:63]
 buffer_load_dwordx4 a[192:195], v0, s[12:15], s24 offen
 s_waitcnt vmcnt(14)
 v_mfma_f32_16x16x32_bf16 v[76:79], a[200:203], a[152:155], v[76:79]
 v_mfma_f32_16x16x32_bf16 v[76:79], a[204:207], a[156:159], v[76:79]
 v_mfma_f32_16x16x32_bf16 v[72:75], a[204:207], a[148:151], v[72:75]
 v_mfma_f32_16x16x32_bf16 v[72:75], a[200:203], a[144:147], v[72:75]
 v_mfma_f32_16x16x32_bf16 v[68:71], a[200:203], a[168:171], v[68:71]
 v_mfma_f32_16x16x32_bf16 v[68:71], a[204:207], a[172:175], v[68:71]
 v_mfma_f32_16x16x32_bf16 v[64:67], a[204:207], a[164:167], v[64:67]
 buffer_load_dwordx4 a[204:207], v0, s[12:15], s24 offen offset:3072
 v_mfma_f32_16x16x32_bf16 v[64:67], a[200:203], a[160:163], v[64:67]
 buffer_load_dwordx4 a[200:203], v0, s[12:15], s24 offen offset:2048
 s_waitcnt vmcnt(14)
 v_mfma_f32_16x16x32_bf16 v[80:83], a[208:211], a[160:163], v[80:83]
 v_mfma_f32_16x16x32_bf16 v[80:83], a[212:215], a[164:167], v[80:83]
 s_add_u32 s24, s24, 4096
 v_mfma_f32_16x16x32_bf16 v[84:87], a[212:215], a[172:175], v[84:87]
 v_mfma_f32_16x16x32_bf16 v[84:87], a[208:211], a[168:171], v[84:87]
 v_mfma_f32_16x16x32_bf16 v[88:91], a[208:211], a[144:147], v[88:91]
 v_mfma_f32_16x16x32_bf16 v[88:91], a[212:215], a[148:151], v[88:91]
 v_mfma_f32_16x16x32_bf16 v[92:95], a[212:215], a[156:159], v[92:95]
 buffer_load_dwordx4 a[212:215], v0, s[12:15], s24 offen offset:1024
 v_mfma_f32_16x16x32_bf16 v[92:95], a[208:211], a[152:155], v[92:95]
 buffer_load_dwordx4 a[208:211], v0, s[12:15], s24 offen
 s_waitcnt vmcnt(14)
 v_mfma_f32_16x16x32_bf16 v[108:111], a[216:219], a[152:155], v[108:111]
 v_mfma_f32_16x16x32_bf16 v[108:111], a[220:223], a[156:159], v[108:111]
 ds_write_b128 v3, a[112:115] offset:28672
 v_mfma_f32_16x16x32_bf16 v[104:107], a[220:223], a[148:151], v[104:107]
 v_mfma_f32_16x16x32_bf16 v[104:107], a[216:219], a[144:147], v[104:107]
 v_mfma_f32_16x16x32_bf16 v[100:103], a[216:219], a[168:171], v[100:103]
 v_mfma_f32_16x16x32_bf16 v[100:103], a[220:223], a[172:175], v[100:103]
 v_mfma_f32_16x16x32_bf16 v[96:99], a[220:223], a[164:167], v[96:99]
 buffer_load_dwordx4 a[220:223], v0, s[12:15], s24 offen offset:3072
 v_mfma_f32_16x16x32_bf16 v[96:99], a[216:219], a[160:163], v[96:99]
 buffer_load_dwordx4 a[216:219], v0, s[12:15], s24 offen offset:2048
 s_waitcnt vmcnt(14)
 v_mfma_f32_16x16x32_bf16 v[112:115], a[224:227], a[160:163], v[112:115]
 v_mfma_f32_16x16x32_bf16 v[112:115], a[228:231], a[164:167], v[112:115]
 s_add_u32 s24, s24, 4096
 v_mfma_f32_16x16x32_bf16 v[116:119], a[228:231], a[172:175], v[116:119]
 v_mfma_f32_16x16x32_bf16 v[116:119], a[224:227], a[168:171], v[116:119]
 v_mfma_f32_16x16x32_bf16 v[120:123], a[224:227], a[144:147], v[120:123]
 v_mfma_f32_16x16x32_bf16 v[120:123], a[228:231], a[148:151], v[120:123]
 v_mfma_f32_16x16x32_bf16 v[124:127], a[228:231], a[156:159], v[124:127]
 buffer_load_dwordx4 a[228:231], v0, s[12:15], s24 offen offset:1024
 v_mfma_f32_16x16x32_bf16 v[124:127], a[224:227], a[152:155], v[124:127]
 buffer_load_dwordx4 a[224:227], v0, s[12:15], s24 offen
 s_waitcnt vmcnt(14)
 v_mfma_f32_16x16x32_bf16 a[244:247], a[232:235], a[152:155], a[244:247]
 ds_read_b128 a[152:155], v1 offset:35840
 v_mfma_f32_16x16x32_bf16 a[244:247], a[236:239], a[156:159], a[244:247]
 ds_read_b128 a[156:159], v1 offset:39936
 v_mfma_f32_16x16x32_bf16 a[240:243], a[236:239], a[148:151], a[240:243]
 ds_read_b128 a[148:151], v1 offset:38912
 v_mfma_f32_16x16x32_bf16 a[240:243], a[232:235], a[144:147], a[240:243]
 ds_read_b128 a[144:147], v1 offset:34816
 v_mfma_f32_16x16x32_bf16 v[132:135], a[232:235], a[168:171], v[132:135]
 v_mfma_f32_16x16x32_bf16 v[132:135], a[236:239], a[172:175], v[132:135]
 v_mfma_f32_16x16x32_bf16 v[128:131], a[236:239], a[164:167], v[128:131]
 buffer_load_dwordx4 a[236:239], v0, s[12:15], s24 offen offset:3072
 v_mfma_f32_16x16x32_bf16 v[128:131], a[232:235], a[160:163], v[128:131]
 buffer_load_dwordx4 a[232:235], v0, s[12:15], s24 offen offset:2048
 s_waitcnt vmcnt(14) lgkmcnt(8)
 v_mfma_f32_16x16x32_bf16 v[16:19], a[176:179], a[128:131], v[16:19]
 v_mfma_f32_16x16x32_bf16 v[16:19], a[180:183], a[132:135], v[16:19]
 s_add_u32 s24, s24, 53248
 s_waitcnt lgkmcnt(5)
 v_mfma_f32_16x16x32_bf16 v[20:23], a[180:183], a[140:143], v[20:23]
 v_mfma_f32_16x16x32_bf16 v[20:23], a[176:179], a[136:139], v[20:23]
 s_waitcnt lgkmcnt(0)
 v_mfma_f32_16x16x32_bf16 v[24:27], a[176:179], a[144:147], v[24:27]
 v_mfma_f32_16x16x32_bf16 v[24:27], a[180:183], a[148:151], v[24:27]
 v_mfma_f32_16x16x32_bf16 v[28:31], a[180:183], a[156:159], v[28:31]
 buffer_load_dwordx4 a[180:183], v0, s[12:15], s24 offen offset:1024
 v_mfma_f32_16x16x32_bf16 v[28:31], a[176:179], a[152:155], v[28:31]
 buffer_load_dwordx4 a[176:179], v0, s[12:15], s24 offen
 s_waitcnt vmcnt(14)
 v_mfma_f32_16x16x32_bf16 v[44:47], a[184:187], a[152:155], v[44:47]
 v_mfma_f32_16x16x32_bf16 v[44:47], a[188:191], a[156:159], v[44:47]
 ds_write_b128 v3, a[68:71] offset:17408
 v_mfma_f32_16x16x32_bf16 v[40:43], a[188:191], a[148:151], v[40:43]
 ds_read_b128 a[160:163], v1 offset:40960
 v_mfma_f32_16x16x32_bf16 v[40:43], a[184:187], a[144:147], v[40:43]
 v_mfma_f32_16x16x32_bf16 v[36:39], a[184:187], a[136:139], v[36:39]
 ds_read_b128 a[164:167], v1 offset:45056
 v_mfma_f32_16x16x32_bf16 v[36:39], a[188:191], a[140:143], v[36:39]
 v_mfma_f32_16x16x32_bf16 v[32:35], a[188:191], a[132:135], v[32:35]
 buffer_load_dwordx4 a[188:191], v0, s[12:15], s24 offen offset:3072
 v_mfma_f32_16x16x32_bf16 v[32:35], a[184:187], a[128:131], v[32:35]
 buffer_load_dwordx4 a[184:187], v0, s[12:15], s24 offen offset:2048
 s_waitcnt vmcnt(14)
 v_mfma_f32_16x16x32_bf16 v[48:51], a[192:195], a[128:131], v[48:51]
 ds_read_b128 a[168:171], v1 offset:41984
 ds_read_b128 a[172:175], v1 offset:46080
 v_mfma_f32_16x16x32_bf16 v[48:51], a[196:199], a[132:135], v[48:51]
 s_add_u32 s24, s24, 4096
 v_mfma_f32_16x16x32_bf16 v[52:55], a[196:199], a[140:143], v[52:55]
 v_mfma_f32_16x16x32_bf16 v[52:55], a[192:195], a[136:139], v[52:55]
 v_mfma_f32_16x16x32_bf16 v[56:59], a[192:195], a[144:147], v[56:59]
 v_mfma_f32_16x16x32_bf16 v[56:59], a[196:199], a[148:151], v[56:59]
 v_mfma_f32_16x16x32_bf16 v[60:63], a[196:199], a[156:159], v[60:63]
 buffer_load_dwordx4 a[196:199], v0, s[12:15], s24 offen offset:1024
 v_mfma_f32_16x16x32_bf16 v[60:63], a[192:195], a[152:155], v[60:63]
 buffer_load_dwordx4 a[192:195], v0, s[12:15], s24 offen
 s_waitcnt vmcnt(14)
 v_mfma_f32_16x16x32_bf16 v[76:79], a[200:203], a[152:155], v[76:79]
 v_mfma_f32_16x16x32_bf16 v[76:79], a[204:207], a[156:159], v[76:79]
 v_mfma_f32_16x16x32_bf16 v[72:75], a[204:207], a[148:151], v[72:75]
 v_mfma_f32_16x16x32_bf16 v[72:75], a[200:203], a[144:147], v[72:75]
 v_mfma_f32_16x16x32_bf16 v[68:71], a[200:203], a[136:139], v[68:71]
 v_mfma_f32_16x16x32_bf16 v[68:71], a[204:207], a[140:143], v[68:71]
 v_mfma_f32_16x16x32_bf16 v[64:67], a[204:207], a[132:135], v[64:67]
 buffer_load_dwordx4 a[204:207], v0, s[12:15], s24 offen offset:3072
 v_mfma_f32_16x16x32_bf16 v[64:67], a[200:203], a[128:131], v[64:67]
 buffer_load_dwordx4 a[200:203], v0, s[12:15], s24 offen offset:2048
 s_waitcnt vmcnt(14)
 v_mfma_f32_16x16x32_bf16 v[80:83], a[208:211], a[128:131], v[80:83]
 v_mfma_f32_16x16x32_bf16 v[80:83], a[212:215], a[132:135], v[80:83]
 s_add_u32 s24, s24, 4096
 v_mfma_f32_16x16x32_bf16 v[84:87], a[212:215], a[140:143], v[84:87]
 v_mfma_f32_16x16x32_bf16 v[84:87], a[208:211], a[136:139], v[84:87]
 v_mfma_f32_16x16x32_bf16 v[88:91], a[208:211], a[144:147], v[88:91]
 v_mfma_f32_16x16x32_bf16 v[88:91], a[212:215], a[148:151], v[88:91]
 ds_write_b128 v3, a[84:87] offset:21504
 v_mfma_f32_16x16x32_bf16 v[92:95], a[212:215], a[156:159], v[92:95]
 buffer_load_dwordx4 a[212:215], v0, s[12:15], s24 offen offset:1024
 v_mfma_f32_16x16x32_bf16 v[92:95], a[208:211], a[152:155], v[92:95]
 buffer_load_dwordx4 a[208:211], v0, s[12:15], s24 offen
 s_waitcnt vmcnt(14)
 v_mfma_f32_16x16x32_bf16 v[108:111], a[216:219], a[152:155], v[108:111]
 v_mfma_f32_16x16x32_bf16 v[108:111], a[220:223], a[156:159], v[108:111]
 v_mfma_f32_16x16x32_bf16 v[104:107], a[220:223], a[148:151], v[104:107]
 v_mfma_f32_16x16x32_bf16 v[104:107], a[216:219], a[144:147], v[104:107]
 v_mfma_f32_16x16x32_bf16 v[100:103], a[216:219], a[136:139], v[100:103]
 v_mfma_f32_16x16x32_bf16 v[100:103], a[220:223], a[140:143], v[100:103]
 v_mfma_f32_16x16x32_bf16 v[96:99], a[220:223], a[132:135], v[96:99]
 buffer_load_dwordx4 a[220:223], v0, s[12:15], s24 offen offset:3072
 v_mfma_f32_16x16x32_bf16 v[96:99], a[216:219], a[128:131], v[96:99]
 buffer_load_dwordx4 a[216:219], v0, s[12:15], s24 offen offset:2048
 s_waitcnt vmcnt(14)
 v_mfma_f32_16x16x32_bf16 v[112:115], a[224:227], a[128:131], v[112:115]
 v_mfma_f32_16x16x32_bf16 v[112:115], a[228:231], a[132:135], v[112:115]
 s_add_u32 s24, s24, 4096
 v_mfma_f32_16x16x32_bf16 v[116:119], a[228:231], a[140:143], v[116:119]
 v_mfma_f32_16x16x32_bf16 v[116:119], a[224:227], a[136:139], v[116:119]
 v_mfma_f32_16x16x32_bf16 v[120:123], a[224:227], a[144:147], v[120:123]
 v_mfma_f32_16x16x32_bf16 v[120:123], a[228:231], a[148:151], v[120:123]
 v_mfma_f32_16x16x32_bf16 v[124:127], a[228:231], a[156:159], v[124:127]
 buffer_load_dwordx4 a[228:231], v0, s[12:15], s24 offen offset:1024
 v_mfma_f32_16x16x32_bf16 v[124:127], a[224:227], a[152:155], v[124:127]
 buffer_load_dwordx4 a[224:227], v0, s[12:15], s24 offen
 s_waitcnt vmcnt(14)
 v_mfma_f32_16x16x32_bf16 a[244:247], a[232:235], a[152:155], a[244:247]
 ds_read_b128 a[152:155], v1 offset:44032
 v_mfma_f32_16x16x32_bf16 a[244:247], a[236:239], a[156:159], a[244:247]
 ds_read_b128 a[156:159], v1 offset:48128
 v_mfma_f32_16x16x32_bf16 a[240:243], a[236:239], a[148:151], a[240:243]
 ds_read_b128 a[148:151], v1 offset:47104
 v_mfma_f32_16x16x32_bf16 a[240:243], a[232:235], a[144:147], a[240:243]
 ds_read_b128 a[144:147], v1 offset:43008
 v_mfma_f32_16x16x32_bf16 v[132:135], a[232:235], a[136:139], v[132:135]
 v_mfma_f32_16x16x32_bf16 v[132:135], a[236:239], a[140:143], v[132:135]
 v_mfma_f32_16x16x32_bf16 v[128:131], a[236:239], a[132:135], v[128:131]
 buffer_load_dwordx4 a[236:239], v0, s[12:15], s24 offen offset:3072
 v_mfma_f32_16x16x32_bf16 v[128:131], a[232:235], a[128:131], v[128:131]
 buffer_load_dwordx4 a[232:235], v0, s[12:15], s24 offen offset:2048
 s_waitcnt vmcnt(14) lgkmcnt(7)
 v_mfma_f32_16x16x32_bf16 v[16:19], a[176:179], a[160:163], v[16:19]
 v_mfma_f32_16x16x32_bf16 v[16:19], a[180:183], a[164:167], v[16:19]
 s_add_u32 s24, s24, 53248
 s_waitcnt lgkmcnt(5)
 v_mfma_f32_16x16x32_bf16 v[20:23], a[180:183], a[172:175], v[20:23]
 v_mfma_f32_16x16x32_bf16 v[20:23], a[176:179], a[168:171], v[20:23]
 s_waitcnt lgkmcnt(0)
 v_mfma_f32_16x16x32_bf16 v[24:27], a[176:179], a[144:147], v[24:27]
 v_mfma_f32_16x16x32_bf16 v[24:27], a[180:183], a[148:151], v[24:27]
 v_mfma_f32_16x16x32_bf16 v[28:31], a[180:183], a[156:159], v[28:31]
 buffer_load_dwordx4 a[180:183], v0, s[12:15], s24 offen offset:1024
 v_mfma_f32_16x16x32_bf16 v[28:31], a[176:179], a[152:155], v[28:31]
 buffer_load_dwordx4 a[176:179], v0, s[12:15], s24 offen
 s_waitcnt vmcnt(14)
 v_mfma_f32_16x16x32_bf16 v[44:47], a[184:187], a[152:155], v[44:47]
 ds_write_b128 v3, a[100:103] offset:25600
 v_mfma_f32_16x16x32_bf16 v[44:47], a[188:191], a[156:159], v[44:47]
 v_mfma_f32_16x16x32_bf16 v[40:43], a[188:191], a[148:151], v[40:43]
 ds_read_b128 a[128:131], v2
 v_mfma_f32_16x16x32_bf16 v[40:43], a[184:187], a[144:147], v[40:43]
 v_mfma_f32_16x16x32_bf16 v[36:39], a[184:187], a[168:171], v[36:39]
 ds_read_b128 a[132:135], v2 offset:4096
 v_mfma_f32_16x16x32_bf16 v[36:39], a[188:191], a[172:175], v[36:39]
 v_mfma_f32_16x16x32_bf16 v[32:35], a[188:191], a[164:167], v[32:35]
 buffer_load_dwordx4 a[188:191], v0, s[12:15], s24 offen offset:3072
 v_mfma_f32_16x16x32_bf16 v[32:35], a[184:187], a[160:163], v[32:35]
 buffer_load_dwordx4 a[184:187], v0, s[12:15], s24 offen offset:2048
 s_waitcnt vmcnt(14)
 v_mfma_f32_16x16x32_bf16 v[48:51], a[192:195], a[160:163], v[48:51]
 ds_read_b128 a[136:139], v2 offset:1024
 ds_read_b128 a[140:143], v2 offset:5120
 v_mfma_f32_16x16x32_bf16 v[48:51], a[196:199], a[164:167], v[48:51]
 s_add_u32 s24, s24, 4096
 v_mfma_f32_16x16x32_bf16 v[52:55], a[196:199], a[172:175], v[52:55]
 v_mfma_f32_16x16x32_bf16 v[52:55], a[192:195], a[168:171], v[52:55]
 v_mfma_f32_16x16x32_bf16 v[56:59], a[192:195], a[144:147], v[56:59]
 v_mfma_f32_16x16x32_bf16 v[56:59], a[196:199], a[148:151], v[56:59]
 v_mfma_f32_16x16x32_bf16 v[60:63], a[196:199], a[156:159], v[60:63]
 buffer_load_dwordx4 a[196:199], v0, s[12:15], s24 offen offset:1024
 v_mfma_f32_16x16x32_bf16 v[60:63], a[192:195], a[152:155], v[60:63]
 buffer_load_dwordx4 a[192:195], v0, s[12:15], s24 offen
 s_waitcnt vmcnt(14)
 v_mfma_f32_16x16x32_bf16 v[76:79], a[200:203], a[152:155], v[76:79]
 v_mfma_f32_16x16x32_bf16 v[76:79], a[204:207], a[156:159], v[76:79]
 v_mfma_f32_16x16x32_bf16 v[72:75], a[204:207], a[148:151], v[72:75]
 v_mfma_f32_16x16x32_bf16 v[72:75], a[200:203], a[144:147], v[72:75]
 v_mfma_f32_16x16x32_bf16 v[68:71], a[200:203], a[168:171], v[68:71]
 v_mfma_f32_16x16x32_bf16 v[68:71], a[204:207], a[172:175], v[68:71]
 v_mfma_f32_16x16x32_bf16 v[64:67], a[204:207], a[164:167], v[64:67]
 buffer_load_dwordx4 a[204:207], v0, s[12:15], s24 offen offset:3072
 v_mfma_f32_16x16x32_bf16 v[64:67], a[200:203], a[160:163], v[64:67]
 buffer_load_dwordx4 a[200:203], v0, s[12:15], s24 offen offset:2048
 s_waitcnt vmcnt(14)
 v_mfma_f32_16x16x32_bf16 v[80:83], a[208:211], a[160:163], v[80:83]
 v_mfma_f32_16x16x32_bf16 v[80:83], a[212:215], a[164:167], v[80:83]
 s_add_u32 s24, s24, 4096
 v_mfma_f32_16x16x32_bf16 v[84:87], a[212:215], a[172:175], v[84:87]
 v_mfma_f32_16x16x32_bf16 v[84:87], a[208:211], a[168:171], v[84:87]
 ds_write_b128 v3, a[116:119] offset:29696
 v_mfma_f32_16x16x32_bf16 v[88:91], a[208:211], a[144:147], v[88:91]
 v_mfma_f32_16x16x32_bf16 v[88:91], a[212:215], a[148:151], v[88:91]
 v_mfma_f32_16x16x32_bf16 v[92:95], a[212:215], a[156:159], v[92:95]
 buffer_load_dwordx4 a[212:215], v0, s[12:15], s24 offen offset:1024
 v_mfma_f32_16x16x32_bf16 v[92:95], a[208:211], a[152:155], v[92:95]
 buffer_load_dwordx4 a[208:211], v0, s[12:15], s24 offen
 s_waitcnt vmcnt(14)
 v_mfma_f32_16x16x32_bf16 v[108:111], a[216:219], a[152:155], v[108:111]
 v_mfma_f32_16x16x32_bf16 v[108:111], a[220:223], a[156:159], v[108:111]
 v_mfma_f32_16x16x32_bf16 v[104:107], a[220:223], a[148:151], v[104:107]
 v_mfma_f32_16x16x32_bf16 v[104:107], a[216:219], a[144:147], v[104:107]
 v_mfma_f32_16x16x32_bf16 v[100:103], a[216:219], a[168:171], v[100:103]
 v_mfma_f32_16x16x32_bf16 v[100:103], a[220:223], a[172:175], v[100:103]
 v_mfma_f32_16x16x32_bf16 v[96:99], a[220:223], a[164:167], v[96:99]
 buffer_load_dwordx4 a[220:223], v0, s[12:15], s24 offen offset:3072
 v_mfma_f32_16x16x32_bf16 v[96:99], a[216:219], a[160:163], v[96:99]
 buffer_load_dwordx4 a[216:219], v0, s[12:15], s24 offen offset:2048
 s_waitcnt vmcnt(14)
 v_mfma_f32_16x16x32_bf16 v[112:115], a[224:227], a[160:163], v[112:115]
 v_mfma_f32_16x16x32_bf16 v[112:115], a[228:231], a[164:167], v[112:115]
 s_add_u32 s24, s24, 4096
 v_mfma_f32_16x16x32_bf16 v[116:119], a[228:231], a[172:175], v[116:119]
 v_mfma_f32_16x16x32_bf16 v[116:119], a[224:227], a[168:171], v[116:119]
 v_mfma_f32_16x16x32_bf16 v[120:123], a[224:227], a[144:147], v[120:123]
 v_mfma_f32_16x16x32_bf16 v[120:123], a[228:231], a[148:151], v[120:123]
 v_mfma_f32_16x16x32_bf16 v[124:127], a[228:231], a[156:159], v[124:127]
 buffer_load_dwordx4 a[228:231], v0, s[12:15], s24 offen offset:1024
 v_mfma_f32_16x16x32_bf16 v[124:127], a[224:227], a[152:155], v[124:127]
 buffer_load_dwordx4 a[224:227], v0, s[12:15], s24 offen
 s_waitcnt vmcnt(14)
 v_mfma_f32_16x16x32_bf16 a[244:247], a[232:235], a[152:155], a[244:247]
 ds_read_b128 a[152:155], v2 offset:3072
 v_mfma_f32_16x16x32_bf16 a[244:247], a[236:239], a[156:159], a[244:247]
 ds_read_b128 a[156:159], v2 offset:7168
 v_mfma_f32_16x16x32_bf16 a[240:243], a[236:239], a[148:151], a[240:243]
 ds_read_b128 a[148:151], v2 offset:6144
 v_mfma_f32_16x16x32_bf16 a[240:243], a[232:235], a[144:147], a[240:243]
 ds_read_b128 a[144:147], v2 offset:2048
 v_mfma_f32_16x16x32_bf16 v[132:135], a[232:235], a[168:171], v[132:135]
 v_mfma_f32_16x16x32_bf16 v[132:135], a[236:239], a[172:175], v[132:135]
 v_mfma_f32_16x16x32_bf16 v[128:131], a[236:239], a[164:167], v[128:131]
 buffer_load_dwordx4 a[236:239], v0, s[12:15], s24 offen offset:3072
 v_mfma_f32_16x16x32_bf16 v[128:131], a[232:235], a[160:163], v[128:131]
 buffer_load_dwordx4 a[232:235], v0, s[12:15], s24 offen offset:2048
 s_waitcnt vmcnt(14) lgkmcnt(7)
 v_mfma_f32_16x16x32_bf16 v[16:19], a[176:179], a[128:131], v[16:19]
 v_mfma_f32_16x16x32_bf16 v[16:19], a[180:183], a[132:135], v[16:19]
 s_add_u32 s24, s24, 53248
 s_waitcnt lgkmcnt(5)
 v_mfma_f32_16x16x32_bf16 v[20:23], a[180:183], a[140:143], v[20:23]
 ds_write_b128 v3, a[72:75] offset:18432
 v_mfma_f32_16x16x32_bf16 v[20:23], a[176:179], a[136:139], v[20:23]
 s_waitcnt lgkmcnt(1)
 v_mfma_f32_16x16x32_bf16 v[24:27], a[176:179], a[144:147], v[24:27]
 v_mfma_f32_16x16x32_bf16 v[24:27], a[180:183], a[148:151], v[24:27]
 v_mfma_f32_16x16x32_bf16 v[28:31], a[180:183], a[156:159], v[28:31]
 buffer_load_dwordx4 a[180:183], v0, s[12:15], s24 offen offset:1024
 v_mfma_f32_16x16x32_bf16 v[28:31], a[176:179], a[152:155], v[28:31]
 buffer_load_dwordx4 a[176:179], v0, s[12:15], s24 offen
 s_waitcnt vmcnt(14)
 v_mfma_f32_16x16x32_bf16 v[44:47], a[184:187], a[152:155], v[44:47]
 v_mfma_f32_16x16x32_bf16 v[44:47], a[188:191], a[156:159], v[44:47]
 v_mfma_f32_16x16x32_bf16 v[40:43], a[188:191], a[148:151], v[40:43]
 ds_read_b128 a[160:163], v2 offset:8192
 v_mfma_f32_16x16x32_bf16 v[40:43], a[184:187], a[144:147], v[40:43]
 v_mfma_f32_16x16x32_bf16 v[36:39], a[184:187], a[136:139], v[36:39]
 ds_read_b128 a[164:167], v2 offset:12288
 v_mfma_f32_16x16x32_bf16 v[36:39], a[188:191], a[140:143], v[36:39]
 v_mfma_f32_16x16x32_bf16 v[32:35], a[188:191], a[132:135], v[32:35]
 buffer_load_dwordx4 a[188:191], v0, s[12:15], s24 offen offset:3072
 v_mfma_f32_16x16x32_bf16 v[32:35], a[184:187], a[128:131], v[32:35]
 buffer_load_dwordx4 a[184:187], v0, s[12:15], s24 offen offset:2048
 s_waitcnt vmcnt(14)
 v_mfma_f32_16x16x32_bf16 v[48:51], a[192:195], a[128:131], v[48:51]
 ds_read_b128 a[168:171], v2 offset:9216
 ds_read_b128 a[172:175], v2 offset:13312
 v_mfma_f32_16x16x32_bf16 v[48:51], a[196:199], a[132:135], v[48:51]
 s_add_u32 s24, s24, 4096
 v_mfma_f32_16x16x32_bf16 v[52:55], a[196:199], a[140:143], v[52:55]
 v_mfma_f32_16x16x32_bf16 v[52:55], a[192:195], a[136:139], v[52:55]
 v_mfma_f32_16x16x32_bf16 v[56:59], a[192:195], a[144:147], v[56:59]
 v_mfma_f32_16x16x32_bf16 v[56:59], a[196:199], a[148:151], v[56:59]
 v_mfma_f32_16x16x32_bf16 v[60:63], a[196:199], a[156:159], v[60:63]
 buffer_load_dwordx4 a[196:199], v0, s[12:15], s24 offen offset:1024
 v_mfma_f32_16x16x32_bf16 v[60:63], a[192:195], a[152:155], v[60:63]
 buffer_load_dwordx4 a[192:195], v0, s[12:15], s24 offen
 s_waitcnt vmcnt(14)
 v_mfma_f32_16x16x32_bf16 v[76:79], a[200:203], a[152:155], v[76:79]
 v_mfma_f32_16x16x32_bf16 v[76:79], a[204:207], a[156:159], v[76:79]
 v_mfma_f32_16x16x32_bf16 v[72:75], a[204:207], a[148:151], v[72:75]
 v_mfma_f32_16x16x32_bf16 v[72:75], a[200:203], a[144:147], v[72:75]
 v_mfma_f32_16x16x32_bf16 v[68:71], a[200:203], a[136:139], v[68:71]
 v_mfma_f32_16x16x32_bf16 v[68:71], a[204:207], a[140:143], v[68:71]
 v_mfma_f32_16x16x32_bf16 v[64:67], a[204:207], a[132:135], v[64:67]
 buffer_load_dwordx4 a[204:207], v0, s[12:15], s24 offen offset:3072
 v_mfma_f32_16x16x32_bf16 v[64:67], a[200:203], a[128:131], v[64:67]
 buffer_load_dwordx4 a[200:203], v0, s[12:15], s24 offen offset:2048
 s_waitcnt vmcnt(14)
 v_mfma_f32_16x16x32_bf16 v[80:83], a[208:211], a[128:131], v[80:83]
 ds_write_b128 v3, a[88:91] offset:22528
 v_mfma_f32_16x16x32_bf16 v[80:83], a[212:215], a[132:135], v[80:83]
 s_add_u32 s24, s24, 4096
 v_mfma_f32_16x16x32_bf16 v[84:87], a[212:215], a[140:143], v[84:87]
 v_mfma_f32_16x16x32_bf16 v[84:87], a[208:211], a[136:139], v[84:87]
 v_mfma_f32_16x16x32_bf16 v[88:91], a[208:211], a[144:147], v[88:91]
 v_mfma_f32_16x16x32_bf16 v[88:91], a[212:215], a[148:151], v[88:91]
 v_mfma_f32_16x16x32_bf16 v[92:95], a[212:215], a[156:159], v[92:95]
 buffer_load_dwordx4 a[212:215], v0, s[12:15], s24 offen offset:1024
 v_mfma_f32_16x16x32_bf16 v[92:95], a[208:211], a[152:155], v[92:95]
 buffer_load_dwordx4 a[208:211], v0, s[12:15], s24 offen
 s_waitcnt vmcnt(14)
 v_mfma_f32_16x16x32_bf16 v[108:111], a[216:219], a[152:155], v[108:111]
 v_mfma_f32_16x16x32_bf16 v[108:111], a[220:223], a[156:159], v[108:111]
 v_mfma_f32_16x16x32_bf16 v[104:107], a[220:223], a[148:151], v[104:107]
 v_mfma_f32_16x16x32_bf16 v[104:107], a[216:219], a[144:147], v[104:107]
 v_mfma_f32_16x16x32_bf16 v[100:103], a[216:219], a[136:139], v[100:103]
 v_mfma_f32_16x16x32_bf16 v[100:103], a[220:223], a[140:143], v[100:103]
 v_mfma_f32_16x16x32_bf16 v[96:99], a[220:223], a[132:135], v[96:99]
 buffer_load_dwordx4 a[220:223], v0, s[12:15], s24 offen offset:3072
 v_mfma_f32_16x16x32_bf16 v[96:99], a[216:219], a[128:131], v[96:99]
 buffer_load_dwordx4 a[216:219], v0, s[12:15], s24 offen offset:2048
 s_waitcnt vmcnt(14)
 v_mfma_f32_16x16x32_bf16 v[112:115], a[224:227], a[128:131], v[112:115]
 v_mfma_f32_16x16x32_bf16 v[112:115], a[228:231], a[132:135], v[112:115]
 s_add_u32 s24, s24, 4096
 v_mfma_f32_16x16x32_bf16 v[116:119], a[228:231], a[140:143], v[116:119]
 v_mfma_f32_16x16x32_bf16 v[116:119], a[224:227], a[136:139], v[116:119]
 v_mfma_f32_16x16x32_bf16 v[120:123], a[224:227], a[144:147], v[120:123]
 v_mfma_f32_16x16x32_bf16 v[120:123], a[228:231], a[148:151], v[120:123]
 v_mfma_f32_16x16x32_bf16 v[124:127], a[228:231], a[156:159], v[124:127]
 buffer_load_dwordx4 a[228:231], v0, s[12:15], s24 offen offset:1024
 v_mfma_f32_16x16x32_bf16 v[124:127], a[224:227], a[152:155], v[124:127]
 buffer_load_dwordx4 a[224:227], v0, s[12:15], s24 offen
 s_waitcnt vmcnt(14)
 v_mfma_f32_16x16x32_bf16 a[244:247], a[232:235], a[152:155], a[244:247]
 ds_read_b128 a[152:155], v2 offset:11264
 v_mfma_f32_16x16x32_bf16 a[244:247], a[236:239], a[156:159], a[244:247]
 ds_read_b128 a[156:159], v2 offset:15360
 v_mfma_f32_16x16x32_bf16 a[240:243], a[236:239], a[148:151], a[240:243]
 ds_read_b128 a[148:151], v2 offset:14336
 v_mfma_f32_16x16x32_bf16 a[240:243], a[232:235], a[144:147], a[240:243]
 ds_read_b128 a[144:147], v2 offset:10240
 v_mfma_f32_16x16x32_bf16 v[132:135], a[232:235], a[136:139], v[132:135]
 v_mfma_f32_16x16x32_bf16 v[132:135], a[236:239], a[140:143], v[132:135]
 ds_write_b128 v3, a[104:107] offset:26624
 v_mfma_f32_16x16x32_bf16 v[128:131], a[236:239], a[132:135], v[128:131]
 buffer_load_dwordx4 a[236:239], v0, s[12:15], s24 offen offset:3072
 v_mfma_f32_16x16x32_bf16 v[128:131], a[232:235], a[128:131], v[128:131]
 buffer_load_dwordx4 a[232:235], v0, s[12:15], s24 offen offset:2048
 s_waitcnt vmcnt(14) lgkmcnt(8)
 v_mfma_f32_16x16x32_bf16 v[16:19], a[176:179], a[160:163], v[16:19]
 v_mfma_f32_16x16x32_bf16 v[16:19], a[180:183], a[164:167], v[16:19]
 s_add_u32 s24, s24, 53248
 s_waitcnt lgkmcnt(6)
 v_mfma_f32_16x16x32_bf16 v[20:23], a[180:183], a[172:175], v[20:23]
 v_mfma_f32_16x16x32_bf16 v[20:23], a[176:179], a[168:171], v[20:23]
 s_waitcnt lgkmcnt(1)
 v_mfma_f32_16x16x32_bf16 v[24:27], a[176:179], a[144:147], v[24:27]
 v_mfma_f32_16x16x32_bf16 v[24:27], a[180:183], a[148:151], v[24:27]
 v_mfma_f32_16x16x32_bf16 v[28:31], a[180:183], a[156:159], v[28:31]
 buffer_load_dwordx4 a[180:183], v0, s[12:15], s24 offen offset:1024
 v_mfma_f32_16x16x32_bf16 v[28:31], a[176:179], a[152:155], v[28:31]
 buffer_load_dwordx4 a[176:179], v0, s[12:15], s24 offen
 s_waitcnt vmcnt(14)
 v_mfma_f32_16x16x32_bf16 v[44:47], a[184:187], a[152:155], v[44:47]
 v_mfma_f32_16x16x32_bf16 v[44:47], a[188:191], a[156:159], v[44:47]
 v_mfma_f32_16x16x32_bf16 v[40:43], a[188:191], a[148:151], v[40:43]
 ds_read_b128 a[128:131], v2 offset:32768
 v_mfma_f32_16x16x32_bf16 v[40:43], a[184:187], a[144:147], v[40:43]
 v_mfma_f32_16x16x32_bf16 v[36:39], a[184:187], a[168:171], v[36:39]
 ds_read_b128 a[132:135], v2 offset:36864
 v_mfma_f32_16x16x32_bf16 v[36:39], a[188:191], a[172:175], v[36:39]
 v_mfma_f32_16x16x32_bf16 v[32:35], a[188:191], a[164:167], v[32:35]
 buffer_load_dwordx4 a[188:191], v0, s[12:15], s24 offen offset:3072
 v_mfma_f32_16x16x32_bf16 v[32:35], a[184:187], a[160:163], v[32:35]
 buffer_load_dwordx4 a[184:187], v0, s[12:15], s24 offen offset:2048
 s_waitcnt vmcnt(14)
 v_mfma_f32_16x16x32_bf16 v[48:51], a[192:195], a[160:163], v[48:51]
 ds_read_b128 a[136:139], v2 offset:33792
 ds_read_b128 a[140:143], v2 offset:37888
 v_mfma_f32_16x16x32_bf16 v[48:51], a[196:199], a[164:167], v[48:51]
 s_add_u32 s24, s24, 4096
 v_mfma_f32_16x16x32_bf16 v[52:55], a[196:199], a[172:175], v[52:55]
 v_mfma_f32_16x16x32_bf16 v[52:55], a[192:195], a[168:171], v[52:55]
 v_mfma_f32_16x16x32_bf16 v[56:59], a[192:195], a[144:147], v[56:59]
 v_mfma_f32_16x16x32_bf16 v[56:59], a[196:199], a[148:151], v[56:59]
 v_mfma_f32_16x16x32_bf16 v[60:63], a[196:199], a[156:159], v[60:63]
 buffer_load_dwordx4 a[196:199], v0, s[12:15], s24 offen offset:1024
 v_mfma_f32_16x16x32_bf16 v[60:63], a[192:195], a[152:155], v[60:63]
 buffer_load_dwordx4 a[192:195], v0, s[12:15], s24 offen
 s_waitcnt vmcnt(14)
 v_mfma_f32_16x16x32_bf16 v[76:79], a[200:203], a[152:155], v[76:79]
 v_mfma_f32_16x16x32_bf16 v[76:79], a[204:207], a[156:159], v[76:79]
 v_mfma_f32_16x16x32_bf16 v[72:75], a[204:207], a[148:151], v[72:75]
 v_mfma_f32_16x16x32_bf16 v[72:75], a[200:203], a[144:147], v[72:75]
 v_mfma_f32_16x16x32_bf16 v[68:71], a[200:203], a[168:171], v[68:71]
 v_mfma_f32_16x16x32_bf16 v[68:71], a[204:207], a[172:175], v[68:71]
 ds_write_b128 v3, a[120:123] offset:30720
 v_mfma_f32_16x16x32_bf16 v[64:67], a[204:207], a[164:167], v[64:67]
 buffer_load_dwordx4 a[204:207], v0, s[12:15], s24 offen offset:3072
 v_mfma_f32_16x16x32_bf16 v[64:67], a[200:203], a[160:163], v[64:67]
 buffer_load_dwordx4 a[200:203], v0, s[12:15], s24 offen offset:2048
 s_waitcnt vmcnt(14)
 v_mfma_f32_16x16x32_bf16 v[80:83], a[208:211], a[160:163], v[80:83]
 v_mfma_f32_16x16x32_bf16 v[80:83], a[212:215], a[164:167], v[80:83]
 s_add_u32 s24, s24, 4096
 v_mfma_f32_16x16x32_bf16 v[84:87], a[212:215], a[172:175], v[84:87]
 v_mfma_f32_16x16x32_bf16 v[84:87], a[208:211], a[168:171], v[84:87]
 v_mfma_f32_16x16x32_bf16 v[88:91], a[208:211], a[144:147], v[88:91]
 v_mfma_f32_16x16x32_bf16 v[88:91], a[212:215], a[148:151], v[88:91]
 v_mfma_f32_16x16x32_bf16 v[92:95], a[212:215], a[156:159], v[92:95]
 buffer_load_dwordx4 a[212:215], v0, s[12:15], s24 offen offset:1024
 v_mfma_f32_16x16x32_bf16 v[92:95], a[208:211], a[152:155], v[92:95]
 buffer_load_dwordx4 a[208:211], v0, s[12:15], s24 offen
 s_waitcnt vmcnt(14)
 v_mfma_f32_16x16x32_bf16 v[108:111], a[216:219], a[152:155], v[108:111]
 v_mfma_f32_16x16x32_bf16 v[108:111], a[220:223], a[156:159], v[108:111]
 v_mfma_f32_16x16x32_bf16 v[104:107], a[220:223], a[148:151], v[104:107]
 v_mfma_f32_16x16x32_bf16 v[104:107], a[216:219], a[144:147], v[104:107]
 v_mfma_f32_16x16x32_bf16 v[100:103], a[216:219], a[168:171], v[100:103]
 v_mfma_f32_16x16x32_bf16 v[100:103], a[220:223], a[172:175], v[100:103]
 v_mfma_f32_16x16x32_bf16 v[96:99], a[220:223], a[164:167], v[96:99]
 buffer_load_dwordx4 a[220:223], v0, s[12:15], s24 offen offset:3072
 v_mfma_f32_16x16x32_bf16 v[96:99], a[216:219], a[160:163], v[96:99]
 buffer_load_dwordx4 a[216:219], v0, s[12:15], s24 offen offset:2048
 s_waitcnt vmcnt(14)
 v_mfma_f32_16x16x32_bf16 v[112:115], a[224:227], a[160:163], v[112:115]
 v_mfma_f32_16x16x32_bf16 v[112:115], a[228:231], a[164:167], v[112:115]
 s_add_u32 s24, s24, 4096
 v_mfma_f32_16x16x32_bf16 v[116:119], a[228:231], a[172:175], v[116:119]
 v_mfma_f32_16x16x32_bf16 v[116:119], a[224:227], a[168:171], v[116:119]
 v_mfma_f32_16x16x32_bf16 v[120:123], a[224:227], a[144:147], v[120:123]
 v_mfma_f32_16x16x32_bf16 v[120:123], a[228:231], a[148:151], v[120:123]
 ds_write_b128 v3, a[76:79] offset:19456
 v_mfma_f32_16x16x32_bf16 v[124:127], a[228:231], a[156:159], v[124:127]
 buffer_load_dwordx4 a[228:231], v0, s[12:15], s24 offen offset:1024
 v_mfma_f32_16x16x32_bf16 v[124:127], a[224:227], a[152:155], v[124:127]
 buffer_load_dwordx4 a[224:227], v0, s[12:15], s24 offen
 s_waitcnt vmcnt(14)
 v_mfma_f32_16x16x32_bf16 a[244:247], a[232:235], a[152:155], a[244:247]
 ds_read_b128 a[152:155], v2 offset:35840
 v_mfma_f32_16x16x32_bf16 a[244:247], a[236:239], a[156:159], a[244:247]
 ds_read_b128 a[156:159], v2 offset:39936
 v_mfma_f32_16x16x32_bf16 a[240:243], a[236:239], a[148:151], a[240:243]
 ds_read_b128 a[148:151], v2 offset:38912
 v_mfma_f32_16x16x32_bf16 a[240:243], a[232:235], a[144:147], a[240:243]
 ds_read_b128 a[144:147], v2 offset:34816
 v_mfma_f32_16x16x32_bf16 v[132:135], a[232:235], a[168:171], v[132:135]
 v_mfma_f32_16x16x32_bf16 v[132:135], a[236:239], a[172:175], v[132:135]
 v_mfma_f32_16x16x32_bf16 v[128:131], a[236:239], a[164:167], v[128:131]
 buffer_load_dwordx4 a[236:239], v0, s[12:15], s24 offen offset:3072
 v_mfma_f32_16x16x32_bf16 v[128:131], a[232:235], a[160:163], v[128:131]
 buffer_load_dwordx4 a[232:235], v0, s[12:15], s24 offen offset:2048
 s_waitcnt vmcnt(14) lgkmcnt(8)
 v_mfma_f32_16x16x32_bf16 v[16:19], a[176:179], a[128:131], v[16:19]
 v_mfma_f32_16x16x32_bf16 v[16:19], a[180:183], a[132:135], v[16:19]
 s_add_u32 s24, s24, 53248
 s_waitcnt lgkmcnt(6)
 v_mfma_f32_16x16x32_bf16 v[20:23], a[180:183], a[140:143], v[20:23]
 v_mfma_f32_16x16x32_bf16 v[20:23], a[176:179], a[136:139], v[20:23]
 s_waitcnt lgkmcnt(0)
 v_mfma_f32_16x16x32_bf16 v[24:27], a[176:179], a[144:147], v[24:27]
 v_mfma_f32_16x16x32_bf16 v[24:27], a[180:183], a[148:151], v[24:27]
 v_mfma_f32_16x16x32_bf16 v[28:31], a[180:183], a[156:159], v[28:31]
 buffer_load_dwordx4 a[180:183], v0, s[12:15], s24 offen offset:1024
 v_mfma_f32_16x16x32_bf16 v[28:31], a[176:179], a[152:155], v[28:31]
 buffer_load_dwordx4 a[176:179], v0, s[12:15], s24 offen
 s_waitcnt vmcnt(14)
 v_mfma_f32_16x16x32_bf16 v[44:47], a[184:187], a[152:155], v[44:47]
 v_mfma_f32_16x16x32_bf16 v[44:47], a[188:191], a[156:159], v[44:47]
 v_mfma_f32_16x16x32_bf16 v[40:43], a[188:191], a[148:151], v[40:43]
 ds_read_b128 a[160:163], v2 offset:40960
 v_mfma_f32_16x16x32_bf16 v[40:43], a[184:187], a[144:147], v[40:43]
 v_mfma_f32_16x16x32_bf16 v[36:39], a[184:187], a[136:139], v[36:39]
 ds_read_b128 a[164:167], v2 offset:45056
 v_mfma_f32_16x16x32_bf16 v[36:39], a[188:191], a[140:143], v[36:39]
 v_mfma_f32_16x16x32_bf16 v[32:35], a[188:191], a[132:135], v[32:35]
 buffer_load_dwordx4 a[188:191], v0, s[12:15], s24 offen offset:3072
 v_mfma_f32_16x16x32_bf16 v[32:35], a[184:187], a[128:131], v[32:35]
 buffer_load_dwordx4 a[184:187], v0, s[12:15], s24 offen offset:2048
 s_waitcnt vmcnt(14)
 v_mfma_f32_16x16x32_bf16 v[48:51], a[192:195], a[128:131], v[48:51]
 ds_read_b128 a[168:171], v2 offset:41984
 ds_read_b128 a[172:175], v2 offset:46080
 v_mfma_f32_16x16x32_bf16 v[48:51], a[196:199], a[132:135], v[48:51]
 s_add_u32 s24, s24, 4096
 v_mfma_f32_16x16x32_bf16 v[52:55], a[196:199], a[140:143], v[52:55]
 v_mfma_f32_16x16x32_bf16 v[52:55], a[192:195], a[136:139], v[52:55]
 v_mfma_f32_16x16x32_bf16 v[56:59], a[192:195], a[144:147], v[56:59]
 v_mfma_f32_16x16x32_bf16 v[56:59], a[196:199], a[148:151], v[56:59]
 v_mfma_f32_16x16x32_bf16 v[60:63], a[196:199], a[156:159], v[60:63]
 buffer_load_dwordx4 a[196:199], v0, s[12:15], s24 offen offset:1024
 v_mfma_f32_16x16x32_bf16 v[60:63], a[192:195], a[152:155], v[60:63]
 buffer_load_dwordx4 a[192:195], v0, s[12:15], s24 offen
 s_waitcnt vmcnt(14)
 v_mfma_f32_16x16x32_bf16 v[76:79], a[200:203], a[152:155], v[76:79]
 v_mfma_f32_16x16x32_bf16 v[76:79], a[204:207], a[156:159], v[76:79]
 v_mfma_f32_16x16x32_bf16 v[72:75], a[204:207], a[148:151], v[72:75]
 v_mfma_f32_16x16x32_bf16 v[72:75], a[200:203], a[144:147], v[72:75]
 ds_write_b128 v3, a[92:95] offset:23552
 v_mfma_f32_16x16x32_bf16 v[68:71], a[200:203], a[136:139], v[68:71]
 v_mfma_f32_16x16x32_bf16 v[68:71], a[204:207], a[140:143], v[68:71]
 v_mfma_f32_16x16x32_bf16 v[64:67], a[204:207], a[132:135], v[64:67]
 buffer_load_dwordx4 a[204:207], v0, s[12:15], s24 offen offset:3072
 v_mfma_f32_16x16x32_bf16 v[64:67], a[200:203], a[128:131], v[64:67]
 buffer_load_dwordx4 a[200:203], v0, s[12:15], s24 offen offset:2048
 s_waitcnt vmcnt(14)
 v_mfma_f32_16x16x32_bf16 v[80:83], a[208:211], a[128:131], v[80:83]
 v_mfma_f32_16x16x32_bf16 v[80:83], a[212:215], a[132:135], v[80:83]
 s_add_u32 s24, s24, 4096
 v_mfma_f32_16x16x32_bf16 v[84:87], a[212:215], a[140:143], v[84:87]
 v_mfma_f32_16x16x32_bf16 v[84:87], a[208:211], a[136:139], v[84:87]
 v_mfma_f32_16x16x32_bf16 v[88:91], a[208:211], a[144:147], v[88:91]
 v_mfma_f32_16x16x32_bf16 v[88:91], a[212:215], a[148:151], v[88:91]
 v_mfma_f32_16x16x32_bf16 v[92:95], a[212:215], a[156:159], v[92:95]
 buffer_load_dwordx4 a[212:215], v0, s[12:15], s24 offen offset:1024
 v_mfma_f32_16x16x32_bf16 v[92:95], a[208:211], a[152:155], v[92:95]
 buffer_load_dwordx4 a[208:211], v0, s[12:15], s24 offen
 s_waitcnt vmcnt(14)
 v_mfma_f32_16x16x32_bf16 v[108:111], a[216:219], a[152:155], v[108:111]
 v_mfma_f32_16x16x32_bf16 v[108:111], a[220:223], a[156:159], v[108:111]
 v_mfma_f32_16x16x32_bf16 v[104:107], a[220:223], a[148:151], v[104:107]
 v_mfma_f32_16x16x32_bf16 v[104:107], a[216:219], a[144:147], v[104:107]
 v_mfma_f32_16x16x32_bf16 v[100:103], a[216:219], a[136:139], v[100:103]
 v_mfma_f32_16x16x32_bf16 v[100:103], a[220:223], a[140:143], v[100:103]
 v_mfma_f32_16x16x32_bf16 v[96:99], a[220:223], a[132:135], v[96:99]
 buffer_load_dwordx4 a[220:223], v0, s[12:15], s24 offen offset:3072
 v_mfma_f32_16x16x32_bf16 v[96:99], a[216:219], a[128:131], v[96:99]
 buffer_load_dwordx4 a[216:219], v0, s[12:15], s24 offen offset:2048
 s_waitcnt vmcnt(14)
 v_mfma_f32_16x16x32_bf16 v[112:115], a[224:227], a[128:131], v[112:115]
 v_mfma_f32_16x16x32_bf16 v[112:115], a[228:231], a[132:135], v[112:115]
 s_add_u32 s24, s24, 4096
 v_mfma_f32_16x16x32_bf16 v[116:119], a[228:231], a[140:143], v[116:119]
 v_mfma_f32_16x16x32_bf16 v[116:119], a[224:227], a[136:139], v[116:119]
 v_mfma_f32_16x16x32_bf16 v[120:123], a[224:227], a[144:147], v[120:123]
 ds_write_b128 v3, a[108:111] offset:27648
 v_mfma_f32_16x16x32_bf16 v[120:123], a[228:231], a[148:151], v[120:123]
 v_mfma_f32_16x16x32_bf16 v[124:127], a[228:231], a[156:159], v[124:127]
 buffer_load_dwordx4 a[228:231], v0, s[12:15], s24 offen offset:1024
 v_mfma_f32_16x16x32_bf16 v[124:127], a[224:227], a[152:155], v[124:127]
 buffer_load_dwordx4 a[224:227], v0, s[12:15], s24 offen
 s_waitcnt vmcnt(14)
 v_mfma_f32_16x16x32_bf16 a[244:247], a[232:235], a[152:155], a[244:247]
 ds_read_b128 a[152:155], v2 offset:44032
 v_mfma_f32_16x16x32_bf16 a[244:247], a[236:239], a[156:159], a[244:247]
 ds_read_b128 a[156:159], v2 offset:48128
 v_mfma_f32_16x16x32_bf16 a[240:243], a[236:239], a[148:151], a[240:243]
 ds_read_b128 a[148:151], v2 offset:47104
 v_mfma_f32_16x16x32_bf16 a[240:243], a[232:235], a[144:147], a[240:243]
 ds_read_b128 a[144:147], v2 offset:43008
 v_mfma_f32_16x16x32_bf16 v[132:135], a[232:235], a[136:139], v[132:135]
 v_mfma_f32_16x16x32_bf16 v[132:135], a[236:239], a[140:143], v[132:135]
 v_mfma_f32_16x16x32_bf16 v[128:131], a[236:239], a[132:135], v[128:131]
 buffer_load_dwordx4 a[236:239], v0, s[12:15], s24 offen offset:3072
 v_mfma_f32_16x16x32_bf16 v[128:131], a[232:235], a[128:131], v[128:131]
 buffer_load_dwordx4 a[232:235], v0, s[12:15], s24 offen offset:2048
 s_waitcnt vmcnt(14) lgkmcnt(8)
 v_mfma_f32_16x16x32_bf16 v[16:19], a[176:179], a[160:163], v[16:19]
 v_mfma_f32_16x16x32_bf16 v[16:19], a[180:183], a[164:167], v[16:19]
 s_add_u32 s24, s24, 53248
 s_waitcnt lgkmcnt(6)
 v_mfma_f32_16x16x32_bf16 v[20:23], a[180:183], a[172:175], v[20:23]
 v_mfma_f32_16x16x32_bf16 v[20:23], a[176:179], a[168:171], v[20:23]
 s_waitcnt lgkmcnt(0)
 v_mfma_f32_16x16x32_bf16 v[24:27], a[176:179], a[144:147], v[24:27]
 v_mfma_f32_16x16x32_bf16 v[24:27], a[180:183], a[148:151], v[24:27]
 v_mfma_f32_16x16x32_bf16 v[28:31], a[180:183], a[156:159], v[28:31]
 buffer_load_dwordx4 a[180:183], v0, s[12:15], s24 offen offset:1024
 v_mfma_f32_16x16x32_bf16 v[28:31], a[176:179], a[152:155], v[28:31]
 buffer_load_dwordx4 a[176:179], v0, s[12:15], s24 offen
 s_waitcnt vmcnt(14)
 v_mfma_f32_16x16x32_bf16 v[44:47], a[184:187], a[152:155], v[44:47]
 v_mfma_f32_16x16x32_bf16 v[44:47], a[188:191], a[156:159], v[44:47]
 v_mfma_f32_16x16x32_bf16 v[40:43], a[188:191], a[148:151], v[40:43]
 v_mfma_f32_16x16x32_bf16 v[40:43], a[184:187], a[144:147], v[40:43]
 v_mfma_f32_16x16x32_bf16 v[36:39], a[184:187], a[168:171], v[36:39]
 v_mfma_f32_16x16x32_bf16 v[36:39], a[188:191], a[172:175], v[36:39]
 v_mfma_f32_16x16x32_bf16 v[32:35], a[188:191], a[164:167], v[32:35]
 buffer_load_dwordx4 a[188:191], v0, s[12:15], s24 offen offset:3072
 v_mfma_f32_16x16x32_bf16 v[32:35], a[184:187], a[160:163], v[32:35]
 buffer_load_dwordx4 a[184:187], v0, s[12:15], s24 offen offset:2048
 s_waitcnt vmcnt(14)
 v_mfma_f32_16x16x32_bf16 v[48:51], a[192:195], a[160:163], v[48:51]
 v_mfma_f32_16x16x32_bf16 v[48:51], a[196:199], a[164:167], v[48:51]
 s_add_u32 s24, s24, 4096
 v_mfma_f32_16x16x32_bf16 v[52:55], a[196:199], a[172:175], v[52:55]
 v_mfma_f32_16x16x32_bf16 v[52:55], a[192:195], a[168:171], v[52:55]
 v_mfma_f32_16x16x32_bf16 v[56:59], a[192:195], a[144:147], v[56:59]
 ds_write_b128 v3, a[124:127] offset:31744
 v_mfma_f32_16x16x32_bf16 v[56:59], a[196:199], a[148:151], v[56:59]
 v_mfma_f32_16x16x32_bf16 v[60:63], a[196:199], a[156:159], v[60:63]
 buffer_load_dwordx4 a[196:199], v0, s[12:15], s24 offen offset:1024
 v_mfma_f32_16x16x32_bf16 v[60:63], a[192:195], a[152:155], v[60:63]
 buffer_load_dwordx4 a[192:195], v0, s[12:15], s24 offen
 s_waitcnt vmcnt(14)
 v_mfma_f32_16x16x32_bf16 v[76:79], a[200:203], a[152:155], v[76:79]
 v_mfma_f32_16x16x32_bf16 v[76:79], a[204:207], a[156:159], v[76:79]
 v_mfma_f32_16x16x32_bf16 v[72:75], a[204:207], a[148:151], v[72:75]
 v_mfma_f32_16x16x32_bf16 v[72:75], a[200:203], a[144:147], v[72:75]
 v_mfma_f32_16x16x32_bf16 v[68:71], a[200:203], a[168:171], v[68:71]
 v_mfma_f32_16x16x32_bf16 v[68:71], a[204:207], a[172:175], v[68:71]
 v_mfma_f32_16x16x32_bf16 v[64:67], a[204:207], a[164:167], v[64:67]
 buffer_load_dwordx4 a[204:207], v0, s[12:15], s24 offen offset:3072
 v_mfma_f32_16x16x32_bf16 v[64:67], a[200:203], a[160:163], v[64:67]
 buffer_load_dwordx4 a[200:203], v0, s[12:15], s24 offen offset:2048
 s_waitcnt vmcnt(14)
 v_mfma_f32_16x16x32_bf16 v[80:83], a[208:211], a[160:163], v[80:83]
 v_mfma_f32_16x16x32_bf16 v[80:83], a[212:215], a[164:167], v[80:83]
 s_add_u32 s24, s24, 4096
 s_waitcnt lgkmcnt(0)
 s_barrier
 v_mfma_f32_16x16x32_bf16 v[84:87], a[212:215], a[172:175], v[84:87]
 ds_read_b128 a[128:131], v1 offset:16384
 v_mfma_f32_16x16x32_bf16 v[84:87], a[208:211], a[168:171], v[84:87]
 v_mfma_f32_16x16x32_bf16 v[88:91], a[208:211], a[144:147], v[88:91]
 ds_read_b128 a[132:135], v1 offset:20480
 v_mfma_f32_16x16x32_bf16 v[88:91], a[212:215], a[148:151], v[88:91]
 v_mfma_f32_16x16x32_bf16 v[92:95], a[212:215], a[156:159], v[92:95]
 buffer_load_dwordx4 a[212:215], v0, s[12:15], s24 offen offset:1024
 v_mfma_f32_16x16x32_bf16 v[92:95], a[208:211], a[152:155], v[92:95]
 buffer_load_dwordx4 a[208:211], v0, s[12:15], s24 offen
 s_waitcnt vmcnt(14)
 v_mfma_f32_16x16x32_bf16 v[108:111], a[216:219], a[152:155], v[108:111]
 ds_read_b128 a[136:139], v1 offset:17408
 ds_read_b128 a[140:143], v1 offset:21504
 v_mfma_f32_16x16x32_bf16 v[108:111], a[220:223], a[156:159], v[108:111]
 v_mfma_f32_16x16x32_bf16 v[104:107], a[220:223], a[148:151], v[104:107]
 v_mfma_f32_16x16x32_bf16 v[104:107], a[216:219], a[144:147], v[104:107]
 v_mfma_f32_16x16x32_bf16 v[100:103], a[216:219], a[168:171], v[100:103]
 v_mfma_f32_16x16x32_bf16 v[100:103], a[220:223], a[172:175], v[100:103]
 v_mfma_f32_16x16x32_bf16 v[96:99], a[220:223], a[164:167], v[96:99]
 buffer_load_dwordx4 a[220:223], v0, s[12:15], s24 offen offset:3072
 v_mfma_f32_16x16x32_bf16 v[96:99], a[216:219], a[160:163], v[96:99]
 buffer_load_dwordx4 a[216:219], v0, s[12:15], s24 offen offset:2048
 s_waitcnt vmcnt(14)
 v_mfma_f32_16x16x32_bf16 v[112:115], a[224:227], a[160:163], v[112:115]
 v_mfma_f32_16x16x32_bf16 v[112:115], a[228:231], a[164:167], v[112:115]
 s_add_u32 s24, s24, 4096
 v_mfma_f32_16x16x32_bf16 v[116:119], a[228:231], a[172:175], v[116:119]
 v_mfma_f32_16x16x32_bf16 v[116:119], a[224:227], a[168:171], v[116:119]
 v_mfma_f32_16x16x32_bf16 v[120:123], a[224:227], a[144:147], v[120:123]
 v_mfma_f32_16x16x32_bf16 v[120:123], a[228:231], a[148:151], v[120:123]
 v_mfma_f32_16x16x32_bf16 v[124:127], a[228:231], a[156:159], v[124:127]
 buffer_load_dwordx4 a[228:231], v0, s[12:15], s24 offen offset:1024
 v_mfma_f32_16x16x32_bf16 v[124:127], a[224:227], a[152:155], v[124:127]
 buffer_load_dwordx4 a[224:227], v0, s[12:15], s24 offen
 s_waitcnt vmcnt(14)
 v_mfma_f32_16x16x32_bf16 a[244:247], a[232:235], a[152:155], a[244:247]
 ds_read_b128 a[152:155], v1 offset:19456
 v_mfma_f32_16x16x32_bf16 a[244:247], a[236:239], a[156:159], a[244:247]
 ds_read_b128 a[156:159], v1 offset:23552
 v_mfma_f32_16x16x32_bf16 a[240:243], a[236:239], a[148:151], a[240:243]
 ds_read_b128 a[148:151], v1 offset:22528
 v_mfma_f32_16x16x32_bf16 a[240:243], a[232:235], a[144:147], a[240:243]
 ds_read_b128 a[144:147], v1 offset:18432
 v_mfma_f32_16x16x32_bf16 v[132:135], a[232:235], a[168:171], v[132:135]
 v_mfma_f32_16x16x32_bf16 v[132:135], a[236:239], a[172:175], v[132:135]
 v_mfma_f32_16x16x32_bf16 v[128:131], a[236:239], a[164:167], v[128:131]
 buffer_load_dwordx4 a[236:239], v0, s[12:15], s24 offen offset:3072
 v_mfma_f32_16x16x32_bf16 v[128:131], a[232:235], a[160:163], v[128:131]
 buffer_load_dwordx4 a[232:235], v0, s[12:15], s24 offen offset:2048
 s_add_u32 s24, s24, 53248
 s_waitcnt vmcnt(14) lgkmcnt(6)
Lloop:
 v_mfma_f32_16x16x32_bf16 v[16:19], a[176:179], a[128:131], v[16:19]
 v_lshrrev_b32 v5, 6, v1
 v_mfma_f32_16x16x32_bf16 v[16:19], a[180:183], a[132:135], v[16:19]
 s_waitcnt lgkmcnt(4)
 v_mfma_f32_16x16x32_bf16 v[20:23], a[180:183], a[140:143], v[20:23]
 v_and_b32 v6, 48, v1
 v_mfma_f32_16x16x32_bf16 v[20:23], a[176:179], a[136:139], v[20:23]
 s_waitcnt lgkmcnt(0)
 v_mfma_f32_16x16x32_bf16 v[24:27], a[176:179], a[144:147], v[24:27]
 v_mfma_f32_16x16x32_bf16 v[24:27], a[180:183], a[148:151], v[24:27]
 v_mfma_f32_16x16x32_bf16 v[28:31], a[180:183], a[156:159], v[28:31]
 buffer_load_dwordx4 a[180:183], v0, s[12:15], s24 offen offset:1024
 v_mfma_f32_16x16x32_bf16 v[28:31], a[176:179], a[152:155], v[28:31]
 buffer_load_dwordx4 a[176:179], v0, s[12:15], s24 offen
 s_waitcnt vmcnt(14)
 v_mfma_f32_16x16x32_bf16 v[44:47], a[184:187], a[152:155], v[44:47]
 v_lshl_add_u32 v5, v5, 11, v6
 v_mfma_f32_16x16x32_bf16 v[44:47], a[188:191], a[156:159], v[44:47]
 s_mov_b32 m0, s52
 v_mfma_f32_16x16x32_bf16 v[40:43], a[188:191], a[148:151], v[40:43]
 ds_read_b128 a[160:163], v1 offset:24576
 v_mfma_f32_16x16x32_bf16 v[40:43], a[184:187], a[144:147], v[40:43]
 v_mfma_f32_16x16x32_bf16 v[36:39], a[184:187], a[136:139], v[36:39]
 ds_read_b128 a[164:167], v1 offset:28672
 v_mfma_f32_16x16x32_bf16 v[36:39], a[188:191], a[140:143], v[36:39]
 s_add_u32 s3, s48, 31744
 v_mfma_f32_16x16x32_bf16 v[32:35], a[188:191], a[132:135], v[32:35]
 buffer_load_dwordx4 a[188:191], v0, s[12:15], s24 offen offset:3072
 v_mfma_f32_16x16x32_bf16 v[32:35], a[184:187], a[128:131], v[32:35]
 buffer_load_dwordx4 a[184:187], v0, s[12:15], s24 offen offset:2048
 s_waitcnt vmcnt(14)
 v_mfma_f32_16x16x32_bf16 v[48:51], a[192:195], a[128:131], v[48:51]
 ds_read_b128 a[168:171], v1 offset:25600
 ds_read_b128 a[172:175], v1 offset:29696
 v_mfma_f32_16x16x32_bf16 v[48:51], a[196:199], a[132:135], v[48:51]
 s_add_u32 s24, s24, 4096
 v_mfma_f32_16x16x32_bf16 v[52:55], a[196:199], a[140:143], v[52:55]
 buffer_load_dwordx4 v5, s[40:43], s48 offen lds
 v_mfma_f32_16x16x32_bf16 v[52:55], a[192:195], a[136:139], v[52:55]
 v_mfma_f32_16x16x32_bf16 v[56:59], a[192:195], a[144:147], v[56:59]
 buffer_load_dwordx4 v5, s[40:43], s3 offen offset:1024 lds
 v_mfma_f32_16x16x32_bf16 v[56:59], a[196:199], a[148:151], v[56:59]
 s_add_u32 s48, s48, 2097152
 v_mfma_f32_16x16x32_bf16 v[60:63], a[196:199], a[156:159], v[60:63]
 buffer_load_dwordx4 a[196:199], v0, s[12:15], s24 offen offset:1024
 v_mfma_f32_16x16x32_bf16 v[60:63], a[192:195], a[152:155], v[60:63]
 buffer_load_dwordx4 a[192:195], v0, s[12:15], s24 offen
 s_waitcnt vmcnt(16)
 v_mfma_f32_16x16x32_bf16 v[76:79], a[200:203], a[152:155], v[76:79]
 v_mfma_f32_16x16x32_bf16 v[76:79], a[204:207], a[156:159], v[76:79]
 v_lshrrev_b32 v4, 8, v1
 v_mfma_f32_16x16x32_bf16 v[72:75], a[204:207], a[148:151], v[72:75]
 v_lshl_add_u32 v4, v4, 5, s51
 v_mfma_f32_16x16x32_bf16 v[72:75], a[200:203], a[144:147], v[72:75]
 v_mfma_f32_16x16x32_bf16 v[68:71], a[200:203], a[136:139], v[68:71]
 ds_read_b128 v[8:11], v4 offset:2048
 v_mfma_f32_16x16x32_bf16 v[68:71], a[204:207], a[140:143], v[68:71]
 s_waitcnt lgkmcnt(0)
 v_mfma_f32_16x16x32_bf16 v[64:67], a[204:207], a[132:135], v[64:67]
 buffer_load_dwordx4 a[204:207], v0, s[12:15], s24 offen offset:3072
 v_mfma_f32_16x16x32_bf16 v[64:67], a[200:203], a[128:131], v[64:67]
 buffer_load_dwordx4 a[200:203], v0, s[12:15], s24 offen offset:2048
 s_waitcnt vmcnt(16)
 v_mfma_f32_16x16x32_bf16 v[80:83], a[208:211], a[128:131], v[80:83]
 v_mfma_f32_16x16x32_bf16 v[80:83], a[212:215], a[132:135], v[80:83]
 s_add_u32 s24, s24, 4096
 v_mfma_f32_16x16x32_bf16 v[84:87], a[212:215], a[140:143], v[84:87]
 v_add_f32 v136, v136, v8
 v_mfma_f32_16x16x32_bf16 v[84:87], a[208:211], a[136:139], v[84:87]
 v_mfma_f32_16x16x32_bf16 v[88:91], a[208:211], a[144:147], v[88:91]
 ds_read_b128 v[12:15], v4 offset:2064
 v_mfma_f32_16x16x32_bf16 v[88:91], a[212:215], a[148:151], v[88:91]
 v_add_f32 v137, v137, v9
 v_mfma_f32_16x16x32_bf16 v[92:95], a[212:215], a[156:159], v[92:95]
 buffer_load_dwordx4 a[212:215], v0, s[12:15], s24 offen offset:1024
 v_mfma_f32_16x16x32_bf16 v[92:95], a[208:211], a[152:155], v[92:95]
 buffer_load_dwordx4 a[208:211], v0, s[12:15], s24 offen
 s_waitcnt vmcnt(16)
 v_mfma_f32_16x16x32_bf16 v[108:111], a[216:219], a[152:155], v[108:111]
 v_mfma_f32_16x16x32_bf16 v[108:111], a[220:223], a[156:159], v[108:111]
 v_add_f32 v138, v138, v10
 v_mfma_f32_16x16x32_bf16 v[104:107], a[220:223], a[148:151], v[104:107]
 v_add_f32 v139, v139, v11
 v_mfma_f32_16x16x32_bf16 v[104:107], a[216:219], a[144:147], v[104:107]
 v_mfma_f32_16x16x32_bf16 v[100:103], a[216:219], a[136:139], v[100:103]
 v_add_f32 v140, v140, v8
 v_mfma_f32_16x16x32_bf16 v[100:103], a[220:223], a[140:143], v[100:103]
 v_add_f32 v141, v141, v9
 v_mfma_f32_16x16x32_bf16 v[96:99], a[220:223], a[132:135], v[96:99]
 buffer_load_dwordx4 a[220:223], v0, s[12:15], s24 offen offset:3072
 v_mfma_f32_16x16x32_bf16 v[96:99], a[216:219], a[128:131], v[96:99]
 buffer_load_dwordx4 a[216:219], v0, s[12:15], s24 offen offset:2048
 s_waitcnt vmcnt(16)
 v_mfma_f32_16x16x32_bf16 v[112:115], a[224:227], a[128:131], v[112:115]
 v_mfma_f32_16x16x32_bf16 v[112:115], a[228:231], a[132:135], v[112:115]
 s_add_u32 s24, s24, 4096
 v_mfma_f32_16x16x32_bf16 v[116:119], a[228:231], a[140:143], v[116:119]
 v_add_f32 v142, v142, v10
 v_mfma_f32_16x16x32_bf16 v[116:119], a[224:227], a[136:139], v[116:119]
 v_add_f32 v143, v143, v11
 v_mfma_f32_16x16x32_bf16 v[120:123], a[224:227], a[144:147], v[120:123]
 v_mfma_f32_16x16x32_bf16 v[120:123], a[228:231], a[148:151], v[120:123]
 v_add_f32 v144, v144, v8
 v_mfma_f32_16x16x32_bf16 v[124:127], a[228:231], a[156:159], v[124:127]
 buffer_load_dwordx4 a[228:231], v0, s[12:15], s24 offen offset:1024
 v_mfma_f32_16x16x32_bf16 v[124:127], a[224:227], a[152:155], v[124:127]
 buffer_load_dwordx4 a[224:227], v0, s[12:15], s24 offen
 s_waitcnt vmcnt(16)
 v_mfma_f32_16x16x32_bf16 a[244:247], a[232:235], a[152:155], a[244:247]
 ds_read_b128 a[152:155], v1 offset:27648
 v_mfma_f32_16x16x32_bf16 a[244:247], a[236:239], a[156:159], a[244:247]
 ds_read_b128 a[156:159], v1 offset:31744
 v_mfma_f32_16x16x32_bf16 a[240:243], a[236:239], a[148:151], a[240:243]
 ds_read_b128 a[148:151], v1 offset:30720
 v_mfma_f32_16x16x32_bf16 a[240:243], a[232:235], a[144:147], a[240:243]
 ds_read_b128 a[144:147], v1 offset:26624
 v_mfma_f32_16x16x32_bf16 v[132:135], a[232:235], a[136:139], v[132:135]
 v_add_f32 v145, v145, v9
 v_mfma_f32_16x16x32_bf16 v[132:135], a[236:239], a[140:143], v[132:135]
 v_mfma_f32_16x16x32_bf16 v[128:131], a[236:239], a[132:135], v[128:131]
 buffer_load_dwordx4 a[236:239], v0, s[12:15], s24 offen offset:3072
 v_mfma_f32_16x16x32_bf16 v[128:131], a[232:235], a[128:131], v[128:131]
 buffer_load_dwordx4 a[232:235], v0, s[12:15], s24 offen offset:2048
 s_waitcnt vmcnt(16)
 v_mfma_f32_16x16x32_bf16 v[16:19], a[176:179], a[160:163], v[16:19]
 v_add_f32 v146, v146, v10
 v_mfma_f32_16x16x32_bf16 v[16:19], a[180:183], a[164:167], v[16:19]
 s_add_u32 s24, s24, 53248
 v_mfma_f32_16x16x32_bf16 v[20:23], a[180:183], a[172:175], v[20:23]
 v_add_f32 v147, v147, v11
 v_mfma_f32_16x16x32_bf16 v[20:23], a[176:179], a[168:171], v[20:23]
 s_waitcnt lgkmcnt(0)
 v_mfma_f32_16x16x32_bf16 v[24:27], a[176:179], a[144:147], v[24:27]
 v_mfma_f32_16x16x32_bf16 v[24:27], a[180:183], a[148:151], v[24:27]
 v_mfma_f32_16x16x32_bf16 v[28:31], a[180:183], a[156:159], v[28:31]
 buffer_load_dwordx4 a[180:183], v0, s[12:15], s24 offen offset:1024
 v_mfma_f32_16x16x32_bf16 v[28:31], a[176:179], a[152:155], v[28:31]
 buffer_load_dwordx4 a[176:179], v0, s[12:15], s24 offen
 s_waitcnt vmcnt(16)
 v_mfma_f32_16x16x32_bf16 v[44:47], a[184:187], a[152:155], v[44:47]
 v_add_f32 v148, v148, v8
 v_mfma_f32_16x16x32_bf16 v[44:47], a[188:191], a[156:159], v[44:47]
 v_mfma_f32_16x16x32_bf16 v[40:43], a[188:191], a[148:151], v[40:43]
 ds_read_b128 a[128:131], v1 offset:49152
 v_mfma_f32_16x16x32_bf16 v[40:43], a[184:187], a[144:147], v[40:43]
 v_add_f32 v149, v149, v9
 v_mfma_f32_16x16x32_bf16 v[36:39], a[184:187], a[168:171], v[36:39]
 ds_read_b128 a[132:135], v1 offset:53248
 v_mfma_f32_16x16x32_bf16 v[36:39], a[188:191], a[172:175], v[36:39]
 v_add_f32 v150, v150, v10
 v_mfma_f32_16x16x32_bf16 v[32:35], a[188:191], a[164:167], v[32:35]
 buffer_load_dwordx4 a[188:191], v0, s[12:15], s24 offen offset:3072
 v_mfma_f32_16x16x32_bf16 v[32:35], a[184:187], a[160:163], v[32:35]
 buffer_load_dwordx4 a[184:187], v0, s[12:15], s24 offen offset:2048
 s_waitcnt vmcnt(14)
 v_mfma_f32_16x16x32_bf16 v[48:51], a[192:195], a[160:163], v[48:51]
 ds_read_b128 a[136:139], v1 offset:50176
 ds_read_b128 a[140:143], v1 offset:54272
 v_mfma_f32_16x16x32_bf16 v[48:51], a[196:199], a[164:167], v[48:51]
 s_add_u32 s24, s24, 4096
 v_mfma_f32_16x16x32_bf16 v[52:55], a[196:199], a[172:175], v[52:55]
 v_mfma_f32_16x16x32_bf16 v[52:55], a[192:195], a[168:171], v[52:55]
 v_add_f32 v151, v151, v11
 v_mfma_f32_16x16x32_bf16 v[56:59], a[192:195], a[144:147], v[56:59]
 v_mfma_f32_16x16x32_bf16 v[56:59], a[196:199], a[148:151], v[56:59]
 v_mfma_f32_16x16x32_bf16 v[60:63], a[196:199], a[156:159], v[60:63]
 buffer_load_dwordx4 a[196:199], v0, s[12:15], s24 offen offset:1024
 v_mfma_f32_16x16x32_bf16 v[60:63], a[192:195], a[152:155], v[60:63]
 buffer_load_dwordx4 a[192:195], v0, s[12:15], s24 offen
 s_waitcnt vmcnt(14)
 v_mfma_f32_16x16x32_bf16 v[76:79], a[200:203], a[152:155], v[76:79]
 v_add_f32 v152, v152, v12
 v_mfma_f32_16x16x32_bf16 v[76:79], a[204:207], a[156:159], v[76:79]
 ds_read_b128 v[8:11], v4 offset:2176
 v_mfma_f32_16x16x32_bf16 v[72:75], a[204:207], a[148:151], v[72:75]
 v_mfma_f32_16x16x32_bf16 v[72:75], a[200:203], a[144:147], v[72:75]
 v_add_f32 v153, v153, v13
 v_mfma_f32_16x16x32_bf16 v[68:71], a[200:203], a[168:171], v[68:71]
 v_add_f32 v154, v154, v14
 v_mfma_f32_16x16x32_bf16 v[68:71], a[204:207], a[172:175], v[68:71]
 v_mfma_f32_16x16x32_bf16 v[64:67], a[204:207], a[164:167], v[64:67]
 buffer_load_dwordx4 a[204:207], v0, s[12:15], s24 offen offset:3072
 v_mfma_f32_16x16x32_bf16 v[64:67], a[200:203], a[160:163], v[64:67]
 buffer_load_dwordx4 a[200:203], v0, s[12:15], s24 offen offset:2048
 s_waitcnt vmcnt(14)
 v_mfma_f32_16x16x32_bf16 v[80:83], a[208:211], a[160:163], v[80:83]
 v_add_f32 v155, v155, v15
 v_mfma_f32_16x16x32_bf16 v[80:83], a[212:215], a[164:167], v[80:83]
 s_add_u32 s24, s24, 4096
 v_mfma_f32_16x16x32_bf16 v[84:87], a[212:215], a[172:175], v[84:87]
 v_add_f32 v156, v156, v12
 v_mfma_f32_16x16x32_bf16 v[84:87], a[208:211], a[168:171], v[84:87]
 v_mfma_f32_16x16x32_bf16 v[88:91], a[208:211], a[144:147], v[88:91]
 v_add_f32 v157, v157, v13
 v_mfma_f32_16x16x32_bf16 v[88:91], a[212:215], a[148:151], v[88:91]
 v_add_f32 v158, v158, v14
 v_mfma_f32_16x16x32_bf16 v[92:95], a[212:215], a[156:159], v[92:95]
 buffer_load_dwordx4 a[212:215], v0, s[12:15], s24 offen offset:1024
 v_mfma_f32_16x16x32_bf16 v[92:95], a[208:211], a[152:155], v[92:95]
 buffer_load_dwordx4 a[208:211], v0, s[12:15], s24 offen
 s_waitcnt vmcnt(14)
 v_mfma_f32_16x16x32_bf16 v[108:111], a[216:219], a[152:155], v[108:111]
 v_mfma_f32_16x16x32_bf16 v[108:111], a[220:223], a[156:159], v[108:111]
 v_add_f32 v159, v159, v15
 v_mfma_f32_16x16x32_bf16 v[104:107], a[220:223], a[148:151], v[104:107]
 v_mfma_f32_16x16x32_bf16 v[104:107], a[216:219], a[144:147], v[104:107]
 v_add_f32 v160, v160, v12
 v_mfma_f32_16x16x32_bf16 v[100:103], a[216:219], a[168:171], v[100:103]
 v_add_f32 v161, v161, v13
 v_mfma_f32_16x16x32_bf16 v[100:103], a[220:223], a[172:175], v[100:103]
 v_mfma_f32_16x16x32_bf16 v[96:99], a[220:223], a[164:167], v[96:99]
 buffer_load_dwordx4 a[220:223], v0, s[12:15], s24 offen offset:3072
 v_mfma_f32_16x16x32_bf16 v[96:99], a[216:219], a[160:163], v[96:99]
 buffer_load_dwordx4 a[216:219], v0, s[12:15], s24 offen offset:2048
 s_waitcnt vmcnt(14)
 v_mfma_f32_16x16x32_bf16 v[112:115], a[224:227], a[160:163], v[112:115]
 v_add_f32 v162, v162, v14
 v_mfma_f32_16x16x32_bf16 v[112:115], a[228:231], a[164:167], v[112:115]
 s_add_u32 s24, s24, 4096
 v_mfma_f32_16x16x32_bf16 v[116:119], a[228:231], a[172:175], v[116:119]
 v_add_f32 v163, v163, v15
 v_mfma_f32_16x16x32_bf16 v[116:119], a[224:227], a[168:171], v[116:119]
 v_mfma_f32_16x16x32_bf16 v[120:123], a[224:227], a[144:147], v[120:123]
 v_add_f32 v164, v164, v12
 v_mfma_f32_16x16x32_bf16 v[120:123], a[228:231], a[148:151], v[120:123]
 v_add_f32 v165, v165, v13
 v_mfma_f32_16x16x32_bf16 v[124:127], a[228:231], a[156:159], v[124:127]
 buffer_load_dwordx4 a[228:231], v0, s[12:15], s24 offen offset:1024
 v_mfma_f32_16x16x32_bf16 v[124:127], a[224:227], a[152:155], v[124:127]
 buffer_load_dwordx4 a[224:227], v0, s[12:15], s24 offen
 s_waitcnt vmcnt(14)
 v_mfma_f32_16x16x32_bf16 a[244:247], a[232:235], a[152:155], a[244:247]
 ds_read_b128 a[152:155], v1 offset:52224
 v_mfma_f32_16x16x32_bf16 a[244:247], a[236:239], a[156:159], a[244:247]
 ds_read_b128 a[156:159], v1 offset:56320
 v_mfma_f32_16x16x32_bf16 a[240:243], a[236:239], a[148:151], a[240:243]
 ds_read_b128 a[148:151], v1 offset:55296
 v_mfma_f32_16x16x32_bf16 a[240:243], a[232:235], a[144:147], a[240:243]
 ds_read_b128 a[144:147], v1 offset:51200
 v_mfma_f32_16x16x32_bf16 v[132:135], a[232:235], a[168:171], v[132:135]
 v_mfma_f32_16x16x32_bf16 v[132:135], a[236:239], a[172:175], v[132:135]
 v_add_f32 v166, v166, v14
 v_mfma_f32_16x16x32_bf16 v[128:131], a[236:239], a[164:167], v[128:131]
 buffer_load_dwordx4 a[236:239], v0, s[12:15], s24 offen offset:3072
 v_mfma_f32_16x16x32_bf16 v[128:131], a[232:235], a[160:163], v[128:131]
 buffer_load_dwordx4 a[232:235], v0, s[12:15], s24 offen offset:2048
 s_waitcnt vmcnt(14) lgkmcnt(7)
 v_mfma_f32_16x16x32_bf16 v[16:19], a[176:179], a[128:131], v[16:19]
 v_add_f32 v167, v167, v15
 v_mfma_f32_16x16x32_bf16 v[16:19], a[180:183], a[132:135], v[16:19]
 s_add_u32 s24, s24, 53248
 s_waitcnt lgkmcnt(5)
 v_mfma_f32_16x16x32_bf16 v[20:23], a[180:183], a[140:143], v[20:23]
 v_mfma_f32_16x16x32_bf16 v[20:23], a[176:179], a[136:139], v[20:23]
 s_waitcnt lgkmcnt(0)
 v_mfma_f32_16x16x32_bf16 v[24:27], a[176:179], a[144:147], v[24:27]
 v_mfma_f32_16x16x32_bf16 v[24:27], a[180:183], a[148:151], v[24:27]
 v_mfma_f32_16x16x32_bf16 v[28:31], a[180:183], a[156:159], v[28:31]
 buffer_load_dwordx4 a[180:183], v0, s[12:15], s24 offen offset:1024
 v_mfma_f32_16x16x32_bf16 v[28:31], a[176:179], a[152:155], v[28:31]
 buffer_load_dwordx4 a[176:179], v0, s[12:15], s24 offen
 s_waitcnt vmcnt(14)
 v_mfma_f32_16x16x32_bf16 v[44:47], a[184:187], a[152:155], v[44:47]
 v_add_f32 v168, v168, v8
 v_mfma_f32_16x16x32_bf16 v[44:47], a[188:191], a[156:159], v[44:47]
 v_mfma_f32_16x16x32_bf16 v[40:43], a[188:191], a[148:151], v[40:43]
 ds_read_b128 a[160:163], v1 offset:57344
 v_mfma_f32_16x16x32_bf16 v[40:43], a[184:187], a[144:147], v[40:43]
 ds_read_b128 v[12:15], v4 offset:2192
 v_mfma_f32_16x16x32_bf16 v[36:39], a[184:187], a[136:139], v[36:39]
 ds_read_b128 a[164:167], v1 offset:61440
 v_mfma_f32_16x16x32_bf16 v[36:39], a[188:191], a[140:143], v[36:39]
 v_add_f32 v169, v169, v9
 v_mfma_f32_16x16x32_bf16 v[32:35], a[188:191], a[132:135], v[32:35]
 buffer_load_dwordx4 a[188:191], v0, s[12:15], s24 offen offset:3072
 v_mfma_f32_16x16x32_bf16 v[32:35], a[184:187], a[128:131], v[32:35]
 buffer_load_dwordx4 a[184:187], v0, s[12:15], s24 offen offset:2048
 s_waitcnt vmcnt(14)
 v_mfma_f32_16x16x32_bf16 v[48:51], a[192:195], a[128:131], v[48:51]
 ds_read_b128 a[168:171], v1 offset:58368
 ds_read_b128 a[172:175], v1 offset:62464
 v_mfma_f32_16x16x32_bf16 v[48:51], a[196:199], a[132:135], v[48:51]
 s_add_u32 s24, s24, 4096
 v_mfma_f32_16x16x32_bf16 v[52:55], a[196:199], a[140:143], v[52:55]
 v_mfma_f32_16x16x32_bf16 v[52:55], a[192:195], a[136:139], v[52:55]
 v_add_f32 v170, v170, v10
 v_mfma_f32_16x16x32_bf16 v[56:59], a[192:195], a[144:147], v[56:59]
 v_mfma_f32_16x16x32_bf16 v[56:59], a[196:199], a[148:151], v[56:59]
 v_add_f32 v171, v171, v11
 v_mfma_f32_16x16x32_bf16 v[60:63], a[196:199], a[156:159], v[60:63]
 buffer_load_dwordx4 a[196:199], v0, s[12:15], s24 offen offset:1024
 v_mfma_f32_16x16x32_bf16 v[60:63], a[192:195], a[152:155], v[60:63]
 buffer_load_dwordx4 a[192:195], v0, s[12:15], s24 offen
 s_waitcnt vmcnt(14)
 v_mfma_f32_16x16x32_bf16 v[76:79], a[200:203], a[152:155], v[76:79]
 v_add_f32 v172, v172, v8
 v_mfma_f32_16x16x32_bf16 v[76:79], a[204:207], a[156:159], v[76:79]
 v_mfma_f32_16x16x32_bf16 v[72:75], a[204:207], a[148:151], v[72:75]
 v_add_f32 v173, v173, v9
 v_mfma_f32_16x16x32_bf16 v[72:75], a[200:203], a[144:147], v[72:75]
 v_add_f32 v174, v174, v10
 v_mfma_f32_16x16x32_bf16 v[68:71], a[200:203], a[136:139], v[68:71]
 v_mfma_f32_16x16x32_bf16 v[68:71], a[204:207], a[140:143], v[68:71]
 v_add_f32 v175, v175, v11
 v_mfma_f32_16x16x32_bf16 v[64:67], a[204:207], a[132:135], v[64:67]
 buffer_load_dwordx4 a[204:207], v0, s[12:15], s24 offen offset:3072
 v_mfma_f32_16x16x32_bf16 v[64:67], a[200:203], a[128:131], v[64:67]
 buffer_load_dwordx4 a[200:203], v0, s[12:15], s24 offen offset:2048
 s_waitcnt vmcnt(14)
 v_mfma_f32_16x16x32_bf16 v[80:83], a[208:211], a[128:131], v[80:83]
 v_add_f32 v176, v176, v8
 v_mfma_f32_16x16x32_bf16 v[80:83], a[212:215], a[132:135], v[80:83]
 s_add_u32 s24, s24, 4096
 v_mfma_f32_16x16x32_bf16 v[84:87], a[212:215], a[140:143], v[84:87]
 v_mfma_f32_16x16x32_bf16 v[84:87], a[208:211], a[136:139], v[84:87]
 v_add_f32 v177, v177, v9
 v_mfma_f32_16x16x32_bf16 v[88:91], a[208:211], a[144:147], v[88:91]
 v_add_f32 v178, v178, v10
 v_mfma_f32_16x16x32_bf16 v[88:91], a[212:215], a[148:151], v[88:91]
 v_mfma_f32_16x16x32_bf16 v[92:95], a[212:215], a[156:159], v[92:95]
 buffer_load_dwordx4 a[212:215], v0, s[12:15], s24 offen offset:1024
 v_mfma_f32_16x16x32_bf16 v[92:95], a[208:211], a[152:155], v[92:95]
 buffer_load_dwordx4 a[208:211], v0, s[12:15], s24 offen
 s_waitcnt vmcnt(14)
 v_mfma_f32_16x16x32_bf16 v[108:111], a[216:219], a[152:155], v[108:111]
 v_add_f32 v179, v179, v11
 v_mfma_f32_16x16x32_bf16 v[108:111], a[220:223], a[156:159], v[108:111]
 v_add_f32 v180, v180, v8
 v_mfma_f32_16x16x32_bf16 v[104:107], a[220:223], a[148:151], v[104:107]
 v_mfma_f32_16x16x32_bf16 v[104:107], a[216:219], a[144:147], v[104:107]
 v_add_f32 v181, v181, v9
 v_mfma_f32_16x16x32_bf16 v[100:103], a[216:219], a[136:139], v[100:103]
 v_add_f32 v182, v182, v10
 v_mfma_f32_16x16x32_bf16 v[100:103], a[220:223], a[140:143], v[100:103]
 v_mfma_f32_16x16x32_bf16 v[96:99], a[220:223], a[132:135], v[96:99]
 buffer_load_dwordx4 a[220:223], v0, s[12:15], s24 offen offset:3072
 v_mfma_f32_16x16x32_bf16 v[96:99], a[216:219], a[128:131], v[96:99]
 buffer_load_dwordx4 a[216:219], v0, s[12:15], s24 offen offset:2048
 s_waitcnt vmcnt(14)
 v_mfma_f32_16x16x32_bf16 v[112:115], a[224:227], a[128:131], v[112:115]
 v_add_f32 v183, v183, v11
 v_mfma_f32_16x16x32_bf16 v[112:115], a[228:231], a[132:135], v[112:115]
 s_add_u32 s24, s24, 4096
 v_mfma_f32_16x16x32_bf16 v[116:119], a[228:231], a[140:143], v[116:119]
 v_mfma_f32_16x16x32_bf16 v[116:119], a[224:227], a[136:139], v[116:119]
 s_waitcnt lgkmcnt(3)
 v_mfma_f32_16x16x32_bf16 v[120:123], a[224:227], a[144:147], v[120:123]
 v_add_f32 v184, v184, v12
 v_mfma_f32_16x16x32_bf16 v[120:123], a[228:231], a[148:151], v[120:123]
 v_mfma_f32_16x16x32_bf16 v[124:127], a[228:231], a[156:159], v[124:127]
 buffer_load_dwordx4 a[228:231], v0, s[12:15], s24 offen offset:1024
 v_mfma_f32_16x16x32_bf16 v[124:127], a[224:227], a[152:155], v[124:127]
 buffer_load_dwordx4 a[224:227], v0, s[12:15], s24 offen
 s_waitcnt vmcnt(14)
 v_mfma_f32_16x16x32_bf16 a[244:247], a[232:235], a[152:155], a[244:247]
 ds_read_b128 a[152:155], v1 offset:60416
 v_mfma_f32_16x16x32_bf16 a[244:247], a[236:239], a[156:159], a[244:247]
 ds_read_b128 a[156:159], v1 offset:64512
 v_mfma_f32_16x16x32_bf16 a[240:243], a[236:239], a[148:151], a[240:243]
 ds_read_b128 a[148:151], v1 offset:63488
 v_mfma_f32_16x16x32_bf16 a[240:243], a[232:235], a[144:147], a[240:243]
 ds_read_b128 a[144:147], v1 offset:59392
 v_mfma_f32_16x16x32_bf16 v[132:135], a[232:235], a[136:139], v[132:135]
 ds_read_b128 v[8:11], v4 offset:2304
 v_mfma_f32_16x16x32_bf16 v[132:135], a[236:239], a[140:143], v[132:135]
 v_add_f32 v185, v185, v13
 v_mfma_f32_16x16x32_bf16 v[128:131], a[236:239], a[132:135], v[128:131]
 buffer_load_dwordx4 a[236:239], v0, s[12:15], s24 offen offset:3072
 v_mfma_f32_16x16x32_bf16 v[128:131], a[232:235], a[128:131], v[128:131]
 buffer_load_dwordx4 a[232:235], v0, s[12:15], s24 offen offset:2048
 s_waitcnt vmcnt(14) lgkmcnt(7)
 v_mfma_f32_16x16x32_bf16 v[16:19], a[176:179], a[160:163], v[16:19]
 v_mfma_f32_16x16x32_bf16 v[16:19], a[180:183], a[164:167], v[16:19]
 s_add_u32 s24, s24, 53248
 s_waitcnt lgkmcnt(5)
 v_mfma_f32_16x16x32_bf16 v[20:23], a[180:183], a[172:175], v[20:23]
 v_add_f32 v186, v186, v14
 v_mfma_f32_16x16x32_bf16 v[20:23], a[176:179], a[168:171], v[20:23]
 s_waitcnt lgkmcnt(1)
 v_mfma_f32_16x16x32_bf16 v[24:27], a[176:179], a[144:147], v[24:27]
 v_add_f32 v187, v187, v15
 v_mfma_f32_16x16x32_bf16 v[24:27], a[180:183], a[148:151], v[24:27]
 v_mfma_f32_16x16x32_bf16 v[28:31], a[180:183], a[156:159], v[28:31]
 buffer_load_dwordx4 a[180:183], v0, s[12:15], s24 offen offset:1024
 v_mfma_f32_16x16x32_bf16 v[28:31], a[176:179], a[152:155], v[28:31]
 buffer_load_dwordx4 a[176:179], v0, s[12:15], s24 offen
 s_waitcnt vmcnt(14)
 v_mfma_f32_16x16x32_bf16 v[44:47], a[184:187], a[152:155], v[44:47]
 v_mfma_f32_16x16x32_bf16 v[44:47], a[188:191], a[156:159], v[44:47]
 v_add_f32 v188, v188, v12
 v_mfma_f32_16x16x32_bf16 v[40:43], a[188:191], a[148:151], v[40:43]
 ds_read_b128 a[128:131], v2 offset:16384
 v_mfma_f32_16x16x32_bf16 v[40:43], a[184:187], a[144:147], v[40:43]
 v_add_f32 v189, v189, v13
 v_mfma_f32_16x16x32_bf16 v[36:39], a[184:187], a[168:171], v[36:39]
 ds_read_b128 a[132:135], v2 offset:20480
 v_mfma_f32_16x16x32_bf16 v[36:39], a[188:191], a[172:175], v[36:39]
 v_mfma_f32_16x16x32_bf16 v[32:35], a[188:191], a[164:167], v[32:35]
 buffer_load_dwordx4 a[188:191], v0, s[12:15], s24 offen offset:3072
 v_mfma_f32_16x16x32_bf16 v[32:35], a[184:187], a[160:163], v[32:35]
 buffer_load_dwordx4 a[184:187], v0, s[12:15], s24 offen offset:2048
 s_waitcnt vmcnt(14)
 v_mfma_f32_16x16x32_bf16 v[48:51], a[192:195], a[160:163], v[48:51]
 ds_read_b128 a[136:139], v2 offset:17408
 ds_read_b128 a[140:143], v2 offset:21504
 v_mfma_f32_16x16x32_bf16 v[48:51], a[196:199], a[164:167], v[48:51]
 s_add_u32 s24, s24, 4096
 v_mfma_f32_16x16x32_bf16 v[52:55], a[196:199], a[172:175], v[52:55]
 v_add_f32 v190, v190, v14
 v_mfma_f32_16x16x32_bf16 v[52:55], a[192:195], a[168:171], v[52:55]
 v_add_f32 v191, v191, v15
 v_mfma_f32_16x16x32_bf16 v[56:59], a[192:195], a[144:147], v[56:59]
 v_mfma_f32_16x16x32_bf16 v[56:59], a[196:199], a[148:151], v[56:59]
 v_add_f32 v192, v192, v12
 v_mfma_f32_16x16x32_bf16 v[60:63], a[196:199], a[156:159], v[60:63]
 buffer_load_dwordx4 a[196:199], v0, s[12:15], s24 offen offset:1024
 v_mfma_f32_16x16x32_bf16 v[60:63], a[192:195], a[152:155], v[60:63]
 buffer_load_dwordx4 a[192:195], v0, s[12:15], s24 offen
 s_waitcnt vmcnt(14)
 v_mfma_f32_16x16x32_bf16 v[76:79], a[200:203], a[152:155], v[76:79]
 v_add_f32 v193, v193, v13
 v_mfma_f32_16x16x32_bf16 v[76:79], a[204:207], a[156:159], v[76:79]
 v_mfma_f32_16x16x32_bf16 v[72:75], a[204:207], a[148:151], v[72:75]
 v_add_f32 v194, v194, v14
 v_mfma_f32_16x16x32_bf16 v[72:75], a[200:203], a[144:147], v[72:75]
 v_mfma_f32_16x16x32_bf16 v[68:71], a[200:203], a[168:171], v[68:71]
 v_add_f32 v195, v195, v15
 v_mfma_f32_16x16x32_bf16 v[68:71], a[204:207], a[172:175], v[68:71]
 v_add_f32 v196, v196, v12
 v_mfma_f32_16x16x32_bf16 v[64:67], a[204:207], a[164:167], v[64:67]
 buffer_load_dwordx4 a[204:207], v0, s[12:15], s24 offen offset:3072
 v_mfma_f32_16x16x32_bf16 v[64:67], a[200:203], a[160:163], v[64:67]
 buffer_load_dwordx4 a[200:203], v0, s[12:15], s24 offen offset:2048
 s_waitcnt vmcnt(14)
 v_mfma_f32_16x16x32_bf16 v[80:83], a[208:211], a[160:163], v[80:83]
 v_mfma_f32_16x16x32_bf16 v[80:83], a[212:215], a[164:167], v[80:83]
 s_add_u32 s24, s24, 4096
 v_mfma_f32_16x16x32_bf16 v[84:87], a[212:215], a[172:175], v[84:87]
 v_add_f32 v197, v197, v13
 v_mfma_f32_16x16x32_bf16 v[84:87], a[208:211], a[168:171], v[84:87]
 v_add_f32 v198, v198, v14
 v_mfma_f32_16x16x32_bf16 v[88:91], a[208:211], a[144:147], v[88:91]
 v_mfma_f32_16x16x32_bf16 v[88:91], a[212:215], a[148:151], v[88:91]
 v_add_f32 v199, v199, v15
 v_mfma_f32_16x16x32_bf16 v[92:95], a[212:215], a[156:159], v[92:95]
 buffer_load_dwordx4 a[212:215], v0, s[12:15], s24 offen offset:1024
 v_mfma_f32_16x16x32_bf16 v[92:95], a[208:211], a[152:155], v[92:95]
 buffer_load_dwordx4 a[208:211], v0, s[12:15], s24 offen
 s_waitcnt vmcnt(14)
 v_mfma_f32_16x16x32_bf16 v[108:111], a[216:219], a[152:155], v[108:111]
 s_waitcnt lgkmcnt(4)
 v_mfma_f32_16x16x32_bf16 v[108:111], a[220:223], a[156:159], v[108:111]
 v_mfma_f32_16x16x32_bf16 v[104:107], a[220:223], a[148:151], v[104:107]
 v_add_f32 v200, v200, v8
 v_mfma_f32_16x16x32_bf16 v[104:107], a[216:219], a[144:147], v[104:107]
 ds_read_b128 v[12:15], v4 offset:2320
 v_mfma_f32_16x16x32_bf16 v[100:103], a[216:219], a[168:171], v[100:103]
 v_mfma_f32_16x16x32_bf16 v[100:103], a[220:223], a[172:175], v[100:103]
 v_add_f32 v201, v201, v9
 v_mfma_f32_16x16x32_bf16 v[96:99], a[220:223], a[164:167], v[96:99]
 buffer_load_dwordx4 a[220:223], v0, s[12:15], s24 offen offset:3072
 v_mfma_f32_16x16x32_bf16 v[96:99], a[216:219], a[160:163], v[96:99]
 buffer_load_dwordx4 a[216:219], v0, s[12:15], s24 offen offset:2048
 s_waitcnt vmcnt(14)
 v_mfma_f32_16x16x32_bf16 v[112:115], a[224:227], a[160:163], v[112:115]
 v_add_f32 v202, v202, v10
 v_mfma_f32_16x16x32_bf16 v[112:115], a[228:231], a[164:167], v[112:115]
 s_add_u32 s24, s24, 4096
 v_mfma_f32_16x16x32_bf16 v[116:119], a[228:231], a[172:175], v[116:119]
 v_mfma_f32_16x16x32_bf16 v[116:119], a[224:227], a[168:171], v[116:119]
 v_add_f32 v203, v203, v11
 v_mfma_f32_16x16x32_bf16 v[120:123], a[224:227], a[144:147], v[120:123]
 v_add_f32 v204, v204, v8
 v_mfma_f32_16x16x32_bf16 v[120:123], a[228:231], a[148:151], v[120:123]
 v_mfma_f32_16x16x32_bf16 v[124:127], a[228:231], a[156:159], v[124:127]
 buffer_load_dwordx4 a[228:231], v0, s[12:15], s24 offen offset:1024
 v_mfma_f32_16x16x32_bf16 v[124:127], a[224:227], a[152:155], v[124:127]
 buffer_load_dwordx4 a[224:227], v0, s[12:15], s24 offen
 s_waitcnt vmcnt(14)
 v_mfma_f32_16x16x32_bf16 a[244:247], a[232:235], a[152:155], a[244:247]
 ds_read_b128 a[152:155], v2 offset:19456
 v_mfma_f32_16x16x32_bf16 a[244:247], a[236:239], a[156:159], a[244:247]
 ds_read_b128 a[156:159], v2 offset:23552
 v_mfma_f32_16x16x32_bf16 a[240:243], a[236:239], a[148:151], a[240:243]
 ds_read_b128 a[148:151], v2 offset:22528
 v_mfma_f32_16x16x32_bf16 a[240:243], a[232:235], a[144:147], a[240:243]
 ds_read_b128 a[144:147], v2 offset:18432
 v_mfma_f32_16x16x32_bf16 v[132:135], a[232:235], a[168:171], v[132:135]
 v_add_f32 v205, v205, v9
 v_mfma_f32_16x16x32_bf16 v[132:135], a[236:239], a[172:175], v[132:135]
 v_mfma_f32_16x16x32_bf16 v[128:131], a[236:239], a[164:167], v[128:131]
 buffer_load_dwordx4 a[236:239], v0, s[12:15], s24 offen offset:3072
 v_mfma_f32_16x16x32_bf16 v[128:131], a[232:235], a[160:163], v[128:131]
 buffer_load_dwordx4 a[232:235], v0, s[12:15], s24 offen offset:2048
 s_waitcnt vmcnt(14) lgkmcnt(7)
 v_mfma_f32_16x16x32_bf16 v[16:19], a[176:179], a[128:131], v[16:19]
 v_add_f32 v206, v206, v10
 v_mfma_f32_16x16x32_bf16 v[16:19], a[180:183], a[132:135], v[16:19]
 s_add_u32 s24, s24, 53248
 s_waitcnt lgkmcnt(5)
 v_mfma_f32_16x16x32_bf16 v[20:23], a[180:183], a[140:143], v[20:23]
 v_add_f32 v207, v207, v11
 v_mfma_f32_16x16x32_bf16 v[20:23], a[176:179], a[136:139], v[20:23]
 s_waitcnt lgkmcnt(0)
 v_mfma_f32_16x16x32_bf16 v[24:27], a[176:179], a[144:147], v[24:27]
 v_mfma_f32_16x16x32_bf16 v[24:27], a[180:183], a[148:151], v[24:27]
 v_mfma_f32_16x16x32_bf16 v[28:31], a[180:183], a[156:159], v[28:31]
 buffer_load_dwordx4 a[180:183], v0, s[12:15], s24 offen offset:1024
 v_mfma_f32_16x16x32_bf16 v[28:31], a[176:179], a[152:155], v[28:31]
 buffer_load_dwordx4 a[176:179], v0, s[12:15], s24 offen
 s_waitcnt vmcnt(14)
 v_mfma_f32_16x16x32_bf16 v[44:47], a[184:187], a[152:155], v[44:47]
 v_add_f32 v208, v208, v8
 v_mfma_f32_16x16x32_bf16 v[44:47], a[188:191], a[156:159], v[44:47]
 v_add_f32 v209, v209, v9
 v_mfma_f32_16x16x32_bf16 v[40:43], a[188:191], a[148:151], v[40:43]
 ds_read_b128 a[160:163], v2 offset:24576
 v_mfma_f32_16x16x32_bf16 v[40:43], a[184:187], a[144:147], v[40:43]
 v_mfma_f32_16x16x32_bf16 v[36:39], a[184:187], a[136:139], v[36:39]
 ds_read_b128 a[164:167], v2 offset:28672
 v_mfma_f32_16x16x32_bf16 v[36:39], a[188:191], a[140:143], v[36:39]
 v_add_f32 v210, v210, v10
 v_mfma_f32_16x16x32_bf16 v[32:35], a[188:191], a[132:135], v[32:35]
 buffer_load_dwordx4 a[188:191], v0, s[12:15], s24 offen offset:3072
 v_mfma_f32_16x16x32_bf16 v[32:35], a[184:187], a[128:131], v[32:35]
 buffer_load_dwordx4 a[184:187], v0, s[12:15], s24 offen offset:2048
 s_waitcnt vmcnt(14)
 v_mfma_f32_16x16x32_bf16 v[48:51], a[192:195], a[128:131], v[48:51]
 ds_read_b128 a[168:171], v2 offset:25600
 ds_read_b128 a[172:175], v2 offset:29696
 v_mfma_f32_16x16x32_bf16 v[48:51], a[196:199], a[132:135], v[48:51]
 s_add_u32 s24, s24, 4096
 v_mfma_f32_16x16x32_bf16 v[52:55], a[196:199], a[140:143], v[52:55]
 v_add_f32 v211, v211, v11
 v_mfma_f32_16x16x32_bf16 v[52:55], a[192:195], a[136:139], v[52:55]
 v_mfma_f32_16x16x32_bf16 v[56:59], a[192:195], a[144:147], v[56:59]
 v_add_f32 v212, v212, v8
 v_mfma_f32_16x16x32_bf16 v[56:59], a[196:199], a[148:151], v[56:59]
 v_add_f32 v213, v213, v9
 v_mfma_f32_16x16x32_bf16 v[60:63], a[196:199], a[156:159], v[60:63]
 buffer_load_dwordx4 a[196:199], v0, s[12:15], s24 offen offset:1024
 v_mfma_f32_16x16x32_bf16 v[60:63], a[192:195], a[152:155], v[60:63]
 buffer_load_dwordx4 a[192:195], v0, s[12:15], s24 offen
 s_waitcnt vmcnt(14)
 v_mfma_f32_16x16x32_bf16 v[76:79], a[200:203], a[152:155], v[76:79]
 v_mfma_f32_16x16x32_bf16 v[76:79], a[204:207], a[156:159], v[76:79]
 v_add_f32 v214, v214, v10
 v_mfma_f32_16x16x32_bf16 v[72:75], a[204:207], a[148:151], v[72:75]
 v_add_f32 v215, v215, v11
 v_mfma_f32_16x16x32_bf16 v[72:75], a[200:203], a[144:147], v[72:75]
 v_mfma_f32_16x16x32_bf16 v[68:71], a[200:203], a[136:139], v[68:71]
 v_mfma_f32_16x16x32_bf16 v[68:71], a[204:207], a[140:143], v[68:71]
 v_add_f32 v216, v216, v12
 v_mfma_f32_16x16x32_bf16 v[64:67], a[204:207], a[132:135], v[64:67]
 buffer_load_dwordx4 a[204:207], v0, s[12:15], s24 offen offset:3072
 v_mfma_f32_16x16x32_bf16 v[64:67], a[200:203], a[128:131], v[64:67]
 buffer_load_dwordx4 a[200:203], v0, s[12:15], s24 offen offset:2048
 s_waitcnt vmcnt(14)
 v_mfma_f32_16x16x32_bf16 v[80:83], a[208:211], a[128:131], v[80:83]
 v_mfma_f32_16x16x32_bf16 v[80:83], a[212:215], a[132:135], v[80:83]
 s_add_u32 s24, s24, 4096
 v_mfma_f32_16x16x32_bf16 v[84:87], a[212:215], a[140:143], v[84:87]
 ds_read_b128 v[8:11], v4 offset:2432
 v_mfma_f32_16x16x32_bf16 v[84:87], a[208:211], a[136:139], v[84:87]
 v_mfma_f32_16x16x32_bf16 v[88:91], a[208:211], a[144:147], v[88:91]
 v_add_f32 v217, v217, v13
 v_mfma_f32_16x16x32_bf16 v[88:91], a[212:215], a[148:151], v[88:91]
 v_add_f32 v218, v218, v14
 v_mfma_f32_16x16x32_bf16 v[92:95], a[212:215], a[156:159], v[92:95]
 buffer_load_dwordx4 a[212:215], v0, s[12:15], s24 offen offset:1024
 v_mfma_f32_16x16x32_bf16 v[92:95], a[208:211], a[152:155], v[92:95]
 buffer_load_dwordx4 a[208:211], v0, s[12:15], s24 offen
 s_waitcnt vmcnt(14)
 v_mfma_f32_16x16x32_bf16 v[108:111], a[216:219], a[152:155], v[108:111]
 v_mfma_f32_16x16x32_bf16 v[108:111], a[220:223], a[156:159], v[108:111]
 v_add_f32 v219, v219, v15
 v_mfma_f32_16x16x32_bf16 v[104:107], a[220:223], a[148:151], v[104:107]
 v_add_f32 v220, v220, v12
 v_mfma_f32_16x16x32_bf16 v[104:107], a[216:219], a[144:147], v[104:107]
 v_mfma_f32_16x16x32_bf16 v[100:103], a[216:219], a[136:139], v[100:103]
 v_add_f32 v221, v221, v13
 v_mfma_f32_16x16x32_bf16 v[100:103], a[220:223], a[140:143], v[100:103]
 v_add_f32 v222, v222, v14
 v_mfma_f32_16x16x32_bf16 v[96:99], a[220:223], a[132:135], v[96:99]
 buffer_load_dwordx4 a[220:223], v0, s[12:15], s24 offen offset:3072
 v_mfma_f32_16x16x32_bf16 v[96:99], a[216:219], a[128:131], v[96:99]
 buffer_load_dwordx4 a[216:219], v0, s[12:15], s24 offen offset:2048
 s_waitcnt vmcnt(14)
 v_mfma_f32_16x16x32_bf16 v[112:115], a[224:227], a[128:131], v[112:115]
 v_mfma_f32_16x16x32_bf16 v[112:115], a[228:231], a[132:135], v[112:115]
 s_add_u32 s24, s24, 4096
 v_mfma_f32_16x16x32_bf16 v[116:119], a[228:231], a[140:143], v[116:119]
 v_add_f32 v223, v223, v15
 v_mfma_f32_16x16x32_bf16 v[116:119], a[224:227], a[136:139], v[116:119]
 v_add_f32 v224, v224, v12
 v_mfma_f32_16x16x32_bf16 v[120:123], a[224:227], a[144:147], v[120:123]
 v_mfma_f32_16x16x32_bf16 v[120:123], a[228:231], a[148:151], v[120:123]
 v_add_f32 v225, v225, v13
 v_mfma_f32_16x16x32_bf16 v[124:127], a[228:231], a[156:159], v[124:127]
 buffer_load_dwordx4 a[228:231], v0, s[12:15], s24 offen offset:1024
 v_mfma_f32_16x16x32_bf16 v[124:127], a[224:227], a[152:155], v[124:127]
 buffer_load_dwordx4 a[224:227], v0, s[12:15], s24 offen
 s_waitcnt vmcnt(14)
 v_mfma_f32_16x16x32_bf16 a[244:247], a[232:235], a[152:155], a[244:247]
 ds_read_b128 a[152:155], v2 offset:27648
 v_mfma_f32_16x16x32_bf16 a[244:247], a[236:239], a[156:159], a[244:247]
 ds_read_b128 a[156:159], v2 offset:31744
 v_mfma_f32_16x16x32_bf16 a[240:243], a[236:239], a[148:151], a[240:243]
 ds_read_b128 a[148:151], v2 offset:30720
 v_mfma_f32_16x16x32_bf16 a[240:243], a[232:235], a[144:147], a[240:243]
 ds_read_b128 a[144:147], v2 offset:26624
 v_mfma_f32_16x16x32_bf16 v[132:135], a[232:235], a[136:139], v[132:135]
 v_add_f32 v226, v226, v14
 v_mfma_f32_16x16x32_bf16 v[132:135], a[236:239], a[140:143], v[132:135]
 v_mfma_f32_16x16x32_bf16 v[128:131], a[236:239], a[132:135], v[128:131]
 buffer_load_dwordx4 a[236:239], v0, s[12:15], s24 offen offset:3072
 v_mfma_f32_16x16x32_bf16 v[128:131], a[232:235], a[128:131], v[128:131]
 buffer_load_dwordx4 a[232:235], v0, s[12:15], s24 offen offset:2048
 s_waitcnt vmcnt(14) lgkmcnt(7)
 v_mfma_f32_16x16x32_bf16 v[16:19], a[176:179], a[160:163], v[16:19]
 v_add_f32 v227, v227, v15
 v_mfma_f32_16x16x32_bf16 v[16:19], a[180:183], a[164:167], v[16:19]
 s_add_u32 s24, s24, 53248
 s_waitcnt lgkmcnt(5)
 v_mfma_f32_16x16x32_bf16 v[20:23], a[180:183], a[172:175], v[20:23]
 v_add_f32 v228, v228, v12
 v_mfma_f32_16x16x32_bf16 v[20:23], a[176:179], a[168:171], v[20:23]
 s_waitcnt lgkmcnt(0)
 v_mfma_f32_16x16x32_bf16 v[24:27], a[176:179], a[144:147], v[24:27]
 v_mfma_f32_16x16x32_bf16 v[24:27], a[180:183], a[148:151], v[24:27]
 v_mfma_f32_16x16x32_bf16 v[28:31], a[180:183], a[156:159], v[28:31]
 buffer_load_dwordx4 a[180:183], v0, s[12:15], s24 offen offset:1024
 v_mfma_f32_16x16x32_bf16 v[28:31], a[176:179], a[152:155], v[28:31]
 buffer_load_dwordx4 a[176:179], v0, s[12:15], s24 offen
 s_waitcnt vmcnt(14)
 v_mfma_f32_16x16x32_bf16 v[44:47], a[184:187], a[152:155], v[44:47]
 v_add_f32 v229, v229, v13
 v_mfma_f32_16x16x32_bf16 v[44:47], a[188:191], a[156:159], v[44:47]
 v_mfma_f32_16x16x32_bf16 v[40:43], a[188:191], a[148:151], v[40:43]
 ds_read_b128 a[128:131], v2 offset:49152
 v_mfma_f32_16x16x32_bf16 v[40:43], a[184:187], a[144:147], v[40:43]
 v_add_f32 v230, v230, v14
 v_mfma_f32_16x16x32_bf16 v[36:39], a[184:187], a[168:171], v[36:39]
 ds_read_b128 a[132:135], v2 offset:53248
 v_mfma_f32_16x16x32_bf16 v[36:39], a[188:191], a[172:175], v[36:39]
 v_add_f32 v231, v231, v15
 v_mfma_f32_16x16x32_bf16 v[32:35], a[188:191], a[164:167], v[32:35]
 buffer_load_dwordx4 a[188:191], v0, s[12:15], s24 offen offset:3072
 v_mfma_f32_16x16x32_bf16 v[32:35], a[184:187], a[160:163], v[32:35]
 buffer_load_dwordx4 a[184:187], v0, s[12:15], s24 offen offset:2048
 s_waitcnt vmcnt(14)
 v_mfma_f32_16x16x32_bf16 v[48:51], a[192:195], a[160:163], v[48:51]
 ds_read_b128 a[136:139], v2 offset:50176
 ds_read_b128 a[140:143], v2 offset:54272
 v_mfma_f32_16x16x32_bf16 v[48:51], a[196:199], a[164:167], v[48:51]
 s_add_u32 s24, s24, 4096
 v_mfma_f32_16x16x32_bf16 v[52:55], a[196:199], a[172:175], v[52:55]
 v_mfma_f32_16x16x32_bf16 v[52:55], a[192:195], a[168:171], v[52:55]
 v_mfma_f32_16x16x32_bf16 v[56:59], a[192:195], a[144:147], v[56:59]
 v_add_f32 v232, v232, v8
 v_mfma_f32_16x16x32_bf16 v[56:59], a[196:199], a[148:151], v[56:59]
 v_mfma_f32_16x16x32_bf16 v[60:63], a[196:199], a[156:159], v[60:63]
 buffer_load_dwordx4 a[196:199], v0, s[12:15], s24 offen offset:1024
 v_mfma_f32_16x16x32_bf16 v[60:63], a[192:195], a[152:155], v[60:63]
 buffer_load_dwordx4 a[192:195], v0, s[12:15], s24 offen
 s_waitcnt vmcnt(14)
 v_mfma_f32_16x16x32_bf16 v[76:79], a[200:203], a[152:155], v[76:79]
 ds_read_b128 v[12:15], v4 offset:2448
 v_mfma_f32_16x16x32_bf16 v[76:79], a[204:207], a[156:159], v[76:79]
 v_add_f32 v233, v233, v9
 v_mfma_f32_16x16x32_bf16 v[72:75], a[204:207], a[148:151], v[72:75]
 v_mfma_f32_16x16x32_bf16 v[72:75], a[200:203], a[144:147], v[72:75]
 v_add_f32 v234, v234, v10
 v_mfma_f32_16x16x32_bf16 v[68:71], a[200:203], a[168:171], v[68:71]
 v_add_f32 v235, v235, v11
 v_mfma_f32_16x16x32_bf16 v[68:71], a[204:207], a[172:175], v[68:71]
 v_mfma_f32_16x16x32_bf16 v[64:67], a[204:207], a[164:167], v[64:67]
 buffer_load_dwordx4 a[204:207], v0, s[12:15], s24 offen offset:3072
 v_mfma_f32_16x16x32_bf16 v[64:67], a[200:203], a[160:163], v[64:67]
 buffer_load_dwordx4 a[200:203], v0, s[12:15], s24 offen offset:2048
 s_waitcnt vmcnt(14)
 v_mfma_f32_16x16x32_bf16 v[80:83], a[208:211], a[160:163], v[80:83]
 v_add_f32 v236, v236, v8
 v_mfma_f32_16x16x32_bf16 v[80:83], a[212:215], a[164:167], v[80:83]
 s_add_u32 s24, s24, 4096
 v_mfma_f32_16x16x32_bf16 v[84:87], a[212:215], a[172:175], v[84:87]
 v_add_f32 v237, v237, v9
 v_mfma_f32_16x16x32_bf16 v[84:87], a[208:211], a[168:171], v[84:87]
 v_mfma_f32_16x16x32_bf16 v[88:91], a[208:211], a[144:147], v[88:91]
 v_add_f32 v238, v238, v10
 v_mfma_f32_16x16x32_bf16 v[88:91], a[212:215], a[148:151], v[88:91]
 v_add_f32 v239, v239, v11
 v_mfma_f32_16x16x32_bf16 v[92:95], a[212:215], a[156:159], v[92:95]
 buffer_load_dwordx4 a[212:215], v0, s[12:15], s24 offen offset:1024
 v_mfma_f32_16x16x32_bf16 v[92:95], a[208:211], a[152:155], v[92:95]
 buffer_load_dwordx4 a[208:211], v0, s[12:15], s24 offen
 s_waitcnt vmcnt(14)
 v_mfma_f32_16x16x32_bf16 v[108:111], a[216:219], a[152:155], v[108:111]
 v_mfma_f32_16x16x32_bf16 v[108:111], a[220:223], a[156:159], v[108:111]
 v_add_f32 v240, v240, v8
 v_mfma_f32_16x16x32_bf16 v[104:107], a[220:223], a[148:151], v[104:107]
 v_mfma_f32_16x16x32_bf16 v[104:107], a[216:219], a[144:147], v[104:107]
 v_add_f32 v241, v241, v9
 v_mfma_f32_16x16x32_bf16 v[100:103], a[216:219], a[168:171], v[100:103]
 v_add_f32 v242, v242, v10
 v_mfma_f32_16x16x32_bf16 v[100:103], a[220:223], a[172:175], v[100:103]
 v_mfma_f32_16x16x32_bf16 v[96:99], a[220:223], a[164:167], v[96:99]
 buffer_load_dwordx4 a[220:223], v0, s[12:15], s24 offen offset:3072
 v_mfma_f32_16x16x32_bf16 v[96:99], a[216:219], a[160:163], v[96:99]
 buffer_load_dwordx4 a[216:219], v0, s[12:15], s24 offen offset:2048
 s_waitcnt vmcnt(14)
 v_mfma_f32_16x16x32_bf16 v[112:115], a[224:227], a[160:163], v[112:115]
 v_add_f32 v243, v243, v11
 v_mfma_f32_16x16x32_bf16 v[112:115], a[228:231], a[164:167], v[112:115]
 s_add_u32 s24, s24, 4096
 v_mfma_f32_16x16x32_bf16 v[116:119], a[228:231], a[172:175], v[116:119]
 v_add_f32 v244, v244, v8
 v_mfma_f32_16x16x32_bf16 v[116:119], a[224:227], a[168:171], v[116:119]
 v_mfma_f32_16x16x32_bf16 v[120:123], a[224:227], a[144:147], v[120:123]
 v_add_f32 v245, v245, v9
 v_mfma_f32_16x16x32_bf16 v[120:123], a[228:231], a[148:151], v[120:123]
 v_add_f32 v246, v246, v10
 v_mfma_f32_16x16x32_bf16 v[124:127], a[228:231], a[156:159], v[124:127]
 buffer_load_dwordx4 a[228:231], v0, s[12:15], s24 offen offset:1024
 v_mfma_f32_16x16x32_bf16 v[124:127], a[224:227], a[152:155], v[124:127]
 buffer_load_dwordx4 a[224:227], v0, s[12:15], s24 offen
 s_waitcnt vmcnt(14)
 v_mfma_f32_16x16x32_bf16 a[244:247], a[232:235], a[152:155], a[244:247]
 ds_read_b128 a[152:155], v2 offset:52224
 v_mfma_f32_16x16x32_bf16 a[244:247], a[236:239], a[156:159], a[244:247]
 ds_read_b128 a[156:159], v2 offset:56320
 v_mfma_f32_16x16x32_bf16 a[240:243], a[236:239], a[148:151], a[240:243]
 ds_read_b128 a[148:151], v2 offset:55296
 v_mfma_f32_16x16x32_bf16 a[240:243], a[232:235], a[144:147], a[240:243]
 ds_read_b128 a[144:147], v2 offset:51200
 v_mfma_f32_16x16x32_bf16 v[132:135], a[232:235], a[168:171], v[132:135]
 v_mfma_f32_16x16x32_bf16 v[132:135], a[236:239], a[172:175], v[132:135]
 v_add_f32 v247, v247, v11
 v_mfma_f32_16x16x32_bf16 v[128:131], a[236:239], a[164:167], v[128:131]
 buffer_load_dwordx4 a[236:239], v0, s[12:15], s24 offen offset:3072
 v_mfma_f32_16x16x32_bf16 v[128:131], a[232:235], a[160:163], v[128:131]
 buffer_load_dwordx4 a[232:235], v0, s[12:15], s24 offen offset:2048
 s_waitcnt vmcnt(14) lgkmcnt(7)
 v_mfma_f32_16x16x32_bf16 v[16:19], a[176:179], a[128:131], v[16:19]
 s_waitcnt lgkmcnt(4)
 v_mfma_f32_16x16x32_bf16 v[16:19], a[180:183], a[132:135], v[16:19]
 s_add_u32 s24, s24, 53248
 v_mfma_f32_16x16x32_bf16 v[20:23], a[180:183], a[140:143], v[20:23]
 v_mfma_f32_16x16x32_bf16 v[20:23], a[176:179], a[136:139], v[20:23]
 s_waitcnt lgkmcnt(0)
 v_mfma_f32_16x16x32_bf16 v[24:27], a[176:179], a[144:147], v[24:27]
 v_add_f32 v248, v248, v12
 v_mfma_f32_16x16x32_bf16 v[24:27], a[180:183], a[148:151], v[24:27]
 v_mfma_f32_16x16x32_bf16 v[28:31], a[180:183], a[156:159], v[28:31]
 buffer_load_dwordx4 a[180:183], v0, s[12:15], s24 offen offset:1024
 v_mfma_f32_16x16x32_bf16 v[28:31], a[176:179], a[152:155], v[28:31]
 buffer_load_dwordx4 a[176:179], v0, s[12:15], s24 offen
 s_waitcnt vmcnt(14)
 v_mfma_f32_16x16x32_bf16 v[44:47], a[184:187], a[152:155], v[44:47]
 v_add_f32 v249, v249, v13
 v_mfma_f32_16x16x32_bf16 v[44:47], a[188:191], a[156:159], v[44:47]
 v_mfma_f32_16x16x32_bf16 v[40:43], a[188:191], a[148:151], v[40:43]
 ds_read_b128 a[160:163], v2 offset:57344
 v_mfma_f32_16x16x32_bf16 v[40:43], a[184:187], a[144:147], v[40:43]
 v_add_f32 v250, v250, v14
 v_mfma_f32_16x16x32_bf16 v[36:39], a[184:187], a[136:139], v[36:39]
 ds_read_b128 a[164:167], v2 offset:61440
 v_mfma_f32_16x16x32_bf16 v[36:39], a[188:191], a[140:143], v[36:39]
 v_add_f32 v251, v251, v15
 v_mfma_f32_16x16x32_bf16 v[32:35], a[188:191], a[132:135], v[32:35]
 buffer_load_dwordx4 a[188:191], v0, s[12:15], s24 offen offset:3072
 v_mfma_f32_16x16x32_bf16 v[32:35], a[184:187], a[128:131], v[32:35]
 buffer_load_dwordx4 a[184:187], v0, s[12:15], s24 offen offset:2048
 s_waitcnt vmcnt(14)
 v_mfma_f32_16x16x32_bf16 v[48:51], a[192:195], a[128:131], v[48:51]
 ds_read_b128 a[168:171], v2 offset:58368
 ds_read_b128 a[172:175], v2 offset:62464
 v_mfma_f32_16x16x32_bf16 v[48:51], a[196:199], a[132:135], v[48:51]
 s_add_u32 s24, s24, 4096
 v_mfma_f32_16x16x32_bf16 v[52:55], a[196:199], a[140:143], v[52:55]
 v_mfma_f32_16x16x32_bf16 v[52:55], a[192:195], a[136:139], v[52:55]
 v_add_f32 v252, v252, v12
 v_mfma_f32_16x16x32_bf16 v[56:59], a[192:195], a[144:147], v[56:59]
 v_mfma_f32_16x16x32_bf16 v[56:59], a[196:199], a[148:151], v[56:59]
 v_add_f32 v253, v253, v13
 v_mfma_f32_16x16x32_bf16 v[60:63], a[196:199], a[156:159], v[60:63]
 buffer_load_dwordx4 a[196:199], v0, s[12:15], s24 offen offset:1024
 v_mfma_f32_16x16x32_bf16 v[60:63], a[192:195], a[152:155], v[60:63]
 buffer_load_dwordx4 a[192:195], v0, s[12:15], s24 offen
 s_waitcnt vmcnt(14)
 v_mfma_f32_16x16x32_bf16 v[76:79], a[200:203], a[152:155], v[76:79]
 v_add_f32 v254, v254, v14
 v_mfma_f32_16x16x32_bf16 v[76:79], a[204:207], a[156:159], v[76:79]
 v_mfma_f32_16x16x32_bf16 v[72:75], a[204:207], a[148:151], v[72:75]
 v_add_f32 v255, v255, v15
 v_mfma_f32_16x16x32_bf16 v[72:75], a[200:203], a[144:147], v[72:75]
 v_accvgpr_read_b32 v5, a248
 v_mfma_f32_16x16x32_bf16 v[68:71], a[200:203], a[136:139], v[68:71]
 v_mfma_f32_16x16x32_bf16 v[68:71], a[204:207], a[140:143], v[68:71]
 v_add_f32 v5, v5, v12
 v_mfma_f32_16x16x32_bf16 v[64:67], a[204:207], a[132:135], v[64:67]
 buffer_load_dwordx4 a[204:207], v0, s[12:15], s24 offen offset:3072
 v_mfma_f32_16x16x32_bf16 v[64:67], a[200:203], a[128:131], v[64:67]
 buffer_load_dwordx4 a[200:203], v0, s[12:15], s24 offen offset:2048
 s_waitcnt vmcnt(14)
 v_mfma_f32_16x16x32_bf16 v[80:83], a[208:211], a[128:131], v[80:83]
 v_accvgpr_write_b32 a248, v5
 v_mfma_f32_16x16x32_bf16 v[80:83], a[212:215], a[132:135], v[80:83]
 s_add_u32 s24, s24, 4096
 v_mfma_f32_16x16x32_bf16 v[84:87], a[212:215], a[140:143], v[84:87]
 v_mfma_f32_16x16x32_bf16 v[84:87], a[208:211], a[136:139], v[84:87]
 v_accvgpr_read_b32 v6, a249
 v_mfma_f32_16x16x32_bf16 v[88:91], a[208:211], a[144:147], v[88:91]
 v_add_f32 v6, v6, v13
 v_mfma_f32_16x16x32_bf16 v[88:91], a[212:215], a[148:151], v[88:91]
 v_mfma_f32_16x16x32_bf16 v[92:95], a[212:215], a[156:159], v[92:95]
 buffer_load_dwordx4 a[212:215], v0, s[12:15], s24 offen offset:1024
 v_mfma_f32_16x16x32_bf16 v[92:95], a[208:211], a[152:155], v[92:95]
 buffer_load_dwordx4 a[208:211], v0, s[12:15], s24 offen
 s_waitcnt vmcnt(14)
 v_mfma_f32_16x16x32_bf16 v[108:111], a[216:219], a[152:155], v[108:111]
 v_accvgpr_write_b32 a249, v6
 v_mfma_f32_16x16x32_bf16 v[108:111], a[220:223], a[156:159], v[108:111]
 v_accvgpr_read_b32 v5, a250
 v_mfma_f32_16x16x32_bf16 v[104:107], a[220:223], a[148:151], v[104:107]
 v_mfma_f32_16x16x32_bf16 v[104:107], a[216:219], a[144:147], v[104:107]
 v_add_f32 v5, v5, v14
 v_mfma_f32_16x16x32_bf16 v[100:103], a[216:219], a[136:139], v[100:103]
 v_accvgpr_write_b32 a250, v5
 v_mfma_f32_16x16x32_bf16 v[100:103], a[220:223], a[140:143], v[100:103]
 v_mfma_f32_16x16x32_bf16 v[96:99], a[220:223], a[132:135], v[96:99]
 buffer_load_dwordx4 a[220:223], v0, s[12:15], s24 offen offset:3072
 v_mfma_f32_16x16x32_bf16 v[96:99], a[216:219], a[128:131], v[96:99]
 buffer_load_dwordx4 a[216:219], v0, s[12:15], s24 offen offset:2048
 s_waitcnt vmcnt(14)
 v_mfma_f32_16x16x32_bf16 v[112:115], a[224:227], a[128:131], v[112:115]
 v_accvgpr_read_b32 v6, a251
 v_mfma_f32_16x16x32_bf16 v[112:115], a[228:231], a[132:135], v[112:115]
 s_add_u32 s24, s24, 4096
 v_mfma_f32_16x16x32_bf16 v[116:119], a[228:231], a[140:143], v[116:119]
 v_mfma_f32_16x16x32_bf16 v[116:119], a[224:227], a[136:139], v[116:119]
 v_add_f32 v6, v6, v15
 v_mfma_f32_16x16x32_bf16 v[120:123], a[224:227], a[144:147], v[120:123]
 v_accvgpr_write_b32 a251, v6
 v_mfma_f32_16x16x32_bf16 v[120:123], a[228:231], a[148:151], v[120:123]
 v_mfma_f32_16x16x32_bf16 v[124:127], a[228:231], a[156:159], v[124:127]
 buffer_load_dwordx4 a[228:231], v0, s[12:15], s24 offen offset:1024
 v_mfma_f32_16x16x32_bf16 v[124:127], a[224:227], a[152:155], v[124:127]
 buffer_load_dwordx4 a[224:227], v0, s[12:15], s24 offen
 s_waitcnt vmcnt(14)
 v_mfma_f32_16x16x32_bf16 a[244:247], a[232:235], a[152:155], a[244:247]
 ds_read_b128 a[152:155], v2 offset:60416
 v_mfma_f32_16x16x32_bf16 a[244:247], a[236:239], a[156:159], a[244:247]
 ds_read_b128 a[156:159], v2 offset:64512
 v_mfma_f32_16x16x32_bf16 a[240:243], a[236:239], a[148:151], a[240:243]
 ds_read_b128 a[148:151], v2 offset:63488
 v_mfma_f32_16x16x32_bf16 a[240:243], a[232:235], a[144:147], a[240:243]
 ds_read_b128 a[144:147], v2 offset:59392
 v_mfma_f32_16x16x32_bf16 v[132:135], a[232:235], a[136:139], v[132:135]
 v_accvgpr_read_b32 v5, a252
 v_mfma_f32_16x16x32_bf16 v[132:135], a[236:239], a[140:143], v[132:135]
 v_add_f32 v5, v5, v12
 v_mfma_f32_16x16x32_bf16 v[128:131], a[236:239], a[132:135], v[128:131]
 buffer_load_dwordx4 a[236:239], v0, s[12:15], s24 offen offset:3072
 v_mfma_f32_16x16x32_bf16 v[128:131], a[232:235], a[128:131], v[128:131]
 buffer_load_dwordx4 a[232:235], v0, s[12:15], s24 offen offset:2048
 s_waitcnt vmcnt(14) lgkmcnt(6)
 v_mfma_f32_16x16x32_bf16 v[16:19], a[176:179], a[160:163], v[16:19]
 v_mfma_f32_16x16x32_bf16 v[16:19], a[180:183], a[164:167], v[16:19]
 s_add_u32 s24, s24, 53248
 s_waitcnt lgkmcnt(4)
 v_mfma_f32_16x16x32_bf16 v[20:23], a[180:183], a[172:175], v[20:23]
 v_accvgpr_write_b32 a252, v5
 v_mfma_f32_16x16x32_bf16 v[20:23], a[176:179], a[168:171], v[20:23]
 s_waitcnt lgkmcnt(0)
 v_mfma_f32_16x16x32_bf16 v[24:27], a[176:179], a[144:147], v[24:27]
 v_accvgpr_read_b32 v6, a253
 v_mfma_f32_16x16x32_bf16 v[24:27], a[180:183], a[148:151], v[24:27]
 v_mfma_f32_16x16x32_bf16 v[28:31], a[180:183], a[156:159], v[28:31]
 buffer_load_dwordx4 a[180:183], v0, s[12:15], s24 offen offset:1024
 v_mfma_f32_16x16x32_bf16 v[28:31], a[176:179], a[152:155], v[28:31]
 buffer_load_dwordx4 a[176:179], v0, s[12:15], s24 offen
 s_waitcnt vmcnt(14)
 v_mfma_f32_16x16x32_bf16 v[44:47], a[184:187], a[152:155], v[44:47]
 v_mfma_f32_16x16x32_bf16 v[44:47], a[188:191], a[156:159], v[44:47]
 v_add_f32 v6, v6, v13
 v_mfma_f32_16x16x32_bf16 v[40:43], a[188:191], a[148:151], v[40:43]
 ds_read_b128 a[128:131], v1
 v_mfma_f32_16x16x32_bf16 v[40:43], a[184:187], a[144:147], v[40:43]
 v_accvgpr_write_b32 a253, v6
 v_mfma_f32_16x16x32_bf16 v[36:39], a[184:187], a[168:171], v[36:39]
 ds_read_b128 a[132:135], v1 offset:4096
 v_mfma_f32_16x16x32_bf16 v[36:39], a[188:191], a[172:175], v[36:39]
 v_mfma_f32_16x16x32_bf16 v[32:35], a[188:191], a[164:167], v[32:35]
 buffer_load_dwordx4 a[188:191], v0, s[12:15], s24 offen offset:3072
 v_mfma_f32_16x16x32_bf16 v[32:35], a[184:187], a[160:163], v[32:35]
 buffer_load_dwordx4 a[184:187], v0, s[12:15], s24 offen offset:2048
 s_waitcnt vmcnt(14)
 v_mfma_f32_16x16x32_bf16 v[48:51], a[192:195], a[160:163], v[48:51]
 ds_read_b128 a[136:139], v1 offset:1024
 ds_read_b128 a[140:143], v1 offset:5120
 v_mfma_f32_16x16x32_bf16 v[48:51], a[196:199], a[164:167], v[48:51]
 s_add_u32 s24, s24, 4096
 v_mfma_f32_16x16x32_bf16 v[52:55], a[196:199], a[172:175], v[52:55]
 v_accvgpr_read_b32 v5, a254
 v_mfma_f32_16x16x32_bf16 v[52:55], a[192:195], a[168:171], v[52:55]
 v_add_f32 v5, v5, v14
 v_mfma_f32_16x16x32_bf16 v[56:59], a[192:195], a[144:147], v[56:59]
 v_mfma_f32_16x16x32_bf16 v[56:59], a[196:199], a[148:151], v[56:59]
 v_accvgpr_write_b32 a254, v5
 v_mfma_f32_16x16x32_bf16 v[60:63], a[196:199], a[156:159], v[60:63]
 buffer_load_dwordx4 a[196:199], v0, s[12:15], s24 offen offset:1024
 v_mfma_f32_16x16x32_bf16 v[60:63], a[192:195], a[152:155], v[60:63]
 buffer_load_dwordx4 a[192:195], v0, s[12:15], s24 offen
 s_waitcnt vmcnt(14)
 v_mfma_f32_16x16x32_bf16 v[76:79], a[200:203], a[152:155], v[76:79]
 v_accvgpr_read_b32 v6, a255
 v_mfma_f32_16x16x32_bf16 v[76:79], a[204:207], a[156:159], v[76:79]
 v_mfma_f32_16x16x32_bf16 v[72:75], a[204:207], a[148:151], v[72:75]
 v_add_f32 v6, v6, v15
 v_mfma_f32_16x16x32_bf16 v[72:75], a[200:203], a[144:147], v[72:75]
 v_mfma_f32_16x16x32_bf16 v[68:71], a[200:203], a[168:171], v[68:71]
 v_accvgpr_write_b32 a255, v6
 v_mfma_f32_16x16x32_bf16 v[68:71], a[204:207], a[172:175], v[68:71]
 v_and_b32 v5, 768, v1
 v_mfma_f32_16x16x32_bf16 v[64:67], a[204:207], a[164:167], v[64:67]
 buffer_load_dwordx4 a[204:207], v0, s[12:15], s24 offen offset:3072
 v_mfma_f32_16x16x32_bf16 v[64:67], a[200:203], a[160:163], v[64:67]
 buffer_load_dwordx4 a[200:203], v0, s[12:15], s24 offen offset:2048
 s_waitcnt vmcnt(14)
 v_mfma_f32_16x16x32_bf16 v[80:83], a[208:211], a[160:163], v[80:83]
 v_mfma_f32_16x16x32_bf16 v[80:83], a[212:215], a[164:167], v[80:83]
 s_add_u32 s24, s24, 4096
 v_mfma_f32_16x16x32_bf16 v[84:87], a[212:215], a[172:175], v[84:87]
 v_add3_u32 v5, v5, v1, s52
 v_mfma_f32_16x16x32_bf16 v[84:87], a[208:211], a[168:171], v[84:87]
 v_mfma_f32_16x16x32_bf16 v[88:91], a[208:211], a[144:147], v[88:91]
 v_mfma_f32_16x16x32_bf16 v[88:91], a[212:215], a[148:151], v[88:91]
 ds_read_b64_tr_b16 v[8:9], v5 offset:0
 v_mfma_f32_16x16x32_bf16 v[92:95], a[212:215], a[156:159], v[92:95]
 buffer_load_dwordx4 a[212:215], v0, s[12:15], s24 offen offset:1024
 v_mfma_f32_16x16x32_bf16 v[92:95], a[208:211], a[152:155], v[92:95]
 buffer_load_dwordx4 a[208:211], v0, s[12:15], s24 offen
 s_waitcnt vmcnt(14)
 v_mfma_f32_16x16x32_bf16 v[108:111], a[216:219], a[152:155], v[108:111]
 ds_read_b64_tr_b16 v[10:11], v5 offset:256
 v_mfma_f32_16x16x32_bf16 v[108:111], a[220:223], a[156:159], v[108:111]
 v_mfma_f32_16x16x32_bf16 v[104:107], a[220:223], a[148:151], v[104:107]
 ds_read_b64_tr_b16 v[12:13], v5 offset:8
 v_mfma_f32_16x16x32_bf16 v[104:107], a[216:219], a[144:147], v[104:107]
 ds_read_b64_tr_b16 v[14:15], v5 offset:264
 v_mfma_f32_16x16x32_bf16 v[100:103], a[216:219], a[168:171], v[100:103]
 v_mfma_f32_16x16x32_bf16 v[100:103], a[220:223], a[172:175], v[100:103]
 s_waitcnt lgkmcnt(2)
 v_mfma_f32_16x16x32_bf16 v[96:99], a[220:223], a[164:167], v[96:99]
 buffer_load_dwordx4 a[220:223], v0, s[12:15], s24 offen offset:3072
 v_mfma_f32_16x16x32_bf16 v[96:99], a[216:219], a[160:163], v[96:99]
 buffer_load_dwordx4 a[216:219], v0, s[12:15], s24 offen offset:2048
 s_waitcnt vmcnt(14)
 v_mfma_f32_16x16x32_bf16 v[112:115], a[224:227], a[160:163], v[112:115]
 buffer_store_dwordx4 v[8:11], v1, s[12:15], s49 offen sc1
 v_mfma_f32_16x16x32_bf16 v[112:115], a[228:231], a[164:167], v[112:115]
 s_add_u32 s24, s24, 4096
 v_mfma_f32_16x16x32_bf16 v[116:119], a[228:231], a[172:175], v[116:119]
 v_mfma_f32_16x16x32_bf16 v[116:119], a[224:227], a[168:171], v[116:119]
 s_waitcnt lgkmcnt(0)
 v_mfma_f32_16x16x32_bf16 v[120:123], a[224:227], a[144:147], v[120:123]
 buffer_store_dwordx4 v[12:15], v1, s[12:15], s49 offen offset:2048 sc1
 v_mfma_f32_16x16x32_bf16 v[120:123], a[228:231], a[148:151], v[120:123]
 v_mfma_f32_16x16x32_bf16 v[124:127], a[228:231], a[156:159], v[124:127]
 buffer_load_dwordx4 a[228:231], v0, s[12:15], s24 offen offset:1024
 v_mfma_f32_16x16x32_bf16 v[124:127], a[224:227], a[152:155], v[124:127]
 buffer_load_dwordx4 a[224:227], v0, s[12:15], s24 offen
 s_waitcnt vmcnt(16)
 v_mfma_f32_16x16x32_bf16 a[244:247], a[232:235], a[152:155], a[244:247]
 ds_read_b128 a[152:155], v1 offset:3072
 v_mfma_f32_16x16x32_bf16 a[244:247], a[236:239], a[156:159], a[244:247]
 ds_read_b128 a[156:159], v1 offset:7168
 v_mfma_f32_16x16x32_bf16 a[240:243], a[236:239], a[148:151], a[240:243]
 ds_read_b128 a[148:151], v1 offset:6144
 v_mfma_f32_16x16x32_bf16 a[240:243], a[232:235], a[144:147], a[240:243]
 ds_read_b128 a[144:147], v1 offset:2048
 v_mfma_f32_16x16x32_bf16 v[132:135], a[232:235], a[168:171], v[132:135]
 s_add_u32 s49, s49, 2097152
 v_mfma_f32_16x16x32_bf16 v[132:135], a[236:239], a[172:175], v[132:135]
 v_mfma_f32_16x16x32_bf16 v[128:131], a[236:239], a[164:167], v[128:131]
 buffer_load_dwordx4 a[236:239], v0, s[12:15], s24 offen offset:3072
 v_mfma_f32_16x16x32_bf16 v[128:131], a[232:235], a[160:163], v[128:131]
 buffer_load_dwordx4 a[232:235], v0, s[12:15], s24 offen offset:2048
 s_add_u32 s24, s24, 53248
 s_waitcnt vmcnt(16)
 v_mfma_f32_16x16x32_bf16 v[136:139], a[176:179], a[128:131], v[136:139]
 ds_read_b128 v[8:11], v4
 v_mfma_f32_16x16x32_bf16 v[136:139], a[180:183], a[132:135], v[136:139]
 v_mfma_f32_16x16x32_bf16 v[140:143], a[180:183], a[140:143], v[140:143]
 s_waitcnt lgkmcnt(0)
 v_mfma_f32_16x16x32_bf16 v[140:143], a[176:179], a[136:139], v[140:143]
 v_mfma_f32_16x16x32_bf16 v[144:147], a[176:179], a[144:147], v[144:147]
 v_mfma_f32_16x16x32_bf16 v[144:147], a[180:183], a[148:151], v[144:147]
 v_mfma_f32_16x16x32_bf16 v[148:151], a[180:183], a[156:159], v[148:151]
 buffer_load_dwordx4 a[180:183], v0, s[12:15], s24 offen offset:1024
 v_mfma_f32_16x16x32_bf16 v[148:151], a[176:179], a[152:155], v[148:151]
 buffer_load_dwordx4 a[176:179], v0, s[12:15], s24 offen
 s_waitcnt vmcnt(16)
 v_mfma_f32_16x16x32_bf16 v[164:167], a[184:187], a[152:155], v[164:167]
 v_add_f32 v16, v16, v8
 v_mfma_f32_16x16x32_bf16 v[164:167], a[188:191], a[156:159], v[164:167]
 ds_read_b128 v[12:15], v4 offset:16
 v_mfma_f32_16x16x32_bf16 v[160:163], a[188:191], a[148:151], v[160:163]
 ds_read_b128 a[160:163], v1 offset:8192
 v_mfma_f32_16x16x32_bf16 v[160:163], a[184:187], a[144:147], v[160:163]
 v_mfma_f32_16x16x32_bf16 v[156:159], a[184:187], a[136:139], v[156:159]
 ds_read_b128 a[164:167], v1 offset:12288
 v_mfma_f32_16x16x32_bf16 v[156:159], a[188:191], a[140:143], v[156:159]
 v_add_f32 v17, v17, v9
 v_mfma_f32_16x16x32_bf16 v[152:155], a[188:191], a[132:135], v[152:155]
 buffer_load_dwordx4 a[188:191], v0, s[12:15], s24 offen offset:3072
 v_mfma_f32_16x16x32_bf16 v[152:155], a[184:187], a[128:131], v[152:155]
 buffer_load_dwordx4 a[184:187], v0, s[12:15], s24 offen offset:2048
 s_waitcnt vmcnt(16)
 v_mfma_f32_16x16x32_bf16 v[168:171], a[192:195], a[128:131], v[168:171]
 ds_read_b128 a[168:171], v1 offset:9216
 ds_read_b128 a[172:175], v1 offset:13312
 v_mfma_f32_16x16x32_bf16 v[168:171], a[196:199], a[132:135], v[168:171]
 s_add_u32 s24, s24, 4096
 v_mfma_f32_16x16x32_bf16 v[172:175], a[196:199], a[140:143], v[172:175]
 v_mfma_f32_16x16x32_bf16 v[172:175], a[192:195], a[136:139], v[172:175]
 v_add_f32 v18, v18, v10
 v_mfma_f32_16x16x32_bf16 v[176:179], a[192:195], a[144:147], v[176:179]
 v_add_f32 v19, v19, v11
 v_mfma_f32_16x16x32_bf16 v[176:179], a[196:199], a[148:151], v[176:179]
 v_mfma_f32_16x16x32_bf16 v[180:183], a[196:199], a[156:159], v[180:183]
 buffer_load_dwordx4 a[196:199], v0, s[12:15], s24 offen offset:1024
 v_mfma_f32_16x16x32_bf16 v[180:183], a[192:195], a[152:155], v[180:183]
 buffer_load_dwordx4 a[192:195], v0, s[12:15], s24 offen
 s_waitcnt vmcnt(16)
 v_mfma_f32_16x16x32_bf16 v[196:199], a[200:203], a[152:155], v[196:199]
 v_add_f32 v20, v20, v8
 v_mfma_f32_16x16x32_bf16 v[196:199], a[204:207], a[156:159], v[196:199]
 v_mfma_f32_16x16x32_bf16 v[192:195], a[204:207], a[148:151], v[192:195]
 v_add_f32 v21, v21, v9
 v_mfma_f32_16x16x32_bf16 v[192:195], a[200:203], a[144:147], v[192:195]
 v_add_f32 v22, v22, v10
 v_mfma_f32_16x16x32_bf16 v[188:191], a[200:203], a[136:139], v[188:191]
 v_mfma_f32_16x16x32_bf16 v[188:191], a[204:207], a[140:143], v[188:191]
 v_add_f32 v23, v23, v11
 v_mfma_f32_16x16x32_bf16 v[184:187], a[204:207], a[132:135], v[184:187]
 buffer_load_dwordx4 a[204:207], v0, s[12:15], s24 offen offset:3072
 v_mfma_f32_16x16x32_bf16 v[184:187], a[200:203], a[128:131], v[184:187]
 buffer_load_dwordx4 a[200:203], v0, s[12:15], s24 offen offset:2048
 s_waitcnt vmcnt(16)
 v_mfma_f32_16x16x32_bf16 v[200:203], a[208:211], a[128:131], v[200:203]
 v_mfma_f32_16x16x32_bf16 v[200:203], a[212:215], a[132:135], v[200:203]
 s_add_u32 s24, s24, 4096
 v_mfma_f32_16x16x32_bf16 v[204:207], a[212:215], a[140:143], v[204:207]
 v_add_f32 v24, v24, v8
 v_mfma_f32_16x16x32_bf16 v[204:207], a[208:211], a[136:139], v[204:207]
 v_add_f32 v25, v25, v9
 v_mfma_f32_16x16x32_bf16 v[208:211], a[208:211], a[144:147], v[208:211]
 v_mfma_f32_16x16x32_bf16 v[208:211], a[212:215], a[148:151], v[208:211]
 v_add_f32 v26, v26, v10
 v_mfma_f32_16x16x32_bf16 v[212:215], a[212:215], a[156:159], v[212:215]
 buffer_load_dwordx4 a[212:215], v0, s[12:15], s24 offen offset:1024
 v_mfma_f32_16x16x32_bf16 v[212:215], a[208:211], a[152:155], v[212:215]
 buffer_load_dwordx4 a[208:211], v0, s[12:15], s24 offen
 s_waitcnt vmcnt(16)
 v_mfma_f32_16x16x32_bf16 v[228:231], a[216:219], a[152:155], v[228:231]
 v_mfma_f32_16x16x32_bf16 v[228:231], a[220:223], a[156:159], v[228:231]
 v_add_f32 v27, v27, v11
 v_mfma_f32_16x16x32_bf16 v[224:227], a[220:223], a[148:151], v[224:227]
 v_add_f32 v28, v28, v8
 v_mfma_f32_16x16x32_bf16 v[224:227], a[216:219], a[144:147], v[224:227]
 v_mfma_f32_16x16x32_bf16 v[220:223], a[216:219], a[136:139], v[220:223]
 v_add_f32 v29, v29, v9
 v_mfma_f32_16x16x32_bf16 v[220:223], a[220:223], a[140:143], v[220:223]
 v_mfma_f32_16x16x32_bf16 v[216:219], a[220:223], a[132:135], v[216:219]
 buffer_load_dwordx4 a[220:223], v0, s[12:15], s24 offen offset:3072
 v_mfma_f32_16x16x32_bf16 v[216:219], a[216:219], a[128:131], v[216:219]
 buffer_load_dwordx4 a[216:219], v0, s[12:15], s24 offen offset:2048
 s_waitcnt vmcnt(14)
 v_mfma_f32_16x16x32_bf16 v[232:235], a[224:227], a[128:131], v[232:235]
 v_add_f32 v30, v30, v10
 v_mfma_f32_16x16x32_bf16 v[232:235], a[228:231], a[132:135], v[232:235]
 s_add_u32 s24, s24, 4096
 v_mfma_f32_16x16x32_bf16 v[236:239], a[228:231], a[140:143], v[236:239]
 v_add_f32 v31, v31, v11
 v_mfma_f32_16x16x32_bf16 v[236:239], a[224:227], a[136:139], v[236:239]
 v_mfma_f32_16x16x32_bf16 v[240:243], a[224:227], a[144:147], v[240:243]
 s_waitcnt lgkmcnt(4)
 v_mfma_f32_16x16x32_bf16 v[240:243], a[228:231], a[148:151], v[240:243]
 v_mfma_f32_16x16x32_bf16 v[244:247], a[228:231], a[156:159], v[244:247]
 buffer_load_dwordx4 a[228:231], v0, s[12:15], s24 offen offset:1024
 v_mfma_f32_16x16x32_bf16 v[244:247], a[224:227], a[152:155], v[244:247]
 buffer_load_dwordx4 a[224:227], v0, s[12:15], s24 offen
 s_waitcnt vmcnt(14)
 v_mfma_f32_16x16x32_bf16 a[252:255], a[232:235], a[152:155], a[252:255]
 ds_read_b128 a[152:155], v1 offset:11264
 v_mfma_f32_16x16x32_bf16 a[252:255], a[236:239], a[156:159], a[252:255]
 ds_read_b128 a[156:159], v1 offset:15360
 v_mfma_f32_16x16x32_bf16 a[248:251], a[236:239], a[148:151], a[248:251]
 ds_read_b128 a[148:151], v1 offset:14336
 v_mfma_f32_16x16x32_bf16 a[248:251], a[232:235], a[144:147], a[248:251]
 ds_read_b128 a[144:147], v1 offset:10240
 v_mfma_f32_16x16x32_bf16 v[252:255], a[232:235], a[136:139], v[252:255]
 v_add_f32 v32, v32, v12
 v_mfma_f32_16x16x32_bf16 v[252:255], a[236:239], a[140:143], v[252:255]
 ds_read_b128 v[8:11], v4 offset:128
 v_mfma_f32_16x16x32_bf16 v[248:251], a[236:239], a[132:135], v[248:251]
 buffer_load_dwordx4 a[236:239], v0, s[12:15], s24 offen offset:3072
 v_mfma_f32_16x16x32_bf16 v[248:251], a[232:235], a[128:131], v[248:251]
 buffer_load_dwordx4 a[232:235], v0, s[12:15], s24 offen offset:2048
 s_waitcnt vmcnt(14) lgkmcnt(7)
 v_mfma_f32_16x16x32_bf16 v[136:139], a[176:179], a[160:163], v[136:139]
 v_mfma_f32_16x16x32_bf16 v[136:139], a[180:183], a[164:167], v[136:139]
 s_add_u32 s24, s24, 53248
 s_waitcnt lgkmcnt(5)
 v_mfma_f32_16x16x32_bf16 v[140:143], a[180:183], a[172:175], v[140:143]
 v_add_f32 v33, v33, v13
 v_mfma_f32_16x16x32_bf16 v[140:143], a[176:179], a[168:171], v[140:143]
 s_waitcnt lgkmcnt(1)
 v_mfma_f32_16x16x32_bf16 v[144:147], a[176:179], a[144:147], v[144:147]
 v_mfma_f32_16x16x32_bf16 v[144:147], a[180:183], a[148:151], v[144:147]
 v_mfma_f32_16x16x32_bf16 v[148:151], a[180:183], a[156:159], v[148:151]
 buffer_load_dwordx4 a[180:183], v0, s[12:15], s24 offen offset:1024
 v_mfma_f32_16x16x32_bf16 v[148:151], a[176:179], a[152:155], v[148:151]
 buffer_load_dwordx4 a[176:179], v0, s[12:15], s24 offen
 s_waitcnt vmcnt(14)
 v_mfma_f32_16x16x32_bf16 v[164:167], a[184:187], a[152:155], v[164:167]
 v_add_f32 v34, v34, v14
 v_mfma_f32_16x16x32_bf16 v[164:167], a[188:191], a[156:159], v[164:167]
 v_add_f32 v35, v35, v15
 v_mfma_f32_16x16x32_bf16 v[160:163], a[188:191], a[148:151], v[160:163]
 ds_read_b128 a[128:131], v1 offset:32768
 v_mfma_f32_16x16x32_bf16 v[160:163], a[184:187], a[144:147], v[160:163]
 v_mfma_f32_16x16x32_bf16 v[156:159], a[184:187], a[168:171], v[156:159]
 ds_read_b128 a[132:135], v1 offset:36864
 v_mfma_f32_16x16x32_bf16 v[156:159], a[188:191], a[172:175], v[156:159]
 v_add_f32 v36, v36, v12
 v_mfma_f32_16x16x32_bf16 v[152:155], a[188:191], a[164:167], v[152:155]
 buffer_load_dwordx4 a[188:191], v0, s[12:15], s24 offen offset:3072
 v_mfma_f32_16x16x32_bf16 v[152:155], a[184:187], a[160:163], v[152:155]
 buffer_load_dwordx4 a[184:187], v0, s[12:15], s24 offen offset:2048
 s_waitcnt vmcnt(14)
 v_mfma_f32_16x16x32_bf16 v[168:171], a[192:195], a[160:163], v[168:171]
 ds_read_b128 a[136:139], v1 offset:33792
 ds_read_b128 a[140:143], v1 offset:37888
 v_mfma_f32_16x16x32_bf16 v[168:171], a[196:199], a[164:167], v[168:171]
 s_add_u32 s24, s24, 4096
 v_mfma_f32_16x16x32_bf16 v[172:175], a[196:199], a[172:175], v[172:175]
 v_mfma_f32_16x16x32_bf16 v[172:175], a[192:195], a[168:171], v[172:175]
 v_add_f32 v37, v37, v13
 v_mfma_f32_16x16x32_bf16 v[176:179], a[192:195], a[144:147], v[176:179]
 v_add_f32 v38, v38, v14
 v_mfma_f32_16x16x32_bf16 v[176:179], a[196:199], a[148:151], v[176:179]
 v_mfma_f32_16x16x32_bf16 v[180:183], a[196:199], a[156:159], v[180:183]
 buffer_load_dwordx4 a[196:199], v0, s[12:15], s24 offen offset:1024
 v_mfma_f32_16x16x32_bf16 v[180:183], a[192:195], a[152:155], v[180:183]
 buffer_load_dwordx4 a[192:195], v0, s[12:15], s24 offen
 s_waitcnt vmcnt(14)
 v_mfma_f32_16x16x32_bf16 v[196:199], a[200:203], a[152:155], v[196:199]
 v_add_f32 v39, v39, v15
 v_mfma_f32_16x16x32_bf16 v[196:199], a[204:207], a[156:159], v[196:199]
 v_mfma_f32_16x16x32_bf16 v[192:195], a[204:207], a[148:151], v[192:195]
 v_add_f32 v40, v40, v12
 v_mfma_f32_16x16x32_bf16 v[192:195], a[200:203], a[144:147], v[192:195]
 v_add_f32 v41, v41, v13
 v_mfma_f32_16x16x32_bf16 v[188:191], a[200:203], a[168:171], v[188:191]
 v_mfma_f32_16x16x32_bf16 v[188:191], a[204:207], a[172:175], v[188:191]
 v_add_f32 v42, v42, v14
 v_mfma_f32_16x16x32_bf16 v[184:187], a[204:207], a[164:167], v[184:187]
 buffer_load_dwordx4 a[204:207], v0, s[12:15], s24 offen offset:3072
 v_mfma_f32_16x16x32_bf16 v[184:187], a[200:203], a[160:163], v[184:187]
 buffer_load_dwordx4 a[200:203], v0, s[12:15], s24 offen offset:2048
 s_waitcnt vmcnt(14)
 v_mfma_f32_16x16x32_bf16 v[200:203], a[208:211], a[160:163], v[200:203]
 v_mfma_f32_16x16x32_bf16 v[200:203], a[212:215], a[164:167], v[200:203]
 s_add_u32 s24, s24, 4096
 v_mfma_f32_16x16x32_bf16 v[204:207], a[212:215], a[172:175], v[204:207]
 v_add_f32 v43, v43, v15
 v_mfma_f32_16x16x32_bf16 v[204:207], a[208:211], a[168:171], v[204:207]
 v_add_f32 v44, v44, v12
 v_mfma_f32_16x16x32_bf16 v[208:211], a[208:211], a[144:147], v[208:211]
 v_mfma_f32_16x16x32_bf16 v[208:211], a[212:215], a[148:151], v[208:211]
 v_add_f32 v45, v45, v13
 v_mfma_f32_16x16x32_bf16 v[212:215], a[212:215], a[156:159], v[212:215]
 buffer_load_dwordx4 a[212:215], v0, s[12:15], s24 offen offset:1024
 v_mfma_f32_16x16x32_bf16 v[212:215], a[208:211], a[152:155], v[212:215]
 buffer_load_dwordx4 a[208:211], v0, s[12:15], s24 offen
 s_waitcnt vmcnt(14)
 v_mfma_f32_16x16x32_bf16 v[228:231], a[216:219], a[152:155], v[228:231]
 v_mfma_f32_16x16x32_bf16 v[228:231], a[220:223], a[156:159], v[228:231]
 v_add_f32 v46, v46, v14
 v_mfma_f32_16x16x32_bf16 v[224:227], a[220:223], a[148:151], v[224:227]
 v_add_f32 v47, v47, v15
 v_mfma_f32_16x16x32_bf16 v[224:227], a[216:219], a[144:147], v[224:227]
 v_mfma_f32_16x16x32_bf16 v[220:223], a[216:219], a[168:171], v[220:223]
 s_waitcnt lgkmcnt(4)
 v_mfma_f32_16x16x32_bf16 v[220:223], a[220:223], a[172:175], v[220:223]
 v_mfma_f32_16x16x32_bf16 v[216:219], a[220:223], a[164:167], v[216:219]
 buffer_load_dwordx4 a[220:223], v0, s[12:15], s24 offen offset:3072
 v_mfma_f32_16x16x32_bf16 v[216:219], a[216:219], a[160:163], v[216:219]
 buffer_load_dwordx4 a[216:219], v0, s[12:15], s24 offen offset:2048
 s_waitcnt vmcnt(14)
 v_mfma_f32_16x16x32_bf16 v[232:235], a[224:227], a[160:163], v[232:235]
 v_add_f32 v48, v48, v8
 v_mfma_f32_16x16x32_bf16 v[232:235], a[228:231], a[164:167], v[232:235]
 s_add_u32 s24, s24, 4096
 v_mfma_f32_16x16x32_bf16 v[236:239], a[228:231], a[172:175], v[236:239]
 ds_read_b128 v[12:15], v4 offset:144
 v_mfma_f32_16x16x32_bf16 v[236:239], a[224:227], a[168:171], v[236:239]
 v_mfma_f32_16x16x32_bf16 v[240:243], a[224:227], a[144:147], v[240:243]
 v_add_f32 v49, v49, v9
 v_mfma_f32_16x16x32_bf16 v[240:243], a[228:231], a[148:151], v[240:243]
 v_mfma_f32_16x16x32_bf16 v[244:247], a[228:231], a[156:159], v[244:247]
 buffer_load_dwordx4 a[228:231], v0, s[12:15], s24 offen offset:1024
 v_mfma_f32_16x16x32_bf16 v[244:247], a[224:227], a[152:155], v[244:247]
 buffer_load_dwordx4 a[224:227], v0, s[12:15], s24 offen
 s_waitcnt vmcnt(14)
 v_mfma_f32_16x16x32_bf16 a[252:255], a[232:235], a[152:155], a[252:255]
 ds_read_b128 a[152:155], v1 offset:35840
 v_mfma_f32_16x16x32_bf16 a[252:255], a[236:239], a[156:159], a[252:255]
 ds_read_b128 a[156:159], v1 offset:39936
 v_mfma_f32_16x16x32_bf16 a[248:251], a[236:239], a[148:151], a[248:251]
 ds_read_b128 a[148:151], v1 offset:38912
 v_mfma_f32_16x16x32_bf16 a[248:251], a[232:235], a[144:147], a[248:251]
 ds_read_b128 a[144:147], v1 offset:34816
 v_mfma_f32_16x16x32_bf16 v[252:255], a[232:235], a[168:171], v[252:255]
 v_add_f32 v50, v50, v10
 v_mfma_f32_16x16x32_bf16 v[252:255], a[236:239], a[172:175], v[252:255]
 v_add_f32 v51, v51, v11
 v_mfma_f32_16x16x32_bf16 v[248:251], a[236:239], a[164:167], v[248:251]
 buffer_load_dwordx4 a[236:239], v0, s[12:15], s24 offen offset:3072
 v_mfma_f32_16x16x32_bf16 v[248:251], a[232:235], a[160:163], v[248:251]
 buffer_load_dwordx4 a[232:235], v0, s[12:15], s24 offen offset:2048
 s_waitcnt vmcnt(14) lgkmcnt(7)
 v_mfma_f32_16x16x32_bf16 v[136:139], a[176:179], a[128:131], v[136:139]
 v_mfma_f32_16x16x32_bf16 v[136:139], a[180:183], a[132:135], v[136:139]
 s_add_u32 s24, s24, 53248
 s_waitcnt lgkmcnt(5)
 v_mfma_f32_16x16x32_bf16 v[140:143], a[180:183], a[140:143], v[140:143]
 v_add_f32 v52, v52, v8
 v_mfma_f32_16x16x32_bf16 v[140:143], a[176:179], a[136:139], v[140:143]
 s_waitcnt lgkmcnt(0)
 v_mfma_f32_16x16x32_bf16 v[144:147], a[176:179], a[144:147], v[144:147]
 v_mfma_f32_16x16x32_bf16 v[144:147], a[180:183], a[148:151], v[144:147]
 v_mfma_f32_16x16x32_bf16 v[148:151], a[180:183], a[156:159], v[148:151]
 buffer_load_dwordx4 a[180:183], v0, s[12:15], s24 offen offset:1024
 v_mfma_f32_16x16x32_bf16 v[148:151], a[176:179], a[152:155], v[148:151]
 buffer_load_dwordx4 a[176:179], v0, s[12:15], s24 offen
 s_waitcnt vmcnt(14)
 v_mfma_f32_16x16x32_bf16 v[164:167], a[184:187], a[152:155], v[164:167]
 v_add_f32 v53, v53, v9
 v_mfma_f32_16x16x32_bf16 v[164:167], a[188:191], a[156:159], v[164:167]
 v_add_f32 v54, v54, v10
 v_mfma_f32_16x16x32_bf16 v[160:163], a[188:191], a[148:151], v[160:163]
 ds_read_b128 a[160:163], v1 offset:40960
 v_mfma_f32_16x16x32_bf16 v[160:163], a[184:187], a[144:147], v[160:163]
 v_mfma_f32_16x16x32_bf16 v[156:159], a[184:187], a[136:139], v[156:159]
 ds_read_b128 a[164:167], v1 offset:45056
 v_mfma_f32_16x16x32_bf16 v[156:159], a[188:191], a[140:143], v[156:159]
 v_add_f32 v55, v55, v11
 v_mfma_f32_16x16x32_bf16 v[152:155], a[188:191], a[132:135], v[152:155]
 buffer_load_dwordx4 a[188:191], v0, s[12:15], s24 offen offset:3072
 v_mfma_f32_16x16x32_bf16 v[152:155], a[184:187], a[128:131], v[152:155]
 buffer_load_dwordx4 a[184:187], v0, s[12:15], s24 offen offset:2048
 s_waitcnt vmcnt(14)
 v_mfma_f32_16x16x32_bf16 v[168:171], a[192:195], a[128:131], v[168:171]
 ds_read_b128 a[168:171], v1 offset:41984
 ds_read_b128 a[172:175], v1 offset:46080
 v_mfma_f32_16x16x32_bf16 v[168:171], a[196:199], a[132:135], v[168:171]
 s_add_u32 s24, s24, 4096
 v_mfma_f32_16x16x32_bf16 v[172:175], a[196:199], a[140:143], v[172:175]
 v_mfma_f32_16x16x32_bf16 v[172:175], a[192:195], a[136:139], v[172:175]
 v_add_f32 v56, v56, v8
 v_mfma_f32_16x16x32_bf16 v[176:179], a[192:195], a[144:147], v[176:179]
 v_add_f32 v57, v57, v9
 v_mfma_f32_16x16x32_bf16 v[176:179], a[196:199], a[148:151], v[176:179]
 v_mfma_f32_16x16x32_bf16 v[180:183], a[196:199], a[156:159], v[180:183]
 buffer_load_dwordx4 a[196:199], v0, s[12:15], s24 offen offset:1024
 v_mfma_f32_16x16x32_bf16 v[180:183], a[192:195], a[152:155], v[180:183]
 buffer_load_dwordx4 a[192:195], v0, s[12:15], s24 offen
 s_waitcnt vmcnt(14)
 v_mfma_f32_16x16x32_bf16 v[196:199], a[200:203], a[152:155], v[196:199]
 v_add_f32 v58, v58, v10
 v_mfma_f32_16x16x32_bf16 v[196:199], a[204:207], a[156:159], v[196:199]
 v_mfma_f32_16x16x32_bf16 v[192:195], a[204:207], a[148:151], v[192:195]
 v_add_f32 v59, v59, v11
 v_mfma_f32_16x16x32_bf16 v[192:195], a[200:203], a[144:147], v[192:195]
 v_add_f32 v60, v60, v8
 v_mfma_f32_16x16x32_bf16 v[188:191], a[200:203], a[136:139], v[188:191]
 v_mfma_f32_16x16x32_bf16 v[188:191], a[204:207], a[140:143], v[188:191]
 v_add_f32 v61, v61, v9
 v_mfma_f32_16x16x32_bf16 v[184:187], a[204:207], a[132:135], v[184:187]
 buffer_load_dwordx4 a[204:207], v0, s[12:15], s24 offen offset:3072
 v_mfma_f32_16x16x32_bf16 v[184:187], a[200:203], a[128:131], v[184:187]
 buffer_load_dwordx4 a[200:203], v0, s[12:15], s24 offen offset:2048
 s_waitcnt vmcnt(14)
 v_mfma_f32_16x16x32_bf16 v[200:203], a[208:211], a[128:131], v[200:203]
 v_mfma_f32_16x16x32_bf16 v[200:203], a[212:215], a[132:135], v[200:203]
 s_add_u32 s24, s24, 4096
 v_mfma_f32_16x16x32_bf16 v[204:207], a[212:215], a[140:143], v[204:207]
 v_add_f32 v62, v62, v10
 v_mfma_f32_16x16x32_bf16 v[204:207], a[208:211], a[136:139], v[204:207]
 v_add_f32 v63, v63, v11
 v_mfma_f32_16x16x32_bf16 v[208:211], a[208:211], a[144:147], v[208:211]
 v_mfma_f32_16x16x32_bf16 v[208:211], a[212:215], a[148:151], v[208:211]
 v_mfma_f32_16x16x32_bf16 v[212:215], a[212:215], a[156:159], v[212:215]
 buffer_load_dwordx4 a[212:215], v0, s[12:15], s24 offen offset:1024
 v_mfma_f32_16x16x32_bf16 v[212:215], a[208:211], a[152:155], v[212:215]
 buffer_load_dwordx4 a[208:211], v0, s[12:15], s24 offen
 s_waitcnt vmcnt(14)
 v_mfma_f32_16x16x32_bf16 v[228:231], a[216:219], a[152:155], v[228:231]
 v_mfma_f32_16x16x32_bf16 v[228:231], a[220:223], a[156:159], v[228:231]
 v_add_f32 v64, v64, v12
 v_mfma_f32_16x16x32_bf16 v[224:227], a[220:223], a[148:151], v[224:227]
 ds_read_b128 v[8:11], v4 offset:256
 v_mfma_f32_16x16x32_bf16 v[224:227], a[216:219], a[144:147], v[224:227]
 v_mfma_f32_16x16x32_bf16 v[220:223], a[216:219], a[136:139], v[220:223]
 v_add_f32 v65, v65, v13
 v_mfma_f32_16x16x32_bf16 v[220:223], a[220:223], a[140:143], v[220:223]
 v_mfma_f32_16x16x32_bf16 v[216:219], a[220:223], a[132:135], v[216:219]
 buffer_load_dwordx4 a[220:223], v0, s[12:15], s24 offen offset:3072
 v_mfma_f32_16x16x32_bf16 v[216:219], a[216:219], a[128:131], v[216:219]
 buffer_load_dwordx4 a[216:219], v0, s[12:15], s24 offen offset:2048
 s_waitcnt vmcnt(14)
 v_mfma_f32_16x16x32_bf16 v[232:235], a[224:227], a[128:131], v[232:235]
 v_add_f32 v66, v66, v14
 v_mfma_f32_16x16x32_bf16 v[232:235], a[228:231], a[132:135], v[232:235]
 s_add_u32 s24, s24, 4096
 v_mfma_f32_16x16x32_bf16 v[236:239], a[228:231], a[140:143], v[236:239]
 v_add_f32 v67, v67, v15
 v_mfma_f32_16x16x32_bf16 v[236:239], a[224:227], a[136:139], v[236:239]
 v_mfma_f32_16x16x32_bf16 v[240:243], a[224:227], a[144:147], v[240:243]
 v_add_f32 v68, v68, v12
 v_mfma_f32_16x16x32_bf16 v[240:243], a[228:231], a[148:151], v[240:243]
 v_mfma_f32_16x16x32_bf16 v[244:247], a[228:231], a[156:159], v[244:247]
 buffer_load_dwordx4 a[228:231], v0, s[12:15], s24 offen offset:1024
 v_mfma_f32_16x16x32_bf16 v[244:247], a[224:227], a[152:155], v[244:247]
 buffer_load_dwordx4 a[224:227], v0, s[12:15], s24 offen
 s_waitcnt vmcnt(14)
 v_mfma_f32_16x16x32_bf16 a[252:255], a[232:235], a[152:155], a[252:255]
 ds_read_b128 a[152:155], v1 offset:44032
 v_mfma_f32_16x16x32_bf16 a[252:255], a[236:239], a[156:159], a[252:255]
 ds_read_b128 a[156:159], v1 offset:48128
 v_mfma_f32_16x16x32_bf16 a[248:251], a[236:239], a[148:151], a[248:251]
 ds_read_b128 a[148:151], v1 offset:47104
 v_mfma_f32_16x16x32_bf16 a[248:251], a[232:235], a[144:147], a[248:251]
 ds_read_b128 a[144:147], v1 offset:43008
 v_mfma_f32_16x16x32_bf16 v[252:255], a[232:235], a[136:139], v[252:255]
 v_add_f32 v69, v69, v13
 v_mfma_f32_16x16x32_bf16 v[252:255], a[236:239], a[140:143], v[252:255]
 v_add_f32 v70, v70, v14
 v_mfma_f32_16x16x32_bf16 v[248:251], a[236:239], a[132:135], v[248:251]
 buffer_load_dwordx4 a[236:239], v0, s[12:15], s24 offen offset:3072
 v_mfma_f32_16x16x32_bf16 v[248:251], a[232:235], a[128:131], v[248:251]
 buffer_load_dwordx4 a[232:235], v0, s[12:15], s24 offen offset:2048
 s_waitcnt vmcnt(14) lgkmcnt(7)
 v_mfma_f32_16x16x32_bf16 v[136:139], a[176:179], a[160:163], v[136:139]
 v_mfma_f32_16x16x32_bf16 v[136:139], a[180:183], a[164:167], v[136:139]
 s_add_u32 s24, s24, 53248
 s_waitcnt lgkmcnt(5)
 v_mfma_f32_16x16x32_bf16 v[140:143], a[180:183], a[172:175], v[140:143]
 v_add_f32 v71, v71, v15
 v_mfma_f32_16x16x32_bf16 v[140:143], a[176:179], a[168:171], v[140:143]
 s_waitcnt lgkmcnt(0)
 v_mfma_f32_16x16x32_bf16 v[144:147], a[176:179], a[144:147], v[144:147]
 v_mfma_f32_16x16x32_bf16 v[144:147], a[180:183], a[148:151], v[144:147]
 v_mfma_f32_16x16x32_bf16 v[148:151], a[180:183], a[156:159], v[148:151]
 buffer_load_dwordx4 a[180:183], v0, s[12:15], s24 offen offset:1024
 v_mfma_f32_16x16x32_bf16 v[148:151], a[176:179], a[152:155], v[148:151]
 buffer_load_dwordx4 a[176:179], v0, s[12:15], s24 offen
 s_waitcnt vmcnt(14)
 v_mfma_f32_16x16x32_bf16 v[164:167], a[184:187], a[152:155], v[164:167]
 v_add_f32 v72, v72, v12
 v_mfma_f32_16x16x32_bf16 v[164:167], a[188:191], a[156:159], v[164:167]
 v_add_f32 v73, v73, v13
 v_mfma_f32_16x16x32_bf16 v[160:163], a[188:191], a[148:151], v[160:163]
 ds_read_b128 a[128:131], v2
 v_mfma_f32_16x16x32_bf16 v[160:163], a[184:187], a[144:147], v[160:163]
 v_mfma_f32_16x16x32_bf16 v[156:159], a[184:187], a[168:171], v[156:159]
 ds_read_b128 a[132:135], v2 offset:4096
 v_mfma_f32_16x16x32_bf16 v[156:159], a[188:191], a[172:175], v[156:159]
 v_add_f32 v74, v74, v14
 v_mfma_f32_16x16x32_bf16 v[152:155], a[188:191], a[164:167], v[152:155]
 buffer_load_dwordx4 a[188:191], v0, s[12:15], s24 offen offset:3072
 v_mfma_f32_16x16x32_bf16 v[152:155], a[184:187], a[160:163], v[152:155]
 buffer_load_dwordx4 a[184:187], v0, s[12:15], s24 offen offset:2048
 s_waitcnt vmcnt(14)
 v_mfma_f32_16x16x32_bf16 v[168:171], a[192:195], a[160:163], v[168:171]
 ds_read_b128 a[136:139], v2 offset:1024
 ds_read_b128 a[140:143], v2 offset:5120
 v_mfma_f32_16x16x32_bf16 v[168:171], a[196:199], a[164:167], v[168:171]
 s_add_u32 s24, s24, 4096
 v_mfma_f32_16x16x32_bf16 v[172:175], a[196:199], a[172:175], v[172:175]
 v_mfma_f32_16x16x32_bf16 v[172:175], a[192:195], a[168:171], v[172:175]
 v_add_f32 v75, v75, v15
 v_mfma_f32_16x16x32_bf16 v[176:179], a[192:195], a[144:147], v[176:179]
 v_add_f32 v76, v76, v12
 v_mfma_f32_16x16x32_bf16 v[176:179], a[196:199], a[148:151], v[176:179]
 v_mfma_f32_16x16x32_bf16 v[180:183], a[196:199], a[156:159], v[180:183]
 buffer_load_dwordx4 a[196:199], v0, s[12:15], s24 offen offset:1024
 v_mfma_f32_16x16x32_bf16 v[180:183], a[192:195], a[152:155], v[180:183]
 buffer_load_dwordx4 a[192:195], v0, s[12:15], s24 offen
 s_waitcnt vmcnt(14)
 v_mfma_f32_16x16x32_bf16 v[196:199], a[200:203], a[152:155], v[196:199]
 v_add_f32 v77, v77, v13
 v_mfma_f32_16x16x32_bf16 v[196:199], a[204:207], a[156:159], v[196:199]
 v_mfma_f32_16x16x32_bf16 v[192:195], a[204:207], a[148:151], v[192:195]
 v_add_f32 v78, v78, v14
 v_mfma_f32_16x16x32_bf16 v[192:195], a[200:203], a[144:147], v[192:195]
 v_add_f32 v79, v79, v15
 v_mfma_f32_16x16x32_bf16 v[188:191], a[200:203], a[168:171], v[188:191]
 v_mfma_f32_16x16x32_bf16 v[188:191], a[204:207], a[172:175], v[188:191]
 v_mfma_f32_16x16x32_bf16 v[184:187], a[204:207], a[164:167], v[184:187]
 buffer_load_dwordx4 a[204:207], v0, s[12:15], s24 offen offset:3072
 v_mfma_f32_16x16x32_bf16 v[184:187], a[200:203], a[160:163], v[184:187]
 buffer_load_dwordx4 a[200:203], v0, s[12:15], s24 offen offset:2048
 s_waitcnt vmcnt(14)
 v_mfma_f32_16x16x32_bf16 v[200:203], a[208:211], a[160:163], v[200:203]
 v_mfma_f32_16x16x32_bf16 v[200:203], a[212:215], a[164:167], v[200:203]
 s_add_u32 s24, s24, 4096
 v_mfma_f32_16x16x32_bf16 v[204:207], a[212:215], a[172:175], v[204:207]
 v_add_f32 v80, v80, v8
 v_mfma_f32_16x16x32_bf16 v[204:207], a[208:211], a[168:171], v[204:207]
 ds_read_b128 v[12:15], v4 offset:272
 v_mfma_f32_16x16x32_bf16 v[208:211], a[208:211], a[144:147], v[208:211]
 v_mfma_f32_16x16x32_bf16 v[208:211], a[212:215], a[148:151], v[208:211]
 v_add_f32 v81, v81, v9
 v_mfma_f32_16x16x32_bf16 v[212:215], a[212:215], a[156:159], v[212:215]
 buffer_load_dwordx4 a[212:215], v0, s[12:15], s24 offen offset:1024
 v_mfma_f32_16x16x32_bf16 v[212:215], a[208:211], a[152:155], v[212:215]
 buffer_load_dwordx4 a[208:211], v0, s[12:15], s24 offen
 s_waitcnt vmcnt(14)
 v_mfma_f32_16x16x32_bf16 v[228:231], a[216:219], a[152:155], v[228:231]
 v_mfma_f32_16x16x32_bf16 v[228:231], a[220:223], a[156:159], v[228:231]
 v_add_f32 v82, v82, v10
 v_mfma_f32_16x16x32_bf16 v[224:227], a[220:223], a[148:151], v[224:227]
 v_add_f32 v83, v83, v11
 v_mfma_f32_16x16x32_bf16 v[224:227], a[216:219], a[144:147], v[224:227]
 v_mfma_f32_16x16x32_bf16 v[220:223], a[216:219], a[168:171], v[220:223]
 v_add_f32 v84, v84, v8
 v_mfma_f32_16x16x32_bf16 v[220:223], a[220:223], a[172:175], v[220:223]
 v_mfma_f32_16x16x32_bf16 v[216:219], a[220:223], a[164:167], v[216:219]
 buffer_load_dwordx4 a[220:223], v0, s[12:15], s24 offen offset:3072
 v_mfma_f32_16x16x32_bf16 v[216:219], a[216:219], a[160:163], v[216:219]
 buffer_load_dwordx4 a[216:219], v0, s[12:15], s24 offen offset:2048
 s_waitcnt vmcnt(14)
 v_mfma_f32_16x16x32_bf16 v[232:235], a[224:227], a[160:163], v[232:235]
 v_add_f32 v85, v85, v9
 v_mfma_f32_16x16x32_bf16 v[232:235], a[228:231], a[164:167], v[232:235]
 s_add_u32 s24, s24, 4096
 v_mfma_f32_16x16x32_bf16 v[236:239], a[228:231], a[172:175], v[236:239]
 v_add_f32 v86, v86, v10
 v_mfma_f32_16x16x32_bf16 v[236:239], a[224:227], a[168:171], v[236:239]
 v_mfma_f32_16x16x32_bf16 v[240:243], a[224:227], a[144:147], v[240:243]
 v_add_f32 v87, v87, v11
 v_mfma_f32_16x16x32_bf16 v[240:243], a[228:231], a[148:151], v[240:243]
 v_add_f32 v88, v88, v8
 v_mfma_f32_16x16x32_bf16 v[244:247], a[228:231], a[156:159], v[244:247]
 buffer_load_dwordx4 a[228:231], v0, s[12:15], s24 offen offset:1024
 v_mfma_f32_16x16x32_bf16 v[244:247], a[224:227], a[152:155], v[244:247]
 buffer_load_dwordx4 a[224:227], v0, s[12:15], s24 offen
 s_waitcnt vmcnt(14)
 v_mfma_f32_16x16x32_bf16 a[252:255], a[232:235], a[152:155], a[252:255]
 ds_read_b128 a[152:155], v2 offset:3072
 v_mfma_f32_16x16x32_bf16 a[252:255], a[236:239], a[156:159], a[252:255]
 ds_read_b128 a[156:159], v2 offset:7168
 v_mfma_f32_16x16x32_bf16 a[248:251], a[236:239], a[148:151], a[248:251]
 ds_read_b128 a[148:151], v2 offset:6144
 v_mfma_f32_16x16x32_bf16 a[248:251], a[232:235], a[144:147], a[248:251]
 ds_read_b128 a[144:147], v2 offset:2048
 v_mfma_f32_16x16x32_bf16 v[252:255], a[232:235], a[168:171], v[252:255]
 v_mfma_f32_16x16x32_bf16 v[252:255], a[236:239], a[172:175], v[252:255]
 v_add_f32 v89, v89, v9
 v_mfma_f32_16x16x32_bf16 v[248:251], a[236:239], a[164:167], v[248:251]
 buffer_load_dwordx4 a[236:239], v0, s[12:15], s24 offen offset:3072
 v_mfma_f32_16x16x32_bf16 v[248:251], a[232:235], a[160:163], v[248:251]
 buffer_load_dwordx4 a[232:235], v0, s[12:15], s24 offen offset:2048
 s_waitcnt vmcnt(14) lgkmcnt(7)
 v_mfma_f32_16x16x32_bf16 v[136:139], a[176:179], a[128:131], v[136:139]
 v_mfma_f32_16x16x32_bf16 v[136:139], a[180:183], a[132:135], v[136:139]
 s_add_u32 s24, s24, 53248
 s_waitcnt lgkmcnt(5)
 v_mfma_f32_16x16x32_bf16 v[140:143], a[180:183], a[140:143], v[140:143]
 v_add_f32 v90, v90, v10
 v_mfma_f32_16x16x32_bf16 v[140:143], a[176:179], a[136:139], v[140:143]
 s_waitcnt lgkmcnt(0)
 v_mfma_f32_16x16x32_bf16 v[144:147], a[176:179], a[144:147], v[144:147]
 v_add_f32 v91, v91, v11
 v_mfma_f32_16x16x32_bf16 v[144:147], a[180:183], a[148:151], v[144:147]
 v_mfma_f32_16x16x32_bf16 v[148:151], a[180:183], a[156:159], v[148:151]
 buffer_load_dwordx4 a[180:183], v0, s[12:15], s24 offen offset:1024
 v_mfma_f32_16x16x32_bf16 v[148:151], a[176:179], a[152:155], v[148:151]
 buffer_load_dwordx4 a[176:179], v0, s[12:15], s24 offen
 s_waitcnt vmcnt(14)
 v_mfma_f32_16x16x32_bf16 v[164:167], a[184:187], a[152:155], v[164:167]
 v_mfma_f32_16x16x32_bf16 v[164:167], a[188:191], a[156:159], v[164:167]
 v_add_f32 v92, v92, v8
 v_mfma_f32_16x16x32_bf16 v[160:163], a[188:191], a[148:151], v[160:163]
 ds_read_b128 a[160:163], v2 offset:8192
 v_mfma_f32_16x16x32_bf16 v[160:163], a[184:187], a[144:147], v[160:163]
 v_mfma_f32_16x16x32_bf16 v[156:159], a[184:187], a[136:139], v[156:159]
 ds_read_b128 a[164:167], v2 offset:12288
 v_mfma_f32_16x16x32_bf16 v[156:159], a[188:191], a[140:143], v[156:159]
 v_add_f32 v93, v93, v9
 v_mfma_f32_16x16x32_bf16 v[152:155], a[188:191], a[132:135], v[152:155]
 buffer_load_dwordx4 a[188:191], v0, s[12:15], s24 offen offset:3072
 v_mfma_f32_16x16x32_bf16 v[152:155], a[184:187], a[128:131], v[152:155]
 buffer_load_dwordx4 a[184:187], v0, s[12:15], s24 offen offset:2048
 s_waitcnt vmcnt(14)
 v_mfma_f32_16x16x32_bf16 v[168:171], a[192:195], a[128:131], v[168:171]
 ds_read_b128 a[168:171], v2 offset:9216
 ds_read_b128 a[172:175], v2 offset:13312
 v_mfma_f32_16x16x32_bf16 v[168:171], a[196:199], a[132:135], v[168:171]
 s_add_u32 s24, s24, 4096
 v_mfma_f32_16x16x32_bf16 v[172:175], a[196:199], a[140:143], v[172:175]
 v_add_f32 v94, v94, v10
 v_mfma_f32_16x16x32_bf16 v[172:175], a[192:195], a[136:139], v[172:175]
 v_mfma_f32_16x16x32_bf16 v[176:179], a[192:195], a[144:147], v[176:179]
 v_add_f32 v95, v95, v11
 v_mfma_f32_16x16x32_bf16 v[176:179], a[196:199], a[148:151], v[176:179]
 v_mfma_f32_16x16x32_bf16 v[180:183], a[196:199], a[156:159], v[180:183]
 buffer_load_dwordx4 a[196:199], v0, s[12:15], s24 offen offset:1024
 v_mfma_f32_16x16x32_bf16 v[180:183], a[192:195], a[152:155], v[180:183]
 buffer_load_dwordx4 a[192:195], v0, s[12:15], s24 offen
 s_waitcnt vmcnt(14)
 v_mfma_f32_16x16x32_bf16 v[196:199], a[200:203], a[152:155], v[196:199]
 v_mfma_f32_16x16x32_bf16 v[196:199], a[204:207], a[156:159], v[196:199]
 v_add_f32 v96, v96, v12
 v_mfma_f32_16x16x32_bf16 v[192:195], a[204:207], a[148:151], v[192:195]
 v_mfma_f32_16x16x32_bf16 v[192:195], a[200:203], a[144:147], v[192:195]
 ds_read_b128 v[8:11], v4 offset:384
 v_mfma_f32_16x16x32_bf16 v[188:191], a[200:203], a[136:139], v[188:191]
 v_mfma_f32_16x16x32_bf16 v[188:191], a[204:207], a[140:143], v[188:191]
 v_add_f32 v97, v97, v13
 v_mfma_f32_16x16x32_bf16 v[184:187], a[204:207], a[132:135], v[184:187]
 buffer_load_dwordx4 a[204:207], v0, s[12:15], s24 offen offset:3072
 v_mfma_f32_16x16x32_bf16 v[184:187], a[200:203], a[128:131], v[184:187]
 buffer_load_dwordx4 a[200:203], v0, s[12:15], s24 offen offset:2048
 s_waitcnt vmcnt(14)
 v_mfma_f32_16x16x32_bf16 v[200:203], a[208:211], a[128:131], v[200:203]
 v_add_f32 v98, v98, v14
 v_mfma_f32_16x16x32_bf16 v[200:203], a[212:215], a[132:135], v[200:203]
 s_add_u32 s24, s24, 4096
 v_mfma_f32_16x16x32_bf16 v[204:207], a[212:215], a[140:143], v[204:207]
 v_mfma_f32_16x16x32_bf16 v[204:207], a[208:211], a[136:139], v[204:207]
 v_add_f32 v99, v99, v15
 v_mfma_f32_16x16x32_bf16 v[208:211], a[208:211], a[144:147], v[208:211]
 v_mfma_f32_16x16x32_bf16 v[208:211], a[212:215], a[148:151], v[208:211]
 v_add_f32 v100, v100, v12
 v_mfma_f32_16x16x32_bf16 v[212:215], a[212:215], a[156:159], v[212:215]
 buffer_load_dwordx4 a[212:215], v0, s[12:15], s24 offen offset:1024
 v_mfma_f32_16x16x32_bf16 v[212:215], a[208:211], a[152:155], v[212:215]
 buffer_load_dwordx4 a[208:211], v0, s[12:15], s24 offen
 s_waitcnt vmcnt(14)
 v_mfma_f32_16x16x32_bf16 v[228:231], a[216:219], a[152:155], v[228:231]
 v_add_f32 v101, v101, v13
 v_mfma_f32_16x16x32_bf16 v[228:231], a[220:223], a[156:159], v[228:231]
 v_mfma_f32_16x16x32_bf16 v[224:227], a[220:223], a[148:151], v[224:227]
 v_add_f32 v102, v102, v14
 v_mfma_f32_16x16x32_bf16 v[224:227], a[216:219], a[144:147], v[224:227]
 v_mfma_f32_16x16x32_bf16 v[220:223], a[216:219], a[136:139], v[220:223]
 v_add_f32 v103, v103, v15
 v_mfma_f32_16x16x32_bf16 v[220:223], a[220:223], a[140:143], v[220:223]
 v_add_f32 v104, v104, v12
 v_mfma_f32_16x16x32_bf16 v[216:219], a[220:223], a[132:135], v[216:219]
 buffer_load_dwordx4 a[220:223], v0, s[12:15], s24 offen offset:3072
 v_mfma_f32_16x16x32_bf16 v[216:219], a[216:219], a[128:131], v[216:219]
 buffer_load_dwordx4 a[216:219], v0, s[12:15], s24 offen offset:2048
 s_waitcnt vmcnt(14)
 v_mfma_f32_16x16x32_bf16 v[232:235], a[224:227], a[128:131], v[232:235]
 v_mfma_f32_16x16x32_bf16 v[232:235], a[228:231], a[132:135], v[232:235]
 s_add_u32 s24, s24, 4096
 v_mfma_f32_16x16x32_bf16 v[236:239], a[228:231], a[140:143], v[236:239]
 v_add_f32 v105, v105, v13
 v_mfma_f32_16x16x32_bf16 v[236:239], a[224:227], a[136:139], v[236:239]
 v_mfma_f32_16x16x32_bf16 v[240:243], a[224:227], a[144:147], v[240:243]
 v_add_f32 v106, v106, v14
 v_mfma_f32_16x16x32_bf16 v[240:243], a[228:231], a[148:151], v[240:243]
 v_add_f32 v107, v107, v15
 v_mfma_f32_16x16x32_bf16 v[244:247], a[228:231], a[156:159], v[244:247]
 buffer_load_dwordx4 a[228:231], v0, s[12:15], s24 offen offset:1024
 v_mfma_f32_16x16x32_bf16 v[244:247], a[224:227], a[152:155], v[244:247]
 buffer_load_dwordx4 a[224:227], v0, s[12:15], s24 offen
 s_waitcnt vmcnt(14)
 v_mfma_f32_16x16x32_bf16 a[252:255], a[232:235], a[152:155], a[252:255]
 ds_read_b128 a[152:155], v2 offset:11264
 v_mfma_f32_16x16x32_bf16 a[252:255], a[236:239], a[156:159], a[252:255]
 ds_read_b128 a[156:159], v2 offset:15360
 v_mfma_f32_16x16x32_bf16 a[248:251], a[236:239], a[148:151], a[248:251]
 ds_read_b128 a[148:151], v2 offset:14336
 v_mfma_f32_16x16x32_bf16 a[248:251], a[232:235], a[144:147], a[248:251]
 ds_read_b128 a[144:147], v2 offset:10240
 v_mfma_f32_16x16x32_bf16 v[252:255], a[232:235], a[136:139], v[252:255]
 v_mfma_f32_16x16x32_bf16 v[252:255], a[236:239], a[140:143], v[252:255]
 v_add_f32 v108, v108, v12
 v_mfma_f32_16x16x32_bf16 v[248:251], a[236:239], a[132:135], v[248:251]
 buffer_load_dwordx4 a[236:239], v0, s[12:15], s24 offen offset:3072
 v_mfma_f32_16x16x32_bf16 v[248:251], a[232:235], a[128:131], v[248:251]
 buffer_load_dwordx4 a[232:235], v0, s[12:15], s24 offen offset:2048
 s_waitcnt vmcnt(14) lgkmcnt(7)
 v_mfma_f32_16x16x32_bf16 v[136:139], a[176:179], a[160:163], v[136:139]
 v_mfma_f32_16x16x32_bf16 v[136:139], a[180:183], a[164:167], v[136:139]
 s_add_u32 s24, s24, 53248
 s_waitcnt lgkmcnt(5)
 v_mfma_f32_16x16x32_bf16 v[140:143], a[180:183], a[172:175], v[140:143]
 v_add_f32 v109, v109, v13
 v_mfma_f32_16x16x32_bf16 v[140:143], a[176:179], a[168:171], v[140:143]
 s_waitcnt lgkmcnt(0)
 v_mfma_f32_16x16x32_bf16 v[144:147], a[176:179], a[144:147], v[144:147]
 v_add_f32 v110, v110, v14
 v_mfma_f32_16x16x32_bf16 v[144:147], a[180:183], a[148:151], v[144:147]
 v_mfma_f32_16x16x32_bf16 v[148:151], a[180:183], a[156:159], v[148:151]
 buffer_load_dwordx4 a[180:183], v0, s[12:15], s24 offen offset:1024
 v_mfma_f32_16x16x32_bf16 v[148:151], a[176:179], a[152:155], v[148:151]
 buffer_load_dwordx4 a[176:179], v0, s[12:15], s24 offen
 s_waitcnt vmcnt(14)
 v_mfma_f32_16x16x32_bf16 v[164:167], a[184:187], a[152:155], v[164:167]
 v_mfma_f32_16x16x32_bf16 v[164:167], a[188:191], a[156:159], v[164:167]
 v_add_f32 v111, v111, v15
 v_mfma_f32_16x16x32_bf16 v[160:163], a[188:191], a[148:151], v[160:163]
 ds_read_b128 a[128:131], v2 offset:32768
 v_mfma_f32_16x16x32_bf16 v[160:163], a[184:187], a[144:147], v[160:163]
 v_mfma_f32_16x16x32_bf16 v[156:159], a[184:187], a[168:171], v[156:159]
 ds_read_b128 a[132:135], v2 offset:36864
 v_mfma_f32_16x16x32_bf16 v[156:159], a[188:191], a[172:175], v[156:159]
 v_mfma_f32_16x16x32_bf16 v[152:155], a[188:191], a[164:167], v[152:155]
 buffer_load_dwordx4 a[188:191], v0, s[12:15], s24 offen offset:3072
 v_mfma_f32_16x16x32_bf16 v[152:155], a[184:187], a[160:163], v[152:155]
 buffer_load_dwordx4 a[184:187], v0, s[12:15], s24 offen offset:2048
 s_waitcnt vmcnt(14)
 v_mfma_f32_16x16x32_bf16 v[168:171], a[192:195], a[160:163], v[168:171]
 ds_read_b128 a[136:139], v2 offset:33792
 ds_read_b128 a[140:143], v2 offset:37888
 v_mfma_f32_16x16x32_bf16 v[168:171], a[196:199], a[164:167], v[168:171]
 s_add_u32 s24, s24, 4096
 v_mfma_f32_16x16x32_bf16 v[172:175], a[196:199], a[172:175], v[172:175]
 v_add_f32 v112, v112, v8
 v_mfma_f32_16x16x32_bf16 v[172:175], a[192:195], a[168:171], v[172:175]
 v_mfma_f32_16x16x32_bf16 v[176:179], a[192:195], a[144:147], v[176:179]
 ds_read_b128 v[12:15], v4 offset:400
 v_mfma_f32_16x16x32_bf16 v[176:179], a[196:199], a[148:151], v[176:179]
 v_mfma_f32_16x16x32_bf16 v[180:183], a[196:199], a[156:159], v[180:183]
 buffer_load_dwordx4 a[196:199], v0, s[12:15], s24 offen offset:1024
 v_mfma_f32_16x16x32_bf16 v[180:183], a[192:195], a[152:155], v[180:183]
 buffer_load_dwordx4 a[192:195], v0, s[12:15], s24 offen
 s_waitcnt vmcnt(14)
 v_mfma_f32_16x16x32_bf16 v[196:199], a[200:203], a[152:155], v[196:199]
 v_add_f32 v113, v113, v9
 v_mfma_f32_16x16x32_bf16 v[196:199], a[204:207], a[156:159], v[196:199]
 v_add_f32 v114, v114, v10
 v_mfma_f32_16x16x32_bf16 v[192:195], a[204:207], a[148:151], v[192:195]
 v_mfma_f32_16x16x32_bf16 v[192:195], a[200:203], a[144:147], v[192:195]
 v_add_f32 v115, v115, v11
 v_mfma_f32_16x16x32_bf16 v[188:191], a[200:203], a[168:171], v[188:191]
 v_mfma_f32_16x16x32_bf16 v[188:191], a[204:207], a[172:175], v[188:191]
 v_add_f32 v116, v116, v8
 v_mfma_f32_16x16x32_bf16 v[184:187], a[204:207], a[164:167], v[184:187]
 buffer_load_dwordx4 a[204:207], v0, s[12:15], s24 offen offset:3072
 v_mfma_f32_16x16x32_bf16 v[184:187], a[200:203], a[160:163], v[184:187]
 buffer_load_dwordx4 a[200:203], v0, s[12:15], s24 offen offset:2048
 s_waitcnt vmcnt(14)
 v_mfma_f32_16x16x32_bf16 v[200:203], a[208:211], a[160:163], v[200:203]
 v_add_f32 v117, v117, v9
 v_mfma_f32_16x16x32_bf16 v[200:203], a[212:215], a[164:167], v[200:203]
 s_add_u32 s24, s24, 4096
 v_mfma_f32_16x16x32_bf16 v[204:207], a[212:215], a[172:175], v[204:207]
 v_mfma_f32_16x16x32_bf16 v[204:207], a[208:211], a[168:171], v[204:207]
 v_add_f32 v118, v118, v10
 v_mfma_f32_16x16x32_bf16 v[208:211], a[208:211], a[144:147], v[208:211]
 v_mfma_f32_16x16x32_bf16 v[208:211], a[212:215], a[148:151], v[208:211]
 v_add_f32 v119, v119, v11
 v_mfma_f32_16x16x32_bf16 v[212:215], a[212:215], a[156:159], v[212:215]
 buffer_load_dwordx4 a[212:215], v0, s[12:15], s24 offen offset:1024
 v_mfma_f32_16x16x32_bf16 v[212:215], a[208:211], a[152:155], v[212:215]
 buffer_load_dwordx4 a[208:211], v0, s[12:15], s24 offen
 s_waitcnt vmcnt(14)
 v_mfma_f32_16x16x32_bf16 v[228:231], a[216:219], a[152:155], v[228:231]
 v_add_f32 v120, v120, v8
 v_mfma_f32_16x16x32_bf16 v[228:231], a[220:223], a[156:159], v[228:231]
 v_mfma_f32_16x16x32_bf16 v[224:227], a[220:223], a[148:151], v[224:227]
 v_add_f32 v121, v121, v9
 v_mfma_f32_16x16x32_bf16 v[224:227], a[216:219], a[144:147], v[224:227]
 v_mfma_f32_16x16x32_bf16 v[220:223], a[216:219], a[168:171], v[220:223]
 v_add_f32 v122, v122, v10
 v_mfma_f32_16x16x32_bf16 v[220:223], a[220:223], a[172:175], v[220:223]
 v_add_f32 v123, v123, v11
 v_mfma_f32_16x16x32_bf16 v[216:219], a[220:223], a[164:167], v[216:219]
 buffer_load_dwordx4 a[220:223], v0, s[12:15], s24 offen offset:3072
 v_mfma_f32_16x16x32_bf16 v[216:219], a[216:219], a[160:163], v[216:219]
 buffer_load_dwordx4 a[216:219], v0, s[12:15], s24 offen offset:2048
 s_waitcnt vmcnt(14)
 v_mfma_f32_16x16x32_bf16 v[232:235], a[224:227], a[160:163], v[232:235]
 v_mfma_f32_16x16x32_bf16 v[232:235], a[228:231], a[164:167], v[232:235]
 s_add_u32 s24, s24, 4096
 v_mfma_f32_16x16x32_bf16 v[236:239], a[228:231], a[172:175], v[236:239]
 v_add_f32 v124, v124, v8
 v_mfma_f32_16x16x32_bf16 v[236:239], a[224:227], a[168:171], v[236:239]
 v_mfma_f32_16x16x32_bf16 v[240:243], a[224:227], a[144:147], v[240:243]
 v_add_f32 v125, v125, v9
 v_mfma_f32_16x16x32_bf16 v[240:243], a[228:231], a[148:151], v[240:243]
 v_add_f32 v126, v126, v10
 v_mfma_f32_16x16x32_bf16 v[244:247], a[228:231], a[156:159], v[244:247]
 buffer_load_dwordx4 a[228:231], v0, s[12:15], s24 offen offset:1024
 v_mfma_f32_16x16x32_bf16 v[244:247], a[224:227], a[152:155], v[244:247]
 buffer_load_dwordx4 a[224:227], v0, s[12:15], s24 offen
 s_waitcnt vmcnt(14)
 v_mfma_f32_16x16x32_bf16 a[252:255], a[232:235], a[152:155], a[252:255]
 ds_read_b128 a[152:155], v2 offset:35840
 v_mfma_f32_16x16x32_bf16 a[252:255], a[236:239], a[156:159], a[252:255]
 ds_read_b128 a[156:159], v2 offset:39936
 v_mfma_f32_16x16x32_bf16 a[248:251], a[236:239], a[148:151], a[248:251]
 ds_read_b128 a[148:151], v2 offset:38912
 v_mfma_f32_16x16x32_bf16 a[248:251], a[232:235], a[144:147], a[248:251]
 ds_read_b128 a[144:147], v2 offset:34816
 v_mfma_f32_16x16x32_bf16 v[252:255], a[232:235], a[168:171], v[252:255]
 v_mfma_f32_16x16x32_bf16 v[252:255], a[236:239], a[172:175], v[252:255]
 v_add_f32 v127, v127, v11
 v_mfma_f32_16x16x32_bf16 v[248:251], a[236:239], a[164:167], v[248:251]
 buffer_load_dwordx4 a[236:239], v0, s[12:15], s24 offen offset:3072
 v_mfma_f32_16x16x32_bf16 v[248:251], a[232:235], a[160:163], v[248:251]
 buffer_load_dwordx4 a[232:235], v0, s[12:15], s24 offen offset:2048
 s_waitcnt vmcnt(14) lgkmcnt(7)
 v_mfma_f32_16x16x32_bf16 v[136:139], a[176:179], a[128:131], v[136:139]
 v_mfma_f32_16x16x32_bf16 v[136:139], a[180:183], a[132:135], v[136:139]
 s_add_u32 s24, s24, 53248
 s_waitcnt lgkmcnt(5)
 v_mfma_f32_16x16x32_bf16 v[140:143], a[180:183], a[140:143], v[140:143]
 s_waitcnt lgkmcnt(4)
 v_mfma_f32_16x16x32_bf16 v[140:143], a[176:179], a[136:139], v[140:143]
 s_waitcnt lgkmcnt(0)
 v_mfma_f32_16x16x32_bf16 v[144:147], a[176:179], a[144:147], v[144:147]
 v_add_f32 v128, v128, v12
 v_mfma_f32_16x16x32_bf16 v[144:147], a[180:183], a[148:151], v[144:147]
 v_mfma_f32_16x16x32_bf16 v[148:151], a[180:183], a[156:159], v[148:151]
 buffer_load_dwordx4 a[180:183], v0, s[12:15], s24 offen offset:1024
 v_mfma_f32_16x16x32_bf16 v[148:151], a[176:179], a[152:155], v[148:151]
 buffer_load_dwordx4 a[176:179], v0, s[12:15], s24 offen
 s_waitcnt vmcnt(14)
 v_mfma_f32_16x16x32_bf16 v[164:167], a[184:187], a[152:155], v[164:167]
 v_mfma_f32_16x16x32_bf16 v[164:167], a[188:191], a[156:159], v[164:167]
 v_add_f32 v129, v129, v13
 v_mfma_f32_16x16x32_bf16 v[160:163], a[188:191], a[148:151], v[160:163]
 ds_read_b128 a[160:163], v2 offset:40960
 v_mfma_f32_16x16x32_bf16 v[160:163], a[184:187], a[144:147], v[160:163]
 v_mfma_f32_16x16x32_bf16 v[156:159], a[184:187], a[136:139], v[156:159]
 ds_read_b128 a[164:167], v2 offset:45056
 v_mfma_f32_16x16x32_bf16 v[156:159], a[188:191], a[140:143], v[156:159]
 v_add_f32 v130, v130, v14
 v_mfma_f32_16x16x32_bf16 v[152:155], a[188:191], a[132:135], v[152:155]
 buffer_load_dwordx4 a[188:191], v0, s[12:15], s24 offen offset:3072
 v_mfma_f32_16x16x32_bf16 v[152:155], a[184:187], a[128:131], v[152:155]
 buffer_load_dwordx4 a[184:187], v0, s[12:15], s24 offen offset:2048
 s_waitcnt vmcnt(14)
 v_mfma_f32_16x16x32_bf16 v[168:171], a[192:195], a[128:131], v[168:171]
 ds_read_b128 a[168:171], v2 offset:41984
 ds_read_b128 a[172:175], v2 offset:46080
 v_mfma_f32_16x16x32_bf16 v[168:171], a[196:199], a[132:135], v[168:171]
 s_add_u32 s24, s24, 4096
 v_mfma_f32_16x16x32_bf16 v[172:175], a[196:199], a[140:143], v[172:175]
 v_add_f32 v131, v131, v15
 v_mfma_f32_16x16x32_bf16 v[172:175], a[192:195], a[136:139], v[172:175]
 v_mfma_f32_16x16x32_bf16 v[176:179], a[192:195], a[144:147], v[176:179]
 v_add_f32 v132, v132, v12
 v_mfma_f32_16x16x32_bf16 v[176:179], a[196:199], a[148:151], v[176:179]
 v_mfma_f32_16x16x32_bf16 v[180:183], a[196:199], a[156:159], v[180:183]
 buffer_load_dwordx4 a[196:199], v0, s[12:15], s24 offen offset:1024
 v_mfma_f32_16x16x32_bf16 v[180:183], a[192:195], a[152:155], v[180:183]
 buffer_load_dwordx4 a[192:195], v0, s[12:15], s24 offen
 s_waitcnt vmcnt(14)
 v_mfma_f32_16x16x32_bf16 v[196:199], a[200:203], a[152:155], v[196:199]
 v_add_f32 v133, v133, v13
 v_mfma_f32_16x16x32_bf16 v[196:199], a[204:207], a[156:159], v[196:199]
 v_add_f32 v134, v134, v14
 v_mfma_f32_16x16x32_bf16 v[192:195], a[204:207], a[148:151], v[192:195]
 v_mfma_f32_16x16x32_bf16 v[192:195], a[200:203], a[144:147], v[192:195]
 v_add_f32 v135, v135, v15
 v_mfma_f32_16x16x32_bf16 v[188:191], a[200:203], a[136:139], v[188:191]
 v_mfma_f32_16x16x32_bf16 v[188:191], a[204:207], a[140:143], v[188:191]
 v_accvgpr_read_b32 v5, a240
 v_mfma_f32_16x16x32_bf16 v[184:187], a[204:207], a[132:135], v[184:187]
 buffer_load_dwordx4 a[204:207], v0, s[12:15], s24 offen offset:3072
 v_mfma_f32_16x16x32_bf16 v[184:187], a[200:203], a[128:131], v[184:187]
 buffer_load_dwordx4 a[200:203], v0, s[12:15], s24 offen offset:2048
 s_waitcnt vmcnt(14)
 v_mfma_f32_16x16x32_bf16 v[200:203], a[208:211], a[128:131], v[200:203]
 v_add_f32 v5, v5, v12
 v_mfma_f32_16x16x32_bf16 v[200:203], a[212:215], a[132:135], v[200:203]
 s_add_u32 s24, s24, 4096
 v_mfma_f32_16x16x32_bf16 v[204:207], a[212:215], a[140:143], v[204:207]
 v_mfma_f32_16x16x32_bf16 v[204:207], a[208:211], a[136:139], v[204:207]
 v_accvgpr_write_b32 a240, v5
 v_mfma_f32_16x16x32_bf16 v[208:211], a[208:211], a[144:147], v[208:211]
 v_mfma_f32_16x16x32_bf16 v[208:211], a[212:215], a[148:151], v[208:211]
 v_accvgpr_read_b32 v6, a241
 v_mfma_f32_16x16x32_bf16 v[212:215], a[212:215], a[156:159], v[212:215]
 buffer_load_dwordx4 a[212:215], v0, s[12:15], s24 offen offset:1024
 v_mfma_f32_16x16x32_bf16 v[212:215], a[208:211], a[152:155], v[212:215]
 buffer_load_dwordx4 a[208:211], v0, s[12:15], s24 offen
 s_waitcnt vmcnt(14)
 v_mfma_f32_16x16x32_bf16 v[228:231], a[216:219], a[152:155], v[228:231]
 v_add_f32 v6, v6, v13
 v_mfma_f32_16x16x32_bf16 v[228:231], a[220:223], a[156:159], v[228:231]
 v_mfma_f32_16x16x32_bf16 v[224:227], a[220:223], a[148:151], v[224:227]
 v_accvgpr_write_b32 a241, v6
 v_mfma_f32_16x16x32_bf16 v[224:227], a[216:219], a[144:147], v[224:227]
 v_mfma_f32_16x16x32_bf16 v[220:223], a[216:219], a[136:139], v[220:223]
 v_accvgpr_read_b32 v5, a242
 v_mfma_f32_16x16x32_bf16 v[220:223], a[220:223], a[140:143], v[220:223]
 v_add_f32 v5, v5, v14
 v_mfma_f32_16x16x32_bf16 v[216:219], a[220:223], a[132:135], v[216:219]
 buffer_load_dwordx4 a[220:223], v0, s[12:15], s24 offen offset:3072
 v_mfma_f32_16x16x32_bf16 v[216:219], a[216:219], a[128:131], v[216:219]
 buffer_load_dwordx4 a[216:219], v0, s[12:15], s24 offen offset:2048
 s_waitcnt vmcnt(14)
 v_mfma_f32_16x16x32_bf16 v[232:235], a[224:227], a[128:131], v[232:235]
 v_mfma_f32_16x16x32_bf16 v[232:235], a[228:231], a[132:135], v[232:235]
 s_add_u32 s24, s24, 4096
 v_mfma_f32_16x16x32_bf16 v[236:239], a[228:231], a[140:143], v[236:239]
 v_accvgpr_write_b32 a242, v5
 v_mfma_f32_16x16x32_bf16 v[236:239], a[224:227], a[136:139], v[236:239]
 v_mfma_f32_16x16x32_bf16 v[240:243], a[224:227], a[144:147], v[240:243]
 v_accvgpr_read_b32 v6, a243
 v_mfma_f32_16x16x32_bf16 v[240:243], a[228:231], a[148:151], v[240:243]
 v_add_f32 v6, v6, v15
 v_mfma_f32_16x16x32_bf16 v[244:247], a[228:231], a[156:159], v[244:247]
 buffer_load_dwordx4 a[228:231], v0, s[12:15], s24 offen offset:1024
 v_mfma_f32_16x16x32_bf16 v[244:247], a[224:227], a[152:155], v[244:247]
 buffer_load_dwordx4 a[224:227], v0, s[12:15], s24 offen
 s_waitcnt vmcnt(14)
 v_mfma_f32_16x16x32_bf16 a[252:255], a[232:235], a[152:155], a[252:255]
 ds_read_b128 a[152:155], v2 offset:44032
 v_mfma_f32_16x16x32_bf16 a[252:255], a[236:239], a[156:159], a[252:255]
 ds_read_b128 a[156:159], v2 offset:48128
 v_mfma_f32_16x16x32_bf16 a[248:251], a[236:239], a[148:151], a[248:251]
 ds_read_b128 a[148:151], v2 offset:47104
 v_mfma_f32_16x16x32_bf16 a[248:251], a[232:235], a[144:147], a[248:251]
 ds_read_b128 a[144:147], v2 offset:43008
 v_mfma_f32_16x16x32_bf16 v[252:255], a[232:235], a[136:139], v[252:255]
 v_mfma_f32_16x16x32_bf16 v[252:255], a[236:239], a[140:143], v[252:255]
 v_accvgpr_write_b32 a243, v6
 v_mfma_f32_16x16x32_bf16 v[248:251], a[236:239], a[132:135], v[248:251]
 buffer_load_dwordx4 a[236:239], v0, s[12:15], s24 offen offset:3072
 v_mfma_f32_16x16x32_bf16 v[248:251], a[232:235], a[128:131], v[248:251]
 buffer_load_dwordx4 a[232:235], v0, s[12:15], s24 offen offset:2048
 s_waitcnt vmcnt(14) lgkmcnt(6)
 v_mfma_f32_16x16x32_bf16 v[136:139], a[176:179], a[160:163], v[136:139]
 v_mfma_f32_16x16x32_bf16 v[136:139], a[180:183], a[164:167], v[136:139]
 s_add_u32 s24, s24, 53248
 s_waitcnt lgkmcnt(4)
 v_mfma_f32_16x16x32_bf16 v[140:143], a[180:183], a[172:175], v[140:143]
 v_accvgpr_read_b32 v5, a244
 v_mfma_f32_16x16x32_bf16 v[140:143], a[176:179], a[168:171], v[140:143]
 s_waitcnt lgkmcnt(0)
 v_mfma_f32_16x16x32_bf16 v[144:147], a[176:179], a[144:147], v[144:147]
 v_add_f32 v5, v5, v12
 v_mfma_f32_16x16x32_bf16 v[144:147], a[180:183], a[148:151], v[144:147]
 v_mfma_f32_16x16x32_bf16 v[148:151], a[180:183], a[156:159], v[148:151]
 buffer_load_dwordx4 a[180:183], v0, s[12:15], s24 offen offset:1024
 v_mfma_f32_16x16x32_bf16 v[148:151], a[176:179], a[152:155], v[148:151]
 buffer_load_dwordx4 a[176:179], v0, s[12:15], s24 offen
 s_waitcnt vmcnt(14)
 v_mfma_f32_16x16x32_bf16 v[164:167], a[184:187], a[152:155], v[164:167]
 v_mfma_f32_16x16x32_bf16 v[164:167], a[188:191], a[156:159], v[164:167]
 v_accvgpr_write_b32 a244, v5
 v_mfma_f32_16x16x32_bf16 v[160:163], a[188:191], a[148:151], v[160:163]
 v_mfma_f32_16x16x32_bf16 v[160:163], a[184:187], a[144:147], v[160:163]
 v_accvgpr_read_b32 v6, a245
 v_mfma_f32_16x16x32_bf16 v[156:159], a[184:187], a[168:171], v[156:159]
 v_add_f32 v6, v6, v13
 v_mfma_f32_16x16x32_bf16 v[156:159], a[188:191], a[172:175], v[156:159]
 v_mfma_f32_16x16x32_bf16 v[152:155], a[188:191], a[164:167], v[152:155]
 buffer_load_dwordx4 a[188:191], v0, s[12:15], s24 offen offset:3072
 v_mfma_f32_16x16x32_bf16 v[152:155], a[184:187], a[160:163], v[152:155]
 buffer_load_dwordx4 a[184:187], v0, s[12:15], s24 offen offset:2048
 s_waitcnt vmcnt(14)
 v_mfma_f32_16x16x32_bf16 v[168:171], a[192:195], a[160:163], v[168:171]
 v_accvgpr_write_b32 a245, v6
 v_mfma_f32_16x16x32_bf16 v[168:171], a[196:199], a[164:167], v[168:171]
 s_add_u32 s24, s24, 4096
 v_mfma_f32_16x16x32_bf16 v[172:175], a[196:199], a[172:175], v[172:175]
 v_mfma_f32_16x16x32_bf16 v[172:175], a[192:195], a[168:171], v[172:175]
 v_accvgpr_read_b32 v5, a246
 v_mfma_f32_16x16x32_bf16 v[176:179], a[192:195], a[144:147], v[176:179]
 v_add_f32 v5, v5, v14
 v_mfma_f32_16x16x32_bf16 v[176:179], a[196:199], a[148:151], v[176:179]
 v_mfma_f32_16x16x32_bf16 v[180:183], a[196:199], a[156:159], v[180:183]
 buffer_load_dwordx4 a[196:199], v0, s[12:15], s24 offen offset:1024
 v_mfma_f32_16x16x32_bf16 v[180:183], a[192:195], a[152:155], v[180:183]
 buffer_load_dwordx4 a[192:195], v0, s[12:15], s24 offen
 s_waitcnt vmcnt(14)
 v_mfma_f32_16x16x32_bf16 v[196:199], a[200:203], a[152:155], v[196:199]
 v_accvgpr_write_b32 a246, v5
 v_mfma_f32_16x16x32_bf16 v[196:199], a[204:207], a[156:159], v[196:199]
 v_mfma_f32_16x16x32_bf16 v[192:195], a[204:207], a[148:151], v[192:195]
 v_accvgpr_read_b32 v6, a247
 v_mfma_f32_16x16x32_bf16 v[192:195], a[200:203], a[144:147], v[192:195]
 v_add_f32 v6, v6, v15
 v_mfma_f32_16x16x32_bf16 v[188:191], a[200:203], a[168:171], v[188:191]
 v_mfma_f32_16x16x32_bf16 v[188:191], a[204:207], a[172:175], v[188:191]
 v_accvgpr_write_b32 a247, v6
 v_mfma_f32_16x16x32_bf16 v[184:187], a[204:207], a[164:167], v[184:187]
 buffer_load_dwordx4 a[204:207], v0, s[12:15], s24 offen offset:3072
 v_mfma_f32_16x16x32_bf16 v[184:187], a[200:203], a[160:163], v[184:187]
 buffer_load_dwordx4 a[200:203], v0, s[12:15], s24 offen offset:2048
 s_waitcnt vmcnt(14)
 v_mfma_f32_16x16x32_bf16 v[200:203], a[208:211], a[160:163], v[200:203]
 v_mfma_f32_16x16x32_bf16 v[200:203], a[212:215], a[164:167], v[200:203]
 s_add_u32 s24, s24, 4096
 s_waitcnt lgkmcnt(0)
 s_barrier
 v_mfma_f32_16x16x32_bf16 v[204:207], a[212:215], a[172:175], v[204:207]
 ds_read_b128 a[128:131], v1 offset:16384
 v_mfma_f32_16x16x32_bf16 v[204:207], a[208:211], a[168:171], v[204:207]
 v_mfma_f32_16x16x32_bf16 v[208:211], a[208:211], a[144:147], v[208:211]
 ds_read_b128 a[132:135], v1 offset:20480
 v_mfma_f32_16x16x32_bf16 v[208:211], a[212:215], a[148:151], v[208:211]
 v_mfma_f32_16x16x32_bf16 v[212:215], a[212:215], a[156:159], v[212:215]
 buffer_load_dwordx4 a[212:215], v0, s[12:15], s24 offen offset:1024
 v_mfma_f32_16x16x32_bf16 v[212:215], a[208:211], a[152:155], v[212:215]
 buffer_load_dwordx4 a[208:211], v0, s[12:15], s24 offen
 s_waitcnt vmcnt(14)
 v_mfma_f32_16x16x32_bf16 v[228:231], a[216:219], a[152:155], v[228:231]
 ds_read_b128 a[136:139], v1 offset:17408
 ds_read_b128 a[140:143], v1 offset:21504
 v_mfma_f32_16x16x32_bf16 v[228:231], a[220:223], a[156:159], v[228:231]
 v_mfma_f32_16x16x32_bf16 v[224:227], a[220:223], a[148:151], v[224:227]
 v_mfma_f32_16x16x32_bf16 v[224:227], a[216:219], a[144:147], v[224:227]
 v_mfma_f32_16x16x32_bf16 v[220:223], a[216:219], a[168:171], v[220:223]
 v_mfma_f32_16x16x32_bf16 v[220:223], a[220:223], a[172:175], v[220:223]
 v_mfma_f32_16x16x32_bf16 v[216:219], a[220:223], a[164:167], v[216:219]
 buffer_load_dwordx4 a[220:223], v0, s[12:15], s24 offen offset:3072
 v_mfma_f32_16x16x32_bf16 v[216:219], a[216:219], a[160:163], v[216:219]
 buffer_load_dwordx4 a[216:219], v0, s[12:15], s24 offen offset:2048
 s_waitcnt vmcnt(14)
 v_mfma_f32_16x16x32_bf16 v[232:235], a[224:227], a[160:163], v[232:235]
 v_mfma_f32_16x16x32_bf16 v[232:235], a[228:231], a[164:167], v[232:235]
 s_add_u32 s24, s24, 4096
 v_mfma_f32_16x16x32_bf16 v[236:239], a[228:231], a[172:175], v[236:239]
 v_mfma_f32_16x16x32_bf16 v[236:239], a[224:227], a[168:171], v[236:239]
 v_mfma_f32_16x16x32_bf16 v[240:243], a[224:227], a[144:147], v[240:243]
 v_mfma_f32_16x16x32_bf16 v[240:243], a[228:231], a[148:151], v[240:243]
 v_mfma_f32_16x16x32_bf16 v[244:247], a[228:231], a[156:159], v[244:247]
 buffer_load_dwordx4 a[228:231], v0, s[12:15], s24 offen offset:1024
 v_mfma_f32_16x16x32_bf16 v[244:247], a[224:227], a[152:155], v[244:247]
 buffer_load_dwordx4 a[224:227], v0, s[12:15], s24 offen
 s_waitcnt vmcnt(14)
 v_mfma_f32_16x16x32_bf16 a[252:255], a[232:235], a[152:155], a[252:255]
 ds_read_b128 a[152:155], v1 offset:19456
 v_mfma_f32_16x16x32_bf16 a[252:255], a[236:239], a[156:159], a[252:255]
 ds_read_b128 a[156:159], v1 offset:23552
 v_mfma_f32_16x16x32_bf16 a[248:251], a[236:239], a[148:151], a[248:251]
 ds_read_b128 a[148:151], v1 offset:22528
 v_mfma_f32_16x16x32_bf16 a[248:251], a[232:235], a[144:147], a[248:251]
 ds_read_b128 a[144:147], v1 offset:18432
 v_mfma_f32_16x16x32_bf16 v[252:255], a[232:235], a[168:171], v[252:255]
 v_mfma_f32_16x16x32_bf16 v[252:255], a[236:239], a[172:175], v[252:255]
 v_mfma_f32_16x16x32_bf16 v[248:251], a[236:239], a[164:167], v[248:251]
 buffer_load_dwordx4 a[236:239], v0, s[12:15], s24 offen offset:3072
 v_mfma_f32_16x16x32_bf16 v[248:251], a[232:235], a[160:163], v[248:251]
 buffer_load_dwordx4 a[232:235], v0, s[12:15], s24 offen offset:2048
 s_add_u32 s24, s24, 53248
 s_waitcnt vmcnt(14) lgkmcnt(6)
 s_add_u32 s51, s51, 4096
 s_add_u32 s25, s25, 1
 s_cmp_eq_u32 s25, 6
 s_cbranch_scc1 Llast
 v_mfma_f32_16x16x32_bf16 v[136:139], a[176:179], a[128:131], v[136:139]
 v_lshlrev_b32 v5, 4, v0
 v_mov_b32 v6, 1
 v_mfma_f32_16x16x32_bf16 v[136:139], a[180:183], a[132:135], v[136:139]
 s_waitcnt lgkmcnt(4)
 v_mfma_f32_16x16x32_bf16 v[140:143], a[180:183], a[140:143], v[140:143]
 buffer_atomic_add v6, v5, s[44:47], s50 offen sc1
 v_accvgpr_read_b32 v5, a0
 v_mfma_f32_16x16x32_bf16 v[140:143], a[176:179], a[136:139], v[140:143]
 s_waitcnt lgkmcnt(0)
 v_mfma_f32_16x16x32_bf16 v[144:147], a[176:179], a[144:147], v[144:147]
 v_lshlrev_b32 v6, 16, v5
 v_mfma_f32_16x16x32_bf16 v[144:147], a[180:183], a[148:151], v[144:147]
 v_and_b32 v5, s26, v5
 v_mfma_f32_16x16x32_bf16 v[148:151], a[180:183], a[156:159], v[148:151]
 buffer_load_dwordx4 a[180:183], v0, s[12:15], s24 offen offset:1024
 v_mfma_f32_16x16x32_bf16 v[148:151], a[176:179], a[152:155], v[148:151]
 buffer_load_dwordx4 a[176:179], v0, s[12:15], s24 offen
 s_waitcnt vmcnt(15)
 v_mfma_f32_16x16x32_bf16 v[164:167], a[184:187], a[152:155], v[164:167]
 v_mul_f32 v6, v6, v16
 v_mfma_f32_16x16x32_bf16 v[164:167], a[188:191], a[156:159], v[164:167]
 v_mul_f32 v5, v5, v17
 v_cvt_pk_bf16_f32 v8, v6, v5
 v_mfma_f32_16x16x32_bf16 v[160:163], a[188:191], a[148:151], v[160:163]
 ds_read_b128 a[160:163], v1 offset:24576
 v_mfma_f32_16x16x32_bf16 v[160:163], a[184:187], a[144:147], v[160:163]
 v_accvgpr_read_b32 v5, a1
 v_lshlrev_b32 v6, 16, v5
 v_mfma_f32_16x16x32_bf16 v[156:159], a[184:187], a[136:139], v[156:159]
 ds_read_b128 a[164:167], v1 offset:28672
 v_mfma_f32_16x16x32_bf16 v[156:159], a[188:191], a[140:143], v[156:159]
 v_and_b32 v5, s26, v5
 v_mfma_f32_16x16x32_bf16 v[152:155], a[188:191], a[132:135], v[152:155]
 v_mul_f32 v6, v6, v18
 buffer_load_dwordx4 a[188:191], v0, s[12:15], s24 offen offset:3072
 v_mfma_f32_16x16x32_bf16 v[152:155], a[184:187], a[128:131], v[152:155]
 buffer_load_dwordx4 a[184:187], v0, s[12:15], s24 offen offset:2048
 s_waitcnt vmcnt(15)
 v_mfma_f32_16x16x32_bf16 v[168:171], a[192:195], a[128:131], v[168:171]
 ds_read_b128 a[168:171], v1 offset:25600
 ds_read_b128 a[172:175], v1 offset:29696
 v_mfma_f32_16x16x32_bf16 v[168:171], a[196:199], a[132:135], v[168:171]
 s_add_u32 s24, s24, 4096
 v_mfma_f32_16x16x32_bf16 v[172:175], a[196:199], a[140:143], v[172:175]
 v_mul_f32 v5, v5, v19
 v_mfma_f32_16x16x32_bf16 v[172:175], a[192:195], a[136:139], v[172:175]
 v_cvt_pk_bf16_f32 v9, v6, v5
 v_accvgpr_read_b32 v5, a2
 v_mfma_f32_16x16x32_bf16 v[176:179], a[192:195], a[144:147], v[176:179]
 v_lshlrev_b32 v6, 16, v5
 v_mfma_f32_16x16x32_bf16 v[176:179], a[196:199], a[148:151], v[176:179]
 v_and_b32 v5, s26, v5
 v_mfma_f32_16x16x32_bf16 v[180:183], a[196:199], a[156:159], v[180:183]
 v_mul_f32 v6, v6, v32
 buffer_load_dwordx4 a[196:199], v0, s[12:15], s24 offen offset:1024
 v_mfma_f32_16x16x32_bf16 v[180:183], a[192:195], a[152:155], v[180:183]
 buffer_load_dwordx4 a[192:195], v0, s[12:15], s24 offen
 s_waitcnt vmcnt(15)
 v_mfma_f32_16x16x32_bf16 v[196:199], a[200:203], a[152:155], v[196:199]
 v_mul_f32 v5, v5, v33
 v_mfma_f32_16x16x32_bf16 v[196:199], a[204:207], a[156:159], v[196:199]
 v_cvt_pk_bf16_f32 v10, v6, v5
 v_accvgpr_read_b32 v5, a3
 v_mfma_f32_16x16x32_bf16 v[192:195], a[204:207], a[148:151], v[192:195]
 v_lshlrev_b32 v6, 16, v5
 v_mfma_f32_16x16x32_bf16 v[192:195], a[200:203], a[144:147], v[192:195]
 v_and_b32 v5, s26, v5
 v_mfma_f32_16x16x32_bf16 v[188:191], a[200:203], a[136:139], v[188:191]
 v_mul_f32 v6, v6, v34
 v_mul_f32 v5, v5, v35
 v_mfma_f32_16x16x32_bf16 v[188:191], a[204:207], a[140:143], v[188:191]
 v_cvt_pk_bf16_f32 v11, v6, v5
 v_mfma_f32_16x16x32_bf16 v[184:187], a[204:207], a[132:135], v[184:187]
 buffer_load_dwordx4 a[204:207], v0, s[12:15], s24 offen offset:3072
 v_mfma_f32_16x16x32_bf16 v[184:187], a[200:203], a[128:131], v[184:187]
 buffer_load_dwordx4 a[200:203], v0, s[12:15], s24 offen offset:2048
 s_waitcnt vmcnt(15)
 v_mfma_f32_16x16x32_bf16 v[200:203], a[208:211], a[128:131], v[200:203]
 ds_write_b128 v3, v[8:11]
 v_accvgpr_read_b32 v5, a4
 v_mfma_f32_16x16x32_bf16 v[200:203], a[212:215], a[132:135], v[200:203]
 s_add_u32 s24, s24, 4096
 v_mfma_f32_16x16x32_bf16 v[204:207], a[212:215], a[140:143], v[204:207]
 v_lshlrev_b32 v6, 16, v5
 v_and_b32 v5, s26, v5
 v_mfma_f32_16x16x32_bf16 v[204:207], a[208:211], a[136:139], v[204:207]
 v_mul_f32 v6, v6, v20
 v_mfma_f32_16x16x32_bf16 v[208:211], a[208:211], a[144:147], v[208:211]
 v_mul_f32 v5, v5, v21
 v_mfma_f32_16x16x32_bf16 v[208:211], a[212:215], a[148:151], v[208:211]
 v_cvt_pk_bf16_f32 v12, v6, v5
 v_accvgpr_read_b32 v5, a5
 v_mfma_f32_16x16x32_bf16 v[212:215], a[212:215], a[156:159], v[212:215]
 buffer_load_dwordx4 a[212:215], v0, s[12:15], s24 offen offset:1024
 v_mfma_f32_16x16x32_bf16 v[212:215], a[208:211], a[152:155], v[212:215]
 buffer_load_dwordx4 a[208:211], v0, s[12:15], s24 offen
 s_waitcnt vmcnt(15)
 v_mfma_f32_16x16x32_bf16 v[228:231], a[216:219], a[152:155], v[228:231]
 v_lshlrev_b32 v6, 16, v5
 v_mfma_f32_16x16x32_bf16 v[228:231], a[220:223], a[156:159], v[228:231]
 v_and_b32 v5, s26, v5
 v_mul_f32 v6, v6, v22
 v_mfma_f32_16x16x32_bf16 v[224:227], a[220:223], a[148:151], v[224:227]
 v_mul_f32 v5, v5, v23
 v_mfma_f32_16x16x32_bf16 v[224:227], a[216:219], a[144:147], v[224:227]
 v_cvt_pk_bf16_f32 v13, v6, v5
 v_mfma_f32_16x16x32_bf16 v[220:223], a[216:219], a[136:139], v[220:223]
 v_accvgpr_read_b32 v5, a6
 v_lshlrev_b32 v6, 16, v5
 v_mfma_f32_16x16x32_bf16 v[220:223], a[220:223], a[140:143], v[220:223]
 v_and_b32 v5, s26, v5
 v_mfma_f32_16x16x32_bf16 v[216:219], a[220:223], a[132:135], v[216:219]
 v_mul_f32 v6, v6, v36
 buffer_load_dwordx4 a[220:223], v0, s[12:15], s24 offen offset:3072
 v_mfma_f32_16x16x32_bf16 v[216:219], a[216:219], a[128:131], v[216:219]
 buffer_load_dwordx4 a[216:219], v0, s[12:15], s24 offen offset:2048
 s_waitcnt vmcnt(15)
 v_mfma_f32_16x16x32_bf16 v[232:235], a[224:227], a[128:131], v[232:235]
 v_mul_f32 v5, v5, v37
 v_mfma_f32_16x16x32_bf16 v[232:235], a[228:231], a[132:135], v[232:235]
 s_add_u32 s24, s24, 4096
 v_mfma_f32_16x16x32_bf16 v[236:239], a[228:231], a[140:143], v[236:239]
 v_cvt_pk_bf16_f32 v14, v6, v5
 v_accvgpr_read_b32 v5, a7
 v_mfma_f32_16x16x32_bf16 v[236:239], a[224:227], a[136:139], v[236:239]
 v_lshlrev_b32 v6, 16, v5
 v_mfma_f32_16x16x32_bf16 v[240:243], a[224:227], a[144:147], v[240:243]
 v_and_b32 v5, s26, v5
 v_mfma_f32_16x16x32_bf16 v[240:243], a[228:231], a[148:151], v[240:243]
 v_mul_f32 v6, v6, v38
 v_mul_f32 v5, v5, v39
 v_mfma_f32_16x16x32_bf16 v[244:247], a[228:231], a[156:159], v[244:247]
 buffer_load_dwordx4 a[228:231], v0, s[12:15], s24 offen offset:1024
 v_mfma_f32_16x16x32_bf16 v[244:247], a[224:227], a[152:155], v[244:247]
 buffer_load_dwordx4 a[224:227], v0, s[12:15], s24 offen
 s_waitcnt vmcnt(15)
 v_mfma_f32_16x16x32_bf16 a[252:255], a[232:235], a[152:155], a[252:255]
 ds_read_b128 a[152:155], v1 offset:27648
 v_mfma_f32_16x16x32_bf16 a[252:255], a[236:239], a[156:159], a[252:255]
 v_cvt_pk_bf16_f32 v15, v6, v5
 ds_read_b128 a[156:159], v1 offset:31744
 v_mfma_f32_16x16x32_bf16 a[248:251], a[236:239], a[148:151], a[248:251]
 ds_read_b128 a[148:151], v1 offset:30720
 v_mfma_f32_16x16x32_bf16 a[248:251], a[232:235], a[144:147], a[248:251]
 ds_write_b128 v3, v[12:15] offset:1024
 ds_read_b128 a[144:147], v1 offset:26624
 v_mfma_f32_16x16x32_bf16 v[252:255], a[232:235], a[136:139], v[252:255]
 v_accvgpr_read_b32 v5, a8
 v_mfma_f32_16x16x32_bf16 v[252:255], a[236:239], a[140:143], v[252:255]
 v_lshlrev_b32 v6, 16, v5
 v_mfma_f32_16x16x32_bf16 v[248:251], a[236:239], a[132:135], v[248:251]
 v_and_b32 v5, s26, v5
 buffer_load_dwordx4 a[236:239], v0, s[12:15], s24 offen offset:3072
 v_mfma_f32_16x16x32_bf16 v[248:251], a[232:235], a[128:131], v[248:251]
 buffer_load_dwordx4 a[232:235], v0, s[12:15], s24 offen offset:2048
 s_waitcnt vmcnt(14) lgkmcnt(8)
 v_mfma_f32_16x16x32_bf16 v[136:139], a[176:179], a[160:163], v[136:139]
 v_mul_f32 v6, v6, v24
 v_mfma_f32_16x16x32_bf16 v[136:139], a[180:183], a[164:167], v[136:139]
 s_add_u32 s24, s24, 53248
 s_waitcnt lgkmcnt(6)
 v_mfma_f32_16x16x32_bf16 v[140:143], a[180:183], a[172:175], v[140:143]
 v_mul_f32 v5, v5, v25
 v_mfma_f32_16x16x32_bf16 v[140:143], a[176:179], a[168:171], v[140:143]
 v_cvt_pk_bf16_f32 v8, v6, v5
 s_waitcnt lgkmcnt(0)
 v_mfma_f32_16x16x32_bf16 v[144:147], a[176:179], a[144:147], v[144:147]
 v_accvgpr_read_b32 v5, a9
 v_mfma_f32_16x16x32_bf16 v[144:147], a[180:183], a[148:151], v[144:147]
 v_lshlrev_b32 v6, 16, v5
 v_mfma_f32_16x16x32_bf16 v[148:151], a[180:183], a[156:159], v[148:151]
 buffer_load_dwordx4 a[180:183], v0, s[12:15], s24 offen offset:1024
 v_mfma_f32_16x16x32_bf16 v[148:151], a[176:179], a[152:155], v[148:151]
 buffer_load_dwordx4 a[176:179], v0, s[12:15], s24 offen
 s_waitcnt vmcnt(14)
 v_mfma_f32_16x16x32_bf16 v[164:167], a[184:187], a[152:155], v[164:167]
 v_and_b32 v5, s26, v5
 v_mfma_f32_16x16x32_bf16 v[164:167], a[188:191], a[156:159], v[164:167]
 v_mul_f32 v6, v6, v26
 v_mul_f32 v5, v5, v27
 v_mfma_f32_16x16x32_bf16 v[160:163], a[188:191], a[148:151], v[160:163]
 ds_read_b128 a[128:131], v1 offset:49152
 v_mfma_f32_16x16x32_bf16 v[160:163], a[184:187], a[144:147], v[160:163]
 v_cvt_pk_bf16_f32 v9, v6, v5
 v_mfma_f32_16x16x32_bf16 v[156:159], a[184:187], a[168:171], v[156:159]
 v_accvgpr_read_b32 v5, a10
 ds_read_b128 a[132:135], v1 offset:53248
 v_mfma_f32_16x16x32_bf16 v[156:159], a[188:191], a[172:175], v[156:159]
 v_lshlrev_b32 v6, 16, v5
 v_mfma_f32_16x16x32_bf16 v[152:155], a[188:191], a[164:167], v[152:155]
 buffer_load_dwordx4 a[188:191], v0, s[12:15], s24 offen offset:3072
 v_mfma_f32_16x16x32_bf16 v[152:155], a[184:187], a[160:163], v[152:155]
 buffer_load_dwordx4 a[184:187], v0, s[12:15], s24 offen offset:2048
 s_waitcnt vmcnt(14)
 v_mfma_f32_16x16x32_bf16 v[168:171], a[192:195], a[160:163], v[168:171]
 ds_read_b128 a[136:139], v1 offset:50176
 ds_read_b128 a[140:143], v1 offset:54272
 v_mfma_f32_16x16x32_bf16 v[168:171], a[196:199], a[164:167], v[168:171]
 v_and_b32 v5, s26, v5
 s_add_u32 s24, s24, 4096
 v_mfma_f32_16x16x32_bf16 v[172:175], a[196:199], a[172:175], v[172:175]
 v_mul_f32 v6, v6, v40
 v_mfma_f32_16x16x32_bf16 v[172:175], a[192:195], a[168:171], v[172:175]
 v_mul_f32 v5, v5, v41
 v_cvt_pk_bf16_f32 v10, v6, v5
 v_mfma_f32_16x16x32_bf16 v[176:179], a[192:195], a[144:147], v[176:179]
 v_accvgpr_read_b32 v5, a11
 v_mfma_f32_16x16x32_bf16 v[176:179], a[196:199], a[148:151], v[176:179]
 v_lshlrev_b32 v6, 16, v5
 v_mfma_f32_16x16x32_bf16 v[180:183], a[196:199], a[156:159], v[180:183]
 v_and_b32 v5, s26, v5
 buffer_load_dwordx4 a[196:199], v0, s[12:15], s24 offen offset:1024
 v_mfma_f32_16x16x32_bf16 v[180:183], a[192:195], a[152:155], v[180:183]
 buffer_load_dwordx4 a[192:195], v0, s[12:15], s24 offen
 s_waitcnt vmcnt(14)
 v_mfma_f32_16x16x32_bf16 v[196:199], a[200:203], a[152:155], v[196:199]
 v_mul_f32 v6, v6, v42
 v_mfma_f32_16x16x32_bf16 v[196:199], a[204:207], a[156:159], v[196:199]
 v_mul_f32 v5, v5, v43
 v_mfma_f32_16x16x32_bf16 v[192:195], a[204:207], a[148:151], v[192:195]
 v_cvt_pk_bf16_f32 v11, v6, v5
 ds_write_b128 v3, v[8:11] offset:2048
 v_mfma_f32_16x16x32_bf16 v[192:195], a[200:203], a[144:147], v[192:195]
 v_accvgpr_read_b32 v5, a12
 v_mfma_f32_16x16x32_bf16 v[188:191], a[200:203], a[168:171], v[188:191]
 v_lshlrev_b32 v6, 16, v5
 v_mfma_f32_16x16x32_bf16 v[188:191], a[204:207], a[172:175], v[188:191]
 v_and_b32 v5, s26, v5
 v_mul_f32 v6, v6, v28
 v_mfma_f32_16x16x32_bf16 v[184:187], a[204:207], a[164:167], v[184:187]
 buffer_load_dwordx4 a[204:207], v0, s[12:15], s24 offen offset:3072
 v_mfma_f32_16x16x32_bf16 v[184:187], a[200:203], a[160:163], v[184:187]
 buffer_load_dwordx4 a[200:203], v0, s[12:15], s24 offen offset:2048
 s_waitcnt vmcnt(14)
 v_mfma_f32_16x16x32_bf16 v[200:203], a[208:211], a[160:163], v[200:203]
 v_mul_f32 v5, v5, v29
 v_cvt_pk_bf16_f32 v12, v6, v5
 v_mfma_f32_16x16x32_bf16 v[200:203], a[212:215], a[164:167], v[200:203]
 s_add_u32 s24, s24, 4096
 v_mfma_f32_16x16x32_bf16 v[204:207], a[212:215], a[172:175], v[204:207]
 v_accvgpr_read_b32 v5, a13
 v_mfma_f32_16x16x32_bf16 v[204:207], a[208:211], a[168:171], v[204:207]
 v_lshlrev_b32 v6, 16, v5
 v_and_b32 v5, s26, v5
 v_mfma_f32_16x16x32_bf16 v[208:211], a[208:211], a[144:147], v[208:211]
 v_mul_f32 v6, v6, v30
 v_mfma_f32_16x16x32_bf16 v[208:211], a[212:215], a[148:151], v[208:211]
 v_mul_f32 v5, v5, v31
 v_mfma_f32_16x16x32_bf16 v[212:215], a[212:215], a[156:159], v[212:215]
 v_cvt_pk_bf16_f32 v13, v6, v5
 buffer_load_dwordx4 a[212:215], v0, s[12:15], s24 offen offset:1024
 v_mfma_f32_16x16x32_bf16 v[212:215], a[208:211], a[152:155], v[212:215]
 buffer_load_dwordx4 a[208:211], v0, s[12:15], s24 offen
 s_waitcnt vmcnt(14)
 v_mfma_f32_16x16x32_bf16 v[228:231], a[216:219], a[152:155], v[228:231]
 v_accvgpr_read_b32 v5, a14
 v_mfma_f32_16x16x32_bf16 v[228:231], a[220:223], a[156:159], v[228:231]
 v_lshlrev_b32 v6, 16, v5
 v_and_b32 v5, s26, v5
 v_mfma_f32_16x16x32_bf16 v[224:227], a[220:223], a[148:151], v[224:227]
 v_mul_f32 v6, v6, v44
 v_mfma_f32_16x16x32_bf16 v[224:227], a[216:219], a[144:147], v[224:227]
 v_mul_f32 v5, v5, v45
 v_mfma_f32_16x16x32_bf16 v[220:223], a[216:219], a[168:171], v[220:223]
 v_cvt_pk_bf16_f32 v14, v6, v5
 v_accvgpr_read_b32 v5, a15
 v_mfma_f32_16x16x32_bf16 v[220:223], a[220:223], a[172:175], v[220:223]
 v_lshlrev_b32 v6, 16, v5
 v_mfma_f32_16x16x32_bf16 v[216:219], a[220:223], a[164:167], v[216:219]
 buffer_load_dwordx4 a[220:223], v0, s[12:15], s24 offen offset:3072
 v_mfma_f32_16x16x32_bf16 v[216:219], a[216:219], a[160:163], v[216:219]
 buffer_load_dwordx4 a[216:219], v0, s[12:15], s24 offen offset:2048
 s_waitcnt vmcnt(14)
 v_mfma_f32_16x16x32_bf16 v[232:235], a[224:227], a[160:163], v[232:235]
 v_and_b32 v5, s26, v5
 v_mul_f32 v6, v6, v46
 v_mfma_f32_16x16x32_bf16 v[232:235], a[228:231], a[164:167], v[232:235]
 s_add_u32 s24, s24, 4096
 v_mfma_f32_16x16x32_bf16 v[236:239], a[228:231], a[172:175], v[236:239]
 v_mul_f32 v5, v5, v47
 v_mfma_f32_16x16x32_bf16 v[236:239], a[224:227], a[168:171], v[236:239]
 v_cvt_pk_bf16_f32 v15, v6, v5
 ds_write_b128 v3, v[12:15] offset:3072
 v_mfma_f32_16x16x32_bf16 v[240:243], a[224:227], a[144:147], v[240:243]
 v_accvgpr_read_b32 v5, a16
 v_mfma_f32_16x16x32_bf16 v[240:243], a[228:231], a[148:151], v[240:243]
 v_lshlrev_b32 v6, 16, v5
 v_and_b32 v5, s26, v5
 v_mfma_f32_16x16x32_bf16 v[244:247], a[228:231], a[156:159], v[244:247]
 buffer_load_dwordx4 a[228:231], v0, s[12:15], s24 offen offset:1024
 v_mfma_f32_16x16x32_bf16 v[244:247], a[224:227], a[152:155], v[244:247]
 buffer_load_dwordx4 a[224:227], v0, s[12:15], s24 offen
 s_waitcnt vmcnt(14)
 v_mfma_f32_16x16x32_bf16 a[252:255], a[232:235], a[152:155], a[252:255]
 ds_read_b128 a[152:155], v1 offset:52224
 v_mfma_f32_16x16x32_bf16 a[252:255], a[236:239], a[156:159], a[252:255]
 v_mul_f32 v6, v6, v48
 ds_read_b128 a[156:159], v1 offset:56320
 v_mfma_f32_16x16x32_bf16 a[248:251], a[236:239], a[148:151], a[248:251]
 ds_read_b128 a[148:151], v1 offset:55296
 v_mfma_f32_16x16x32_bf16 a[248:251], a[232:235], a[144:147], a[248:251]
 ds_read_b128 a[144:147], v1 offset:51200
 v_mfma_f32_16x16x32_bf16 v[252:255], a[232:235], a[168:171], v[252:255]
 v_mul_f32 v5, v5, v49
 v_cvt_pk_bf16_f32 v8, v6, v5
 v_mfma_f32_16x16x32_bf16 v[252:255], a[236:239], a[172:175], v[252:255]
 v_accvgpr_read_b32 v5, a17
 v_mfma_f32_16x16x32_bf16 v[248:251], a[236:239], a[164:167], v[248:251]
 v_lshlrev_b32 v6, 16, v5
 buffer_load_dwordx4 a[236:239], v0, s[12:15], s24 offen offset:3072
 v_mfma_f32_16x16x32_bf16 v[248:251], a[232:235], a[160:163], v[248:251]
 buffer_load_dwordx4 a[232:235], v0, s[12:15], s24 offen offset:2048
 s_waitcnt vmcnt(14) lgkmcnt(8)
 v_mfma_f32_16x16x32_bf16 v[136:139], a[176:179], a[128:131], v[136:139]
 v_and_b32 v5, s26, v5
 v_mfma_f32_16x16x32_bf16 v[136:139], a[180:183], a[132:135], v[136:139]
 s_add_u32 s24, s24, 53248
 s_waitcnt lgkmcnt(6)
 v_mfma_f32_16x16x32_bf16 v[140:143], a[180:183], a[140:143], v[140:143]
 v_mul_f32 v6, v6, v50
 v_mfma_f32_16x16x32_bf16 v[140:143], a[176:179], a[136:139], v[140:143]
 v_mul_f32 v5, v5, v51
 s_waitcnt lgkmcnt(0)
 v_mfma_f32_16x16x32_bf16 v[144:147], a[176:179], a[144:147], v[144:147]
 v_cvt_pk_bf16_f32 v9, v6, v5
 v_mfma_f32_16x16x32_bf16 v[144:147], a[180:183], a[148:151], v[144:147]
 v_mfma_f32_16x16x32_bf16 v[148:151], a[180:183], a[156:159], v[148:151]
 v_accvgpr_read_b32 v5, a18
 buffer_load_dwordx4 a[180:183], v0, s[12:15], s24 offen offset:1024
 v_mfma_f32_16x16x32_bf16 v[148:151], a[176:179], a[152:155], v[148:151]
 buffer_load_dwordx4 a[176:179], v0, s[12:15], s24 offen
 s_waitcnt vmcnt(14)
 v_mfma_f32_16x16x32_bf16 v[164:167], a[184:187], a[152:155], v[164:167]
 v_lshlrev_b32 v6, 16, v5
 v_mfma_f32_16x16x32_bf16 v[164:167], a[188:191], a[156:159], v[164:167]
 v_and_b32 v5, s26, v5
 v_mfma_f32_16x16x32_bf16 v[160:163], a[188:191], a[148:151], v[160:163]
 v_mul_f32 v6, v6, v64
 ds_read_b128 a[160:163], v1 offset:57344
 v_mfma_f32_16x16x32_bf16 v[160:163], a[184:187], a[144:147], v[160:163]
 v_mul_f32 v5, v5, v65
 v_mfma_f32_16x16x32_bf16 v[156:159], a[184:187], a[136:139], v[156:159]
 v_cvt_pk_bf16_f32 v10, v6, v5
 ds_read_b128 a[164:167], v1 offset:61440
 v_mfma_f32_16x16x32_bf16 v[156:159], a[188:191], a[140:143], v[156:159]
 v_accvgpr_read_b32 v5, a19
 v_mfma_f32_16x16x32_bf16 v[152:155], a[188:191], a[132:135], v[152:155]
 buffer_load_dwordx4 a[188:191], v0, s[12:15], s24 offen offset:3072
 v_mfma_f32_16x16x32_bf16 v[152:155], a[184:187], a[128:131], v[152:155]
 buffer_load_dwordx4 a[184:187], v0, s[12:15], s24 offen offset:2048
 s_waitcnt vmcnt(14)
 v_mfma_f32_16x16x32_bf16 v[168:171], a[192:195], a[128:131], v[168:171]
 ds_read_b128 a[168:171], v1 offset:58368
 ds_read_b128 a[172:175], v1 offset:62464
 v_mfma_f32_16x16x32_bf16 v[168:171], a[196:199], a[132:135], v[168:171]
 v_lshlrev_b32 v6, 16, v5
 s_add_u32 s24, s24, 4096
 v_mfma_f32_16x16x32_bf16 v[172:175], a[196:199], a[140:143], v[172:175]
 v_and_b32 v5, s26, v5
 v_mfma_f32_16x16x32_bf16 v[172:175], a[192:195], a[136:139], v[172:175]
 v_mul_f32 v6, v6, v66
 v_mfma_f32_16x16x32_bf16 v[176:179], a[192:195], a[144:147], v[176:179]
 v_mul_f32 v5, v5, v67
 v_cvt_pk_bf16_f32 v11, v6, v5
 v_mfma_f32_16x16x32_bf16 v[176:179], a[196:199], a[148:151], v[176:179]
 ds_write_b128 v3, v[8:11] offset:4096
 v_mfma_f32_16x16x32_bf16 v[180:183], a[196:199], a[156:159], v[180:183]
 buffer_load_dwordx4 a[196:199], v0, s[12:15], s24 offen offset:1024
 v_mfma_f32_16x16x32_bf16 v[180:183], a[192:195], a[152:155], v[180:183]
 buffer_load_dwordx4 a[192:195], v0, s[12:15], s24 offen
 s_waitcnt vmcnt(14)
 v_mfma_f32_16x16x32_bf16 v[196:199], a[200:203], a[152:155], v[196:199]
 v_accvgpr_read_b32 v5, a20
 v_lshlrev_b32 v6, 16, v5
 v_mfma_f32_16x16x32_bf16 v[196:199], a[204:207], a[156:159], v[196:199]
 v_and_b32 v5, s26, v5
 v_mfma_f32_16x16x32_bf16 v[192:195], a[204:207], a[148:151], v[192:195]
 v_mul_f32 v6, v6, v52
 v_mul_f32 v5, v5, v53
 v_mfma_f32_16x16x32_bf16 v[192:195], a[200:203], a[144:147], v[192:195]
 v_cvt_pk_bf16_f32 v12, v6, v5
 v_mfma_f32_16x16x32_bf16 v[188:191], a[200:203], a[136:139], v[188:191]
 v_accvgpr_read_b32 v5, a21
 v_mfma_f32_16x16x32_bf16 v[188:191], a[204:207], a[140:143], v[188:191]
 v_lshlrev_b32 v6, 16, v5
 v_and_b32 v5, s26, v5
 v_mfma_f32_16x16x32_bf16 v[184:187], a[204:207], a[132:135], v[184:187]
 buffer_load_dwordx4 a[204:207], v0, s[12:15], s24 offen offset:3072
 v_mfma_f32_16x16x32_bf16 v[184:187], a[200:203], a[128:131], v[184:187]
 buffer_load_dwordx4 a[200:203], v0, s[12:15], s24 offen offset:2048
 s_waitcnt vmcnt(14)
 v_mfma_f32_16x16x32_bf16 v[200:203], a[208:211], a[128:131], v[200:203]
 v_mul_f32 v6, v6, v54
 v_mfma_f32_16x16x32_bf16 v[200:203], a[212:215], a[132:135], v[200:203]
 v_mul_f32 v5, v5, v55
 s_add_u32 s24, s24, 4096
 v_mfma_f32_16x16x32_bf16 v[204:207], a[212:215], a[140:143], v[204:207]
 v_cvt_pk_bf16_f32 v13, v6, v5
 v_mfma_f32_16x16x32_bf16 v[204:207], a[208:211], a[136:139], v[204:207]
 v_accvgpr_read_b32 v5, a22
 v_lshlrev_b32 v6, 16, v5
 v_mfma_f32_16x16x32_bf16 v[208:211], a[208:211], a[144:147], v[208:211]
 v_and_b32 v5, s26, v5
 v_mfma_f32_16x16x32_bf16 v[208:211], a[212:215], a[148:151], v[208:211]
 v_mul_f32 v6, v6, v68
 v_mfma_f32_16x16x32_bf16 v[212:215], a[212:215], a[156:159], v[212:215]
 v_mul_f32 v5, v5, v69
 buffer_load_dwordx4 a[212:215], v0, s[12:15], s24 offen offset:1024
 v_mfma_f32_16x16x32_bf16 v[212:215], a[208:211], a[152:155], v[212:215]
 buffer_load_dwordx4 a[208:211], v0, s[12:15], s24 offen
 s_waitcnt vmcnt(14)
 v_mfma_f32_16x16x32_bf16 v[228:231], a[216:219], a[152:155], v[228:231]
 v_cvt_pk_bf16_f32 v14, v6, v5
 v_mfma_f32_16x16x32_bf16 v[228:231], a[220:223], a[156:159], v[228:231]
 v_accvgpr_read_b32 v5, a23
 v_mfma_f32_16x16x32_bf16 v[224:227], a[220:223], a[148:151], v[224:227]
 v_lshlrev_b32 v6, 16, v5
 v_and_b32 v5, s26, v5
 v_mfma_f32_16x16x32_bf16 v[224:227], a[216:219], a[144:147], v[224:227]
 v_mul_f32 v6, v6, v70
 v_mfma_f32_16x16x32_bf16 v[220:223], a[216:219], a[136:139], v[220:223]
 v_mul_f32 v5, v5, v71
 v_mfma_f32_16x16x32_bf16 v[220:223], a[220:223], a[140:143], v[220:223]
 v_cvt_pk_bf16_f32 v15, v6, v5
 ds_write_b128 v3, v[12:15] offset:5120
 v_mfma_f32_16x16x32_bf16 v[216:219], a[220:223], a[132:135], v[216:219]
 buffer_load_dwordx4 a[220:223], v0, s[12:15], s24 offen offset:3072
 v_mfma_f32_16x16x32_bf16 v[216:219], a[216:219], a[128:131], v[216:219]
 buffer_load_dwordx4 a[216:219], v0, s[12:15], s24 offen offset:2048
 s_waitcnt vmcnt(14)
 v_mfma_f32_16x16x32_bf16 v[232:235], a[224:227], a[128:131], v[232:235]
 v_accvgpr_read_b32 v5, a24
 v_lshlrev_b32 v6, 16, v5
 v_mfma_f32_16x16x32_bf16 v[232:235], a[228:231], a[132:135], v[232:235]
 s_add_u32 s24, s24, 4096
 v_mfma_f32_16x16x32_bf16 v[236:239], a[228:231], a[140:143], v[236:239]
 v_and_b32 v5, s26, v5
 v_mfma_f32_16x16x32_bf16 v[236:239], a[224:227], a[136:139], v[236:239]
 v_mul_f32 v6, v6, v56
 v_mul_f32 v5, v5, v57
 v_mfma_f32_16x16x32_bf16 v[240:243], a[224:227], a[144:147], v[240:243]
 v_cvt_pk_bf16_f32 v8, v6, v5
 v_mfma_f32_16x16x32_bf16 v[240:243], a[228:231], a[148:151], v[240:243]
 v_accvgpr_read_b32 v5, a25
 v_mfma_f32_16x16x32_bf16 v[244:247], a[228:231], a[156:159], v[244:247]
 v_lshlrev_b32 v6, 16, v5
 buffer_load_dwordx4 a[228:231], v0, s[12:15], s24 offen offset:1024
 v_mfma_f32_16x16x32_bf16 v[244:247], a[224:227], a[152:155], v[244:247]
 buffer_load_dwordx4 a[224:227], v0, s[12:15], s24 offen
 s_waitcnt vmcnt(14)
 v_mfma_f32_16x16x32_bf16 a[252:255], a[232:235], a[152:155], a[252:255]
 ds_read_b128 a[152:155], v1 offset:60416
 v_mfma_f32_16x16x32_bf16 a[252:255], a[236:239], a[156:159], a[252:255]
 ds_read_b128 a[156:159], v1 offset:64512
 v_mfma_f32_16x16x32_bf16 a[248:251], a[236:239], a[148:151], a[248:251]
 v_and_b32 v5, s26, v5
 ds_read_b128 a[148:151], v1 offset:63488
 v_mfma_f32_16x16x32_bf16 a[248:251], a[232:235], a[144:147], a[248:251]
 ds_read_b128 a[144:147], v1 offset:59392
 v_mfma_f32_16x16x32_bf16 v[252:255], a[232:235], a[136:139], v[252:255]
 v_mul_f32 v6, v6, v58
 v_mul_f32 v5, v5, v59
 v_mfma_f32_16x16x32_bf16 v[252:255], a[236:239], a[140:143], v[252:255]
 v_cvt_pk_bf16_f32 v9, v6, v5
 v_mfma_f32_16x16x32_bf16 v[248:251], a[236:239], a[132:135], v[248:251]
 buffer_load_dwordx4 a[236:239], v0, s[12:15], s24 offen offset:3072
 v_mfma_f32_16x16x32_bf16 v[248:251], a[232:235], a[128:131], v[248:251]
 buffer_load_dwordx4 a[232:235], v0, s[12:15], s24 offen offset:2048
 s_waitcnt vmcnt(14) lgkmcnt(8)
 v_mfma_f32_16x16x32_bf16 v[136:139], a[176:179], a[160:163], v[136:139]
 v_accvgpr_read_b32 v5, a26
 v_lshlrev_b32 v6, 16, v5
 v_mfma_f32_16x16x32_bf16 v[136:139], a[180:183], a[164:167], v[136:139]
 s_add_u32 s24, s24, 53248
 s_waitcnt lgkmcnt(6)
 v_mfma_f32_16x16x32_bf16 v[140:143], a[180:183], a[172:175], v[140:143]
 v_and_b32 v5, s26, v5
 v_mfma_f32_16x16x32_bf16 v[140:143], a[176:179], a[168:171], v[140:143]
 s_waitcnt lgkmcnt(0)
 v_mfma_f32_16x16x32_bf16 v[144:147], a[176:179], a[144:147], v[144:147]
 v_mul_f32 v6, v6, v72
 v_mul_f32 v5, v5, v73
 v_mfma_f32_16x16x32_bf16 v[144:147], a[180:183], a[148:151], v[144:147]
 v_mfma_f32_16x16x32_bf16 v[148:151], a[180:183], a[156:159], v[148:151]
 v_cvt_pk_bf16_f32 v10, v6, v5
 buffer_load_dwordx4 a[180:183], v0, s[12:15], s24 offen offset:1024
 v_mfma_f32_16x16x32_bf16 v[148:151], a[176:179], a[152:155], v[148:151]
 buffer_load_dwordx4 a[176:179], v0, s[12:15], s24 offen
 s_waitcnt vmcnt(14)
 v_mfma_f32_16x16x32_bf16 v[164:167], a[184:187], a[152:155], v[164:167]
 v_accvgpr_read_b32 v5, a27
 v_mfma_f32_16x16x32_bf16 v[164:167], a[188:191], a[156:159], v[164:167]
 v_lshlrev_b32 v6, 16, v5
 v_mfma_f32_16x16x32_bf16 v[160:163], a[188:191], a[148:151], v[160:163]
 v_and_b32 v5, s26, v5
 ds_read_b128 a[128:131], v2 offset:16384
 v_mfma_f32_16x16x32_bf16 v[160:163], a[184:187], a[144:147], v[160:163]
 v_mul_f32 v6, v6, v74
 v_mfma_f32_16x16x32_bf16 v[156:159], a[184:187], a[168:171], v[156:159]
 ds_read_b128 a[132:135], v2 offset:20480
 v_mfma_f32_16x16x32_bf16 v[156:159], a[188:191], a[172:175], v[156:159]
 v_mul_f32 v5, v5, v75
 v_cvt_pk_bf16_f32 v11, v6, v5
 v_mfma_f32_16x16x32_bf16 v[152:155], a[188:191], a[164:167], v[152:155]
 buffer_load_dwordx4 a[188:191], v0, s[12:15], s24 offen offset:3072
 v_mfma_f32_16x16x32_bf16 v[152:155], a[184:187], a[160:163], v[152:155]
 buffer_load_dwordx4 a[184:187], v0, s[12:15], s24 offen offset:2048
 s_waitcnt vmcnt(14)
 v_mfma_f32_16x16x32_bf16 v[168:171], a[192:195], a[160:163], v[168:171]
 ds_read_b128 a[136:139], v2 offset:17408
 ds_read_b128 a[140:143], v2 offset:21504
 v_mfma_f32_16x16x32_bf16 v[168:171], a[196:199], a[164:167], v[168:171]
 s_add_u32 s24, s24, 4096
 v_mfma_f32_16x16x32_bf16 v[172:175], a[196:199], a[172:175], v[172:175]
 ds_write_b128 v3, v[8:11] offset:6144
 v_lshlrev_b32 v4, 2, v1
 v_mfma_f32_16x16x32_bf16 v[172:175], a[192:195], a[168:171], v[172:175]
 v_and_b32 v4, 192, v4
 v_mfma_f32_16x16x32_bf16 v[176:179], a[192:195], a[144:147], v[176:179]
 buffer_load_dword v4, v4, s[44:47], 0 offen sc1
 v_accvgpr_read_b32 v5, a28
 v_mfma_f32_16x16x32_bf16 v[176:179], a[196:199], a[148:151], v[176:179]
 v_lshlrev_b32 v6, 16, v5
 v_mfma_f32_16x16x32_bf16 v[180:183], a[196:199], a[156:159], v[180:183]
 buffer_load_dwordx4 a[196:199], v0, s[12:15], s24 offen offset:1024
 v_mfma_f32_16x16x32_bf16 v[180:183], a[192:195], a[152:155], v[180:183]
 buffer_load_dwordx4 a[192:195], v0, s[12:15], s24 offen
 s_waitcnt vmcnt(15)
 v_mfma_f32_16x16x32_bf16 v[196:199], a[200:203], a[152:155], v[196:199]
 v_and_b32 v5, s26, v5
 v_mul_f32 v6, v6, v60
 v_mfma_f32_16x16x32_bf16 v[196:199], a[204:207], a[156:159], v[196:199]
 v_mul_f32 v5, v5, v61
 v_mfma_f32_16x16x32_bf16 v[192:195], a[204:207], a[148:151], v[192:195]
 v_cvt_pk_bf16_f32 v12, v6, v5
 v_mfma_f32_16x16x32_bf16 v[192:195], a[200:203], a[144:147], v[192:195]
 v_accvgpr_read_b32 v5, a29
 v_lshlrev_b32 v6, 16, v5
 v_mfma_f32_16x16x32_bf16 v[188:191], a[200:203], a[168:171], v[188:191]
 v_and_b32 v5, s26, v5
 v_mfma_f32_16x16x32_bf16 v[188:191], a[204:207], a[172:175], v[188:191]
 v_mul_f32 v6, v6, v62
 v_mfma_f32_16x16x32_bf16 v[184:187], a[204:207], a[164:167], v[184:187]
 v_mul_f32 v5, v5, v63
 buffer_load_dwordx4 a[204:207], v0, s[12:15], s24 offen offset:3072
 v_mfma_f32_16x16x32_bf16 v[184:187], a[200:203], a[160:163], v[184:187]
 buffer_load_dwordx4 a[200:203], v0, s[12:15], s24 offen offset:2048
 s_waitcnt vmcnt(15)
 v_mfma_f32_16x16x32_bf16 v[200:203], a[208:211], a[160:163], v[200:203]
 v_cvt_pk_bf16_f32 v13, v6, v5
 v_mfma_f32_16x16x32_bf16 v[200:203], a[212:215], a[164:167], v[200:203]
 v_accvgpr_read_b32 v5, a30
 s_add_u32 s24, s24, 4096
 v_mfma_f32_16x16x32_bf16 v[204:207], a[212:215], a[172:175], v[204:207]
 v_lshlrev_b32 v6, 16, v5
 v_mfma_f32_16x16x32_bf16 v[204:207], a[208:211], a[168:171], v[204:207]
 v_and_b32 v5, s26, v5
 v_mfma_f32_16x16x32_bf16 v[208:211], a[208:211], a[144:147], v[208:211]
 v_mul_f32 v6, v6, v76
 v_mul_f32 v5, v5, v77
 v_mfma_f32_16x16x32_bf16 v[208:211], a[212:215], a[148:151], v[208:211]
 v_cvt_pk_bf16_f32 v14, v6, v5
 v_mfma_f32_16x16x32_bf16 v[212:215], a[212:215], a[156:159], v[212:215]
 buffer_load_dwordx4 a[212:215], v0, s[12:15], s24 offen offset:1024
 v_mfma_f32_16x16x32_bf16 v[212:215], a[208:211], a[152:155], v[212:215]
 buffer_load_dwordx4 a[208:211], v0, s[12:15], s24 offen
 s_waitcnt vmcnt(15)
 v_mfma_f32_16x16x32_bf16 v[228:231], a[216:219], a[152:155], v[228:231]
 v_accvgpr_read_b32 v5, a31
 v_lshlrev_b32 v6, 16, v5
 v_mfma_f32_16x16x32_bf16 v[228:231], a[220:223], a[156:159], v[228:231]
 v_and_b32 v5, s26, v5
 v_mfma_f32_16x16x32_bf16 v[224:227], a[220:223], a[148:151], v[224:227]
 v_mul_f32 v6, v6, v78
 v_mul_f32 v5, v5, v79
 v_mfma_f32_16x16x32_bf16 v[224:227], a[216:219], a[144:147], v[224:227]
 v_cvt_pk_bf16_f32 v15, v6, v5
 v_mfma_f32_16x16x32_bf16 v[220:223], a[216:219], a[168:171], v[220:223]
 ds_write_b128 v3, v[12:15] offset:7168
 v_mfma_f32_16x16x32_bf16 v[220:223], a[220:223], a[172:175], v[220:223]
 v_accvgpr_read_b32 v5, a32
 v_lshlrev_b32 v6, 16, v5
 v_mfma_f32_16x16x32_bf16 v[216:219], a[220:223], a[164:167], v[216:219]
 buffer_load_dwordx4 a[220:223], v0, s[12:15], s24 offen offset:3072
 v_mfma_f32_16x16x32_bf16 v[216:219], a[216:219], a[160:163], v[216:219]
 buffer_load_dwordx4 a[216:219], v0, s[12:15], s24 offen offset:2048
 s_waitcnt vmcnt(15)
 v_mfma_f32_16x16x32_bf16 v[232:235], a[224:227], a[160:163], v[232:235]
 v_and_b32 v5, s26, v5
 v_mfma_f32_16x16x32_bf16 v[232:235], a[228:231], a[164:167], v[232:235]
 v_mul_f32 v6, v6, v80
 s_add_u32 s24, s24, 4096
 v_mfma_f32_16x16x32_bf16 v[236:239], a[228:231], a[172:175], v[236:239]
 v_mul_f32 v5, v5, v81
 v_mfma_f32_16x16x32_bf16 v[236:239], a[224:227], a[168:171], v[236:239]
 v_cvt_pk_bf16_f32 v8, v6, v5
 v_mfma_f32_16x16x32_bf16 v[240:243], a[224:227], a[144:147], v[240:243]
 v_accvgpr_read_b32 v5, a33
 v_lshlrev_b32 v6, 16, v5
 v_mfma_f32_16x16x32_bf16 v[240:243], a[228:231], a[148:151], v[240:243]
 v_and_b32 v5, s26, v5
 v_mfma_f32_16x16x32_bf16 v[244:247], a[228:231], a[156:159], v[244:247]
 v_mul_f32 v6, v6, v82
 buffer_load_dwordx4 a[228:231], v0, s[12:15], s24 offen offset:1024
 v_mfma_f32_16x16x32_bf16 v[244:247], a[224:227], a[152:155], v[244:247]
 buffer_load_dwordx4 a[224:227], v0, s[12:15], s24 offen
 s_waitcnt vmcnt(15)
 v_mfma_f32_16x16x32_bf16 a[252:255], a[232:235], a[152:155], a[252:255]
 ds_read_b128 a[152:155], v2 offset:19456
 v_mfma_f32_16x16x32_bf16 a[252:255], a[236:239], a[156:159], a[252:255]
 ds_read_b128 a[156:159], v2 offset:23552
 v_mfma_f32_16x16x32_bf16 a[248:251], a[236:239], a[148:151], a[248:251]
 v_mul_f32 v5, v5, v83
 ds_read_b128 a[148:151], v2 offset:22528
 v_mfma_f32_16x16x32_bf16 a[248:251], a[232:235], a[144:147], a[248:251]
 ds_read_b128 a[144:147], v2 offset:18432
 v_mfma_f32_16x16x32_bf16 v[252:255], a[232:235], a[168:171], v[252:255]
 v_cvt_pk_bf16_f32 v9, v6, v5
 v_mfma_f32_16x16x32_bf16 v[252:255], a[236:239], a[172:175], v[252:255]
 v_accvgpr_read_b32 v5, a34
 v_lshlrev_b32 v6, 16, v5
 v_mfma_f32_16x16x32_bf16 v[248:251], a[236:239], a[164:167], v[248:251]
 buffer_load_dwordx4 a[236:239], v0, s[12:15], s24 offen offset:3072
 v_mfma_f32_16x16x32_bf16 v[248:251], a[232:235], a[160:163], v[248:251]
 buffer_load_dwordx4 a[232:235], v0, s[12:15], s24 offen offset:2048
 s_waitcnt vmcnt(15) lgkmcnt(8)
 v_mfma_f32_16x16x32_bf16 v[136:139], a[176:179], a[128:131], v[136:139]
 v_and_b32 v5, s26, v5
 v_mul_f32 v6, v6, v96
 v_mfma_f32_16x16x32_bf16 v[136:139], a[180:183], a[132:135], v[136:139]
 s_add_u32 s24, s24, 53248
 s_waitcnt lgkmcnt(6)
 v_mfma_f32_16x16x32_bf16 v[140:143], a[180:183], a[140:143], v[140:143]
 v_mul_f32 v5, v5, v97
 v_mfma_f32_16x16x32_bf16 v[140:143], a[176:179], a[136:139], v[140:143]
 s_waitcnt lgkmcnt(0)
 v_mfma_f32_16x16x32_bf16 v[144:147], a[176:179], a[144:147], v[144:147]
 v_cvt_pk_bf16_f32 v10, v6, v5
 v_accvgpr_read_b32 v5, a35
 v_mfma_f32_16x16x32_bf16 v[144:147], a[180:183], a[148:151], v[144:147]
 v_mfma_f32_16x16x32_bf16 v[148:151], a[180:183], a[156:159], v[148:151]
 buffer_load_dwordx4 a[180:183], v0, s[12:15], s24 offen offset:1024
 v_mfma_f32_16x16x32_bf16 v[148:151], a[176:179], a[152:155], v[148:151]
 buffer_load_dwordx4 a[176:179], v0, s[12:15], s24 offen
 s_waitcnt vmcnt(15)
 v_mfma_f32_16x16x32_bf16 v[164:167], a[184:187], a[152:155], v[164:167]
 v_lshlrev_b32 v6, 16, v5
 v_and_b32 v5, s26, v5
 v_mfma_f32_16x16x32_bf16 v[164:167], a[188:191], a[156:159], v[164:167]
 v_mul_f32 v6, v6, v98
 v_mfma_f32_16x16x32_bf16 v[160:163], a[188:191], a[148:151], v[160:163]
 ds_read_b128 a[160:163], v2 offset:24576
 v_mfma_f32_16x16x32_bf16 v[160:163], a[184:187], a[144:147], v[160:163]
 v_mul_f32 v5, v5, v99
 v_cvt_pk_bf16_f32 v11, v6, v5
 v_mfma_f32_16x16x32_bf16 v[156:159], a[184:187], a[136:139], v[156:159]
 ds_read_b128 a[164:167], v2 offset:28672
 v_mfma_f32_16x16x32_bf16 v[156:159], a[188:191], a[140:143], v[156:159]
 ds_write_b128 v3, v[8:11] offset:8192
 v_accvgpr_read_b32 v5, a36
 v_mfma_f32_16x16x32_bf16 v[152:155], a[188:191], a[132:135], v[152:155]
 buffer_load_dwordx4 a[188:191], v0, s[12:15], s24 offen offset:3072
 v_mfma_f32_16x16x32_bf16 v[152:155], a[184:187], a[128:131], v[152:155]
 buffer_load_dwordx4 a[184:187], v0, s[12:15], s24 offen offset:2048
 s_waitcnt vmcnt(14)
 v_mfma_f32_16x16x32_bf16 v[168:171], a[192:195], a[128:131], v[168:171]
 ds_read_b128 a[168:171], v2 offset:25600
 ds_read_b128 a[172:175], v2 offset:29696
 v_mfma_f32_16x16x32_bf16 v[168:171], a[196:199], a[132:135], v[168:171]
 s_add_u32 s24, s24, 4096
 v_mfma_f32_16x16x32_bf16 v[172:175], a[196:199], a[140:143], v[172:175]
 v_lshlrev_b32 v6, 16, v5
 v_and_b32 v5, s26, v5
 v_mfma_f32_16x16x32_bf16 v[172:175], a[192:195], a[136:139], v[172:175]
 v_mul_f32 v6, v6, v84
 v_mfma_f32_16x16x32_bf16 v[176:179], a[192:195], a[144:147], v[176:179]
 v_mul_f32 v5, v5, v85
 v_mfma_f32_16x16x32_bf16 v[176:179], a[196:199], a[148:151], v[176:179]
 v_cvt_pk_bf16_f32 v12, v6, v5
 v_accvgpr_read_b32 v5, a37
 v_mfma_f32_16x16x32_bf16 v[180:183], a[196:199], a[156:159], v[180:183]
 buffer_load_dwordx4 a[196:199], v0, s[12:15], s24 offen offset:1024
 v_mfma_f32_16x16x32_bf16 v[180:183], a[192:195], a[152:155], v[180:183]
 buffer_load_dwordx4 a[192:195], v0, s[12:15], s24 offen
 s_waitcnt vmcnt(14)
 v_mfma_f32_16x16x32_bf16 v[196:199], a[200:203], a[152:155], v[196:199]
 v_lshlrev_b32 v6, 16, v5
 v_mfma_f32_16x16x32_bf16 v[196:199], a[204:207], a[156:159], v[196:199]
 v_and_b32 v5, s26, v5
 v_mul_f32 v6, v6, v86
 v_mfma_f32_16x16x32_bf16 v[192:195], a[204:207], a[148:151], v[192:195]
 v_mul_f32 v5, v5, v87
 v_mfma_f32_16x16x32_bf16 v[192:195], a[200:203], a[144:147], v[192:195]
 v_cvt_pk_bf16_f32 v13, v6, v5
 v_accvgpr_read_b32 v5, a38
 v_mfma_f32_16x16x32_bf16 v[188:191], a[200:203], a[136:139], v[188:191]
 v_lshlrev_b32 v6, 16, v5
 v_mfma_f32_16x16x32_bf16 v[188:191], a[204:207], a[140:143], v[188:191]
 v_and_b32 v5, s26, v5
 v_mfma_f32_16x16x32_bf16 v[184:187], a[204:207], a[132:135], v[184:187]
 v_mul_f32 v6, v6, v100
 buffer_load_dwordx4 a[204:207], v0, s[12:15], s24 offen offset:3072
 v_mfma_f32_16x16x32_bf16 v[184:187], a[200:203], a[128:131], v[184:187]
 buffer_load_dwordx4 a[200:203], v0, s[12:15], s24 offen offset:2048
 s_waitcnt vmcnt(14)
 v_mfma_f32_16x16x32_bf16 v[200:203], a[208:211], a[128:131], v[200:203]
 v_mul_f32 v5, v5, v101
 v_mfma_f32_16x16x32_bf16 v[200:203], a[212:215], a[132:135], v[200:203]
 s_add_u32 s24, s24, 4096
 v_mfma_f32_16x16x32_bf16 v[204:207], a[212:215], a[140:143], v[204:207]
 v_cvt_pk_bf16_f32 v14, v6, v5
 v_accvgpr_read_b32 v5, a39
 v_mfma_f32_16x16x32_bf16 v[204:207], a[208:211], a[136:139], v[204:207]
 v_lshlrev_b32 v6, 16, v5
 v_mfma_f32_16x16x32_bf16 v[208:211], a[208:211], a[144:147], v[208:211]
 v_and_b32 v5, s26, v5
 v_mul_f32 v6, v6, v102
 v_mfma_f32_16x16x32_bf16 v[208:211], a[212:215], a[148:151], v[208:211]
 v_mul_f32 v5, v5, v103
 v_mfma_f32_16x16x32_bf16 v[212:215], a[212:215], a[156:159], v[212:215]
 buffer_load_dwordx4 a[212:215], v0, s[12:15], s24 offen offset:1024
 v_mfma_f32_16x16x32_bf16 v[212:215], a[208:211], a[152:155], v[212:215]
 buffer_load_dwordx4 a[208:211], v0, s[12:15], s24 offen
 s_waitcnt vmcnt(14)
 v_mfma_f32_16x16x32_bf16 v[228:231], a[216:219], a[152:155], v[228:231]
 v_cvt_pk_bf16_f32 v15, v6, v5
 ds_write_b128 v3, v[12:15] offset:9216
 v_mfma_f32_16x16x32_bf16 v[228:231], a[220:223], a[156:159], v[228:231]
 v_accvgpr_read_b32 v5, a40
 v_mfma_f32_16x16x32_bf16 v[224:227], a[220:223], a[148:151], v[224:227]
 v_lshlrev_b32 v6, 16, v5
 v_mfma_f32_16x16x32_bf16 v[224:227], a[216:219], a[144:147], v[224:227]
 v_and_b32 v5, s26, v5
 v_mul_f32 v6, v6, v88
 v_mfma_f32_16x16x32_bf16 v[220:223], a[216:219], a[136:139], v[220:223]
 v_mul_f32 v5, v5, v89
 v_mfma_f32_16x16x32_bf16 v[220:223], a[220:223], a[140:143], v[220:223]
 v_cvt_pk_bf16_f32 v8, v6, v5
 v_mfma_f32_16x16x32_bf16 v[216:219], a[220:223], a[132:135], v[216:219]
 v_accvgpr_read_b32 v5, a41
 buffer_load_dwordx4 a[220:223], v0, s[12:15], s24 offen offset:3072
 v_mfma_f32_16x16x32_bf16 v[216:219], a[216:219], a[128:131], v[216:219]
 buffer_load_dwordx4 a[216:219], v0, s[12:15], s24 offen offset:2048
 s_waitcnt vmcnt(14)
 v_mfma_f32_16x16x32_bf16 v[232:235], a[224:227], a[128:131], v[232:235]
 v_lshlrev_b32 v6, 16, v5
 v_mfma_f32_16x16x32_bf16 v[232:235], a[228:231], a[132:135], v[232:235]
 v_and_b32 v5, s26, v5
 s_add_u32 s24, s24, 4096
 v_mfma_f32_16x16x32_bf16 v[236:239], a[228:231], a[140:143], v[236:239]
 v_mul_f32 v6, v6, v90
 v_mfma_f32_16x16x32_bf16 v[236:239], a[224:227], a[136:139], v[236:239]
 v_mul_f32 v5, v5, v91
 v_mfma_f32_16x16x32_bf16 v[240:243], a[224:227], a[144:147], v[240:243]
 v_cvt_pk_bf16_f32 v9, v6, v5
 v_accvgpr_read_b32 v5, a42
 v_mfma_f32_16x16x32_bf16 v[240:243], a[228:231], a[148:151], v[240:243]
 v_lshlrev_b32 v6, 16, v5
 v_mfma_f32_16x16x32_bf16 v[244:247], a[228:231], a[156:159], v[244:247]
 buffer_load_dwordx4 a[228:231], v0, s[12:15], s24 offen offset:1024
 v_mfma_f32_16x16x32_bf16 v[244:247], a[224:227], a[152:155], v[244:247]
 buffer_load_dwordx4 a[224:227], v0, s[12:15], s24 offen
 s_waitcnt vmcnt(14)
 v_mfma_f32_16x16x32_bf16 a[252:255], a[232:235], a[152:155], a[252:255]
 v_and_b32 v5, s26, v5
 ds_read_b128 a[152:155], v2 offset:27648
 v_mfma_f32_16x16x32_bf16 a[252:255], a[236:239], a[156:159], a[252:255]
 ds_read_b128 a[156:159], v2 offset:31744
 v_mfma_f32_16x16x32_bf16 a[248:251], a[236:239], a[148:151], a[248:251]
 ds_read_b128 a[148:151], v2 offset:30720
 v_mfma_f32_16x16x32_bf16 a[248:251], a[232:235], a[144:147], a[248:251]
 v_mul_f32 v6, v6, v104
 ds_read_b128 a[144:147], v2 offset:26624
 v_mfma_f32_16x16x32_bf16 v[252:255], a[232:235], a[136:139], v[252:255]
 v_mul_f32 v5, v5, v105
 v_mfma_f32_16x16x32_bf16 v[252:255], a[236:239], a[140:143], v[252:255]
 v_cvt_pk_bf16_f32 v10, v6, v5
 v_accvgpr_read_b32 v5, a43
 v_mfma_f32_16x16x32_bf16 v[248:251], a[236:239], a[132:135], v[248:251]
 buffer_load_dwordx4 a[236:239], v0, s[12:15], s24 offen offset:3072
 v_mfma_f32_16x16x32_bf16 v[248:251], a[232:235], a[128:131], v[248:251]
 buffer_load_dwordx4 a[232:235], v0, s[12:15], s24 offen offset:2048
 s_waitcnt vmcnt(14) lgkmcnt(8)
 v_mfma_f32_16x16x32_bf16 v[136:139], a[176:179], a[160:163], v[136:139]
 v_lshlrev_b32 v6, 16, v5
 v_mfma_f32_16x16x32_bf16 v[136:139], a[180:183], a[164:167], v[136:139]
 s_add_u32 s24, s24, 53248
 s_waitcnt lgkmcnt(5)
 v_mfma_f32_16x16x32_bf16 v[140:143], a[180:183], a[172:175], v[140:143]
 v_and_b32 v5, s26, v5
 v_mul_f32 v6, v6, v106
 v_mfma_f32_16x16x32_bf16 v[140:143], a[176:179], a[168:171], v[140:143]
 s_waitcnt lgkmcnt(0)
 v_mfma_f32_16x16x32_bf16 v[144:147], a[176:179], a[144:147], v[144:147]
 v_mul_f32 v5, v5, v107
 v_mfma_f32_16x16x32_bf16 v[144:147], a[180:183], a[148:151], v[144:147]
 v_cvt_pk_bf16_f32 v11, v6, v5
 v_mfma_f32_16x16x32_bf16 v[148:151], a[180:183], a[156:159], v[148:151]
 buffer_load_dwordx4 a[180:183], v0, s[12:15], s24 offen offset:1024
 v_mfma_f32_16x16x32_bf16 v[148:151], a[176:179], a[152:155], v[148:151]
 buffer_load_dwordx4 a[176:179], v0, s[12:15], s24 offen
 s_waitcnt vmcnt(14)
 v_mfma_f32_16x16x32_bf16 v[164:167], a[184:187], a[152:155], v[164:167]
 ds_write_b128 v3, v[8:11] offset:10240
 v_accvgpr_read_b32 v5, a44
 v_mfma_f32_16x16x32_bf16 v[164:167], a[188:191], a[156:159], v[164:167]
 v_lshlrev_b32 v6, 16, v5
 v_mfma_f32_16x16x32_bf16 v[160:163], a[188:191], a[148:151], v[160:163]
 ds_read_b128 a[128:131], v2 offset:49152
 v_mfma_f32_16x16x32_bf16 v[160:163], a[184:187], a[144:147], v[160:163]
 v_and_b32 v5, s26, v5
 v_mul_f32 v6, v6, v92
 v_mfma_f32_16x16x32_bf16 v[156:159], a[184:187], a[168:171], v[156:159]
 ds_read_b128 a[132:135], v2 offset:53248
 v_mfma_f32_16x16x32_bf16 v[156:159], a[188:191], a[172:175], v[156:159]
 v_mul_f32 v5, v5, v93
 v_mfma_f32_16x16x32_bf16 v[152:155], a[188:191], a[164:167], v[152:155]
 v_cvt_pk_bf16_f32 v12, v6, v5
 buffer_load_dwordx4 a[188:191], v0, s[12:15], s24 offen offset:3072
 v_mfma_f32_16x16x32_bf16 v[152:155], a[184:187], a[160:163], v[152:155]
 buffer_load_dwordx4 a[184:187], v0, s[12:15], s24 offen offset:2048
 s_waitcnt vmcnt(14)
 v_mfma_f32_16x16x32_bf16 v[168:171], a[192:195], a[160:163], v[168:171]
 ds_read_b128 a[136:139], v2 offset:50176
 ds_read_b128 a[140:143], v2 offset:54272
 v_mfma_f32_16x16x32_bf16 v[168:171], a[196:199], a[164:167], v[168:171]
 s_add_u32 s24, s24, 4096
 v_mfma_f32_16x16x32_bf16 v[172:175], a[196:199], a[172:175], v[172:175]
 v_accvgpr_read_b32 v5, a45
 v_mfma_f32_16x16x32_bf16 v[172:175], a[192:195], a[168:171], v[172:175]
 v_lshlrev_b32 v6, 16, v5
 v_and_b32 v5, s26, v5
 v_mfma_f32_16x16x32_bf16 v[176:179], a[192:195], a[144:147], v[176:179]
 v_mul_f32 v6, v6, v94
 v_mfma_f32_16x16x32_bf16 v[176:179], a[196:199], a[148:151], v[176:179]
 v_mul_f32 v5, v5, v95
 v_cvt_pk_bf16_f32 v13, v6, v5
 v_mfma_f32_16x16x32_bf16 v[180:183], a[196:199], a[156:159], v[180:183]
 buffer_load_dwordx4 a[196:199], v0, s[12:15], s24 offen offset:1024
 v_mfma_f32_16x16x32_bf16 v[180:183], a[192:195], a[152:155], v[180:183]
 buffer_load_dwordx4 a[192:195], v0, s[12:15], s24 offen
 s_waitcnt vmcnt(14)
 v_mfma_f32_16x16x32_bf16 v[196:199], a[200:203], a[152:155], v[196:199]
 v_accvgpr_read_b32 v5, a46
 v_mfma_f32_16x16x32_bf16 v[196:199], a[204:207], a[156:159], v[196:199]
 v_lshlrev_b32 v6, 16, v5
 v_and_b32 v5, s26, v5
 v_mfma_f32_16x16x32_bf16 v[192:195], a[204:207], a[148:151], v[192:195]
 v_mul_f32 v6, v6, v108
 v_mfma_f32_16x16x32_bf16 v[192:195], a[200:203], a[144:147], v[192:195]
 v_mul_f32 v5, v5, v109
 v_mfma_f32_16x16x32_bf16 v[188:191], a[200:203], a[168:171], v[188:191]
 v_cvt_pk_bf16_f32 v14, v6, v5
 v_accvgpr_read_b32 v5, a47
 v_mfma_f32_16x16x32_bf16 v[188:191], a[204:207], a[172:175], v[188:191]
 v_lshlrev_b32 v6, 16, v5
 v_mfma_f32_16x16x32_bf16 v[184:187], a[204:207], a[164:167], v[184:187]
 buffer_load_dwordx4 a[204:207], v0, s[12:15], s24 offen offset:3072
 v_mfma_f32_16x16x32_bf16 v[184:187], a[200:203], a[160:163], v[184:187]
 buffer_load_dwordx4 a[200:203], v0, s[12:15], s24 offen offset:2048
 s_waitcnt vmcnt(14)
 v_mfma_f32_16x16x32_bf16 v[200:203], a[208:211], a[160:163], v[200:203]
 v_and_b32 v5, s26, v5
 v_mul_f32 v6, v6, v110
 v_mfma_f32_16x16x32_bf16 v[200:203], a[212:215], a[164:167], v[200:203]
 s_add_u32 s24, s24, 4096
 v_mfma_f32_16x16x32_bf16 v[204:207], a[212:215], a[172:175], v[204:207]
 v_mul_f32 v5, v5, v111
 v_cvt_pk_bf16_f32 v15, v6, v5
 v_mfma_f32_16x16x32_bf16 v[204:207], a[208:211], a[168:171], v[204:207]
 ds_write_b128 v3, v[12:15] offset:11264
 v_mfma_f32_16x16x32_bf16 v[208:211], a[208:211], a[144:147], v[208:211]
 v_accvgpr_read_b32 v5, a48
 v_mfma_f32_16x16x32_bf16 v[208:211], a[212:215], a[148:151], v[208:211]
 v_lshlrev_b32 v6, 16, v5
 v_and_b32 v5, s26, v5
 v_mfma_f32_16x16x32_bf16 v[212:215], a[212:215], a[156:159], v[212:215]
 buffer_load_dwordx4 a[212:215], v0, s[12:15], s24 offen offset:1024
 v_mfma_f32_16x16x32_bf16 v[212:215], a[208:211], a[152:155], v[212:215]
 buffer_load_dwordx4 a[208:211], v0, s[12:15], s24 offen
 s_waitcnt vmcnt(14)
 v_mfma_f32_16x16x32_bf16 v[228:231], a[216:219], a[152:155], v[228:231]
 v_mul_f32 v6, v6, v112
 v_mfma_f32_16x16x32_bf16 v[228:231], a[220:223], a[156:159], v[228:231]
 v_mul_f32 v5, v5, v113
 v_cvt_pk_bf16_f32 v8, v6, v5
 v_mfma_f32_16x16x32_bf16 v[224:227], a[220:223], a[148:151], v[224:227]
 v_accvgpr_read_b32 v5, a49
 v_mfma_f32_16x16x32_bf16 v[224:227], a[216:219], a[144:147], v[224:227]
 v_lshlrev_b32 v6, 16, v5
 v_and_b32 v5, s26, v5
 v_mfma_f32_16x16x32_bf16 v[220:223], a[216:219], a[168:171], v[220:223]
 v_mul_f32 v6, v6, v114
 v_mfma_f32_16x16x32_bf16 v[220:223], a[220:223], a[172:175], v[220:223]
 v_mul_f32 v5, v5, v115
 v_mfma_f32_16x16x32_bf16 v[216:219], a[220:223], a[164:167], v[216:219]
 v_cvt_pk_bf16_f32 v9, v6, v5
 buffer_load_dwordx4 a[220:223], v0, s[12:15], s24 offen offset:3072
 v_mfma_f32_16x16x32_bf16 v[216:219], a[216:219], a[160:163], v[216:219]
 buffer_load_dwordx4 a[216:219], v0, s[12:15], s24 offen offset:2048
 s_waitcnt vmcnt(14)
 v_mfma_f32_16x16x32_bf16 v[232:235], a[224:227], a[160:163], v[232:235]
 v_accvgpr_read_b32 v5, a50
 v_mfma_f32_16x16x32_bf16 v[232:235], a[228:231], a[164:167], v[232:235]
 s_add_u32 s24, s24, 4096
 v_mfma_f32_16x16x32_bf16 v[236:239], a[228:231], a[172:175], v[236:239]
 v_lshlrev_b32 v6, 16, v5
 v_and_b32 v5, s26, v5
 v_mfma_f32_16x16x32_bf16 v[236:239], a[224:227], a[168:171], v[236:239]
 v_mul_f32 v6, v6, v128
 v_mfma_f32_16x16x32_bf16 v[240:243], a[224:227], a[144:147], v[240:243]
 v_mul_f32 v5, v5, v129
 v_mfma_f32_16x16x32_bf16 v[240:243], a[228:231], a[148:151], v[240:243]
 v_cvt_pk_bf16_f32 v10, v6, v5
 v_accvgpr_read_b32 v5, a51
 v_mfma_f32_16x16x32_bf16 v[244:247], a[228:231], a[156:159], v[244:247]
 buffer_load_dwordx4 a[228:231], v0, s[12:15], s24 offen offset:1024
 v_mfma_f32_16x16x32_bf16 v[244:247], a[224:227], a[152:155], v[244:247]
 buffer_load_dwordx4 a[224:227], v0, s[12:15], s24 offen
 s_waitcnt vmcnt(14)
 v_mfma_f32_16x16x32_bf16 a[252:255], a[232:235], a[152:155], a[252:255]
 v_lshlrev_b32 v6, 16, v5
 ds_read_b128 a[152:155], v2 offset:52224
 v_mfma_f32_16x16x32_bf16 a[252:255], a[236:239], a[156:159], a[252:255]
 ds_read_b128 a[156:159], v2 offset:56320
 v_mfma_f32_16x16x32_bf16 a[248:251], a[236:239], a[148:151], a[248:251]
 ds_read_b128 a[148:151], v2 offset:55296
 v_mfma_f32_16x16x32_bf16 a[248:251], a[232:235], a[144:147], a[248:251]
 v_and_b32 v5, s26, v5
 ds_read_b128 a[144:147], v2 offset:51200
 v_mfma_f32_16x16x32_bf16 v[252:255], a[232:235], a[168:171], v[252:255]
 v_mul_f32 v6, v6, v130
 v_mfma_f32_16x16x32_bf16 v[252:255], a[236:239], a[172:175], v[252:255]
 v_mul_f32 v5, v5, v131
 v_mfma_f32_16x16x32_bf16 v[248:251], a[236:239], a[164:167], v[248:251]
 v_cvt_pk_bf16_f32 v11, v6, v5
 buffer_load_dwordx4 a[236:239], v0, s[12:15], s24 offen offset:3072
 v_mfma_f32_16x16x32_bf16 v[248:251], a[232:235], a[160:163], v[248:251]
 buffer_load_dwordx4 a[232:235], v0, s[12:15], s24 offen offset:2048
 s_waitcnt vmcnt(14) lgkmcnt(7)
 v_mfma_f32_16x16x32_bf16 v[136:139], a[176:179], a[128:131], v[136:139]
 ds_write_b128 v3, v[8:11] offset:12288
 v_mfma_f32_16x16x32_bf16 v[136:139], a[180:183], a[132:135], v[136:139]
 s_add_u32 s24, s24, 53248
 s_waitcnt lgkmcnt(6)
 v_mfma_f32_16x16x32_bf16 v[140:143], a[180:183], a[140:143], v[140:143]
 v_accvgpr_read_b32 v5, a52
 v_lshlrev_b32 v6, 16, v5
 v_mfma_f32_16x16x32_bf16 v[140:143], a[176:179], a[136:139], v[140:143]
 s_waitcnt lgkmcnt(1)
 v_mfma_f32_16x16x32_bf16 v[144:147], a[176:179], a[144:147], v[144:147]
 v_and_b32 v5, s26, v5
 v_mfma_f32_16x16x32_bf16 v[144:147], a[180:183], a[148:151], v[144:147]
 v_mul_f32 v6, v6, v116
 v_mfma_f32_16x16x32_bf16 v[148:151], a[180:183], a[156:159], v[148:151]
 buffer_load_dwordx4 a[180:183], v0, s[12:15], s24 offen offset:1024
 v_mfma_f32_16x16x32_bf16 v[148:151], a[176:179], a[152:155], v[148:151]
 buffer_load_dwordx4 a[176:179], v0, s[12:15], s24 offen
 s_waitcnt vmcnt(14)
 v_mfma_f32_16x16x32_bf16 v[164:167], a[184:187], a[152:155], v[164:167]
 v_mul_f32 v5, v5, v117
 v_mfma_f32_16x16x32_bf16 v[164:167], a[188:191], a[156:159], v[164:167]
 v_cvt_pk_bf16_f32 v12, v6, v5
 v_accvgpr_read_b32 v5, a53
 v_mfma_f32_16x16x32_bf16 v[160:163], a[188:191], a[148:151], v[160:163]
 ds_read_b128 a[160:163], v2 offset:57344
 v_mfma_f32_16x16x32_bf16 v[160:163], a[184:187], a[144:147], v[160:163]
 v_lshlrev_b32 v6, 16, v5
 v_mfma_f32_16x16x32_bf16 v[156:159], a[184:187], a[136:139], v[156:159]
 v_and_b32 v5, s26, v5
 ds_read_b128 a[164:167], v2 offset:61440
 v_mfma_f32_16x16x32_bf16 v[156:159], a[188:191], a[140:143], v[156:159]
 v_mul_f32 v6, v6, v118
 v_mfma_f32_16x16x32_bf16 v[152:155], a[188:191], a[132:135], v[152:155]
 v_mul_f32 v5, v5, v119
 buffer_load_dwordx4 a[188:191], v0, s[12:15], s24 offen offset:3072
 v_mfma_f32_16x16x32_bf16 v[152:155], a[184:187], a[128:131], v[152:155]
 buffer_load_dwordx4 a[184:187], v0, s[12:15], s24 offen offset:2048
 s_waitcnt vmcnt(14)
 v_mfma_f32_16x16x32_bf16 v[168:171], a[192:195], a[128:131], v[168:171]
 ds_read_b128 a[168:171], v2 offset:58368
 ds_read_b128 a[172:175], v2 offset:62464
 v_mfma_f32_16x16x32_bf16 v[168:171], a[196:199], a[132:135], v[168:171]
 s_add_u32 s24, s24, 4096
 v_mfma_f32_16x16x32_bf16 v[172:175], a[196:199], a[140:143], v[172:175]
 v_cvt_pk_bf16_f32 v13, v6, v5
 v_mfma_f32_16x16x32_bf16 v[172:175], a[192:195], a[136:139], v[172:175]
 v_accvgpr_read_b32 v5, a54
 v_lshlrev_b32 v6, 16, v5
 v_mfma_f32_16x16x32_bf16 v[176:179], a[192:195], a[144:147], v[176:179]
 v_and_b32 v5, s26, v5
 v_mfma_f32_16x16x32_bf16 v[176:179], a[196:199], a[148:151], v[176:179]
 v_mul_f32 v6, v6, v132
 v_mfma_f32_16x16x32_bf16 v[180:183], a[196:199], a[156:159], v[180:183]
 v_mul_f32 v5, v5, v133
 buffer_load_dwordx4 a[196:199], v0, s[12:15], s24 offen offset:1024
 v_mfma_f32_16x16x32_bf16 v[180:183], a[192:195], a[152:155], v[180:183]
 buffer_load_dwordx4 a[192:195], v0, s[12:15], s24 offen
 s_waitcnt vmcnt(14)
 v_mfma_f32_16x16x32_bf16 v[196:199], a[200:203], a[152:155], v[196:199]
 v_cvt_pk_bf16_f32 v14, v6, v5
 v_mfma_f32_16x16x32_bf16 v[196:199], a[204:207], a[156:159], v[196:199]
 v_accvgpr_read_b32 v5, a55
 v_mfma_f32_16x16x32_bf16 v[192:195], a[204:207], a[148:151], v[192:195]
 v_lshlrev_b32 v6, 16, v5
 v_and_b32 v5, s26, v5
 v_mfma_f32_16x16x32_bf16 v[192:195], a[200:203], a[144:147], v[192:195]
 v_mul_f32 v6, v6, v134
 v_mfma_f32_16x16x32_bf16 v[188:191], a[200:203], a[136:139], v[188:191]
 v_mul_f32 v5, v5, v135
 v_cvt_pk_bf16_f32 v15, v6, v5
 v_mfma_f32_16x16x32_bf16 v[188:191], a[204:207], a[140:143], v[188:191]
 ds_write_b128 v3, v[12:15] offset:13312
 v_mfma_f32_16x16x32_bf16 v[184:187], a[204:207], a[132:135], v[184:187]
 buffer_load_dwordx4 a[204:207], v0, s[12:15], s24 offen offset:3072
 v_mfma_f32_16x16x32_bf16 v[184:187], a[200:203], a[128:131], v[184:187]
 buffer_load_dwordx4 a[200:203], v0, s[12:15], s24 offen offset:2048
 s_waitcnt vmcnt(14)
 v_mfma_f32_16x16x32_bf16 v[200:203], a[208:211], a[128:131], v[200:203]
 v_accvgpr_read_b32 v5, a56
 v_lshlrev_b32 v6, 16, v5
 v_mfma_f32_16x16x32_bf16 v[200:203], a[212:215], a[132:135], v[200:203]
 s_add_u32 s24, s24, 4096
 v_mfma_f32_16x16x32_bf16 v[204:207], a[212:215], a[140:143], v[204:207]
 v_and_b32 v5, s26, v5
 v_mfma_f32_16x16x32_bf16 v[204:207], a[208:211], a[136:139], v[204:207]
 v_mul_f32 v6, v6, v120
 v_mul_f32 v5, v5, v121
 v_mfma_f32_16x16x32_bf16 v[208:211], a[208:211], a[144:147], v[208:211]
 v_cvt_pk_bf16_f32 v8, v6, v5
 v_mfma_f32_16x16x32_bf16 v[208:211], a[212:215], a[148:151], v[208:211]
 v_accvgpr_read_b32 v5, a57
 v_lshlrev_b32 v6, 16, v5
 v_mfma_f32_16x16x32_bf16 v[212:215], a[212:215], a[156:159], v[212:215]
 buffer_load_dwordx4 a[212:215], v0, s[12:15], s24 offen offset:1024
 v_mfma_f32_16x16x32_bf16 v[212:215], a[208:211], a[152:155], v[212:215]
 buffer_load_dwordx4 a[208:211], v0, s[12:15], s24 offen
 s_waitcnt vmcnt(14)
 v_mfma_f32_16x16x32_bf16 v[228:231], a[216:219], a[152:155], v[228:231]
 v_and_b32 v5, s26, v5
 v_mfma_f32_16x16x32_bf16 v[228:231], a[220:223], a[156:159], v[228:231]
 v_mul_f32 v6, v6, v122
 v_mul_f32 v5, v5, v123
 v_mfma_f32_16x16x32_bf16 v[224:227], a[220:223], a[148:151], v[224:227]
 v_cvt_pk_bf16_f32 v9, v6, v5
 v_mfma_f32_16x16x32_bf16 v[224:227], a[216:219], a[144:147], v[224:227]
 v_accvgpr_read_b32 v5, a58
 v_mfma_f32_16x16x32_bf16 v[220:223], a[216:219], a[136:139], v[220:223]
 v_accvgpr_read_b32 v7, a240
 v_lshlrev_b32 v6, 16, v5
 v_mfma_f32_16x16x32_bf16 v[220:223], a[220:223], a[140:143], v[220:223]
 v_and_b32 v5, s26, v5
 v_mfma_f32_16x16x32_bf16 v[216:219], a[220:223], a[132:135], v[216:219]
 buffer_load_dwordx4 a[220:223], v0, s[12:15], s24 offen offset:3072
 v_mfma_f32_16x16x32_bf16 v[216:219], a[216:219], a[128:131], v[216:219]
 buffer_load_dwordx4 a[216:219], v0, s[12:15], s24 offen offset:2048
 s_waitcnt vmcnt(14)
 v_mfma_f32_16x16x32_bf16 v[232:235], a[224:227], a[128:131], v[232:235]
 v_mul_f32 v6, v6, v7
 v_accvgpr_read_b32 v7, a241
 v_mfma_f32_16x16x32_bf16 v[232:235], a[228:231], a[132:135], v[232:235]
 s_add_u32 s24, s24, 4096
 v_mfma_f32_16x16x32_bf16 v[236:239], a[228:231], a[140:143], v[236:239]
 v_mul_f32 v5, v5, v7
 v_cvt_pk_bf16_f32 v10, v6, v5
 v_mfma_f32_16x16x32_bf16 v[236:239], a[224:227], a[136:139], v[236:239]
 v_accvgpr_read_b32 v5, a59
 v_mfma_f32_16x16x32_bf16 v[240:243], a[224:227], a[144:147], v[240:243]
 v_accvgpr_read_b32 v7, a242
 v_mfma_f32_16x16x32_bf16 v[240:243], a[228:231], a[148:151], v[240:243]
 v_lshlrev_b32 v6, 16, v5
 v_and_b32 v5, s26, v5
 v_mfma_f32_16x16x32_bf16 v[244:247], a[228:231], a[156:159], v[244:247]
 buffer_load_dwordx4 a[228:231], v0, s[12:15], s24 offen offset:1024
 v_mfma_f32_16x16x32_bf16 v[244:247], a[224:227], a[152:155], v[244:247]
 buffer_load_dwordx4 a[224:227], v0, s[12:15], s24 offen
 s_waitcnt vmcnt(14)
 v_mfma_f32_16x16x32_bf16 a[252:255], a[232:235], a[152:155], a[252:255]
 ds_read_b128 a[152:155], v2 offset:60416
 v_mfma_f32_16x16x32_bf16 a[252:255], a[236:239], a[156:159], a[252:255]
 v_mul_f32 v6, v6, v7
 ds_read_b128 a[156:159], v2 offset:64512
 v_mfma_f32_16x16x32_bf16 a[248:251], a[236:239], a[148:151], a[248:251]
 ds_read_b128 a[148:151], v2 offset:63488
 v_mfma_f32_16x16x32_bf16 a[248:251], a[232:235], a[144:147], a[248:251]
 ds_read_b128 a[144:147], v2 offset:59392
 v_mfma_f32_16x16x32_bf16 v[252:255], a[232:235], a[136:139], v[252:255]
 v_accvgpr_read_b32 v7, a243
 v_mul_f32 v5, v5, v7
 v_mfma_f32_16x16x32_bf16 v[252:255], a[236:239], a[140:143], v[252:255]
 v_cvt_pk_bf16_f32 v11, v6, v5
 v_mfma_f32_16x16x32_bf16 v[248:251], a[236:239], a[132:135], v[248:251]
 ds_write_b128 v3, v[8:11] offset:14336
 buffer_load_dwordx4 a[236:239], v0, s[12:15], s24 offen offset:3072
 v_mfma_f32_16x16x32_bf16 v[248:251], a[232:235], a[128:131], v[248:251]
 buffer_load_dwordx4 a[232:235], v0, s[12:15], s24 offen offset:2048
 s_waitcnt vmcnt(14) lgkmcnt(8)
 v_mfma_f32_16x16x32_bf16 v[136:139], a[176:179], a[160:163], v[136:139]
 v_accvgpr_read_b32 v5, a60
 v_mfma_f32_16x16x32_bf16 v[136:139], a[180:183], a[164:167], v[136:139]
 s_add_u32 s24, s24, 53248
 s_waitcnt lgkmcnt(6)
 v_mfma_f32_16x16x32_bf16 v[140:143], a[180:183], a[172:175], v[140:143]
 v_cmp_gt_u32 vcc, s27, v4
 s_cbranch_vccnz Lspin_loop
Lok_loop:
 s_add_u32 s27, s27, 64
 v_mfma_f32_16x16x32_bf16 v[140:143], a[176:179], a[168:171], v[140:143]
 s_waitcnt lgkmcnt(1)
 v_mfma_f32_16x16x32_bf16 v[144:147], a[176:179], a[144:147], v[144:147]
 v_lshlrev_b32 v6, 16, v5
 v_and_b32 v5, s26, v5
 v_mfma_f32_16x16x32_bf16 v[144:147], a[180:183], a[148:151], v[144:147]
 v_mfma_f32_16x16x32_bf16 v[148:151], a[180:183], a[156:159], v[148:151]
 buffer_load_dwordx4 a[180:183], v0, s[12:15], s24 offen offset:1024
 v_mfma_f32_16x16x32_bf16 v[148:151], a[176:179], a[152:155], v[148:151]
 buffer_load_dwordx4 a[176:179], v0, s[12:15], s24 offen
 s_waitcnt vmcnt(14)
 v_mfma_f32_16x16x32_bf16 v[164:167], a[184:187], a[152:155], v[164:167]
 v_mul_f32 v6, v6, v124
 v_mul_f32 v5, v5, v125
 v_mfma_f32_16x16x32_bf16 v[164:167], a[188:191], a[156:159], v[164:167]
 v_cvt_pk_bf16_f32 v12, v6, v5
 v_mfma_f32_16x16x32_bf16 v[160:163], a[188:191], a[148:151], v[160:163]
 v_accvgpr_read_b32 v5, a61
 v_lshlrev_b32 v6, 16, v5
 v_mfma_f32_16x16x32_bf16 v[160:163], a[184:187], a[144:147], v[160:163]
 v_and_b32 v5, s26, v5
 v_mfma_f32_16x16x32_bf16 v[156:159], a[184:187], a[168:171], v[156:159]
 v_mul_f32 v6, v6, v126
 v_mfma_f32_16x16x32_bf16 v[156:159], a[188:191], a[172:175], v[156:159]
 v_mul_f32 v5, v5, v127
 v_cvt_pk_bf16_f32 v13, v6, v5
 v_mfma_f32_16x16x32_bf16 v[152:155], a[188:191], a[164:167], v[152:155]
 buffer_load_dwordx4 a[188:191], v0, s[12:15], s24 offen offset:3072
 v_mfma_f32_16x16x32_bf16 v[152:155], a[184:187], a[160:163], v[152:155]
 buffer_load_dwordx4 a[184:187], v0, s[12:15], s24 offen offset:2048
 s_waitcnt vmcnt(14)
 v_mfma_f32_16x16x32_bf16 v[168:171], a[192:195], a[160:163], v[168:171]
 v_accvgpr_read_b32 v5, a62
 v_mfma_f32_16x16x32_bf16 v[168:171], a[196:199], a[164:167], v[168:171]
 v_accvgpr_read_b32 v7, a244
 s_add_u32 s24, s24, 4096
 v_mfma_f32_16x16x32_bf16 v[172:175], a[196:199], a[172:175], v[172:175]
 v_lshlrev_b32 v6, 16, v5
 v_mfma_f32_16x16x32_bf16 v[172:175], a[192:195], a[168:171], v[172:175]
 v_and_b32 v5, s26, v5
 v_mfma_f32_16x16x32_bf16 v[176:179], a[192:195], a[144:147], v[176:179]
 v_mul_f32 v6, v6, v7
 v_accvgpr_read_b32 v7, a245
 v_mfma_f32_16x16x32_bf16 v[176:179], a[196:199], a[148:151], v[176:179]
 v_mul_f32 v5, v5, v7
 v_mfma_f32_16x16x32_bf16 v[180:183], a[196:199], a[156:159], v[180:183]
 v_cvt_pk_bf16_f32 v14, v6, v5
 buffer_load_dwordx4 a[196:199], v0, s[12:15], s24 offen offset:1024
 v_mfma_f32_16x16x32_bf16 v[180:183], a[192:195], a[152:155], v[180:183]
 buffer_load_dwordx4 a[192:195], v0, s[12:15], s24 offen
 s_waitcnt vmcnt(14)
 v_mfma_f32_16x16x32_bf16 v[196:199], a[200:203], a[152:155], v[196:199]
 v_accvgpr_read_b32 v5, a63
 v_mfma_f32_16x16x32_bf16 v[196:199], a[204:207], a[156:159], v[196:199]
 v_accvgpr_read_b32 v7, a246
 v_mfma_f32_16x16x32_bf16 v[192:195], a[204:207], a[148:151], v[192:195]
 v_lshlrev_b32 v6, 16, v5
 v_and_b32 v5, s26, v5
 v_mfma_f32_16x16x32_bf16 v[192:195], a[200:203], a[144:147], v[192:195]
 v_mul_f32 v6, v6, v7
 v_mfma_f32_16x16x32_bf16 v[188:191], a[200:203], a[168:171], v[188:191]
 v_accvgpr_read_b32 v7, a247
 v_mfma_f32_16x16x32_bf16 v[188:191], a[204:207], a[172:175], v[188:191]
 v_mul_f32 v5, v5, v7
 v_cvt_pk_bf16_f32 v15, v6, v5
 v_mfma_f32_16x16x32_bf16 v[184:187], a[204:207], a[164:167], v[184:187]
 buffer_load_dwordx4 a[204:207], v0, s[12:15], s24 offen offset:3072
 v_mfma_f32_16x16x32_bf16 v[184:187], a[200:203], a[160:163], v[184:187]
 buffer_load_dwordx4 a[200:203], v0, s[12:15], s24 offen offset:2048
 s_waitcnt vmcnt(14)
 v_mfma_f32_16x16x32_bf16 v[200:203], a[208:211], a[160:163], v[200:203]
 ds_write_b128 v3, v[12:15] offset:15360
 v_mfma_f32_16x16x32_bf16 v[200:203], a[212:215], a[164:167], v[200:203]
 s_add_u32 s24, s24, 4096
 s_waitcnt lgkmcnt(0)
 s_barrier
 v_mfma_f32_16x16x32_bf16 v[204:207], a[212:215], a[172:175], v[204:207]
 ds_read_b128 a[128:131], v1
 v_mfma_f32_16x16x32_bf16 v[204:207], a[208:211], a[168:171], v[204:207]
 v_mfma_f32_16x16x32_bf16 v[208:211], a[208:211], a[144:147], v[208:211]
 ds_read_b128 a[132:135], v1 offset:4096
 v_mfma_f32_16x16x32_bf16 v[208:211], a[212:215], a[148:151], v[208:211]
 v_mfma_f32_16x16x32_bf16 v[212:215], a[212:215], a[156:159], v[212:215]
 buffer_load_dwordx4 a[212:215], v0, s[12:15], s24 offen offset:1024
 v_mfma_f32_16x16x32_bf16 v[212:215], a[208:211], a[152:155], v[212:215]
 buffer_load_dwordx4 a[208:211], v0, s[12:15], s24 offen
 s_waitcnt vmcnt(14)
 v_mfma_f32_16x16x32_bf16 v[228:231], a[216:219], a[152:155], v[228:231]
 ds_read_b128 a[136:139], v1 offset:1024
 ds_read_b128 a[140:143], v1 offset:5120
 v_mfma_f32_16x16x32_bf16 v[228:231], a[220:223], a[156:159], v[228:231]
 v_mfma_f32_16x16x32_bf16 v[224:227], a[220:223], a[148:151], v[224:227]
 v_mfma_f32_16x16x32_bf16 v[224:227], a[216:219], a[144:147], v[224:227]
 v_mfma_f32_16x16x32_bf16 v[220:223], a[216:219], a[168:171], v[220:223]
 v_mfma_f32_16x16x32_bf16 v[220:223], a[220:223], a[172:175], v[220:223]
 v_mfma_f32_16x16x32_bf16 v[216:219], a[220:223], a[164:167], v[216:219]
 buffer_load_dwordx4 a[220:223], v0, s[12:15], s24 offen offset:3072
 v_mfma_f32_16x16x32_bf16 v[216:219], a[216:219], a[160:163], v[216:219]
 buffer_load_dwordx4 a[216:219], v0, s[12:15], s24 offen offset:2048
 s_waitcnt vmcnt(14)
 v_mfma_f32_16x16x32_bf16 v[232:235], a[224:227], a[160:163], v[232:235]
 v_mfma_f32_16x16x32_bf16 v[232:235], a[228:231], a[164:167], v[232:235]
 s_add_u32 s24, s24, 4096
 v_mfma_f32_16x16x32_bf16 v[236:239], a[228:231], a[172:175], v[236:239]
 v_mfma_f32_16x16x32_bf16 v[236:239], a[224:227], a[168:171], v[236:239]
 v_mfma_f32_16x16x32_bf16 v[240:243], a[224:227], a[144:147], v[240:243]
 v_mfma_f32_16x16x32_bf16 v[240:243], a[228:231], a[148:151], v[240:243]
 v_mfma_f32_16x16x32_bf16 v[244:247], a[228:231], a[156:159], v[244:247]
 buffer_load_dwordx4 a[228:231], v0, s[12:15], s24 offen offset:1024
 v_mfma_f32_16x16x32_bf16 v[244:247], a[224:227], a[152:155], v[244:247]
 buffer_load_dwordx4 a[224:227], v0, s[12:15], s24 offen
 s_waitcnt vmcnt(14)
 v_mfma_f32_16x16x32_bf16 a[252:255], a[232:235], a[152:155], a[252:255]
 ds_read_b128 a[152:155], v1 offset:3072
 v_mfma_f32_16x16x32_bf16 a[252:255], a[236:239], a[156:159], a[252:255]
 ds_read_b128 a[156:159], v1 offset:7168
 v_mfma_f32_16x16x32_bf16 a[248:251], a[236:239], a[148:151], a[248:251]
 ds_read_b128 a[148:151], v1 offset:6144
 v_mfma_f32_16x16x32_bf16 a[248:251], a[232:235], a[144:147], a[248:251]
 ds_read_b128 a[144:147], v1 offset:2048
 v_mfma_f32_16x16x32_bf16 v[252:255], a[232:235], a[168:171], v[252:255]
 v_mfma_f32_16x16x32_bf16 v[252:255], a[236:239], a[172:175], v[252:255]
 v_mfma_f32_16x16x32_bf16 v[248:251], a[236:239], a[164:167], v[248:251]
 buffer_load_dwordx4 a[236:239], v0, s[12:15], s24 offen offset:3072
 v_mfma_f32_16x16x32_bf16 v[248:251], a[232:235], a[160:163], v[248:251]
 buffer_load_dwordx4 a[232:235], v0, s[12:15], s24 offen offset:2048
 s_add_u32 s24, s24, 53248
 s_waitcnt vmcnt(14) lgkmcnt(6)
 v_mfma_f32_16x16x32_bf16 v[16:19], a[176:179], a[128:131], v[16:19]
 v_accvgpr_read_b32 v5, a64
 v_lshlrev_b32 v6, 16, v5
 v_mfma_f32_16x16x32_bf16 v[16:19], a[180:183], a[132:135], v[16:19]
 s_waitcnt lgkmcnt(4)
 v_mfma_f32_16x16x32_bf16 v[20:23], a[180:183], a[140:143], v[20:23]
 v_and_b32 v5, s26, v5
 v_mul_f32 v6, v6, v136
 v_mfma_f32_16x16x32_bf16 v[20:23], a[176:179], a[136:139], v[20:23]
 s_waitcnt lgkmcnt(0)
 v_mfma_f32_16x16x32_bf16 v[24:27], a[176:179], a[144:147], v[24:27]
 v_mul_f32 v5, v5, v137
 v_mfma_f32_16x16x32_bf16 v[24:27], a[180:183], a[148:151], v[24:27]
 v_cvt_pk_bf16_f32 v8, v6, v5
 v_mfma_f32_16x16x32_bf16 v[28:31], a[180:183], a[156:159], v[28:31]
 buffer_load_dwordx4 a[180:183], v0, s[12:15], s24 offen offset:1024
 v_mfma_f32_16x16x32_bf16 v[28:31], a[176:179], a[152:155], v[28:31]
 buffer_load_dwordx4 a[176:179], v0, s[12:15], s24 offen
 s_waitcnt vmcnt(14)
 v_mfma_f32_16x16x32_bf16 v[44:47], a[184:187], a[152:155], v[44:47]
 v_accvgpr_read_b32 v5, a65
 v_mfma_f32_16x16x32_bf16 v[44:47], a[188:191], a[156:159], v[44:47]
 v_lshlrev_b32 v6, 16, v5
 v_and_b32 v5, s26, v5
 v_mfma_f32_16x16x32_bf16 v[40:43], a[188:191], a[148:151], v[40:43]
 ds_read_b128 a[160:163], v1 offset:8192
 v_mfma_f32_16x16x32_bf16 v[40:43], a[184:187], a[144:147], v[40:43]
 v_mul_f32 v6, v6, v138
 v_mfma_f32_16x16x32_bf16 v[36:39], a[184:187], a[136:139], v[36:39]
 v_mul_f32 v5, v5, v139
 ds_read_b128 a[164:167], v1 offset:12288
 v_mfma_f32_16x16x32_bf16 v[36:39], a[188:191], a[140:143], v[36:39]
 v_cvt_pk_bf16_f32 v9, v6, v5
 v_mfma_f32_16x16x32_bf16 v[32:35], a[188:191], a[132:135], v[32:35]
 buffer_load_dwordx4 a[188:191], v0, s[12:15], s24 offen offset:3072
 v_mfma_f32_16x16x32_bf16 v[32:35], a[184:187], a[128:131], v[32:35]
 buffer_load_dwordx4 a[184:187], v0, s[12:15], s24 offen offset:2048
 s_waitcnt vmcnt(14)
 v_mfma_f32_16x16x32_bf16 v[48:51], a[192:195], a[128:131], v[48:51]
 ds_read_b128 a[168:171], v1 offset:9216
 ds_read_b128 a[172:175], v1 offset:13312
 v_mfma_f32_16x16x32_bf16 v[48:51], a[196:199], a[132:135], v[48:51]
 v_accvgpr_read_b32 v5, a66
 s_add_u32 s24, s24, 4096
 v_mfma_f32_16x16x32_bf16 v[52:55], a[196:199], a[140:143], v[52:55]
 v_lshlrev_b32 v6, 16, v5
 v_mfma_f32_16x16x32_bf16 v[52:55], a[192:195], a[136:139], v[52:55]
 v_and_b32 v5, s26, v5
 v_mfma_f32_16x16x32_bf16 v[56:59], a[192:195], a[144:147], v[56:59]
 v_mul_f32 v6, v6, v152
 v_mul_f32 v5, v5, v153
 v_mfma_f32_16x16x32_bf16 v[56:59], a[196:199], a[148:151], v[56:59]
 v_cvt_pk_bf16_f32 v10, v6, v5
 v_mfma_f32_16x16x32_bf16 v[60:63], a[196:199], a[156:159], v[60:63]
 buffer_load_dwordx4 a[196:199], v0, s[12:15], s24 offen offset:1024
 v_mfma_f32_16x16x32_bf16 v[60:63], a[192:195], a[152:155], v[60:63]
 buffer_load_dwordx4 a[192:195], v0, s[12:15], s24 offen
 s_waitcnt vmcnt(14)
 v_mfma_f32_16x16x32_bf16 v[76:79], a[200:203], a[152:155], v[76:79]
 v_accvgpr_read_b32 v5, a67
 v_lshlrev_b32 v6, 16, v5
 v_mfma_f32_16x16x32_bf16 v[76:79], a[204:207], a[156:159], v[76:79]
 v_and_b32 v5, s26, v5
 v_mfma_f32_16x16x32_bf16 v[72:75], a[204:207], a[148:151], v[72:75]
 v_mul_f32 v6, v6, v154
 v_mul_f32 v5, v5, v155
 v_mfma_f32_16x16x32_bf16 v[72:75], a[200:203], a[144:147], v[72:75]
 v_cvt_pk_bf16_f32 v11, v6, v5
 v_mfma_f32_16x16x32_bf16 v[68:71], a[200:203], a[136:139], v[68:71]
 ds_write_b128 v3, v[8:11] offset:16384
 v_mfma_f32_16x16x32_bf16 v[68:71], a[204:207], a[140:143], v[68:71]
 v_accvgpr_read_b32 v5, a68
 v_lshlrev_b32 v6, 16, v5
 v_mfma_f32_16x16x32_bf16 v[64:67], a[204:207], a[132:135], v[64:67]
 buffer_load_dwordx4 a[204:207], v0, s[12:15], s24 offen offset:3072
 v_mfma_f32_16x16x32_bf16 v[64:67], a[200:203], a[128:131], v[64:67]
 buffer_load_dwordx4 a[200:203], v0, s[12:15], s24 offen offset:2048
 s_waitcnt vmcnt(14)
 v_mfma_f32_16x16x32_bf16 v[80:83], a[208:211], a[128:131], v[80:83]
 v_and_b32 v5, s26, v5
 v_mfma_f32_16x16x32_bf16 v[80:83], a[212:215], a[132:135], v[80:83]
 v_mul_f32 v6, v6, v140
 s_add_u32 s24, s24, 4096
 v_mfma_f32_16x16x32_bf16 v[84:87], a[212:215], a[140:143], v[84:87]
 v_mul_f32 v5, v5, v141
 v_mfma_f32_16x16x32_bf16 v[84:87], a[208:211], a[136:139], v[84:87]
 v_cvt_pk_bf16_f32 v12, v6, v5
 v_mfma_f32_16x16x32_bf16 v[88:91], a[208:211], a[144:147], v[88:91]
 v_accvgpr_read_b32 v5, a69
 v_lshlrev_b32 v6, 16, v5
 v_mfma_f32_16x16x32_bf16 v[88:91], a[212:215], a[148:151], v[88:91]
 v_and_b32 v5, s26, v5
 v_mfma_f32_16x16x32_bf16 v[92:95], a[212:215], a[156:159], v[92:95]
 buffer_load_dwordx4 a[212:215], v0, s[12:15], s24 offen offset:1024
 v_mfma_f32_16x16x32_bf16 v[92:95], a[208:211], a[152:155], v[92:95]
 buffer_load_dwordx4 a[208:211], v0, s[12:15], s24 offen
 s_waitcnt vmcnt(14)
 v_mfma_f32_16x16x32_bf16 v[108:111], a[216:219], a[152:155], v[108:111]
 v_mul_f32 v6, v6, v142
 v_mul_f32 v5, v5, v143
 v_mfma_f32_16x16x32_bf16 v[108:111], a[220:223], a[156:159], v[108:111]
 v_cvt_pk_bf16_f32 v13, v6, v5
 v_mfma_f32_16x16x32_bf16 v[104:107], a[220:223], a[148:151], v[104:107]
 v_accvgpr_read_b32 v5, a70
 v_mfma_f32_16x16x32_bf16 v[104:107], a[216:219], a[144:147], v[104:107]
 v_lshlrev_b32 v6, 16, v5
 v_and_b32 v5, s26, v5
 v_mfma_f32_16x16x32_bf16 v[100:103], a[216:219], a[136:139], v[100:103]
 v_mul_f32 v6, v6, v156
 v_mfma_f32_16x16x32_bf16 v[100:103], a[220:223], a[140:143], v[100:103]
 v_mul_f32 v5, v5, v157
 v_mfma_f32_16x16x32_bf16 v[96:99], a[220:223], a[132:135], v[96:99]
 v_cvt_pk_bf16_f32 v14, v6, v5
 buffer_load_dwordx4 a[220:223], v0, s[12:15], s24 offen offset:3072
 v_mfma_f32_16x16x32_bf16 v[96:99], a[216:219], a[128:131], v[96:99]
 buffer_load_dwordx4 a[216:219], v0, s[12:15], s24 offen offset:2048
 s_waitcnt vmcnt(14)
 v_mfma_f32_16x16x32_bf16 v[112:115], a[224:227], a[128:131], v[112:115]
 v_accvgpr_read_b32 v5, a71
 v_mfma_f32_16x16x32_bf16 v[112:115], a[228:231], a[132:135], v[112:115]
 v_lshlrev_b32 v6, 16, v5
 s_add_u32 s24, s24, 4096
 v_mfma_f32_16x16x32_bf16 v[116:119], a[228:231], a[140:143], v[116:119]
 v_and_b32 v5, s26, v5
 v_mfma_f32_16x16x32_bf16 v[116:119], a[224:227], a[136:139], v[116:119]
 v_mul_f32 v6, v6, v158
 v_mfma_f32_16x16x32_bf16 v[120:123], a[224:227], a[144:147], v[120:123]
 v_mul_f32 v5, v5, v159
 v_cvt_pk_bf16_f32 v15, v6, v5
 v_mfma_f32_16x16x32_bf16 v[120:123], a[228:231], a[148:151], v[120:123]
 ds_write_b128 v3, v[12:15] offset:17408
 v_mfma_f32_16x16x32_bf16 v[124:127], a[228:231], a[156:159], v[124:127]
 buffer_load_dwordx4 a[228:231], v0, s[12:15], s24 offen offset:1024
 v_mfma_f32_16x16x32_bf16 v[124:127], a[224:227], a[152:155], v[124:127]
 buffer_load_dwordx4 a[224:227], v0, s[12:15], s24 offen
 s_waitcnt vmcnt(14)
 v_mfma_f32_16x16x32_bf16 a[244:247], a[232:235], a[152:155], a[244:247]
 v_accvgpr_read_b32 v5, a72
 ds_read_b128 a[152:155], v1 offset:11264
 v_mfma_f32_16x16x32_bf16 a[244:247], a[236:239], a[156:159], a[244:247]
 ds_read_b128 a[156:159], v1 offset:15360
 v_mfma_f32_16x16x32_bf16 a[240:243], a[236:239], a[148:151], a[240:243]
 ds_read_b128 a[148:151], v1 offset:14336
 v_mfma_f32_16x16x32_bf16 a[240:243], a[232:235], a[144:147], a[240:243]
 v_lshlrev_b32 v6, 16, v5
 ds_read_b128 a[144:147], v1 offset:10240
 v_mfma_f32_16x16x32_bf16 v[132:135], a[232:235], a[136:139], v[132:135]
 v_and_b32 v5, s26, v5
 v_mfma_f32_16x16x32_bf16 v[132:135], a[236:239], a[140:143], v[132:135]
 v_mul_f32 v6, v6, v144
 v_mfma_f32_16x16x32_bf16 v[128:131], a[236:239], a[132:135], v[128:131]
 v_mul_f32 v5, v5, v145
 buffer_load_dwordx4 a[236:239], v0, s[12:15], s24 offen offset:3072
 v_mfma_f32_16x16x32_bf16 v[128:131], a[232:235], a[128:131], v[128:131]
 buffer_load_dwordx4 a[232:235], v0, s[12:15], s24 offen offset:2048
 s_waitcnt vmcnt(14) lgkmcnt(8)
 v_mfma_f32_16x16x32_bf16 v[16:19], a[176:179], a[160:163], v[16:19]
 v_cvt_pk_bf16_f32 v8, v6, v5
 v_mfma_f32_16x16x32_bf16 v[16:19], a[180:183], a[164:167], v[16:19]
 s_add_u32 s24, s24, 53248
 s_waitcnt lgkmcnt(6)
 v_mfma_f32_16x16x32_bf16 v[20:23], a[180:183], a[172:175], v[20:23]
 v_accvgpr_read_b32 v5, a73
 v_mfma_f32_16x16x32_bf16 v[20:23], a[176:179], a[168:171], v[20:23]
 v_lshlrev_b32 v6, 16, v5
 s_waitcnt lgkmcnt(0)
 v_mfma_f32_16x16x32_bf16 v[24:27], a[176:179], a[144:147], v[24:27]
 v_and_b32 v5, s26, v5
 v_mfma_f32_16x16x32_bf16 v[24:27], a[180:183], a[148:151], v[24:27]
 v_mfma_f32_16x16x32_bf16 v[28:31], a[180:183], a[156:159], v[28:31]
 v_mul_f32 v6, v6, v146
 buffer_load_dwordx4 a[180:183], v0, s[12:15], s24 offen offset:1024
 v_mfma_f32_16x16x32_bf16 v[28:31], a[176:179], a[152:155], v[28:31]
 buffer_load_dwordx4 a[176:179], v0, s[12:15], s24 offen
 s_waitcnt vmcnt(14)
 v_mfma_f32_16x16x32_bf16 v[44:47], a[184:187], a[152:155], v[44:47]
 v_mul_f32 v5, v5, v147
 v_mfma_f32_16x16x32_bf16 v[44:47], a[188:191], a[156:159], v[44:47]
 v_cvt_pk_bf16_f32 v9, v6, v5
 v_mfma_f32_16x16x32_bf16 v[40:43], a[188:191], a[148:151], v[40:43]
 v_accvgpr_read_b32 v5, a74
 ds_read_b128 a[128:131], v1 offset:32768
 v_mfma_f32_16x16x32_bf16 v[40:43], a[184:187], a[144:147], v[40:43]
 v_lshlrev_b32 v6, 16, v5
 v_mfma_f32_16x16x32_bf16 v[36:39], a[184:187], a[168:171], v[36:39]
 v_and_b32 v5, s26, v5
 ds_read_b128 a[132:135], v1 offset:36864
 v_mfma_f32_16x16x32_bf16 v[36:39], a[188:191], a[172:175], v[36:39]
 v_mul_f32 v6, v6, v160
 v_mfma_f32_16x16x32_bf16 v[32:35], a[188:191], a[164:167], v[32:35]
 buffer_load_dwordx4 a[188:191], v0, s[12:15], s24 offen offset:3072
 v_mfma_f32_16x16x32_bf16 v[32:35], a[184:187], a[160:163], v[32:35]
 buffer_load_dwordx4 a[184:187], v0, s[12:15], s24 offen offset:2048
 s_waitcnt vmcnt(14)
 v_mfma_f32_16x16x32_bf16 v[48:51], a[192:195], a[160:163], v[48:51]
 ds_read_b128 a[136:139], v1 offset:33792
 ds_read_b128 a[140:143], v1 offset:37888
 v_mfma_f32_16x16x32_bf16 v[48:51], a[196:199], a[164:167], v[48:51]
 v_mul_f32 v5, v5, v161
 s_add_u32 s24, s24, 4096
 v_mfma_f32_16x16x32_bf16 v[52:55], a[196:199], a[172:175], v[52:55]
 v_cvt_pk_bf16_f32 v10, v6, v5
 v_mfma_f32_16x16x32_bf16 v[52:55], a[192:195], a[168:171], v[52:55]
 v_accvgpr_read_b32 v5, a75
 v_mfma_f32_16x16x32_bf16 v[56:59], a[192:195], a[144:147], v[56:59]
 v_lshlrev_b32 v6, 16, v5
 v_and_b32 v5, s26, v5
 v_mfma_f32_16x16x32_bf16 v[56:59], a[196:199], a[148:151], v[56:59]
 v_mul_f32 v6, v6, v162
 v_mfma_f32_16x16x32_bf16 v[60:63], a[196:199], a[156:159], v[60:63]
 buffer_load_dwordx4 a[196:199], v0, s[12:15], s24 offen offset:1024
 v_mfma_f32_16x16x32_bf16 v[60:63], a[192:195], a[152:155], v[60:63]
 buffer_load_dwordx4 a[192:195], v0, s[12:15], s24 offen
 s_waitcnt vmcnt(14)
 v_mfma_f32_16x16x32_bf16 v[76:79], a[200:203], a[152:155], v[76:79]
 v_mul_f32 v5, v5, v163
 v_cvt_pk_bf16_f32 v11, v6, v5
 v_mfma_f32_16x16x32_bf16 v[76:79], a[204:207], a[156:159], v[76:79]
 ds_write_b128 v3, v[8:11] offset:18432
 v_mfma_f32_16x16x32_bf16 v[72:75], a[204:207], a[148:151], v[72:75]
 v_accvgpr_read_b32 v5, a76
 v_mfma_f32_16x16x32_bf16 v[72:75], a[200:203], a[144:147], v[72:75]
 v_lshlrev_b32 v6, 16, v5
 v_and_b32 v5, s26, v5
 v_mfma_f32_16x16x32_bf16 v[68:71], a[200:203], a[168:171], v[68:71]
 v_mul_f32 v6, v6, v148
 v_mfma_f32_16x16x32_bf16 v[68:71], a[204:207], a[172:175], v[68:71]
 v_mul_f32 v5, v5, v149
 v_mfma_f32_16x16x32_bf16 v[64:67], a[204:207], a[164:167], v[64:67]
 v_cvt_pk_bf16_f32 v12, v6, v5
 buffer_load_dwordx4 a[204:207], v0, s[12:15], s24 offen offset:3072
 v_mfma_f32_16x16x32_bf16 v[64:67], a[200:203], a[160:163], v[64:67]
 buffer_load_dwordx4 a[200:203], v0, s[12:15], s24 offen offset:2048
 s_waitcnt vmcnt(14)
 v_mfma_f32_16x16x32_bf16 v[80:83], a[208:211], a[160:163], v[80:83]
 v_accvgpr_read_b32 v5, a77
 v_mfma_f32_16x16x32_bf16 v[80:83], a[212:215], a[164:167], v[80:83]
 s_add_u32 s24, s24, 4096
 v_mfma_f32_16x16x32_bf16 v[84:87], a[212:215], a[172:175], v[84:87]
 v_lshlrev_b32 v6, 16, v5
 v_and_b32 v5, s26, v5
 v_mfma_f32_16x16x32_bf16 v[84:87], a[208:211], a[168:171], v[84:87]
 v_mul_f32 v6, v6, v150
 v_mfma_f32_16x16x32_bf16 v[88:91], a[208:211], a[144:147], v[88:91]
 v_mul_f32 v5, v5, v151
 v_cvt_pk_bf16_f32 v13, v6, v5
 v_mfma_f32_16x16x32_bf16 v[88:91], a[212:215], a[148:151], v[88:91]
 v_accvgpr_read_b32 v5, a78
 v_mfma_f32_16x16x32_bf16 v[92:95], a[212:215], a[156:159], v[92:95]
 buffer_load_dwordx4 a[212:215], v0, s[12:15], s24 offen offset:1024
 v_mfma_f32_16x16x32_bf16 v[92:95], a[208:211], a[152:155], v[92:95]
 buffer_load_dwordx4 a[208:211], v0, s[12:15], s24 offen
 s_waitcnt vmcnt(14)
 v_mfma_f32_16x16x32_bf16 v[108:111], a[216:219], a[152:155], v[108:111]
 v_lshlrev_b32 v6, 16, v5
 v_and_b32 v5, s26, v5
 v_mfma_f32_16x16x32_bf16 v[108:111], a[220:223], a[156:159], v[108:111]
 v_mul_f32 v6, v6, v164
 v_mfma_f32_16x16x32_bf16 v[104:107], a[220:223], a[148:151], v[104:107]
 v_mul_f32 v5, v5, v165
 v_mfma_f32_16x16x32_bf16 v[104:107], a[216:219], a[144:147], v[104:107]
 v_cvt_pk_bf16_f32 v14, v6, v5
 v_accvgpr_read_b32 v5, a79
 v_mfma_f32_16x16x32_bf16 v[100:103], a[216:219], a[168:171], v[100:103]
 v_lshlrev_b32 v6, 16, v5
 v_mfma_f32_16x16x32_bf16 v[100:103], a[220:223], a[172:175], v[100:103]
 v_and_b32 v5, s26, v5
 v_mfma_f32_16x16x32_bf16 v[96:99], a[220:223], a[164:167], v[96:99]
 v_mul_f32 v6, v6, v166
 buffer_load_dwordx4 a[220:223], v0, s[12:15], s24 offen offset:3072
 v_mfma_f32_16x16x32_bf16 v[96:99], a[216:219], a[160:163], v[96:99]
 buffer_load_dwordx4 a[216:219], v0, s[12:15], s24 offen offset:2048
 s_waitcnt vmcnt(14)
 v_mfma_f32_16x16x32_bf16 v[112:115], a[224:227], a[160:163], v[112:115]
 v_mul_f32 v5, v5, v167
 v_mfma_f32_16x16x32_bf16 v[112:115], a[228:231], a[164:167], v[112:115]
 s_add_u32 s24, s24, 4096
 v_mfma_f32_16x16x32_bf16 v[116:119], a[228:231], a[172:175], v[116:119]
 v_cvt_pk_bf16_f32 v15, v6, v5
 ds_write_b128 v3, v[12:15] offset:19456
 v_mfma_f32_16x16x32_bf16 v[116:119], a[224:227], a[168:171], v[116:119]
 v_accvgpr_read_b32 v5, a80
 v_mfma_f32_16x16x32_bf16 v[120:123], a[224:227], a[144:147], v[120:123]
 v_lshlrev_b32 v6, 16, v5
 v_mfma_f32_16x16x32_bf16 v[120:123], a[228:231], a[148:151], v[120:123]
 v_and_b32 v5, s26, v5
 v_mul_f32 v6, v6, v168
 v_mfma_f32_16x16x32_bf16 v[124:127], a[228:231], a[156:159], v[124:127]
 buffer_load_dwordx4 a[228:231], v0, s[12:15], s24 offen offset:1024
 v_mfma_f32_16x16x32_bf16 v[124:127], a[224:227], a[152:155], v[124:127]
 buffer_load_dwordx4 a[224:227], v0, s[12:15], s24 offen
 s_waitcnt vmcnt(14)
 v_mfma_f32_16x16x32_bf16 a[244:247], a[232:235], a[152:155], a[244:247]
 ds_read_b128 a[152:155], v1 offset:35840
 v_mfma_f32_16x16x32_bf16 a[244:247], a[236:239], a[156:159], a[244:247]
 v_mul_f32 v5, v5, v169
 ds_read_b128 a[156:159], v1 offset:39936
 v_mfma_f32_16x16x32_bf16 a[240:243], a[236:239], a[148:151], a[240:243]
 ds_read_b128 a[148:151], v1 offset:38912
 v_mfma_f32_16x16x32_bf16 a[240:243], a[232:235], a[144:147], a[240:243]
 ds_read_b128 a[144:147], v1 offset:34816
 v_mfma_f32_16x16x32_bf16 v[132:135], a[232:235], a[168:171], v[132:135]
 v_cvt_pk_bf16_f32 v8, v6, v5
 v_accvgpr_read_b32 v5, a81
 v_mfma_f32_16x16x32_bf16 v[132:135], a[236:239], a[172:175], v[132:135]
 v_lshlrev_b32 v6, 16, v5
 v_mfma_f32_16x16x32_bf16 v[128:131], a[236:239], a[164:167], v[128:131]
 v_and_b32 v5, s26, v5
 buffer_load_dwordx4 a[236:239], v0, s[12:15], s24 offen offset:3072
 v_mfma_f32_16x16x32_bf16 v[128:131], a[232:235], a[160:163], v[128:131]
 buffer_load_dwordx4 a[232:235], v0, s[12:15], s24 offen offset:2048
 s_waitcnt vmcnt(14) lgkmcnt(8)
 v_mfma_f32_16x16x32_bf16 v[16:19], a[176:179], a[128:131], v[16:19]
 v_mul_f32 v6, v6, v170
 v_mfma_f32_16x16x32_bf16 v[16:19], a[180:183], a[132:135], v[16:19]
 s_add_u32 s24, s24, 53248
 s_waitcnt lgkmcnt(6)
 v_mfma_f32_16x16x32_bf16 v[20:23], a[180:183], a[140:143], v[20:23]
 v_mul_f32 v5, v5, v171
 v_mfma_f32_16x16x32_bf16 v[20:23], a[176:179], a[136:139], v[20:23]
 v_cvt_pk_bf16_f32 v9, v6, v5
 s_waitcnt lgkmcnt(0)
 v_mfma_f32_16x16x32_bf16 v[24:27], a[176:179], a[144:147], v[24:27]
 v_accvgpr_read_b32 v5, a82
 v_mfma_f32_16x16x32_bf16 v[24:27], a[180:183], a[148:151], v[24:27]
 v_mfma_f32_16x16x32_bf16 v[28:31], a[180:183], a[156:159], v[28:31]
 v_lshlrev_b32 v6, 16, v5
 buffer_load_dwordx4 a[180:183], v0, s[12:15], s24 offen offset:1024
 v_mfma_f32_16x16x32_bf16 v[28:31], a[176:179], a[152:155], v[28:31]
 buffer_load_dwordx4 a[176:179], v0, s[12:15], s24 offen
 s_waitcnt vmcnt(14)
 v_mfma_f32_16x16x32_bf16 v[44:47], a[184:187], a[152:155], v[44:47]
 v_and_b32 v5, s26, v5
 v_mfma_f32_16x16x32_bf16 v[44:47], a[188:191], a[156:159], v[44:47]
 v_mul_f32 v6, v6, v184
 v_mfma_f32_16x16x32_bf16 v[40:43], a[188:191], a[148:151], v[40:43]
 v_mul_f32 v5, v5, v185
 ds_read_b128 a[160:163], v1 offset:40960
 v_mfma_f32_16x16x32_bf16 v[40:43], a[184:187], a[144:147], v[40:43]
 v_cvt_pk_bf16_f32 v10, v6, v5
 v_mfma_f32_16x16x32_bf16 v[36:39], a[184:187], a[136:139], v[36:39]
 ds_read_b128 a[164:167], v1 offset:45056
 v_mfma_f32_16x16x32_bf16 v[36:39], a[188:191], a[140:143], v[36:39]
 v_accvgpr_read_b32 v5, a83
 v_lshlrev_b32 v6, 16, v5
 v_mfma_f32_16x16x32_bf16 v[32:35], a[188:191], a[132:135], v[32:35]
 buffer_load_dwordx4 a[188:191], v0, s[12:15], s24 offen offset:3072
 v_mfma_f32_16x16x32_bf16 v[32:35], a[184:187], a[128:131], v[32:35]
 buffer_load_dwordx4 a[184:187], v0, s[12:15], s24 offen offset:2048
 s_waitcnt vmcnt(14)
 v_mfma_f32_16x16x32_bf16 v[48:51], a[192:195], a[128:131], v[48:51]
 ds_read_b128 a[168:171], v1 offset:41984
 ds_read_b128 a[172:175], v1 offset:46080
 v_mfma_f32_16x16x32_bf16 v[48:51], a[196:199], a[132:135], v[48:51]
 s_add_u32 s24, s24, 4096
 v_mfma_f32_16x16x32_bf16 v[52:55], a[196:199], a[140:143], v[52:55]
 v_and_b32 v5, s26, v5
 v_mul_f32 v6, v6, v186
 v_mfma_f32_16x16x32_bf16 v[52:55], a[192:195], a[136:139], v[52:55]
 v_mul_f32 v5, v5, v187
 v_mfma_f32_16x16x32_bf16 v[56:59], a[192:195], a[144:147], v[56:59]
 v_cvt_pk_bf16_f32 v11, v6, v5
 v_mfma_f32_16x16x32_bf16 v[56:59], a[196:199], a[148:151], v[56:59]
 ds_write_b128 v3, v[8:11] offset:20480
 v_accvgpr_read_b32 v5, a84
 v_mfma_f32_16x16x32_bf16 v[60:63], a[196:199], a[156:159], v[60:63]
 buffer_load_dwordx4 a[196:199], v0, s[12:15], s24 offen offset:1024
 v_mfma_f32_16x16x32_bf16 v[60:63], a[192:195], a[152:155], v[60:63]
 buffer_load_dwordx4 a[192:195], v0, s[12:15], s24 offen
 s_waitcnt vmcnt(14)
 v_mfma_f32_16x16x32_bf16 v[76:79], a[200:203], a[152:155], v[76:79]
 v_lshlrev_b32 v6, 16, v5
 v_and_b32 v5, s26, v5
 v_mfma_f32_16x16x32_bf16 v[76:79], a[204:207], a[156:159], v[76:79]
 v_mul_f32 v6, v6, v172
 v_mfma_f32_16x16x32_bf16 v[72:75], a[204:207], a[148:151], v[72:75]
 v_mul_f32 v5, v5, v173
 v_mfma_f32_16x16x32_bf16 v[72:75], a[200:203], a[144:147], v[72:75]
 v_cvt_pk_bf16_f32 v12, v6, v5
 v_accvgpr_read_b32 v5, a85
 v_mfma_f32_16x16x32_bf16 v[68:71], a[200:203], a[136:139], v[68:71]
 v_lshlrev_b32 v6, 16, v5
 v_mfma_f32_16x16x32_bf16 v[68:71], a[204:207], a[140:143], v[68:71]
 v_and_b32 v5, s26, v5
 v_mfma_f32_16x16x32_bf16 v[64:67], a[204:207], a[132:135], v[64:67]
 v_mul_f32 v6, v6, v174
 buffer_load_dwordx4 a[204:207], v0, s[12:15], s24 offen offset:3072
 v_mfma_f32_16x16x32_bf16 v[64:67], a[200:203], a[128:131], v[64:67]
 buffer_load_dwordx4 a[200:203], v0, s[12:15], s24 offen offset:2048
 s_waitcnt vmcnt(14)
 v_mfma_f32_16x16x32_bf16 v[80:83], a[208:211], a[128:131], v[80:83]
 v_mul_f32 v5, v5, v175
 v_mfma_f32_16x16x32_bf16 v[80:83], a[212:215], a[132:135], v[80:83]
 s_add_u32 s24, s24, 4096
 v_mfma_f32_16x16x32_bf16 v[84:87], a[212:215], a[140:143], v[84:87]
 v_cvt_pk_bf16_f32 v13, v6, v5
 v_accvgpr_read_b32 v5, a86
 v_mfma_f32_16x16x32_bf16 v[84:87], a[208:211], a[136:139], v[84:87]
 v_lshlrev_b32 v6, 16, v5
 v_mfma_f32_16x16x32_bf16 v[88:91], a[208:211], a[144:147], v[88:91]
 v_and_b32 v5, s26, v5
 v_mfma_f32_16x16x32_bf16 v[88:91], a[212:215], a[148:151], v[88:91]
 v_mul_f32 v6, v6, v188
 v_mul_f32 v5, v5, v189
 v_mfma_f32_16x16x32_bf16 v[92:95], a[212:215], a[156:159], v[92:95]
 buffer_load_dwordx4 a[212:215], v0, s[12:15], s24 offen offset:1024
 v_mfma_f32_16x16x32_bf16 v[92:95], a[208:211], a[152:155], v[92:95]
 buffer_load_dwordx4 a[208:211], v0, s[12:15], s24 offen
 s_waitcnt vmcnt(14)
 v_mfma_f32_16x16x32_bf16 v[108:111], a[216:219], a[152:155], v[108:111]
 v_cvt_pk_bf16_f32 v14, v6, v5
 v_mfma_f32_16x16x32_bf16 v[108:111], a[220:223], a[156:159], v[108:111]
 v_accvgpr_read_b32 v5, a87
 v_lshlrev_b32 v6, 16, v5
 v_mfma_f32_16x16x32_bf16 v[104:107], a[220:223], a[148:151], v[104:107]
 v_and_b32 v5, s26, v5
 v_mfma_f32_16x16x32_bf16 v[104:107], a[216:219], a[144:147], v[104:107]
 v_mul_f32 v6, v6, v190
 v_mfma_f32_16x16x32_bf16 v[100:103], a[216:219], a[136:139], v[100:103]
 v_mul_f32 v5, v5, v191
 v_cvt_pk_bf16_f32 v15, v6, v5
 v_mfma_f32_16x16x32_bf16 v[100:103], a[220:223], a[140:143], v[100:103]
 ds_write_b128 v3, v[12:15] offset:21504
 v_mfma_f32_16x16x32_bf16 v[96:99], a[220:223], a[132:135], v[96:99]
 buffer_load_dwordx4 a[220:223], v0, s[12:15], s24 offen offset:3072
 v_mfma_f32_16x16x32_bf16 v[96:99], a[216:219], a[128:131], v[96:99]
 buffer_load_dwordx4 a[216:219], v0, s[12:15], s24 offen offset:2048
 s_waitcnt vmcnt(14)
 v_mfma_f32_16x16x32_bf16 v[112:115], a[224:227], a[128:131], v[112:115]
 v_accvgpr_read_b32 v5, a88
 v_lshlrev_b32 v6, 16, v5
 v_mfma_f32_16x16x32_bf16 v[112:115], a[228:231], a[132:135], v[112:115]
 s_add_u32 s24, s24, 4096
 v_mfma_f32_16x16x32_bf16 v[116:119], a[228:231], a[140:143], v[116:119]
 v_and_b32 v5, s26, v5
 v_mul_f32 v6, v6, v176
 v_mfma_f32_16x16x32_bf16 v[116:119], a[224:227], a[136:139], v[116:119]
 v_mul_f32 v5, v5, v177
 v_mfma_f32_16x16x32_bf16 v[120:123], a[224:227], a[144:147], v[120:123]
 v_cvt_pk_bf16_f32 v8, v6, v5
 v_mfma_f32_16x16x32_bf16 v[120:123], a[228:231], a[148:151], v[120:123]
 v_accvgpr_read_b32 v5, a89
 v_lshlrev_b32 v6, 16, v5
 v_mfma_f32_16x16x32_bf16 v[124:127], a[228:231], a[156:159], v[124:127]
 buffer_load_dwordx4 a[228:231], v0, s[12:15], s24 offen offset:1024
 v_mfma_f32_16x16x32_bf16 v[124:127], a[224:227], a[152:155], v[124:127]
 buffer_load_dwordx4 a[224:227], v0, s[12:15], s24 offen
 s_waitcnt vmcnt(14)
 v_mfma_f32_16x16x32_bf16 a[244:247], a[232:235], a[152:155], a[244:247]
 ds_read_b128 a[152:155], v1 offset:44032
 v_mfma_f32_16x16x32_bf16 a[244:247], a[236:239], a[156:159], a[244:247]
 v_and_b32 v5, s26, v5
 ds_read_b128 a[156:159], v1 offset:48128
 v_mfma_f32_16x16x32_bf16 a[240:243], a[236:239], a[148:151], a[240:243]
 ds_read_b128 a[148:151], v1 offset:47104
 v_mfma_f32_16x16x32_bf16 a[240:243], a[232:235], a[144:147], a[240:243]
 ds_read_b128 a[144:147], v1 offset:43008
 v_mfma_f32_16x16x32_bf16 v[132:135], a[232:235], a[136:139], v[132:135]
 v_mul_f32 v6, v6, v178
 v_mul_f32 v5, v5, v179
 v_mfma_f32_16x16x32_bf16 v[132:135], a[236:239], a[140:143], v[132:135]
 v_cvt_pk_bf16_f32 v9, v6, v5
 v_mfma_f32_16x16x32_bf16 v[128:131], a[236:239], a[132:135], v[128:131]
 buffer_load_dwordx4 a[236:239], v0, s[12:15], s24 offen offset:3072
 v_mfma_f32_16x16x32_bf16 v[128:131], a[232:235], a[128:131], v[128:131]
 buffer_load_dwordx4 a[232:235], v0, s[12:15], s24 offen offset:2048
 s_waitcnt vmcnt(14) lgkmcnt(8)
 v_mfma_f32_16x16x32_bf16 v[16:19], a[176:179], a[160:163], v[16:19]
 v_accvgpr_read_b32 v5, a90
 v_lshlrev_b32 v6, 16, v5
 v_mfma_f32_16x16x32_bf16 v[16:19], a[180:183], a[164:167], v[16:19]
 s_add_u32 s24, s24, 53248
 s_waitcnt lgkmcnt(6)
 v_mfma_f32_16x16x32_bf16 v[20:23], a[180:183], a[172:175], v[20:23]
 v_and_b32 v5, s26, v5
 v_mfma_f32_16x16x32_bf16 v[20:23], a[176:179], a[168:171], v[20:23]
 s_waitcnt lgkmcnt(0)
 v_mfma_f32_16x16x32_bf16 v[24:27], a[176:179], a[144:147], v[24:27]
 v_mul_f32 v6, v6, v192
 v_mul_f32 v5, v5, v193
 v_mfma_f32_16x16x32_bf16 v[24:27], a[180:183], a[148:151], v[24:27]
 v_mfma_f32_16x16x32_bf16 v[28:31], a[180:183], a[156:159], v[28:31]
 buffer_load_dwordx4 a[180:183], v0, s[12:15], s24 offen offset:1024
 v_mfma_f32_16x16x32_bf16 v[28:31], a[176:179], a[152:155], v[28:31]
 buffer_load_dwordx4 a[176:179], v0, s[12:15], s24 offen
 s_waitcnt vmcnt(14)
 v_mfma_f32_16x16x32_bf16 v[44:47], a[184:187], a[152:155], v[44:47]
 v_cvt_pk_bf16_f32 v10, v6, v5
 v_accvgpr_read_b32 v5, a91
 v_mfma_f32_16x16x32_bf16 v[44:47], a[188:191], a[156:159], v[44:47]
 v_lshlrev_b32 v6, 16, v5
 v_mfma_f32_16x16x32_bf16 v[40:43], a[188:191], a[148:151], v[40:43]
 v_and_b32 v5, s26, v5
 ds_read_b128 a[128:131], v2
 v_mfma_f32_16x16x32_bf16 v[40:43], a[184:187], a[144:147], v[40:43]
 v_mul_f32 v6, v6, v194
 v_mfma_f32_16x16x32_bf16 v[36:39], a[184:187], a[168:171], v[36:39]
 ds_read_b128 a[132:135], v2 offset:4096
 v_mfma_f32_16x16x32_bf16 v[36:39], a[188:191], a[172:175], v[36:39]
 v_mul_f32 v5, v5, v195
 v_cvt_pk_bf16_f32 v11, v6, v5
 v_mfma_f32_16x16x32_bf16 v[32:35], a[188:191], a[164:167], v[32:35]
 buffer_load_dwordx4 a[188:191], v0, s[12:15], s24 offen offset:3072
 v_mfma_f32_16x16x32_bf16 v[32:35], a[184:187], a[160:163], v[32:35]
 buffer_load_dwordx4 a[184:187], v0, s[12:15], s24 offen offset:2048
 s_waitcnt vmcnt(14)
 v_mfma_f32_16x16x32_bf16 v[48:51], a[192:195], a[160:163], v[48:51]
 ds_read_b128 a[136:139], v2 offset:1024
 ds_read_b128 a[140:143], v2 offset:5120
 v_mfma_f32_16x16x32_bf16 v[48:51], a[196:199], a[164:167], v[48:51]
 s_add_u32 s24, s24, 4096
 v_mfma_f32_16x16x32_bf16 v[52:55], a[196:199], a[172:175], v[52:55]
 ds_write_b128 v3, v[8:11] offset:22528
 v_accvgpr_read_b32 v5, a92
 v_mfma_f32_16x16x32_bf16 v[52:55], a[192:195], a[168:171], v[52:55]
 v_lshlrev_b32 v6, 16, v5
 v_mfma_f32_16x16x32_bf16 v[56:59], a[192:195], a[144:147], v[56:59]
 v_and_b32 v5, s26, v5
 v_mfma_f32_16x16x32_bf16 v[56:59], a[196:199], a[148:151], v[56:59]
 v_mul_f32 v6, v6, v180
 v_mul_f32 v5, v5, v181
 v_mfma_f32_16x16x32_bf16 v[60:63], a[196:199], a[156:159], v[60:63]
 buffer_load_dwordx4 a[196:199], v0, s[12:15], s24 offen offset:1024
 v_mfma_f32_16x16x32_bf16 v[60:63], a[192:195], a[152:155], v[60:63]
 buffer_load_dwordx4 a[192:195], v0, s[12:15], s24 offen
 s_waitcnt vmcnt(14)
 v_mfma_f32_16x16x32_bf16 v[76:79], a[200:203], a[152:155], v[76:79]
 v_cvt_pk_bf16_f32 v12, v6, v5
 v_mfma_f32_16x16x32_bf16 v[76:79], a[204:207], a[156:159], v[76:79]
 v_accvgpr_read_b32 v5, a93
 v_lshlrev_b32 v6, 16, v5
 v_mfma_f32_16x16x32_bf16 v[72:75], a[204:207], a[148:151], v[72:75]
 v_and_b32 v5, s26, v5
 v_mfma_f32_16x16x32_bf16 v[72:75], a[200:203], a[144:147], v[72:75]
 v_mul_f32 v6, v6, v182
 v_mfma_f32_16x16x32_bf16 v[68:71], a[200:203], a[168:171], v[68:71]
 v_mul_f32 v5, v5, v183
 v_cvt_pk_bf16_f32 v13, v6, v5
 v_mfma_f32_16x16x32_bf16 v[68:71], a[204:207], a[172:175], v[68:71]
 v_accvgpr_read_b32 v5, a94
 v_mfma_f32_16x16x32_bf16 v[64:67], a[204:207], a[164:167], v[64:67]
 buffer_load_dwordx4 a[204:207], v0, s[12:15], s24 offen offset:3072
 v_mfma_f32_16x16x32_bf16 v[64:67], a[200:203], a[160:163], v[64:67]
 buffer_load_dwordx4 a[200:203], v0, s[12:15], s24 offen offset:2048
 s_waitcnt vmcnt(14)
 v_mfma_f32_16x16x32_bf16 v[80:83], a[208:211], a[160:163], v[80:83]
 v_lshlrev_b32 v6, 16, v5
 v_and_b32 v5, s26, v5
 v_mfma_f32_16x16x32_bf16 v[80:83], a[212:215], a[164:167], v[80:83]
 s_add_u32 s24, s24, 4096
 v_mfma_f32_16x16x32_bf16 v[84:87], a[212:215], a[172:175], v[84:87]
 v_mul_f32 v6, v6, v196
 v_mfma_f32_16x16x32_bf16 v[84:87], a[208:211], a[168:171], v[84:87]
 v_mul_f32 v5, v5, v197
 v_cvt_pk_bf16_f32 v14, v6, v5
 v_mfma_f32_16x16x32_bf16 v[88:91], a[208:211], a[144:147], v[88:91]
 v_accvgpr_read_b32 v5, a95
 v_mfma_f32_16x16x32_bf16 v[88:91], a[212:215], a[148:151], v[88:91]
 v_lshlrev_b32 v6, 16, v5
 v_and_b32 v5, s26, v5
 v_mfma_f32_16x16x32_bf16 v[92:95], a[212:215], a[156:159], v[92:95]
 buffer_load_dwordx4 a[212:215], v0, s[12:15], s24 offen offset:1024
 v_mfma_f32_16x16x32_bf16 v[92:95], a[208:211], a[152:155], v[92:95]
 buffer_load_dwordx4 a[208:211], v0, s[12:15], s24 offen
 s_waitcnt vmcnt(14)
 v_mfma_f32_16x16x32_bf16 v[108:111], a[216:219], a[152:155], v[108:111]
 v_mul_f32 v6, v6, v198
 v_mfma_f32_16x16x32_bf16 v[108:111], a[220:223], a[156:159], v[108:111]
 v_mul_f32 v5, v5, v199
 v_cvt_pk_bf16_f32 v15, v6, v5
 v_mfma_f32_16x16x32_bf16 v[104:107], a[220:223], a[148:151], v[104:107]
 ds_write_b128 v3, v[12:15] offset:23552
 v_mfma_f32_16x16x32_bf16 v[104:107], a[216:219], a[144:147], v[104:107]
 v_accvgpr_read_b32 v5, a96
 v_mfma_f32_16x16x32_bf16 v[100:103], a[216:219], a[168:171], v[100:103]
 v_lshlrev_b32 v6, 16, v5
 v_and_b32 v5, s26, v5
 v_mfma_f32_16x16x32_bf16 v[100:103], a[220:223], a[172:175], v[100:103]
 v_mul_f32 v6, v6, v200
 v_mfma_f32_16x16x32_bf16 v[96:99], a[220:223], a[164:167], v[96:99]
 buffer_load_dwordx4 a[220:223], v0, s[12:15], s24 offen offset:3072
 v_mfma_f32_16x16x32_bf16 v[96:99], a[216:219], a[160:163], v[96:99]
 buffer_load_dwordx4 a[216:219], v0, s[12:15], s24 offen offset:2048
 s_waitcnt vmcnt(14)
 v_mfma_f32_16x16x32_bf16 v[112:115], a[224:227], a[160:163], v[112:115]
 v_mul_f32 v5, v5, v201
 v_cvt_pk_bf16_f32 v8, v6, v5
 v_mfma_f32_16x16x32_bf16 v[112:115], a[228:231], a[164:167], v[112:115]
 s_add_u32 s24, s24, 4096
 v_mfma_f32_16x16x32_bf16 v[116:119], a[228:231], a[172:175], v[116:119]
 v_accvgpr_read_b32 v5, a97
 v_mfma_f32_16x16x32_bf16 v[116:119], a[224:227], a[168:171], v[116:119]
 v_lshlrev_b32 v6, 16, v5
 v_and_b32 v5, s26, v5
 v_mfma_f32_16x16x32_bf16 v[120:123], a[224:227], a[144:147], v[120:123]
 v_mul_f32 v6, v6, v202
 v_mfma_f32_16x16x32_bf16 v[120:123], a[228:231], a[148:151], v[120:123]
 v_mul_f32 v5, v5, v203
 v_mfma_f32_16x16x32_bf16 v[124:127], a[228:231], a[156:159], v[124:127]
 v_cvt_pk_bf16_f32 v9, v6, v5
 buffer_load_dwordx4 a[228:231], v0, s[12:15], s24 offen offset:1024
 v_mfma_f32_16x16x32_bf16 v[124:127], a[224:227], a[152:155], v[124:127]
 buffer_load_dwordx4 a[224:227], v0, s[12:15], s24 offen
 s_waitcnt vmcnt(14)
 v_mfma_f32_16x16x32_bf16 a[244:247], a[232:235], a[152:155], a[244:247]
 ds_read_b128 a[152:155], v2 offset:3072
 v_mfma_f32_16x16x32_bf16 a[244:247], a[236:239], a[156:159], a[244:247]
 ds_read_b128 a[156:159], v2 offset:7168
 v_mfma_f32_16x16x32_bf16 a[240:243], a[236:239], a[148:151], a[240:243]
 v_accvgpr_read_b32 v5, a98
 ds_read_b128 a[148:151], v2 offset:6144
 v_mfma_f32_16x16x32_bf16 a[240:243], a[232:235], a[144:147], a[240:243]
 ds_read_b128 a[144:147], v2 offset:2048
 v_mfma_f32_16x16x32_bf16 v[132:135], a[232:235], a[168:171], v[132:135]
 v_lshlrev_b32 v6, 16, v5
 v_and_b32 v5, s26, v5
 v_mfma_f32_16x16x32_bf16 v[132:135], a[236:239], a[172:175], v[132:135]
 v_mul_f32 v6, v6, v216
 v_mfma_f32_16x16x32_bf16 v[128:131], a[236:239], a[164:167], v[128:131]
 buffer_load_dwordx4 a[236:239], v0, s[12:15], s24 offen offset:3072
 v_mfma_f32_16x16x32_bf16 v[128:131], a[232:235], a[160:163], v[128:131]
 buffer_load_dwordx4 a[232:235], v0, s[12:15], s24 offen offset:2048
 s_waitcnt vmcnt(14) lgkmcnt(8)
 v_mfma_f32_16x16x32_bf16 v[16:19], a[176:179], a[128:131], v[16:19]
 v_mul_f32 v5, v5, v217
 v_cvt_pk_bf16_f32 v10, v6, v5
 v_mfma_f32_16x16x32_bf16 v[16:19], a[180:183], a[132:135], v[16:19]
 s_add_u32 s24, s24, 53248
 s_waitcnt lgkmcnt(6)
 v_mfma_f32_16x16x32_bf16 v[20:23], a[180:183], a[140:143], v[20:23]
 v_accvgpr_read_b32 v5, a99
 v_mfma_f32_16x16x32_bf16 v[20:23], a[176:179], a[136:139], v[20:23]
 s_waitcnt lgkmcnt(0)
 v_mfma_f32_16x16x32_bf16 v[24:27], a[176:179], a[144:147], v[24:27]
 v_lshlrev_b32 v6, 16, v5
 v_and_b32 v5, s26, v5
 v_mfma_f32_16x16x32_bf16 v[24:27], a[180:183], a[148:151], v[24:27]
 v_mfma_f32_16x16x32_bf16 v[28:31], a[180:183], a[156:159], v[28:31]
 buffer_load_dwordx4 a[180:183], v0, s[12:15], s24 offen offset:1024
 v_mfma_f32_16x16x32_bf16 v[28:31], a[176:179], a[152:155], v[28:31]
 buffer_load_dwordx4 a[176:179], v0, s[12:15], s24 offen
 s_waitcnt vmcnt(14)
 v_mfma_f32_16x16x32_bf16 v[44:47], a[184:187], a[152:155], v[44:47]
 v_mul_f32 v6, v6, v218
 v_mul_f32 v5, v5, v219
 v_mfma_f32_16x16x32_bf16 v[44:47], a[188:191], a[156:159], v[44:47]
 v_cvt_pk_bf16_f32 v11, v6, v5
 v_mfma_f32_16x16x32_bf16 v[40:43], a[188:191], a[148:151], v[40:43]
 ds_read_b128 a[160:163], v2 offset:8192
 v_mfma_f32_16x16x32_bf16 v[40:43], a[184:187], a[144:147], v[40:43]
 ds_write_b128 v3, v[8:11] offset:24576
 v_accvgpr_read_b32 v5, a100
 v_mfma_f32_16x16x32_bf16 v[36:39], a[184:187], a[136:139], v[36:39]
 ds_read_b128 a[164:167], v2 offset:12288
 v_mfma_f32_16x16x32_bf16 v[36:39], a[188:191], a[140:143], v[36:39]
 v_lshlrev_b32 v6, 16, v5
 v_mfma_f32_16x16x32_bf16 v[32:35], a[188:191], a[132:135], v[32:35]
 v_and_b32 v5, s26, v5
 buffer_load_dwordx4 a[188:191], v0, s[12:15], s24 offen offset:3072
 v_mfma_f32_16x16x32_bf16 v[32:35], a[184:187], a[128:131], v[32:35]
 buffer_load_dwordx4 a[184:187], v0, s[12:15], s24 offen offset:2048
 s_waitcnt vmcnt(14)
 v_mfma_f32_16x16x32_bf16 v[48:51], a[192:195], a[128:131], v[48:51]
 ds_read_b128 a[168:171], v2 offset:9216
 ds_read_b128 a[172:175], v2 offset:13312
 v_mfma_f32_16x16x32_bf16 v[48:51], a[196:199], a[132:135], v[48:51]
 s_add_u32 s24, s24, 4096
 v_mfma_f32_16x16x32_bf16 v[52:55], a[196:199], a[140:143], v[52:55]
 v_mul_f32 v6, v6, v204
 v_mfma_f32_16x16x32_bf16 v[52:55], a[192:195], a[136:139], v[52:55]
 v_mul_f32 v5, v5, v205
 v_cvt_pk_bf16_f32 v12, v6, v5
 v_mfma_f32_16x16x32_bf16 v[56:59], a[192:195], a[144:147], v[56:59]
 v_accvgpr_read_b32 v5, a101
 v_mfma_f32_16x16x32_bf16 v[56:59], a[196:199], a[148:151], v[56:59]
 v_lshlrev_b32 v6, 16, v5
 v_mfma_f32_16x16x32_bf16 v[60:63], a[196:199], a[156:159], v[60:63]
 v_and_b32 v5, s26, v5
 buffer_load_dwordx4 a[196:199], v0, s[12:15], s24 offen offset:1024
 v_mfma_f32_16x16x32_bf16 v[60:63], a[192:195], a[152:155], v[60:63]
 buffer_load_dwordx4 a[192:195], v0, s[12:15], s24 offen
 s_waitcnt vmcnt(14)
 v_mfma_f32_16x16x32_bf16 v[76:79], a[200:203], a[152:155], v[76:79]
 v_mul_f32 v6, v6, v206
 v_mfma_f32_16x16x32_bf16 v[76:79], a[204:207], a[156:159], v[76:79]
 v_mul_f32 v5, v5, v207
 v_cvt_pk_bf16_f32 v13, v6, v5
 v_mfma_f32_16x16x32_bf16 v[72:75], a[204:207], a[148:151], v[72:75]
 v_accvgpr_read_b32 v5, a102
 v_mfma_f32_16x16x32_bf16 v[72:75], a[200:203], a[144:147], v[72:75]
 v_lshlrev_b32 v6, 16, v5
 v_mfma_f32_16x16x32_bf16 v[68:71], a[200:203], a[136:139], v[68:71]
 v_and_b32 v5, s26, v5
 v_mul_f32 v6, v6, v220
 v_mfma_f32_16x16x32_bf16 v[68:71], a[204:207], a[140:143], v[68:71]
 v_mul_f32 v5, v5, v221
 v_mfma_f32_16x16x32_bf16 v[64:67], a[204:207], a[132:135], v[64:67]
 buffer_load_dwordx4 a[204:207], v0, s[12:15], s24 offen offset:3072
 v_mfma_f32_16x16x32_bf16 v[64:67], a[200:203], a[128:131], v[64:67]
 buffer_load_dwordx4 a[200:203], v0, s[12:15], s24 offen offset:2048
 s_waitcnt vmcnt(14)
 v_mfma_f32_16x16x32_bf16 v[80:83], a[208:211], a[128:131], v[80:83]
 v_cvt_pk_bf16_f32 v14, v6, v5
 v_accvgpr_read_b32 v5, a103
 v_mfma_f32_16x16x32_bf16 v[80:83], a[212:215], a[132:135], v[80:83]
 s_add_u32 s24, s24, 4096
 v_mfma_f32_16x16x32_bf16 v[84:87], a[212:215], a[140:143], v[84:87]
 v_lshlrev_b32 v6, 16, v5
 v_mfma_f32_16x16x32_bf16 v[84:87], a[208:211], a[136:139], v[84:87]
 v_and_b32 v5, s26, v5
 v_mul_f32 v6, v6, v222
 v_mfma_f32_16x16x32_bf16 v[88:91], a[208:211], a[144:147], v[88:91]
 v_mul_f32 v5, v5, v223
 v_mfma_f32_16x16x32_bf16 v[88:91], a[212:215], a[148:151], v[88:91]
 v_cvt_pk_bf16_f32 v15, v6, v5
 v_mfma_f32_16x16x32_bf16 v[92:95], a[212:215], a[156:159], v[92:95]
 ds_write_b128 v3, v[12:15] offset:25600
 buffer_load_dwordx4 a[212:215], v0, s[12:15], s24 offen offset:1024
 v_mfma_f32_16x16x32_bf16 v[92:95], a[208:211], a[152:155], v[92:95]
 buffer_load_dwordx4 a[208:211], v0, s[12:15], s24 offen
 s_waitcnt vmcnt(14)
 v_mfma_f32_16x16x32_bf16 v[108:111], a[216:219], a[152:155], v[108:111]
 v_accvgpr_read_b32 v5, a104
 v_mfma_f32_16x16x32_bf16 v[108:111], a[220:223], a[156:159], v[108:111]
 v_lshlrev_b32 v6, 16, v5
 v_mfma_f32_16x16x32_bf16 v[104:107], a[220:223], a[148:151], v[104:107]
 v_and_b32 v5, s26, v5
 v_mul_f32 v6, v6, v208
 v_mfma_f32_16x16x32_bf16 v[104:107], a[216:219], a[144:147], v[104:107]
 v_mul_f32 v5, v5, v209
 v_mfma_f32_16x16x32_bf16 v[100:103], a[216:219], a[136:139], v[100:103]
 v_cvt_pk_bf16_f32 v8, v6, v5
 v_mfma_f32_16x16x32_bf16 v[100:103], a[220:223], a[140:143], v[100:103]
 v_accvgpr_read_b32 v5, a105
 v_lshlrev_b32 v6, 16, v5
 v_mfma_f32_16x16x32_bf16 v[96:99], a[220:223], a[132:135], v[96:99]
 buffer_load_dwordx4 a[220:223], v0, s[12:15], s24 offen offset:3072
 v_mfma_f32_16x16x32_bf16 v[96:99], a[216:219], a[128:131], v[96:99]
 buffer_load_dwordx4 a[216:219], v0, s[12:15], s24 offen offset:2048
 s_waitcnt vmcnt(14)
 v_mfma_f32_16x16x32_bf16 v[112:115], a[224:227], a[128:131], v[112:115]
 v_and_b32 v5, s26, v5
 v_mul_f32 v6, v6, v210
 v_mfma_f32_16x16x32_bf16 v[112:115], a[228:231], a[132:135], v[112:115]
 s_add_u32 s24, s24, 4096
 v_mfma_f32_16x16x32_bf16 v[116:119], a[228:231], a[140:143], v[116:119]
 v_mul_f32 v5, v5, v211
 v_mfma_f32_16x16x32_bf16 v[116:119], a[224:227], a[136:139], v[116:119]
 v_cvt_pk_bf16_f32 v9, v6, v5
 v_accvgpr_read_b32 v5, a106
 v_mfma_f32_16x16x32_bf16 v[120:123], a[224:227], a[144:147], v[120:123]
 v_lshlrev_b32 v6, 16, v5
 v_mfma_f32_16x16x32_bf16 v[120:123], a[228:231], a[148:151], v[120:123]
 v_and_b32 v5, s26, v5
 v_mfma_f32_16x16x32_bf16 v[124:127], a[228:231], a[156:159], v[124:127]
 v_mul_f32 v6, v6, v224
 buffer_load_dwordx4 a[228:231], v0, s[12:15], s24 offen offset:1024
 v_mfma_f32_16x16x32_bf16 v[124:127], a[224:227], a[152:155], v[124:127]
 buffer_load_dwordx4 a[224:227], v0, s[12:15], s24 offen
 s_waitcnt vmcnt(14)
 v_mfma_f32_16x16x32_bf16 a[244:247], a[232:235], a[152:155], a[244:247]
 ds_read_b128 a[152:155], v2 offset:11264
 v_mfma_f32_16x16x32_bf16 a[244:247], a[236:239], a[156:159], a[244:247]
 ds_read_b128 a[156:159], v2 offset:15360
 v_mfma_f32_16x16x32_bf16 a[240:243], a[236:239], a[148:151], a[240:243]
 v_mul_f32 v5, v5, v225
 ds_read_b128 a[148:151], v2 offset:14336
 v_mfma_f32_16x16x32_bf16 a[240:243], a[232:235], a[144:147], a[240:243]
 ds_read_b128 a[144:147], v2 offset:10240
 v_mfma_f32_16x16x32_bf16 v[132:135], a[232:235], a[136:139], v[132:135]
 v_cvt_pk_bf16_f32 v10, v6, v5
 v_mfma_f32_16x16x32_bf16 v[132:135], a[236:239], a[140:143], v[132:135]
 v_accvgpr_read_b32 v5, a107
 v_lshlrev_b32 v6, 16, v5
 v_mfma_f32_16x16x32_bf16 v[128:131], a[236:239], a[132:135], v[128:131]
 buffer_load_dwordx4 a[236:239], v0, s[12:15], s24 offen offset:3072
 v_mfma_f32_16x16x32_bf16 v[128:131], a[232:235], a[128:131], v[128:131]
 buffer_load_dwordx4 a[232:235], v0, s[12:15], s24 offen offset:2048
 s_waitcnt vmcnt(14) lgkmcnt(7)
 v_mfma_f32_16x16x32_bf16 v[16:19], a[176:179], a[160:163], v[16:19]
 v_and_b32 v5, s26, v5
 v_mfma_f32_16x16x32_bf16 v[16:19], a[180:183], a[164:167], v[16:19]
 s_add_u32 s24, s24, 53248
 s_waitcnt lgkmcnt(5)
 v_mfma_f32_16x16x32_bf16 v[20:23], a[180:183], a[172:175], v[20:23]
 v_mul_f32 v6, v6, v226
 v_mul_f32 v5, v5, v227
 v_mfma_f32_16x16x32_bf16 v[20:23], a[176:179], a[168:171], v[20:23]
 s_waitcnt lgkmcnt(0)
 v_mfma_f32_16x16x32_bf16 v[24:27], a[176:179], a[144:147], v[24:27]
 v_cvt_pk_bf16_f32 v11, v6, v5
 v_mfma_f32_16x16x32_bf16 v[24:27], a[180:183], a[148:151], v[24:27]
 ds_write_b128 v3, v[8:11] offset:26624
 v_mfma_f32_16x16x32_bf16 v[28:31], a[180:183], a[156:159], v[28:31]
 buffer_load_dwordx4 a[180:183], v0, s[12:15], s24 offen offset:1024
 v_mfma_f32_16x16x32_bf16 v[28:31], a[176:179], a[152:155], v[28:31]
 buffer_load_dwordx4 a[176:179], v0, s[12:15], s24 offen
 s_waitcnt vmcnt(14)
 v_mfma_f32_16x16x32_bf16 v[44:47], a[184:187], a[152:155], v[44:47]
 v_accvgpr_read_b32 v5, a108
 v_mfma_f32_16x16x32_bf16 v[44:47], a[188:191], a[156:159], v[44:47]
 v_lshlrev_b32 v6, 16, v5
 v_and_b32 v5, s26, v5
 v_mfma_f32_16x16x32_bf16 v[40:43], a[188:191], a[148:151], v[40:43]
 ds_read_b128 a[128:131], v2 offset:32768
 v_mfma_f32_16x16x32_bf16 v[40:43], a[184:187], a[144:147], v[40:43]
 v_mul_f32 v6, v6, v212
 v_mul_f32 v5, v5, v213
 v_mfma_f32_16x16x32_bf16 v[36:39], a[184:187], a[168:171], v[36:39]
 ds_read_b128 a[132:135], v2 offset:36864
 v_mfma_f32_16x16x32_bf16 v[36:39], a[188:191], a[172:175], v[36:39]
 v_cvt_pk_bf16_f32 v12, v6, v5
 v_mfma_f32_16x16x32_bf16 v[32:35], a[188:191], a[164:167], v[32:35]
 v_accvgpr_read_b32 v5, a109
 buffer_load_dwordx4 a[188:191], v0, s[12:15], s24 offen offset:3072
 v_mfma_f32_16x16x32_bf16 v[32:35], a[184:187], a[160:163], v[32:35]
 buffer_load_dwordx4 a[184:187], v0, s[12:15], s24 offen offset:2048
 s_waitcnt vmcnt(14)
 v_mfma_f32_16x16x32_bf16 v[48:51], a[192:195], a[160:163], v[48:51]
 ds_read_b128 a[136:139], v2 offset:33792
 ds_read_b128 a[140:143], v2 offset:37888
 v_mfma_f32_16x16x32_bf16 v[48:51], a[196:199], a[164:167], v[48:51]
 s_add_u32 s24, s24, 4096
 v_mfma_f32_16x16x32_bf16 v[52:55], a[196:199], a[172:175], v[52:55]
 v_lshlrev_b32 v6, 16, v5
 v_mfma_f32_16x16x32_bf16 v[52:55], a[192:195], a[168:171], v[52:55]
 v_and_b32 v5, s26, v5
 v_mul_f32 v6, v6, v214
 v_mfma_f32_16x16x32_bf16 v[56:59], a[192:195], a[144:147], v[56:59]
 v_mul_f32 v5, v5, v215
 v_mfma_f32_16x16x32_bf16 v[56:59], a[196:199], a[148:151], v[56:59]
 v_cvt_pk_bf16_f32 v13, v6, v5
 v_mfma_f32_16x16x32_bf16 v[60:63], a[196:199], a[156:159], v[60:63]
 v_accvgpr_read_b32 v5, a110
 buffer_load_dwordx4 a[196:199], v0, s[12:15], s24 offen offset:1024
 v_mfma_f32_16x16x32_bf16 v[60:63], a[192:195], a[152:155], v[60:63]
 buffer_load_dwordx4 a[192:195], v0, s[12:15], s24 offen
 s_waitcnt vmcnt(14)
 v_mfma_f32_16x16x32_bf16 v[76:79], a[200:203], a[152:155], v[76:79]
 v_lshlrev_b32 v6, 16, v5
 v_mfma_f32_16x16x32_bf16 v[76:79], a[204:207], a[156:159], v[76:79]
 v_and_b32 v5, s26, v5
 v_mfma_f32_16x16x32_bf16 v[72:75], a[204:207], a[148:151], v[72:75]
 v_mul_f32 v6, v6, v228
 v_mul_f32 v5, v5, v229
 v_mfma_f32_16x16x32_bf16 v[72:75], a[200:203], a[144:147], v[72:75]
 v_cvt_pk_bf16_f32 v14, v6, v5
 v_mfma_f32_16x16x32_bf16 v[68:71], a[200:203], a[168:171], v[68:71]
 v_accvgpr_read_b32 v5, a111
 v_mfma_f32_16x16x32_bf16 v[68:71], a[204:207], a[172:175], v[68:71]
 v_lshlrev_b32 v6, 16, v5
 v_and_b32 v5, s26, v5
 v_mfma_f32_16x16x32_bf16 v[64:67], a[204:207], a[164:167], v[64:67]
 buffer_load_dwordx4 a[204:207], v0, s[12:15], s24 offen offset:3072
 v_mfma_f32_16x16x32_bf16 v[64:67], a[200:203], a[160:163], v[64:67]
 buffer_load_dwordx4 a[200:203], v0, s[12:15], s24 offen offset:2048
 s_waitcnt vmcnt(14)
 v_mfma_f32_16x16x32_bf16 v[80:83], a[208:211], a[160:163], v[80:83]
 v_mul_f32 v6, v6, v230
 v_mfma_f32_16x16x32_bf16 v[80:83], a[212:215], a[164:167], v[80:83]
 v_mul_f32 v5, v5, v231
 s_add_u32 s24, s24, 4096
 v_mfma_f32_16x16x32_bf16 v[84:87], a[212:215], a[172:175], v[84:87]
 v_cvt_pk_bf16_f32 v15, v6, v5
 v_mfma_f32_16x16x32_bf16 v[84:87], a[208:211], a[168:171], v[84:87]
 ds_write_b128 v3, v[12:15] offset:27648
 v_accvgpr_read_b32 v5, a112
 v_mfma_f32_16x16x32_bf16 v[88:91], a[208:211], a[144:147], v[88:91]
 v_lshlrev_b32 v6, 16, v5
 v_mfma_f32_16x16x32_bf16 v[88:91], a[212:215], a[148:151], v[88:91]
 v_and_b32 v5, s26, v5
 v_mfma_f32_16x16x32_bf16 v[92:95], a[212:215], a[156:159], v[92:95]
 v_mul_f32 v6, v6, v232
 buffer_load_dwordx4 a[212:215], v0, s[12:15], s24 offen offset:1024
 v_mfma_f32_16x16x32_bf16 v[92:95], a[208:211], a[152:155], v[92:95]
 buffer_load_dwordx4 a[208:211], v0, s[12:15], s24 offen
 s_waitcnt vmcnt(14)
 v_mfma_f32_16x16x32_bf16 v[108:111], a[216:219], a[152:155], v[108:111]
 v_mul_f32 v5, v5, v233
 v_mfma_f32_16x16x32_bf16 v[108:111], a[220:223], a[156:159], v[108:111]
 v_cvt_pk_bf16_f32 v8, v6, v5
 v_mfma_f32_16x16x32_bf16 v[104:107], a[220:223], a[148:151], v[104:107]
 v_accvgpr_read_b32 v5, a113
 v_lshlrev_b32 v6, 16, v5
 v_mfma_f32_16x16x32_bf16 v[104:107], a[216:219], a[144:147], v[104:107]
 v_and_b32 v5, s26, v5
 v_mfma_f32_16x16x32_bf16 v[100:103], a[216:219], a[168:171], v[100:103]
 v_mul_f32 v6, v6, v234
 v_mfma_f32_16x16x32_bf16 v[100:103], a[220:223], a[172:175], v[100:103]
 v_mul_f32 v5, v5, v235
 v_cvt_pk_bf16_f32 v9, v6, v5
 v_mfma_f32_16x16x32_bf16 v[96:99], a[220:223], a[164:167], v[96:99]
 buffer_load_dwordx4 a[220:223], v0, s[12:15], s24 offen offset:3072
 v_mfma_f32_16x16x32_bf16 v[96:99], a[216:219], a[160:163], v[96:99]
 buffer_load_dwordx4 a[216:219], v0, s[12:15], s24 offen offset:2048
 s_waitcnt vmcnt(14)
 v_mfma_f32_16x16x32_bf16 v[112:115], a[224:227], a[160:163], v[112:115]
 v_accvgpr_read_b32 v5, a114
 v_mfma_f32_16x16x32_bf16 v[112:115], a[228:231], a[164:167], v[112:115]
 v_lshlrev_b32 v6, 16, v5
 s_add_u32 s24, s24, 4096
 v_mfma_f32_16x16x32_bf16 v[116:119], a[228:231], a[172:175], v[116:119]
 v_and_b32 v5, s26, v5
 v_mfma_f32_16x16x32_bf16 v[116:119], a[224:227], a[168:171], v[116:119]
 v_mul_f32 v6, v6, v248
 v_mfma_f32_16x16x32_bf16 v[120:123], a[224:227], a[144:147], v[120:123]
 v_mul_f32 v5, v5, v249
 v_cvt_pk_bf16_f32 v10, v6, v5
 v_mfma_f32_16x16x32_bf16 v[120:123], a[228:231], a[148:151], v[120:123]
 v_accvgpr_read_b32 v5, a115
 v_mfma_f32_16x16x32_bf16 v[124:127], a[228:231], a[156:159], v[124:127]
 buffer_load_dwordx4 a[228:231], v0, s[12:15], s24 offen offset:1024
 v_mfma_f32_16x16x32_bf16 v[124:127], a[224:227], a[152:155], v[124:127]
 buffer_load_dwordx4 a[224:227], v0, s[12:15], s24 offen
 s_waitcnt vmcnt(14)
 v_mfma_f32_16x16x32_bf16 a[244:247], a[232:235], a[152:155], a[244:247]
 v_lshlrev_b32 v6, 16, v5
 ds_read_b128 a[152:155], v2 offset:35840
 v_mfma_f32_16x16x32_bf16 a[244:247], a[236:239], a[156:159], a[244:247]
 ds_read_b128 a[156:159], v2 offset:39936
 v_mfma_f32_16x16x32_bf16 a[240:243], a[236:239], a[148:151], a[240:243]
 ds_read_b128 a[148:151], v2 offset:38912
 v_mfma_f32_16x16x32_bf16 a[240:243], a[232:235], a[144:147], a[240:243]
 v_and_b32 v5, s26, v5
 ds_read_b128 a[144:147], v2 offset:34816
 v_mfma_f32_16x16x32_bf16 v[132:135], a[232:235], a[168:171], v[132:135]
 v_mul_f32 v6, v6, v250
 v_mfma_f32_16x16x32_bf16 v[132:135], a[236:239], a[172:175], v[132:135]
 v_mul_f32 v5, v5, v251
 v_cvt_pk_bf16_f32 v11, v6, v5
 v_mfma_f32_16x16x32_bf16 v[128:131], a[236:239], a[164:167], v[128:131]
 buffer_load_dwordx4 a[236:239], v0, s[12:15], s24 offen offset:3072
 v_mfma_f32_16x16x32_bf16 v[128:131], a[232:235], a[160:163], v[128:131]
 buffer_load_dwordx4 a[232:235], v0, s[12:15], s24 offen offset:2048
 s_waitcnt vmcnt(14) lgkmcnt(7)
 v_mfma_f32_16x16x32_bf16 v[16:19], a[176:179], a[128:131], v[16:19]
 ds_write_b128 v3, v[8:11] offset:28672
 v_mfma_f32_16x16x32_bf16 v[16:19], a[180:183], a[132:135], v[16:19]
 s_add_u32 s24, s24, 53248
 s_waitcnt lgkmcnt(6)
 v_mfma_f32_16x16x32_bf16 v[20:23], a[180:183], a[140:143], v[20:23]
 v_accvgpr_read_b32 v5, a116
 v_lshlrev_b32 v6, 16, v5
 v_mfma_f32_16x16x32_bf16 v[20:23], a[176:179], a[136:139], v[20:23]
 s_waitcnt lgkmcnt(1)
 v_mfma_f32_16x16x32_bf16 v[24:27], a[176:179], a[144:147], v[24:27]
 v_and_b32 v5, s26, v5
 v_mfma_f32_16x16x32_bf16 v[24:27], a[180:183], a[148:151], v[24:27]
 v_mul_f32 v6, v6, v236
 v_mfma_f32_16x16x32_bf16 v[28:31], a[180:183], a[156:159], v[28:31]
 buffer_load_dwordx4 a[180:183], v0, s[12:15], s24 offen offset:1024
 v_mfma_f32_16x16x32_bf16 v[28:31], a[176:179], a[152:155], v[28:31]
 buffer_load_dwordx4 a[176:179], v0, s[12:15], s24 offen
 s_waitcnt vmcnt(14)
 v_mfma_f32_16x16x32_bf16 v[44:47], a[184:187], a[152:155], v[44:47]
 v_mul_f32 v5, v5, v237
 v_mfma_f32_16x16x32_bf16 v[44:47], a[188:191], a[156:159], v[44:47]
 v_cvt_pk_bf16_f32 v12, v6, v5
 v_accvgpr_read_b32 v5, a117
 v_mfma_f32_16x16x32_bf16 v[40:43], a[188:191], a[148:151], v[40:43]
 ds_read_b128 a[160:163], v2 offset:40960
 v_mfma_f32_16x16x32_bf16 v[40:43], a[184:187], a[144:147], v[40:43]
 v_lshlrev_b32 v6, 16, v5
 v_mfma_f32_16x16x32_bf16 v[36:39], a[184:187], a[136:139], v[36:39]
 v_and_b32 v5, s26, v5
 ds_read_b128 a[164:167], v2 offset:45056
 v_mfma_f32_16x16x32_bf16 v[36:39], a[188:191], a[140:143], v[36:39]
 v_mul_f32 v6, v6, v238
 v_mfma_f32_16x16x32_bf16 v[32:35], a[188:191], a[132:135], v[32:35]
 buffer_load_dwordx4 a[188:191], v0, s[12:15], s24 offen offset:3072
 v_mfma_f32_16x16x32_bf16 v[32:35], a[184:187], a[128:131], v[32:35]
 buffer_load_dwordx4 a[184:187], v0, s[12:15], s24 offen offset:2048
 s_waitcnt vmcnt(14)
 v_mfma_f32_16x16x32_bf16 v[48:51], a[192:195], a[128:131], v[48:51]
 ds_read_b128 a[168:171], v2 offset:41984
 ds_read_b128 a[172:175], v2 offset:46080
 v_mfma_f32_16x16x32_bf16 v[48:51], a[196:199], a[132:135], v[48:51]
 v_mul_f32 v5, v5, v239
 s_add_u32 s24, s24, 4096
 v_mfma_f32_16x16x32_bf16 v[52:55], a[196:199], a[140:143], v[52:55]
 v_cvt_pk_bf16_f32 v13, v6, v5
 v_mfma_f32_16x16x32_bf16 v[52:55], a[192:195], a[136:139], v[52:55]
 v_accvgpr_read_b32 v5, a118
 v_mfma_f32_16x16x32_bf16 v[56:59], a[192:195], a[144:147], v[56:59]
 v_lshlrev_b32 v6, 16, v5
 v_and_b32 v5, s26, v5
 v_mfma_f32_16x16x32_bf16 v[56:59], a[196:199], a[148:151], v[56:59]
 v_mul_f32 v6, v6, v252
 v_mfma_f32_16x16x32_bf16 v[60:63], a[196:199], a[156:159], v[60:63]
 v_mul_f32 v5, v5, v253
 buffer_load_dwordx4 a[196:199], v0, s[12:15], s24 offen offset:1024
 v_mfma_f32_16x16x32_bf16 v[60:63], a[192:195], a[152:155], v[60:63]
 buffer_load_dwordx4 a[192:195], v0, s[12:15], s24 offen
 s_waitcnt vmcnt(14)
 v_mfma_f32_16x16x32_bf16 v[76:79], a[200:203], a[152:155], v[76:79]
 v_cvt_pk_bf16_f32 v14, v6, v5
 v_mfma_f32_16x16x32_bf16 v[76:79], a[204:207], a[156:159], v[76:79]
 v_accvgpr_read_b32 v5, a119
 v_mfma_f32_16x16x32_bf16 v[72:75], a[204:207], a[148:151], v[72:75]
 v_lshlrev_b32 v6, 16, v5
 v_and_b32 v5, s26, v5
 v_mfma_f32_16x16x32_bf16 v[72:75], a[200:203], a[144:147], v[72:75]
 v_mul_f32 v6, v6, v254
 v_mfma_f32_16x16x32_bf16 v[68:71], a[200:203], a[136:139], v[68:71]
 v_mul_f32 v5, v5, v255
 v_mfma_f32_16x16x32_bf16 v[68:71], a[204:207], a[140:143], v[68:71]
 v_cvt_pk_bf16_f32 v15, v6, v5
 ds_write_b128 v3, v[12:15] offset:29696
 v_mfma_f32_16x16x32_bf16 v[64:67], a[204:207], a[132:135], v[64:67]
 buffer_load_dwordx4 a[204:207], v0, s[12:15], s24 offen offset:3072
 v_mfma_f32_16x16x32_bf16 v[64:67], a[200:203], a[128:131], v[64:67]
 buffer_load_dwordx4 a[200:203], v0, s[12:15], s24 offen offset:2048
 s_waitcnt vmcnt(14)
 v_mfma_f32_16x16x32_bf16 v[80:83], a[208:211], a[128:131], v[80:83]
 v_accvgpr_read_b32 v5, a120
 v_mfma_f32_16x16x32_bf16 v[80:83], a[212:215], a[132:135], v[80:83]
 v_lshlrev_b32 v6, 16, v5
 s_add_u32 s24, s24, 4096
 v_mfma_f32_16x16x32_bf16 v[84:87], a[212:215], a[140:143], v[84:87]
 v_and_b32 v5, s26, v5
 v_mfma_f32_16x16x32_bf16 v[84:87], a[208:211], a[136:139], v[84:87]
 v_mul_f32 v6, v6, v240
 v_mfma_f32_16x16x32_bf16 v[88:91], a[208:211], a[144:147], v[88:91]
 v_mul_f32 v5, v5, v241
 v_cvt_pk_bf16_f32 v8, v6, v5
 v_mfma_f32_16x16x32_bf16 v[88:91], a[212:215], a[148:151], v[88:91]
 v_accvgpr_read_b32 v5, a121
 v_mfma_f32_16x16x32_bf16 v[92:95], a[212:215], a[156:159], v[92:95]
 buffer_load_dwordx4 a[212:215], v0, s[12:15], s24 offen offset:1024
 v_mfma_f32_16x16x32_bf16 v[92:95], a[208:211], a[152:155], v[92:95]
 buffer_load_dwordx4 a[208:211], v0, s[12:15], s24 offen
 s_waitcnt vmcnt(14)
 v_mfma_f32_16x16x32_bf16 v[108:111], a[216:219], a[152:155], v[108:111]
 v_lshlrev_b32 v6, 16, v5
 v_and_b32 v5, s26, v5
 v_mfma_f32_16x16x32_bf16 v[108:111], a[220:223], a[156:159], v[108:111]
 v_mul_f32 v6, v6, v242
 v_mfma_f32_16x16x32_bf16 v[104:107], a[220:223], a[148:151], v[104:107]
 v_mul_f32 v5, v5, v243
 v_mfma_f32_16x16x32_bf16 v[104:107], a[216:219], a[144:147], v[104:107]
 v_cvt_pk_bf16_f32 v9, v6, v5
 v_accvgpr_read_b32 v5, a122
 v_mfma_f32_16x16x32_bf16 v[100:103], a[216:219], a[136:139], v[100:103]
 v_accvgpr_read_b32 v7, a248
 v_mfma_f32_16x16x32_bf16 v[100:103], a[220:223], a[140:143], v[100:103]
 v_lshlrev_b32 v6, 16, v5
 v_mfma_f32_16x16x32_bf16 v[96:99], a[220:223], a[132:135], v[96:99]
 v_and_b32 v5, s26, v5
 buffer_load_dwordx4 a[220:223], v0, s[12:15], s24 offen offset:3072
 v_mfma_f32_16x16x32_bf16 v[96:99], a[216:219], a[128:131], v[96:99]
 buffer_load_dwordx4 a[216:219], v0, s[12:15], s24 offen offset:2048
 s_waitcnt vmcnt(14)
 v_mfma_f32_16x16x32_bf16 v[112:115], a[224:227], a[128:131], v[112:115]
 v_mul_f32 v6, v6, v7
 v_mfma_f32_16x16x32_bf16 v[112:115], a[228:231], a[132:135], v[112:115]
 v_accvgpr_read_b32 v7, a249
 s_add_u32 s24, s24, 4096
 v_mfma_f32_16x16x32_bf16 v[116:119], a[228:231], a[140:143], v[116:119]
 v_mul_f32 v5, v5, v7
 v_mfma_f32_16x16x32_bf16 v[116:119], a[224:227], a[136:139], v[116:119]
 v_cvt_pk_bf16_f32 v10, v6, v5
 v_mfma_f32_16x16x32_bf16 v[120:123], a[224:227], a[144:147], v[120:123]
 v_accvgpr_read_b32 v5, a123
 v_accvgpr_read_b32 v7, a250
 v_mfma_f32_16x16x32_bf16 v[120:123], a[228:231], a[148:151], v[120:123]
 v_lshlrev_b32 v6, 16, v5
 v_mfma_f32_16x16x32_bf16 v[124:127], a[228:231], a[156:159], v[124:127]
 buffer_load_dwordx4 a[228:231], v0, s[12:15], s24 offen offset:1024
 v_mfma_f32_16x16x32_bf16 v[124:127], a[224:227], a[152:155], v[124:127]
 buffer_load_dwordx4 a[224:227], v0, s[12:15], s24 offen
 s_waitcnt vmcnt(14)
 v_mfma_f32_16x16x32_bf16 a[244:247], a[232:235], a[152:155], a[244:247]
 v_and_b32 v5, s26, v5
 ds_read_b128 a[152:155], v2 offset:44032
 v_mfma_f32_16x16x32_bf16 a[244:247], a[236:239], a[156:159], a[244:247]
 ds_read_b128 a[156:159], v2 offset:48128
 v_mfma_f32_16x16x32_bf16 a[240:243], a[236:239], a[148:151], a[240:243]
 ds_read_b128 a[148:151], v2 offset:47104
 v_mfma_f32_16x16x32_bf16 a[240:243], a[232:235], a[144:147], a[240:243]
 v_mul_f32 v6, v6, v7
 ds_read_b128 a[144:147], v2 offset:43008
 v_mfma_f32_16x16x32_bf16 v[132:135], a[232:235], a[136:139], v[132:135]
 v_accvgpr_read_b32 v7, a251
 v_mfma_f32_16x16x32_bf16 v[132:135], a[236:239], a[140:143], v[132:135]
 v_mul_f32 v5, v5, v7
 v_mfma_f32_16x16x32_bf16 v[128:131], a[236:239], a[132:135], v[128:131]
 v_cvt_pk_bf16_f32 v11, v6, v5
 buffer_load_dwordx4 a[236:239], v0, s[12:15], s24 offen offset:3072
 v_mfma_f32_16x16x32_bf16 v[128:131], a[232:235], a[128:131], v[128:131]
 buffer_load_dwordx4 a[232:235], v0, s[12:15], s24 offen offset:2048
 s_waitcnt vmcnt(14) lgkmcnt(7)
 v_mfma_f32_16x16x32_bf16 v[16:19], a[176:179], a[160:163], v[16:19]
 ds_write_b128 v3, v[8:11] offset:30720
 v_mfma_f32_16x16x32_bf16 v[16:19], a[180:183], a[164:167], v[16:19]
 s_add_u32 s24, s24, 53248
 s_waitcnt lgkmcnt(6)
 v_mfma_f32_16x16x32_bf16 v[20:23], a[180:183], a[172:175], v[20:23]
 v_accvgpr_read_b32 v5, a124
 v_mfma_f32_16x16x32_bf16 v[20:23], a[176:179], a[168:171], v[20:23]
 v_lshlrev_b32 v6, 16, v5
 s_waitcnt lgkmcnt(1)
 v_mfma_f32_16x16x32_bf16 v[24:27], a[176:179], a[144:147], v[24:27]
 v_and_b32 v5, s26, v5
 v_mfma_f32_16x16x32_bf16 v[24:27], a[180:183], a[148:151], v[24:27]
 v_mfma_f32_16x16x32_bf16 v[28:31], a[180:183], a[156:159], v[28:31]
 v_mul_f32 v6, v6, v244
 buffer_load_dwordx4 a[180:183], v0, s[12:15], s24 offen offset:1024
 v_mfma_f32_16x16x32_bf16 v[28:31], a[176:179], a[152:155], v[28:31]
 buffer_load_dwordx4 a[176:179], v0, s[12:15], s24 offen
 s_waitcnt vmcnt(14)
 v_mfma_f32_16x16x32_bf16 v[44:47], a[184:187], a[152:155], v[44:47]
 v_mul_f32 v5, v5, v245
 v_mfma_f32_16x16x32_bf16 v[44:47], a[188:191], a[156:159], v[44:47]
 v_cvt_pk_bf16_f32 v12, v6, v5
 v_accvgpr_read_b32 v5, a125
 v_mfma_f32_16x16x32_bf16 v[40:43], a[188:191], a[148:151], v[40:43]
 v_lshlrev_b32 v6, 16, v5
 v_mfma_f32_16x16x32_bf16 v[40:43], a[184:187], a[144:147], v[40:43]
 v_and_b32 v5, s26, v5
 v_mfma_f32_16x16x32_bf16 v[36:39], a[184:187], a[168:171], v[36:39]
 v_mul_f32 v6, v6, v246
 v_mul_f32 v5, v5, v247
 v_mfma_f32_16x16x32_bf16 v[36:39], a[188:191], a[172:175], v[36:39]
 v_cvt_pk_bf16_f32 v13, v6, v5
 v_mfma_f32_16x16x32_bf16 v[32:35], a[188:191], a[164:167], v[32:35]
 buffer_load_dwordx4 a[188:191], v0, s[12:15], s24 offen offset:3072
 v_mfma_f32_16x16x32_bf16 v[32:35], a[184:187], a[160:163], v[32:35]
 buffer_load_dwordx4 a[184:187], v0, s[12:15], s24 offen offset:2048
 s_waitcnt vmcnt(14)
 v_mfma_f32_16x16x32_bf16 v[48:51], a[192:195], a[160:163], v[48:51]
 v_accvgpr_read_b32 v5, a126
 v_accvgpr_read_b32 v7, a252
 v_mfma_f32_16x16x32_bf16 v[48:51], a[196:199], a[164:167], v[48:51]
 s_add_u32 s24, s24, 4096
 v_mfma_f32_16x16x32_bf16 v[52:55], a[196:199], a[172:175], v[52:55]
 v_lshlrev_b32 v6, 16, v5
 v_mfma_f32_16x16x32_bf16 v[52:55], a[192:195], a[168:171], v[52:55]
 v_and_b32 v5, s26, v5
 v_mul_f32 v6, v6, v7
 v_mfma_f32_16x16x32_bf16 v[56:59], a[192:195], a[144:147], v[56:59]
 v_accvgpr_read_b32 v7, a253
 v_mfma_f32_16x16x32_bf16 v[56:59], a[196:199], a[148:151], v[56:59]
 v_mul_f32 v5, v5, v7
 v_mfma_f32_16x16x32_bf16 v[60:63], a[196:199], a[156:159], v[60:63]
 v_cvt_pk_bf16_f32 v14, v6, v5
 buffer_load_dwordx4 a[196:199], v0, s[12:15], s24 offen offset:1024
 v_mfma_f32_16x16x32_bf16 v[60:63], a[192:195], a[152:155], v[60:63]
 buffer_load_dwordx4 a[192:195], v0, s[12:15], s24 offen
 s_waitcnt vmcnt(14)
 v_mfma_f32_16x16x32_bf16 v[76:79], a[200:203], a[152:155], v[76:79]
 v_accvgpr_read_b32 v5, a127
 v_mfma_f32_16x16x32_bf16 v[76:79], a[204:207], a[156:159], v[76:79]
 v_accvgpr_read_b32 v7, a254
 v_mfma_f32_16x16x32_bf16 v[72:75], a[204:207], a[148:151], v[72:75]
 v_lshlrev_b32 v6, 16, v5
 v_and_b32 v5, s26, v5
 v_mfma_f32_16x16x32_bf16 v[72:75], a[200:203], a[144:147], v[72:75]
 v_mul_f32 v6, v6, v7
 v_mfma_f32_16x16x32_bf16 v[68:71], a[200:203], a[168:171], v[68:71]
 v_accvgpr_read_b32 v7, a255
 v_mfma_f32_16x16x32_bf16 v[68:71], a[204:207], a[172:175], v[68:71]
 v_mul_f32 v5, v5, v7
 v_cvt_pk_bf16_f32 v15, v6, v5
 v_mfma_f32_16x16x32_bf16 v[64:67], a[204:207], a[164:167], v[64:67]
 buffer_load_dwordx4 a[204:207], v0, s[12:15], s24 offen offset:3072
 v_mfma_f32_16x16x32_bf16 v[64:67], a[200:203], a[160:163], v[64:67]
 buffer_load_dwordx4 a[200:203], v0, s[12:15], s24 offen offset:2048
 s_waitcnt vmcnt(14)
 v_mfma_f32_16x16x32_bf16 v[80:83], a[208:211], a[160:163], v[80:83]
 ds_write_b128 v3, v[12:15] offset:31744
 v_mfma_f32_16x16x32_bf16 v[80:83], a[212:215], a[164:167], v[80:83]
 s_add_u32 s24, s24, 4096
 s_waitcnt lgkmcnt(0)
 s_barrier
 v_mfma_f32_16x16x32_bf16 v[84:87], a[212:215], a[172:175], v[84:87]
 ds_read_b128 a[128:131], v1 offset:16384
 v_mfma_f32_16x16x32_bf16 v[84:87], a[208:211], a[168:171], v[84:87]
 v_mfma_f32_16x16x32_bf16 v[88:91], a[208:211], a[144:147], v[88:91]
 ds_read_b128 a[132:135], v1 offset:20480
 v_mfma_f32_16x16x32_bf16 v[88:91], a[212:215], a[148:151], v[88:91]
 v_mfma_f32_16x16x32_bf16 v[92:95], a[212:215], a[156:159], v[92:95]
 buffer_load_dwordx4 a[212:215], v0, s[12:15], s24 offen offset:1024
 v_mfma_f32_16x16x32_bf16 v[92:95], a[208:211], a[152:155], v[92:95]
 buffer_load_dwordx4 a[208:211], v0, s[12:15], s24 offen
 s_waitcnt vmcnt(14)
 v_mfma_f32_16x16x32_bf16 v[108:111], a[216:219], a[152:155], v[108:111]
 ds_read_b128 a[136:139], v1 offset:17408
 ds_read_b128 a[140:143], v1 offset:21504
 v_mfma_f32_16x16x32_bf16 v[108:111], a[220:223], a[156:159], v[108:111]
 v_mfma_f32_16x16x32_bf16 v[104:107], a[220:223], a[148:151], v[104:107]
 v_mfma_f32_16x16x32_bf16 v[104:107], a[216:219], a[144:147], v[104:107]
 v_mfma_f32_16x16x32_bf16 v[100:103], a[216:219], a[168:171], v[100:103]
 v_mfma_f32_16x16x32_bf16 v[100:103], a[220:223], a[172:175], v[100:103]
 v_mfma_f32_16x16x32_bf16 v[96:99], a[220:223], a[164:167], v[96:99]
 buffer_load_dwordx4 a[220:223], v0, s[12:15], s24 offen offset:3072
 v_mfma_f32_16x16x32_bf16 v[96:99], a[216:219], a[160:163], v[96:99]
 buffer_load_dwordx4 a[216:219], v0, s[12:15], s24 offen offset:2048
 s_waitcnt vmcnt(14)
 v_mfma_f32_16x16x32_bf16 v[112:115], a[224:227], a[160:163], v[112:115]
 v_mfma_f32_16x16x32_bf16 v[112:115], a[228:231], a[164:167], v[112:115]
 s_add_u32 s24, s24, 4096
 v_mfma_f32_16x16x32_bf16 v[116:119], a[228:231], a[172:175], v[116:119]
 v_mfma_f32_16x16x32_bf16 v[116:119], a[224:227], a[168:171], v[116:119]
 v_mfma_f32_16x16x32_bf16 v[120:123], a[224:227], a[144:147], v[120:123]
 v_mfma_f32_16x16x32_bf16 v[120:123], a[228:231], a[148:151], v[120:123]
 v_mfma_f32_16x16x32_bf16 v[124:127], a[228:231], a[156:159], v[124:127]
 buffer_load_dwordx4 a[228:231], v0, s[12:15], s24 offen offset:1024
 v_mfma_f32_16x16x32_bf16 v[124:127], a[224:227], a[152:155], v[124:127]
 buffer_load_dwordx4 a[224:227], v0, s[12:15], s24 offen
 s_waitcnt vmcnt(14)
 v_mfma_f32_16x16x32_bf16 a[244:247], a[232:235], a[152:155], a[244:247]
 ds_read_b128 a[152:155], v1 offset:19456
 v_mfma_f32_16x16x32_bf16 a[244:247], a[236:239], a[156:159], a[244:247]
 ds_read_b128 a[156:159], v1 offset:23552
 v_mfma_f32_16x16x32_bf16 a[240:243], a[236:239], a[148:151], a[240:243]
 ds_read_b128 a[148:151], v1 offset:22528
 v_mfma_f32_16x16x32_bf16 a[240:243], a[232:235], a[144:147], a[240:243]
 ds_read_b128 a[144:147], v1 offset:18432
 v_mfma_f32_16x16x32_bf16 v[132:135], a[232:235], a[168:171], v[132:135]
 v_mfma_f32_16x16x32_bf16 v[132:135], a[236:239], a[172:175], v[132:135]
 v_mfma_f32_16x16x32_bf16 v[128:131], a[236:239], a[164:167], v[128:131]
 buffer_load_dwordx4 a[236:239], v0, s[12:15], s24 offen offset:3072
 v_mfma_f32_16x16x32_bf16 v[128:131], a[232:235], a[160:163], v[128:131]
 buffer_load_dwordx4 a[232:235], v0, s[12:15], s24 offen offset:2048
 s_add_u32 s24, s24, 53248
 s_waitcnt vmcnt(14) lgkmcnt(6)
 s_branch Lloop
Llast:
 v_mfma_f32_16x16x32_bf16 v[136:139], a[176:179], a[128:131], v[136:139]
 v_bfe_u32 v4, v1, 4, 4
 v_lshlrev_b32 v4, 11, v4
 v_mfma_f32_16x16x32_bf16 v[136:139], a[180:183], a[132:135], v[136:139]
 s_waitcnt lgkmcnt(4)
 v_mfma_f32_16x16x32_bf16 v[140:143], a[180:183], a[140:143], v[140:143]
 v_lshrrev_b32 v5, 8, v1
 v_mfma_f32_16x16x32_bf16 v[140:143], a[176:179], a[136:139], v[140:143]
 v_lshl_add_u32 v4, v5, 4, v4
 s_waitcnt lgkmcnt(0)
 v_mfma_f32_16x16x32_bf16 v[144:147], a[176:179], a[144:147], v[144:147]
 v_lshrrev_b32 v5, 14, v0
 v_mfma_f32_16x16x32_bf16 v[144:147], a[180:183], a[148:151], v[144:147]
 v_mfma_f32_16x16x32_bf16 v[148:151], a[180:183], a[156:159], v[148:151]
 buffer_load_dwordx4 a[180:183], v0, s[12:15], s24 offen offset:1024
 v_mfma_f32_16x16x32_bf16 v[148:151], a[176:179], a[152:155], v[148:151]
 buffer_load_dwordx4 a[176:179], v0, s[12:15], s24 offen
 s_waitcnt vmcnt(14)
 v_mfma_f32_16x16x32_bf16 v[164:167], a[184:187], a[152:155], v[164:167]
 v_lshl_add_u32 v4, v5, 8, v4
 v_accvgpr_read_b32 v5, a0
 v_mfma_f32_16x16x32_bf16 v[164:167], a[188:191], a[156:159], v[164:167]
 v_lshlrev_b32 v6, 16, v5
 v_mfma_f32_16x16x32_bf16 v[160:163], a[188:191], a[148:151], v[160:163]
 ds_read_b128 a[160:163], v1 offset:24576
 v_mfma_f32_16x16x32_bf16 v[160:163], a[184:187], a[144:147], v[160:163]
 v_and_b32 v5, s26, v5
 v_mfma_f32_16x16x32_bf16 v[156:159], a[184:187], a[136:139], v[156:159]
 v_mul_f32 v6, v6, v16
 ds_read_b128 a[164:167], v1 offset:28672
 v_mfma_f32_16x16x32_bf16 v[156:159], a[188:191], a[140:143], v[156:159]
 v_mul_f32 v5, v5, v17
 v_mfma_f32_16x16x32_bf16 v[152:155], a[188:191], a[132:135], v[152:155]
 buffer_load_dwordx4 a[188:191], v0, s[12:15], s24 offen offset:3072
 v_mfma_f32_16x16x32_bf16 v[152:155], a[184:187], a[128:131], v[152:155]
 buffer_load_dwordx4 a[184:187], v0, s[12:15], s24 offen offset:2048
 s_waitcnt vmcnt(14)
 v_mfma_f32_16x16x32_bf16 v[168:171], a[192:195], a[128:131], v[168:171]
 ds_read_b128 a[168:171], v1 offset:25600
 ds_read_b128 a[172:175], v1 offset:29696
 v_mfma_f32_16x16x32_bf16 v[168:171], a[196:199], a[132:135], v[168:171]
 s_add_u32 s24, s24, 4096
 v_mfma_f32_16x16x32_bf16 v[172:175], a[196:199], a[140:143], v[172:175]
 v_cvt_pk_bf16_f32 v8, v6, v5
 v_accvgpr_read_b32 v5, a1
 v_mfma_f32_16x16x32_bf16 v[172:175], a[192:195], a[136:139], v[172:175]
 v_lshlrev_b32 v6, 16, v5
 v_mfma_f32_16x16x32_bf16 v[176:179], a[192:195], a[144:147], v[176:179]
 v_and_b32 v5, s26, v5
 v_mfma_f32_16x16x32_bf16 v[176:179], a[196:199], a[148:151], v[176:179]
 v_mul_f32 v6, v6, v18
 v_mfma_f32_16x16x32_bf16 v[180:183], a[196:199], a[156:159], v[180:183]
 v_mul_f32 v5, v5, v19
 buffer_load_dwordx4 a[196:199], v0, s[12:15], s24 offen offset:1024
 v_mfma_f32_16x16x32_bf16 v[180:183], a[192:195], a[152:155], v[180:183]
 buffer_load_dwordx4 a[192:195], v0, s[12:15], s24 offen
 s_waitcnt vmcnt(14)
 v_mfma_f32_16x16x32_bf16 v[196:199], a[200:203], a[152:155], v[196:199]
 v_cvt_pk_bf16_f32 v9, v6, v5
 v_mfma_f32_16x16x32_bf16 v[196:199], a[204:207], a[156:159], v[196:199]
 v_accvgpr_read_b32 v5, a2
 v_mfma_f32_16x16x32_bf16 v[192:195], a[204:207], a[148:151], v[192:195]
 v_lshlrev_b32 v6, 16, v5
 v_and_b32 v5, s26, v5
 v_mfma_f32_16x16x32_bf16 v[192:195], a[200:203], a[144:147], v[192:195]
 v_mul_f32 v6, v6, v32
 v_mfma_f32_16x16x32_bf16 v[188:191], a[200:203], a[136:139], v[188:191]
 v_mul_f32 v5, v5, v33
 v_mfma_f32_16x16x32_bf16 v[188:191], a[204:207], a[140:143], v[188:191]
 v_cvt_pk_bf16_f32 v10, v6, v5
 v_mfma_f32_16x16x32_bf16 v[184:187], a[204:207], a[132:135], v[184:187]
 v_accvgpr_read_b32 v5, a3
 buffer_load_dwordx4 a[204:207], v0, s[12:15], s24 offen offset:3072
 v_mfma_f32_16x16x32_bf16 v[184:187], a[200:203], a[128:131], v[184:187]
 buffer_load_dwordx4 a[200:203], v0, s[12:15], s24 offen offset:2048
 s_waitcnt vmcnt(14)
 v_mfma_f32_16x16x32_bf16 v[200:203], a[208:211], a[128:131], v[200:203]
 v_lshlrev_b32 v6, 16, v5
 v_mfma_f32_16x16x32_bf16 v[200:203], a[212:215], a[132:135], v[200:203]
 s_add_u32 s24, s24, 4096
 v_mfma_f32_16x16x32_bf16 v[204:207], a[212:215], a[140:143], v[204:207]
 v_and_b32 v5, s26, v5
 v_mfma_f32_16x16x32_bf16 v[204:207], a[208:211], a[136:139], v[204:207]
 v_mul_f32 v6, v6, v34
 v_mul_f32 v5, v5, v35
 v_mfma_f32_16x16x32_bf16 v[208:211], a[208:211], a[144:147], v[208:211]
 v_cvt_pk_bf16_f32 v11, v6, v5
 v_mfma_f32_16x16x32_bf16 v[208:211], a[212:215], a[148:151], v[208:211]
 buffer_store_dwordx4 v[8:11], v4, s[16:19], s28 offen nt
 v_mfma_f32_16x16x32_bf16 v[212:215], a[212:215], a[156:159], v[212:215]
 buffer_load_dwordx4 a[212:215], v0, s[12:15], s24 offen offset:1024
 v_mfma_f32_16x16x32_bf16 v[212:215], a[208:211], a[152:155], v[212:215]
 buffer_load_dwordx4 a[208:211], v0, s[12:15], s24 offen
 s_waitcnt vmcnt(15)
 v_mfma_f32_16x16x32_bf16 v[228:231], a[216:219], a[152:155], v[228:231]
 v_accvgpr_read_b32 v5, a16
 v_lshlrev_b32 v6, 16, v5
 v_mfma_f32_16x16x32_bf16 v[228:231], a[220:223], a[156:159], v[228:231]
 v_and_b32 v5, s26, v5
 v_mfma_f32_16x16x32_bf16 v[224:227], a[220:223], a[148:151], v[224:227]
 v_mul_f32 v6, v6, v48
 v_mfma_f32_16x16x32_bf16 v[224:227], a[216:219], a[144:147], v[224:227]
 v_mul_f32 v5, v5, v49
 v_mfma_f32_16x16x32_bf16 v[220:223], a[216:219], a[136:139], v[220:223]
 v_cvt_pk_bf16_f32 v12, v6, v5
 v_accvgpr_read_b32 v5, a17
 v_mfma_f32_16x16x32_bf16 v[220:223], a[220:223], a[140:143], v[220:223]
 v_lshlrev_b32 v6, 16, v5
 v_mfma_f32_16x16x32_bf16 v[216:219], a[220:223], a[132:135], v[216:219]
 buffer_load_dwordx4 a[220:223], v0, s[12:15], s24 offen offset:3072
 v_mfma_f32_16x16x32_bf16 v[216:219], a[216:219], a[128:131], v[216:219]
 buffer_load_dwordx4 a[216:219], v0, s[12:15], s24 offen offset:2048
 s_waitcnt vmcnt(15)
 v_mfma_f32_16x16x32_bf16 v[232:235], a[224:227], a[128:131], v[232:235]
 v_and_b32 v5, s26, v5
 v_mul_f32 v6, v6, v50
 v_mfma_f32_16x16x32_bf16 v[232:235], a[228:231], a[132:135], v[232:235]
 s_add_u32 s24, s24, 4096
 v_mfma_f32_16x16x32_bf16 v[236:239], a[228:231], a[140:143], v[236:239]
 v_mul_f32 v5, v5, v51
 v_mfma_f32_16x16x32_bf16 v[236:239], a[224:227], a[136:139], v[236:239]
 v_cvt_pk_bf16_f32 v13, v6, v5
 v_mfma_f32_16x16x32_bf16 v[240:243], a[224:227], a[144:147], v[240:243]
 v_accvgpr_read_b32 v5, a18
 v_lshlrev_b32 v6, 16, v5
 v_mfma_f32_16x16x32_bf16 v[240:243], a[228:231], a[148:151], v[240:243]
 v_and_b32 v5, s26, v5
 v_mfma_f32_16x16x32_bf16 v[244:247], a[228:231], a[156:159], v[244:247]
 buffer_load_dwordx4 a[228:231], v0, s[12:15], s24 offen offset:1024
 v_mfma_f32_16x16x32_bf16 v[244:247], a[224:227], a[152:155], v[244:247]
 buffer_load_dwordx4 a[224:227], v0, s[12:15], s24 offen
 s_waitcnt vmcnt(15)
 v_mfma_f32_16x16x32_bf16 a[252:255], a[232:235], a[152:155], a[252:255]
 ds_read_b128 a[152:155], v1 offset:27648
 v_mfma_f32_16x16x32_bf16 a[252:255], a[236:239], a[156:159], a[252:255]
 v_mul_f32 v6, v6, v64
 ds_read_b128 a[156:159], v1 offset:31744
 v_mfma_f32_16x16x32_bf16 a[248:251], a[236:239], a[148:151], a[248:251]
 ds_read_b128 a[148:151], v1 offset:30720
 v_mfma_f32_16x16x32_bf16 a[248:251], a[232:235], a[144:147], a[248:251]
 ds_read_b128 a[144:147], v1 offset:26624
 v_mfma_f32_16x16x32_bf16 v[252:255], a[232:235], a[136:139], v[252:255]
 v_mul_f32 v5, v5, v65
 v_mfma_f32_16x16x32_bf16 v[252:255], a[236:239], a[140:143], v[252:255]
 v_cvt_pk_bf16_f32 v14, v6, v5
 v_accvgpr_read_b32 v5, a19
 v_mfma_f32_16x16x32_bf16 v[248:251], a[236:239], a[132:135], v[248:251]
 buffer_load_dwordx4 a[236:239], v0, s[12:15], s24 offen offset:3072
 v_mfma_f32_16x16x32_bf16 v[248:251], a[232:235], a[128:131], v[248:251]
 buffer_load_dwordx4 a[232:235], v0, s[12:15], s24 offen offset:2048
 s_waitcnt vmcnt(15) lgkmcnt(6)
 v_mfma_f32_16x16x32_bf16 v[136:139], a[176:179], a[160:163], v[136:139]
 v_lshlrev_b32 v6, 16, v5
 v_mfma_f32_16x16x32_bf16 v[136:139], a[180:183], a[164:167], v[136:139]
 s_add_u32 s24, s24, 53248
 s_waitcnt lgkmcnt(4)
 v_mfma_f32_16x16x32_bf16 v[140:143], a[180:183], a[172:175], v[140:143]
 v_and_b32 v5, s26, v5
 v_mfma_f32_16x16x32_bf16 v[140:143], a[176:179], a[168:171], v[140:143]
 v_mul_f32 v6, v6, v66
 s_waitcnt lgkmcnt(0)
 v_mfma_f32_16x16x32_bf16 v[144:147], a[176:179], a[144:147], v[144:147]
 v_mul_f32 v5, v5, v67
 v_mfma_f32_16x16x32_bf16 v[144:147], a[180:183], a[148:151], v[144:147]
 v_mfma_f32_16x16x32_bf16 v[148:151], a[180:183], a[156:159], v[148:151]
 v_cvt_pk_bf16_f32 v15, v6, v5
 buffer_load_dwordx4 a[180:183], v0, s[12:15], s24 offen offset:1024
 v_mfma_f32_16x16x32_bf16 v[148:151], a[176:179], a[152:155], v[148:151]
 buffer_load_dwordx4 a[176:179], v0, s[12:15], s24 offen
 s_waitcnt vmcnt(15)
 v_mfma_f32_16x16x32_bf16 v[164:167], a[184:187], a[152:155], v[164:167]
 buffer_store_dwordx4 v[12:15], v4, s[16:19], s28 offen offset:64 nt
 v_mfma_f32_16x16x32_bf16 v[164:167], a[188:191], a[156:159], v[164:167]
 v_accvgpr_read_b32 v5, a32
 v_mfma_f32_16x16x32_bf16 v[160:163], a[188:191], a[148:151], v[160:163]
 ds_read_b128 a[128:131], v1 offset:49152
 v_mfma_f32_16x16x32_bf16 v[160:163], a[184:187], a[144:147], v[160:163]
 v_lshlrev_b32 v6, 16, v5
 v_and_b32 v5, s26, v5
 v_mfma_f32_16x16x32_bf16 v[156:159], a[184:187], a[168:171], v[156:159]
 ds_read_b128 a[132:135], v1 offset:53248
 v_mfma_f32_16x16x32_bf16 v[156:159], a[188:191], a[172:175], v[156:159]
 v_mul_f32 v6, v6, v80
 v_mfma_f32_16x16x32_bf16 v[152:155], a[188:191], a[164:167], v[152:155]
 buffer_load_dwordx4 a[188:191], v0, s[12:15], s24 offen offset:3072
 v_mfma_f32_16x16x32_bf16 v[152:155], a[184:187], a[160:163], v[152:155]
 buffer_load_dwordx4 a[184:187], v0, s[12:15], s24 offen offset:2048
 s_waitcnt vmcnt(16)
 v_mfma_f32_16x16x32_bf16 v[168:171], a[192:195], a[160:163], v[168:171]
 ds_read_b128 a[136:139], v1 offset:50176
 ds_read_b128 a[140:143], v1 offset:54272
 v_mfma_f32_16x16x32_bf16 v[168:171], a[196:199], a[164:167], v[168:171]
 v_mul_f32 v5, v5, v81
 s_add_u32 s24, s24, 4096
 v_mfma_f32_16x16x32_bf16 v[172:175], a[196:199], a[172:175], v[172:175]
 v_cvt_pk_bf16_f32 v8, v6, v5
 v_mfma_f32_16x16x32_bf16 v[172:175], a[192:195], a[168:171], v[172:175]
 v_accvgpr_read_b32 v5, a33
 v_mfma_f32_16x16x32_bf16 v[176:179], a[192:195], a[144:147], v[176:179]
 v_lshlrev_b32 v6, 16, v5
 v_mfma_f32_16x16x32_bf16 v[176:179], a[196:199], a[148:151], v[176:179]
 v_and_b32 v5, s26, v5
 v_mul_f32 v6, v6, v82
 v_mfma_f32_16x16x32_bf16 v[180:183], a[196:199], a[156:159], v[180:183]
 buffer_load_dwordx4 a[196:199], v0, s[12:15], s24 offen offset:1024
 v_mfma_f32_16x16x32_bf16 v[180:183], a[192:195], a[152:155], v[180:183]
 buffer_load_dwordx4 a[192:195], v0, s[12:15], s24 offen
 s_waitcnt vmcnt(16)
 v_mfma_f32_16x16x32_bf16 v[196:199], a[200:203], a[152:155], v[196:199]
 v_mul_f32 v5, v5, v83
 v_mfma_f32_16x16x32_bf16 v[196:199], a[204:207], a[156:159], v[196:199]
 v_cvt_pk_bf16_f32 v9, v6, v5
 v_mfma_f32_16x16x32_bf16 v[192:195], a[204:207], a[148:151], v[192:195]
 v_accvgpr_read_b32 v5, a34
 v_lshlrev_b32 v6, 16, v5
 v_mfma_f32_16x16x32_bf16 v[192:195], a[200:203], a[144:147], v[192:195]
 v_and_b32 v5, s26, v5
 v_mfma_f32_16x16x32_bf16 v[188:191], a[200:203], a[168:171], v[188:191]
 v_mul_f32 v6, v6, v96
 v_mfma_f32_16x16x32_bf16 v[188:191], a[204:207], a[172:175], v[188:191]
 v_mul_f32 v5, v5, v97
 v_cvt_pk_bf16_f32 v10, v6, v5
 v_mfma_f32_16x16x32_bf16 v[184:187], a[204:207], a[164:167], v[184:187]
 buffer_load_dwordx4 a[204:207], v0, s[12:15], s24 offen offset:3072
 v_mfma_f32_16x16x32_bf16 v[184:187], a[200:203], a[160:163], v[184:187]
 buffer_load_dwordx4 a[200:203], v0, s[12:15], s24 offen offset:2048
 s_waitcnt vmcnt(15)
 v_mfma_f32_16x16x32_bf16 v[200:203], a[208:211], a[160:163], v[200:203]
 v_accvgpr_read_b32 v5, a35
 v_mfma_f32_16x16x32_bf16 v[200:203], a[212:215], a[164:167], v[200:203]
 s_add_u32 s24, s24, 4096
 v_mfma_f32_16x16x32_bf16 v[204:207], a[212:215], a[172:175], v[204:207]
 v_lshlrev_b32 v6, 16, v5
 v_and_b32 v5, s26, v5
 v_mfma_f32_16x16x32_bf16 v[204:207], a[208:211], a[168:171], v[204:207]
 v_mul_f32 v6, v6, v98
 v_mfma_f32_16x16x32_bf16 v[208:211], a[208:211], a[144:147], v[208:211]
 v_mul_f32 v5, v5, v99
 v_mfma_f32_16x16x32_bf16 v[208:211], a[212:215], a[148:151], v[208:211]
 v_cvt_pk_bf16_f32 v11, v6, v5
 v_mfma_f32_16x16x32_bf16 v[212:215], a[212:215], a[156:159], v[212:215]
 buffer_store_dwordx4 v[8:11], v4, s[16:19], s28 offen offset:128 nt
 buffer_load_dwordx4 a[212:215], v0, s[12:15], s24 offen offset:1024
 v_mfma_f32_16x16x32_bf16 v[212:215], a[208:211], a[152:155], v[212:215]
 buffer_load_dwordx4 a[208:211], v0, s[12:15], s24 offen
 s_waitcnt vmcnt(16)
 v_mfma_f32_16x16x32_bf16 v[228:231], a[216:219], a[152:155], v[228:231]
 v_accvgpr_read_b32 v5, a48
 v_mfma_f32_16x16x32_bf16 v[228:231], a[220:223], a[156:159], v[228:231]
 v_lshlrev_b32 v6, 16, v5
 v_mfma_f32_16x16x32_bf16 v[224:227], a[220:223], a[148:151], v[224:227]
 v_and_b32 v5, s26, v5
 v_mfma_f32_16x16x32_bf16 v[224:227], a[216:219], a[144:147], v[224:227]
 v_mul_f32 v6, v6, v112
 v_mul_f32 v5, v5, v113
 v_mfma_f32_16x16x32_bf16 v[220:223], a[216:219], a[168:171], v[220:223]
 v_cvt_pk_bf16_f32 v12, v6, v5
 v_mfma_f32_16x16x32_bf16 v[220:223], a[220:223], a[172:175], v[220:223]
 v_accvgpr_read_b32 v5, a49
 v_mfma_f32_16x16x32_bf16 v[216:219], a[220:223], a[164:167], v[216:219]
 buffer_load_dwordx4 a[220:223], v0, s[12:15], s24 offen offset:3072
 v_mfma_f32_16x16x32_bf16 v[216:219], a[216:219], a[160:163], v[216:219]
 buffer_load_dwordx4 a[216:219], v0, s[12:15], s24 offen offset:2048
 s_waitcnt vmcnt(16)
 v_mfma_f32_16x16x32_bf16 v[232:235], a[224:227], a[160:163], v[232:235]
 v_lshlrev_b32 v6, 16, v5
 v_and_b32 v5, s26, v5
 v_mfma_f32_16x16x32_bf16 v[232:235], a[228:231], a[164:167], v[232:235]
 s_add_u32 s24, s24, 4096
 v_mfma_f32_16x16x32_bf16 v[236:239], a[228:231], a[172:175], v[236:239]
 v_mul_f32 v6, v6, v114
 v_mfma_f32_16x16x32_bf16 v[236:239], a[224:227], a[168:171], v[236:239]
 v_mul_f32 v5, v5, v115
 v_cvt_pk_bf16_f32 v13, v6, v5
 v_mfma_f32_16x16x32_bf16 v[240:243], a[224:227], a[144:147], v[240:243]
 v_accvgpr_read_b32 v5, a50
 v_mfma_f32_16x16x32_bf16 v[240:243], a[228:231], a[148:151], v[240:243]
 v_lshlrev_b32 v6, 16, v5
 v_mfma_f32_16x16x32_bf16 v[244:247], a[228:231], a[156:159], v[244:247]
 buffer_load_dwordx4 a[228:231], v0, s[12:15], s24 offen offset:1024
 v_mfma_f32_16x16x32_bf16 v[244:247], a[224:227], a[152:155], v[244:247]
 buffer_load_dwordx4 a[224:227], v0, s[12:15], s24 offen
 s_waitcnt vmcnt(16)
 v_mfma_f32_16x16x32_bf16 a[252:255], a[232:235], a[152:155], a[252:255]
 v_and_b32 v5, s26, v5
 ds_read_b128 a[152:155], v1 offset:52224
 v_mfma_f32_16x16x32_bf16 a[252:255], a[236:239], a[156:159], a[252:255]
 ds_read_b128 a[156:159], v1 offset:56320
 v_mfma_f32_16x16x32_bf16 a[248:251], a[236:239], a[148:151], a[248:251]
 ds_read_b128 a[148:151], v1 offset:55296
 v_mfma_f32_16x16x32_bf16 a[248:251], a[232:235], a[144:147], a[248:251]
 ds_read_b128 a[144:147], v1 offset:51200
 v_mfma_f32_16x16x32_bf16 v[252:255], a[232:235], a[168:171], v[252:255]
 v_mul_f32 v6, v6, v128
 v_mul_f32 v5, v5, v129
 v_mfma_f32_16x16x32_bf16 v[252:255], a[236:239], a[172:175], v[252:255]
 v_cvt_pk_bf16_f32 v14, v6, v5
 v_mfma_f32_16x16x32_bf16 v[248:251], a[236:239], a[164:167], v[248:251]
 buffer_load_dwordx4 a[236:239], v0, s[12:15], s24 offen offset:3072
 v_mfma_f32_16x16x32_bf16 v[248:251], a[232:235], a[160:163], v[248:251]
 buffer_load_dwordx4 a[232:235], v0, s[12:15], s24 offen offset:2048
 s_waitcnt vmcnt(16) lgkmcnt(6)
 v_mfma_f32_16x16x32_bf16 v[136:139], a[176:179], a[128:131], v[136:139]
 v_accvgpr_read_b32 v5, a51
 v_mfma_f32_16x16x32_bf16 v[136:139], a[180:183], a[132:135], v[136:139]
 s_add_u32 s24, s24, 53248
 s_waitcnt lgkmcnt(4)
 v_mfma_f32_16x16x32_bf16 v[140:143], a[180:183], a[140:143], v[140:143]
 v_lshlrev_b32 v6, 16, v5
 v_and_b32 v5, s26, v5
 v_mfma_f32_16x16x32_bf16 v[140:143], a[176:179], a[136:139], v[140:143]
 s_waitcnt lgkmcnt(0)
 v_mfma_f32_16x16x32_bf16 v[144:147], a[176:179], a[144:147], v[144:147]
 v_mul_f32 v6, v6, v130
 v_mfma_f32_16x16x32_bf16 v[144:147], a[180:183], a[148:151], v[144:147]
 v_mfma_f32_16x16x32_bf16 v[148:151], a[180:183], a[156:159], v[148:151]
 v_mul_f32 v5, v5, v131
 buffer_load_dwordx4 a[180:183], v0, s[12:15], s24 offen offset:1024
 v_mfma_f32_16x16x32_bf16 v[148:151], a[176:179], a[152:155], v[148:151]
 buffer_load_dwordx4 a[176:179], v0, s[12:15], s24 offen
 s_waitcnt vmcnt(15)
 v_mfma_f32_16x16x32_bf16 v[164:167], a[184:187], a[152:155], v[164:167]
 v_cvt_pk_bf16_f32 v15, v6, v5
 v_mfma_f32_16x16x32_bf16 v[164:167], a[188:191], a[156:159], v[164:167]
 buffer_store_dwordx4 v[12:15], v4, s[16:19], s28 offen offset:192 nt
 v_mfma_f32_16x16x32_bf16 v[160:163], a[188:191], a[148:151], v[160:163]
 v_accvgpr_read_b32 v5, a4
 ds_read_b128 a[160:163], v1 offset:57344
 v_mfma_f32_16x16x32_bf16 v[160:163], a[184:187], a[144:147], v[160:163]
 v_lshlrev_b32 v6, 16, v5
 v_mfma_f32_16x16x32_bf16 v[156:159], a[184:187], a[136:139], v[156:159]
 ds_read_b128 a[164:167], v1 offset:61440
 v_mfma_f32_16x16x32_bf16 v[156:159], a[188:191], a[140:143], v[156:159]
 v_and_b32 v5, s26, v5
 v_mfma_f32_16x16x32_bf16 v[152:155], a[188:191], a[132:135], v[152:155]
 v_mul_f32 v6, v6, v20
 buffer_load_dwordx4 a[188:191], v0, s[12:15], s24 offen offset:3072
 v_mfma_f32_16x16x32_bf16 v[152:155], a[184:187], a[128:131], v[152:155]
 buffer_load_dwordx4 a[184:187], v0, s[12:15], s24 offen offset:2048
 s_waitcnt vmcnt(16)
 v_mfma_f32_16x16x32_bf16 v[168:171], a[192:195], a[128:131], v[168:171]
 ds_read_b128 a[168:171], v1 offset:58368
 ds_read_b128 a[172:175], v1 offset:62464
 v_mfma_f32_16x16x32_bf16 v[168:171], a[196:199], a[132:135], v[168:171]
 s_add_u32 s24, s24, 4096
 v_mfma_f32_16x16x32_bf16 v[172:175], a[196:199], a[140:143], v[172:175]
 v_mul_f32 v5, v5, v21
 v_mfma_f32_16x16x32_bf16 v[172:175], a[192:195], a[136:139], v[172:175]
 v_cvt_pk_bf16_f32 v8, v6, v5
 v_mfma_f32_16x16x32_bf16 v[176:179], a[192:195], a[144:147], v[176:179]
 v_accvgpr_read_b32 v5, a5
 v_lshlrev_b32 v6, 16, v5
 v_mfma_f32_16x16x32_bf16 v[176:179], a[196:199], a[148:151], v[176:179]
 v_and_b32 v5, s26, v5
 v_mfma_f32_16x16x32_bf16 v[180:183], a[196:199], a[156:159], v[180:183]
 buffer_load_dwordx4 a[196:199], v0, s[12:15], s24 offen offset:1024
 v_mfma_f32_16x16x32_bf16 v[180:183], a[192:195], a[152:155], v[180:183]
 buffer_load_dwordx4 a[192:195], v0, s[12:15], s24 offen
 s_waitcnt vmcnt(16)
 v_mfma_f32_16x16x32_bf16 v[196:199], a[200:203], a[152:155], v[196:199]
 v_mul_f32 v6, v6, v22
 v_mfma_f32_16x16x32_bf16 v[196:199], a[204:207], a[156:159], v[196:199]
 v_mul_f32 v5, v5, v23
 v_cvt_pk_bf16_f32 v9, v6, v5
 v_mfma_f32_16x16x32_bf16 v[192:195], a[204:207], a[148:151], v[192:195]
 v_accvgpr_read_b32 v5, a6
 v_mfma_f32_16x16x32_bf16 v[192:195], a[200:203], a[144:147], v[192:195]
 v_lshlrev_b32 v6, 16, v5
 v_mfma_f32_16x16x32_bf16 v[188:191], a[200:203], a[136:139], v[188:191]
 v_and_b32 v5, s26, v5
 v_mfma_f32_16x16x32_bf16 v[188:191], a[204:207], a[140:143], v[188:191]
 v_mul_f32 v6, v6, v36
 v_mul_f32 v5, v5, v37
 v_mfma_f32_16x16x32_bf16 v[184:187], a[204:207], a[132:135], v[184:187]
 buffer_load_dwordx4 a[204:207], v0, s[12:15], s24 offen offset:3072
 v_mfma_f32_16x16x32_bf16 v[184:187], a[200:203], a[128:131], v[184:187]
 buffer_load_dwordx4 a[200:203], v0, s[12:15], s24 offen offset:2048
 s_waitcnt vmcnt(15)
 v_mfma_f32_16x16x32_bf16 v[200:203], a[208:211], a[128:131], v[200:203]
 v_cvt_pk_bf16_f32 v10, v6, v5
 v_mfma_f32_16x16x32_bf16 v[200:203], a[212:215], a[132:135], v[200:203]
 v_accvgpr_read_b32 v5, a7
 s_add_u32 s24, s24, 4096
 v_mfma_f32_16x16x32_bf16 v[204:207], a[212:215], a[140:143], v[204:207]
 v_lshlrev_b32 v6, 16, v5
 v_mfma_f32_16x16x32_bf16 v[204:207], a[208:211], a[136:139], v[204:207]
 v_and_b32 v5, s26, v5
 v_mfma_f32_16x16x32_bf16 v[208:211], a[208:211], a[144:147], v[208:211]
 v_mul_f32 v6, v6, v38
 v_mfma_f32_16x16x32_bf16 v[208:211], a[212:215], a[148:151], v[208:211]
 v_mul_f32 v5, v5, v39
 v_cvt_pk_bf16_f32 v11, v6, v5
 v_mfma_f32_16x16x32_bf16 v[212:215], a[212:215], a[156:159], v[212:215]
 buffer_load_dwordx4 a[212:215], v0, s[12:15], s24 offen offset:1024
 v_mfma_f32_16x16x32_bf16 v[212:215], a[208:211], a[152:155], v[212:215]
 buffer_load_dwordx4 a[208:211], v0, s[12:15], s24 offen
 s_waitcnt vmcnt(15)
 v_mfma_f32_16x16x32_bf16 v[228:231], a[216:219], a[152:155], v[228:231]
 buffer_store_dwordx4 v[8:11], v4, s[16:19], s29 offen nt
 v_mfma_f32_16x16x32_bf16 v[228:231], a[220:223], a[156:159], v[228:231]
 v_accvgpr_read_b32 v5, a20
 v_mfma_f32_16x16x32_bf16 v[224:227], a[220:223], a[148:151], v[224:227]
 v_lshlrev_b32 v6, 16, v5
 v_and_b32 v5, s26, v5
 v_mfma_f32_16x16x32_bf16 v[224:227], a[216:219], a[144:147], v[224:227]
 v_mul_f32 v6, v6, v52
 v_mfma_f32_16x16x32_bf16 v[220:223], a[216:219], a[136:139], v[220:223]
 v_mul_f32 v5, v5, v53
 v_mfma_f32_16x16x32_bf16 v[220:223], a[220:223], a[140:143], v[220:223]
 v_cvt_pk_bf16_f32 v12, v6, v5
 v_mfma_f32_16x16x32_bf16 v[216:219], a[220:223], a[132:135], v[216:219]
 v_accvgpr_read_b32 v5, a21
 buffer_load_dwordx4 a[220:223], v0, s[12:15], s24 offen offset:3072
 v_mfma_f32_16x16x32_bf16 v[216:219], a[216:219], a[128:131], v[216:219]
 buffer_load_dwordx4 a[216:219], v0, s[12:15], s24 offen offset:2048
 s_waitcnt vmcnt(16)
 v_mfma_f32_16x16x32_bf16 v[232:235], a[224:227], a[128:131], v[232:235]
 v_lshlrev_b32 v6, 16, v5
 v_mfma_f32_16x16x32_bf16 v[232:235], a[228:231], a[132:135], v[232:235]
 s_add_u32 s24, s24, 4096
 v_mfma_f32_16x16x32_bf16 v[236:239], a[228:231], a[140:143], v[236:239]
 v_and_b32 v5, s26, v5
 v_mfma_f32_16x16x32_bf16 v[236:239], a[224:227], a[136:139], v[236:239]
 v_mul_f32 v6, v6, v54
 v_mul_f32 v5, v5, v55
 v_mfma_f32_16x16x32_bf16 v[240:243], a[224:227], a[144:147], v[240:243]
 v_cvt_pk_bf16_f32 v13, v6, v5
 v_mfma_f32_16x16x32_bf16 v[240:243], a[228:231], a[148:151], v[240:243]
 v_accvgpr_read_b32 v5, a22
 v_mfma_f32_16x16x32_bf16 v[244:247], a[228:231], a[156:159], v[244:247]
 v_lshlrev_b32 v6, 16, v5
 buffer_load_dwordx4 a[228:231], v0, s[12:15], s24 offen offset:1024
 v_mfma_f32_16x16x32_bf16 v[244:247], a[224:227], a[152:155], v[244:247]
 buffer_load_dwordx4 a[224:227], v0, s[12:15], s24 offen
 s_waitcnt vmcnt(16)
 v_mfma_f32_16x16x32_bf16 a[252:255], a[232:235], a[152:155], a[252:255]
 ds_read_b128 a[152:155], v1 offset:60416
 v_mfma_f32_16x16x32_bf16 a[252:255], a[236:239], a[156:159], a[252:255]
 ds_read_b128 a[156:159], v1 offset:64512
 v_mfma_f32_16x16x32_bf16 a[248:251], a[236:239], a[148:151], a[248:251]
 ds_read_b128 a[148:151], v1 offset:63488
 v_mfma_f32_16x16x32_bf16 a[248:251], a[232:235], a[144:147], a[248:251]
 v_and_b32 v5, s26, v5
 ds_read_b128 a[144:147], v1 offset:59392
 v_mfma_f32_16x16x32_bf16 v[252:255], a[232:235], a[136:139], v[252:255]
 v_mul_f32 v6, v6, v68
 v_mfma_f32_16x16x32_bf16 v[252:255], a[236:239], a[140:143], v[252:255]
 v_mul_f32 v5, v5, v69
 v_mfma_f32_16x16x32_bf16 v[248:251], a[236:239], a[132:135], v[248:251]
 buffer_load_dwordx4 a[236:239], v0, s[12:15], s24 offen offset:3072
 v_mfma_f32_16x16x32_bf16 v[248:251], a[232:235], a[128:131], v[248:251]
 buffer_load_dwordx4 a[232:235], v0, s[12:15], s24 offen offset:2048
 s_waitcnt vmcnt(16) lgkmcnt(6)
 v_mfma_f32_16x16x32_bf16 v[136:139], a[176:179], a[160:163], v[136:139]
 v_cvt_pk_bf16_f32 v14, v6, v5
 v_accvgpr_read_b32 v5, a23
 v_mfma_f32_16x16x32_bf16 v[136:139], a[180:183], a[164:167], v[136:139]
 s_add_u32 s24, s24, 53248
 s_waitcnt lgkmcnt(4)
 v_mfma_f32_16x16x32_bf16 v[140:143], a[180:183], a[172:175], v[140:143]
 v_lshlrev_b32 v6, 16, v5
 v_mfma_f32_16x16x32_bf16 v[140:143], a[176:179], a[168:171], v[140:143]
 s_waitcnt lgkmcnt(0)
 v_mfma_f32_16x16x32_bf16 v[144:147], a[176:179], a[144:147], v[144:147]
 v_and_b32 v5, s26, v5
 v_mfma_f32_16x16x32_bf16 v[144:147], a[180:183], a[148:151], v[144:147]
 v_mul_f32 v6, v6, v70
 v_mfma_f32_16x16x32_bf16 v[148:151], a[180:183], a[156:159], v[148:151]
 buffer_load_dwordx4 a[180:183], v0, s[12:15], s24 offen offset:1024
 v_mfma_f32_16x16x32_bf16 v[148:151], a[176:179], a[152:155], v[148:151]
 buffer_load_dwordx4 a[176:179], v0, s[12:15], s24 offen
 s_waitcnt vmcnt(15)
 v_mfma_f32_16x16x32_bf16 v[164:167], a[184:187], a[152:155], v[164:167]
 v_mul_f32 v5, v5, v71
 v_mfma_f32_16x16x32_bf16 v[164:167], a[188:191], a[156:159], v[164:167]
 v_cvt_pk_bf16_f32 v15, v6, v5
 v_mfma_f32_16x16x32_bf16 v[160:163], a[188:191], a[148:151], v[160:163]
 buffer_store_dwordx4 v[12:15], v4, s[16:19], s29 offen offset:64 nt
 ds_read_b128 a[128:131], v2 offset:16384
 v_mfma_f32_16x16x32_bf16 v[160:163], a[184:187], a[144:147], v[160:163]
 v_accvgpr_read_b32 v5, a36
 v_mfma_f32_16x16x32_bf16 v[156:159], a[184:187], a[168:171], v[156:159]
 ds_read_b128 a[132:135], v2 offset:20480
 v_mfma_f32_16x16x32_bf16 v[156:159], a[188:191], a[172:175], v[156:159]
 v_lshlrev_b32 v6, 16, v5
 v_and_b32 v5, s26, v5
 v_mfma_f32_16x16x32_bf16 v[152:155], a[188:191], a[164:167], v[152:155]
 buffer_load_dwordx4 a[188:191], v0, s[12:15], s24 offen offset:3072
 v_mfma_f32_16x16x32_bf16 v[152:155], a[184:187], a[160:163], v[152:155]
 buffer_load_dwordx4 a[184:187], v0, s[12:15], s24 offen offset:2048
 s_waitcnt vmcnt(16)
 v_mfma_f32_16x16x32_bf16 v[168:171], a[192:195], a[160:163], v[168:171]
 ds_read_b128 a[136:139], v2 offset:17408
 ds_read_b128 a[140:143], v2 offset:21504
 v_mfma_f32_16x16x32_bf16 v[168:171], a[196:199], a[164:167], v[168:171]
 s_add_u32 s24, s24, 4096
 v_mfma_f32_16x16x32_bf16 v[172:175], a[196:199], a[172:175], v[172:175]
 v_mul_f32 v6, v6, v84
 v_mfma_f32_16x16x32_bf16 v[172:175], a[192:195], a[168:171], v[172:175]
 v_mul_f32 v5, v5, v85
 v_cvt_pk_bf16_f32 v8, v6, v5
 v_mfma_f32_16x16x32_bf16 v[176:179], a[192:195], a[144:147], v[176:179]
 v_accvgpr_read_b32 v5, a37
 v_mfma_f32_16x16x32_bf16 v[176:179], a[196:199], a[148:151], v[176:179]
 v_lshlrev_b32 v6, 16, v5
 v_mfma_f32_16x16x32_bf16 v[180:183], a[196:199], a[156:159], v[180:183]
 buffer_load_dwordx4 a[196:199], v0, s[12:15], s24 offen offset:1024
 v_mfma_f32_16x16x32_bf16 v[180:183], a[192:195], a[152:155], v[180:183]
 buffer_load_dwordx4 a[192:195], v0, s[12:15], s24 offen
 s_waitcnt vmcnt(16)
 v_mfma_f32_16x16x32_bf16 v[196:199], a[200:203], a[152:155], v[196:199]
 v_and_b32 v5, s26, v5
 v_mul_f32 v6, v6, v86
 v_mfma_f32_16x16x32_bf16 v[196:199], a[204:207], a[156:159], v[196:199]
 v_mul_f32 v5, v5, v87
 v_mfma_f32_16x16x32_bf16 v[192:195], a[204:207], a[148:151], v[192:195]
 v_cvt_pk_bf16_f32 v9, v6, v5
 v_mfma_f32_16x16x32_bf16 v[192:195], a[200:203], a[144:147], v[192:195]
 v_accvgpr_read_b32 v5, a38
 v_mfma_f32_16x16x32_bf16 v[188:191], a[200:203], a[168:171], v[188:191]
 v_lshlrev_b32 v6, 16, v5
 v_and_b32 v5, s26, v5
 v_mfma_f32_16x16x32_bf16 v[188:191], a[204:207], a[172:175], v[188:191]
 v_mul_f32 v6, v6, v100
 v_mfma_f32_16x16x32_bf16 v[184:187], a[204:207], a[164:167], v[184:187]
 buffer_load_dwordx4 a[204:207], v0, s[12:15], s24 offen offset:3072
 v_mfma_f32_16x16x32_bf16 v[184:187], a[200:203], a[160:163], v[184:187]
 buffer_load_dwordx4 a[200:203], v0, s[12:15], s24 offen offset:2048
 s_waitcnt vmcnt(16)
 v_mfma_f32_16x16x32_bf16 v[200:203], a[208:211], a[160:163], v[200:203]
 v_mul_f32 v5, v5, v101
 v_mfma_f32_16x16x32_bf16 v[200:203], a[212:215], a[164:167], v[200:203]
 v_cvt_pk_bf16_f32 v10, v6, v5
 s_add_u32 s24, s24, 4096
 v_mfma_f32_16x16x32_bf16 v[204:207], a[212:215], a[172:175], v[204:207]
 v_accvgpr_read_b32 v5, a39
 v_mfma_f32_16x16x32_bf16 v[204:207], a[208:211], a[168:171], v[204:207]
 v_lshlrev_b32 v6, 16, v5
 v_mfma_f32_16x16x32_bf16 v[208:211], a[208:211], a[144:147], v[208:211]
 v_and_b32 v5, s26, v5
 v_mul_f32 v6, v6, v102
 v_mfma_f32_16x16x32_bf16 v[208:211], a[212:215], a[148:151], v[208:211]
 v_mul_f32 v5, v5, v103
 v_mfma_f32_16x16x32_bf16 v[212:215], a[212:215], a[156:159], v[212:215]
 buffer_load_dwordx4 a[212:215], v0, s[12:15], s24 offen offset:1024
 v_mfma_f32_16x16x32_bf16 v[212:215], a[208:211], a[152:155], v[212:215]
 buffer_load_dwordx4 a[208:211], v0, s[12:15], s24 offen
 s_waitcnt vmcnt(15)
 v_mfma_f32_16x16x32_bf16 v[228:231], a[216:219], a[152:155], v[228:231]
 v_cvt_pk_bf16_f32 v11, v6, v5
 v_mfma_f32_16x16x32_bf16 v[228:231], a[220:223], a[156:159], v[228:231]
 buffer_store_dwordx4 v[8:11], v4, s[16:19], s29 offen offset:128 nt
 v_accvgpr_read_b32 v5, a52
 v_mfma_f32_16x16x32_bf16 v[224:227], a[220:223], a[148:151], v[224:227]
 v_lshlrev_b32 v6, 16, v5
 v_mfma_f32_16x16x32_bf16 v[224:227], a[216:219], a[144:147], v[224:227]
 v_and_b32 v5, s26, v5
 v_mfma_f32_16x16x32_bf16 v[220:223], a[216:219], a[168:171], v[220:223]
 v_mul_f32 v6, v6, v116
 v_mfma_f32_16x16x32_bf16 v[220:223], a[220:223], a[172:175], v[220:223]
 v_mul_f32 v5, v5, v117
 v_cvt_pk_bf16_f32 v12, v6, v5
 v_mfma_f32_16x16x32_bf16 v[216:219], a[220:223], a[164:167], v[216:219]
 buffer_load_dwordx4 a[220:223], v0, s[12:15], s24 offen offset:3072
 v_mfma_f32_16x16x32_bf16 v[216:219], a[216:219], a[160:163], v[216:219]
 buffer_load_dwordx4 a[216:219], v0, s[12:15], s24 offen offset:2048
 s_waitcnt vmcnt(16)
 v_mfma_f32_16x16x32_bf16 v[232:235], a[224:227], a[160:163], v[232:235]
 v_accvgpr_read_b32 v5, a53
 v_mfma_f32_16x16x32_bf16 v[232:235], a[228:231], a[164:167], v[232:235]
 s_add_u32 s24, s24, 4096
 v_mfma_f32_16x16x32_bf16 v[236:239], a[228:231], a[172:175], v[236:239]
 v_lshlrev_b32 v6, 16, v5
 v_and_b32 v5, s26, v5
 v_mfma_f32_16x16x32_bf16 v[236:239], a[224:227], a[168:171], v[236:239]
 v_mul_f32 v6, v6, v118
 v_mfma_f32_16x16x32_bf16 v[240:243], a[224:227], a[144:147], v[240:243]
 v_mul_f32 v5, v5, v119
 v_mfma_f32_16x16x32_bf16 v[240:243], a[228:231], a[148:151], v[240:243]
 v_cvt_pk_bf16_f32 v13, v6, v5
 v_mfma_f32_16x16x32_bf16 v[244:247], a[228:231], a[156:159], v[244:247]
 v_accvgpr_read_b32 v5, a54
 buffer_load_dwordx4 a[228:231], v0, s[12:15], s24 offen offset:1024
 v_mfma_f32_16x16x32_bf16 v[244:247], a[224:227], a[152:155], v[244:247]
 buffer_load_dwordx4 a[224:227], v0, s[12:15], s24 offen
 s_waitcnt vmcnt(16)
 v_mfma_f32_16x16x32_bf16 a[252:255], a[232:235], a[152:155], a[252:255]
 ds_read_b128 a[152:155], v2 offset:19456
 v_mfma_f32_16x16x32_bf16 a[252:255], a[236:239], a[156:159], a[252:255]
 ds_read_b128 a[156:159], v2 offset:23552
 v_mfma_f32_16x16x32_bf16 a[248:251], a[236:239], a[148:151], a[248:251]
 v_lshlrev_b32 v6, 16, v5
 ds_read_b128 a[148:151], v2 offset:22528
 v_mfma_f32_16x16x32_bf16 a[248:251], a[232:235], a[144:147], a[248:251]
 ds_read_b128 a[144:147], v2 offset:18432
 v_mfma_f32_16x16x32_bf16 v[252:255], a[232:235], a[168:171], v[252:255]
 v_and_b32 v5, s26, v5
 v_mfma_f32_16x16x32_bf16 v[252:255], a[236:239], a[172:175], v[252:255]
 v_mul_f32 v6, v6, v132
 v_mfma_f32_16x16x32_bf16 v[248:251], a[236:239], a[164:167], v[248:251]
 v_mul_f32 v5, v5, v133
 buffer_load_dwordx4 a[236:239], v0, s[12:15], s24 offen offset:3072
 v_mfma_f32_16x16x32_bf16 v[248:251], a[232:235], a[160:163], v[248:251]
 buffer_load_dwordx4 a[232:235], v0, s[12:15], s24 offen offset:2048
 s_waitcnt vmcnt(16) lgkmcnt(6)
 v_mfma_f32_16x16x32_bf16 v[136:139], a[176:179], a[128:131], v[136:139]
 v_cvt_pk_bf16_f32 v14, v6, v5
 v_mfma_f32_16x16x32_bf16 v[136:139], a[180:183], a[132:135], v[136:139]
 s_add_u32 s24, s24, 53248
 s_waitcnt lgkmcnt(4)
 v_mfma_f32_16x16x32_bf16 v[140:143], a[180:183], a[140:143], v[140:143]
 v_accvgpr_read_b32 v5, a55
 v_mfma_f32_16x16x32_bf16 v[140:143], a[176:179], a[136:139], v[140:143]
 s_waitcnt lgkmcnt(0)
 v_mfma_f32_16x16x32_bf16 v[144:147], a[176:179], a[144:147], v[144:147]
 v_lshlrev_b32 v6, 16, v5
 v_and_b32 v5, s26, v5
 v_mfma_f32_16x16x32_bf16 v[144:147], a[180:183], a[148:151], v[144:147]
 v_mfma_f32_16x16x32_bf16 v[148:151], a[180:183], a[156:159], v[148:151]
 buffer_load_dwordx4 a[180:183], v0, s[12:15], s24 offen offset:1024
 v_mfma_f32_16x16x32_bf16 v[148:151], a[176:179], a[152:155], v[148:151]
 buffer_load_dwordx4 a[176:179], v0, s[12:15], s24 offen
 s_waitcnt vmcnt(15)
 v_mfma_f32_16x16x32_bf16 v[164:167], a[184:187], a[152:155], v[164:167]
 v_mul_f32 v6, v6, v134
 v_mfma_f32_16x16x32_bf16 v[164:167], a[188:191], a[156:159], v[164:167]
 v_mul_f32 v5, v5, v135
 v_cvt_pk_bf16_f32 v15, v6, v5
 v_mfma_f32_16x16x32_bf16 v[160:163], a[188:191], a[148:151], v[160:163]
 ds_read_b128 a[160:163], v2 offset:24576
 v_mfma_f32_16x16x32_bf16 v[160:163], a[184:187], a[144:147], v[160:163]
 buffer_store_dwordx4 v[12:15], v4, s[16:19], s29 offen offset:192 nt
 v_mfma_f32_16x16x32_bf16 v[156:159], a[184:187], a[136:139], v[156:159]
 ds_read_b128 a[164:167], v2 offset:28672
 v_mfma_f32_16x16x32_bf16 v[156:159], a[188:191], a[140:143], v[156:159]
 v_accvgpr_read_b32 v5, a8
 v_lshlrev_b32 v6, 16, v5
 v_mfma_f32_16x16x32_bf16 v[152:155], a[188:191], a[132:135], v[152:155]
 buffer_load_dwordx4 a[188:191], v0, s[12:15], s24 offen offset:3072
 v_mfma_f32_16x16x32_bf16 v[152:155], a[184:187], a[128:131], v[152:155]
 buffer_load_dwordx4 a[184:187], v0, s[12:15], s24 offen offset:2048
 s_waitcnt vmcnt(16)
 v_mfma_f32_16x16x32_bf16 v[168:171], a[192:195], a[128:131], v[168:171]
 ds_read_b128 a[168:171], v2 offset:25600
 ds_read_b128 a[172:175], v2 offset:29696
 v_mfma_f32_16x16x32_bf16 v[168:171], a[196:199], a[132:135], v[168:171]
 s_add_u32 s24, s24, 4096
 v_mfma_f32_16x16x32_bf16 v[172:175], a[196:199], a[140:143], v[172:175]
 v_and_b32 v5, s26, v5
 v_mul_f32 v6, v6, v24
 v_mfma_f32_16x16x32_bf16 v[172:175], a[192:195], a[136:139], v[172:175]
 v_mul_f32 v5, v5, v25
 v_mfma_f32_16x16x32_bf16 v[176:179], a[192:195], a[144:147], v[176:179]
 v_cvt_pk_bf16_f32 v8, v6, v5
 v_mfma_f32_16x16x32_bf16 v[176:179], a[196:199], a[148:151], v[176:179]
 v_accvgpr_read_b32 v5, a9
 v_mfma_f32_16x16x32_bf16 v[180:183], a[196:199], a[156:159], v[180:183]
 v_lshlrev_b32 v6, 16, v5
 buffer_load_dwordx4 a[196:199], v0, s[12:15], s24 offen offset:1024
 v_mfma_f32_16x16x32_bf16 v[180:183], a[192:195], a[152:155], v[180:183]
 buffer_load_dwordx4 a[192:195], v0, s[12:15], s24 offen
 s_waitcnt vmcnt(16)
 v_mfma_f32_16x16x32_bf16 v[196:199], a[200:203], a[152:155], v[196:199]
 v_and_b32 v5, s26, v5
 v_mfma_f32_16x16x32_bf16 v[196:199], a[204:207], a[156:159], v[196:199]
 v_mul_f32 v6, v6, v26
 v_mfma_f32_16x16x32_bf16 v[192:195], a[204:207], a[148:151], v[192:195]
 v_mul_f32 v5, v5, v27
 v_mfma_f32_16x16x32_bf16 v[192:195], a[200:203], a[144:147], v[192:195]
 v_cvt_pk_bf16_f32 v9, v6, v5
 v_accvgpr_read_b32 v5, a10
 v_mfma_f32_16x16x32_bf16 v[188:191], a[200:203], a[136:139], v[188:191]
 v_lshlrev_b32 v6, 16, v5
 v_mfma_f32_16x16x32_bf16 v[188:191], a[204:207], a[140:143], v[188:191]
 v_and_b32 v5, s26, v5
 v_mfma_f32_16x16x32_bf16 v[184:187], a[204:207], a[132:135], v[184:187]
 buffer_load_dwordx4 a[204:207], v0, s[12:15], s24 offen offset:3072
 v_mfma_f32_16x16x32_bf16 v[184:187], a[200:203], a[128:131], v[184:187]
 buffer_load_dwordx4 a[200:203], v0, s[12:15], s24 offen offset:2048
 s_waitcnt vmcnt(16)
 v_mfma_f32_16x16x32_bf16 v[200:203], a[208:211], a[128:131], v[200:203]
 v_mul_f32 v6, v6, v40
 v_mul_f32 v5, v5, v41
 v_mfma_f32_16x16x32_bf16 v[200:203], a[212:215], a[132:135], v[200:203]
 s_add_u32 s24, s24, 4096
 v_mfma_f32_16x16x32_bf16 v[204:207], a[212:215], a[140:143], v[204:207]
 v_cvt_pk_bf16_f32 v10, v6, v5
 v_mfma_f32_16x16x32_bf16 v[204:207], a[208:211], a[136:139], v[204:207]
 v_accvgpr_read_b32 v5, a11
 v_mfma_f32_16x16x32_bf16 v[208:211], a[208:211], a[144:147], v[208:211]
 v_lshlrev_b32 v6, 16, v5
 v_and_b32 v5, s26, v5
 v_mfma_f32_16x16x32_bf16 v[208:211], a[212:215], a[148:151], v[208:211]
 v_mul_f32 v6, v6, v42
 v_mfma_f32_16x16x32_bf16 v[212:215], a[212:215], a[156:159], v[212:215]
 buffer_load_dwordx4 a[212:215], v0, s[12:15], s24 offen offset:1024
 v_mfma_f32_16x16x32_bf16 v[212:215], a[208:211], a[152:155], v[212:215]
 buffer_load_dwordx4 a[208:211], v0, s[12:15], s24 offen
 s_waitcnt vmcnt(15)
 v_mfma_f32_16x16x32_bf16 v[228:231], a[216:219], a[152:155], v[228:231]
 v_mul_f32 v5, v5, v43
 v_cvt_pk_bf16_f32 v11, v6, v5
 v_mfma_f32_16x16x32_bf16 v[228:231], a[220:223], a[156:159], v[228:231]
 buffer_store_dwordx4 v[8:11], v4, s[16:19], s30 offen nt
 v_mfma_f32_16x16x32_bf16 v[224:227], a[220:223], a[148:151], v[224:227]
 v_accvgpr_read_b32 v5, a24
 v_mfma_f32_16x16x32_bf16 v[224:227], a[216:219], a[144:147], v[224:227]
 v_lshlrev_b32 v6, 16, v5
 v_mfma_f32_16x16x32_bf16 v[220:223], a[216:219], a[136:139], v[220:223]
 v_and_b32 v5, s26, v5
 v_mul_f32 v6, v6, v56
 v_mfma_f32_16x16x32_bf16 v[220:223], a[220:223], a[140:143], v[220:223]
 v_mul_f32 v5, v5, v57
 v_mfma_f32_16x16x32_bf16 v[216:219], a[220:223], a[132:135], v[216:219]
 buffer_load_dwordx4 a[220:223], v0, s[12:15], s24 offen offset:3072
 v_mfma_f32_16x16x32_bf16 v[216:219], a[216:219], a[128:131], v[216:219]
 buffer_load_dwordx4 a[216:219], v0, s[12:15], s24 offen offset:2048
 s_waitcnt vmcnt(16)
 v_mfma_f32_16x16x32_bf16 v[232:235], a[224:227], a[128:131], v[232:235]
 v_cvt_pk_bf16_f32 v12, v6, v5
 v_mfma_f32_16x16x32_bf16 v[232:235], a[228:231], a[132:135], v[232:235]
 v_accvgpr_read_b32 v5, a25
 s_add_u32 s24, s24, 4096
 v_mfma_f32_16x16x32_bf16 v[236:239], a[228:231], a[140:143], v[236:239]
 v_lshlrev_b32 v6, 16, v5
 v_mfma_f32_16x16x32_bf16 v[236:239], a[224:227], a[136:139], v[236:239]
 v_and_b32 v5, s26, v5
 v_mfma_f32_16x16x32_bf16 v[240:243], a[224:227], a[144:147], v[240:243]
 v_mul_f32 v6, v6, v58
 v_mfma_f32_16x16x32_bf16 v[240:243], a[228:231], a[148:151], v[240:243]
 v_mul_f32 v5, v5, v59
 v_cvt_pk_bf16_f32 v13, v6, v5
 v_mfma_f32_16x16x32_bf16 v[244:247], a[228:231], a[156:159], v[244:247]
 buffer_load_dwordx4 a[228:231], v0, s[12:15], s24 offen offset:1024
 v_mfma_f32_16x16x32_bf16 v[244:247], a[224:227], a[152:155], v[244:247]
 buffer_load_dwordx4 a[224:227], v0, s[12:15], s24 offen
 s_waitcnt vmcnt(16)
 v_mfma_f32_16x16x32_bf16 a[252:255], a[232:235], a[152:155], a[252:255]
 ds_read_b128 a[152:155], v2 offset:27648
 v_mfma_f32_16x16x32_bf16 a[252:255], a[236:239], a[156:159], a[252:255]
 ds_read_b128 a[156:159], v2 offset:31744
 v_mfma_f32_16x16x32_bf16 a[248:251], a[236:239], a[148:151], a[248:251]
 v_accvgpr_read_b32 v5, a26
 ds_read_b128 a[148:151], v2 offset:30720
 v_mfma_f32_16x16x32_bf16 a[248:251], a[232:235], a[144:147], a[248:251]
 ds_read_b128 a[144:147], v2 offset:26624
 v_mfma_f32_16x16x32_bf16 v[252:255], a[232:235], a[136:139], v[252:255]
 v_lshlrev_b32 v6, 16, v5
 v_mfma_f32_16x16x32_bf16 v[252:255], a[236:239], a[140:143], v[252:255]
 v_and_b32 v5, s26, v5
 v_mul_f32 v6, v6, v72
 v_mfma_f32_16x16x32_bf16 v[248:251], a[236:239], a[132:135], v[248:251]
 buffer_load_dwordx4 a[236:239], v0, s[12:15], s24 offen offset:3072
 v_mfma_f32_16x16x32_bf16 v[248:251], a[232:235], a[128:131], v[248:251]
 buffer_load_dwordx4 a[232:235], v0, s[12:15], s24 offen offset:2048
 s_waitcnt vmcnt(16) lgkmcnt(6)
 v_mfma_f32_16x16x32_bf16 v[136:139], a[176:179], a[160:163], v[136:139]
 v_mul_f32 v5, v5, v73
 v_mfma_f32_16x16x32_bf16 v[136:139], a[180:183], a[164:167], v[136:139]
 s_add_u32 s24, s24, 53248
 s_waitcnt lgkmcnt(4)
 v_mfma_f32_16x16x32_bf16 v[140:143], a[180:183], a[172:175], v[140:143]
 v_cvt_pk_bf16_f32 v14, v6, v5
 v_mfma_f32_16x16x32_bf16 v[140:143], a[176:179], a[168:171], v[140:143]
 v_accvgpr_read_b32 v5, a27
 s_waitcnt lgkmcnt(0)
 v_mfma_f32_16x16x32_bf16 v[144:147], a[176:179], a[144:147], v[144:147]
 v_lshlrev_b32 v6, 16, v5
 v_mfma_f32_16x16x32_bf16 v[144:147], a[180:183], a[148:151], v[144:147]
 v_mfma_f32_16x16x32_bf16 v[148:151], a[180:183], a[156:159], v[148:151]
 buffer_load_dwordx4 a[180:183], v0, s[12:15], s24 offen offset:1024
 v_mfma_f32_16x16x32_bf16 v[148:151], a[176:179], a[152:155], v[148:151]
 buffer_load_dwordx4 a[176:179], v0, s[12:15], s24 offen
 s_waitcnt vmcnt(15)
 v_mfma_f32_16x16x32_bf16 v[164:167], a[184:187], a[152:155], v[164:167]
 v_and_b32 v5, s26, v5
 v_mul_f32 v6, v6, v74
 v_mfma_f32_16x16x32_bf16 v[164:167], a[188:191], a[156:159], v[164:167]
 v_mul_f32 v5, v5, v75
 v_mfma_f32_16x16x32_bf16 v[160:163], a[188:191], a[148:151], v[160:163]
 ds_read_b128 a[128:131], v2 offset:49152
 v_mfma_f32_16x16x32_bf16 v[160:163], a[184:187], a[144:147], v[160:163]
 v_cvt_pk_bf16_f32 v15, v6, v5
 v_mfma_f32_16x16x32_bf16 v[156:159], a[184:187], a[168:171], v[156:159]
 buffer_store_dwordx4 v[12:15], v4, s[16:19], s30 offen offset:64 nt
 ds_read_b128 a[132:135], v2 offset:53248
 v_mfma_f32_16x16x32_bf16 v[156:159], a[188:191], a[172:175], v[156:159]
 v_accvgpr_read_b32 v5, a40
 v_mfma_f32_16x16x32_bf16 v[152:155], a[188:191], a[164:167], v[152:155]
 buffer_load_dwordx4 a[188:191], v0, s[12:15], s24 offen offset:3072
 v_mfma_f32_16x16x32_bf16 v[152:155], a[184:187], a[160:163], v[152:155]
 buffer_load_dwordx4 a[184:187], v0, s[12:15], s24 offen offset:2048
 s_waitcnt vmcnt(16)
 v_mfma_f32_16x16x32_bf16 v[168:171], a[192:195], a[160:163], v[168:171]
 ds_read_b128 a[136:139], v2 offset:50176
 ds_read_b128 a[140:143], v2 offset:54272
 v_mfma_f32_16x16x32_bf16 v[168:171], a[196:199], a[164:167], v[168:171]
 s_add_u32 s24, s24, 4096
 v_mfma_f32_16x16x32_bf16 v[172:175], a[196:199], a[172:175], v[172:175]
 v_lshlrev_b32 v6, 16, v5
 v_and_b32 v5, s26, v5
 v_mfma_f32_16x16x32_bf16 v[172:175], a[192:195], a[168:171], v[172:175]
 v_mul_f32 v6, v6, v88
 v_mfma_f32_16x16x32_bf16 v[176:179], a[192:195], a[144:147], v[176:179]
 v_mul_f32 v5, v5, v89
 v_mfma_f32_16x16x32_bf16 v[176:179], a[196:199], a[148:151], v[176:179]
 v_cvt_pk_bf16_f32 v8, v6, v5
 v_accvgpr_read_b32 v5, a41
 v_mfma_f32_16x16x32_bf16 v[180:183], a[196:199], a[156:159], v[180:183]
 buffer_load_dwordx4 a[196:199], v0, s[12:15], s24 offen offset:1024
 v_mfma_f32_16x16x32_bf16 v[180:183], a[192:195], a[152:155], v[180:183]
 buffer_load_dwordx4 a[192:195], v0, s[12:15], s24 offen
 s_waitcnt vmcnt(16)
 v_mfma_f32_16x16x32_bf16 v[196:199], a[200:203], a[152:155], v[196:199]
 v_lshlrev_b32 v6, 16, v5
 v_mfma_f32_16x16x32_bf16 v[196:199], a[204:207], a[156:159], v[196:199]
 v_and_b32 v5, s26, v5
 v_mfma_f32_16x16x32_bf16 v[192:195], a[204:207], a[148:151], v[192:195]
 v_mul_f32 v6, v6, v90
 v_mul_f32 v5, v5, v91
 v_mfma_f32_16x16x32_bf16 v[192:195], a[200:203], a[144:147], v[192:195]
 v_cvt_pk_bf16_f32 v9, v6, v5
 v_mfma_f32_16x16x32_bf16 v[188:191], a[200:203], a[168:171], v[188:191]
 v_accvgpr_read_b32 v5, a42
 v_mfma_f32_16x16x32_bf16 v[188:191], a[204:207], a[172:175], v[188:191]
 v_lshlrev_b32 v6, 16, v5
 v_mfma_f32_16x16x32_bf16 v[184:187], a[204:207], a[164:167], v[184:187]
 v_and_b32 v5, s26, v5
 buffer_load_dwordx4 a[204:207], v0, s[12:15], s24 offen offset:3072
 v_mfma_f32_16x16x32_bf16 v[184:187], a[200:203], a[160:163], v[184:187]
 buffer_load_dwordx4 a[200:203], v0, s[12:15], s24 offen offset:2048
 s_waitcnt vmcnt(16)
 v_mfma_f32_16x16x32_bf16 v[200:203], a[208:211], a[160:163], v[200:203]
 v_mul_f32 v6, v6, v104
 v_mfma_f32_16x16x32_bf16 v[200:203], a[212:215], a[164:167], v[200:203]
 s_add_u32 s24, s24, 4096
 v_mfma_f32_16x16x32_bf16 v[204:207], a[212:215], a[172:175], v[204:207]
 v_mul_f32 v5, v5, v105
 v_mfma_f32_16x16x32_bf16 v[204:207], a[208:211], a[168:171], v[204:207]
 v_cvt_pk_bf16_f32 v10, v6, v5
 v_accvgpr_read_b32 v5, a43
 v_mfma_f32_16x16x32_bf16 v[208:211], a[208:211], a[144:147], v[208:211]
 v_lshlrev_b32 v6, 16, v5
 v_mfma_f32_16x16x32_bf16 v[208:211], a[212:215], a[148:151], v[208:211]
 v_and_b32 v5, s26, v5
 v_mfma_f32_16x16x32_bf16 v[212:215], a[212:215], a[156:159], v[212:215]
 buffer_load_dwordx4 a[212:215], v0, s[12:15], s24 offen offset:1024
 v_mfma_f32_16x16x32_bf16 v[212:215], a[208:211], a[152:155], v[212:215]
 buffer_load_dwordx4 a[208:211], v0, s[12:15], s24 offen
 s_waitcnt vmcnt(15)
 v_mfma_f32_16x16x32_bf16 v[228:231], a[216:219], a[152:155], v[228:231]
 v_mul_f32 v6, v6, v106
 v_mul_f32 v5, v5, v107
 v_mfma_f32_16x16x32_bf16 v[228:231], a[220:223], a[156:159], v[228:231]
 v_cvt_pk_bf16_f32 v11, v6, v5
 v_mfma_f32_16x16x32_bf16 v[224:227], a[220:223], a[148:151], v[224:227]
 buffer_store_dwordx4 v[8:11], v4, s[16:19], s30 offen offset:128 nt
 v_mfma_f32_16x16x32_bf16 v[224:227], a[216:219], a[144:147], v[224:227]
 v_accvgpr_read_b32 v5, a56
 v_lshlrev_b32 v6, 16, v5
 v_mfma_f32_16x16x32_bf16 v[220:223], a[216:219], a[168:171], v[220:223]
 v_and_b32 v5, s26, v5
 v_mfma_f32_16x16x32_bf16 v[220:223], a[220:223], a[172:175], v[220:223]
 v_mul_f32 v6, v6, v120
 v_mfma_f32_16x16x32_bf16 v[216:219], a[220:223], a[164:167], v[216:219]
 buffer_load_dwordx4 a[220:223], v0, s[12:15], s24 offen offset:3072
 v_mfma_f32_16x16x32_bf16 v[216:219], a[216:219], a[160:163], v[216:219]
 buffer_load_dwordx4 a[216:219], v0, s[12:15], s24 offen offset:2048
 s_waitcnt vmcnt(16)
 v_mfma_f32_16x16x32_bf16 v[232:235], a[224:227], a[160:163], v[232:235]
 v_mul_f32 v5, v5, v121
 v_cvt_pk_bf16_f32 v12, v6, v5
 v_mfma_f32_16x16x32_bf16 v[232:235], a[228:231], a[164:167], v[232:235]
 s_add_u32 s24, s24, 4096
 v_mfma_f32_16x16x32_bf16 v[236:239], a[228:231], a[172:175], v[236:239]
 v_accvgpr_read_b32 v5, a57
 v_mfma_f32_16x16x32_bf16 v[236:239], a[224:227], a[168:171], v[236:239]
 v_lshlrev_b32 v6, 16, v5
 v_mfma_f32_16x16x32_bf16 v[240:243], a[224:227], a[144:147], v[240:243]
 v_and_b32 v5, s26, v5
 v_mul_f32 v6, v6, v122
 v_mfma_f32_16x16x32_bf16 v[240:243], a[228:231], a[148:151], v[240:243]
 v_mul_f32 v5, v5, v123
 v_mfma_f32_16x16x32_bf16 v[244:247], a[228:231], a[156:159], v[244:247]
 buffer_load_dwordx4 a[228:231], v0, s[12:15], s24 offen offset:1024
 v_mfma_f32_16x16x32_bf16 v[244:247], a[224:227], a[152:155], v[244:247]
 buffer_load_dwordx4 a[224:227], v0, s[12:15], s24 offen
 s_waitcnt vmcnt(16)
 v_mfma_f32_16x16x32_bf16 a[252:255], a[232:235], a[152:155], a[252:255]
 ds_read_b128 a[152:155], v2 offset:52224
 v_mfma_f32_16x16x32_bf16 a[252:255], a[236:239], a[156:159], a[252:255]
 v_cvt_pk_bf16_f32 v13, v6, v5
 ds_read_b128 a[156:159], v2 offset:56320
 v_mfma_f32_16x16x32_bf16 a[248:251], a[236:239], a[148:151], a[248:251]
 ds_read_b128 a[148:151], v2 offset:55296
 v_mfma_f32_16x16x32_bf16 a[248:251], a[232:235], a[144:147], a[248:251]
 ds_read_b128 a[144:147], v2 offset:51200
 v_mfma_f32_16x16x32_bf16 v[252:255], a[232:235], a[168:171], v[252:255]
 v_accvgpr_read_b32 v5, a58
 v_mfma_f32_16x16x32_bf16 v[252:255], a[236:239], a[172:175], v[252:255]
 v_accvgpr_read_b32 v7, a240
 v_lshlrev_b32 v6, 16, v5
 v_mfma_f32_16x16x32_bf16 v[248:251], a[236:239], a[164:167], v[248:251]
 buffer_load_dwordx4 a[236:239], v0, s[12:15], s24 offen offset:3072
 v_mfma_f32_16x16x32_bf16 v[248:251], a[232:235], a[160:163], v[248:251]
 buffer_load_dwordx4 a[232:235], v0, s[12:15], s24 offen offset:2048
 s_waitcnt vmcnt(16) lgkmcnt(6)
 v_mfma_f32_16x16x32_bf16 v[136:139], a[176:179], a[128:131], v[136:139]
 v_and_b32 v5, s26, v5
 v_mfma_f32_16x16x32_bf16 v[136:139], a[180:183], a[132:135], v[136:139]
 s_add_u32 s24, s24, 53248
 s_waitcnt lgkmcnt(4)
 v_mfma_f32_16x16x32_bf16 v[140:143], a[180:183], a[140:143], v[140:143]
 v_mul_f32 v6, v6, v7
 v_accvgpr_read_b32 v7, a241
 v_mfma_f32_16x16x32_bf16 v[140:143], a[176:179], a[136:139], v[140:143]
 s_waitcnt lgkmcnt(0)
 v_mfma_f32_16x16x32_bf16 v[144:147], a[176:179], a[144:147], v[144:147]
 v_mul_f32 v5, v5, v7
 v_mfma_f32_16x16x32_bf16 v[144:147], a[180:183], a[148:151], v[144:147]
 v_mfma_f32_16x16x32_bf16 v[148:151], a[180:183], a[156:159], v[148:151]
 v_cvt_pk_bf16_f32 v14, v6, v5
 buffer_load_dwordx4 a[180:183], v0, s[12:15], s24 offen offset:1024
 v_mfma_f32_16x16x32_bf16 v[148:151], a[176:179], a[152:155], v[148:151]
 buffer_load_dwordx4 a[176:179], v0, s[12:15], s24 offen
 s_waitcnt vmcnt(15)
 v_mfma_f32_16x16x32_bf16 v[164:167], a[184:187], a[152:155], v[164:167]
 v_accvgpr_read_b32 v5, a59
 v_mfma_f32_16x16x32_bf16 v[164:167], a[188:191], a[156:159], v[164:167]
 v_accvgpr_read_b32 v7, a242
 v_mfma_f32_16x16x32_bf16 v[160:163], a[188:191], a[148:151], v[160:163]
 ds_read_b128 a[160:163], v2 offset:57344
 v_mfma_f32_16x16x32_bf16 v[160:163], a[184:187], a[144:147], v[160:163]
 v_lshlrev_b32 v6, 16, v5
 v_and_b32 v5, s26, v5
 v_mfma_f32_16x16x32_bf16 v[156:159], a[184:187], a[136:139], v[156:159]
 ds_read_b128 a[164:167], v2 offset:61440
 v_mfma_f32_16x16x32_bf16 v[156:159], a[188:191], a[140:143], v[156:159]
 v_mul_f32 v6, v6, v7
 v_mfma_f32_16x16x32_bf16 v[152:155], a[188:191], a[132:135], v[152:155]
 buffer_load_dwordx4 a[188:191], v0, s[12:15], s24 offen offset:3072
 v_mfma_f32_16x16x32_bf16 v[152:155], a[184:187], a[128:131], v[152:155]
 buffer_load_dwordx4 a[184:187], v0, s[12:15], s24 offen offset:2048
 s_waitcnt vmcnt(15)
 v_mfma_f32_16x16x32_bf16 v[168:171], a[192:195], a[128:131], v[168:171]
 ds_read_b128 a[168:171], v2 offset:58368
 ds_read_b128 a[172:175], v2 offset:62464
 v_mfma_f32_16x16x32_bf16 v[168:171], a[196:199], a[132:135], v[168:171]
 v_accvgpr_read_b32 v7, a243
 s_add_u32 s24, s24, 4096
 v_mfma_f32_16x16x32_bf16 v[172:175], a[196:199], a[140:143], v[172:175]
 v_mul_f32 v5, v5, v7
 v_mfma_f32_16x16x32_bf16 v[172:175], a[192:195], a[136:139], v[172:175]
 v_cvt_pk_bf16_f32 v15, v6, v5
 v_mfma_f32_16x16x32_bf16 v[176:179], a[192:195], a[144:147], v[176:179]
 buffer_store_dwordx4 v[12:15], v4, s[16:19], s30 offen offset:192 nt
 v_mfma_f32_16x16x32_bf16 v[176:179], a[196:199], a[148:151], v[176:179]
 v_accvgpr_read_b32 v5, a12
 v_lshlrev_b32 v6, 16, v5
 v_mfma_f32_16x16x32_bf16 v[180:183], a[196:199], a[156:159], v[180:183]
 buffer_load_dwordx4 a[196:199], v0, s[12:15], s24 offen offset:1024
 v_mfma_f32_16x16x32_bf16 v[180:183], a[192:195], a[152:155], v[180:183]
 buffer_load_dwordx4 a[192:195], v0, s[12:15], s24 offen
 s_waitcnt vmcnt(16)
 v_mfma_f32_16x16x32_bf16 v[196:199], a[200:203], a[152:155], v[196:199]
 v_and_b32 v5, s26, v5
 v_mfma_f32_16x16x32_bf16 v[196:199], a[204:207], a[156:159], v[196:199]
 v_mul_f32 v6, v6, v28
 v_mul_f32 v5, v5, v29
 v_mfma_f32_16x16x32_bf16 v[192:195], a[204:207], a[148:151], v[192:195]
 v_cvt_pk_bf16_f32 v8, v6, v5
 v_mfma_f32_16x16x32_bf16 v[192:195], a[200:203], a[144:147], v[192:195]
 v_accvgpr_read_b32 v5, a13
 v_mfma_f32_16x16x32_bf16 v[188:191], a[200:203], a[136:139], v[188:191]
 v_lshlrev_b32 v6, 16, v5
 v_mfma_f32_16x16x32_bf16 v[188:191], a[204:207], a[140:143], v[188:191]
 v_and_b32 v5, s26, v5
 v_mul_f32 v6, v6, v30
 v_mfma_f32_16x16x32_bf16 v[184:187], a[204:207], a[132:135], v[184:187]
 buffer_load_dwordx4 a[204:207], v0, s[12:15], s24 offen offset:3072
 v_mfma_f32_16x16x32_bf16 v[184:187], a[200:203], a[128:131], v[184:187]
 buffer_load_dwordx4 a[200:203], v0, s[12:15], s24 offen offset:2048
 s_waitcnt vmcnt(16)
 v_mfma_f32_16x16x32_bf16 v[200:203], a[208:211], a[128:131], v[200:203]
 v_mul_f32 v5, v5, v31
 v_mfma_f32_16x16x32_bf16 v[200:203], a[212:215], a[132:135], v[200:203]
 s_add_u32 s24, s24, 4096
 v_mfma_f32_16x16x32_bf16 v[204:207], a[212:215], a[140:143], v[204:207]
 v_cvt_pk_bf16_f32 v9, v6, v5
 v_accvgpr_read_b32 v5, a14
 v_mfma_f32_16x16x32_bf16 v[204:207], a[208:211], a[136:139], v[204:207]
 v_lshlrev_b32 v6, 16, v5
 v_mfma_f32_16x16x32_bf16 v[208:211], a[208:211], a[144:147], v[208:211]
 v_and_b32 v5, s26, v5
 v_mfma_f32_16x16x32_bf16 v[208:211], a[212:215], a[148:151], v[208:211]
 v_mul_f32 v6, v6, v44
 v_mfma_f32_16x16x32_bf16 v[212:215], a[212:215], a[156:159], v[212:215]
 v_mul_f32 v5, v5, v45
 buffer_load_dwordx4 a[212:215], v0, s[12:15], s24 offen offset:1024
 v_mfma_f32_16x16x32_bf16 v[212:215], a[208:211], a[152:155], v[212:215]
 buffer_load_dwordx4 a[208:211], v0, s[12:15], s24 offen
 s_waitcnt vmcnt(15)
 v_mfma_f32_16x16x32_bf16 v[228:231], a[216:219], a[152:155], v[228:231]
 v_cvt_pk_bf16_f32 v10, v6, v5
 v_mfma_f32_16x16x32_bf16 v[228:231], a[220:223], a[156:159], v[228:231]
 v_accvgpr_read_b32 v5, a15
 v_mfma_f32_16x16x32_bf16 v[224:227], a[220:223], a[148:151], v[224:227]
 v_lshlrev_b32 v6, 16, v5
 v_mfma_f32_16x16x32_bf16 v[224:227], a[216:219], a[144:147], v[224:227]
 v_and_b32 v5, s26, v5
 v_mul_f32 v6, v6, v46
 v_mfma_f32_16x16x32_bf16 v[220:223], a[216:219], a[136:139], v[220:223]
 v_mul_f32 v5, v5, v47
 v_mfma_f32_16x16x32_bf16 v[220:223], a[220:223], a[140:143], v[220:223]
 v_cvt_pk_bf16_f32 v11, v6, v5
 v_mfma_f32_16x16x32_bf16 v[216:219], a[220:223], a[132:135], v[216:219]
 buffer_store_dwordx4 v[8:11], v4, s[16:19], s31 offen nt
 buffer_load_dwordx4 a[220:223], v0, s[12:15], s24 offen offset:3072
 v_mfma_f32_16x16x32_bf16 v[216:219], a[216:219], a[128:131], v[216:219]
 buffer_load_dwordx4 a[216:219], v0, s[12:15], s24 offen offset:2048
 s_waitcnt vmcnt(16)
 v_mfma_f32_16x16x32_bf16 v[232:235], a[224:227], a[128:131], v[232:235]
 v_accvgpr_read_b32 v5, a28
 v_mfma_f32_16x16x32_bf16 v[232:235], a[228:231], a[132:135], v[232:235]
 s_add_u32 s24, s24, 4096
 v_mfma_f32_16x16x32_bf16 v[236:239], a[228:231], a[140:143], v[236:239]
 v_lshlrev_b32 v6, 16, v5
 v_mfma_f32_16x16x32_bf16 v[236:239], a[224:227], a[136:139], v[236:239]
 v_and_b32 v5, s26, v5
 v_mul_f32 v6, v6, v60
 v_mfma_f32_16x16x32_bf16 v[240:243], a[224:227], a[144:147], v[240:243]
 v_mul_f32 v5, v5, v61
 v_mfma_f32_16x16x32_bf16 v[240:243], a[228:231], a[148:151], v[240:243]
 v_cvt_pk_bf16_f32 v12, v6, v5
 v_mfma_f32_16x16x32_bf16 v[244:247], a[228:231], a[156:159], v[244:247]
 buffer_load_dwordx4 a[228:231], v0, s[12:15], s24 offen offset:1024
 v_mfma_f32_16x16x32_bf16 v[244:247], a[224:227], a[152:155], v[244:247]
 buffer_load_dwordx4 a[224:227], v0, s[12:15], s24 offen
 s_waitcnt vmcnt(16)
 v_mfma_f32_16x16x32_bf16 a[252:255], a[232:235], a[152:155], a[252:255]
 v_accvgpr_read_b32 v5, a29
 ds_read_b128 a[152:155], v2 offset:60416
 v_mfma_f32_16x16x32_bf16 a[252:255], a[236:239], a[156:159], a[252:255]
 ds_read_b128 a[156:159], v2 offset:64512
 v_mfma_f32_16x16x32_bf16 a[248:251], a[236:239], a[148:151], a[248:251]
 ds_read_b128 a[148:151], v2 offset:63488
 v_mfma_f32_16x16x32_bf16 a[248:251], a[232:235], a[144:147], a[248:251]
 ds_read_b128 a[144:147], v2 offset:59392
 v_mfma_f32_16x16x32_bf16 v[252:255], a[232:235], a[136:139], v[252:255]
 v_lshlrev_b32 v6, 16, v5
 v_and_b32 v5, s26, v5
 v_mfma_f32_16x16x32_bf16 v[252:255], a[236:239], a[140:143], v[252:255]
 v_mul_f32 v6, v6, v62
 v_mfma_f32_16x16x32_bf16 v[248:251], a[236:239], a[132:135], v[248:251]
 buffer_load_dwordx4 a[236:239], v0, s[12:15], s24 offen offset:3072
 v_mfma_f32_16x16x32_bf16 v[248:251], a[232:235], a[128:131], v[248:251]
 buffer_load_dwordx4 a[232:235], v0, s[12:15], s24 offen offset:2048
 s_waitcnt vmcnt(16) lgkmcnt(6)
 v_mfma_f32_16x16x32_bf16 v[136:139], a[176:179], a[160:163], v[136:139]
 v_mul_f32 v5, v5, v63
 v_mfma_f32_16x16x32_bf16 v[136:139], a[180:183], a[164:167], v[136:139]
 s_add_u32 s24, s24, 53248
 s_waitcnt lgkmcnt(4)
 v_mfma_f32_16x16x32_bf16 v[140:143], a[180:183], a[172:175], v[140:143]
 v_cvt_pk_bf16_f32 v13, v6, v5
 v_accvgpr_read_b32 v5, a30
 v_mfma_f32_16x16x32_bf16 v[140:143], a[176:179], a[168:171], v[140:143]
 s_waitcnt lgkmcnt(0)
 v_mfma_f32_16x16x32_bf16 v[144:147], a[176:179], a[144:147], v[144:147]
 v_lshlrev_b32 v6, 16, v5
 v_mfma_f32_16x16x32_bf16 v[144:147], a[180:183], a[148:151], v[144:147]
 v_and_b32 v5, s26, v5
 v_mfma_f32_16x16x32_bf16 v[148:151], a[180:183], a[156:159], v[148:151]
 v_mul_f32 v6, v6, v76
 v_mfma_f32_16x16x32_bf16 v[148:151], a[176:179], a[152:155], v[148:151]
 s_waitcnt vmcnt(14)
 v_mfma_f32_16x16x32_bf16 v[164:167], a[184:187], a[152:155], v[164:167]
 v_mul_f32 v5, v5, v77
 v_mfma_f32_16x16x32_bf16 v[164:167], a[188:191], a[156:159], v[164:167]
 v_cvt_pk_bf16_f32 v14, v6, v5
 v_accvgpr_read_b32 v5, a31
 v_mfma_f32_16x16x32_bf16 v[160:163], a[188:191], a[148:151], v[160:163]
 v_lshlrev_b32 v6, 16, v5
 v_mfma_f32_16x16x32_bf16 v[160:163], a[184:187], a[144:147], v[160:163]
 v_and_b32 v5, s26, v5
 v_mfma_f32_16x16x32_bf16 v[156:159], a[184:187], a[168:171], v[156:159]
 v_mul_f32 v6, v6, v78
 v_mfma_f32_16x16x32_bf16 v[156:159], a[188:191], a[172:175], v[156:159]
 v_mul_f32 v5, v5, v79
 v_cvt_pk_bf16_f32 v15, v6, v5
 v_mfma_f32_16x16x32_bf16 v[152:155], a[188:191], a[164:167], v[152:155]
 buffer_store_dwordx4 v[12:15], v4, s[16:19], s31 offen offset:64 nt
 v_mfma_f32_16x16x32_bf16 v[152:155], a[184:187], a[160:163], v[152:155]
 s_waitcnt vmcnt(12)
 v_mfma_f32_16x16x32_bf16 v[168:171], a[192:195], a[160:163], v[168:171]
 v_accvgpr_read_b32 v5, a44
 v_mfma_f32_16x16x32_bf16 v[168:171], a[196:199], a[164:167], v[168:171]
 v_lshlrev_b32 v6, 16, v5
 v_and_b32 v5, s26, v5
 v_mfma_f32_16x16x32_bf16 v[172:175], a[196:199], a[172:175], v[172:175]
 v_mul_f32 v6, v6, v92
 v_mfma_f32_16x16x32_bf16 v[172:175], a[192:195], a[168:171], v[172:175]
 v_mul_f32 v5, v5, v93
 v_mfma_f32_16x16x32_bf16 v[176:179], a[192:195], a[144:147], v[176:179]
 v_cvt_pk_bf16_f32 v8, v6, v5
 v_mfma_f32_16x16x32_bf16 v[176:179], a[196:199], a[148:151], v[176:179]
 v_accvgpr_read_b32 v5, a45
 v_lshlrev_b32 v6, 16, v5
 v_mfma_f32_16x16x32_bf16 v[180:183], a[196:199], a[156:159], v[180:183]
 v_and_b32 v5, s26, v5
 v_mfma_f32_16x16x32_bf16 v[180:183], a[192:195], a[152:155], v[180:183]
 s_waitcnt vmcnt(10)
 v_mfma_f32_16x16x32_bf16 v[196:199], a[200:203], a[152:155], v[196:199]
 v_mul_f32 v6, v6, v94
 v_mul_f32 v5, v5, v95
 v_mfma_f32_16x16x32_bf16 v[196:199], a[204:207], a[156:159], v[196:199]
 v_cvt_pk_bf16_f32 v9, v6, v5
 v_mfma_f32_16x16x32_bf16 v[192:195], a[204:207], a[148:151], v[192:195]
 v_accvgpr_read_b32 v5, a46
 v_mfma_f32_16x16x32_bf16 v[192:195], a[200:203], a[144:147], v[192:195]
 v_lshlrev_b32 v6, 16, v5
 v_mfma_f32_16x16x32_bf16 v[188:191], a[200:203], a[168:171], v[188:191]
 v_and_b32 v5, s26, v5
 v_mul_f32 v6, v6, v108
 v_mfma_f32_16x16x32_bf16 v[188:191], a[204:207], a[172:175], v[188:191]
 v_mul_f32 v5, v5, v109
 v_mfma_f32_16x16x32_bf16 v[184:187], a[204:207], a[164:167], v[184:187]
 v_cvt_pk_bf16_f32 v10, v6, v5
 v_mfma_f32_16x16x32_bf16 v[184:187], a[200:203], a[160:163], v[184:187]
 s_waitcnt vmcnt(8)
 v_mfma_f32_16x16x32_bf16 v[200:203], a[208:211], a[160:163], v[200:203]
 v_accvgpr_read_b32 v5, a47
 v_lshlrev_b32 v6, 16, v5
 v_mfma_f32_16x16x32_bf16 v[200:203], a[212:215], a[164:167], v[200:203]
 v_and_b32 v5, s26, v5
 v_mfma_f32_16x16x32_bf16 v[204:207], a[212:215], a[172:175], v[204:207]
 v_mul_f32 v6, v6, v110
 v_mfma_f32_16x16x32_bf16 v[204:207], a[208:211], a[168:171], v[204:207]
 v_mul_f32 v5, v5, v111
 v_mfma_f32_16x16x32_bf16 v[208:211], a[208:211], a[144:147], v[208:211]
 v_cvt_pk_bf16_f32 v11, v6, v5
 buffer_store_dwordx4 v[8:11], v4, s[16:19], s31 offen offset:128 nt
 v_mfma_f32_16x16x32_bf16 v[208:211], a[212:215], a[148:151], v[208:211]
 v_accvgpr_read_b32 v5, a60
 v_mfma_f32_16x16x32_bf16 v[212:215], a[212:215], a[156:159], v[212:215]
 v_lshlrev_b32 v6, 16, v5
 v_mfma_f32_16x16x32_bf16 v[212:215], a[208:211], a[152:155], v[212:215]
 s_waitcnt vmcnt(6)
 v_mfma_f32_16x16x32_bf16 v[228:231], a[216:219], a[152:155], v[228:231]
 v_and_b32 v5, s26, v5
 v_mul_f32 v6, v6, v124
 v_mfma_f32_16x16x32_bf16 v[228:231], a[220:223], a[156:159], v[228:231]
 v_mul_f32 v5, v5, v125
 v_mfma_f32_16x16x32_bf16 v[224:227], a[220:223], a[148:151], v[224:227]
 v_cvt_pk_bf16_f32 v12, v6, v5
 v_mfma_f32_16x16x32_bf16 v[224:227], a[216:219], a[144:147], v[224:227]
 v_accvgpr_read_b32 v5, a61
 v_lshlrev_b32 v6, 16, v5
 v_mfma_f32_16x16x32_bf16 v[220:223], a[216:219], a[168:171], v[220:223]
 v_and_b32 v5, s26, v5
 v_mfma_f32_16x16x32_bf16 v[220:223], a[220:223], a[172:175], v[220:223]
 v_mul_f32 v6, v6, v126
 v_mfma_f32_16x16x32_bf16 v[216:219], a[220:223], a[164:167], v[216:219]
 v_mul_f32 v5, v5, v127
 v_mfma_f32_16x16x32_bf16 v[216:219], a[216:219], a[160:163], v[216:219]
 v_cvt_pk_bf16_f32 v13, v6, v5
 s_waitcnt vmcnt(4)
 v_mfma_f32_16x16x32_bf16 v[232:235], a[224:227], a[160:163], v[232:235]
 v_accvgpr_read_b32 v5, a62
 v_mfma_f32_16x16x32_bf16 v[232:235], a[228:231], a[164:167], v[232:235]
 v_accvgpr_read_b32 v7, a244
 v_mfma_f32_16x16x32_bf16 v[236:239], a[228:231], a[172:175], v[236:239]
 v_lshlrev_b32 v6, 16, v5
 v_mfma_f32_16x16x32_bf16 v[236:239], a[224:227], a[168:171], v[236:239]
 v_and_b32 v5, s26, v5
 v_mul_f32 v6, v6, v7
 v_mfma_f32_16x16x32_bf16 v[240:243], a[224:227], a[144:147], v[240:243]
 v_accvgpr_read_b32 v7, a245
 v_mfma_f32_16x16x32_bf16 v[240:243], a[228:231], a[148:151], v[240:243]
 v_mul_f32 v5, v5, v7
 v_mfma_f32_16x16x32_bf16 v[244:247], a[228:231], a[156:159], v[244:247]
 v_cvt_pk_bf16_f32 v14, v6, v5
 v_mfma_f32_16x16x32_bf16 v[244:247], a[224:227], a[152:155], v[244:247]
 v_accvgpr_read_b32 v5, a63
 s_waitcnt vmcnt(2)
 v_mfma_f32_16x16x32_bf16 a[252:255], a[232:235], a[152:155], a[252:255]
 v_accvgpr_read_b32 v7, a246
 v_mfma_f32_16x16x32_bf16 a[252:255], a[236:239], a[156:159], a[252:255]
 v_lshlrev_b32 v6, 16, v5
 v_mfma_f32_16x16x32_bf16 a[248:251], a[236:239], a[148:151], a[248:251]
 v_and_b32 v5, s26, v5
 v_mfma_f32_16x16x32_bf16 a[248:251], a[232:235], a[144:147], a[248:251]
 v_mul_f32 v6, v6, v7
 v_accvgpr_read_b32 v7, a247
 v_mfma_f32_16x16x32_bf16 v[252:255], a[232:235], a[168:171], v[252:255]
 v_mul_f32 v5, v5, v7
 v_mfma_f32_16x16x32_bf16 v[252:255], a[236:239], a[172:175], v[252:255]
 v_cvt_pk_bf16_f32 v15, v6, v5
 v_mfma_f32_16x16x32_bf16 v[248:251], a[236:239], a[164:167], v[248:251]
 buffer_store_dwordx4 v[12:15], v4, s[16:19], s31 offen offset:192 nt
 v_mfma_f32_16x16x32_bf16 v[248:251], a[232:235], a[160:163], v[248:251]
 s_nop 7
 v_accvgpr_read_b32 v5, a64
 v_lshlrev_b32 v6, 16, v5
 v_and_b32 v5, s26, v5
 v_mul_f32 v6, v6, v136
 v_mul_f32 v5, v5, v137
 v_cvt_pk_bf16_f32 v8, v6, v5
 v_accvgpr_read_b32 v5, a65
 v_lshlrev_b32 v6, 16, v5
 v_and_b32 v5, s26, v5
 v_mul_f32 v6, v6, v138
 v_mul_f32 v5, v5, v139
 v_cvt_pk_bf16_f32 v9, v6, v5
 v_accvgpr_read_b32 v5, a66
 v_lshlrev_b32 v6, 16, v5
 v_and_b32 v5, s26, v5
 v_mul_f32 v6, v6, v152
 v_mul_f32 v5, v5, v153
 v_cvt_pk_bf16_f32 v10, v6, v5
 v_accvgpr_read_b32 v5, a67
 v_lshlrev_b32 v6, 16, v5
 v_and_b32 v5, s26, v5
 v_mul_f32 v6, v6, v154
 v_mul_f32 v5, v5, v155
 v_cvt_pk_bf16_f32 v11, v6, v5
 buffer_store_dwordx4 v[8:11], v4, s[16:19], s28 offen offset:1024 nt
 v_accvgpr_read_b32 v5, a80
 v_lshlrev_b32 v6, 16, v5
 v_and_b32 v5, s26, v5
 v_mul_f32 v6, v6, v168
 v_mul_f32 v5, v5, v169
 v_cvt_pk_bf16_f32 v12, v6, v5
 v_accvgpr_read_b32 v5, a81
 v_lshlrev_b32 v6, 16, v5
 v_and_b32 v5, s26, v5
 v_mul_f32 v6, v6, v170
 v_mul_f32 v5, v5, v171
 v_cvt_pk_bf16_f32 v13, v6, v5
 v_accvgpr_read_b32 v5, a82
 v_lshlrev_b32 v6, 16, v5
 v_and_b32 v5, s26, v5
 v_mul_f32 v6, v6, v184
 v_mul_f32 v5, v5, v185
 v_cvt_pk_bf16_f32 v14, v6, v5
 v_accvgpr_read_b32 v5, a83
 v_lshlrev_b32 v6, 16, v5
 v_and_b32 v5, s26, v5
 v_mul_f32 v6, v6, v186
 v_mul_f32 v5, v5, v187
 v_cvt_pk_bf16_f32 v15, v6, v5
 buffer_store_dwordx4 v[12:15], v4, s[16:19], s28 offen offset:1088 nt
 v_accvgpr_read_b32 v5, a96
 v_lshlrev_b32 v6, 16, v5
 v_and_b32 v5, s26, v5
 v_mul_f32 v6, v6, v200
 v_mul_f32 v5, v5, v201
 v_cvt_pk_bf16_f32 v8, v6, v5
 v_accvgpr_read_b32 v5, a97
 v_lshlrev_b32 v6, 16, v5
 v_and_b32 v5, s26, v5
 v_mul_f32 v6, v6, v202
 v_mul_f32 v5, v5, v203
 v_cvt_pk_bf16_f32 v9, v6, v5
 v_accvgpr_read_b32 v5, a98
 v_lshlrev_b32 v6, 16, v5
 v_and_b32 v5, s26, v5
 v_mul_f32 v6, v6, v216
 v_mul_f32 v5, v5, v217
 v_cvt_pk_bf16_f32 v10, v6, v5
 v_accvgpr_read_b32 v5, a99
 v_lshlrev_b32 v6, 16, v5
 v_and_b32 v5, s26, v5
 v_mul_f32 v6, v6, v218
 v_mul_f32 v5, v5, v219
 v_cvt_pk_bf16_f32 v11, v6, v5
 buffer_store_dwordx4 v[8:11], v4, s[16:19], s28 offen offset:1152 nt
 v_accvgpr_read_b32 v5, a112
 v_lshlrev_b32 v6, 16, v5
 v_and_b32 v5, s26, v5
 v_mul_f32 v6, v6, v232
 v_mul_f32 v5, v5, v233
 v_cvt_pk_bf16_f32 v12, v6, v5
 v_accvgpr_read_b32 v5, a113
 v_lshlrev_b32 v6, 16, v5
 v_and_b32 v5, s26, v5
 v_mul_f32 v6, v6, v234
 v_mul_f32 v5, v5, v235
 v_cvt_pk_bf16_f32 v13, v6, v5
 v_accvgpr_read_b32 v5, a114
 v_lshlrev_b32 v6, 16, v5
 v_and_b32 v5, s26, v5
 v_mul_f32 v6, v6, v248
 v_mul_f32 v5, v5, v249
 v_cvt_pk_bf16_f32 v14, v6, v5
 v_accvgpr_read_b32 v5, a115
 v_lshlrev_b32 v6, 16, v5
 v_and_b32 v5, s26, v5
 v_mul_f32 v6, v6, v250
 v_mul_f32 v5, v5, v251
 v_cvt_pk_bf16_f32 v15, v6, v5
 buffer_store_dwordx4 v[12:15], v4, s[16:19], s28 offen offset:1216 nt
 v_accvgpr_read_b32 v5, a68
 v_lshlrev_b32 v6, 16, v5
 v_and_b32 v5, s26, v5
 v_mul_f32 v6, v6, v140
 v_mul_f32 v5, v5, v141
 v_cvt_pk_bf16_f32 v8, v6, v5
 v_accvgpr_read_b32 v5, a69
 v_lshlrev_b32 v6, 16, v5
 v_and_b32 v5, s26, v5
 v_mul_f32 v6, v6, v142
 v_mul_f32 v5, v5, v143
 v_cvt_pk_bf16_f32 v9, v6, v5
 v_accvgpr_read_b32 v5, a70
 v_lshlrev_b32 v6, 16, v5
 v_and_b32 v5, s26, v5
 v_mul_f32 v6, v6, v156
 v_mul_f32 v5, v5, v157
 v_cvt_pk_bf16_f32 v10, v6, v5
 v_accvgpr_read_b32 v5, a71
 v_lshlrev_b32 v6, 16, v5
 v_and_b32 v5, s26, v5
 v_mul_f32 v6, v6, v158
 v_mul_f32 v5, v5, v159
 v_cvt_pk_bf16_f32 v11, v6, v5
 buffer_store_dwordx4 v[8:11], v4, s[16:19], s29 offen offset:1024 nt
 v_accvgpr_read_b32 v5, a84
 v_lshlrev_b32 v6, 16, v5
 v_and_b32 v5, s26, v5
 v_mul_f32 v6, v6, v172
 v_mul_f32 v5, v5, v173
 v_cvt_pk_bf16_f32 v12, v6, v5
 v_accvgpr_read_b32 v5, a85
 v_lshlrev_b32 v6, 16, v5
 v_and_b32 v5, s26, v5
 v_mul_f32 v6, v6, v174
 v_mul_f32 v5, v5, v175
 v_cvt_pk_bf16_f32 v13, v6, v5
 v_accvgpr_read_b32 v5, a86
 v_lshlrev_b32 v6, 16, v5
 v_and_b32 v5, s26, v5
 v_mul_f32 v6, v6, v188
 v_mul_f32 v5, v5, v189
 v_cvt_pk_bf16_f32 v14, v6, v5
 v_accvgpr_read_b32 v5, a87
 v_lshlrev_b32 v6, 16, v5
 v_and_b32 v5, s26, v5
 v_mul_f32 v6, v6, v190
 v_mul_f32 v5, v5, v191
 v_cvt_pk_bf16_f32 v15, v6, v5
 buffer_store_dwordx4 v[12:15], v4, s[16:19], s29 offen offset:1088 nt
 v_accvgpr_read_b32 v5, a100
 v_lshlrev_b32 v6, 16, v5
 v_and_b32 v5, s26, v5
 v_mul_f32 v6, v6, v204
 v_mul_f32 v5, v5, v205
 v_cvt_pk_bf16_f32 v8, v6, v5
 v_accvgpr_read_b32 v5, a101
 v_lshlrev_b32 v6, 16, v5
 v_and_b32 v5, s26, v5
 v_mul_f32 v6, v6, v206
 v_mul_f32 v5, v5, v207
 v_cvt_pk_bf16_f32 v9, v6, v5
 v_accvgpr_read_b32 v5, a102
 v_lshlrev_b32 v6, 16, v5
 v_and_b32 v5, s26, v5
 v_mul_f32 v6, v6, v220
 v_mul_f32 v5, v5, v221
 v_cvt_pk_bf16_f32 v10, v6, v5
 v_accvgpr_read_b32 v5, a103
 v_lshlrev_b32 v6, 16, v5
 v_and_b32 v5, s26, v5
 v_mul_f32 v6, v6, v222
 v_mul_f32 v5, v5, v223
 v_cvt_pk_bf16_f32 v11, v6, v5
 buffer_store_dwordx4 v[8:11], v4, s[16:19], s29 offen offset:1152 nt
 v_accvgpr_read_b32 v5, a116
 v_lshlrev_b32 v6, 16, v5
 v_and_b32 v5, s26, v5
 v_mul_f32 v6, v6, v236
 v_mul_f32 v5, v5, v237
 v_cvt_pk_bf16_f32 v12, v6, v5
 v_accvgpr_read_b32 v5, a117
 v_lshlrev_b32 v6, 16, v5
 v_and_b32 v5, s26, v5
 v_mul_f32 v6, v6, v238
 v_mul_f32 v5, v5, v239
 v_cvt_pk_bf16_f32 v13, v6, v5
 v_accvgpr_read_b32 v5, a118
 v_lshlrev_b32 v6, 16, v5
 v_and_b32 v5, s26, v5
 v_mul_f32 v6, v6, v252
 v_mul_f32 v5, v5, v253
 v_cvt_pk_bf16_f32 v14, v6, v5
 v_accvgpr_read_b32 v5, a119
 v_lshlrev_b32 v6, 16, v5
 v_and_b32 v5, s26, v5
 v_mul_f32 v6, v6, v254
 v_mul_f32 v5, v5, v255
 v_cvt_pk_bf16_f32 v15, v6, v5
 buffer_store_dwordx4 v[12:15], v4, s[16:19], s29 offen offset:1216 nt
 v_accvgpr_read_b32 v5, a72
 v_lshlrev_b32 v6, 16, v5
 v_and_b32 v5, s26, v5
 v_mul_f32 v6, v6, v144
 v_mul_f32 v5, v5, v145
 v_cvt_pk_bf16_f32 v8, v6, v5
 v_accvgpr_read_b32 v5, a73
 v_lshlrev_b32 v6, 16, v5
 v_and_b32 v5, s26, v5
 v_mul_f32 v6, v6, v146
 v_mul_f32 v5, v5, v147
 v_cvt_pk_bf16_f32 v9, v6, v5
 v_accvgpr_read_b32 v5, a74
 v_lshlrev_b32 v6, 16, v5
 v_and_b32 v5, s26, v5
 v_mul_f32 v6, v6, v160
 v_mul_f32 v5, v5, v161
 v_cvt_pk_bf16_f32 v10, v6, v5
 v_accvgpr_read_b32 v5, a75
 v_lshlrev_b32 v6, 16, v5
 v_and_b32 v5, s26, v5
 v_mul_f32 v6, v6, v162
 v_mul_f32 v5, v5, v163
 v_cvt_pk_bf16_f32 v11, v6, v5
 buffer_store_dwordx4 v[8:11], v4, s[16:19], s30 offen offset:1024 nt
 v_accvgpr_read_b32 v5, a88
 v_lshlrev_b32 v6, 16, v5
 v_and_b32 v5, s26, v5
 v_mul_f32 v6, v6, v176
 v_mul_f32 v5, v5, v177
 v_cvt_pk_bf16_f32 v12, v6, v5
 v_accvgpr_read_b32 v5, a89
 v_lshlrev_b32 v6, 16, v5
 v_and_b32 v5, s26, v5
 v_mul_f32 v6, v6, v178
 v_mul_f32 v5, v5, v179
 v_cvt_pk_bf16_f32 v13, v6, v5
 v_accvgpr_read_b32 v5, a90
 v_lshlrev_b32 v6, 16, v5
 v_and_b32 v5, s26, v5
 v_mul_f32 v6, v6, v192
 v_mul_f32 v5, v5, v193
 v_cvt_pk_bf16_f32 v14, v6, v5
 v_accvgpr_read_b32 v5, a91
 v_lshlrev_b32 v6, 16, v5
 v_and_b32 v5, s26, v5
 v_mul_f32 v6, v6, v194
 v_mul_f32 v5, v5, v195
 v_cvt_pk_bf16_f32 v15, v6, v5
 buffer_store_dwordx4 v[12:15], v4, s[16:19], s30 offen offset:1088 nt
 v_accvgpr_read_b32 v5, a104
 v_lshlrev_b32 v6, 16, v5
 v_and_b32 v5, s26, v5
 v_mul_f32 v6, v6, v208
 v_mul_f32 v5, v5, v209
 v_cvt_pk_bf16_f32 v8, v6, v5
 v_accvgpr_read_b32 v5, a105
 v_lshlrev_b32 v6, 16, v5
 v_and_b32 v5, s26, v5
 v_mul_f32 v6, v6, v210
 v_mul_f32 v5, v5, v211
 v_cvt_pk_bf16_f32 v9, v6, v5
 v_accvgpr_read_b32 v5, a106
 v_lshlrev_b32 v6, 16, v5
 v_and_b32 v5, s26, v5
 v_mul_f32 v6, v6, v224
 v_mul_f32 v5, v5, v225
 v_cvt_pk_bf16_f32 v10, v6, v5
 v_accvgpr_read_b32 v5, a107
 v_lshlrev_b32 v6, 16, v5
 v_and_b32 v5, s26, v5
 v_mul_f32 v6, v6, v226
 v_mul_f32 v5, v5, v227
 v_cvt_pk_bf16_f32 v11, v6, v5
 buffer_store_dwordx4 v[8:11], v4, s[16:19], s30 offen offset:1152 nt
 v_accvgpr_read_b32 v5, a120
 v_lshlrev_b32 v6, 16, v5
 v_and_b32 v5, s26, v5
 v_mul_f32 v6, v6, v240
 v_mul_f32 v5, v5, v241
 v_cvt_pk_bf16_f32 v12, v6, v5
 v_accvgpr_read_b32 v5, a121
 v_lshlrev_b32 v6, 16, v5
 v_and_b32 v5, s26, v5
 v_mul_f32 v6, v6, v242
 v_mul_f32 v5, v5, v243
 v_cvt_pk_bf16_f32 v13, v6, v5
 v_accvgpr_read_b32 v5, a122
 v_accvgpr_read_b32 v7, a248
 v_lshlrev_b32 v6, 16, v5
 v_and_b32 v5, s26, v5
 v_mul_f32 v6, v6, v7
 v_accvgpr_read_b32 v7, a249
 v_mul_f32 v5, v5, v7
 v_cvt_pk_bf16_f32 v14, v6, v5
 v_accvgpr_read_b32 v5, a123
 v_accvgpr_read_b32 v7, a250
 v_lshlrev_b32 v6, 16, v5
 v_and_b32 v5, s26, v5
 v_mul_f32 v6, v6, v7
 v_accvgpr_read_b32 v7, a251
 v_mul_f32 v5, v5, v7
 v_cvt_pk_bf16_f32 v15, v6, v5
 buffer_store_dwordx4 v[12:15], v4, s[16:19], s30 offen offset:1216 nt
 v_accvgpr_read_b32 v5, a76
 v_lshlrev_b32 v6, 16, v5
 v_and_b32 v5, s26, v5
 v_mul_f32 v6, v6, v148
 v_mul_f32 v5, v5, v149
 v_cvt_pk_bf16_f32 v8, v6, v5
 v_accvgpr_read_b32 v5, a77
 v_lshlrev_b32 v6, 16, v5
 v_and_b32 v5, s26, v5
 v_mul_f32 v6, v6, v150
 v_mul_f32 v5, v5, v151
 v_cvt_pk_bf16_f32 v9, v6, v5
 v_accvgpr_read_b32 v5, a78
 v_lshlrev_b32 v6, 16, v5
 v_and_b32 v5, s26, v5
 v_mul_f32 v6, v6, v164
 v_mul_f32 v5, v5, v165
 v_cvt_pk_bf16_f32 v10, v6, v5
 v_accvgpr_read_b32 v5, a79
 v_lshlrev_b32 v6, 16, v5
 v_and_b32 v5, s26, v5
 v_mul_f32 v6, v6, v166
 v_mul_f32 v5, v5, v167
 v_cvt_pk_bf16_f32 v11, v6, v5
 buffer_store_dwordx4 v[8:11], v4, s[16:19], s31 offen offset:1024 nt
 v_accvgpr_read_b32 v5, a92
 v_lshlrev_b32 v6, 16, v5
 v_and_b32 v5, s26, v5
 v_mul_f32 v6, v6, v180
 v_mul_f32 v5, v5, v181
 v_cvt_pk_bf16_f32 v12, v6, v5
 v_accvgpr_read_b32 v5, a93
 v_lshlrev_b32 v6, 16, v5
 v_and_b32 v5, s26, v5
 v_mul_f32 v6, v6, v182
 v_mul_f32 v5, v5, v183
 v_cvt_pk_bf16_f32 v13, v6, v5
 v_accvgpr_read_b32 v5, a94
 v_lshlrev_b32 v6, 16, v5
 v_and_b32 v5, s26, v5
 v_mul_f32 v6, v6, v196
 v_mul_f32 v5, v5, v197
 v_cvt_pk_bf16_f32 v14, v6, v5
 v_accvgpr_read_b32 v5, a95
 v_lshlrev_b32 v6, 16, v5
 v_and_b32 v5, s26, v5
 v_mul_f32 v6, v6, v198
 v_mul_f32 v5, v5, v199
 v_cvt_pk_bf16_f32 v15, v6, v5
 buffer_store_dwordx4 v[12:15], v4, s[16:19], s31 offen offset:1088 nt
 v_accvgpr_read_b32 v5, a108
 v_lshlrev_b32 v6, 16, v5
 v_and_b32 v5, s26, v5
 v_mul_f32 v6, v6, v212
 v_mul_f32 v5, v5, v213
 v_cvt_pk_bf16_f32 v8, v6, v5
 v_accvgpr_read_b32 v5, a109
 v_lshlrev_b32 v6, 16, v5
 v_and_b32 v5, s26, v5
 v_mul_f32 v6, v6, v214
 v_mul_f32 v5, v5, v215
 v_cvt_pk_bf16_f32 v9, v6, v5
 v_accvgpr_read_b32 v5, a110
 v_lshlrev_b32 v6, 16, v5
 v_and_b32 v5, s26, v5
 v_mul_f32 v6, v6, v228
 v_mul_f32 v5, v5, v229
 v_cvt_pk_bf16_f32 v10, v6, v5
 v_accvgpr_read_b32 v5, a111
 v_lshlrev_b32 v6, 16, v5
 v_and_b32 v5, s26, v5
 v_mul_f32 v6, v6, v230
 v_mul_f32 v5, v5, v231
 v_cvt_pk_bf16_f32 v11, v6, v5
 buffer_store_dwordx4 v[8:11], v4, s[16:19], s31 offen offset:1152 nt
 v_accvgpr_read_b32 v5, a124
 v_lshlrev_b32 v6, 16, v5
 v_and_b32 v5, s26, v5
 v_mul_f32 v6, v6, v244
 v_mul_f32 v5, v5, v245
 v_cvt_pk_bf16_f32 v12, v6, v5
 v_accvgpr_read_b32 v5, a125
 v_lshlrev_b32 v6, 16, v5
 v_and_b32 v5, s26, v5
 v_mul_f32 v6, v6, v246
 v_mul_f32 v5, v5, v247
 v_cvt_pk_bf16_f32 v13, v6, v5
 v_accvgpr_read_b32 v5, a126
 v_accvgpr_read_b32 v7, a252
 v_lshlrev_b32 v6, 16, v5
 v_and_b32 v5, s26, v5
 v_mul_f32 v6, v6, v7
 v_accvgpr_read_b32 v7, a253
 v_mul_f32 v5, v5, v7
 v_cvt_pk_bf16_f32 v14, v6, v5
 v_accvgpr_read_b32 v5, a127
 v_accvgpr_read_b32 v7, a254
 v_lshlrev_b32 v6, 16, v5
 v_and_b32 v5, s26, v5
 v_mul_f32 v6, v6, v7
 v_accvgpr_read_b32 v7, a255
 v_mul_f32 v5, v5, v7
 v_cvt_pk_bf16_f32 v15, v6, v5
 buffer_store_dwordx4 v[12:15], v4, s[16:19], s31 offen offset:1216 nt
Lend:
 s_endpgm
Lspin_pro:
 v_lshlrev_b32 v4, 2, v1
 v_and_b32 v4, 192, v4
 s_add_u32 s53, s53, 1
 buffer_load_dword v4, v4, s[44:47], 0 offen sc1
 s_cmp_ge_u32 s53, 0x400000
 s_cbranch_scc1 Lgiveup_pro
 s_waitcnt vmcnt(0)
 v_cmp_gt_u32 vcc, s27, v4
 s_cbranch_vccnz Lspin_pro
Lgiveup_pro:
 s_waitcnt vmcnt(0)
 s_branch Lok_pro
Lspin_loop:
 v_lshlrev_b32 v4, 2, v1
 v_and_b32 v4, 192, v4
 s_add_u32 s53, s53, 1
 buffer_load_dword v4, v4, s[44:47], 0 offen sc1
 s_cmp_ge_u32 s53, 0x400000
 s_cbranch_scc1 Lgiveup_loop
 s_waitcnt vmcnt(0)
 v_cmp_gt_u32 vcc, s27, v4
 s_cbranch_vccnz Lspin_loop
Lgiveup_loop:
 s_waitcnt vmcnt(0)
 s_branch Lok_loop
.section .rodata,"a"
.p2align 6
.amdhsa_kernel standalone__cross_network_dcn__recsys_kernel
  .amdhsa_next_free_vgpr 512
  .amdhsa_next_free_sgpr 102
  .amdhsa_accum_offset 256
  .amdhsa_group_segment_fixed_size 0
  .amdhsa_kernarg_size 48
  .amdhsa_user_sgpr_count 2
  .amdhsa_user_sgpr_kernarg_segment_ptr 1
  .amdhsa_system_sgpr_workgroup_id_x 1
  .amdhsa_float_denorm_mode_32 3
.end_amdhsa_kernel
```

```asm
; @launch grid=(256,1,1) block=(256,1,1) lds=151552
.amdgcn_target "amdgcn-amd-amdhsa--gfx950"
.text
.globl standalone__cross_network_dcn__recsys_kernel
.p2align 8
.type standalone__cross_network_dcn__recsys_kernel,@function
standalone__cross_network_dcn__recsys_kernel:
 s_cmp_ge_u32 s2, 256
 s_cbranch_scc1 Lend
 s_load_dwordx4 s[56:59], s[0:1], 0
 s_load_dwordx4 s[60:63], s[0:1], 16
 s_load_dwordx4 s[64:67], s[0:1], 32
 v_lshrrev_b32 v9, 6, v0
 v_and_b32 v10, 63, v0
 v_readfirstlane_b32 s54, v9
 v_lshlrev_b32 v1, 4, v10
 s_getpc_b64 s[4:5]
Lpc:
 v_lshlrev_b32 v11, 6, v0
 v_min_u32 v12, Lend-Lpc, v11
 global_load_dword v60, v12, s[4:5]
 v_add_u32 v11, 16384, v11
 v_min_u32 v12, Lend-Lpc, v11
 global_load_dword v61, v12, s[4:5]
 v_add_u32 v11, 16384, v11
 v_min_u32 v12, Lend-Lpc, v11
 global_load_dword v62, v12, s[4:5]
 v_add_u32 v11, 16384, v11
 v_min_u32 v12, Lend-Lpc, v11
 global_load_dword v63, v12, s[4:5]
 v_add_u32 v11, 16384, v11
 v_lshrrev_b32 v11, 7, v0
 v_and_b32 v12, 127, v0
 v_lshlrev_b32 v12, 3, v12
 v_lshl_add_u32 v30, v11, 11, v12
 v_lshlrev_b32 v31, 4, v0
 v_add_u32 v31, 131072, v31
 v_add_u32 v2, 65536, v1
 v_lshl_add_u32 v3, v9, 15, v1
 v_lshl_add_u32 v0, v9, 18, v1
 v_lshrrev_b32 v11, 4, v10
 v_and_b32 v12, 15, v10
 v_xor_b32 v13, v11, v12
 v_lshlrev_b32 v13, 4, v13
 v_lshl_add_u32 v20, v11, 11, v13
 v_xor_b32 v21, 64, v20
 v_xor_b32 v22, 128, v20
 v_xor_b32 v23, 192, v20
 v_lshl_add_u32 v24, v12, 8, v13
 v_lshl_add_u32 v24, v9, 15, v24
 v_xor_b32 v25, 64, v24
 v_xor_b32 v26, 128, v24
 v_xor_b32 v27, 192, v24
 s_and_b32 s7, s2, 1
 s_lshr_b32 s28, s2, 1
 s_lshl_b32 s28, s28, 18
 s_lshl_b32 s6, s7, 10
 s_add_u32 s28, s28, s6
 s_lshl_b32 s6, s54, 8
 s_add_u32 s28, s28, s6
 s_mov_b32 s26, 0xffff0000
 s_lshl_b32 s24, s7, 20
 s_mov_b32 s25, 0
 s_mov_b32 s53, 0
 s_mov_b32 s31, 0
 s_mov_b32 s27, 64
 s_mov_b32 s55, 1
 s_lshl_b32 s50, s54, 15
 s_lshl_b32 s29, s2, 17
 s_add_u32 s29, s29, 33554432
 s_xor_b32 s30, s29, 131072
 s_lshr_b32 s4, s2, 3
 s_and_b32 s5, s2, 7
 s_lshl_b32 s48, s4, 16
 s_lshl_b32 s6, s5, 8
 s_add_u32 s48, s48, s6
 s_lshl_b32 s6, s54, 6
 s_add_u32 s48, s48, s6
 s_lshl_b32 s49, s5, 18
 s_and_b32 s6, s4, 1
 s_lshl_b32 s6, s6, 10
 s_add_u32 s49, s49, s6
 s_lshr_b32 s6, s4, 4
 s_lshr_b32 s5, s5, 2
 s_xor_b32 s5, s5, s6
 s_bfe_u32 s6, s4, 0x10001
 s_lshl_b32 s3, s5, 1
 s_add_u32 s3, s3, s6
 s_lshl_b32 s3, s3, 16
 s_add_u32 s49, s49, s3
 s_bfe_u32 s4, s4, 0x20002
 s_xor_b32 s5, s5, s6
 s_lshr_b32 s3, s54, 1
 s_lshl_b32 s3, s3, 4
 s_lshl_b32 s6, s4, 2
 s_add_u32 s3, s3, s6
 s_and_b32 s6, s54, 1
 s_lshl_b32 s6, s6, 1
 s_add_u32 s3, s3, s6
 s_lshl_b32 s4, s4, 3
 s_lshl_b32 s6, s54, 1
 s_add_u32 s4, s4, s6
 s_cmp_eq_u32 s5, 0
 s_cselect_b32 s3, s3, s4
 s_lshl_b32 s3, s3, 11
 s_add_u32 s49, s49, s3
 s_lshl_b32 s52, s54, 11
 s_add_u32 s52, s52, 143360
 s_lshl_b32 s51, s54, 9
 s_add_u32 s51, s51, 131072
 s_waitcnt lgkmcnt(0)
 s_mov_b32 s40, s58
 s_mov_b32 s41, s59
 s_mov_b32 s42, 0xc00000
 s_mov_b32 s43, 0x20000
 v_lshrrev_b32 v5, 6, v1
 v_and_b32 v6, 48, v1
 v_lshl_add_u32 v5, v5, 11, v6
 s_mov_b32 m0, s52
 s_add_u32 s3, s48, 31744
 buffer_load_dwordx4 v5, s[40:43], s48 offen lds
 buffer_load_dwordx4 v5, s[40:43], s3 offen offset:1024 lds
 s_add_u32 s48, s48, 2097152
 s_mov_b32 s20, s60
 s_mov_b32 s21, s61
 s_mov_b32 s22, 0x3000
 s_mov_b32 s23, 0x20000
 s_lshl_b32 s3, s7, 10
 buffer_load_dwordx2 v[32:33], v30, s[20:23], s3 offen
 s_add_u32 s3, s3, 4096
 buffer_load_dwordx2 v[34:35], v30, s[20:23], s3 offen
 s_add_u32 s3, s3, 4096
 buffer_load_dwordx2 v[36:37], v30, s[20:23], s3 offen
 s_add_u32 s3, s3, 4096
 s_mov_b32 s8, s56
 s_mov_b32 s9, s57
 s_mov_b32 s10, 0x2000000
 s_mov_b32 s11, 0x20000
 s_mov_b32 s16, s62
 s_mov_b32 s17, s63
 s_mov_b32 s18, 0x2000000
 s_mov_b32 s19, 0x20000
 s_mov_b32 s12, s66
 s_mov_b32 s13, s67
 s_mov_b32 s14, 0xc00000
 s_mov_b32 s15, 0x20000
 s_mov_b32 s32, s66
 s_mov_b32 s33, s67
 s_mov_b32 s34, 0x10000000
 s_mov_b32 s35, 0x20000
 s_mov_b32 s44, s64
 s_mov_b32 s45, s65
 s_mov_b32 s46, 0x100
 s_mov_b32 s47, 0x20000
 s_and_b32 s3, s2, 3
 s_lshl_b32 s3, s3, 6
 s_add_u32 s56, s44, s3
 s_addc_u32 s57, s45, 0
 s_mov_b32 s58, 0x4
 s_mov_b32 s59, 0x20000
 s_lshl_b32 s3, s2, 2
 s_add_u32 s3, s3, s54
 s_lshl_b32 s3, s3, 7
 s_add_u32 s3, s3, 15728640
 s_add_u32 s60, s32, s3
 s_addc_u32 s61, s33, 0
 s_mov_b32 s62, 0x4
 s_mov_b32 s63, 0x20000
 s_xor_b32 s3, s3, 512
 s_add_u32 s64, s32, s3
 s_addc_u32 s65, s33, 0
 s_mov_b32 s66, 0x4
 s_mov_b32 s67, 0x20000
 v_mov_b32 v7, 0
 buffer_store_dword v7, v1, s[60:63], 0 offen sc1
 v_mov_b32 v64, 1.0
 v_mov_b32 v65, 1.0
 v_mov_b32 v66, 1.0
 v_mov_b32 v67, 1.0
 v_mov_b32 v68, 1.0
 v_mov_b32 v69, 1.0
 v_mov_b32 v70, 1.0
 v_mov_b32 v71, 1.0
 v_mov_b32 v72, 1.0
 v_mov_b32 v73, 1.0
 v_mov_b32 v74, 1.0
 v_mov_b32 v75, 1.0
 v_mov_b32 v76, 1.0
 v_mov_b32 v77, 1.0
 v_mov_b32 v78, 1.0
 v_mov_b32 v79, 1.0
 v_mov_b32 v80, 1.0
 v_mov_b32 v81, 1.0
 v_mov_b32 v82, 1.0
 v_mov_b32 v83, 1.0
 v_mov_b32 v84, 1.0
 v_mov_b32 v85, 1.0
 v_mov_b32 v86, 1.0
 v_mov_b32 v87, 1.0
 v_mov_b32 v88, 1.0
 v_mov_b32 v89, 1.0
 v_mov_b32 v90, 1.0
 v_mov_b32 v91, 1.0
 v_mov_b32 v92, 1.0
 v_mov_b32 v93, 1.0
 v_mov_b32 v94, 1.0
 v_mov_b32 v95, 1.0
 v_mov_b32 v96, 1.0
 v_mov_b32 v97, 1.0
 v_mov_b32 v98, 1.0
 v_mov_b32 v99, 1.0
 v_mov_b32 v100, 1.0
 v_mov_b32 v101, 1.0
 v_mov_b32 v102, 1.0
 v_mov_b32 v103, 1.0
 v_mov_b32 v104, 1.0
 v_mov_b32 v105, 1.0
 v_mov_b32 v106, 1.0
 v_mov_b32 v107, 1.0
 v_mov_b32 v108, 1.0
 v_mov_b32 v109, 1.0
 v_mov_b32 v110, 1.0
 v_mov_b32 v111, 1.0
 v_mov_b32 v112, 1.0
 v_mov_b32 v113, 1.0
 v_mov_b32 v114, 1.0
 v_mov_b32 v115, 1.0
 v_mov_b32 v116, 1.0
 v_mov_b32 v117, 1.0
 v_mov_b32 v118, 1.0
 v_mov_b32 v119, 1.0
 v_mov_b32 v120, 1.0
 v_mov_b32 v121, 1.0
 v_mov_b32 v122, 1.0
 v_mov_b32 v123, 1.0
 v_mov_b32 v124, 1.0
 v_mov_b32 v125, 1.0
 v_mov_b32 v126, 1.0
 v_mov_b32 v127, 1.0
 v_mov_b32 v128, 1.0
 v_mov_b32 v129, 1.0
 v_mov_b32 v130, 1.0
 v_mov_b32 v131, 1.0
 v_mov_b32 v132, 1.0
 v_mov_b32 v133, 1.0
 v_mov_b32 v134, 1.0
 v_mov_b32 v135, 1.0
 v_accvgpr_write_b32 a240, 1.0
 v_accvgpr_write_b32 a241, 1.0
 v_accvgpr_write_b32 a242, 1.0
 v_accvgpr_write_b32 a243, 1.0
 v_accvgpr_write_b32 a244, 1.0
 v_accvgpr_write_b32 a245, 1.0
 v_accvgpr_write_b32 a246, 1.0
 v_accvgpr_write_b32 a247, 1.0
 v_mov_b32 v136, 1.0
 v_mov_b32 v137, 1.0
 v_mov_b32 v138, 1.0
 v_mov_b32 v139, 1.0
 v_mov_b32 v140, 1.0
 v_mov_b32 v141, 1.0
 v_mov_b32 v142, 1.0
 v_mov_b32 v143, 1.0
 v_mov_b32 v144, 1.0
 v_mov_b32 v145, 1.0
 v_mov_b32 v146, 1.0
 v_mov_b32 v147, 1.0
 v_mov_b32 v148, 1.0
 v_mov_b32 v149, 1.0
 v_mov_b32 v150, 1.0
 v_mov_b32 v151, 1.0
 v_mov_b32 v152, 1.0
 v_mov_b32 v153, 1.0
 v_mov_b32 v154, 1.0
 v_mov_b32 v155, 1.0
 v_mov_b32 v156, 1.0
 v_mov_b32 v157, 1.0
 v_mov_b32 v158, 1.0
 v_mov_b32 v159, 1.0
 v_mov_b32 v160, 1.0
 v_mov_b32 v161, 1.0
 v_mov_b32 v162, 1.0
 v_mov_b32 v163, 1.0
 v_mov_b32 v164, 1.0
 v_mov_b32 v165, 1.0
 v_mov_b32 v166, 1.0
 v_mov_b32 v167, 1.0
 v_mov_b32 v168, 1.0
 v_mov_b32 v169, 1.0
 v_mov_b32 v170, 1.0
 v_mov_b32 v171, 1.0
 v_mov_b32 v172, 1.0
 v_mov_b32 v173, 1.0
 v_mov_b32 v174, 1.0
 v_mov_b32 v175, 1.0
 v_mov_b32 v176, 1.0
 v_mov_b32 v177, 1.0
 v_mov_b32 v178, 1.0
 v_mov_b32 v179, 1.0
 v_mov_b32 v180, 1.0
 v_mov_b32 v181, 1.0
 v_mov_b32 v182, 1.0
 v_mov_b32 v183, 1.0
 v_mov_b32 v184, 1.0
 v_mov_b32 v185, 1.0
 v_mov_b32 v186, 1.0
 v_mov_b32 v187, 1.0
 v_mov_b32 v188, 1.0
 v_mov_b32 v189, 1.0
 v_mov_b32 v190, 1.0
 v_mov_b32 v191, 1.0
 v_mov_b32 v192, 1.0
 v_mov_b32 v193, 1.0
 v_mov_b32 v194, 1.0
 v_mov_b32 v195, 1.0
 v_mov_b32 v196, 1.0
 v_mov_b32 v197, 1.0
 v_mov_b32 v198, 1.0
 v_mov_b32 v199, 1.0
 v_mov_b32 v200, 1.0
 v_mov_b32 v201, 1.0
 v_mov_b32 v202, 1.0
 v_mov_b32 v203, 1.0
 v_mov_b32 v204, 1.0
 v_mov_b32 v205, 1.0
 v_mov_b32 v206, 1.0
 v_mov_b32 v207, 1.0
 v_mov_b32 v208, 1.0
 v_mov_b32 v209, 1.0
 v_mov_b32 v210, 1.0
 v_mov_b32 v211, 1.0
 v_mov_b32 v212, 1.0
 v_mov_b32 v213, 1.0
 v_mov_b32 v214, 1.0
 v_mov_b32 v215, 1.0
 v_mov_b32 v216, 1.0
 v_mov_b32 v217, 1.0
 v_mov_b32 v218, 1.0
 v_mov_b32 v219, 1.0
 v_mov_b32 v220, 1.0
 v_mov_b32 v221, 1.0
 v_mov_b32 v222, 1.0
 v_mov_b32 v223, 1.0
 v_mov_b32 v224, 1.0
 v_mov_b32 v225, 1.0
 v_mov_b32 v226, 1.0
 v_mov_b32 v227, 1.0
 v_mov_b32 v228, 1.0
 v_mov_b32 v229, 1.0
 v_mov_b32 v230, 1.0
 v_mov_b32 v231, 1.0
 v_mov_b32 v232, 1.0
 v_mov_b32 v233, 1.0
 v_mov_b32 v234, 1.0
 v_mov_b32 v235, 1.0
 v_mov_b32 v236, 1.0
 v_mov_b32 v237, 1.0
 v_mov_b32 v238, 1.0
 v_mov_b32 v239, 1.0
 v_mov_b32 v240, 1.0
 v_mov_b32 v241, 1.0
 v_mov_b32 v242, 1.0
 v_mov_b32 v243, 1.0
 v_mov_b32 v244, 1.0
 v_mov_b32 v245, 1.0
 v_mov_b32 v246, 1.0
 v_mov_b32 v247, 1.0
 v_mov_b32 v248, 1.0
 v_mov_b32 v249, 1.0
 v_mov_b32 v250, 1.0
 v_mov_b32 v251, 1.0
 v_mov_b32 v252, 1.0
 v_mov_b32 v253, 1.0
 v_mov_b32 v254, 1.0
 v_mov_b32 v255, 1.0
 v_accvgpr_write_b32 a248, 1.0
 v_accvgpr_write_b32 a249, 1.0
 v_accvgpr_write_b32 a250, 1.0
 v_accvgpr_write_b32 a251, 1.0
 v_accvgpr_write_b32 a252, 1.0
 v_accvgpr_write_b32 a253, 1.0
 v_accvgpr_write_b32 a254, 1.0
 v_accvgpr_write_b32 a255, 1.0
 v_and_b32 v5, 768, v1
 v_add3_u32 v5, v5, v1, s52
 s_waitcnt vmcnt(4)
 ds_read_b64_tr_b16 v[8:9], v5 offset:0
 ds_read_b64_tr_b16 v[10:11], v5 offset:256
 ds_read_b64_tr_b16 v[12:13], v5 offset:8
 ds_read_b64_tr_b16 v[14:15], v5 offset:264
 s_waitcnt lgkmcnt(2)
 buffer_store_dwordx4 v[8:11], v1, s[12:15], s49 offen sc1
 s_waitcnt lgkmcnt(0)
 buffer_store_dwordx4 v[12:15], v1, s[12:15], s49 offen offset:2048 sc1
 s_add_u32 s49, s49, 2097152
 s_add_u32 m0, s50, 0
 s_add_u32 s3, s28, 0
 buffer_load_dwordx4 v20, s[8:11], s3 offen nt lds
 s_add_u32 m0, s50, 1024
 s_add_u32 s3, s28, 8192
 buffer_load_dwordx4 v21, s[8:11], s3 offen nt lds
 s_add_u32 m0, s50, 2048
 s_add_u32 s3, s28, 16384
 buffer_load_dwordx4 v22, s[8:11], s3 offen nt lds
 s_add_u32 m0, s50, 3072
 s_add_u32 s3, s28, 24576
 buffer_load_dwordx4 v23, s[8:11], s3 offen nt lds
 s_waitcnt vmcnt(9)
 v_lshlrev_b32 v40, 16, v32
 v_and_b32 v41, s26, v32
 v_lshlrev_b32 v42, 16, v33
 v_and_b32 v43, s26, v33
 ds_write_b128 v31, v[40:43]
 s_waitcnt vmcnt(8)
 v_lshlrev_b32 v44, 16, v34
 v_and_b32 v45, s26, v34
 v_lshlrev_b32 v46, 16, v35
 v_and_b32 v47, s26, v35
 ds_write_b128 v31, v[44:47] offset:4096
 s_waitcnt vmcnt(7)
 v_lshlrev_b32 v48, 16, v36
 v_and_b32 v49, s26, v36
 v_lshlrev_b32 v50, 16, v37
 v_and_b32 v51, s26, v37
 ds_write_b128 v31, v[48:51] offset:8192
 s_waitcnt lgkmcnt(0)
 v_mov_b32 v32, 1.0
 v_mov_b32 v33, 1.0
 v_mov_b32 v34, 1.0
 v_mov_b32 v35, 1.0
 v_mov_b32 v36, 1.0
 v_mov_b32 v37, 1.0
 v_mov_b32 v38, 1.0
 v_mov_b32 v39, 1.0
 v_mov_b32 v40, 1.0
 v_mov_b32 v41, 1.0
 v_mov_b32 v42, 1.0
 v_mov_b32 v43, 1.0
 v_mov_b32 v44, 1.0
 v_mov_b32 v45, 1.0
 v_mov_b32 v46, 1.0
 v_mov_b32 v47, 1.0
 v_mov_b32 v48, 1.0
 v_mov_b32 v49, 1.0
 v_mov_b32 v50, 1.0
 v_mov_b32 v51, 1.0
 v_mov_b32 v52, 1.0
 v_mov_b32 v53, 1.0
 v_mov_b32 v54, 1.0
 v_mov_b32 v55, 1.0
 v_mov_b32 v56, 1.0
 v_mov_b32 v57, 1.0
 v_mov_b32 v58, 1.0
 v_mov_b32 v59, 1.0
 v_mov_b32 v60, 1.0
 v_mov_b32 v61, 1.0
 v_mov_b32 v62, 1.0
 v_mov_b32 v63, 1.0
 s_waitcnt vmcnt(4)
 s_barrier
 v_mov_b32 v7, 1
 buffer_atomic_add v7, v0, s[56:59], 0 offen sc1
 s_add_u32 m0, s50, 4096
 s_add_u32 s3, s28, 32768
 buffer_load_dwordx4 v20, s[8:11], s3 offen nt lds
 s_add_u32 m0, s50, 5120
 s_add_u32 s3, s28, 40960
 buffer_load_dwordx4 v21, s[8:11], s3 offen nt lds
 s_add_u32 m0, s50, 6144
 s_add_u32 s3, s28, 49152
 buffer_load_dwordx4 v22, s[8:11], s3 offen nt lds
 s_add_u32 m0, s50, 7168
 s_add_u32 s3, s28, 57344
 buffer_load_dwordx4 v23, s[8:11], s3 offen nt lds
 s_add_u32 m0, s50, 8192
 s_add_u32 s3, s28, 65536
 buffer_load_dwordx4 v20, s[8:11], s3 offen nt lds
 s_add_u32 m0, s50, 9216
 s_add_u32 s3, s28, 73728
 buffer_load_dwordx4 v21, s[8:11], s3 offen nt lds
 s_add_u32 m0, s50, 10240
 s_add_u32 s3, s28, 81920
 buffer_load_dwordx4 v22, s[8:11], s3 offen nt lds
 s_add_u32 m0, s50, 11264
 s_add_u32 s3, s28, 90112
 buffer_load_dwordx4 v23, s[8:11], s3 offen nt lds
 s_add_u32 m0, s50, 12288
 s_add_u32 s3, s28, 98304
 buffer_load_dwordx4 v20, s[8:11], s3 offen nt lds
 s_add_u32 m0, s50, 13312
 s_add_u32 s3, s28, 106496
 buffer_load_dwordx4 v21, s[8:11], s3 offen nt lds
 s_add_u32 m0, s50, 14336
 s_add_u32 s3, s28, 114688
 buffer_load_dwordx4 v22, s[8:11], s3 offen nt lds
 s_add_u32 m0, s50, 15360
 s_add_u32 s3, s28, 122880
 buffer_load_dwordx4 v23, s[8:11], s3 offen nt lds
 s_waitcnt vmcnt(13)
 ds_read_b128 a[0:3], v24
 ds_read_b128 a[32:35], v25
 ds_read_b128 a[64:67], v26
 ds_read_b128 a[96:99], v27
 s_waitcnt lgkmcnt(0)
 ds_write_b128 v3, a[0:3]
 ds_write_b128 v3, a[32:35] offset:1024
 ds_write_b128 v3, a[64:67] offset:2048
 ds_write_b128 v3, a[96:99] offset:3072
 s_add_u32 m0, s50, 16384
 s_add_u32 s3, s28, 131072
 buffer_load_dwordx4 v20, s[8:11], s3 offen nt lds
 s_add_u32 m0, s50, 17408
 s_add_u32 s3, s28, 139264
 buffer_load_dwordx4 v21, s[8:11], s3 offen nt lds
 s_add_u32 m0, s50, 18432
 s_add_u32 s3, s28, 147456
 buffer_load_dwordx4 v22, s[8:11], s3 offen nt lds
 s_add_u32 m0, s50, 19456
 s_add_u32 s3, s28, 155648
 buffer_load_dwordx4 v23, s[8:11], s3 offen nt lds
 s_waitcnt vmcnt(12)
 ds_read_b128 a[4:7], v24 offset:4096
 ds_read_b128 a[36:39], v25 offset:4096
 ds_read_b128 a[68:71], v26 offset:4096
 ds_read_b128 a[100:103], v27 offset:4096
 s_waitcnt lgkmcnt(0)
 ds_write_b128 v3, a[4:7] offset:4096
 ds_write_b128 v3, a[36:39] offset:5120
 ds_write_b128 v3, a[68:71] offset:6144
 ds_write_b128 v3, a[100:103] offset:7168
 v_lshlrev_b32 v4, 2, v1
 v_and_b32 v4, 192, v4
 buffer_load_dword v4, v4, s[44:47], 0 offen sc1
 s_add_u32 m0, s50, 20480
 s_add_u32 s3, s28, 163840
 buffer_load_dwordx4 v20, s[8:11], s3 offen nt lds
 s_add_u32 m0, s50, 21504
 s_add_u32 s3, s28, 172032
 buffer_load_dwordx4 v21, s[8:11], s3 offen nt lds
 s_add_u32 m0, s50, 22528
 s_add_u32 s3, s28, 180224
 buffer_load_dwordx4 v22, s[8:11], s3 offen nt lds
 s_add_u32 m0, s50, 23552
 s_add_u32 s3, s28, 188416
 buffer_load_dwordx4 v23, s[8:11], s3 offen nt lds
 s_waitcnt vmcnt(13)
 ds_read_b128 a[8:11], v24 offset:8192
 ds_read_b128 a[40:43], v25 offset:8192
 ds_read_b128 a[72:75], v26 offset:8192
 ds_read_b128 a[104:107], v27 offset:8192
 s_waitcnt lgkmcnt(0)
 ds_write_b128 v3, a[8:11] offset:8192
 ds_write_b128 v3, a[40:43] offset:9216
 ds_write_b128 v3, a[72:75] offset:10240
 ds_write_b128 v3, a[104:107] offset:11264
 s_add_u32 m0, s50, 24576
 s_add_u32 s3, s28, 196608
 buffer_load_dwordx4 v20, s[8:11], s3 offen nt lds
 s_add_u32 m0, s50, 25600
 s_add_u32 s3, s28, 204800
 buffer_load_dwordx4 v21, s[8:11], s3 offen nt lds
 s_add_u32 m0, s50, 26624
 s_add_u32 s3, s28, 212992
 buffer_load_dwordx4 v22, s[8:11], s3 offen nt lds
 s_add_u32 m0, s50, 27648
 s_add_u32 s3, s28, 221184
 buffer_load_dwordx4 v23, s[8:11], s3 offen nt lds
 s_waitcnt vmcnt(13)
 ds_read_b128 a[12:15], v24 offset:12288
 ds_read_b128 a[44:47], v25 offset:12288
 ds_read_b128 a[76:79], v26 offset:12288
 ds_read_b128 a[108:111], v27 offset:12288
 s_waitcnt lgkmcnt(0)
 ds_write_b128 v3, a[12:15] offset:12288
 ds_write_b128 v3, a[44:47] offset:13312
 ds_write_b128 v3, a[76:79] offset:14336
 ds_write_b128 v3, a[108:111] offset:15360
 s_add_u32 m0, s50, 28672
 s_add_u32 s3, s28, 229376
 buffer_load_dwordx4 v20, s[8:11], s3 offen nt lds
 s_add_u32 m0, s50, 29696
 s_add_u32 s3, s28, 237568
 buffer_load_dwordx4 v21, s[8:11], s3 offen nt lds
 s_add_u32 m0, s50, 30720
 s_add_u32 s3, s28, 245760
 buffer_load_dwordx4 v22, s[8:11], s3 offen nt lds
 s_add_u32 m0, s50, 31744
 s_add_u32 s3, s28, 253952
 buffer_load_dwordx4 v23, s[8:11], s3 offen nt lds
 s_waitcnt vmcnt(13)
 ds_read_b128 a[16:19], v24 offset:16384
 ds_read_b128 a[48:51], v25 offset:16384
 ds_read_b128 a[80:83], v26 offset:16384
 ds_read_b128 a[112:115], v27 offset:16384
 s_waitcnt lgkmcnt(0)
 ds_write_b128 v3, a[16:19] offset:16384
 ds_write_b128 v3, a[48:51] offset:17408
 ds_write_b128 v3, a[80:83] offset:18432
 ds_write_b128 v3, a[112:115] offset:19456
 s_waitcnt vmcnt(12)
 v_cmp_gt_u32 vcc, s27, v4
 s_cbranch_vccnz Lspin_pro
Lok_pro:
 s_add_u32 s27, s27, 64
 buffer_load_dwordx4 a[196:199], v0, s[12:15], s24 offen offset:1024
 buffer_load_dwordx4 a[192:195], v0, s[12:15], s24 offen
 buffer_load_dwordx4 a[204:207], v0, s[12:15], s24 offen offset:3072
 buffer_load_dwordx4 a[200:203], v0, s[12:15], s24 offen offset:2048
 s_add_u32 s24, s24, 4096
 buffer_load_dwordx4 a[212:215], v0, s[12:15], s24 offen offset:1024
 buffer_load_dwordx4 a[208:211], v0, s[12:15], s24 offen
 buffer_load_dwordx4 a[220:223], v0, s[12:15], s24 offen offset:3072
 buffer_load_dwordx4 a[216:219], v0, s[12:15], s24 offen offset:2048
 s_add_u32 s24, s24, 4096
 buffer_load_dwordx4 a[228:231], v0, s[12:15], s24 offen offset:1024
 buffer_load_dwordx4 a[224:227], v0, s[12:15], s24 offen
 buffer_load_dwordx4 a[236:239], v0, s[12:15], s24 offen offset:3072
 buffer_load_dwordx4 a[232:235], v0, s[12:15], s24 offen offset:2048
 s_add_u32 s24, s24, 4096
 s_waitcnt vmcnt(20)
 ds_read_b128 a[20:23], v24 offset:20480
 ds_read_b128 a[52:55], v25 offset:20480
 ds_read_b128 a[84:87], v26 offset:20480
 ds_read_b128 a[116:119], v27 offset:20480
 s_waitcnt lgkmcnt(0)
 ds_write_b128 v3, a[20:23] offset:20480
 ds_write_b128 v3, a[52:55] offset:21504
 ds_write_b128 v3, a[84:87] offset:22528
 ds_write_b128 v3, a[116:119] offset:23552
 s_waitcnt vmcnt(16)
 ds_read_b128 a[24:27], v24 offset:24576
 ds_read_b128 a[56:59], v25 offset:24576
 ds_read_b128 a[88:91], v26 offset:24576
 ds_read_b128 a[120:123], v27 offset:24576
 s_waitcnt lgkmcnt(0)
 ds_write_b128 v3, a[24:27] offset:24576
 ds_write_b128 v3, a[56:59] offset:25600
 ds_write_b128 v3, a[88:91] offset:26624
 ds_write_b128 v3, a[120:123] offset:27648
 s_waitcnt vmcnt(12)
 ds_read_b128 a[28:31], v24 offset:28672
 ds_read_b128 a[60:63], v25 offset:28672
 ds_read_b128 a[92:95], v26 offset:28672
 ds_read_b128 a[124:127], v27 offset:28672
 s_waitcnt lgkmcnt(0)
 ds_write_b128 v3, a[28:31] offset:28672
 ds_write_b128 v3, a[60:63] offset:29696
 ds_write_b128 v3, a[92:95] offset:30720
 ds_write_b128 v3, a[124:127] offset:31744
 v_mov_b32 v16, 1.0
 v_mov_b32 v17, 1.0
 v_mov_b32 v18, 1.0
 v_mov_b32 v19, 1.0
 v_mov_b32 v20, 1.0
 v_mov_b32 v21, 1.0
 v_mov_b32 v22, 1.0
 v_mov_b32 v23, 1.0
 v_mov_b32 v24, 1.0
 v_mov_b32 v25, 1.0
 v_mov_b32 v26, 1.0
 v_mov_b32 v27, 1.0
 v_mov_b32 v28, 1.0
 v_mov_b32 v29, 1.0
 v_mov_b32 v30, 1.0
 v_mov_b32 v31, 1.0
 s_waitcnt lgkmcnt(0)
 s_barrier
 ds_read_b128 a[128:131], v1
 ds_read_b128 a[132:135], v1 offset:1024
 ds_read_b128 a[140:143], v1 offset:5120
 ds_read_b128 a[136:139], v1 offset:4096
 ds_read_b128 a[144:147], v1 offset:8192
 ds_read_b128 a[148:151], v1 offset:9216
 ds_read_b128 a[156:159], v1 offset:13312
 ds_read_b128 a[152:155], v1 offset:12288
 ds_read_b128 a[160:163], v1 offset:16384
 ds_read_b128 a[164:167], v1 offset:17408
 ds_read_b128 a[172:175], v1 offset:21504
 ds_read_b128 a[168:171], v1 offset:20480
 ds_read_b128 a[176:179], v1 offset:24576
 ds_read_b128 a[180:183], v1 offset:25600
 ds_read_b128 a[188:191], v1 offset:29696
 ds_read_b128 a[184:187], v1 offset:28672
 s_waitcnt vmcnt(10) lgkmcnt(8)
 v_mfma_f32_16x16x32_bf16 v[16:19], a[192:195], a[128:131], v[16:19]
 s_add_u32 s68, s29, 0
 v_mfma_f32_16x16x32_bf16 v[16:19], a[196:199], a[132:135], v[16:19]
 v_mfma_f32_16x16x32_bf16 v[20:23], a[196:199], a[140:143], v[20:23]
 v_mfma_f32_16x16x32_bf16 v[20:23], a[192:195], a[136:139], v[20:23]
 v_mfma_f32_16x16x32_bf16 v[24:27], a[192:195], a[144:147], v[24:27]
 v_mfma_f32_16x16x32_bf16 v[24:27], a[196:199], a[148:151], v[24:27]
 v_mfma_f32_16x16x32_bf16 v[28:31], a[196:199], a[156:159], v[28:31]
 v_mfma_f32_16x16x32_bf16 v[28:31], a[192:195], a[152:155], v[28:31]
 s_waitcnt lgkmcnt(0)
 v_mfma_f32_16x16x32_bf16 v[32:35], a[192:195], a[160:163], v[32:35]
 buffer_store_dwordx4 a[0:3], v3, s[32:35], s68 offen sc1
 v_mfma_f32_16x16x32_bf16 v[32:35], a[196:199], a[164:167], v[32:35]
 v_mfma_f32_16x16x32_bf16 v[36:39], a[196:199], a[172:175], v[36:39]
 v_mfma_f32_16x16x32_bf16 v[36:39], a[192:195], a[168:171], v[36:39]
 v_mfma_f32_16x16x32_bf16 v[40:43], a[192:195], a[176:179], v[40:43]
 v_mfma_f32_16x16x32_bf16 v[40:43], a[196:199], a[180:183], v[40:43]
 v_mfma_f32_16x16x32_bf16 v[44:47], a[196:199], a[188:191], v[44:47]
 buffer_load_dwordx4 a[196:199], v0, s[12:15], s24 offen offset:1024
 v_mfma_f32_16x16x32_bf16 v[44:47], a[192:195], a[184:187], v[44:47]
 s_waitcnt vmcnt(10)
 v_mfma_f32_16x16x32_bf16 v[76:79], a[200:203], a[184:187], v[76:79]
 v_mfma_f32_16x16x32_bf16 v[76:79], a[204:207], a[188:191], v[76:79]
 buffer_load_dwordx4 a[192:195], v0, s[12:15], s24 offen
 v_mfma_f32_16x16x32_bf16 v[72:75], a[204:207], a[180:183], v[72:75]
 buffer_store_dwordx4 a[32:35], v3, s[32:35], s68 offen offset:1024 sc1
 v_mfma_f32_16x16x32_bf16 v[72:75], a[200:203], a[176:179], v[72:75]
 v_mfma_f32_16x16x32_bf16 v[68:71], a[200:203], a[168:171], v[68:71]
 v_mfma_f32_16x16x32_bf16 v[68:71], a[204:207], a[172:175], v[68:71]
 v_mfma_f32_16x16x32_bf16 v[64:67], a[204:207], a[164:167], v[64:67]
 v_mfma_f32_16x16x32_bf16 v[64:67], a[200:203], a[160:163], v[64:67]
 v_mfma_f32_16x16x32_bf16 v[60:63], a[200:203], a[152:155], v[60:63]
 v_mfma_f32_16x16x32_bf16 v[60:63], a[204:207], a[156:159], v[60:63]
 buffer_store_dwordx4 a[4:7], v3, s[32:35], s68 offen offset:2048 sc1
 v_mfma_f32_16x16x32_bf16 v[56:59], a[204:207], a[148:151], v[56:59]
 v_mfma_f32_16x16x32_bf16 v[56:59], a[200:203], a[144:147], v[56:59]
 v_mfma_f32_16x16x32_bf16 v[52:55], a[200:203], a[136:139], v[52:55]
 v_mfma_f32_16x16x32_bf16 v[52:55], a[204:207], a[140:143], v[52:55]
 v_mfma_f32_16x16x32_bf16 v[48:51], a[204:207], a[132:135], v[48:51]
 buffer_load_dwordx4 a[204:207], v0, s[12:15], s24 offen offset:3072
 v_mfma_f32_16x16x32_bf16 v[48:51], a[200:203], a[128:131], v[48:51]
 s_waitcnt vmcnt(12)
 v_mfma_f32_16x16x32_bf16 v[80:83], a[208:211], a[128:131], v[80:83]
 v_mfma_f32_16x16x32_bf16 v[80:83], a[212:215], a[132:135], v[80:83]
 buffer_load_dwordx4 a[200:203], v0, s[12:15], s24 offen offset:2048
 v_mfma_f32_16x16x32_bf16 v[84:87], a[212:215], a[140:143], v[84:87]
 v_mfma_f32_16x16x32_bf16 v[84:87], a[208:211], a[136:139], v[84:87]
 s_add_u32 s24, s24, 4096
 v_mfma_f32_16x16x32_bf16 v[88:91], a[208:211], a[144:147], v[88:91]
 buffer_store_dwordx4 a[36:39], v3, s[32:35], s68 offen offset:3072 sc1
 v_mfma_f32_16x16x32_bf16 v[88:91], a[212:215], a[148:151], v[88:91]
 v_mfma_f32_16x16x32_bf16 v[92:95], a[212:215], a[156:159], v[92:95]
 v_mfma_f32_16x16x32_bf16 v[92:95], a[208:211], a[152:155], v[92:95]
 v_mfma_f32_16x16x32_bf16 v[96:99], a[208:211], a[160:163], v[96:99]
 v_mfma_f32_16x16x32_bf16 v[96:99], a[212:215], a[164:167], v[96:99]
 v_mfma_f32_16x16x32_bf16 v[100:103], a[212:215], a[172:175], v[100:103]
 v_mfma_f32_16x16x32_bf16 v[100:103], a[208:211], a[168:171], v[100:103]
 s_add_u32 s68, s29, 4096
 v_mfma_f32_16x16x32_bf16 v[104:107], a[208:211], a[176:179], v[104:107]
 v_mfma_f32_16x16x32_bf16 v[104:107], a[212:215], a[180:183], v[104:107]
 v_mfma_f32_16x16x32_bf16 v[108:111], a[212:215], a[188:191], v[108:111]
 buffer_load_dwordx4 a[212:215], v0, s[12:15], s24 offen offset:1024
 v_mfma_f32_16x16x32_bf16 v[108:111], a[208:211], a[184:187], v[108:111]
 s_waitcnt vmcnt(13)
 v_mfma_f32_16x16x32_bf16 a[244:247], a[216:219], a[184:187], a[244:247]
 ds_read_b128 a[184:187], v1 offset:61440
 v_mfma_f32_16x16x32_bf16 a[244:247], a[220:223], a[188:191], a[244:247]
 buffer_load_dwordx4 a[208:211], v0, s[12:15], s24 offen
 ds_read_b128 a[188:191], v1 offset:62464
 v_mfma_f32_16x16x32_bf16 a[240:243], a[220:223], a[180:183], a[240:243]
 ds_read_b128 a[180:183], v1 offset:58368
 v_mfma_f32_16x16x32_bf16 a[240:243], a[216:219], a[176:179], a[240:243]
 ds_read_b128 a[176:179], v1 offset:57344
 v_mfma_f32_16x16x32_bf16 v[132:135], a[216:219], a[168:171], v[132:135]
 ds_read_b128 a[168:171], v1 offset:53248
 v_mfma_f32_16x16x32_bf16 v[132:135], a[220:223], a[172:175], v[132:135]
 ds_read_b128 a[172:175], v1 offset:54272
 v_mfma_f32_16x16x32_bf16 v[128:131], a[220:223], a[164:167], v[128:131]
 ds_read_b128 a[164:167], v1 offset:50176
 v_mfma_f32_16x16x32_bf16 v[128:131], a[216:219], a[160:163], v[128:131]
 ds_read_b128 a[160:163], v1 offset:49152
 v_mfma_f32_16x16x32_bf16 v[124:127], a[216:219], a[152:155], v[124:127]
 ds_read_b128 a[152:155], v1 offset:45056
 v_mfma_f32_16x16x32_bf16 v[124:127], a[220:223], a[156:159], v[124:127]
 ds_read_b128 a[156:159], v1 offset:46080
 v_mfma_f32_16x16x32_bf16 v[120:123], a[220:223], a[148:151], v[120:123]
 ds_read_b128 a[148:151], v1 offset:41984
 v_mfma_f32_16x16x32_bf16 v[120:123], a[216:219], a[144:147], v[120:123]
 ds_read_b128 a[144:147], v1 offset:40960
 v_mfma_f32_16x16x32_bf16 v[116:119], a[216:219], a[136:139], v[116:119]
 ds_read_b128 a[136:139], v1 offset:36864
 v_mfma_f32_16x16x32_bf16 v[116:119], a[220:223], a[140:143], v[116:119]
 ds_read_b128 a[140:143], v1 offset:37888
 v_mfma_f32_16x16x32_bf16 v[112:115], a[220:223], a[132:135], v[112:115]
 ds_read_b128 a[132:135], v1 offset:33792
 v_mfma_f32_16x16x32_bf16 v[112:115], a[216:219], a[128:131], v[112:115]
 ds_read_b128 a[128:131], v1 offset:32768
 s_waitcnt vmcnt(12) lgkmcnt(8)
 v_mfma_f32_16x16x32_bf16 v[44:47], a[224:227], a[184:187], v[44:47]
 v_mfma_f32_16x16x32_bf16 v[44:47], a[228:231], a[188:191], v[44:47]
 buffer_load_dwordx4 a[220:223], v0, s[12:15], s24 offen offset:3072
 v_mfma_f32_16x16x32_bf16 v[40:43], a[228:231], a[180:183], v[40:43]
 v_mfma_f32_16x16x32_bf16 v[40:43], a[224:227], a[176:179], v[40:43]
 buffer_load_dwordx4 a[216:219], v0, s[12:15], s24 offen offset:2048
 v_mfma_f32_16x16x32_bf16 v[36:39], a[224:227], a[168:171], v[36:39]
 s_add_u32 s24, s24, 4096
 v_mfma_f32_16x16x32_bf16 v[36:39], a[228:231], a[172:175], v[36:39]
 v_mfma_f32_16x16x32_bf16 v[32:35], a[228:231], a[164:167], v[32:35]
 v_mfma_f32_16x16x32_bf16 v[32:35], a[224:227], a[160:163], v[32:35]
 s_waitcnt lgkmcnt(0)
 v_mfma_f32_16x16x32_bf16 v[28:31], a[224:227], a[152:155], v[28:31]
 buffer_store_dwordx4 a[8:11], v3, s[32:35], s68 offen sc1
 v_mfma_f32_16x16x32_bf16 v[28:31], a[228:231], a[156:159], v[28:31]
 v_mfma_f32_16x16x32_bf16 v[24:27], a[228:231], a[148:151], v[24:27]
 v_mfma_f32_16x16x32_bf16 v[24:27], a[224:227], a[144:147], v[24:27]
 v_mfma_f32_16x16x32_bf16 v[20:23], a[224:227], a[136:139], v[20:23]
 v_mfma_f32_16x16x32_bf16 v[20:23], a[228:231], a[140:143], v[20:23]
 v_mfma_f32_16x16x32_bf16 v[16:19], a[228:231], a[132:135], v[16:19]
 buffer_load_dwordx4 a[228:231], v0, s[12:15], s24 offen offset:1024
 v_mfma_f32_16x16x32_bf16 v[16:19], a[224:227], a[128:131], v[16:19]
 s_waitcnt vmcnt(14)
 v_mfma_f32_16x16x32_bf16 v[48:51], a[232:235], a[128:131], v[48:51]
 v_mfma_f32_16x16x32_bf16 v[48:51], a[236:239], a[132:135], v[48:51]
 buffer_load_dwordx4 a[224:227], v0, s[12:15], s24 offen
 v_mfma_f32_16x16x32_bf16 v[52:55], a[236:239], a[140:143], v[52:55]
 v_mfma_f32_16x16x32_bf16 v[52:55], a[232:235], a[136:139], v[52:55]
 buffer_store_dwordx4 a[40:43], v3, s[32:35], s68 offen offset:1024 sc1
 v_mfma_f32_16x16x32_bf16 v[56:59], a[232:235], a[144:147], v[56:59]
 v_mfma_f32_16x16x32_bf16 v[56:59], a[236:239], a[148:151], v[56:59]
 v_mfma_f32_16x16x32_bf16 v[60:63], a[236:239], a[156:159], v[60:63]
 v_mfma_f32_16x16x32_bf16 v[60:63], a[232:235], a[152:155], v[60:63]
 v_mfma_f32_16x16x32_bf16 v[64:67], a[232:235], a[160:163], v[64:67]
 v_mfma_f32_16x16x32_bf16 v[64:67], a[236:239], a[164:167], v[64:67]
 v_mfma_f32_16x16x32_bf16 v[68:71], a[236:239], a[172:175], v[68:71]
 buffer_store_dwordx4 a[12:15], v3, s[32:35], s68 offen offset:2048 sc1
 v_mfma_f32_16x16x32_bf16 v[68:71], a[232:235], a[168:171], v[68:71]
 v_mfma_f32_16x16x32_bf16 v[72:75], a[232:235], a[176:179], v[72:75]
 v_mfma_f32_16x16x32_bf16 v[72:75], a[236:239], a[180:183], v[72:75]
 v_mfma_f32_16x16x32_bf16 v[76:79], a[236:239], a[188:191], v[76:79]
 buffer_load_dwordx4 a[236:239], v0, s[12:15], s24 offen offset:3072
 v_mfma_f32_16x16x32_bf16 v[76:79], a[232:235], a[184:187], v[76:79]
 s_waitcnt vmcnt(15)
 v_mfma_f32_16x16x32_bf16 v[108:111], a[192:195], a[184:187], v[108:111]
 v_mfma_f32_16x16x32_bf16 v[108:111], a[196:199], a[188:191], v[108:111]
 buffer_load_dwordx4 a[232:235], v0, s[12:15], s24 offen offset:2048
 v_mfma_f32_16x16x32_bf16 v[104:107], a[196:199], a[180:183], v[104:107]
 v_mfma_f32_16x16x32_bf16 v[104:107], a[192:195], a[176:179], v[104:107]
 s_add_u32 s24, s24, 4096
 v_mfma_f32_16x16x32_bf16 v[100:103], a[192:195], a[168:171], v[100:103]
 v_mfma_f32_16x16x32_bf16 v[100:103], a[196:199], a[172:175], v[100:103]
 buffer_store_dwordx4 a[44:47], v3, s[32:35], s68 offen offset:3072 sc1
 v_mfma_f32_16x16x32_bf16 v[96:99], a[196:199], a[164:167], v[96:99]
 v_mfma_f32_16x16x32_bf16 v[96:99], a[192:195], a[160:163], v[96:99]
 v_mfma_f32_16x16x32_bf16 v[92:95], a[192:195], a[152:155], v[92:95]
 v_mfma_f32_16x16x32_bf16 v[92:95], a[196:199], a[156:159], v[92:95]
 v_mfma_f32_16x16x32_bf16 v[88:91], a[196:199], a[148:151], v[88:91]
 v_mfma_f32_16x16x32_bf16 v[88:91], a[192:195], a[144:147], v[88:91]
 v_mfma_f32_16x16x32_bf16 v[84:87], a[192:195], a[136:139], v[84:87]
 s_add_u32 s68, s29, 8192
 v_mfma_f32_16x16x32_bf16 v[84:87], a[196:199], a[140:143], v[84:87]
 v_mfma_f32_16x16x32_bf16 v[80:83], a[196:199], a[132:135], v[80:83]
 buffer_load_dwordx4 a[196:199], v0, s[12:15], s24 offen offset:1024
 v_mfma_f32_16x16x32_bf16 v[80:83], a[192:195], a[128:131], v[80:83]
 s_waitcnt vmcnt(14)
 v_mfma_f32_16x16x32_bf16 v[112:115], a[200:203], a[128:131], v[112:115]
 ds_read_b128 a[128:131], v2
 v_mfma_f32_16x16x32_bf16 v[112:115], a[204:207], a[132:135], v[112:115]
 buffer_load_dwordx4 a[192:195], v0, s[12:15], s24 offen
 ds_read_b128 a[132:135], v2 offset:1024
 v_mfma_f32_16x16x32_bf16 v[116:119], a[204:207], a[140:143], v[116:119]
 ds_read_b128 a[140:143], v2 offset:5120
 v_mfma_f32_16x16x32_bf16 v[116:119], a[200:203], a[136:139], v[116:119]
 ds_read_b128 a[136:139], v2 offset:4096
 v_mfma_f32_16x16x32_bf16 v[120:123], a[200:203], a[144:147], v[120:123]
 ds_read_b128 a[144:147], v2 offset:8192
 v_mfma_f32_16x16x32_bf16 v[120:123], a[204:207], a[148:151], v[120:123]
 ds_read_b128 a[148:151], v2 offset:9216
 v_mfma_f32_16x16x32_bf16 v[124:127], a[204:207], a[156:159], v[124:127]
 ds_read_b128 a[156:159], v2 offset:13312
 v_mfma_f32_16x16x32_bf16 v[124:127], a[200:203], a[152:155], v[124:127]
 ds_read_b128 a[152:155], v2 offset:12288
 v_mfma_f32_16x16x32_bf16 v[128:131], a[200:203], a[160:163], v[128:131]
 ds_read_b128 a[160:163], v2 offset:16384
 v_mfma_f32_16x16x32_bf16 v[128:131], a[204:207], a[164:167], v[128:131]
 ds_read_b128 a[164:167], v2 offset:17408
 v_mfma_f32_16x16x32_bf16 v[132:135], a[204:207], a[172:175], v[132:135]
 ds_read_b128 a[172:175], v2 offset:21504
 v_mfma_f32_16x16x32_bf16 v[132:135], a[200:203], a[168:171], v[132:135]
 ds_read_b128 a[168:171], v2 offset:20480
 v_mfma_f32_16x16x32_bf16 a[240:243], a[200:203], a[176:179], a[240:243]
 ds_read_b128 a[176:179], v2 offset:24576
 v_mfma_f32_16x16x32_bf16 a[240:243], a[204:207], a[180:183], a[240:243]
 ds_read_b128 a[180:183], v2 offset:25600
 v_mfma_f32_16x16x32_bf16 a[244:247], a[204:207], a[188:191], a[244:247]
 ds_read_b128 a[188:191], v2 offset:29696
 v_mfma_f32_16x16x32_bf16 a[244:247], a[200:203], a[184:187], a[244:247]
 ds_read_b128 a[184:187], v2 offset:28672
 s_waitcnt vmcnt(12) lgkmcnt(8)
 v_mfma_f32_16x16x32_bf16 v[16:19], a[208:211], a[128:131], v[16:19]
 v_mfma_f32_16x16x32_bf16 v[16:19], a[212:215], a[132:135], v[16:19]
 buffer_load_dwordx4 a[204:207], v0, s[12:15], s24 offen offset:3072
 v_mfma_f32_16x16x32_bf16 v[20:23], a[212:215], a[140:143], v[20:23]
 v_mfma_f32_16x16x32_bf16 v[20:23], a[208:211], a[136:139], v[20:23]
 buffer_load_dwordx4 a[200:203], v0, s[12:15], s24 offen offset:2048
 v_mfma_f32_16x16x32_bf16 v[24:27], a[208:211], a[144:147], v[24:27]
 s_add_u32 s24, s24, 4096
 v_mfma_f32_16x16x32_bf16 v[24:27], a[212:215], a[148:151], v[24:27]
 v_mfma_f32_16x16x32_bf16 v[28:31], a[212:215], a[156:159], v[28:31]
 v_mfma_f32_16x16x32_bf16 v[28:31], a[208:211], a[152:155], v[28:31]
 s_waitcnt lgkmcnt(0)
 v_mfma_f32_16x16x32_bf16 v[32:35], a[208:211], a[160:163], v[32:35]
 v_mfma_f32_16x16x32_bf16 v[32:35], a[212:215], a[164:167], v[32:35]
 buffer_store_dwordx4 a[16:19], v3, s[32:35], s68 offen sc1
 v_mfma_f32_16x16x32_bf16 v[36:39], a[212:215], a[172:175], v[36:39]
 v_mfma_f32_16x16x32_bf16 v[36:39], a[208:211], a[168:171], v[36:39]
 v_mfma_f32_16x16x32_bf16 v[40:43], a[208:211], a[176:179], v[40:43]
 v_mfma_f32_16x16x32_bf16 v[40:43], a[212:215], a[180:183], v[40:43]
 v_mfma_f32_16x16x32_bf16 v[44:47], a[212:215], a[188:191], v[44:47]
 buffer_load_dwordx4 a[212:215], v0, s[12:15], s24 offen offset:1024
 v_mfma_f32_16x16x32_bf16 v[44:47], a[208:211], a[184:187], v[44:47]
 s_waitcnt vmcnt(14)
 v_mfma_f32_16x16x32_bf16 v[76:79], a[216:219], a[184:187], v[76:79]
 v_mfma_f32_16x16x32_bf16 v[76:79], a[220:223], a[188:191], v[76:79]
 buffer_load_dwordx4 a[208:211], v0, s[12:15], s24 offen
 v_mfma_f32_16x16x32_bf16 v[72:75], a[220:223], a[180:183], v[72:75]
 v_mfma_f32_16x16x32_bf16 v[72:75], a[216:219], a[176:179], v[72:75]
 buffer_store_dwordx4 a[48:51], v3, s[32:35], s68 offen offset:1024 sc1
 v_mfma_f32_16x16x32_bf16 v[68:71], a[216:219], a[168:171], v[68:71]
 v_mfma_f32_16x16x32_bf16 v[68:71], a[220:223], a[172:175], v[68:71]
 v_mfma_f32_16x16x32_bf16 v[64:67], a[220:223], a[164:167], v[64:67]
 v_mfma_f32_16x16x32_bf16 v[64:67], a[216:219], a[160:163], v[64:67]
 v_mfma_f32_16x16x32_bf16 v[60:63], a[216:219], a[152:155], v[60:63]
 v_mfma_f32_16x16x32_bf16 v[60:63], a[220:223], a[156:159], v[60:63]
 v_mfma_f32_16x16x32_bf16 v[56:59], a[220:223], a[148:151], v[56:59]
 buffer_store_dwordx4 a[20:23], v3, s[32:35], s68 offen offset:2048 sc1
 v_mfma_f32_16x16x32_bf16 v[56:59], a[216:219], a[144:147], v[56:59]
 v_mfma_f32_16x16x32_bf16 v[52:55], a[216:219], a[136:139], v[52:55]
 v_mfma_f32_16x16x32_bf16 v[52:55], a[220:223], a[140:143], v[52:55]
 v_mfma_f32_16x16x32_bf16 v[48:51], a[220:223], a[132:135], v[48:51]
 buffer_load_dwordx4 a[220:223], v0, s[12:15], s24 offen offset:3072
 v_mfma_f32_16x16x32_bf16 v[48:51], a[216:219], a[128:131], v[48:51]
 s_waitcnt vmcnt(15)
 v_mfma_f32_16x16x32_bf16 v[80:83], a[224:227], a[128:131], v[80:83]
 v_mfma_f32_16x16x32_bf16 v[80:83], a[228:231], a[132:135], v[80:83]
 buffer_load_dwordx4 a[216:219], v0, s[12:15], s24 offen offset:2048
 v_mfma_f32_16x16x32_bf16 v[84:87], a[228:231], a[140:143], v[84:87]
 v_mfma_f32_16x16x32_bf16 v[84:87], a[224:227], a[136:139], v[84:87]
 s_add_u32 s24, s24, 4096
 v_mfma_f32_16x16x32_bf16 v[88:91], a[224:227], a[144:147], v[88:91]
 v_mfma_f32_16x16x32_bf16 v[88:91], a[228:231], a[148:151], v[88:91]
 v_mfma_f32_16x16x32_bf16 v[92:95], a[228:231], a[156:159], v[92:95]
 buffer_store_dwordx4 a[52:55], v3, s[32:35], s68 offen offset:3072 sc1
 v_mfma_f32_16x16x32_bf16 v[92:95], a[224:227], a[152:155], v[92:95]
 v_mfma_f32_16x16x32_bf16 v[96:99], a[224:227], a[160:163], v[96:99]
 v_mfma_f32_16x16x32_bf16 v[96:99], a[228:231], a[164:167], v[96:99]
 v_mfma_f32_16x16x32_bf16 v[100:103], a[228:231], a[172:175], v[100:103]
 v_mfma_f32_16x16x32_bf16 v[100:103], a[224:227], a[168:171], v[100:103]
 v_mfma_f32_16x16x32_bf16 v[104:107], a[224:227], a[176:179], v[104:107]
 v_mfma_f32_16x16x32_bf16 v[104:107], a[228:231], a[180:183], v[104:107]
 s_add_u32 s68, s29, 12288
 v_mfma_f32_16x16x32_bf16 v[108:111], a[228:231], a[188:191], v[108:111]
 buffer_load_dwordx4 a[228:231], v0, s[12:15], s24 offen offset:1024
 v_mfma_f32_16x16x32_bf16 v[108:111], a[224:227], a[184:187], v[108:111]
 s_waitcnt vmcnt(14)
 v_mfma_f32_16x16x32_bf16 a[244:247], a[232:235], a[184:187], a[244:247]
 ds_read_b128 a[184:187], v2 offset:61440
 v_mfma_f32_16x16x32_bf16 a[244:247], a[236:239], a[188:191], a[244:247]
 buffer_load_dwordx4 a[224:227], v0, s[12:15], s24 offen
 ds_read_b128 a[188:191], v2 offset:62464
 v_mfma_f32_16x16x32_bf16 a[240:243], a[236:239], a[180:183], a[240:243]
 ds_read_b128 a[180:183], v2 offset:58368
 v_mfma_f32_16x16x32_bf16 a[240:243], a[232:235], a[176:179], a[240:243]
 ds_read_b128 a[176:179], v2 offset:57344
 v_mfma_f32_16x16x32_bf16 v[132:135], a[232:235], a[168:171], v[132:135]
 ds_read_b128 a[168:171], v2 offset:53248
 v_mfma_f32_16x16x32_bf16 v[132:135], a[236:239], a[172:175], v[132:135]
 ds_read_b128 a[172:175], v2 offset:54272
 v_mfma_f32_16x16x32_bf16 v[128:131], a[236:239], a[164:167], v[128:131]
 ds_read_b128 a[164:167], v2 offset:50176
 v_mfma_f32_16x16x32_bf16 v[128:131], a[232:235], a[160:163], v[128:131]
 ds_read_b128 a[160:163], v2 offset:49152
 v_mfma_f32_16x16x32_bf16 v[124:127], a[232:235], a[152:155], v[124:127]
 ds_read_b128 a[152:155], v2 offset:45056
 v_mfma_f32_16x16x32_bf16 v[124:127], a[236:239], a[156:159], v[124:127]
 ds_read_b128 a[156:159], v2 offset:46080
 v_mfma_f32_16x16x32_bf16 v[120:123], a[236:239], a[148:151], v[120:123]
 ds_read_b128 a[148:151], v2 offset:41984
 v_mfma_f32_16x16x32_bf16 v[120:123], a[232:235], a[144:147], v[120:123]
 ds_read_b128 a[144:147], v2 offset:40960
 v_mfma_f32_16x16x32_bf16 v[116:119], a[232:235], a[136:139], v[116:119]
 ds_read_b128 a[136:139], v2 offset:36864
 v_mfma_f32_16x16x32_bf16 v[116:119], a[236:239], a[140:143], v[116:119]
 ds_read_b128 a[140:143], v2 offset:37888
 v_mfma_f32_16x16x32_bf16 v[112:115], a[236:239], a[132:135], v[112:115]
 ds_read_b128 a[132:135], v2 offset:33792
 v_mfma_f32_16x16x32_bf16 v[112:115], a[232:235], a[128:131], v[112:115]
 ds_read_b128 a[128:131], v2 offset:32768
 s_waitcnt vmcnt(12) lgkmcnt(8)
 v_mfma_f32_16x16x32_bf16 v[44:47], a[192:195], a[184:187], v[44:47]
 v_mfma_f32_16x16x32_bf16 v[44:47], a[196:199], a[188:191], v[44:47]
 buffer_load_dwordx4 a[236:239], v0, s[12:15], s24 offen offset:3072
 v_mfma_f32_16x16x32_bf16 v[40:43], a[196:199], a[180:183], v[40:43]
 v_mfma_f32_16x16x32_bf16 v[40:43], a[192:195], a[176:179], v[40:43]
 buffer_load_dwordx4 a[232:235], v0, s[12:15], s24 offen offset:2048
 v_mfma_f32_16x16x32_bf16 v[36:39], a[192:195], a[168:171], v[36:39]
 s_add_u32 s24, s24, 4096
 v_mfma_f32_16x16x32_bf16 v[36:39], a[196:199], a[172:175], v[36:39]
 v_mfma_f32_16x16x32_bf16 v[32:35], a[196:199], a[164:167], v[32:35]
 v_mfma_f32_16x16x32_bf16 v[32:35], a[192:195], a[160:163], v[32:35]
 s_waitcnt lgkmcnt(0)
 v_mfma_f32_16x16x32_bf16 v[28:31], a[192:195], a[152:155], v[28:31]
 v_mfma_f32_16x16x32_bf16 v[28:31], a[196:199], a[156:159], v[28:31]
 v_mfma_f32_16x16x32_bf16 v[24:27], a[196:199], a[148:151], v[24:27]
 buffer_store_dwordx4 a[24:27], v3, s[32:35], s68 offen sc1
 v_mfma_f32_16x16x32_bf16 v[24:27], a[192:195], a[144:147], v[24:27]
 v_mfma_f32_16x16x32_bf16 v[20:23], a[192:195], a[136:139], v[20:23]
 v_mfma_f32_16x16x32_bf16 v[20:23], a[196:199], a[140:143], v[20:23]
 v_mfma_f32_16x16x32_bf16 v[16:19], a[196:199], a[132:135], v[16:19]
 buffer_load_dwordx4 a[196:199], v0, s[12:15], s24 offen offset:1024
 v_mfma_f32_16x16x32_bf16 v[16:19], a[192:195], a[128:131], v[16:19]
 s_waitcnt vmcnt(14)
 v_mfma_f32_16x16x32_bf16 v[48:51], a[200:203], a[128:131], v[48:51]
 v_mfma_f32_16x16x32_bf16 v[48:51], a[204:207], a[132:135], v[48:51]
 buffer_load_dwordx4 a[192:195], v0, s[12:15], s24 offen
 v_mfma_f32_16x16x32_bf16 v[52:55], a[204:207], a[140:143], v[52:55]
 v_mfma_f32_16x16x32_bf16 v[52:55], a[200:203], a[136:139], v[52:55]
 v_mfma_f32_16x16x32_bf16 v[56:59], a[200:203], a[144:147], v[56:59]
 buffer_store_dwordx4 a[56:59], v3, s[32:35], s68 offen offset:1024 sc1
 v_mfma_f32_16x16x32_bf16 v[56:59], a[204:207], a[148:151], v[56:59]
 v_mfma_f32_16x16x32_bf16 v[60:63], a[204:207], a[156:159], v[60:63]
 v_mfma_f32_16x16x32_bf16 v[60:63], a[200:203], a[152:155], v[60:63]
 v_mfma_f32_16x16x32_bf16 v[64:67], a[200:203], a[160:163], v[64:67]
 v_mfma_f32_16x16x32_bf16 v[64:67], a[204:207], a[164:167], v[64:67]
 v_mfma_f32_16x16x32_bf16 v[68:71], a[204:207], a[172:175], v[68:71]
 v_mfma_f32_16x16x32_bf16 v[68:71], a[200:203], a[168:171], v[68:71]
 buffer_store_dwordx4 a[28:31], v3, s[32:35], s68 offen offset:2048 sc1
 v_mfma_f32_16x16x32_bf16 v[72:75], a[200:203], a[176:179], v[72:75]
 v_mfma_f32_16x16x32_bf16 v[72:75], a[204:207], a[180:183], v[72:75]
 v_mfma_f32_16x16x32_bf16 v[76:79], a[204:207], a[188:191], v[76:79]
 buffer_load_dwordx4 a[204:207], v0, s[12:15], s24 offen offset:3072
 v_mfma_f32_16x16x32_bf16 v[76:79], a[200:203], a[184:187], v[76:79]
 s_waitcnt vmcnt(15)
 v_mfma_f32_16x16x32_bf16 v[108:111], a[208:211], a[184:187], v[108:111]
 v_mfma_f32_16x16x32_bf16 v[108:111], a[212:215], a[188:191], v[108:111]
 buffer_load_dwordx4 a[200:203], v0, s[12:15], s24 offen offset:2048
 v_mfma_f32_16x16x32_bf16 v[104:107], a[212:215], a[180:183], v[104:107]
 v_mfma_f32_16x16x32_bf16 v[104:107], a[208:211], a[176:179], v[104:107]
 s_add_u32 s24, s24, 4096
 v_mfma_f32_16x16x32_bf16 v[100:103], a[208:211], a[168:171], v[100:103]
 v_mfma_f32_16x16x32_bf16 v[100:103], a[212:215], a[172:175], v[100:103]
 v_mfma_f32_16x16x32_bf16 v[96:99], a[212:215], a[164:167], v[96:99]
 buffer_store_dwordx4 a[60:63], v3, s[32:35], s68 offen offset:3072 sc1
 v_mfma_f32_16x16x32_bf16 v[96:99], a[208:211], a[160:163], v[96:99]
 v_mfma_f32_16x16x32_bf16 v[92:95], a[208:211], a[152:155], v[92:95]
 v_mfma_f32_16x16x32_bf16 v[92:95], a[212:215], a[156:159], v[92:95]
 v_mfma_f32_16x16x32_bf16 v[88:91], a[212:215], a[148:151], v[88:91]
 v_mfma_f32_16x16x32_bf16 v[88:91], a[208:211], a[144:147], v[88:91]
 v_mfma_f32_16x16x32_bf16 v[84:87], a[208:211], a[136:139], v[84:87]
 v_mfma_f32_16x16x32_bf16 v[84:87], a[212:215], a[140:143], v[84:87]
 v_mfma_f32_16x16x32_bf16 v[80:83], a[212:215], a[132:135], v[80:83]
 buffer_load_dwordx4 a[212:215], v0, s[12:15], s24 offen offset:1024
 v_mfma_f32_16x16x32_bf16 v[80:83], a[208:211], a[128:131], v[80:83]
 s_waitcnt vmcnt(14)
 v_mfma_f32_16x16x32_bf16 v[112:115], a[216:219], a[128:131], v[112:115]
 ds_read_b128 a[128:131], v1
 v_mfma_f32_16x16x32_bf16 v[112:115], a[220:223], a[132:135], v[112:115]
 buffer_load_dwordx4 a[208:211], v0, s[12:15], s24 offen
 ds_read_b128 a[132:135], v1 offset:1024
 v_mfma_f32_16x16x32_bf16 v[116:119], a[220:223], a[140:143], v[116:119]
 ds_read_b128 a[140:143], v1 offset:5120
 v_mfma_f32_16x16x32_bf16 v[116:119], a[216:219], a[136:139], v[116:119]
 ds_read_b128 a[136:139], v1 offset:4096
 v_mfma_f32_16x16x32_bf16 v[120:123], a[216:219], a[144:147], v[120:123]
 ds_read_b128 a[144:147], v1 offset:8192
 v_mfma_f32_16x16x32_bf16 v[120:123], a[220:223], a[148:151], v[120:123]
 ds_read_b128 a[148:151], v1 offset:9216
 v_mfma_f32_16x16x32_bf16 v[124:127], a[220:223], a[156:159], v[124:127]
 ds_read_b128 a[156:159], v1 offset:13312
 v_mfma_f32_16x16x32_bf16 v[124:127], a[216:219], a[152:155], v[124:127]
 ds_read_b128 a[152:155], v1 offset:12288
 v_mfma_f32_16x16x32_bf16 v[128:131], a[216:219], a[160:163], v[128:131]
 ds_read_b128 a[160:163], v1 offset:16384
 v_mfma_f32_16x16x32_bf16 v[128:131], a[220:223], a[164:167], v[128:131]
 ds_read_b128 a[164:167], v1 offset:17408
 v_mfma_f32_16x16x32_bf16 v[132:135], a[220:223], a[172:175], v[132:135]
 ds_read_b128 a[172:175], v1 offset:21504
 v_mfma_f32_16x16x32_bf16 v[132:135], a[216:219], a[168:171], v[132:135]
 ds_read_b128 a[168:171], v1 offset:20480
 v_mfma_f32_16x16x32_bf16 a[240:243], a[216:219], a[176:179], a[240:243]
 ds_read_b128 a[176:179], v1 offset:24576
 v_mfma_f32_16x16x32_bf16 a[240:243], a[220:223], a[180:183], a[240:243]
 ds_read_b128 a[180:183], v1 offset:25600
 v_mfma_f32_16x16x32_bf16 a[244:247], a[220:223], a[188:191], a[244:247]
 buffer_load_dwordx4 a[220:223], v0, s[12:15], s24 offen offset:3072
 ds_read_b128 a[188:191], v1 offset:29696
 v_mfma_f32_16x16x32_bf16 a[244:247], a[216:219], a[184:187], a[244:247]
 buffer_load_dwordx4 a[216:219], v0, s[12:15], s24 offen offset:2048
 s_add_u32 s24, s24, 4096
 ds_read_b128 a[184:187], v1 offset:28672
 s_waitcnt vmcnt(14) lgkmcnt(8)
 v_mfma_f32_16x16x32_bf16 v[136:139], a[224:227], a[128:131], v[136:139]
 v_lshrrev_b32 v4, 8, v1
 s_add_u32 s68, s29, 16384
 v_mfma_f32_16x16x32_bf16 v[136:139], a[228:231], a[132:135], v[136:139]
 v_lshl_add_u32 v4, v4, 5, s51
 v_mfma_f32_16x16x32_bf16 v[140:143], a[228:231], a[140:143], v[140:143]
 ds_read_b128 v[8:11], v4
 v_mfma_f32_16x16x32_bf16 v[140:143], a[224:227], a[136:139], v[140:143]
 s_waitcnt lgkmcnt(0)
 v_mfma_f32_16x16x32_bf16 v[144:147], a[224:227], a[144:147], v[144:147]
 v_add_f32 v16, v16, v8
 v_mfma_f32_16x16x32_bf16 v[144:147], a[228:231], a[148:151], v[144:147]
 ds_read_b128 v[12:15], v4 offset:16
 v_add_f32 v17, v17, v9
 v_mfma_f32_16x16x32_bf16 v[148:151], a[228:231], a[156:159], v[148:151]
 buffer_store_dwordx4 a[64:67], v3, s[32:35], s68 offen sc1
 v_mfma_f32_16x16x32_bf16 v[148:151], a[224:227], a[152:155], v[148:151]
 v_mfma_f32_16x16x32_bf16 v[152:155], a[224:227], a[160:163], v[152:155]
 v_add_f32 v18, v18, v10
 v_mfma_f32_16x16x32_bf16 v[152:155], a[228:231], a[164:167], v[152:155]
 v_add_f32 v19, v19, v11
 v_mfma_f32_16x16x32_bf16 v[156:159], a[228:231], a[172:175], v[156:159]
 v_add_f32 v20, v20, v8
 v_mfma_f32_16x16x32_bf16 v[156:159], a[224:227], a[168:171], v[156:159]
 v_add_f32 v21, v21, v9
 v_add_f32 v22, v22, v10
 v_mfma_f32_16x16x32_bf16 v[160:163], a[224:227], a[176:179], v[160:163]
 v_add_f32 v23, v23, v11
 v_mfma_f32_16x16x32_bf16 v[160:163], a[228:231], a[180:183], v[160:163]
 v_add_f32 v24, v24, v8
 v_mfma_f32_16x16x32_bf16 v[164:167], a[228:231], a[188:191], v[164:167]
 buffer_load_dwordx4 a[228:231], v0, s[12:15], s24 offen offset:1024
 v_mfma_f32_16x16x32_bf16 v[164:167], a[224:227], a[184:187], v[164:167]
 s_waitcnt vmcnt(14)
 v_mfma_f32_16x16x32_bf16 v[196:199], a[232:235], a[184:187], v[196:199]
 buffer_store_dwordx4 a[96:99], v3, s[32:35], s68 offen offset:1024 sc1
 v_mfma_f32_16x16x32_bf16 v[196:199], a[236:239], a[188:191], v[196:199]
 v_add_f32 v25, v25, v9
 buffer_load_dwordx4 a[224:227], v0, s[12:15], s24 offen
 v_mfma_f32_16x16x32_bf16 v[192:195], a[236:239], a[180:183], v[192:195]
 s_add_u32 s31, s31, 1
 v_mfma_f32_16x16x32_bf16 v[192:195], a[232:235], a[176:179], v[192:195]
 s_waitcnt vmcnt(8)
 v_mfma_f32_16x16x32_bf16 v[188:191], a[232:235], a[168:171], v[188:191]
 v_mov_b32 v7, s31
 v_mfma_f32_16x16x32_bf16 v[188:191], a[236:239], a[172:175], v[188:191]
 buffer_store_dword v7, v1, s[60:63], 0 offen sc1
 v_mfma_f32_16x16x32_bf16 v[184:187], a[236:239], a[164:167], v[184:187]
 v_add_f32 v26, v26, v10
 v_add_f32 v27, v27, v11
 v_mfma_f32_16x16x32_bf16 v[184:187], a[232:235], a[160:163], v[184:187]
 v_add_f32 v28, v28, v8
 v_mfma_f32_16x16x32_bf16 v[180:183], a[232:235], a[152:155], v[180:183]
 buffer_store_dwordx4 a[68:71], v3, s[32:35], s68 offen offset:2048 sc1
 v_mfma_f32_16x16x32_bf16 v[180:183], a[236:239], a[156:159], v[180:183]
 v_add_f32 v29, v29, v9
 v_mfma_f32_16x16x32_bf16 v[176:179], a[236:239], a[148:151], v[176:179]
 v_add_f32 v30, v30, v10
 v_mfma_f32_16x16x32_bf16 v[176:179], a[232:235], a[144:147], v[176:179]
 v_add_f32 v31, v31, v11
 v_mfma_f32_16x16x32_bf16 v[172:175], a[232:235], a[136:139], v[172:175]
 v_add_f32 v32, v32, v8
 v_add_f32 v33, v33, v9
 v_mfma_f32_16x16x32_bf16 v[172:175], a[236:239], a[140:143], v[172:175]
 v_add_f32 v34, v34, v10
 v_mfma_f32_16x16x32_bf16 v[168:171], a[236:239], a[132:135], v[168:171]
 buffer_load_dwordx4 a[236:239], v0, s[12:15], s24 offen offset:3072
 v_mfma_f32_16x16x32_bf16 v[168:171], a[232:235], a[128:131], v[168:171]
 v_mfma_f32_16x16x32_bf16 v[200:203], a[192:195], a[128:131], v[200:203]
 v_add_f32 v35, v35, v11
 v_mfma_f32_16x16x32_bf16 v[200:203], a[196:199], a[132:135], v[200:203]
 buffer_load_dwordx4 a[232:235], v0, s[12:15], s24 offen offset:2048
 v_mfma_f32_16x16x32_bf16 v[204:207], a[196:199], a[140:143], v[204:207]
 v_add_f32 v36, v36, v8
 buffer_store_dwordx4 a[100:103], v3, s[32:35], s68 offen offset:3072 sc1
 v_mfma_f32_16x16x32_bf16 v[204:207], a[192:195], a[136:139], v[204:207]
 s_add_u32 s24, s24, 4096
 v_mfma_f32_16x16x32_bf16 v[208:211], a[192:195], a[144:147], v[208:211]
 v_add_f32 v37, v37, v9
 v_mfma_f32_16x16x32_bf16 v[208:211], a[196:199], a[148:151], v[208:211]
 v_add_f32 v38, v38, v10
 v_mfma_f32_16x16x32_bf16 v[212:215], a[196:199], a[156:159], v[212:215]
 v_add_f32 v39, v39, v11
 v_mfma_f32_16x16x32_bf16 v[212:215], a[192:195], a[152:155], v[212:215]
 v_add_f32 v40, v40, v8
 v_add_f32 v41, v41, v9
 v_mfma_f32_16x16x32_bf16 v[216:219], a[192:195], a[160:163], v[216:219]
 v_add_f32 v42, v42, v10
 v_mfma_f32_16x16x32_bf16 v[216:219], a[196:199], a[164:167], v[216:219]
 s_add_u32 s68, s29, 20480
 v_mfma_f32_16x16x32_bf16 v[220:223], a[196:199], a[172:175], v[220:223]
 v_add_f32 v43, v43, v11
 v_mfma_f32_16x16x32_bf16 v[220:223], a[192:195], a[168:171], v[220:223]
 v_add_f32 v44, v44, v8
 v_mfma_f32_16x16x32_bf16 v[224:227], a[192:195], a[176:179], v[224:227]
 v_add_f32 v45, v45, v9
 v_mfma_f32_16x16x32_bf16 v[224:227], a[196:199], a[180:183], v[224:227]
 v_add_f32 v46, v46, v10
 v_add_f32 v47, v47, v11
 v_mfma_f32_16x16x32_bf16 v[228:231], a[196:199], a[188:191], v[228:231]
 buffer_load_dwordx4 a[196:199], v0, s[12:15], s24 offen offset:1024
 v_mfma_f32_16x16x32_bf16 v[228:231], a[192:195], a[184:187], v[228:231]
 v_mfma_f32_16x16x32_bf16 a[252:255], a[200:203], a[184:187], a[252:255]
 ds_read_b128 a[184:187], v1 offset:61440
 v_mfma_f32_16x16x32_bf16 a[252:255], a[204:207], a[188:191], a[252:255]
 buffer_load_dwordx4 a[192:195], v0, s[12:15], s24 offen
 ds_read_b128 a[188:191], v1 offset:62464
 v_mfma_f32_16x16x32_bf16 a[248:251], a[204:207], a[180:183], a[248:251]
 ds_read_b128 a[180:183], v1 offset:58368
 v_mfma_f32_16x16x32_bf16 a[248:251], a[200:203], a[176:179], a[248:251]
 ds_read_b128 a[176:179], v1 offset:57344
 v_mfma_f32_16x16x32_bf16 v[252:255], a[200:203], a[168:171], v[252:255]
 s_waitcnt lgkmcnt(4)
 ds_read_b128 a[168:171], v1 offset:53248
 v_mfma_f32_16x16x32_bf16 v[252:255], a[204:207], a[172:175], v[252:255]
 ds_read_b128 a[172:175], v1 offset:54272
 v_mfma_f32_16x16x32_bf16 v[248:251], a[204:207], a[164:167], v[248:251]
 ds_read_b128 a[164:167], v1 offset:50176
 v_mfma_f32_16x16x32_bf16 v[248:251], a[200:203], a[160:163], v[248:251]
 ds_read_b128 a[160:163], v1 offset:49152
 v_mfma_f32_16x16x32_bf16 v[244:247], a[200:203], a[152:155], v[244:247]
 ds_read_b128 a[152:155], v1 offset:45056
 v_mfma_f32_16x16x32_bf16 v[244:247], a[204:207], a[156:159], v[244:247]
 ds_read_b128 a[156:159], v1 offset:46080
 v_mfma_f32_16x16x32_bf16 v[240:243], a[204:207], a[148:151], v[240:243]
 v_add_f32 v48, v48, v12
 ds_read_b128 a[148:151], v1 offset:41984
 v_mfma_f32_16x16x32_bf16 v[240:243], a[200:203], a[144:147], v[240:243]
 ds_read_b128 a[144:147], v1 offset:40960
 v_mfma_f32_16x16x32_bf16 v[236:239], a[200:203], a[136:139], v[236:239]
 ds_read_b128 a[136:139], v1 offset:36864
 v_mfma_f32_16x16x32_bf16 v[236:239], a[204:207], a[140:143], v[236:239]
 ds_read_b128 a[140:143], v1 offset:37888
 v_mfma_f32_16x16x32_bf16 v[232:235], a[204:207], a[132:135], v[232:235]
 ds_read_b128 a[132:135], v1 offset:33792
 v_mfma_f32_16x16x32_bf16 v[232:235], a[200:203], a[128:131], v[232:235]
 ds_read_b128 a[128:131], v1 offset:32768
 s_waitcnt vmcnt(13) lgkmcnt(8)
 v_mfma_f32_16x16x32_bf16 v[164:167], a[208:211], a[184:187], v[164:167]
 ds_read_b128 v[8:11], v4 offset:128
 v_add_f32 v49, v49, v13
 v_mfma_f32_16x16x32_bf16 v[164:167], a[212:215], a[188:191], v[164:167]
 buffer_load_dwordx4 a[204:207], v0, s[12:15], s24 offen offset:3072
 v_mfma_f32_16x16x32_bf16 v[160:163], a[212:215], a[180:183], v[160:163]
 v_add_f32 v50, v50, v14
 v_mfma_f32_16x16x32_bf16 v[160:163], a[208:211], a[176:179], v[160:163]
 buffer_load_dwordx4 a[200:203], v0, s[12:15], s24 offen offset:2048
 v_mfma_f32_16x16x32_bf16 v[156:159], a[208:211], a[168:171], v[156:159]
 s_add_u32 s24, s24, 4096
 v_mfma_f32_16x16x32_bf16 v[156:159], a[212:215], a[172:175], v[156:159]
 buffer_store_dwordx4 a[72:75], v3, s[32:35], s68 offen sc1
 v_mfma_f32_16x16x32_bf16 v[152:155], a[212:215], a[164:167], v[152:155]
 v_add_f32 v51, v51, v15
 v_add_f32 v52, v52, v12
 v_mfma_f32_16x16x32_bf16 v[152:155], a[208:211], a[160:163], v[152:155]
 s_waitcnt lgkmcnt(1)
 v_mfma_f32_16x16x32_bf16 v[148:151], a[208:211], a[152:155], v[148:151]
 v_add_f32 v53, v53, v13
 v_mfma_f32_16x16x32_bf16 v[148:151], a[212:215], a[156:159], v[148:151]
 v_add_f32 v54, v54, v14
 v_mfma_f32_16x16x32_bf16 v[144:147], a[212:215], a[148:151], v[144:147]
 v_add_f32 v55, v55, v15
 v_mfma_f32_16x16x32_bf16 v[144:147], a[208:211], a[144:147], v[144:147]
 v_add_f32 v56, v56, v12
 v_mfma_f32_16x16x32_bf16 v[140:143], a[208:211], a[136:139], v[140:143]
 v_add_f32 v57, v57, v13
 v_add_f32 v58, v58, v14
 v_mfma_f32_16x16x32_bf16 v[140:143], a[212:215], a[140:143], v[140:143]
 buffer_store_dwordx4 a[104:107], v3, s[32:35], s68 offen offset:1024 sc1
 v_mfma_f32_16x16x32_bf16 v[136:139], a[212:215], a[132:135], v[136:139]
 buffer_load_dwordx4 a[212:215], v0, s[12:15], s24 offen offset:1024
 v_mfma_f32_16x16x32_bf16 v[136:139], a[208:211], a[128:131], v[136:139]
 s_waitcnt vmcnt(16)
 v_mfma_f32_16x16x32_bf16 v[168:171], a[216:219], a[128:131], v[168:171]
 v_add_f32 v59, v59, v15
 v_mfma_f32_16x16x32_bf16 v[168:171], a[220:223], a[132:135], v[168:171]
 v_add_f32 v60, v60, v12
 buffer_load_dwordx4 a[208:211], v0, s[12:15], s24 offen
 v_mfma_f32_16x16x32_bf16 v[172:175], a[220:223], a[140:143], v[172:175]
 v_add_f32 v61, v61, v13
 v_mfma_f32_16x16x32_bf16 v[172:175], a[216:219], a[136:139], v[172:175]
 v_add_f32 v62, v62, v14
 v_mfma_f32_16x16x32_bf16 v[176:179], a[216:219], a[144:147], v[176:179]
 v_add_f32 v63, v63, v15
 v_mfma_f32_16x16x32_bf16 v[176:179], a[220:223], a[148:151], v[176:179]
 v_add_f32 v64, v64, v12
 v_mfma_f32_16x16x32_bf16 v[180:183], a[220:223], a[156:159], v[180:183]
 v_add_f32 v65, v65, v13
 v_mfma_f32_16x16x32_bf16 v[180:183], a[216:219], a[152:155], v[180:183]
 v_add_f32 v66, v66, v14
 buffer_store_dwordx4 a[76:79], v3, s[32:35], s68 offen offset:2048 sc1
 v_mfma_f32_16x16x32_bf16 v[184:187], a[216:219], a[160:163], v[184:187]
 v_add_f32 v67, v67, v15
 v_mfma_f32_16x16x32_bf16 v[184:187], a[220:223], a[164:167], v[184:187]
 v_add_f32 v68, v68, v12
 v_mfma_f32_16x16x32_bf16 v[188:191], a[220:223], a[172:175], v[188:191]
 v_add_f32 v69, v69, v13
 v_mfma_f32_16x16x32_bf16 v[188:191], a[216:219], a[168:171], v[188:191]
 v_add_f32 v70, v70, v14
 v_mfma_f32_16x16x32_bf16 v[192:195], a[216:219], a[176:179], v[192:195]
 v_add_f32 v71, v71, v15
 v_mfma_f32_16x16x32_bf16 v[192:195], a[220:223], a[180:183], v[192:195]
 v_add_f32 v72, v72, v12
 buffer_store_dwordx4 a[108:111], v3, s[32:35], s68 offen offset:3072 sc1
 v_mfma_f32_16x16x32_bf16 v[196:199], a[220:223], a[188:191], v[196:199]
 buffer_load_dwordx4 a[220:223], v0, s[12:15], s24 offen offset:3072
 v_mfma_f32_16x16x32_bf16 v[196:199], a[216:219], a[184:187], v[196:199]
 s_waitcnt vmcnt(16)
 v_mfma_f32_16x16x32_bf16 v[228:231], a[224:227], a[184:187], v[228:231]
 v_add_f32 v73, v73, v13
 v_mfma_f32_16x16x32_bf16 v[228:231], a[228:231], a[188:191], v[228:231]
 buffer_load_dwordx4 a[216:219], v0, s[12:15], s24 offen offset:2048
 v_mfma_f32_16x16x32_bf16 v[224:227], a[228:231], a[180:183], v[224:227]
 v_add_f32 v74, v74, v14
 v_add_f32 v75, v75, v15
 v_mfma_f32_16x16x32_bf16 v[224:227], a[224:227], a[176:179], v[224:227]
 s_add_u32 s24, s24, 4096
 v_mfma_f32_16x16x32_bf16 v[220:223], a[224:227], a[168:171], v[220:223]
 v_add_f32 v76, v76, v12
 v_mfma_f32_16x16x32_bf16 v[220:223], a[228:231], a[172:175], v[220:223]
 v_add_f32 v77, v77, v13
 v_mfma_f32_16x16x32_bf16 v[216:219], a[228:231], a[164:167], v[216:219]
 v_add_f32 v78, v78, v14
 v_mfma_f32_16x16x32_bf16 v[216:219], a[224:227], a[160:163], v[216:219]
 v_add_f32 v79, v79, v15
 v_mfma_f32_16x16x32_bf16 v[212:215], a[224:227], a[152:155], v[212:215]
 s_waitcnt lgkmcnt(0)
 s_add_u32 s68, s29, 24576
 v_mfma_f32_16x16x32_bf16 v[212:215], a[228:231], a[156:159], v[212:215]
 v_add_f32 v80, v80, v8
 v_mfma_f32_16x16x32_bf16 v[208:211], a[228:231], a[148:151], v[208:211]
 ds_read_b128 v[12:15], v4 offset:144
 v_mfma_f32_16x16x32_bf16 v[208:211], a[224:227], a[144:147], v[208:211]
 v_add_f32 v81, v81, v9
 v_mfma_f32_16x16x32_bf16 v[204:207], a[224:227], a[136:139], v[204:207]
 v_add_f32 v82, v82, v10
 v_mfma_f32_16x16x32_bf16 v[204:207], a[228:231], a[140:143], v[204:207]
 v_add_f32 v83, v83, v11
 v_mfma_f32_16x16x32_bf16 v[200:203], a[228:231], a[132:135], v[200:203]
 v_add_f32 v84, v84, v8
 buffer_load_dwordx4 a[228:231], v0, s[12:15], s24 offen offset:1024
 v_mfma_f32_16x16x32_bf16 v[200:203], a[224:227], a[128:131], v[200:203]
 s_waitcnt vmcnt(14)
 v_mfma_f32_16x16x32_bf16 v[232:235], a[232:235], a[128:131], v[232:235]
 ds_read_b128 a[128:131], v2
 v_mfma_f32_16x16x32_bf16 v[232:235], a[236:239], a[132:135], v[232:235]
 buffer_load_dwordx4 a[224:227], v0, s[12:15], s24 offen
 ds_read_b128 a[132:135], v2 offset:1024
 v_mfma_f32_16x16x32_bf16 v[236:239], a[236:239], a[140:143], v[236:239]
 ds_read_b128 a[140:143], v2 offset:5120
 v_mfma_f32_16x16x32_bf16 v[236:239], a[232:235], a[136:139], v[236:239]
 ds_read_b128 a[136:139], v2 offset:4096
 v_mfma_f32_16x16x32_bf16 v[240:243], a[232:235], a[144:147], v[240:243]
 ds_read_b128 a[144:147], v2 offset:8192
 v_mfma_f32_16x16x32_bf16 v[240:243], a[236:239], a[148:151], v[240:243]
 v_add_f32 v85, v85, v9
 ds_read_b128 a[148:151], v2 offset:9216
 v_mfma_f32_16x16x32_bf16 v[244:247], a[236:239], a[156:159], v[244:247]
 ds_read_b128 a[156:159], v2 offset:13312
 v_mfma_f32_16x16x32_bf16 v[244:247], a[232:235], a[152:155], v[244:247]
 ds_read_b128 a[152:155], v2 offset:12288
 v_mfma_f32_16x16x32_bf16 v[248:251], a[232:235], a[160:163], v[248:251]
 ds_read_b128 a[160:163], v2 offset:16384
 v_mfma_f32_16x16x32_bf16 v[248:251], a[236:239], a[164:167], v[248:251]
 ds_read_b128 a[164:167], v2 offset:17408
 v_mfma_f32_16x16x32_bf16 v[252:255], a[236:239], a[172:175], v[252:255]
 v_add_f32 v86, v86, v10
 ds_read_b128 a[172:175], v2 offset:21504
 v_mfma_f32_16x16x32_bf16 v[252:255], a[232:235], a[168:171], v[252:255]
 ds_read_b128 a[168:171], v2 offset:20480
 v_mfma_f32_16x16x32_bf16 a[248:251], a[232:235], a[176:179], a[248:251]
 ds_read_b128 a[176:179], v2 offset:24576
 v_mfma_f32_16x16x32_bf16 a[248:251], a[236:239], a[180:183], a[248:251]
 ds_read_b128 a[180:183], v2 offset:25600
 v_mfma_f32_16x16x32_bf16 a[252:255], a[236:239], a[188:191], a[252:255]
 ds_read_b128 a[188:191], v2 offset:29696
 v_mfma_f32_16x16x32_bf16 a[252:255], a[232:235], a[184:187], a[252:255]
 ds_read_b128 a[184:187], v2 offset:28672
 s_waitcnt vmcnt(12) lgkmcnt(8)
 v_mfma_f32_16x16x32_bf16 v[136:139], a[192:195], a[128:131], v[136:139]
 v_add_f32 v87, v87, v11
 v_mfma_f32_16x16x32_bf16 v[136:139], a[196:199], a[132:135], v[136:139]
 v_add_f32 v88, v88, v8
 buffer_load_dwordx4 a[236:239], v0, s[12:15], s24 offen offset:3072
 v_mfma_f32_16x16x32_bf16 v[140:143], a[196:199], a[140:143], v[140:143]
 buffer_store_dwordx4 a[80:83], v3, s[32:35], s68 offen sc1
 v_mfma_f32_16x16x32_bf16 v[140:143], a[192:195], a[136:139], v[140:143]
 buffer_load_dwordx4 a[232:235], v0, s[12:15], s24 offen offset:2048
 v_mfma_f32_16x16x32_bf16 v[144:147], a[192:195], a[144:147], v[144:147]
 s_add_u32 s24, s24, 4096
 v_mfma_f32_16x16x32_bf16 v[144:147], a[196:199], a[148:151], v[144:147]
 v_add_f32 v89, v89, v9
 v_mfma_f32_16x16x32_bf16 v[148:151], a[196:199], a[156:159], v[148:151]
 v_add_f32 v90, v90, v10
 v_mfma_f32_16x16x32_bf16 v[148:151], a[192:195], a[152:155], v[148:151]
 v_add_f32 v91, v91, v11
 s_waitcnt lgkmcnt(0)
 v_mfma_f32_16x16x32_bf16 v[152:155], a[192:195], a[160:163], v[152:155]
 v_add_f32 v92, v92, v8
 v_mfma_f32_16x16x32_bf16 v[152:155], a[196:199], a[164:167], v[152:155]
 v_add_f32 v93, v93, v9
 v_mfma_f32_16x16x32_bf16 v[156:159], a[196:199], a[172:175], v[156:159]
 v_add_f32 v94, v94, v10
 v_mfma_f32_16x16x32_bf16 v[156:159], a[192:195], a[168:171], v[156:159]
 v_add_f32 v95, v95, v11
 v_mfma_f32_16x16x32_bf16 v[160:163], a[192:195], a[176:179], v[160:163]
 v_add_f32 v96, v96, v8
 buffer_store_dwordx4 a[112:115], v3, s[32:35], s68 offen offset:1024 sc1
 v_mfma_f32_16x16x32_bf16 v[160:163], a[196:199], a[180:183], v[160:163]
 v_add_f32 v97, v97, v9
 v_mfma_f32_16x16x32_bf16 v[164:167], a[196:199], a[188:191], v[164:167]
 buffer_load_dwordx4 a[196:199], v0, s[12:15], s24 offen offset:1024
 v_mfma_f32_16x16x32_bf16 v[164:167], a[192:195], a[184:187], v[164:167]
 s_waitcnt vmcnt(15)
 v_mfma_f32_16x16x32_bf16 v[196:199], a[200:203], a[184:187], v[196:199]
 v_add_f32 v98, v98, v10
 v_mfma_f32_16x16x32_bf16 v[196:199], a[204:207], a[188:191], v[196:199]
 buffer_load_dwordx4 a[192:195], v0, s[12:15], s24 offen
 v_mfma_f32_16x16x32_bf16 v[192:195], a[204:207], a[180:183], v[192:195]
 v_add_f32 v99, v99, v11
 v_add_f32 v100, v100, v8
 v_mfma_f32_16x16x32_bf16 v[192:195], a[200:203], a[176:179], v[192:195]
 v_add_f32 v101, v101, v9
 v_mfma_f32_16x16x32_bf16 v[188:191], a[200:203], a[168:171], v[188:191]
 v_add_f32 v102, v102, v10
 v_mfma_f32_16x16x32_bf16 v[188:191], a[204:207], a[172:175], v[188:191]
 buffer_store_dwordx4 a[84:87], v3, s[32:35], s68 offen offset:2048 sc1
 v_mfma_f32_16x16x32_bf16 v[184:187], a[204:207], a[164:167], v[184:187]
 v_add_f32 v103, v103, v11
 v_mfma_f32_16x16x32_bf16 v[184:187], a[200:203], a[160:163], v[184:187]
 v_add_f32 v104, v104, v8
 v_mfma_f32_16x16x32_bf16 v[180:183], a[200:203], a[152:155], v[180:183]
 v_add_f32 v105, v105, v9
 v_add_f32 v106, v106, v10
 v_mfma_f32_16x16x32_bf16 v[180:183], a[204:207], a[156:159], v[180:183]
 v_add_f32 v107, v107, v11
 v_mfma_f32_16x16x32_bf16 v[176:179], a[204:207], a[148:151], v[176:179]
 v_add_f32 v108, v108, v8
 v_mfma_f32_16x16x32_bf16 v[176:179], a[200:203], a[144:147], v[176:179]
 v_add_f32 v109, v109, v9
 v_mfma_f32_16x16x32_bf16 v[172:175], a[200:203], a[136:139], v[172:175]
 buffer_store_dwordx4 a[116:119], v3, s[32:35], s68 offen offset:3072 sc1
 v_mfma_f32_16x16x32_bf16 v[172:175], a[204:207], a[140:143], v[172:175]
 v_add_f32 v110, v110, v10
 v_add_f32 v111, v111, v11
 v_mfma_f32_16x16x32_bf16 v[168:171], a[204:207], a[132:135], v[168:171]
 buffer_load_dwordx4 a[204:207], v0, s[12:15], s24 offen offset:3072
 v_mfma_f32_16x16x32_bf16 v[168:171], a[200:203], a[128:131], v[168:171]
 s_waitcnt vmcnt(15)
 v_mfma_f32_16x16x32_bf16 v[200:203], a[208:211], a[128:131], v[200:203]
 v_mfma_f32_16x16x32_bf16 v[200:203], a[212:215], a[132:135], v[200:203]
 buffer_load_dwordx4 a[200:203], v0, s[12:15], s24 offen offset:2048
 v_mfma_f32_16x16x32_bf16 v[204:207], a[212:215], a[140:143], v[204:207]
 v_add_f32 v112, v112, v12
 v_mfma_f32_16x16x32_bf16 v[204:207], a[208:211], a[136:139], v[204:207]
 buffer_load_dword v4, off, s[64:67], 0 sc1
 s_add_u32 s24, s24, 4096
 v_mfma_f32_16x16x32_bf16 v[208:211], a[208:211], a[144:147], v[208:211]
 v_add_f32 v113, v113, v13
 v_mfma_f32_16x16x32_bf16 v[208:211], a[212:215], a[148:151], v[208:211]
 v_add_f32 v114, v114, v14
 v_mfma_f32_16x16x32_bf16 v[212:215], a[212:215], a[156:159], v[212:215]
 v_add_f32 v115, v115, v15
 v_mfma_f32_16x16x32_bf16 v[212:215], a[208:211], a[152:155], v[212:215]
 s_add_u32 s68, s29, 28672
 v_mfma_f32_16x16x32_bf16 v[216:219], a[208:211], a[160:163], v[216:219]
 v_add_f32 v116, v116, v12
 v_mfma_f32_16x16x32_bf16 v[216:219], a[212:215], a[164:167], v[216:219]
 v_add_f32 v117, v117, v13
 v_add_f32 v118, v118, v14
 v_mfma_f32_16x16x32_bf16 v[220:223], a[212:215], a[172:175], v[220:223]
 v_add_f32 v119, v119, v15
 v_mfma_f32_16x16x32_bf16 v[220:223], a[208:211], a[168:171], v[220:223]
 v_add_f32 v120, v120, v12
 v_mfma_f32_16x16x32_bf16 v[224:227], a[208:211], a[176:179], v[224:227]
 v_add_f32 v121, v121, v13
 v_mfma_f32_16x16x32_bf16 v[224:227], a[212:215], a[180:183], v[224:227]
 v_add_f32 v122, v122, v14
 v_mfma_f32_16x16x32_bf16 v[228:231], a[212:215], a[188:191], v[228:231]
 buffer_load_dwordx4 a[212:215], v0, s[12:15], s24 offen offset:1024
 v_mfma_f32_16x16x32_bf16 v[228:231], a[208:211], a[184:187], v[228:231]
 v_add_f32 v123, v123, v15
 s_waitcnt vmcnt(14)
 v_mfma_f32_16x16x32_bf16 a[252:255], a[216:219], a[184:187], a[252:255]
 ds_read_b128 a[184:187], v2 offset:61440
 v_mfma_f32_16x16x32_bf16 a[252:255], a[220:223], a[188:191], a[252:255]
 buffer_load_dwordx4 a[208:211], v0, s[12:15], s24 offen
 ds_read_b128 a[188:191], v2 offset:62464
 v_mfma_f32_16x16x32_bf16 a[248:251], a[220:223], a[180:183], a[248:251]
 ds_read_b128 a[180:183], v2 offset:58368
 v_mfma_f32_16x16x32_bf16 a[248:251], a[216:219], a[176:179], a[248:251]
 ds_read_b128 a[176:179], v2 offset:57344
 v_mfma_f32_16x16x32_bf16 v[252:255], a[216:219], a[168:171], v[252:255]
 ds_read_b128 a[168:171], v2 offset:53248
 v_mfma_f32_16x16x32_bf16 v[252:255], a[220:223], a[172:175], v[252:255]
 v_add_f32 v124, v124, v12
 ds_read_b128 a[172:175], v2 offset:54272
 v_mfma_f32_16x16x32_bf16 v[248:251], a[220:223], a[164:167], v[248:251]
 ds_read_b128 a[164:167], v2 offset:50176
 v_mfma_f32_16x16x32_bf16 v[248:251], a[216:219], a[160:163], v[248:251]
 ds_read_b128 a[160:163], v2 offset:49152
 v_mfma_f32_16x16x32_bf16 v[244:247], a[216:219], a[152:155], v[244:247]
 ds_read_b128 a[152:155], v2 offset:45056
 v_mfma_f32_16x16x32_bf16 v[244:247], a[220:223], a[156:159], v[244:247]
 ds_read_b128 a[156:159], v2 offset:46080
 v_mfma_f32_16x16x32_bf16 v[240:243], a[220:223], a[148:151], v[240:243]
 ds_read_b128 a[148:151], v2 offset:41984
 v_mfma_f32_16x16x32_bf16 v[240:243], a[216:219], a[144:147], v[240:243]
 v_add_f32 v125, v125, v13
 ds_read_b128 a[144:147], v2 offset:40960
 v_mfma_f32_16x16x32_bf16 v[236:239], a[216:219], a[136:139], v[236:239]
 ds_read_b128 a[136:139], v2 offset:36864
 v_mfma_f32_16x16x32_bf16 v[236:239], a[220:223], a[140:143], v[236:239]
 ds_read_b128 a[140:143], v2 offset:37888
 v_mfma_f32_16x16x32_bf16 v[232:235], a[220:223], a[132:135], v[232:235]
 ds_read_b128 a[132:135], v2 offset:33792
 v_mfma_f32_16x16x32_bf16 v[232:235], a[216:219], a[128:131], v[232:235]
 ds_read_b128 a[128:131], v2 offset:32768
 s_waitcnt vmcnt(13) lgkmcnt(8)
 v_mfma_f32_16x16x32_bf16 v[164:167], a[224:227], a[184:187], v[164:167]
 buffer_store_dwordx4 a[88:91], v3, s[32:35], s68 offen sc1
 v_mfma_f32_16x16x32_bf16 v[164:167], a[228:231], a[188:191], v[164:167]
 buffer_load_dwordx4 a[220:223], v0, s[12:15], s24 offen offset:3072
 v_mfma_f32_16x16x32_bf16 v[160:163], a[228:231], a[180:183], v[160:163]
 v_add_f32 v126, v126, v14
 v_add_f32 v127, v127, v15
 v_mfma_f32_16x16x32_bf16 v[160:163], a[224:227], a[176:179], v[160:163]
 buffer_load_dwordx4 a[216:219], v0, s[12:15], s24 offen offset:2048
 v_mfma_f32_16x16x32_bf16 v[156:159], a[224:227], a[168:171], v[156:159]
 s_add_u32 s24, s24, 4096
 v_mfma_f32_16x16x32_bf16 v[156:159], a[228:231], a[172:175], v[156:159]
 v_add_f32 v128, v128, v12
 v_mfma_f32_16x16x32_bf16 v[152:155], a[228:231], a[164:167], v[152:155]
 v_add_f32 v129, v129, v13
 v_mfma_f32_16x16x32_bf16 v[152:155], a[224:227], a[160:163], v[152:155]
 v_add_f32 v130, v130, v14
 s_waitcnt lgkmcnt(0)
 v_mfma_f32_16x16x32_bf16 v[148:151], a[224:227], a[152:155], v[148:151]
 v_add_f32 v131, v131, v15
 v_mfma_f32_16x16x32_bf16 v[148:151], a[228:231], a[156:159], v[148:151]
 v_add_f32 v132, v132, v12
 v_mfma_f32_16x16x32_bf16 v[144:147], a[228:231], a[148:151], v[144:147]
 buffer_store_dwordx4 a[120:123], v3, s[32:35], s68 offen offset:1024 sc1
 v_mfma_f32_16x16x32_bf16 v[144:147], a[224:227], a[144:147], v[144:147]
 v_add_f32 v133, v133, v13
 v_mfma_f32_16x16x32_bf16 v[140:143], a[224:227], a[136:139], v[140:143]
 v_add_f32 v134, v134, v14
 v_mfma_f32_16x16x32_bf16 v[140:143], a[228:231], a[140:143], v[140:143]
 v_add_f32 v135, v135, v15
 v_accvgpr_read_b32 v5, a240
 v_mfma_f32_16x16x32_bf16 v[136:139], a[228:231], a[132:135], v[136:139]
 buffer_load_dwordx4 a[228:231], v0, s[12:15], s24 offen offset:1024
 v_mfma_f32_16x16x32_bf16 v[136:139], a[224:227], a[128:131], v[136:139]
 s_waitcnt vmcnt(15)
 v_mfma_f32_16x16x32_bf16 v[168:171], a[232:235], a[128:131], v[168:171]
 v_add_f32 v5, v5, v12
 v_mfma_f32_16x16x32_bf16 v[168:171], a[236:239], a[132:135], v[168:171]
 buffer_load_dwordx4 a[224:227], v0, s[12:15], s24 offen
 v_mfma_f32_16x16x32_bf16 v[172:175], a[236:239], a[140:143], v[172:175]
 v_accvgpr_write_b32 a240, v5
 v_mfma_f32_16x16x32_bf16 v[172:175], a[232:235], a[136:139], v[172:175]
 v_accvgpr_read_b32 v6, a241
 v_add_f32 v6, v6, v13
 v_mfma_f32_16x16x32_bf16 v[176:179], a[232:235], a[144:147], v[176:179]
 buffer_store_dwordx4 a[92:95], v3, s[32:35], s68 offen offset:2048 sc1
 v_mfma_f32_16x16x32_bf16 v[176:179], a[236:239], a[148:151], v[176:179]
 v_accvgpr_write_b32 a241, v6
 v_mfma_f32_16x16x32_bf16 v[180:183], a[236:239], a[156:159], v[180:183]
 v_accvgpr_read_b32 v5, a242
 v_mfma_f32_16x16x32_bf16 v[180:183], a[232:235], a[152:155], v[180:183]
 v_add_f32 v5, v5, v14
 v_mfma_f32_16x16x32_bf16 v[184:187], a[232:235], a[160:163], v[184:187]
 v_accvgpr_write_b32 a242, v5
 v_accvgpr_read_b32 v6, a243
 v_mfma_f32_16x16x32_bf16 v[184:187], a[236:239], a[164:167], v[184:187]
 v_add_f32 v6, v6, v15
 v_mfma_f32_16x16x32_bf16 v[188:191], a[236:239], a[172:175], v[188:191]
 v_accvgpr_write_b32 a243, v6
 v_mfma_f32_16x16x32_bf16 v[188:191], a[232:235], a[168:171], v[188:191]
 buffer_store_dwordx4 a[124:127], v3, s[32:35], s68 offen offset:3072 sc1
 v_mfma_f32_16x16x32_bf16 v[192:195], a[232:235], a[176:179], v[192:195]
 v_accvgpr_read_b32 v5, a244
 v_mfma_f32_16x16x32_bf16 v[192:195], a[236:239], a[180:183], v[192:195]
 v_add_f32 v5, v5, v12
 v_mfma_f32_16x16x32_bf16 v[196:199], a[236:239], a[188:191], v[196:199]
 v_accvgpr_write_b32 a244, v5
 buffer_load_dwordx4 a[236:239], v0, s[12:15], s24 offen offset:3072
 v_mfma_f32_16x16x32_bf16 v[196:199], a[232:235], a[184:187], v[196:199]
 s_waitcnt vmcnt(16)
 v_mfma_f32_16x16x32_bf16 v[228:231], a[192:195], a[184:187], v[228:231]
 v_accvgpr_read_b32 v6, a245
 v_mfma_f32_16x16x32_bf16 v[228:231], a[196:199], a[188:191], v[228:231]
 buffer_load_dwordx4 a[232:235], v0, s[12:15], s24 offen offset:2048
 v_mfma_f32_16x16x32_bf16 v[224:227], a[196:199], a[180:183], v[224:227]
 v_add_f32 v6, v6, v13
 v_mfma_f32_16x16x32_bf16 v[224:227], a[192:195], a[176:179], v[224:227]
 s_add_u32 s24, s24, 4096
 v_mfma_f32_16x16x32_bf16 v[220:223], a[192:195], a[168:171], v[220:223]
 v_accvgpr_write_b32 a245, v6
 v_accvgpr_read_b32 v5, a246
 v_mfma_f32_16x16x32_bf16 v[220:223], a[196:199], a[172:175], v[220:223]
 v_add_f32 v5, v5, v14
 v_mfma_f32_16x16x32_bf16 v[216:219], a[196:199], a[164:167], v[216:219]
 v_accvgpr_write_b32 a246, v5
 v_mfma_f32_16x16x32_bf16 v[216:219], a[192:195], a[160:163], v[216:219]
 v_accvgpr_read_b32 v6, a247
 v_mfma_f32_16x16x32_bf16 v[212:215], a[192:195], a[152:155], v[212:215]
 v_add_f32 v6, v6, v15
 v_mfma_f32_16x16x32_bf16 v[212:215], a[196:199], a[156:159], v[212:215]
 v_accvgpr_write_b32 a247, v6
 v_mfma_f32_16x16x32_bf16 v[208:211], a[196:199], a[148:151], v[208:211]
 s_waitcnt vmcnt(12)
 v_cmp_gt_u32 vcc, s55, v4
 s_cbranch_vccnz Lspin_pa0
Lok_pa0:
 s_add_u32 s55, s55, 1
 s_waitcnt lgkmcnt(0)
 s_barrier
 v_mfma_f32_16x16x32_bf16 v[208:211], a[192:195], a[144:147], v[208:211]
 v_mfma_f32_16x16x32_bf16 v[204:207], a[192:195], a[136:139], v[204:207]
 v_mfma_f32_16x16x32_bf16 v[204:207], a[196:199], a[140:143], v[204:207]
 v_mfma_f32_16x16x32_bf16 v[200:203], a[196:199], a[132:135], v[200:203]
 buffer_load_dwordx4 a[196:199], v0, s[12:15], s24 offen offset:1024
 v_mfma_f32_16x16x32_bf16 v[200:203], a[192:195], a[128:131], v[200:203]
 v_mfma_f32_16x16x32_bf16 v[232:235], a[200:203], a[128:131], v[232:235]
 ds_read_b128 a[128:131], v1 offset:2048
 v_mfma_f32_16x16x32_bf16 v[232:235], a[204:207], a[132:135], v[232:235]
 buffer_load_dwordx4 a[192:195], v0, s[12:15], s24 offen
 ds_read_b128 a[132:135], v1 offset:3072
 v_mfma_f32_16x16x32_bf16 v[236:239], a[204:207], a[140:143], v[236:239]
 ds_read_b128 a[140:143], v1 offset:7168
 v_mfma_f32_16x16x32_bf16 v[236:239], a[200:203], a[136:139], v[236:239]
 ds_read_b128 a[136:139], v1 offset:6144
 v_mfma_f32_16x16x32_bf16 v[240:243], a[200:203], a[144:147], v[240:243]
 ds_read_b128 a[144:147], v1 offset:10240
 v_mfma_f32_16x16x32_bf16 v[240:243], a[204:207], a[148:151], v[240:243]
 ds_read_b128 a[148:151], v1 offset:11264
 v_mfma_f32_16x16x32_bf16 v[244:247], a[204:207], a[156:159], v[244:247]
 ds_read_b128 a[156:159], v1 offset:15360
 v_mfma_f32_16x16x32_bf16 v[244:247], a[200:203], a[152:155], v[244:247]
 ds_read_b128 a[152:155], v1 offset:14336
 v_mfma_f32_16x16x32_bf16 v[248:251], a[200:203], a[160:163], v[248:251]
 ds_read_b128 a[160:163], v1 offset:18432
 v_mfma_f32_16x16x32_bf16 v[248:251], a[204:207], a[164:167], v[248:251]
 ds_read_b128 a[164:167], v1 offset:19456
 v_mfma_f32_16x16x32_bf16 v[252:255], a[204:207], a[172:175], v[252:255]
 ds_read_b128 a[172:175], v1 offset:23552
 v_mfma_f32_16x16x32_bf16 v[252:255], a[200:203], a[168:171], v[252:255]
 ds_read_b128 a[168:171], v1 offset:22528
 v_mfma_f32_16x16x32_bf16 a[248:251], a[200:203], a[176:179], a[248:251]
 ds_read_b128 a[176:179], v1 offset:26624
 v_mfma_f32_16x16x32_bf16 a[248:251], a[204:207], a[180:183], a[248:251]
 ds_read_b128 a[180:183], v1 offset:27648
 v_mfma_f32_16x16x32_bf16 a[252:255], a[204:207], a[188:191], a[252:255]
 buffer_load_dwordx4 a[204:207], v0, s[12:15], s24 offen offset:3072
 ds_read_b128 a[188:191], v1 offset:31744
 v_mfma_f32_16x16x32_bf16 a[252:255], a[200:203], a[184:187], a[252:255]
 buffer_load_dwordx4 a[200:203], v0, s[12:15], s24 offen offset:2048
 s_add_u32 s24, s24, 4096
 ds_read_b128 a[184:187], v1 offset:30720
 s_waitcnt vmcnt(14) lgkmcnt(8)
Lloop:
 v_mfma_f32_16x16x32_bf16 v[16:19], a[208:211], a[128:131], v[16:19]
 s_add_u32 m0, s50, 0
 v_mfma_f32_16x16x32_bf16 v[16:19], a[212:215], a[132:135], v[16:19]
 s_add_u32 s29, s29, 0x2000000
 v_mfma_f32_16x16x32_bf16 v[20:23], a[212:215], a[140:143], v[20:23]
 v_mfma_f32_16x16x32_bf16 v[20:23], a[208:211], a[136:139], v[20:23]
 v_mfma_f32_16x16x32_bf16 v[24:27], a[208:211], a[144:147], v[24:27]
 v_mfma_f32_16x16x32_bf16 v[24:27], a[212:215], a[148:151], v[24:27]
 v_mfma_f32_16x16x32_bf16 v[28:31], a[212:215], a[156:159], v[28:31]
 v_mfma_f32_16x16x32_bf16 v[28:31], a[208:211], a[152:155], v[28:31]
 s_waitcnt lgkmcnt(0)
 v_mfma_f32_16x16x32_bf16 v[32:35], a[208:211], a[160:163], v[32:35]
 s_nop 0
 v_mfma_f32_16x16x32_bf16 v[32:35], a[212:215], a[164:167], v[32:35]
 v_mfma_f32_16x16x32_bf16 v[36:39], a[212:215], a[172:175], v[36:39]
 v_mfma_f32_16x16x32_bf16 v[36:39], a[208:211], a[168:171], v[36:39]
 v_mfma_f32_16x16x32_bf16 v[40:43], a[208:211], a[176:179], v[40:43]
 v_mfma_f32_16x16x32_bf16 v[40:43], a[212:215], a[180:183], v[40:43]
 v_mfma_f32_16x16x32_bf16 v[44:47], a[212:215], a[188:191], v[44:47]
 buffer_load_dwordx4 a[212:215], v0, s[12:15], s24 offen offset:1024
 v_mfma_f32_16x16x32_bf16 v[44:47], a[208:211], a[184:187], v[44:47]
 s_waitcnt vmcnt(9)
 v_mfma_f32_16x16x32_bf16 v[76:79], a[216:219], a[184:187], v[76:79]
 v_mfma_f32_16x16x32_bf16 v[76:79], a[220:223], a[188:191], v[76:79]
 buffer_load_dwordx4 a[208:211], v0, s[12:15], s24 offen
 v_mfma_f32_16x16x32_bf16 v[72:75], a[220:223], a[180:183], v[72:75]
 buffer_load_dwordx4 v3, s[32:35], s30 offen sc1 lds
 v_mfma_f32_16x16x32_bf16 v[72:75], a[216:219], a[176:179], v[72:75]
 v_mfma_f32_16x16x32_bf16 v[68:71], a[216:219], a[168:171], v[68:71]
 v_mfma_f32_16x16x32_bf16 v[68:71], a[220:223], a[172:175], v[68:71]
 v_mfma_f32_16x16x32_bf16 v[64:67], a[220:223], a[164:167], v[64:67]
 v_mfma_f32_16x16x32_bf16 v[64:67], a[216:219], a[160:163], v[64:67]
 v_mfma_f32_16x16x32_bf16 v[60:63], a[216:219], a[152:155], v[60:63]
 buffer_load_dwordx4 v3, s[32:35], s30 offen offset:1024 sc1 lds
 v_mfma_f32_16x16x32_bf16 v[60:63], a[220:223], a[156:159], v[60:63]
 v_mfma_f32_16x16x32_bf16 v[56:59], a[220:223], a[148:151], v[56:59]
 v_mfma_f32_16x16x32_bf16 v[56:59], a[216:219], a[144:147], v[56:59]
 v_mfma_f32_16x16x32_bf16 v[52:55], a[216:219], a[136:139], v[52:55]
 v_mfma_f32_16x16x32_bf16 v[52:55], a[220:223], a[140:143], v[52:55]
 v_mfma_f32_16x16x32_bf16 v[48:51], a[220:223], a[132:135], v[48:51]
 buffer_load_dwordx4 a[220:223], v0, s[12:15], s24 offen offset:3072
 v_mfma_f32_16x16x32_bf16 v[48:51], a[216:219], a[128:131], v[48:51]
 s_waitcnt vmcnt(11)
 v_mfma_f32_16x16x32_bf16 v[80:83], a[224:227], a[128:131], v[80:83]
 v_mfma_f32_16x16x32_bf16 v[80:83], a[228:231], a[132:135], v[80:83]
 buffer_load_dwordx4 a[216:219], v0, s[12:15], s24 offen offset:2048
 v_mfma_f32_16x16x32_bf16 v[84:87], a[228:231], a[140:143], v[84:87]
 s_add_u32 m0, m0, 4096
 v_mfma_f32_16x16x32_bf16 v[84:87], a[224:227], a[136:139], v[84:87]
 s_add_u32 s24, s24, 4096
 v_mfma_f32_16x16x32_bf16 v[88:91], a[224:227], a[144:147], v[88:91]
 v_mfma_f32_16x16x32_bf16 v[88:91], a[228:231], a[148:151], v[88:91]
 v_mfma_f32_16x16x32_bf16 v[92:95], a[228:231], a[156:159], v[92:95]
 v_mfma_f32_16x16x32_bf16 v[92:95], a[224:227], a[152:155], v[92:95]
 v_mfma_f32_16x16x32_bf16 v[96:99], a[224:227], a[160:163], v[96:99]
 v_mfma_f32_16x16x32_bf16 v[96:99], a[228:231], a[164:167], v[96:99]
 v_mfma_f32_16x16x32_bf16 v[100:103], a[228:231], a[172:175], v[100:103]
 s_add_u32 s30, s30, 2048
 v_mfma_f32_16x16x32_bf16 v[100:103], a[224:227], a[168:171], v[100:103]
 v_mfma_f32_16x16x32_bf16 v[104:107], a[224:227], a[176:179], v[104:107]
 v_mfma_f32_16x16x32_bf16 v[104:107], a[228:231], a[180:183], v[104:107]
 v_mfma_f32_16x16x32_bf16 v[108:111], a[228:231], a[188:191], v[108:111]
 buffer_load_dwordx4 a[228:231], v0, s[12:15], s24 offen offset:1024
 v_mfma_f32_16x16x32_bf16 v[108:111], a[224:227], a[184:187], v[108:111]
 s_waitcnt vmcnt(11)
 v_mfma_f32_16x16x32_bf16 a[244:247], a[232:235], a[184:187], a[244:247]
 v_mfma_f32_16x16x32_bf16 a[244:247], a[236:239], a[188:191], a[244:247]
 buffer_load_dwordx4 a[224:227], v0, s[12:15], s24 offen
 v_mfma_f32_16x16x32_bf16 a[240:243], a[236:239], a[180:183], a[240:243]
 v_mfma_f32_16x16x32_bf16 a[240:243], a[232:235], a[176:179], a[240:243]
 buffer_load_dwordx4 v3, s[32:35], s30 offen sc1 lds
 v_mfma_f32_16x16x32_bf16 v[132:135], a[232:235], a[168:171], v[132:135]
 v_mfma_f32_16x16x32_bf16 v[132:135], a[236:239], a[172:175], v[132:135]
 v_mfma_f32_16x16x32_bf16 v[128:131], a[236:239], a[164:167], v[128:131]
 v_mfma_f32_16x16x32_bf16 v[128:131], a[232:235], a[160:163], v[128:131]
 v_mfma_f32_16x16x32_bf16 v[124:127], a[232:235], a[152:155], v[124:127]
 v_mfma_f32_16x16x32_bf16 v[124:127], a[236:239], a[156:159], v[124:127]
 v_mfma_f32_16x16x32_bf16 v[120:123], a[236:239], a[148:151], v[120:123]
 buffer_load_dwordx4 v3, s[32:35], s30 offen offset:1024 sc1 lds
 v_mfma_f32_16x16x32_bf16 v[120:123], a[232:235], a[144:147], v[120:123]
 v_mfma_f32_16x16x32_bf16 v[116:119], a[232:235], a[136:139], v[116:119]
 v_mfma_f32_16x16x32_bf16 v[116:119], a[236:239], a[140:143], v[116:119]
 v_mfma_f32_16x16x32_bf16 v[112:115], a[236:239], a[132:135], v[112:115]
 buffer_load_dwordx4 a[236:239], v0, s[12:15], s24 offen offset:3072
 v_mfma_f32_16x16x32_bf16 v[112:115], a[232:235], a[128:131], v[112:115]
 s_waitcnt vmcnt(13)
 v_mfma_f32_16x16x32_bf16 v[136:139], a[192:195], a[128:131], v[136:139]
 v_mfma_f32_16x16x32_bf16 v[136:139], a[196:199], a[132:135], v[136:139]
 buffer_load_dwordx4 a[232:235], v0, s[12:15], s24 offen offset:2048
 v_mfma_f32_16x16x32_bf16 v[140:143], a[196:199], a[140:143], v[140:143]
 v_mfma_f32_16x16x32_bf16 v[140:143], a[192:195], a[136:139], v[140:143]
 s_add_u32 s24, s24, 4096
 v_mfma_f32_16x16x32_bf16 v[144:147], a[192:195], a[144:147], v[144:147]
 v_mfma_f32_16x16x32_bf16 v[144:147], a[196:199], a[148:151], v[144:147]
 s_add_u32 m0, m0, 4096
 v_mfma_f32_16x16x32_bf16 v[148:151], a[196:199], a[156:159], v[148:151]
 v_mfma_f32_16x16x32_bf16 v[148:151], a[192:195], a[152:155], v[148:151]
 v_mfma_f32_16x16x32_bf16 v[152:155], a[192:195], a[160:163], v[152:155]
 v_mfma_f32_16x16x32_bf16 v[152:155], a[196:199], a[164:167], v[152:155]
 v_mfma_f32_16x16x32_bf16 v[156:159], a[196:199], a[172:175], v[156:159]
 v_mfma_f32_16x16x32_bf16 v[156:159], a[192:195], a[168:171], v[156:159]
 s_add_u32 s30, s30, 2048
 v_mfma_f32_16x16x32_bf16 v[160:163], a[192:195], a[176:179], v[160:163]
 v_mfma_f32_16x16x32_bf16 v[160:163], a[196:199], a[180:183], v[160:163]
 v_mfma_f32_16x16x32_bf16 v[164:167], a[196:199], a[188:191], v[164:167]
 buffer_load_dwordx4 a[196:199], v0, s[12:15], s24 offen offset:1024
 v_mfma_f32_16x16x32_bf16 v[164:167], a[192:195], a[184:187], v[164:167]
 s_waitcnt vmcnt(13)
 v_mfma_f32_16x16x32_bf16 v[196:199], a[200:203], a[184:187], v[196:199]
 v_mfma_f32_16x16x32_bf16 v[196:199], a[204:207], a[188:191], v[196:199]
 buffer_load_dwordx4 a[192:195], v0, s[12:15], s24 offen
 v_mfma_f32_16x16x32_bf16 v[192:195], a[204:207], a[180:183], v[192:195]
 s_add_u32 s31, s31, 1
 v_mov_b32 v7, s31
 buffer_store_dword v7, v1, s[60:63], 0 offen sc1
 v_mfma_f32_16x16x32_bf16 v[192:195], a[200:203], a[176:179], v[192:195]
 v_mfma_f32_16x16x32_bf16 v[188:191], a[200:203], a[168:171], v[188:191]
 v_mfma_f32_16x16x32_bf16 v[188:191], a[204:207], a[172:175], v[188:191]
 v_mfma_f32_16x16x32_bf16 v[184:187], a[204:207], a[164:167], v[184:187]
 buffer_load_dwordx4 v3, s[32:35], s30 offen sc1 lds
 v_mfma_f32_16x16x32_bf16 v[184:187], a[200:203], a[160:163], v[184:187]
 v_mfma_f32_16x16x32_bf16 v[180:183], a[200:203], a[152:155], v[180:183]
 v_mfma_f32_16x16x32_bf16 v[180:183], a[204:207], a[156:159], v[180:183]
 v_mfma_f32_16x16x32_bf16 v[176:179], a[204:207], a[148:151], v[176:179]
 v_mfma_f32_16x16x32_bf16 v[176:179], a[200:203], a[144:147], v[176:179]
 v_mfma_f32_16x16x32_bf16 v[172:175], a[200:203], a[136:139], v[172:175]
 v_mfma_f32_16x16x32_bf16 v[172:175], a[204:207], a[140:143], v[172:175]
 buffer_load_dwordx4 v3, s[32:35], s30 offen offset:1024 sc1 lds
 v_mfma_f32_16x16x32_bf16 v[168:171], a[204:207], a[132:135], v[168:171]
 buffer_load_dwordx4 a[204:207], v0, s[12:15], s24 offen offset:3072
 v_mfma_f32_16x16x32_bf16 v[168:171], a[200:203], a[128:131], v[168:171]
 s_waitcnt vmcnt(16)
 v_mfma_f32_16x16x32_bf16 v[200:203], a[208:211], a[128:131], v[200:203]
 v_mfma_f32_16x16x32_bf16 v[200:203], a[212:215], a[132:135], v[200:203]
 buffer_load_dwordx4 a[200:203], v0, s[12:15], s24 offen offset:2048
 v_mfma_f32_16x16x32_bf16 v[204:207], a[212:215], a[140:143], v[204:207]
 v_mfma_f32_16x16x32_bf16 v[204:207], a[208:211], a[136:139], v[204:207]
 s_add_u32 s24, s24, 4096
 v_mfma_f32_16x16x32_bf16 v[208:211], a[208:211], a[144:147], v[208:211]
 v_mfma_f32_16x16x32_bf16 v[208:211], a[212:215], a[148:151], v[208:211]
 v_mfma_f32_16x16x32_bf16 v[212:215], a[212:215], a[156:159], v[212:215]
 v_mfma_f32_16x16x32_bf16 v[212:215], a[208:211], a[152:155], v[212:215]
 s_add_u32 m0, m0, 4096
 v_mfma_f32_16x16x32_bf16 v[216:219], a[208:211], a[160:163], v[216:219]
 v_mfma_f32_16x16x32_bf16 v[216:219], a[212:215], a[164:167], v[216:219]
 v_mfma_f32_16x16x32_bf16 v[220:223], a[212:215], a[172:175], v[220:223]
 v_mfma_f32_16x16x32_bf16 v[220:223], a[208:211], a[168:171], v[220:223]
 v_mfma_f32_16x16x32_bf16 v[224:227], a[208:211], a[176:179], v[224:227]
 v_mfma_f32_16x16x32_bf16 v[224:227], a[212:215], a[180:183], v[224:227]
 v_mfma_f32_16x16x32_bf16 v[228:231], a[212:215], a[188:191], v[228:231]
 buffer_load_dwordx4 a[212:215], v0, s[12:15], s24 offen offset:1024
 v_mfma_f32_16x16x32_bf16 v[228:231], a[208:211], a[184:187], v[228:231]
 s_waitcnt vmcnt(14)
 v_mfma_f32_16x16x32_bf16 a[252:255], a[216:219], a[184:187], a[252:255]
 ds_read_b128 a[184:187], v1 offset:63488
 v_mfma_f32_16x16x32_bf16 a[252:255], a[220:223], a[188:191], a[252:255]
 buffer_load_dwordx4 a[208:211], v0, s[12:15], s24 offen
 ds_read_b128 a[188:191], v1 offset:64512
 v_mfma_f32_16x16x32_bf16 a[248:251], a[220:223], a[180:183], a[248:251]
 ds_read_b128 a[180:183], v1 offset:60416
 v_mfma_f32_16x16x32_bf16 a[248:251], a[216:219], a[176:179], a[248:251]
 ds_read_b128 a[176:179], v1 offset:59392
 v_mfma_f32_16x16x32_bf16 v[252:255], a[216:219], a[168:171], v[252:255]
 ds_read_b128 a[168:171], v1 offset:55296
 v_mfma_f32_16x16x32_bf16 v[252:255], a[220:223], a[172:175], v[252:255]
 ds_read_b128 a[172:175], v1 offset:56320
 v_mfma_f32_16x16x32_bf16 v[248:251], a[220:223], a[164:167], v[248:251]
 ds_read_b128 a[164:167], v1 offset:52224
 v_mfma_f32_16x16x32_bf16 v[248:251], a[216:219], a[160:163], v[248:251]
 ds_read_b128 a[160:163], v1 offset:51200
 v_mfma_f32_16x16x32_bf16 v[244:247], a[216:219], a[152:155], v[244:247]
 ds_read_b128 a[152:155], v1 offset:47104
 v_mfma_f32_16x16x32_bf16 v[244:247], a[220:223], a[156:159], v[244:247]
 ds_read_b128 a[156:159], v1 offset:48128
 v_mfma_f32_16x16x32_bf16 v[240:243], a[220:223], a[148:151], v[240:243]
 ds_read_b128 a[148:151], v1 offset:44032
 v_mfma_f32_16x16x32_bf16 v[240:243], a[216:219], a[144:147], v[240:243]
 ds_read_b128 a[144:147], v1 offset:43008
 v_mfma_f32_16x16x32_bf16 v[236:239], a[216:219], a[136:139], v[236:239]
 ds_read_b128 a[136:139], v1 offset:38912
 v_mfma_f32_16x16x32_bf16 v[236:239], a[220:223], a[140:143], v[236:239]
 ds_read_b128 a[140:143], v1 offset:39936
 v_mfma_f32_16x16x32_bf16 v[232:235], a[220:223], a[132:135], v[232:235]
 ds_read_b128 a[132:135], v1 offset:35840
 v_mfma_f32_16x16x32_bf16 v[232:235], a[216:219], a[128:131], v[232:235]
 ds_read_b128 a[128:131], v1 offset:34816
 s_waitcnt vmcnt(13) lgkmcnt(8)
 v_mfma_f32_16x16x32_bf16 v[44:47], a[224:227], a[184:187], v[44:47]
 s_add_u32 s30, s30, 2048
 v_mfma_f32_16x16x32_bf16 v[44:47], a[228:231], a[188:191], v[44:47]
 buffer_load_dwordx4 a[220:223], v0, s[12:15], s24 offen offset:3072
 v_mfma_f32_16x16x32_bf16 v[40:43], a[228:231], a[180:183], v[40:43]
 v_mfma_f32_16x16x32_bf16 v[40:43], a[224:227], a[176:179], v[40:43]
 buffer_load_dwordx4 a[216:219], v0, s[12:15], s24 offen offset:2048
 v_mfma_f32_16x16x32_bf16 v[36:39], a[224:227], a[168:171], v[36:39]
 s_add_u32 s24, s24, 4096
 v_mfma_f32_16x16x32_bf16 v[36:39], a[228:231], a[172:175], v[36:39]
 v_mfma_f32_16x16x32_bf16 v[32:35], a[228:231], a[164:167], v[32:35]
 v_mfma_f32_16x16x32_bf16 v[32:35], a[224:227], a[160:163], v[32:35]
 s_waitcnt lgkmcnt(0)
 v_mfma_f32_16x16x32_bf16 v[28:31], a[224:227], a[152:155], v[28:31]
 v_mfma_f32_16x16x32_bf16 v[28:31], a[228:231], a[156:159], v[28:31]
 v_mfma_f32_16x16x32_bf16 v[24:27], a[228:231], a[148:151], v[24:27]
 buffer_load_dwordx4 v3, s[32:35], s30 offen sc1 lds
 v_mfma_f32_16x16x32_bf16 v[24:27], a[224:227], a[144:147], v[24:27]
 v_mfma_f32_16x16x32_bf16 v[20:23], a[224:227], a[136:139], v[20:23]
 v_mfma_f32_16x16x32_bf16 v[20:23], a[228:231], a[140:143], v[20:23]
 v_mfma_f32_16x16x32_bf16 v[16:19], a[228:231], a[132:135], v[16:19]
 buffer_load_dwordx4 a[228:231], v0, s[12:15], s24 offen offset:1024
 v_mfma_f32_16x16x32_bf16 v[16:19], a[224:227], a[128:131], v[16:19]
 s_waitcnt vmcnt(13)
 v_mfma_f32_16x16x32_bf16 v[48:51], a[232:235], a[128:131], v[48:51]
 v_mfma_f32_16x16x32_bf16 v[48:51], a[236:239], a[132:135], v[48:51]
 buffer_load_dwordx4 a[224:227], v0, s[12:15], s24 offen
 v_mfma_f32_16x16x32_bf16 v[52:55], a[236:239], a[140:143], v[52:55]
 v_mfma_f32_16x16x32_bf16 v[52:55], a[232:235], a[136:139], v[52:55]
 v_mfma_f32_16x16x32_bf16 v[56:59], a[232:235], a[144:147], v[56:59]
 buffer_load_dwordx4 v3, s[32:35], s30 offen offset:1024 sc1 lds
 v_mfma_f32_16x16x32_bf16 v[56:59], a[236:239], a[148:151], v[56:59]
 v_mfma_f32_16x16x32_bf16 v[60:63], a[236:239], a[156:159], v[60:63]
 v_mfma_f32_16x16x32_bf16 v[60:63], a[232:235], a[152:155], v[60:63]
 v_mfma_f32_16x16x32_bf16 v[64:67], a[232:235], a[160:163], v[64:67]
 v_mfma_f32_16x16x32_bf16 v[64:67], a[236:239], a[164:167], v[64:67]
 v_mfma_f32_16x16x32_bf16 v[68:71], a[236:239], a[172:175], v[68:71]
 v_mfma_f32_16x16x32_bf16 v[68:71], a[232:235], a[168:171], v[68:71]
 s_add_u32 m0, m0, 4096
 v_mfma_f32_16x16x32_bf16 v[72:75], a[232:235], a[176:179], v[72:75]
 v_mfma_f32_16x16x32_bf16 v[72:75], a[236:239], a[180:183], v[72:75]
 v_mfma_f32_16x16x32_bf16 v[76:79], a[236:239], a[188:191], v[76:79]
 buffer_load_dwordx4 a[236:239], v0, s[12:15], s24 offen offset:3072
 v_mfma_f32_16x16x32_bf16 v[76:79], a[232:235], a[184:187], v[76:79]
 s_waitcnt vmcnt(14)
 v_mfma_f32_16x16x32_bf16 v[108:111], a[192:195], a[184:187], v[108:111]
 v_mfma_f32_16x16x32_bf16 v[108:111], a[196:199], a[188:191], v[108:111]
 buffer_load_dwordx4 a[232:235], v0, s[12:15], s24 offen offset:2048
 v_mfma_f32_16x16x32_bf16 v[104:107], a[196:199], a[180:183], v[104:107]
 v_mfma_f32_16x16x32_bf16 v[104:107], a[192:195], a[176:179], v[104:107]
 s_add_u32 s24, s24, 4096
 v_mfma_f32_16x16x32_bf16 v[100:103], a[192:195], a[168:171], v[100:103]
 v_mfma_f32_16x16x32_bf16 v[100:103], a[196:199], a[172:175], v[100:103]
 s_add_u32 s30, s30, 2048
 v_mfma_f32_16x16x32_bf16 v[96:99], a[196:199], a[164:167], v[96:99]
 v_mfma_f32_16x16x32_bf16 v[96:99], a[192:195], a[160:163], v[96:99]
 v_mfma_f32_16x16x32_bf16 v[92:95], a[192:195], a[152:155], v[92:95]
 v_mfma_f32_16x16x32_bf16 v[92:95], a[196:199], a[156:159], v[92:95]
 v_mfma_f32_16x16x32_bf16 v[88:91], a[196:199], a[148:151], v[88:91]
 v_mfma_f32_16x16x32_bf16 v[88:91], a[192:195], a[144:147], v[88:91]
 v_mfma_f32_16x16x32_bf16 v[84:87], a[192:195], a[136:139], v[84:87]
 buffer_load_dwordx4 v3, s[32:35], s30 offen sc1 lds
 v_mfma_f32_16x16x32_bf16 v[84:87], a[196:199], a[140:143], v[84:87]
 v_mfma_f32_16x16x32_bf16 v[80:83], a[196:199], a[132:135], v[80:83]
 buffer_load_dwordx4 a[196:199], v0, s[12:15], s24 offen offset:1024
 v_mfma_f32_16x16x32_bf16 v[80:83], a[192:195], a[128:131], v[80:83]
 s_waitcnt vmcnt(12)
 v_mfma_f32_16x16x32_bf16 v[112:115], a[200:203], a[128:131], v[112:115]
 v_mfma_f32_16x16x32_bf16 v[112:115], a[204:207], a[132:135], v[112:115]
 buffer_load_dwordx4 a[192:195], v0, s[12:15], s24 offen
 v_mfma_f32_16x16x32_bf16 v[116:119], a[204:207], a[140:143], v[116:119]
 v_mfma_f32_16x16x32_bf16 v[116:119], a[200:203], a[136:139], v[116:119]
 v_mfma_f32_16x16x32_bf16 v[120:123], a[200:203], a[144:147], v[120:123]
 v_mfma_f32_16x16x32_bf16 v[120:123], a[204:207], a[148:151], v[120:123]
 v_mfma_f32_16x16x32_bf16 v[124:127], a[204:207], a[156:159], v[124:127]
 buffer_load_dwordx4 v3, s[32:35], s30 offen offset:1024 sc1 lds
 v_mfma_f32_16x16x32_bf16 v[124:127], a[200:203], a[152:155], v[124:127]
 v_mfma_f32_16x16x32_bf16 v[128:131], a[200:203], a[160:163], v[128:131]
 v_mfma_f32_16x16x32_bf16 v[128:131], a[204:207], a[164:167], v[128:131]
 v_mfma_f32_16x16x32_bf16 v[132:135], a[204:207], a[172:175], v[132:135]
 v_mfma_f32_16x16x32_bf16 v[132:135], a[200:203], a[168:171], v[132:135]
 v_mfma_f32_16x16x32_bf16 a[240:243], a[200:203], a[176:179], a[240:243]
 s_add_u32 m0, m0, 4096
 v_mfma_f32_16x16x32_bf16 a[240:243], a[204:207], a[180:183], a[240:243]
 v_mfma_f32_16x16x32_bf16 a[244:247], a[204:207], a[188:191], a[244:247]
 buffer_load_dwordx4 a[204:207], v0, s[12:15], s24 offen offset:3072
 v_mfma_f32_16x16x32_bf16 a[244:247], a[200:203], a[184:187], a[244:247]
 s_waitcnt vmcnt(13)
 v_mfma_f32_16x16x32_bf16 v[164:167], a[208:211], a[184:187], v[164:167]
 v_mfma_f32_16x16x32_bf16 v[164:167], a[212:215], a[188:191], v[164:167]
 buffer_load_dwordx4 a[200:203], v0, s[12:15], s24 offen offset:2048
 v_mfma_f32_16x16x32_bf16 v[160:163], a[212:215], a[180:183], v[160:163]
 v_mfma_f32_16x16x32_bf16 v[160:163], a[208:211], a[176:179], v[160:163]
 s_add_u32 s24, s24, 4096
 v_mfma_f32_16x16x32_bf16 v[156:159], a[208:211], a[168:171], v[156:159]
 v_mfma_f32_16x16x32_bf16 v[156:159], a[212:215], a[172:175], v[156:159]
 v_mfma_f32_16x16x32_bf16 v[152:155], a[212:215], a[164:167], v[152:155]
 v_mfma_f32_16x16x32_bf16 v[152:155], a[208:211], a[160:163], v[152:155]
 s_add_u32 s30, s30, 2048
 v_mfma_f32_16x16x32_bf16 v[148:151], a[208:211], a[152:155], v[148:151]
 v_mfma_f32_16x16x32_bf16 v[148:151], a[212:215], a[156:159], v[148:151]
 v_mfma_f32_16x16x32_bf16 v[144:147], a[212:215], a[148:151], v[144:147]
 v_mfma_f32_16x16x32_bf16 v[144:147], a[208:211], a[144:147], v[144:147]
 v_mfma_f32_16x16x32_bf16 v[140:143], a[208:211], a[136:139], v[140:143]
 v_mfma_f32_16x16x32_bf16 v[140:143], a[212:215], a[140:143], v[140:143]
 v_mfma_f32_16x16x32_bf16 v[136:139], a[212:215], a[132:135], v[136:139]
 buffer_load_dwordx4 a[212:215], v0, s[12:15], s24 offen offset:1024
 v_mfma_f32_16x16x32_bf16 v[136:139], a[208:211], a[128:131], v[136:139]
 s_waitcnt vmcnt(13)
 v_mfma_f32_16x16x32_bf16 v[168:171], a[216:219], a[128:131], v[168:171]
 buffer_load_dwordx4 v3, s[32:35], s30 offen sc1 lds
 v_mfma_f32_16x16x32_bf16 v[168:171], a[220:223], a[132:135], v[168:171]
 buffer_load_dwordx4 a[208:211], v0, s[12:15], s24 offen
 v_mfma_f32_16x16x32_bf16 v[172:175], a[220:223], a[140:143], v[172:175]
 v_mfma_f32_16x16x32_bf16 v[172:175], a[216:219], a[136:139], v[172:175]
 v_mfma_f32_16x16x32_bf16 v[176:179], a[216:219], a[144:147], v[176:179]
 v_mfma_f32_16x16x32_bf16 v[176:179], a[220:223], a[148:151], v[176:179]
 v_mfma_f32_16x16x32_bf16 v[180:183], a[220:223], a[156:159], v[180:183]
 v_mfma_f32_16x16x32_bf16 v[180:183], a[216:219], a[152:155], v[180:183]
 buffer_load_dwordx4 v3, s[32:35], s30 offen offset:1024 sc1 lds
 v_mfma_f32_16x16x32_bf16 v[184:187], a[216:219], a[160:163], v[184:187]
 v_mfma_f32_16x16x32_bf16 v[184:187], a[220:223], a[164:167], v[184:187]
 v_mfma_f32_16x16x32_bf16 v[188:191], a[220:223], a[172:175], v[188:191]
 v_mfma_f32_16x16x32_bf16 v[188:191], a[216:219], a[168:171], v[188:191]
 v_mfma_f32_16x16x32_bf16 v[192:195], a[216:219], a[176:179], v[192:195]
 v_mfma_f32_16x16x32_bf16 v[192:195], a[220:223], a[180:183], v[192:195]
 v_mfma_f32_16x16x32_bf16 v[196:199], a[220:223], a[188:191], v[196:199]
 buffer_load_dwordx4 a[220:223], v0, s[12:15], s24 offen offset:3072
 v_mfma_f32_16x16x32_bf16 v[196:199], a[216:219], a[184:187], v[196:199]
 s_waitcnt vmcnt(14)
 v_mfma_f32_16x16x32_bf16 v[228:231], a[224:227], a[184:187], v[228:231]
 s_add_u32 m0, m0, 4096
 v_mfma_f32_16x16x32_bf16 v[228:231], a[228:231], a[188:191], v[228:231]
 buffer_load_dwordx4 a[216:219], v0, s[12:15], s24 offen offset:2048
 v_mfma_f32_16x16x32_bf16 v[224:227], a[228:231], a[180:183], v[224:227]
 v_mfma_f32_16x16x32_bf16 v[224:227], a[224:227], a[176:179], v[224:227]
 s_add_u32 s24, s24, 4096
 v_mfma_f32_16x16x32_bf16 v[220:223], a[224:227], a[168:171], v[220:223]
 v_mfma_f32_16x16x32_bf16 v[220:223], a[228:231], a[172:175], v[220:223]
 v_mfma_f32_16x16x32_bf16 v[216:219], a[228:231], a[164:167], v[216:219]
 v_mfma_f32_16x16x32_bf16 v[216:219], a[224:227], a[160:163], v[216:219]
 v_mfma_f32_16x16x32_bf16 v[212:215], a[224:227], a[152:155], v[212:215]
 s_add_u32 s30, s30, 2048
 v_mfma_f32_16x16x32_bf16 v[212:215], a[228:231], a[156:159], v[212:215]
 v_mfma_f32_16x16x32_bf16 v[208:211], a[228:231], a[148:151], v[208:211]
 v_mfma_f32_16x16x32_bf16 v[208:211], a[224:227], a[144:147], v[208:211]
 v_mfma_f32_16x16x32_bf16 v[204:207], a[224:227], a[136:139], v[204:207]
 v_mfma_f32_16x16x32_bf16 v[204:207], a[228:231], a[140:143], v[204:207]
 v_mfma_f32_16x16x32_bf16 v[200:203], a[228:231], a[132:135], v[200:203]
 buffer_load_dwordx4 a[228:231], v0, s[12:15], s24 offen offset:1024
 v_mfma_f32_16x16x32_bf16 v[200:203], a[224:227], a[128:131], v[200:203]
 s_waitcnt vmcnt(13)
 v_mfma_f32_16x16x32_bf16 v[232:235], a[232:235], a[128:131], v[232:235]
 ds_read_b128 a[128:131], v2 offset:2048
 v_mfma_f32_16x16x32_bf16 v[232:235], a[236:239], a[132:135], v[232:235]
 buffer_load_dwordx4 a[224:227], v0, s[12:15], s24 offen
 ds_read_b128 a[132:135], v2 offset:3072
 v_mfma_f32_16x16x32_bf16 v[236:239], a[236:239], a[140:143], v[236:239]
 ds_read_b128 a[140:143], v2 offset:7168
 v_mfma_f32_16x16x32_bf16 v[236:239], a[232:235], a[136:139], v[236:239]
 ds_read_b128 a[136:139], v2 offset:6144
 v_mfma_f32_16x16x32_bf16 v[240:243], a[232:235], a[144:147], v[240:243]
 ds_read_b128 a[144:147], v2 offset:10240
 v_mfma_f32_16x16x32_bf16 v[240:243], a[236:239], a[148:151], v[240:243]
 ds_read_b128 a[148:151], v2 offset:11264
 v_mfma_f32_16x16x32_bf16 v[244:247], a[236:239], a[156:159], v[244:247]
 ds_read_b128 a[156:159], v2 offset:15360
 v_mfma_f32_16x16x32_bf16 v[244:247], a[232:235], a[152:155], v[244:247]
 ds_read_b128 a[152:155], v2 offset:14336
 v_mfma_f32_16x16x32_bf16 v[248:251], a[232:235], a[160:163], v[248:251]
 ds_read_b128 a[160:163], v2 offset:18432
 v_mfma_f32_16x16x32_bf16 v[248:251], a[236:239], a[164:167], v[248:251]
 ds_read_b128 a[164:167], v2 offset:19456
 v_mfma_f32_16x16x32_bf16 v[252:255], a[236:239], a[172:175], v[252:255]
 ds_read_b128 a[172:175], v2 offset:23552
 v_mfma_f32_16x16x32_bf16 v[252:255], a[232:235], a[168:171], v[252:255]
 ds_read_b128 a[168:171], v2 offset:22528
 v_mfma_f32_16x16x32_bf16 a[248:251], a[232:235], a[176:179], a[248:251]
 ds_read_b128 a[176:179], v2 offset:26624
 v_mfma_f32_16x16x32_bf16 a[248:251], a[236:239], a[180:183], a[248:251]
 ds_read_b128 a[180:183], v2 offset:27648
 v_mfma_f32_16x16x32_bf16 a[252:255], a[236:239], a[188:191], a[252:255]
 ds_read_b128 a[188:191], v2 offset:31744
 v_mfma_f32_16x16x32_bf16 a[252:255], a[232:235], a[184:187], a[252:255]
 ds_read_b128 a[184:187], v2 offset:30720
 s_waitcnt vmcnt(11) lgkmcnt(8)
 v_mfma_f32_16x16x32_bf16 v[16:19], a[192:195], a[128:131], v[16:19]
 v_mfma_f32_16x16x32_bf16 v[16:19], a[196:199], a[132:135], v[16:19]
 buffer_load_dwordx4 a[236:239], v0, s[12:15], s24 offen offset:3072
 v_mfma_f32_16x16x32_bf16 v[20:23], a[196:199], a[140:143], v[20:23]
 buffer_load_dwordx4 v3, s[32:35], s30 offen sc1 lds
 v_mfma_f32_16x16x32_bf16 v[20:23], a[192:195], a[136:139], v[20:23]
 buffer_load_dwordx4 a[232:235], v0, s[12:15], s24 offen offset:2048
 v_mfma_f32_16x16x32_bf16 v[24:27], a[192:195], a[144:147], v[24:27]
 s_add_u32 s24, s24, 4096
 v_mfma_f32_16x16x32_bf16 v[24:27], a[196:199], a[148:151], v[24:27]
 v_mfma_f32_16x16x32_bf16 v[28:31], a[196:199], a[156:159], v[28:31]
 v_mfma_f32_16x16x32_bf16 v[28:31], a[192:195], a[152:155], v[28:31]
 s_waitcnt lgkmcnt(0)
 v_mfma_f32_16x16x32_bf16 v[32:35], a[192:195], a[160:163], v[32:35]
 v_mfma_f32_16x16x32_bf16 v[32:35], a[196:199], a[164:167], v[32:35]
 v_mfma_f32_16x16x32_bf16 v[36:39], a[196:199], a[172:175], v[36:39]
 v_mfma_f32_16x16x32_bf16 v[36:39], a[192:195], a[168:171], v[36:39]
 v_mfma_f32_16x16x32_bf16 v[40:43], a[192:195], a[176:179], v[40:43]
 buffer_load_dwordx4 v3, s[32:35], s30 offen offset:1024 sc1 lds
 v_mfma_f32_16x16x32_bf16 v[40:43], a[196:199], a[180:183], v[40:43]
 v_mfma_f32_16x16x32_bf16 v[44:47], a[196:199], a[188:191], v[44:47]
 buffer_load_dwordx4 a[196:199], v0, s[12:15], s24 offen offset:1024
 v_mfma_f32_16x16x32_bf16 v[44:47], a[192:195], a[184:187], v[44:47]
 s_waitcnt vmcnt(13)
 v_mfma_f32_16x16x32_bf16 v[76:79], a[200:203], a[184:187], v[76:79]
 v_mfma_f32_16x16x32_bf16 v[76:79], a[204:207], a[188:191], v[76:79]
 buffer_load_dwordx4 a[192:195], v0, s[12:15], s24 offen
 v_mfma_f32_16x16x32_bf16 v[72:75], a[204:207], a[180:183], v[72:75]
 v_mfma_f32_16x16x32_bf16 v[72:75], a[200:203], a[176:179], v[72:75]
 v_mfma_f32_16x16x32_bf16 v[68:71], a[200:203], a[168:171], v[68:71]
 v_mfma_f32_16x16x32_bf16 v[68:71], a[204:207], a[172:175], v[68:71]
 s_add_u32 m0, m0, 4096
 v_mfma_f32_16x16x32_bf16 v[64:67], a[204:207], a[164:167], v[64:67]
 v_mfma_f32_16x16x32_bf16 v[64:67], a[200:203], a[160:163], v[64:67]
 v_mfma_f32_16x16x32_bf16 v[60:63], a[200:203], a[152:155], v[60:63]
 v_mfma_f32_16x16x32_bf16 v[60:63], a[204:207], a[156:159], v[60:63]
 v_mfma_f32_16x16x32_bf16 v[56:59], a[204:207], a[148:151], v[56:59]
 v_mfma_f32_16x16x32_bf16 v[56:59], a[200:203], a[144:147], v[56:59]
 v_mfma_f32_16x16x32_bf16 v[52:55], a[200:203], a[136:139], v[52:55]
 s_add_u32 s30, s30, 2048
 v_mfma_f32_16x16x32_bf16 v[52:55], a[204:207], a[140:143], v[52:55]
 v_mfma_f32_16x16x32_bf16 v[48:51], a[204:207], a[132:135], v[48:51]
 buffer_load_dwordx4 a[204:207], v0, s[12:15], s24 offen offset:3072
 v_mfma_f32_16x16x32_bf16 v[48:51], a[200:203], a[128:131], v[48:51]
 s_waitcnt vmcnt(12)
 v_mfma_f32_16x16x32_bf16 v[80:83], a[208:211], a[128:131], v[80:83]
 v_mfma_f32_16x16x32_bf16 v[80:83], a[212:215], a[132:135], v[80:83]
 buffer_load_dwordx4 a[200:203], v0, s[12:15], s24 offen offset:2048
 v_mfma_f32_16x16x32_bf16 v[84:87], a[212:215], a[140:143], v[84:87]
 v_mfma_f32_16x16x32_bf16 v[84:87], a[208:211], a[136:139], v[84:87]
 s_add_u32 s24, s24, 4096
 v_mfma_f32_16x16x32_bf16 v[88:91], a[208:211], a[144:147], v[88:91]
 v_mfma_f32_16x16x32_bf16 v[88:91], a[212:215], a[148:151], v[88:91]
 v_mfma_f32_16x16x32_bf16 v[92:95], a[212:215], a[156:159], v[92:95]
 v_mfma_f32_16x16x32_bf16 v[92:95], a[208:211], a[152:155], v[92:95]
 buffer_load_dwordx4 v3, s[32:35], s30 offen sc1 lds
 v_mfma_f32_16x16x32_bf16 v[96:99], a[208:211], a[160:163], v[96:99]
 v_mfma_f32_16x16x32_bf16 v[96:99], a[212:215], a[164:167], v[96:99]
 v_mfma_f32_16x16x32_bf16 v[100:103], a[212:215], a[172:175], v[100:103]
 v_mfma_f32_16x16x32_bf16 v[100:103], a[208:211], a[168:171], v[100:103]
 v_mfma_f32_16x16x32_bf16 v[104:107], a[208:211], a[176:179], v[104:107]
 v_mfma_f32_16x16x32_bf16 v[104:107], a[212:215], a[180:183], v[104:107]
 buffer_load_dwordx4 v3, s[32:35], s30 offen offset:1024 sc1 lds
 v_mfma_f32_16x16x32_bf16 v[108:111], a[212:215], a[188:191], v[108:111]
 buffer_load_dwordx4 a[212:215], v0, s[12:15], s24 offen offset:1024
 v_mfma_f32_16x16x32_bf16 v[108:111], a[208:211], a[184:187], v[108:111]
 s_waitcnt vmcnt(13)
 v_mfma_f32_16x16x32_bf16 a[244:247], a[216:219], a[184:187], a[244:247]
 v_mfma_f32_16x16x32_bf16 a[244:247], a[220:223], a[188:191], a[244:247]
 buffer_load_dwordx4 a[208:211], v0, s[12:15], s24 offen
 v_mfma_f32_16x16x32_bf16 a[240:243], a[220:223], a[180:183], a[240:243]
 v_mfma_f32_16x16x32_bf16 a[240:243], a[216:219], a[176:179], a[240:243]
 v_mfma_f32_16x16x32_bf16 v[132:135], a[216:219], a[168:171], v[132:135]
 v_mfma_f32_16x16x32_bf16 v[132:135], a[220:223], a[172:175], v[132:135]
 v_mfma_f32_16x16x32_bf16 v[128:131], a[220:223], a[164:167], v[128:131]
 v_mfma_f32_16x16x32_bf16 v[128:131], a[216:219], a[160:163], v[128:131]
 s_add_u32 s30, s30, 2048
 v_mfma_f32_16x16x32_bf16 v[124:127], a[216:219], a[152:155], v[124:127]
 v_mfma_f32_16x16x32_bf16 v[124:127], a[220:223], a[156:159], v[124:127]
 v_mfma_f32_16x16x32_bf16 v[120:123], a[220:223], a[148:151], v[120:123]
 v_mfma_f32_16x16x32_bf16 v[120:123], a[216:219], a[144:147], v[120:123]
 v_mfma_f32_16x16x32_bf16 v[116:119], a[216:219], a[136:139], v[116:119]
 v_mfma_f32_16x16x32_bf16 v[116:119], a[220:223], a[140:143], v[116:119]
 v_mfma_f32_16x16x32_bf16 v[112:115], a[220:223], a[132:135], v[112:115]
 buffer_load_dwordx4 a[220:223], v0, s[12:15], s24 offen offset:3072
 v_mfma_f32_16x16x32_bf16 v[112:115], a[216:219], a[128:131], v[112:115]
 s_waitcnt vmcnt(13)
 v_mfma_f32_16x16x32_bf16 v[136:139], a[224:227], a[128:131], v[136:139]
 v_mfma_f32_16x16x32_bf16 v[136:139], a[228:231], a[132:135], v[136:139]
 buffer_load_dwordx4 a[216:219], v0, s[12:15], s24 offen offset:2048
 v_mfma_f32_16x16x32_bf16 v[140:143], a[228:231], a[140:143], v[140:143]
 v_mfma_f32_16x16x32_bf16 v[140:143], a[224:227], a[136:139], v[140:143]
 s_add_u32 s24, s24, 4096
 v_mfma_f32_16x16x32_bf16 v[144:147], a[224:227], a[144:147], v[144:147]
 v_mfma_f32_16x16x32_bf16 v[144:147], a[228:231], a[148:151], v[144:147]
 v_mfma_f32_16x16x32_bf16 v[148:151], a[228:231], a[156:159], v[148:151]
 v_mfma_f32_16x16x32_bf16 v[148:151], a[224:227], a[152:155], v[148:151]
 v_mfma_f32_16x16x32_bf16 v[152:155], a[224:227], a[160:163], v[152:155]
 v_mfma_f32_16x16x32_bf16 v[152:155], a[228:231], a[164:167], v[152:155]
 v_mfma_f32_16x16x32_bf16 v[156:159], a[228:231], a[172:175], v[156:159]
 v_mfma_f32_16x16x32_bf16 v[156:159], a[224:227], a[168:171], v[156:159]
 v_mfma_f32_16x16x32_bf16 v[160:163], a[224:227], a[176:179], v[160:163]
 v_mfma_f32_16x16x32_bf16 v[160:163], a[228:231], a[180:183], v[160:163]
 v_mfma_f32_16x16x32_bf16 v[164:167], a[228:231], a[188:191], v[164:167]
 buffer_load_dwordx4 a[228:231], v0, s[12:15], s24 offen offset:1024
 v_mfma_f32_16x16x32_bf16 v[164:167], a[224:227], a[184:187], v[164:167]
 s_waitcnt vmcnt(12)
 v_mfma_f32_16x16x32_bf16 v[196:199], a[232:235], a[184:187], v[196:199]
 v_mfma_f32_16x16x32_bf16 v[196:199], a[236:239], a[188:191], v[196:199]
 buffer_load_dwordx4 a[224:227], v0, s[12:15], s24 offen
 v_mfma_f32_16x16x32_bf16 v[192:195], a[236:239], a[180:183], v[192:195]
 v_mfma_f32_16x16x32_bf16 v[192:195], a[232:235], a[176:179], v[192:195]
 v_mfma_f32_16x16x32_bf16 v[188:191], a[232:235], a[168:171], v[188:191]
 v_mfma_f32_16x16x32_bf16 v[188:191], a[236:239], a[172:175], v[188:191]
 v_mfma_f32_16x16x32_bf16 v[184:187], a[236:239], a[164:167], v[184:187]
 v_mfma_f32_16x16x32_bf16 v[184:187], a[232:235], a[160:163], v[184:187]
 v_mfma_f32_16x16x32_bf16 v[180:183], a[232:235], a[152:155], v[180:183]
 v_mfma_f32_16x16x32_bf16 v[180:183], a[236:239], a[156:159], v[180:183]
 v_mfma_f32_16x16x32_bf16 v[176:179], a[236:239], a[148:151], v[176:179]
 v_mfma_f32_16x16x32_bf16 v[176:179], a[232:235], a[144:147], v[176:179]
 v_mfma_f32_16x16x32_bf16 v[172:175], a[232:235], a[136:139], v[172:175]
 v_mfma_f32_16x16x32_bf16 v[172:175], a[236:239], a[140:143], v[172:175]
 v_mfma_f32_16x16x32_bf16 v[168:171], a[236:239], a[132:135], v[168:171]
 buffer_load_dwordx4 a[236:239], v0, s[12:15], s24 offen offset:3072
 v_mfma_f32_16x16x32_bf16 v[168:171], a[232:235], a[128:131], v[168:171]
 s_waitcnt vmcnt(11)
 v_mfma_f32_16x16x32_bf16 v[200:203], a[192:195], a[128:131], v[200:203]
 v_mfma_f32_16x16x32_bf16 v[200:203], a[196:199], a[132:135], v[200:203]
 buffer_load_dwordx4 a[232:235], v0, s[12:15], s24 offen offset:2048
 v_mfma_f32_16x16x32_bf16 v[204:207], a[196:199], a[140:143], v[204:207]
 v_mfma_f32_16x16x32_bf16 v[204:207], a[192:195], a[136:139], v[204:207]
 s_add_u32 s24, s24, 4096
 v_mfma_f32_16x16x32_bf16 v[208:211], a[192:195], a[144:147], v[208:211]
 v_mfma_f32_16x16x32_bf16 v[208:211], a[196:199], a[148:151], v[208:211]
 v_mfma_f32_16x16x32_bf16 v[212:215], a[196:199], a[156:159], v[212:215]
 v_mfma_f32_16x16x32_bf16 v[212:215], a[192:195], a[152:155], v[212:215]
 v_mfma_f32_16x16x32_bf16 v[216:219], a[192:195], a[160:163], v[216:219]
 v_mfma_f32_16x16x32_bf16 v[216:219], a[196:199], a[164:167], v[216:219]
 v_mfma_f32_16x16x32_bf16 v[220:223], a[196:199], a[172:175], v[220:223]
 v_mfma_f32_16x16x32_bf16 v[220:223], a[192:195], a[168:171], v[220:223]
 v_mfma_f32_16x16x32_bf16 v[224:227], a[192:195], a[176:179], v[224:227]
 v_mfma_f32_16x16x32_bf16 v[224:227], a[196:199], a[180:183], v[224:227]
 v_mfma_f32_16x16x32_bf16 v[228:231], a[196:199], a[188:191], v[228:231]
 buffer_load_dwordx4 a[196:199], v0, s[12:15], s24 offen offset:1024
 v_mfma_f32_16x16x32_bf16 v[228:231], a[192:195], a[184:187], v[228:231]
 s_waitcnt vmcnt(11)
 v_mfma_f32_16x16x32_bf16 a[252:255], a[200:203], a[184:187], a[252:255]
 ds_read_b128 a[184:187], v2 offset:63488
 v_mfma_f32_16x16x32_bf16 a[252:255], a[204:207], a[188:191], a[252:255]
 buffer_load_dwordx4 a[192:195], v0, s[12:15], s24 offen
 ds_read_b128 a[188:191], v2 offset:64512
 v_mfma_f32_16x16x32_bf16 a[248:251], a[204:207], a[180:183], a[248:251]
 ds_read_b128 a[180:183], v2 offset:60416
 v_mfma_f32_16x16x32_bf16 a[248:251], a[200:203], a[176:179], a[248:251]
 ds_read_b128 a[176:179], v2 offset:59392
 v_mfma_f32_16x16x32_bf16 v[252:255], a[200:203], a[168:171], v[252:255]
 ds_read_b128 a[168:171], v2 offset:55296
 v_mfma_f32_16x16x32_bf16 v[252:255], a[204:207], a[172:175], v[252:255]
 ds_read_b128 a[172:175], v2 offset:56320
 v_mfma_f32_16x16x32_bf16 v[248:251], a[204:207], a[164:167], v[248:251]
 ds_read_b128 a[164:167], v2 offset:52224
 v_mfma_f32_16x16x32_bf16 v[248:251], a[200:203], a[160:163], v[248:251]
 ds_read_b128 a[160:163], v2 offset:51200
 v_mfma_f32_16x16x32_bf16 v[244:247], a[200:203], a[152:155], v[244:247]
 ds_read_b128 a[152:155], v2 offset:47104
 v_mfma_f32_16x16x32_bf16 v[244:247], a[204:207], a[156:159], v[244:247]
 ds_read_b128 a[156:159], v2 offset:48128
 v_mfma_f32_16x16x32_bf16 v[240:243], a[204:207], a[148:151], v[240:243]
 ds_read_b128 a[148:151], v2 offset:44032
 v_mfma_f32_16x16x32_bf16 v[240:243], a[200:203], a[144:147], v[240:243]
 ds_read_b128 a[144:147], v2 offset:43008
 v_mfma_f32_16x16x32_bf16 v[236:239], a[200:203], a[136:139], v[236:239]
 ds_read_b128 a[136:139], v2 offset:38912
 v_mfma_f32_16x16x32_bf16 v[236:239], a[204:207], a[140:143], v[236:239]
 ds_read_b128 a[140:143], v2 offset:39936
 v_mfma_f32_16x16x32_bf16 v[232:235], a[204:207], a[132:135], v[232:235]
 ds_read_b128 a[132:135], v2 offset:35840
 v_mfma_f32_16x16x32_bf16 v[232:235], a[200:203], a[128:131], v[232:235]
 ds_read_b128 a[128:131], v2 offset:34816
 s_waitcnt vmcnt(8) lgkmcnt(8)
 v_mfma_f32_16x16x32_bf16 v[44:47], a[208:211], a[184:187], v[44:47]
 v_mfma_f32_16x16x32_bf16 v[44:47], a[212:215], a[188:191], v[44:47]
 buffer_load_dwordx4 a[204:207], v0, s[12:15], s24 offen offset:3072
 v_mfma_f32_16x16x32_bf16 v[40:43], a[212:215], a[180:183], v[40:43]
 buffer_load_dword v4, off, s[64:67], 0 sc1
 v_mfma_f32_16x16x32_bf16 v[40:43], a[208:211], a[176:179], v[40:43]
 buffer_load_dwordx4 a[200:203], v0, s[12:15], s24 offen offset:2048
 v_mfma_f32_16x16x32_bf16 v[36:39], a[208:211], a[168:171], v[36:39]
 s_add_u32 s24, s24, 4096
 v_mfma_f32_16x16x32_bf16 v[36:39], a[212:215], a[172:175], v[36:39]
 v_mfma_f32_16x16x32_bf16 v[32:35], a[212:215], a[164:167], v[32:35]
 v_mfma_f32_16x16x32_bf16 v[32:35], a[208:211], a[160:163], v[32:35]
 s_waitcnt lgkmcnt(0)
 v_mfma_f32_16x16x32_bf16 v[28:31], a[208:211], a[152:155], v[28:31]
 v_mfma_f32_16x16x32_bf16 v[28:31], a[212:215], a[156:159], v[28:31]
 v_mfma_f32_16x16x32_bf16 v[24:27], a[212:215], a[148:151], v[24:27]
 v_mfma_f32_16x16x32_bf16 v[24:27], a[208:211], a[144:147], v[24:27]
 v_mfma_f32_16x16x32_bf16 v[20:23], a[208:211], a[136:139], v[20:23]
 v_mfma_f32_16x16x32_bf16 v[20:23], a[212:215], a[140:143], v[20:23]
 v_mfma_f32_16x16x32_bf16 v[16:19], a[212:215], a[132:135], v[16:19]
 buffer_load_dwordx4 a[212:215], v0, s[12:15], s24 offen offset:1024
 v_mfma_f32_16x16x32_bf16 v[16:19], a[208:211], a[128:131], v[16:19]
 s_waitcnt vmcnt(10)
 v_mfma_f32_16x16x32_bf16 v[48:51], a[216:219], a[128:131], v[48:51]
 v_lshrrev_b32 v5, 6, v1
 v_mfma_f32_16x16x32_bf16 v[48:51], a[220:223], a[132:135], v[48:51]
 buffer_load_dwordx4 a[208:211], v0, s[12:15], s24 offen
 v_mfma_f32_16x16x32_bf16 v[52:55], a[220:223], a[140:143], v[52:55]
 v_and_b32 v6, 48, v1
 v_mfma_f32_16x16x32_bf16 v[52:55], a[216:219], a[136:139], v[52:55]
 v_lshl_add_u32 v5, v5, 11, v6
 v_mfma_f32_16x16x32_bf16 v[56:59], a[216:219], a[144:147], v[56:59]
 v_mfma_f32_16x16x32_bf16 v[56:59], a[220:223], a[148:151], v[56:59]
 s_mov_b32 m0, s52
 v_mfma_f32_16x16x32_bf16 v[60:63], a[220:223], a[156:159], v[60:63]
 s_add_u32 s3, s48, 31744
 v_mfma_f32_16x16x32_bf16 v[60:63], a[216:219], a[152:155], v[60:63]
 buffer_load_dwordx4 v5, s[40:43], s48 offen lds
 v_mfma_f32_16x16x32_bf16 v[64:67], a[216:219], a[160:163], v[64:67]
 v_mfma_f32_16x16x32_bf16 v[64:67], a[220:223], a[164:167], v[64:67]
 buffer_load_dwordx4 v5, s[40:43], s3 offen offset:1024 lds
 v_mfma_f32_16x16x32_bf16 v[68:71], a[220:223], a[172:175], v[68:71]
 s_add_u32 s48, s48, 2097152
 v_mfma_f32_16x16x32_bf16 v[68:71], a[216:219], a[168:171], v[68:71]
 v_mfma_f32_16x16x32_bf16 v[72:75], a[216:219], a[176:179], v[72:75]
 v_mfma_f32_16x16x32_bf16 v[72:75], a[220:223], a[180:183], v[72:75]
 v_mfma_f32_16x16x32_bf16 v[76:79], a[220:223], a[188:191], v[76:79]
 buffer_load_dwordx4 a[220:223], v0, s[12:15], s24 offen offset:3072
 v_mfma_f32_16x16x32_bf16 v[76:79], a[216:219], a[184:187], v[76:79]
 s_waitcnt vmcnt(12)
 v_mfma_f32_16x16x32_bf16 v[108:111], a[224:227], a[184:187], v[108:111]
 v_mfma_f32_16x16x32_bf16 v[108:111], a[228:231], a[188:191], v[108:111]
 buffer_load_dwordx4 a[216:219], v0, s[12:15], s24 offen offset:2048
 v_mfma_f32_16x16x32_bf16 v[104:107], a[228:231], a[180:183], v[104:107]
 v_mfma_f32_16x16x32_bf16 v[104:107], a[224:227], a[176:179], v[104:107]
 s_add_u32 s24, s24, 4096
 v_mfma_f32_16x16x32_bf16 v[100:103], a[224:227], a[168:171], v[100:103]
 v_mfma_f32_16x16x32_bf16 v[100:103], a[228:231], a[172:175], v[100:103]
 v_mfma_f32_16x16x32_bf16 v[96:99], a[228:231], a[164:167], v[96:99]
 v_mfma_f32_16x16x32_bf16 v[96:99], a[224:227], a[160:163], v[96:99]
 v_mfma_f32_16x16x32_bf16 v[92:95], a[224:227], a[152:155], v[92:95]
 v_mfma_f32_16x16x32_bf16 v[92:95], a[228:231], a[156:159], v[92:95]
 v_mfma_f32_16x16x32_bf16 v[88:91], a[228:231], a[148:151], v[88:91]
 v_mfma_f32_16x16x32_bf16 v[88:91], a[224:227], a[144:147], v[88:91]
 v_mfma_f32_16x16x32_bf16 v[84:87], a[224:227], a[136:139], v[84:87]
 v_mfma_f32_16x16x32_bf16 v[84:87], a[228:231], a[140:143], v[84:87]
 v_mfma_f32_16x16x32_bf16 v[80:83], a[228:231], a[132:135], v[80:83]
 buffer_load_dwordx4 a[228:231], v0, s[12:15], s24 offen offset:1024
 v_mfma_f32_16x16x32_bf16 v[80:83], a[224:227], a[128:131], v[80:83]
 s_waitcnt vmcnt(12)
 v_mfma_f32_16x16x32_bf16 v[112:115], a[232:235], a[128:131], v[112:115]
 v_mfma_f32_16x16x32_bf16 v[112:115], a[236:239], a[132:135], v[112:115]
 buffer_load_dwordx4 a[224:227], v0, s[12:15], s24 offen
 v_mfma_f32_16x16x32_bf16 v[116:119], a[236:239], a[140:143], v[116:119]
 v_mfma_f32_16x16x32_bf16 v[116:119], a[232:235], a[136:139], v[116:119]
 v_mfma_f32_16x16x32_bf16 v[120:123], a[232:235], a[144:147], v[120:123]
 v_mfma_f32_16x16x32_bf16 v[120:123], a[236:239], a[148:151], v[120:123]
 v_mfma_f32_16x16x32_bf16 v[124:127], a[236:239], a[156:159], v[124:127]
 v_mfma_f32_16x16x32_bf16 v[124:127], a[232:235], a[152:155], v[124:127]
 v_mfma_f32_16x16x32_bf16 v[128:131], a[232:235], a[160:163], v[128:131]
 v_mfma_f32_16x16x32_bf16 v[128:131], a[236:239], a[164:167], v[128:131]
 v_mfma_f32_16x16x32_bf16 v[132:135], a[236:239], a[172:175], v[132:135]
 v_mfma_f32_16x16x32_bf16 v[132:135], a[232:235], a[168:171], v[132:135]
 v_mfma_f32_16x16x32_bf16 a[240:243], a[232:235], a[176:179], a[240:243]
 v_mfma_f32_16x16x32_bf16 a[240:243], a[236:239], a[180:183], a[240:243]
 v_mfma_f32_16x16x32_bf16 a[244:247], a[236:239], a[188:191], a[244:247]
 buffer_load_dwordx4 a[236:239], v0, s[12:15], s24 offen offset:3072
 v_mfma_f32_16x16x32_bf16 a[244:247], a[232:235], a[184:187], a[244:247]
 s_waitcnt vmcnt(12)
 v_mfma_f32_16x16x32_bf16 v[164:167], a[192:195], a[184:187], v[164:167]
 v_mfma_f32_16x16x32_bf16 v[164:167], a[196:199], a[188:191], v[164:167]
 buffer_load_dwordx4 a[232:235], v0, s[12:15], s24 offen offset:2048
 v_mfma_f32_16x16x32_bf16 v[160:163], a[196:199], a[180:183], v[160:163]
 v_mfma_f32_16x16x32_bf16 v[160:163], a[192:195], a[176:179], v[160:163]
 s_add_u32 s24, s24, 4096
 v_mfma_f32_16x16x32_bf16 v[156:159], a[192:195], a[168:171], v[156:159]
 v_mfma_f32_16x16x32_bf16 v[156:159], a[196:199], a[172:175], v[156:159]
 v_mfma_f32_16x16x32_bf16 v[152:155], a[196:199], a[164:167], v[152:155]
 v_mfma_f32_16x16x32_bf16 v[152:155], a[192:195], a[160:163], v[152:155]
 v_mfma_f32_16x16x32_bf16 v[148:151], a[192:195], a[152:155], v[148:151]
 v_mfma_f32_16x16x32_bf16 v[148:151], a[196:199], a[156:159], v[148:151]
 v_mfma_f32_16x16x32_bf16 v[144:147], a[196:199], a[148:151], v[144:147]
 v_mfma_f32_16x16x32_bf16 v[144:147], a[192:195], a[144:147], v[144:147]
 v_mfma_f32_16x16x32_bf16 v[140:143], a[192:195], a[136:139], v[140:143]
 v_mfma_f32_16x16x32_bf16 v[140:143], a[196:199], a[140:143], v[140:143]
 v_mfma_f32_16x16x32_bf16 v[136:139], a[196:199], a[132:135], v[136:139]
 buffer_load_dwordx4 a[196:199], v0, s[12:15], s24 offen offset:1024
 v_mfma_f32_16x16x32_bf16 v[136:139], a[192:195], a[128:131], v[136:139]
 s_waitcnt vmcnt(11)
 v_mfma_f32_16x16x32_bf16 v[168:171], a[200:203], a[128:131], v[168:171]
 v_mfma_f32_16x16x32_bf16 v[168:171], a[204:207], a[132:135], v[168:171]
 buffer_load_dwordx4 a[192:195], v0, s[12:15], s24 offen
 v_mfma_f32_16x16x32_bf16 v[172:175], a[204:207], a[140:143], v[172:175]
 v_mfma_f32_16x16x32_bf16 v[172:175], a[200:203], a[136:139], v[172:175]
 v_mfma_f32_16x16x32_bf16 v[176:179], a[200:203], a[144:147], v[176:179]
 v_mfma_f32_16x16x32_bf16 v[176:179], a[204:207], a[148:151], v[176:179]
 v_mfma_f32_16x16x32_bf16 v[180:183], a[204:207], a[156:159], v[180:183]
 v_mfma_f32_16x16x32_bf16 v[180:183], a[200:203], a[152:155], v[180:183]
 v_mfma_f32_16x16x32_bf16 v[184:187], a[200:203], a[160:163], v[184:187]
 v_mfma_f32_16x16x32_bf16 v[184:187], a[204:207], a[164:167], v[184:187]
 v_mfma_f32_16x16x32_bf16 v[188:191], a[204:207], a[172:175], v[188:191]
 v_mfma_f32_16x16x32_bf16 v[188:191], a[200:203], a[168:171], v[188:191]
 v_mfma_f32_16x16x32_bf16 v[192:195], a[200:203], a[176:179], v[192:195]
 v_mfma_f32_16x16x32_bf16 v[192:195], a[204:207], a[180:183], v[192:195]
 v_mfma_f32_16x16x32_bf16 v[196:199], a[204:207], a[188:191], v[196:199]
 buffer_load_dwordx4 a[204:207], v0, s[12:15], s24 offen offset:3072
 v_mfma_f32_16x16x32_bf16 v[196:199], a[200:203], a[184:187], v[196:199]
 s_waitcnt vmcnt(11)
 v_mfma_f32_16x16x32_bf16 v[228:231], a[208:211], a[184:187], v[228:231]
 v_mfma_f32_16x16x32_bf16 v[228:231], a[212:215], a[188:191], v[228:231]
 buffer_load_dwordx4 a[200:203], v0, s[12:15], s24 offen offset:2048
 v_mfma_f32_16x16x32_bf16 v[224:227], a[212:215], a[180:183], v[224:227]
 v_mfma_f32_16x16x32_bf16 v[224:227], a[208:211], a[176:179], v[224:227]
 s_add_u32 s24, s24, 4096
 v_mfma_f32_16x16x32_bf16 v[220:223], a[208:211], a[168:171], v[220:223]
 v_mfma_f32_16x16x32_bf16 v[220:223], a[212:215], a[172:175], v[220:223]
 v_mfma_f32_16x16x32_bf16 v[216:219], a[212:215], a[164:167], v[216:219]
 v_mfma_f32_16x16x32_bf16 v[216:219], a[208:211], a[160:163], v[216:219]
 v_mfma_f32_16x16x32_bf16 v[212:215], a[208:211], a[152:155], v[212:215]
 v_mfma_f32_16x16x32_bf16 v[212:215], a[212:215], a[156:159], v[212:215]
 v_mfma_f32_16x16x32_bf16 v[208:211], a[212:215], a[148:151], v[208:211]
 v_cmp_gt_u32 vcc, s55, v4
 s_cbranch_vccnz Lspin_pb
Lok_pb:
 s_add_u32 s55, s55, 1
 s_waitcnt lgkmcnt(0)
 s_barrier
 v_mfma_f32_16x16x32_bf16 v[208:211], a[208:211], a[144:147], v[208:211]
 v_mfma_f32_16x16x32_bf16 v[204:207], a[208:211], a[136:139], v[204:207]
 v_mfma_f32_16x16x32_bf16 v[204:207], a[212:215], a[140:143], v[204:207]
 v_mfma_f32_16x16x32_bf16 v[200:203], a[212:215], a[132:135], v[200:203]
 buffer_load_dwordx4 a[212:215], v0, s[12:15], s24 offen offset:1024
 v_mfma_f32_16x16x32_bf16 v[200:203], a[208:211], a[128:131], v[200:203]
 s_waitcnt vmcnt(9)
 v_mfma_f32_16x16x32_bf16 v[232:235], a[216:219], a[128:131], v[232:235]
 ds_read_b128 a[128:131], v1
 v_mfma_f32_16x16x32_bf16 v[232:235], a[220:223], a[132:135], v[232:235]
 buffer_load_dwordx4 a[208:211], v0, s[12:15], s24 offen
 ds_read_b128 a[132:135], v1 offset:1024
 v_mfma_f32_16x16x32_bf16 v[236:239], a[220:223], a[140:143], v[236:239]
 ds_read_b128 a[140:143], v1 offset:5120
 v_mfma_f32_16x16x32_bf16 v[236:239], a[216:219], a[136:139], v[236:239]
 ds_read_b128 a[136:139], v1 offset:4096
 v_mfma_f32_16x16x32_bf16 v[240:243], a[216:219], a[144:147], v[240:243]
 ds_read_b128 a[144:147], v1 offset:8192
 v_mfma_f32_16x16x32_bf16 v[240:243], a[220:223], a[148:151], v[240:243]
 ds_read_b128 a[148:151], v1 offset:9216
 v_mfma_f32_16x16x32_bf16 v[244:247], a[220:223], a[156:159], v[244:247]
 ds_read_b128 a[156:159], v1 offset:13312
 v_mfma_f32_16x16x32_bf16 v[244:247], a[216:219], a[152:155], v[244:247]
 ds_read_b128 a[152:155], v1 offset:12288
 v_mfma_f32_16x16x32_bf16 v[248:251], a[216:219], a[160:163], v[248:251]
 ds_read_b128 a[160:163], v1 offset:16384
 v_mfma_f32_16x16x32_bf16 v[248:251], a[220:223], a[164:167], v[248:251]
 ds_read_b128 a[164:167], v1 offset:17408
 v_mfma_f32_16x16x32_bf16 v[252:255], a[220:223], a[172:175], v[252:255]
 ds_read_b128 a[172:175], v1 offset:21504
 v_mfma_f32_16x16x32_bf16 v[252:255], a[216:219], a[168:171], v[252:255]
 ds_read_b128 a[168:171], v1 offset:20480
 v_mfma_f32_16x16x32_bf16 a[248:251], a[216:219], a[176:179], a[248:251]
 ds_read_b128 a[176:179], v1 offset:24576
 v_mfma_f32_16x16x32_bf16 a[248:251], a[220:223], a[180:183], a[248:251]
 ds_read_b128 a[180:183], v1 offset:25600
 v_mfma_f32_16x16x32_bf16 a[252:255], a[220:223], a[188:191], a[252:255]
 buffer_load_dwordx4 a[220:223], v0, s[12:15], s24 offen offset:3072
 ds_read_b128 a[188:191], v1 offset:29696
 v_mfma_f32_16x16x32_bf16 a[252:255], a[216:219], a[184:187], a[252:255]
 buffer_load_dwordx4 a[216:219], v0, s[12:15], s24 offen offset:2048
 s_add_u32 s24, s24, 4096
 ds_read_b128 a[184:187], v1 offset:28672
 s_waitcnt vmcnt(10) lgkmcnt(8)
 v_mfma_f32_16x16x32_bf16 v[16:19], a[224:227], a[128:131], v[16:19]
 s_add_u32 m0, s50, 2048
 v_mfma_f32_16x16x32_bf16 v[16:19], a[228:231], a[132:135], v[16:19]
 v_mfma_f32_16x16x32_bf16 v[20:23], a[228:231], a[140:143], v[20:23]
 v_mfma_f32_16x16x32_bf16 v[20:23], a[224:227], a[136:139], v[20:23]
 v_mfma_f32_16x16x32_bf16 v[24:27], a[224:227], a[144:147], v[24:27]
 v_mfma_f32_16x16x32_bf16 v[24:27], a[228:231], a[148:151], v[24:27]
 v_mfma_f32_16x16x32_bf16 v[28:31], a[228:231], a[156:159], v[28:31]
 s_nop 0
 v_mfma_f32_16x16x32_bf16 v[28:31], a[224:227], a[152:155], v[28:31]
 s_waitcnt lgkmcnt(0)
 v_mfma_f32_16x16x32_bf16 v[32:35], a[224:227], a[160:163], v[32:35]
 v_mfma_f32_16x16x32_bf16 v[32:35], a[228:231], a[164:167], v[32:35]
 v_mfma_f32_16x16x32_bf16 v[36:39], a[228:231], a[172:175], v[36:39]
 v_mfma_f32_16x16x32_bf16 v[36:39], a[224:227], a[168:171], v[36:39]
 v_mfma_f32_16x16x32_bf16 v[40:43], a[224:227], a[176:179], v[40:43]
 v_mfma_f32_16x16x32_bf16 v[40:43], a[228:231], a[180:183], v[40:43]
 v_mfma_f32_16x16x32_bf16 v[44:47], a[228:231], a[188:191], v[44:47]
 buffer_load_dwordx4 a[228:231], v0, s[12:15], s24 offen offset:1024
 v_mfma_f32_16x16x32_bf16 v[44:47], a[224:227], a[184:187], v[44:47]
 s_waitcnt vmcnt(9)
 v_mfma_f32_16x16x32_bf16 v[76:79], a[232:235], a[184:187], v[76:79]
 buffer_load_dwordx4 v3, s[32:35], s30 offen sc1 lds
 v_mfma_f32_16x16x32_bf16 v[76:79], a[236:239], a[188:191], v[76:79]
 buffer_load_dwordx4 a[224:227], v0, s[12:15], s24 offen
 v_mfma_f32_16x16x32_bf16 v[72:75], a[236:239], a[180:183], v[72:75]
 v_mfma_f32_16x16x32_bf16 v[72:75], a[232:235], a[176:179], v[72:75]
 v_mfma_f32_16x16x32_bf16 v[68:71], a[232:235], a[168:171], v[68:71]
 v_mfma_f32_16x16x32_bf16 v[68:71], a[236:239], a[172:175], v[68:71]
 v_mfma_f32_16x16x32_bf16 v[64:67], a[236:239], a[164:167], v[64:67]
 v_mfma_f32_16x16x32_bf16 v[64:67], a[232:235], a[160:163], v[64:67]
 v_mfma_f32_16x16x32_bf16 v[60:63], a[232:235], a[152:155], v[60:63]
 buffer_load_dwordx4 v3, s[32:35], s30 offen offset:1024 sc1 lds
 v_mfma_f32_16x16x32_bf16 v[60:63], a[236:239], a[156:159], v[60:63]
 v_mfma_f32_16x16x32_bf16 v[56:59], a[236:239], a[148:151], v[56:59]
 v_mfma_f32_16x16x32_bf16 v[56:59], a[232:235], a[144:147], v[56:59]
 v_mfma_f32_16x16x32_bf16 v[52:55], a[232:235], a[136:139], v[52:55]
 v_mfma_f32_16x16x32_bf16 v[52:55], a[236:239], a[140:143], v[52:55]
 v_mfma_f32_16x16x32_bf16 v[48:51], a[236:239], a[132:135], v[48:51]
 buffer_load_dwordx4 a[236:239], v0, s[12:15], s24 offen offset:3072
 v_mfma_f32_16x16x32_bf16 v[48:51], a[232:235], a[128:131], v[48:51]
 s_waitcnt vmcnt(11)
 v_mfma_f32_16x16x32_bf16 v[80:83], a[192:195], a[128:131], v[80:83]
 v_mfma_f32_16x16x32_bf16 v[80:83], a[196:199], a[132:135], v[80:83]
 buffer_load_dwordx4 a[232:235], v0, s[12:15], s24 offen offset:2048
 v_mfma_f32_16x16x32_bf16 v[84:87], a[196:199], a[140:143], v[84:87]
 s_add_u32 m0, m0, 4096
 v_mfma_f32_16x16x32_bf16 v[84:87], a[192:195], a[136:139], v[84:87]
 s_add_u32 s24, s24, 4096
 v_mfma_f32_16x16x32_bf16 v[88:91], a[192:195], a[144:147], v[88:91]
 v_mfma_f32_16x16x32_bf16 v[88:91], a[196:199], a[148:151], v[88:91]
 v_mfma_f32_16x16x32_bf16 v[92:95], a[196:199], a[156:159], v[92:95]
 v_mfma_f32_16x16x32_bf16 v[92:95], a[192:195], a[152:155], v[92:95]
 v_mfma_f32_16x16x32_bf16 v[96:99], a[192:195], a[160:163], v[96:99]
 v_mfma_f32_16x16x32_bf16 v[96:99], a[196:199], a[164:167], v[96:99]
 s_add_u32 s30, s30, 2048
 v_mfma_f32_16x16x32_bf16 v[100:103], a[196:199], a[172:175], v[100:103]
 v_mfma_f32_16x16x32_bf16 v[100:103], a[192:195], a[168:171], v[100:103]
 v_mfma_f32_16x16x32_bf16 v[104:107], a[192:195], a[176:179], v[104:107]
 v_mfma_f32_16x16x32_bf16 v[104:107], a[196:199], a[180:183], v[104:107]
 v_mfma_f32_16x16x32_bf16 v[108:111], a[196:199], a[188:191], v[108:111]
 buffer_load_dwordx4 a[196:199], v0, s[12:15], s24 offen offset:1024
 v_mfma_f32_16x16x32_bf16 v[108:111], a[192:195], a[184:187], v[108:111]
 s_waitcnt vmcnt(11)
 v_mfma_f32_16x16x32_bf16 a[244:247], a[200:203], a[184:187], a[244:247]
 v_mfma_f32_16x16x32_bf16 a[244:247], a[204:207], a[188:191], a[244:247]
 buffer_load_dwordx4 a[192:195], v0, s[12:15], s24 offen
 v_mfma_f32_16x16x32_bf16 a[240:243], a[204:207], a[180:183], a[240:243]
 v_mfma_f32_16x16x32_bf16 a[240:243], a[200:203], a[176:179], a[240:243]
 buffer_load_dwordx4 v3, s[32:35], s30 offen sc1 lds
 v_mfma_f32_16x16x32_bf16 v[132:135], a[200:203], a[168:171], v[132:135]
 v_mfma_f32_16x16x32_bf16 v[132:135], a[204:207], a[172:175], v[132:135]
 v_mfma_f32_16x16x32_bf16 v[128:131], a[204:207], a[164:167], v[128:131]
 v_mfma_f32_16x16x32_bf16 v[128:131], a[200:203], a[160:163], v[128:131]
 v_mfma_f32_16x16x32_bf16 v[124:127], a[200:203], a[152:155], v[124:127]
 v_mfma_f32_16x16x32_bf16 v[124:127], a[204:207], a[156:159], v[124:127]
 v_mfma_f32_16x16x32_bf16 v[120:123], a[204:207], a[148:151], v[120:123]
 buffer_load_dwordx4 v3, s[32:35], s30 offen offset:1024 sc1 lds
 v_mfma_f32_16x16x32_bf16 v[120:123], a[200:203], a[144:147], v[120:123]
 v_mfma_f32_16x16x32_bf16 v[116:119], a[200:203], a[136:139], v[116:119]
 v_mfma_f32_16x16x32_bf16 v[116:119], a[204:207], a[140:143], v[116:119]
 v_mfma_f32_16x16x32_bf16 v[112:115], a[204:207], a[132:135], v[112:115]
 buffer_load_dwordx4 a[204:207], v0, s[12:15], s24 offen offset:3072
 v_mfma_f32_16x16x32_bf16 v[112:115], a[200:203], a[128:131], v[112:115]
 s_waitcnt vmcnt(13)
 v_mfma_f32_16x16x32_bf16 v[136:139], a[208:211], a[128:131], v[136:139]
 v_mfma_f32_16x16x32_bf16 v[136:139], a[212:215], a[132:135], v[136:139]
 buffer_load_dwordx4 a[200:203], v0, s[12:15], s24 offen offset:2048
 v_mfma_f32_16x16x32_bf16 v[140:143], a[212:215], a[140:143], v[140:143]
 v_mfma_f32_16x16x32_bf16 v[140:143], a[208:211], a[136:139], v[140:143]
 s_add_u32 s24, s24, 4096
 v_mfma_f32_16x16x32_bf16 v[144:147], a[208:211], a[144:147], v[144:147]
 v_mfma_f32_16x16x32_bf16 v[144:147], a[212:215], a[148:151], v[144:147]
 s_add_u32 m0, m0, 4096
 v_mfma_f32_16x16x32_bf16 v[148:151], a[212:215], a[156:159], v[148:151]
 v_mfma_f32_16x16x32_bf16 v[148:151], a[208:211], a[152:155], v[148:151]
 v_mfma_f32_16x16x32_bf16 v[152:155], a[208:211], a[160:163], v[152:155]
 v_mfma_f32_16x16x32_bf16 v[152:155], a[212:215], a[164:167], v[152:155]
 v_mfma_f32_16x16x32_bf16 v[156:159], a[212:215], a[172:175], v[156:159]
 v_mfma_f32_16x16x32_bf16 v[156:159], a[208:211], a[168:171], v[156:159]
 v_mfma_f32_16x16x32_bf16 v[160:163], a[208:211], a[176:179], v[160:163]
 s_add_u32 s30, s30, 2048
 v_mfma_f32_16x16x32_bf16 v[160:163], a[212:215], a[180:183], v[160:163]
 v_mfma_f32_16x16x32_bf16 v[164:167], a[212:215], a[188:191], v[164:167]
 buffer_load_dwordx4 a[212:215], v0, s[12:15], s24 offen offset:1024
 v_mfma_f32_16x16x32_bf16 v[164:167], a[208:211], a[184:187], v[164:167]
 s_waitcnt vmcnt(13)
 v_mfma_f32_16x16x32_bf16 v[196:199], a[216:219], a[184:187], v[196:199]
 v_mfma_f32_16x16x32_bf16 v[196:199], a[220:223], a[188:191], v[196:199]
 buffer_load_dwordx4 a[208:211], v0, s[12:15], s24 offen
 v_mfma_f32_16x16x32_bf16 v[192:195], a[220:223], a[180:183], v[192:195]
 v_mfma_f32_16x16x32_bf16 v[192:195], a[216:219], a[176:179], v[192:195]
 v_mfma_f32_16x16x32_bf16 v[188:191], a[216:219], a[168:171], v[188:191]
 v_mfma_f32_16x16x32_bf16 v[188:191], a[220:223], a[172:175], v[188:191]
 buffer_load_dwordx4 v3, s[32:35], s30 offen sc1 lds
 v_mfma_f32_16x16x32_bf16 v[184:187], a[220:223], a[164:167], v[184:187]
 v_mfma_f32_16x16x32_bf16 v[184:187], a[216:219], a[160:163], v[184:187]
 v_mfma_f32_16x16x32_bf16 v[180:183], a[216:219], a[152:155], v[180:183]
 v_mfma_f32_16x16x32_bf16 v[180:183], a[220:223], a[156:159], v[180:183]
 v_mfma_f32_16x16x32_bf16 v[176:179], a[220:223], a[148:151], v[176:179]
 v_mfma_f32_16x16x32_bf16 v[176:179], a[216:219], a[144:147], v[176:179]
 v_mfma_f32_16x16x32_bf16 v[172:175], a[216:219], a[136:139], v[172:175]
 buffer_load_dwordx4 v3, s[32:35], s30 offen offset:1024 sc1 lds
 v_mfma_f32_16x16x32_bf16 v[172:175], a[220:223], a[140:143], v[172:175]
 v_mfma_f32_16x16x32_bf16 v[168:171], a[220:223], a[132:135], v[168:171]
 buffer_load_dwordx4 a[220:223], v0, s[12:15], s24 offen offset:3072
 v_mfma_f32_16x16x32_bf16 v[168:171], a[216:219], a[128:131], v[168:171]
 s_waitcnt vmcnt(14)
 v_mfma_f32_16x16x32_bf16 v[200:203], a[224:227], a[128:131], v[200:203]
 v_mfma_f32_16x16x32_bf16 v[200:203], a[228:231], a[132:135], v[200:203]
 buffer_load_dwordx4 a[216:219], v0, s[12:15], s24 offen offset:2048
 v_mfma_f32_16x16x32_bf16 v[204:207], a[228:231], a[140:143], v[204:207]
 v_mfma_f32_16x16x32_bf16 v[204:207], a[224:227], a[136:139], v[204:207]
 s_add_u32 s24, s24, 4096
 v_mfma_f32_16x16x32_bf16 v[208:211], a[224:227], a[144:147], v[208:211]
 v_mfma_f32_16x16x32_bf16 v[208:211], a[228:231], a[148:151], v[208:211]
 v_mfma_f32_16x16x32_bf16 v[212:215], a[228:231], a[156:159], v[212:215]
 v_mfma_f32_16x16x32_bf16 v[212:215], a[224:227], a[152:155], v[212:215]
 s_add_u32 m0, m0, 4096
 v_mfma_f32_16x16x32_bf16 v[216:219], a[224:227], a[160:163], v[216:219]
 v_mfma_f32_16x16x32_bf16 v[216:219], a[228:231], a[164:167], v[216:219]
 v_mfma_f32_16x16x32_bf16 v[220:223], a[228:231], a[172:175], v[220:223]
 v_mfma_f32_16x16x32_bf16 v[220:223], a[224:227], a[168:171], v[220:223]
 v_mfma_f32_16x16x32_bf16 v[224:227], a[224:227], a[176:179], v[224:227]
 v_mfma_f32_16x16x32_bf16 v[224:227], a[228:231], a[180:183], v[224:227]
 v_mfma_f32_16x16x32_bf16 v[228:231], a[228:231], a[188:191], v[228:231]
 buffer_load_dwordx4 a[228:231], v0, s[12:15], s24 offen offset:1024
 v_mfma_f32_16x16x32_bf16 v[228:231], a[224:227], a[184:187], v[228:231]
 s_waitcnt vmcnt(13)
 v_mfma_f32_16x16x32_bf16 a[252:255], a[232:235], a[184:187], a[252:255]
 ds_read_b128 a[184:187], v1 offset:61440
 v_mfma_f32_16x16x32_bf16 a[252:255], a[236:239], a[188:191], a[252:255]
 buffer_load_dwordx4 a[224:227], v0, s[12:15], s24 offen
 ds_read_b128 a[188:191], v1 offset:62464
 v_mfma_f32_16x16x32_bf16 a[248:251], a[236:239], a[180:183], a[248:251]
 ds_read_b128 a[180:183], v1 offset:58368
 v_mfma_f32_16x16x32_bf16 a[248:251], a[232:235], a[176:179], a[248:251]
 ds_read_b128 a[176:179], v1 offset:57344
 v_mfma_f32_16x16x32_bf16 v[252:255], a[232:235], a[168:171], v[252:255]
 ds_read_b128 a[168:171], v1 offset:53248
 v_mfma_f32_16x16x32_bf16 v[252:255], a[236:239], a[172:175], v[252:255]
 ds_read_b128 a[172:175], v1 offset:54272
 v_mfma_f32_16x16x32_bf16 v[248:251], a[236:239], a[164:167], v[248:251]
 ds_read_b128 a[164:167], v1 offset:50176
 v_mfma_f32_16x16x32_bf16 v[248:251], a[232:235], a[160:163], v[248:251]
 ds_read_b128 a[160:163], v1 offset:49152
 v_mfma_f32_16x16x32_bf16 v[244:247], a[232:235], a[152:155], v[244:247]
 ds_read_b128 a[152:155], v1 offset:45056
 v_mfma_f32_16x16x32_bf16 v[244:247], a[236:239], a[156:159], v[244:247]
 ds_read_b128 a[156:159], v1 offset:46080
 v_mfma_f32_16x16x32_bf16 v[240:243], a[236:239], a[148:151], v[240:243]
 ds_read_b128 a[148:151], v1 offset:41984
 v_mfma_f32_16x16x32_bf16 v[240:243], a[232:235], a[144:147], v[240:243]
 ds_read_b128 a[144:147], v1 offset:40960
 v_mfma_f32_16x16x32_bf16 v[236:239], a[232:235], a[136:139], v[236:239]
 ds_read_b128 a[136:139], v1 offset:36864
 v_mfma_f32_16x16x32_bf16 v[236:239], a[236:239], a[140:143], v[236:239]
 ds_read_b128 a[140:143], v1 offset:37888
 v_mfma_f32_16x16x32_bf16 v[232:235], a[236:239], a[132:135], v[232:235]
 ds_read_b128 a[132:135], v1 offset:33792
 v_mfma_f32_16x16x32_bf16 v[232:235], a[232:235], a[128:131], v[232:235]
 ds_read_b128 a[128:131], v1 offset:32768
 s_waitcnt vmcnt(12) lgkmcnt(8)
 v_mfma_f32_16x16x32_bf16 v[44:47], a[192:195], a[184:187], v[44:47]
 s_add_u32 s30, s30, 2048
 v_mfma_f32_16x16x32_bf16 v[44:47], a[196:199], a[188:191], v[44:47]
 v_mfma_f32_16x16x32_bf16 v[40:43], a[196:199], a[180:183], v[40:43]
 v_mfma_f32_16x16x32_bf16 v[40:43], a[192:195], a[176:179], v[40:43]
 v_mfma_f32_16x16x32_bf16 v[36:39], a[192:195], a[168:171], v[36:39]
 v_mfma_f32_16x16x32_bf16 v[36:39], a[196:199], a[172:175], v[36:39]
 v_mfma_f32_16x16x32_bf16 v[32:35], a[196:199], a[164:167], v[32:35]
 v_mfma_f32_16x16x32_bf16 v[32:35], a[192:195], a[160:163], v[32:35]
 s_waitcnt lgkmcnt(0)
 v_mfma_f32_16x16x32_bf16 v[28:31], a[192:195], a[152:155], v[28:31]
 buffer_load_dwordx4 v3, s[32:35], s30 offen sc1 lds
 v_mfma_f32_16x16x32_bf16 v[28:31], a[196:199], a[156:159], v[28:31]
 v_mfma_f32_16x16x32_bf16 v[24:27], a[196:199], a[148:151], v[24:27]
 v_mfma_f32_16x16x32_bf16 v[24:27], a[192:195], a[144:147], v[24:27]
 v_mfma_f32_16x16x32_bf16 v[20:23], a[192:195], a[136:139], v[20:23]
 v_mfma_f32_16x16x32_bf16 v[20:23], a[196:199], a[140:143], v[20:23]
 v_mfma_f32_16x16x32_bf16 v[16:19], a[196:199], a[132:135], v[16:19]
 buffer_load_dwordx4 a[196:199], v0, s[12:15], s24 offen offset:3072
 v_mfma_f32_16x16x32_bf16 v[16:19], a[192:195], a[128:131], v[16:19]
 s_waitcnt vmcnt(10)
 v_mfma_f32_16x16x32_bf16 v[48:51], a[200:203], a[128:131], v[48:51]
 buffer_load_dwordx4 v3, s[32:35], s30 offen offset:1024 sc1 lds
 v_mfma_f32_16x16x32_bf16 v[48:51], a[204:207], a[132:135], v[48:51]
 buffer_load_dwordx4 a[192:195], v0, s[12:15], s24 offen offset:2048
 v_mfma_f32_16x16x32_bf16 v[52:55], a[204:207], a[140:143], v[52:55]
 v_mfma_f32_16x16x32_bf16 v[52:55], a[200:203], a[136:139], v[52:55]
 s_add_u32 s24, s24, 4096
 v_mfma_f32_16x16x32_bf16 v[56:59], a[200:203], a[144:147], v[56:59]
 v_mfma_f32_16x16x32_bf16 v[56:59], a[204:207], a[148:151], v[56:59]
 v_mfma_f32_16x16x32_bf16 v[60:63], a[204:207], a[156:159], v[60:63]
 v_mfma_f32_16x16x32_bf16 v[60:63], a[200:203], a[152:155], v[60:63]
 v_mfma_f32_16x16x32_bf16 v[64:67], a[200:203], a[160:163], v[64:67]
 v_mfma_f32_16x16x32_bf16 v[64:67], a[204:207], a[164:167], v[64:67]
 s_add_u32 m0, m0, 4096
 v_mfma_f32_16x16x32_bf16 v[68:71], a[204:207], a[172:175], v[68:71]
 v_mfma_f32_16x16x32_bf16 v[68:71], a[200:203], a[168:171], v[68:71]
 v_mfma_f32_16x16x32_bf16 v[72:75], a[200:203], a[176:179], v[72:75]
 v_mfma_f32_16x16x32_bf16 v[72:75], a[204:207], a[180:183], v[72:75]
 v_mfma_f32_16x16x32_bf16 v[76:79], a[204:207], a[188:191], v[76:79]
 buffer_load_dwordx4 a[204:207], v0, s[12:15], s24 offen offset:1024
 v_mfma_f32_16x16x32_bf16 v[76:79], a[200:203], a[184:187], v[76:79]
 s_waitcnt vmcnt(11)
 v_mfma_f32_16x16x32_bf16 v[108:111], a[208:211], a[184:187], v[108:111]
 v_mfma_f32_16x16x32_bf16 v[108:111], a[212:215], a[188:191], v[108:111]
 buffer_load_dwordx4 a[200:203], v0, s[12:15], s24 offen
 v_mfma_f32_16x16x32_bf16 v[104:107], a[212:215], a[180:183], v[104:107]
 v_mfma_f32_16x16x32_bf16 v[104:107], a[208:211], a[176:179], v[104:107]
 s_add_u32 s30, s30, 2048
 v_mfma_f32_16x16x32_bf16 v[100:103], a[208:211], a[168:171], v[100:103]
 v_mfma_f32_16x16x32_bf16 v[100:103], a[212:215], a[172:175], v[100:103]
 v_mfma_f32_16x16x32_bf16 v[96:99], a[212:215], a[164:167], v[96:99]
 v_mfma_f32_16x16x32_bf16 v[96:99], a[208:211], a[160:163], v[96:99]
 v_mfma_f32_16x16x32_bf16 v[92:95], a[208:211], a[152:155], v[92:95]
 v_mfma_f32_16x16x32_bf16 v[92:95], a[212:215], a[156:159], v[92:95]
 v_mfma_f32_16x16x32_bf16 v[88:91], a[212:215], a[148:151], v[88:91]
 buffer_load_dwordx4 v3, s[32:35], s30 offen sc1 lds
 v_mfma_f32_16x16x32_bf16 v[88:91], a[208:211], a[144:147], v[88:91]
 v_mfma_f32_16x16x32_bf16 v[84:87], a[208:211], a[136:139], v[84:87]
 v_mfma_f32_16x16x32_bf16 v[84:87], a[212:215], a[140:143], v[84:87]
 v_mfma_f32_16x16x32_bf16 v[80:83], a[212:215], a[132:135], v[80:83]
 buffer_load_dwordx4 a[212:215], v0, s[12:15], s24 offen offset:3072
 v_mfma_f32_16x16x32_bf16 v[80:83], a[208:211], a[128:131], v[80:83]
 s_waitcnt vmcnt(10)
 v_mfma_f32_16x16x32_bf16 v[112:115], a[216:219], a[128:131], v[112:115]
 v_mfma_f32_16x16x32_bf16 v[112:115], a[220:223], a[132:135], v[112:115]
 buffer_load_dwordx4 a[208:211], v0, s[12:15], s24 offen offset:2048
 v_mfma_f32_16x16x32_bf16 v[116:119], a[220:223], a[140:143], v[116:119]
 v_mfma_f32_16x16x32_bf16 v[116:119], a[216:219], a[136:139], v[116:119]
 s_add_u32 s24, s24, 4096
 v_mfma_f32_16x16x32_bf16 v[120:123], a[216:219], a[144:147], v[120:123]
 buffer_load_dwordx4 v3, s[32:35], s30 offen offset:1024 sc1 lds
 v_mfma_f32_16x16x32_bf16 v[120:123], a[220:223], a[148:151], v[120:123]
 v_mfma_f32_16x16x32_bf16 v[124:127], a[220:223], a[156:159], v[124:127]
 v_mfma_f32_16x16x32_bf16 v[124:127], a[216:219], a[152:155], v[124:127]
 v_mfma_f32_16x16x32_bf16 v[128:131], a[216:219], a[160:163], v[128:131]
 v_mfma_f32_16x16x32_bf16 v[128:131], a[220:223], a[164:167], v[128:131]
 v_mfma_f32_16x16x32_bf16 v[132:135], a[220:223], a[172:175], v[132:135]
 v_mfma_f32_16x16x32_bf16 v[132:135], a[216:219], a[168:171], v[132:135]
 s_add_u32 m0, m0, 4096
 v_mfma_f32_16x16x32_bf16 a[240:243], a[216:219], a[176:179], a[240:243]
 v_mfma_f32_16x16x32_bf16 a[240:243], a[220:223], a[180:183], a[240:243]
 v_mfma_f32_16x16x32_bf16 a[244:247], a[220:223], a[188:191], a[244:247]
 buffer_load_dwordx4 a[220:223], v0, s[12:15], s24 offen offset:1024
 v_mfma_f32_16x16x32_bf16 a[244:247], a[216:219], a[184:187], a[244:247]
 s_waitcnt vmcnt(11)
 v_mfma_f32_16x16x32_bf16 v[164:167], a[224:227], a[184:187], v[164:167]
 v_mfma_f32_16x16x32_bf16 v[164:167], a[228:231], a[188:191], v[164:167]
 buffer_load_dwordx4 a[216:219], v0, s[12:15], s24 offen
 v_mfma_f32_16x16x32_bf16 v[160:163], a[228:231], a[180:183], v[160:163]
 v_mfma_f32_16x16x32_bf16 v[160:163], a[224:227], a[176:179], v[160:163]
 v_mfma_f32_16x16x32_bf16 v[156:159], a[224:227], a[168:171], v[156:159]
 v_mfma_f32_16x16x32_bf16 v[156:159], a[228:231], a[172:175], v[156:159]
 s_add_u32 s30, s30, 2048
 v_mfma_f32_16x16x32_bf16 v[152:155], a[228:231], a[164:167], v[152:155]
 v_mfma_f32_16x16x32_bf16 v[152:155], a[224:227], a[160:163], v[152:155]
 v_mfma_f32_16x16x32_bf16 v[148:151], a[224:227], a[152:155], v[148:151]
 v_mfma_f32_16x16x32_bf16 v[148:151], a[228:231], a[156:159], v[148:151]
 v_mfma_f32_16x16x32_bf16 v[144:147], a[228:231], a[148:151], v[144:147]
 v_mfma_f32_16x16x32_bf16 v[144:147], a[224:227], a[144:147], v[144:147]
 v_mfma_f32_16x16x32_bf16 v[140:143], a[224:227], a[136:139], v[140:143]
 buffer_load_dwordx4 v3, s[32:35], s30 offen sc1 lds
 v_mfma_f32_16x16x32_bf16 v[140:143], a[228:231], a[140:143], v[140:143]
 v_mfma_f32_16x16x32_bf16 v[136:139], a[228:231], a[132:135], v[136:139]
 buffer_load_dwordx4 a[228:231], v0, s[12:15], s24 offen offset:3072
 v_mfma_f32_16x16x32_bf16 v[136:139], a[224:227], a[128:131], v[136:139]
 s_waitcnt vmcnt(10)
 v_mfma_f32_16x16x32_bf16 v[168:171], a[192:195], a[128:131], v[168:171]
 v_mfma_f32_16x16x32_bf16 v[168:171], a[196:199], a[132:135], v[168:171]
 buffer_load_dwordx4 a[224:227], v0, s[12:15], s24 offen offset:2048
 v_mfma_f32_16x16x32_bf16 v[172:175], a[196:199], a[140:143], v[172:175]
 v_mfma_f32_16x16x32_bf16 v[172:175], a[192:195], a[136:139], v[172:175]
 s_add_u32 s24, s24, 4096
 v_mfma_f32_16x16x32_bf16 v[176:179], a[192:195], a[144:147], v[176:179]
 v_mfma_f32_16x16x32_bf16 v[176:179], a[196:199], a[148:151], v[176:179]
 v_mfma_f32_16x16x32_bf16 v[180:183], a[196:199], a[156:159], v[180:183]
 v_mfma_f32_16x16x32_bf16 v[180:183], a[192:195], a[152:155], v[180:183]
 buffer_load_dwordx4 v3, s[32:35], s30 offen offset:1024 sc1 lds
 v_mfma_f32_16x16x32_bf16 v[184:187], a[192:195], a[160:163], v[184:187]
 v_mfma_f32_16x16x32_bf16 v[184:187], a[196:199], a[164:167], v[184:187]
 v_mfma_f32_16x16x32_bf16 v[188:191], a[196:199], a[172:175], v[188:191]
 v_mfma_f32_16x16x32_bf16 v[188:191], a[192:195], a[168:171], v[188:191]
 v_mfma_f32_16x16x32_bf16 v[192:195], a[192:195], a[176:179], v[192:195]
 v_mfma_f32_16x16x32_bf16 v[192:195], a[196:199], a[180:183], v[192:195]
 s_add_u32 m0, m0, 4096
 v_mfma_f32_16x16x32_bf16 v[196:199], a[196:199], a[188:191], v[196:199]
 buffer_load_dwordx4 a[196:199], v0, s[12:15], s24 offen offset:1024
 v_mfma_f32_16x16x32_bf16 v[196:199], a[192:195], a[184:187], v[196:199]
 s_waitcnt vmcnt(11)
 v_mfma_f32_16x16x32_bf16 v[228:231], a[200:203], a[184:187], v[228:231]
 v_mfma_f32_16x16x32_bf16 v[228:231], a[204:207], a[188:191], v[228:231]
 buffer_load_dwordx4 a[192:195], v0, s[12:15], s24 offen
 v_mfma_f32_16x16x32_bf16 v[224:227], a[204:207], a[180:183], v[224:227]
 v_mfma_f32_16x16x32_bf16 v[224:227], a[200:203], a[176:179], v[224:227]
 v_mfma_f32_16x16x32_bf16 v[220:223], a[200:203], a[168:171], v[220:223]
 v_mfma_f32_16x16x32_bf16 v[220:223], a[204:207], a[172:175], v[220:223]
 v_mfma_f32_16x16x32_bf16 v[216:219], a[204:207], a[164:167], v[216:219]
 v_mfma_f32_16x16x32_bf16 v[216:219], a[200:203], a[160:163], v[216:219]
 s_add_u32 s30, s30, 2048
 v_mfma_f32_16x16x32_bf16 v[212:215], a[200:203], a[152:155], v[212:215]
 v_mfma_f32_16x16x32_bf16 v[212:215], a[204:207], a[156:159], v[212:215]
 v_mfma_f32_16x16x32_bf16 v[208:211], a[204:207], a[148:151], v[208:211]
 v_mfma_f32_16x16x32_bf16 v[208:211], a[200:203], a[144:147], v[208:211]
 v_mfma_f32_16x16x32_bf16 v[204:207], a[200:203], a[136:139], v[204:207]
 v_mfma_f32_16x16x32_bf16 v[204:207], a[204:207], a[140:143], v[204:207]
 v_mfma_f32_16x16x32_bf16 v[200:203], a[204:207], a[132:135], v[200:203]
 buffer_load_dwordx4 a[204:207], v0, s[12:15], s24 offen offset:3072
 v_mfma_f32_16x16x32_bf16 v[200:203], a[200:203], a[128:131], v[200:203]
 s_waitcnt vmcnt(10)
 v_mfma_f32_16x16x32_bf16 v[232:235], a[208:211], a[128:131], v[232:235]
 ds_read_b128 a[128:131], v2
 v_mfma_f32_16x16x32_bf16 v[232:235], a[212:215], a[132:135], v[232:235]
 buffer_load_dwordx4 a[200:203], v0, s[12:15], s24 offen offset:2048
 ds_read_b128 a[132:135], v2 offset:1024
 v_mfma_f32_16x16x32_bf16 v[236:239], a[212:215], a[140:143], v[236:239]
 ds_read_b128 a[140:143], v2 offset:5120
 v_mfma_f32_16x16x32_bf16 v[236:239], a[208:211], a[136:139], v[236:239]
 s_add_u32 s24, s24, 4096
 ds_read_b128 a[136:139], v2 offset:4096
 v_mfma_f32_16x16x32_bf16 v[240:243], a[208:211], a[144:147], v[240:243]
 ds_read_b128 a[144:147], v2 offset:8192
 v_mfma_f32_16x16x32_bf16 v[240:243], a[212:215], a[148:151], v[240:243]
 ds_read_b128 a[148:151], v2 offset:9216
 v_mfma_f32_16x16x32_bf16 v[244:247], a[212:215], a[156:159], v[244:247]
 ds_read_b128 a[156:159], v2 offset:13312
 v_mfma_f32_16x16x32_bf16 v[244:247], a[208:211], a[152:155], v[244:247]
 ds_read_b128 a[152:155], v2 offset:12288
 v_mfma_f32_16x16x32_bf16 v[248:251], a[208:211], a[160:163], v[248:251]
 ds_read_b128 a[160:163], v2 offset:16384
 v_mfma_f32_16x16x32_bf16 v[248:251], a[212:215], a[164:167], v[248:251]
 ds_read_b128 a[164:167], v2 offset:17408
 v_mfma_f32_16x16x32_bf16 v[252:255], a[212:215], a[172:175], v[252:255]
 ds_read_b128 a[172:175], v2 offset:21504
 v_mfma_f32_16x16x32_bf16 v[252:255], a[208:211], a[168:171], v[252:255]
 ds_read_b128 a[168:171], v2 offset:20480
 v_mfma_f32_16x16x32_bf16 a[248:251], a[208:211], a[176:179], a[248:251]
 ds_read_b128 a[176:179], v2 offset:24576
 v_mfma_f32_16x16x32_bf16 a[248:251], a[212:215], a[180:183], a[248:251]
 ds_read_b128 a[180:183], v2 offset:25600
 v_mfma_f32_16x16x32_bf16 a[252:255], a[212:215], a[188:191], a[252:255]
 ds_read_b128 a[188:191], v2 offset:29696
 v_mfma_f32_16x16x32_bf16 a[252:255], a[208:211], a[184:187], a[252:255]
 ds_read_b128 a[184:187], v2 offset:28672
 s_waitcnt vmcnt(8) lgkmcnt(8)
 v_mfma_f32_16x16x32_bf16 v[16:19], a[216:219], a[128:131], v[16:19]
 buffer_load_dwordx4 v3, s[32:35], s30 offen sc1 lds
 v_mfma_f32_16x16x32_bf16 v[16:19], a[220:223], a[132:135], v[16:19]
 buffer_load_dwordx4 a[212:215], v0, s[12:15], s24 offen offset:1024
 v_mfma_f32_16x16x32_bf16 v[20:23], a[220:223], a[140:143], v[20:23]
 v_mfma_f32_16x16x32_bf16 v[20:23], a[216:219], a[136:139], v[20:23]
 buffer_load_dwordx4 a[208:211], v0, s[12:15], s24 offen
 v_mfma_f32_16x16x32_bf16 v[24:27], a[216:219], a[144:147], v[24:27]
 v_mfma_f32_16x16x32_bf16 v[24:27], a[220:223], a[148:151], v[24:27]
 v_mfma_f32_16x16x32_bf16 v[28:31], a[220:223], a[156:159], v[28:31]
 v_mfma_f32_16x16x32_bf16 v[28:31], a[216:219], a[152:155], v[28:31]
 s_waitcnt lgkmcnt(0)
 v_mfma_f32_16x16x32_bf16 v[32:35], a[216:219], a[160:163], v[32:35]
 v_mfma_f32_16x16x32_bf16 v[32:35], a[220:223], a[164:167], v[32:35]
 v_mfma_f32_16x16x32_bf16 v[36:39], a[220:223], a[172:175], v[36:39]
 buffer_load_dwordx4 v3, s[32:35], s30 offen offset:1024 sc1 lds
 v_mfma_f32_16x16x32_bf16 v[36:39], a[216:219], a[168:171], v[36:39]
 v_mfma_f32_16x16x32_bf16 v[40:43], a[216:219], a[176:179], v[40:43]
 v_mfma_f32_16x16x32_bf16 v[40:43], a[220:223], a[180:183], v[40:43]
 v_mfma_f32_16x16x32_bf16 v[44:47], a[220:223], a[188:191], v[44:47]
 buffer_load_dwordx4 a[220:223], v0, s[12:15], s24 offen offset:3072
 v_mfma_f32_16x16x32_bf16 v[44:47], a[216:219], a[184:187], v[44:47]
 s_waitcnt vmcnt(10)
 v_mfma_f32_16x16x32_bf16 v[76:79], a[224:227], a[184:187], v[76:79]
 v_mfma_f32_16x16x32_bf16 v[76:79], a[228:231], a[188:191], v[76:79]
 buffer_load_dwordx4 a[216:219], v0, s[12:15], s24 offen offset:2048
 v_mfma_f32_16x16x32_bf16 v[72:75], a[228:231], a[180:183], v[72:75]
 v_mfma_f32_16x16x32_bf16 v[72:75], a[224:227], a[176:179], v[72:75]
 s_add_u32 s24, s24, 4096
 v_mfma_f32_16x16x32_bf16 v[68:71], a[224:227], a[168:171], v[68:71]
 v_mfma_f32_16x16x32_bf16 v[68:71], a[228:231], a[172:175], v[68:71]
 s_add_u32 m0, m0, 4096
 v_mfma_f32_16x16x32_bf16 v[64:67], a[228:231], a[164:167], v[64:67]
 v_mfma_f32_16x16x32_bf16 v[64:67], a[224:227], a[160:163], v[64:67]
 v_mfma_f32_16x16x32_bf16 v[60:63], a[224:227], a[152:155], v[60:63]
 v_mfma_f32_16x16x32_bf16 v[60:63], a[228:231], a[156:159], v[60:63]
 v_mfma_f32_16x16x32_bf16 v[56:59], a[228:231], a[148:151], v[56:59]
 v_mfma_f32_16x16x32_bf16 v[56:59], a[224:227], a[144:147], v[56:59]
 s_add_u32 s30, s30, 2048
 v_mfma_f32_16x16x32_bf16 v[52:55], a[224:227], a[136:139], v[52:55]
 v_mfma_f32_16x16x32_bf16 v[52:55], a[228:231], a[140:143], v[52:55]
 v_mfma_f32_16x16x32_bf16 v[48:51], a[228:231], a[132:135], v[48:51]
 buffer_load_dwordx4 a[228:231], v0, s[12:15], s24 offen offset:1024
 v_mfma_f32_16x16x32_bf16 v[48:51], a[224:227], a[128:131], v[48:51]
 s_waitcnt vmcnt(9)
 v_mfma_f32_16x16x32_bf16 v[80:83], a[192:195], a[128:131], v[80:83]
 v_mfma_f32_16x16x32_bf16 v[80:83], a[196:199], a[132:135], v[80:83]
 buffer_load_dwordx4 a[224:227], v0, s[12:15], s24 offen
 v_mfma_f32_16x16x32_bf16 v[84:87], a[196:199], a[140:143], v[84:87]
 v_mfma_f32_16x16x32_bf16 v[84:87], a[192:195], a[136:139], v[84:87]
 v_mfma_f32_16x16x32_bf16 v[88:91], a[192:195], a[144:147], v[88:91]
 v_mfma_f32_16x16x32_bf16 v[88:91], a[196:199], a[148:151], v[88:91]
 buffer_load_dwordx4 v3, s[32:35], s30 offen sc1 lds
 v_mfma_f32_16x16x32_bf16 v[92:95], a[196:199], a[156:159], v[92:95]
 v_mfma_f32_16x16x32_bf16 v[92:95], a[192:195], a[152:155], v[92:95]
 v_mfma_f32_16x16x32_bf16 v[96:99], a[192:195], a[160:163], v[96:99]
 v_mfma_f32_16x16x32_bf16 v[96:99], a[196:199], a[164:167], v[96:99]
 v_mfma_f32_16x16x32_bf16 v[100:103], a[196:199], a[172:175], v[100:103]
 v_mfma_f32_16x16x32_bf16 v[100:103], a[192:195], a[168:171], v[100:103]
 v_mfma_f32_16x16x32_bf16 v[104:107], a[192:195], a[176:179], v[104:107]
 buffer_load_dwordx4 v3, s[32:35], s30 offen offset:1024 sc1 lds
 v_mfma_f32_16x16x32_bf16 v[104:107], a[196:199], a[180:183], v[104:107]
 v_mfma_f32_16x16x32_bf16 v[108:111], a[196:199], a[188:191], v[108:111]
 buffer_load_dwordx4 a[196:199], v0, s[12:15], s24 offen offset:3072
 v_mfma_f32_16x16x32_bf16 v[108:111], a[192:195], a[184:187], v[108:111]
 s_waitcnt vmcnt(11)
 v_mfma_f32_16x16x32_bf16 a[244:247], a[200:203], a[184:187], a[244:247]
 v_mfma_f32_16x16x32_bf16 a[244:247], a[204:207], a[188:191], a[244:247]
 buffer_load_dwordx4 a[192:195], v0, s[12:15], s24 offen offset:2048
 v_mfma_f32_16x16x32_bf16 a[240:243], a[204:207], a[180:183], a[240:243]
 v_mfma_f32_16x16x32_bf16 a[240:243], a[200:203], a[176:179], a[240:243]
 s_add_u32 s24, s24, 4096
 v_mfma_f32_16x16x32_bf16 v[132:135], a[200:203], a[168:171], v[132:135]
 v_mfma_f32_16x16x32_bf16 v[132:135], a[204:207], a[172:175], v[132:135]
 v_mfma_f32_16x16x32_bf16 v[128:131], a[204:207], a[164:167], v[128:131]
 v_mfma_f32_16x16x32_bf16 v[128:131], a[200:203], a[160:163], v[128:131]
 s_add_u32 s30, s30, 0x1ff8800
 v_mfma_f32_16x16x32_bf16 v[124:127], a[200:203], a[152:155], v[124:127]
 v_mfma_f32_16x16x32_bf16 v[124:127], a[204:207], a[156:159], v[124:127]
 v_mfma_f32_16x16x32_bf16 v[120:123], a[204:207], a[148:151], v[120:123]
 v_mfma_f32_16x16x32_bf16 v[120:123], a[200:203], a[144:147], v[120:123]
 v_mfma_f32_16x16x32_bf16 v[116:119], a[200:203], a[136:139], v[116:119]
 v_mfma_f32_16x16x32_bf16 v[116:119], a[204:207], a[140:143], v[116:119]
 v_mfma_f32_16x16x32_bf16 v[112:115], a[204:207], a[132:135], v[112:115]
 buffer_load_dwordx4 a[204:207], v0, s[12:15], s24 offen offset:1024
 v_mfma_f32_16x16x32_bf16 v[112:115], a[200:203], a[128:131], v[112:115]
 s_waitcnt vmcnt(10)
 v_mfma_f32_16x16x32_bf16 v[136:139], a[208:211], a[128:131], v[136:139]
 v_mfma_f32_16x16x32_bf16 v[136:139], a[212:215], a[132:135], v[136:139]
 buffer_load_dwordx4 a[200:203], v0, s[12:15], s24 offen
 v_mfma_f32_16x16x32_bf16 v[140:143], a[212:215], a[140:143], v[140:143]
 v_mfma_f32_16x16x32_bf16 v[140:143], a[208:211], a[136:139], v[140:143]
 v_mfma_f32_16x16x32_bf16 v[144:147], a[208:211], a[144:147], v[144:147]
 v_mfma_f32_16x16x32_bf16 v[144:147], a[212:215], a[148:151], v[144:147]
 v_mfma_f32_16x16x32_bf16 v[148:151], a[212:215], a[156:159], v[148:151]
 v_mfma_f32_16x16x32_bf16 v[148:151], a[208:211], a[152:155], v[148:151]
 v_mfma_f32_16x16x32_bf16 v[152:155], a[208:211], a[160:163], v[152:155]
 v_mfma_f32_16x16x32_bf16 v[152:155], a[212:215], a[164:167], v[152:155]
 v_mfma_f32_16x16x32_bf16 v[156:159], a[212:215], a[172:175], v[156:159]
 v_and_b32 v5, 768, v1
 v_mfma_f32_16x16x32_bf16 v[156:159], a[208:211], a[168:171], v[156:159]
 v_add3_u32 v5, v5, v1, s52
 v_mfma_f32_16x16x32_bf16 v[160:163], a[208:211], a[176:179], v[160:163]
 v_mfma_f32_16x16x32_bf16 v[160:163], a[212:215], a[180:183], v[160:163]
 v_mfma_f32_16x16x32_bf16 v[164:167], a[212:215], a[188:191], v[164:167]
 buffer_load_dwordx4 a[212:215], v0, s[12:15], s24 offen offset:3072
 v_mfma_f32_16x16x32_bf16 v[164:167], a[208:211], a[184:187], v[164:167]
 s_waitcnt vmcnt(9)
 v_mfma_f32_16x16x32_bf16 v[196:199], a[216:219], a[184:187], v[196:199]
 v_mfma_f32_16x16x32_bf16 v[196:199], a[220:223], a[188:191], v[196:199]
 buffer_load_dwordx4 a[208:211], v0, s[12:15], s24 offen offset:2048
 v_mfma_f32_16x16x32_bf16 v[192:195], a[220:223], a[180:183], v[192:195]
 ds_read_b64_tr_b16 v[8:9], v5 offset:0
 v_mfma_f32_16x16x32_bf16 v[192:195], a[216:219], a[176:179], v[192:195]
 s_add_u32 s24, s24, 4096
 v_mfma_f32_16x16x32_bf16 v[188:191], a[216:219], a[168:171], v[188:191]
 v_mfma_f32_16x16x32_bf16 v[188:191], a[220:223], a[172:175], v[188:191]
 ds_read_b64_tr_b16 v[10:11], v5 offset:256
 v_mfma_f32_16x16x32_bf16 v[184:187], a[220:223], a[164:167], v[184:187]
 v_mfma_f32_16x16x32_bf16 v[184:187], a[216:219], a[160:163], v[184:187]
 ds_read_b64_tr_b16 v[12:13], v5 offset:8
 v_mfma_f32_16x16x32_bf16 v[180:183], a[216:219], a[152:155], v[180:183]
 v_mfma_f32_16x16x32_bf16 v[180:183], a[220:223], a[156:159], v[180:183]
 ds_read_b64_tr_b16 v[14:15], v5 offset:264
 v_mfma_f32_16x16x32_bf16 v[176:179], a[220:223], a[148:151], v[176:179]
 v_mfma_f32_16x16x32_bf16 v[176:179], a[216:219], a[144:147], v[176:179]
 s_waitcnt lgkmcnt(2)
 v_mfma_f32_16x16x32_bf16 v[172:175], a[216:219], a[136:139], v[172:175]
 v_mfma_f32_16x16x32_bf16 v[172:175], a[220:223], a[140:143], v[172:175]
 buffer_store_dwordx4 v[8:11], v1, s[12:15], s49 offen sc1
 v_mfma_f32_16x16x32_bf16 v[168:171], a[220:223], a[132:135], v[168:171]
 buffer_load_dwordx4 a[220:223], v0, s[12:15], s24 offen offset:1024
 v_mfma_f32_16x16x32_bf16 v[168:171], a[216:219], a[128:131], v[168:171]
 s_waitcnt vmcnt(10)
 v_mfma_f32_16x16x32_bf16 v[200:203], a[224:227], a[128:131], v[200:203]
 v_mfma_f32_16x16x32_bf16 v[200:203], a[228:231], a[132:135], v[200:203]
 buffer_load_dwordx4 a[216:219], v0, s[12:15], s24 offen
 v_mfma_f32_16x16x32_bf16 v[204:207], a[228:231], a[140:143], v[204:207]
 s_waitcnt lgkmcnt(0)
 v_mfma_f32_16x16x32_bf16 v[204:207], a[224:227], a[136:139], v[204:207]
 v_mfma_f32_16x16x32_bf16 v[208:211], a[224:227], a[144:147], v[208:211]
 buffer_store_dwordx4 v[12:15], v1, s[12:15], s49 offen offset:2048 sc1
 v_mfma_f32_16x16x32_bf16 v[208:211], a[228:231], a[148:151], v[208:211]
 v_mfma_f32_16x16x32_bf16 v[212:215], a[228:231], a[156:159], v[212:215]
 s_add_u32 s49, s49, 2097152
 v_mfma_f32_16x16x32_bf16 v[212:215], a[224:227], a[152:155], v[212:215]
 v_mfma_f32_16x16x32_bf16 v[216:219], a[224:227], a[160:163], v[216:219]
 v_mfma_f32_16x16x32_bf16 v[216:219], a[228:231], a[164:167], v[216:219]
 v_mfma_f32_16x16x32_bf16 v[220:223], a[228:231], a[172:175], v[220:223]
 v_mfma_f32_16x16x32_bf16 v[220:223], a[224:227], a[168:171], v[220:223]
 v_mfma_f32_16x16x32_bf16 v[224:227], a[224:227], a[176:179], v[224:227]
 v_mfma_f32_16x16x32_bf16 v[224:227], a[228:231], a[180:183], v[224:227]
 v_mfma_f32_16x16x32_bf16 v[228:231], a[228:231], a[188:191], v[228:231]
 buffer_load_dwordx4 a[228:231], v0, s[12:15], s24 offen offset:3072
 v_mfma_f32_16x16x32_bf16 v[228:231], a[224:227], a[184:187], v[228:231]
 s_waitcnt vmcnt(9)
 v_mfma_f32_16x16x32_bf16 a[252:255], a[192:195], a[184:187], a[252:255]
 ds_read_b128 a[184:187], v2 offset:61440
 v_mfma_f32_16x16x32_bf16 a[252:255], a[196:199], a[188:191], a[252:255]
 buffer_load_dwordx4 a[224:227], v0, s[12:15], s24 offen offset:2048
 ds_read_b128 a[188:191], v2 offset:62464
 v_mfma_f32_16x16x32_bf16 a[248:251], a[196:199], a[180:183], a[248:251]
 ds_read_b128 a[180:183], v2 offset:58368
 v_mfma_f32_16x16x32_bf16 a[248:251], a[192:195], a[176:179], a[248:251]
 s_add_u32 s24, s24, 4096
 ds_read_b128 a[176:179], v2 offset:57344
 v_mfma_f32_16x16x32_bf16 v[252:255], a[192:195], a[168:171], v[252:255]
 ds_read_b128 a[168:171], v2 offset:53248
 v_mfma_f32_16x16x32_bf16 v[252:255], a[196:199], a[172:175], v[252:255]
 ds_read_b128 a[172:175], v2 offset:54272
 v_mfma_f32_16x16x32_bf16 v[248:251], a[196:199], a[164:167], v[248:251]
 ds_read_b128 a[164:167], v2 offset:50176
 v_mfma_f32_16x16x32_bf16 v[248:251], a[192:195], a[160:163], v[248:251]
 ds_read_b128 a[160:163], v2 offset:49152
 v_mfma_f32_16x16x32_bf16 v[244:247], a[192:195], a[152:155], v[244:247]
 ds_read_b128 a[152:155], v2 offset:45056
 v_mfma_f32_16x16x32_bf16 v[244:247], a[196:199], a[156:159], v[244:247]
 ds_read_b128 a[156:159], v2 offset:46080
 v_mfma_f32_16x16x32_bf16 v[240:243], a[196:199], a[148:151], v[240:243]
 ds_read_b128 a[148:151], v2 offset:41984
 v_mfma_f32_16x16x32_bf16 v[240:243], a[192:195], a[144:147], v[240:243]
 ds_read_b128 a[144:147], v2 offset:40960
 v_mfma_f32_16x16x32_bf16 v[236:239], a[192:195], a[136:139], v[236:239]
 ds_read_b128 a[136:139], v2 offset:36864
 v_mfma_f32_16x16x32_bf16 v[236:239], a[196:199], a[140:143], v[236:239]
 ds_read_b128 a[140:143], v2 offset:37888
 v_mfma_f32_16x16x32_bf16 v[232:235], a[196:199], a[132:135], v[232:235]
 ds_read_b128 a[132:135], v2 offset:33792
 v_mfma_f32_16x16x32_bf16 v[232:235], a[192:195], a[128:131], v[232:235]
 ds_read_b128 a[128:131], v2 offset:32768
 s_waitcnt vmcnt(8) lgkmcnt(8)
 v_mfma_f32_16x16x32_bf16 v[44:47], a[200:203], a[184:187], v[44:47]
 v_mfma_f32_16x16x32_bf16 v[44:47], a[204:207], a[188:191], v[44:47]
 buffer_load_dwordx4 a[196:199], v0, s[12:15], s24 offen offset:1024
 v_mfma_f32_16x16x32_bf16 v[40:43], a[204:207], a[180:183], v[40:43]
 v_mfma_f32_16x16x32_bf16 v[40:43], a[200:203], a[176:179], v[40:43]
 buffer_load_dwordx4 a[192:195], v0, s[12:15], s24 offen
 v_mfma_f32_16x16x32_bf16 v[36:39], a[200:203], a[168:171], v[36:39]
 v_mfma_f32_16x16x32_bf16 v[36:39], a[204:207], a[172:175], v[36:39]
 v_mfma_f32_16x16x32_bf16 v[32:35], a[204:207], a[164:167], v[32:35]
 v_mfma_f32_16x16x32_bf16 v[32:35], a[200:203], a[160:163], v[32:35]
 s_waitcnt lgkmcnt(0)
 v_mfma_f32_16x16x32_bf16 v[28:31], a[200:203], a[152:155], v[28:31]
 v_mfma_f32_16x16x32_bf16 v[28:31], a[204:207], a[156:159], v[28:31]
 v_mfma_f32_16x16x32_bf16 v[24:27], a[204:207], a[148:151], v[24:27]
 v_mfma_f32_16x16x32_bf16 v[24:27], a[200:203], a[144:147], v[24:27]
 v_mfma_f32_16x16x32_bf16 v[20:23], a[200:203], a[136:139], v[20:23]
 v_mfma_f32_16x16x32_bf16 v[20:23], a[204:207], a[140:143], v[20:23]
 v_mfma_f32_16x16x32_bf16 v[16:19], a[204:207], a[132:135], v[16:19]
 buffer_load_dwordx4 a[204:207], v0, s[12:15], s24 offen offset:3072
 v_mfma_f32_16x16x32_bf16 v[16:19], a[200:203], a[128:131], v[16:19]
 s_waitcnt vmcnt(9)
 v_mfma_f32_16x16x32_bf16 v[48:51], a[208:211], a[128:131], v[48:51]
 v_mfma_f32_16x16x32_bf16 v[48:51], a[212:215], a[132:135], v[48:51]
 buffer_load_dwordx4 a[200:203], v0, s[12:15], s24 offen offset:2048
 v_mfma_f32_16x16x32_bf16 v[52:55], a[212:215], a[140:143], v[52:55]
 v_mfma_f32_16x16x32_bf16 v[52:55], a[208:211], a[136:139], v[52:55]
 s_add_u32 s24, s24, 4096
 v_mfma_f32_16x16x32_bf16 v[56:59], a[208:211], a[144:147], v[56:59]
 v_mfma_f32_16x16x32_bf16 v[56:59], a[212:215], a[148:151], v[56:59]
 v_mfma_f32_16x16x32_bf16 v[60:63], a[212:215], a[156:159], v[60:63]
 v_mfma_f32_16x16x32_bf16 v[60:63], a[208:211], a[152:155], v[60:63]
 v_mfma_f32_16x16x32_bf16 v[64:67], a[208:211], a[160:163], v[64:67]
 v_mfma_f32_16x16x32_bf16 v[64:67], a[212:215], a[164:167], v[64:67]
 v_mfma_f32_16x16x32_bf16 v[68:71], a[212:215], a[172:175], v[68:71]
 v_mfma_f32_16x16x32_bf16 v[68:71], a[208:211], a[168:171], v[68:71]
 v_mfma_f32_16x16x32_bf16 v[72:75], a[208:211], a[176:179], v[72:75]
 v_mfma_f32_16x16x32_bf16 v[72:75], a[212:215], a[180:183], v[72:75]
 v_mfma_f32_16x16x32_bf16 v[76:79], a[212:215], a[188:191], v[76:79]
 buffer_load_dwordx4 a[212:215], v0, s[12:15], s24 offen offset:1024
 v_mfma_f32_16x16x32_bf16 v[76:79], a[208:211], a[184:187], v[76:79]
 s_waitcnt vmcnt(8)
 v_mfma_f32_16x16x32_bf16 v[108:111], a[216:219], a[184:187], v[108:111]
 v_mfma_f32_16x16x32_bf16 v[108:111], a[220:223], a[188:191], v[108:111]
 buffer_load_dwordx4 a[208:211], v0, s[12:15], s24 offen
 v_mfma_f32_16x16x32_bf16 v[104:107], a[220:223], a[180:183], v[104:107]
 v_mfma_f32_16x16x32_bf16 v[104:107], a[216:219], a[176:179], v[104:107]
 v_mfma_f32_16x16x32_bf16 v[100:103], a[216:219], a[168:171], v[100:103]
 v_mfma_f32_16x16x32_bf16 v[100:103], a[220:223], a[172:175], v[100:103]
 v_mfma_f32_16x16x32_bf16 v[96:99], a[220:223], a[164:167], v[96:99]
 v_mfma_f32_16x16x32_bf16 v[96:99], a[216:219], a[160:163], v[96:99]
 v_mfma_f32_16x16x32_bf16 v[92:95], a[216:219], a[152:155], v[92:95]
 v_mfma_f32_16x16x32_bf16 v[92:95], a[220:223], a[156:159], v[92:95]
 v_mfma_f32_16x16x32_bf16 v[88:91], a[220:223], a[148:151], v[88:91]
 v_mfma_f32_16x16x32_bf16 v[88:91], a[216:219], a[144:147], v[88:91]
 v_mfma_f32_16x16x32_bf16 v[84:87], a[216:219], a[136:139], v[84:87]
 v_mfma_f32_16x16x32_bf16 v[84:87], a[220:223], a[140:143], v[84:87]
 v_mfma_f32_16x16x32_bf16 v[80:83], a[220:223], a[132:135], v[80:83]
 buffer_load_dwordx4 a[220:223], v0, s[12:15], s24 offen offset:3072
 v_mfma_f32_16x16x32_bf16 v[80:83], a[216:219], a[128:131], v[80:83]
 s_waitcnt vmcnt(7)
 v_mfma_f32_16x16x32_bf16 v[112:115], a[224:227], a[128:131], v[112:115]
 v_mfma_f32_16x16x32_bf16 v[112:115], a[228:231], a[132:135], v[112:115]
 buffer_load_dwordx4 a[216:219], v0, s[12:15], s24 offen offset:2048
 v_mfma_f32_16x16x32_bf16 v[116:119], a[228:231], a[140:143], v[116:119]
 v_mfma_f32_16x16x32_bf16 v[116:119], a[224:227], a[136:139], v[116:119]
 s_add_u32 s24, s24, 4096
 v_mfma_f32_16x16x32_bf16 v[120:123], a[224:227], a[144:147], v[120:123]
 v_mfma_f32_16x16x32_bf16 v[120:123], a[228:231], a[148:151], v[120:123]
 v_mfma_f32_16x16x32_bf16 v[124:127], a[228:231], a[156:159], v[124:127]
 v_mfma_f32_16x16x32_bf16 v[124:127], a[224:227], a[152:155], v[124:127]
 v_mfma_f32_16x16x32_bf16 v[128:131], a[224:227], a[160:163], v[128:131]
 v_mfma_f32_16x16x32_bf16 v[128:131], a[228:231], a[164:167], v[128:131]
 v_mfma_f32_16x16x32_bf16 v[132:135], a[228:231], a[172:175], v[132:135]
 v_mfma_f32_16x16x32_bf16 v[132:135], a[224:227], a[168:171], v[132:135]
 v_mfma_f32_16x16x32_bf16 a[240:243], a[224:227], a[176:179], a[240:243]
 v_mfma_f32_16x16x32_bf16 a[240:243], a[228:231], a[180:183], a[240:243]
 v_mfma_f32_16x16x32_bf16 a[244:247], a[228:231], a[188:191], a[244:247]
 buffer_load_dwordx4 a[228:231], v0, s[12:15], s24 offen offset:1024
 v_mfma_f32_16x16x32_bf16 a[244:247], a[224:227], a[184:187], a[244:247]
 buffer_load_dwordx4 a[224:227], v0, s[12:15], s24 offen
 buffer_load_dwordx4 a[236:239], v0, s[12:15], s24 offen offset:3072
 buffer_load_dwordx4 a[232:235], v0, s[12:15], s24 offen offset:2048
 s_waitcnt vmcnt(10)
 v_mfma_f32_16x16x32_bf16 v[164:167], a[192:195], a[184:187], v[164:167]
 v_mfma_f32_16x16x32_bf16 v[164:167], a[196:199], a[188:191], v[164:167]
 v_mfma_f32_16x16x32_bf16 v[160:163], a[196:199], a[180:183], v[160:163]
 s_add_u32 s24, s24, 4096
 v_mfma_f32_16x16x32_bf16 v[160:163], a[192:195], a[176:179], v[160:163]
 v_mfma_f32_16x16x32_bf16 v[156:159], a[192:195], a[168:171], v[156:159]
 v_mfma_f32_16x16x32_bf16 v[156:159], a[196:199], a[172:175], v[156:159]
 v_mfma_f32_16x16x32_bf16 v[152:155], a[196:199], a[164:167], v[152:155]
 v_mfma_f32_16x16x32_bf16 v[152:155], a[192:195], a[160:163], v[152:155]
 v_mfma_f32_16x16x32_bf16 v[148:151], a[192:195], a[152:155], v[148:151]
 v_mfma_f32_16x16x32_bf16 v[148:151], a[196:199], a[156:159], v[148:151]
 v_mfma_f32_16x16x32_bf16 v[144:147], a[196:199], a[148:151], v[144:147]
 v_mfma_f32_16x16x32_bf16 v[144:147], a[192:195], a[144:147], v[144:147]
 v_mfma_f32_16x16x32_bf16 v[140:143], a[192:195], a[136:139], v[140:143]
 v_mfma_f32_16x16x32_bf16 v[140:143], a[196:199], a[140:143], v[140:143]
 v_mfma_f32_16x16x32_bf16 v[136:139], a[196:199], a[132:135], v[136:139]
 buffer_load_dwordx4 a[196:199], v0, s[12:15], s24 offen offset:1024
 v_mfma_f32_16x16x32_bf16 v[136:139], a[192:195], a[128:131], v[136:139]
 s_waitcnt vmcnt(9)
 v_mfma_f32_16x16x32_bf16 v[168:171], a[200:203], a[128:131], v[168:171]
 v_mfma_f32_16x16x32_bf16 v[168:171], a[204:207], a[132:135], v[168:171]
 buffer_load_dwordx4 a[192:195], v0, s[12:15], s24 offen
 v_mfma_f32_16x16x32_bf16 v[172:175], a[204:207], a[140:143], v[172:175]
 v_mfma_f32_16x16x32_bf16 v[172:175], a[200:203], a[136:139], v[172:175]
 v_mfma_f32_16x16x32_bf16 v[176:179], a[200:203], a[144:147], v[176:179]
 v_mfma_f32_16x16x32_bf16 v[176:179], a[204:207], a[148:151], v[176:179]
 v_mfma_f32_16x16x32_bf16 v[180:183], a[204:207], a[156:159], v[180:183]
 v_mfma_f32_16x16x32_bf16 v[180:183], a[200:203], a[152:155], v[180:183]
 v_mfma_f32_16x16x32_bf16 v[184:187], a[200:203], a[160:163], v[184:187]
 v_mfma_f32_16x16x32_bf16 v[184:187], a[204:207], a[164:167], v[184:187]
 v_mfma_f32_16x16x32_bf16 v[188:191], a[204:207], a[172:175], v[188:191]
 v_mfma_f32_16x16x32_bf16 v[188:191], a[200:203], a[168:171], v[188:191]
 v_mfma_f32_16x16x32_bf16 v[192:195], a[200:203], a[176:179], v[192:195]
 v_mfma_f32_16x16x32_bf16 v[192:195], a[204:207], a[180:183], v[192:195]
 v_mfma_f32_16x16x32_bf16 v[196:199], a[204:207], a[188:191], v[196:199]
 buffer_load_dwordx4 a[204:207], v0, s[12:15], s24 offen offset:3072
 v_mfma_f32_16x16x32_bf16 v[196:199], a[200:203], a[184:187], v[196:199]
 s_waitcnt vmcnt(9)
 v_mfma_f32_16x16x32_bf16 v[228:231], a[208:211], a[184:187], v[228:231]
 v_mfma_f32_16x16x32_bf16 v[228:231], a[212:215], a[188:191], v[228:231]
 buffer_load_dwordx4 a[200:203], v0, s[12:15], s24 offen offset:2048
 v_mfma_f32_16x16x32_bf16 v[224:227], a[212:215], a[180:183], v[224:227]
 v_mfma_f32_16x16x32_bf16 v[224:227], a[208:211], a[176:179], v[224:227]
 s_add_u32 s24, s24, 4096
 v_mfma_f32_16x16x32_bf16 v[220:223], a[208:211], a[168:171], v[220:223]
 v_mfma_f32_16x16x32_bf16 v[220:223], a[212:215], a[172:175], v[220:223]
 v_mfma_f32_16x16x32_bf16 v[216:219], a[212:215], a[164:167], v[216:219]
 v_mfma_f32_16x16x32_bf16 v[216:219], a[208:211], a[160:163], v[216:219]
 v_mfma_f32_16x16x32_bf16 v[212:215], a[208:211], a[152:155], v[212:215]
 v_mfma_f32_16x16x32_bf16 v[212:215], a[212:215], a[156:159], v[212:215]
 v_mfma_f32_16x16x32_bf16 v[208:211], a[212:215], a[148:151], v[208:211]
 s_waitcnt lgkmcnt(0)
 s_barrier
 v_mfma_f32_16x16x32_bf16 v[208:211], a[208:211], a[144:147], v[208:211]
 v_mfma_f32_16x16x32_bf16 v[204:207], a[208:211], a[136:139], v[204:207]
 v_mfma_f32_16x16x32_bf16 v[204:207], a[212:215], a[140:143], v[204:207]
 v_mfma_f32_16x16x32_bf16 v[200:203], a[212:215], a[132:135], v[200:203]
 buffer_load_dwordx4 a[212:215], v0, s[12:15], s24 offen offset:1024
 v_mfma_f32_16x16x32_bf16 v[200:203], a[208:211], a[128:131], v[200:203]
 s_waitcnt vmcnt(9)
 v_mfma_f32_16x16x32_bf16 v[232:235], a[216:219], a[128:131], v[232:235]
 ds_read_b128 a[128:131], v1 offset:2048
 v_mfma_f32_16x16x32_bf16 v[232:235], a[220:223], a[132:135], v[232:235]
 buffer_load_dwordx4 a[208:211], v0, s[12:15], s24 offen
 ds_read_b128 a[132:135], v1 offset:3072
 v_mfma_f32_16x16x32_bf16 v[236:239], a[220:223], a[140:143], v[236:239]
 ds_read_b128 a[140:143], v1 offset:7168
 v_mfma_f32_16x16x32_bf16 v[236:239], a[216:219], a[136:139], v[236:239]
 ds_read_b128 a[136:139], v1 offset:6144
 v_mfma_f32_16x16x32_bf16 v[240:243], a[216:219], a[144:147], v[240:243]
 ds_read_b128 a[144:147], v1 offset:10240
 v_mfma_f32_16x16x32_bf16 v[240:243], a[220:223], a[148:151], v[240:243]
 ds_read_b128 a[148:151], v1 offset:11264
 v_mfma_f32_16x16x32_bf16 v[244:247], a[220:223], a[156:159], v[244:247]
 ds_read_b128 a[156:159], v1 offset:15360
 v_mfma_f32_16x16x32_bf16 v[244:247], a[216:219], a[152:155], v[244:247]
 ds_read_b128 a[152:155], v1 offset:14336
 v_mfma_f32_16x16x32_bf16 v[248:251], a[216:219], a[160:163], v[248:251]
 ds_read_b128 a[160:163], v1 offset:18432
 v_mfma_f32_16x16x32_bf16 v[248:251], a[220:223], a[164:167], v[248:251]
 ds_read_b128 a[164:167], v1 offset:19456
 v_mfma_f32_16x16x32_bf16 v[252:255], a[220:223], a[172:175], v[252:255]
 ds_read_b128 a[172:175], v1 offset:23552
 v_mfma_f32_16x16x32_bf16 v[252:255], a[216:219], a[168:171], v[252:255]
 ds_read_b128 a[168:171], v1 offset:22528
 v_mfma_f32_16x16x32_bf16 a[248:251], a[216:219], a[176:179], a[248:251]
 ds_read_b128 a[176:179], v1 offset:26624
 v_mfma_f32_16x16x32_bf16 a[248:251], a[220:223], a[180:183], a[248:251]
 ds_read_b128 a[180:183], v1 offset:27648
 v_mfma_f32_16x16x32_bf16 a[252:255], a[220:223], a[188:191], a[252:255]
 buffer_load_dwordx4 a[220:223], v0, s[12:15], s24 offen offset:3072
 ds_read_b128 a[188:191], v1 offset:31744
 v_mfma_f32_16x16x32_bf16 a[252:255], a[216:219], a[184:187], a[252:255]
 buffer_load_dwordx4 a[216:219], v0, s[12:15], s24 offen offset:2048
 s_add_u32 s24, s24, 4096
 ds_read_b128 a[184:187], v1 offset:30720
 s_waitcnt vmcnt(10) lgkmcnt(8)
 v_mfma_f32_16x16x32_bf16 v[16:19], a[224:227], a[128:131], v[16:19]
 v_mov_b32 v7, 1
 buffer_atomic_add v7, v0, s[56:59], 0 offen sc1
 v_mfma_f32_16x16x32_bf16 v[16:19], a[228:231], a[132:135], v[16:19]
 v_lshrrev_b32 v4, 8, v1
 v_mfma_f32_16x16x32_bf16 v[20:23], a[228:231], a[140:143], v[20:23]
 v_lshl_add_u32 v4, v4, 5, s51
 v_mfma_f32_16x16x32_bf16 v[20:23], a[224:227], a[136:139], v[20:23]
 ds_read_b128 v[8:11], v4 offset:256
 v_mfma_f32_16x16x32_bf16 v[24:27], a[224:227], a[144:147], v[24:27]
 s_waitcnt lgkmcnt(0)
 v_mfma_f32_16x16x32_bf16 v[24:27], a[228:231], a[148:151], v[24:27]
 v_add_f32 v136, v136, v8
 v_mfma_f32_16x16x32_bf16 v[28:31], a[228:231], a[156:159], v[28:31]
 ds_read_b128 v[12:15], v4 offset:272
 v_mfma_f32_16x16x32_bf16 v[28:31], a[224:227], a[152:155], v[28:31]
 v_mfma_f32_16x16x32_bf16 v[32:35], a[224:227], a[160:163], v[32:35]
 v_add_f32 v137, v137, v9
 v_mfma_f32_16x16x32_bf16 v[32:35], a[228:231], a[164:167], v[32:35]
 v_add_f32 v138, v138, v10
 v_mfma_f32_16x16x32_bf16 v[36:39], a[228:231], a[172:175], v[36:39]
 v_add_f32 v139, v139, v11
 v_mfma_f32_16x16x32_bf16 v[36:39], a[224:227], a[168:171], v[36:39]
 v_add_f32 v140, v140, v8
 v_mfma_f32_16x16x32_bf16 v[40:43], a[224:227], a[176:179], v[40:43]
 v_add_f32 v141, v141, v9
 v_mfma_f32_16x16x32_bf16 v[40:43], a[228:231], a[180:183], v[40:43]
 v_add_f32 v142, v142, v10
 v_mfma_f32_16x16x32_bf16 v[44:47], a[228:231], a[188:191], v[44:47]
 buffer_load_dwordx4 a[228:231], v0, s[12:15], s24 offen offset:1024
 v_mfma_f32_16x16x32_bf16 v[44:47], a[224:227], a[184:187], v[44:47]
 s_waitcnt vmcnt(10)
 v_mfma_f32_16x16x32_bf16 v[76:79], a[232:235], a[184:187], v[76:79]
 v_add_f32 v143, v143, v11
 v_mfma_f32_16x16x32_bf16 v[76:79], a[236:239], a[188:191], v[76:79]
 buffer_load_dwordx4 a[224:227], v0, s[12:15], s24 offen
 v_mfma_f32_16x16x32_bf16 v[72:75], a[236:239], a[180:183], v[72:75]
 v_add_f32 v144, v144, v8
 v_mfma_f32_16x16x32_bf16 v[72:75], a[232:235], a[176:179], v[72:75]
 v_add_f32 v145, v145, v9
 v_add_f32 v146, v146, v10
 v_mfma_f32_16x16x32_bf16 v[68:71], a[232:235], a[168:171], v[68:71]
 v_add_f32 v147, v147, v11
 v_mfma_f32_16x16x32_bf16 v[68:71], a[236:239], a[172:175], v[68:71]
 v_add_f32 v148, v148, v8
 v_mfma_f32_16x16x32_bf16 v[64:67], a[236:239], a[164:167], v[64:67]
 v_add_f32 v149, v149, v9
 v_mfma_f32_16x16x32_bf16 v[64:67], a[232:235], a[160:163], v[64:67]
 v_add_f32 v150, v150, v10
 v_mfma_f32_16x16x32_bf16 v[60:63], a[232:235], a[152:155], v[60:63]
 v_add_f32 v151, v151, v11
 v_mfma_f32_16x16x32_bf16 v[60:63], a[236:239], a[156:159], v[60:63]
 v_add_f32 v152, v152, v8
 v_mfma_f32_16x16x32_bf16 v[56:59], a[236:239], a[148:151], v[56:59]
 v_add_f32 v153, v153, v9
 v_mfma_f32_16x16x32_bf16 v[56:59], a[232:235], a[144:147], v[56:59]
 v_add_f32 v154, v154, v10
 v_mfma_f32_16x16x32_bf16 v[52:55], a[232:235], a[136:139], v[52:55]
 v_add_f32 v155, v155, v11
 v_mfma_f32_16x16x32_bf16 v[52:55], a[236:239], a[140:143], v[52:55]
 v_add_f32 v156, v156, v8
 v_mfma_f32_16x16x32_bf16 v[48:51], a[236:239], a[132:135], v[48:51]
 buffer_load_dwordx4 a[236:239], v0, s[12:15], s24 offen offset:3072
 v_mfma_f32_16x16x32_bf16 v[48:51], a[232:235], a[128:131], v[48:51]
 s_waitcnt vmcnt(10)
 v_mfma_f32_16x16x32_bf16 v[80:83], a[192:195], a[128:131], v[80:83]
 v_add_f32 v157, v157, v9
 v_mfma_f32_16x16x32_bf16 v[80:83], a[196:199], a[132:135], v[80:83]
 buffer_load_dwordx4 a[232:235], v0, s[12:15], s24 offen offset:2048
 v_mfma_f32_16x16x32_bf16 v[84:87], a[196:199], a[140:143], v[84:87]
 v_add_f32 v158, v158, v10
 v_mfma_f32_16x16x32_bf16 v[84:87], a[192:195], a[136:139], v[84:87]
 s_add_u32 s24, s24, 4096
 v_mfma_f32_16x16x32_bf16 v[88:91], a[192:195], a[144:147], v[88:91]
 v_add_f32 v159, v159, v11
 v_mfma_f32_16x16x32_bf16 v[88:91], a[196:199], a[148:151], v[88:91]
 v_add_f32 v160, v160, v8
 v_mfma_f32_16x16x32_bf16 v[92:95], a[196:199], a[156:159], v[92:95]
 v_add_f32 v161, v161, v9
 v_add_f32 v162, v162, v10
 v_mfma_f32_16x16x32_bf16 v[92:95], a[192:195], a[152:155], v[92:95]
 v_add_f32 v163, v163, v11
 v_mfma_f32_16x16x32_bf16 v[96:99], a[192:195], a[160:163], v[96:99]
 v_add_f32 v164, v164, v8
 v_mfma_f32_16x16x32_bf16 v[96:99], a[196:199], a[164:167], v[96:99]
 v_add_f32 v165, v165, v9
 v_mfma_f32_16x16x32_bf16 v[100:103], a[196:199], a[172:175], v[100:103]
 v_add_f32 v166, v166, v10
 v_mfma_f32_16x16x32_bf16 v[100:103], a[192:195], a[168:171], v[100:103]
 v_add_f32 v167, v167, v11
 v_mfma_f32_16x16x32_bf16 v[104:107], a[192:195], a[176:179], v[104:107]
 s_waitcnt lgkmcnt(0)
 v_mfma_f32_16x16x32_bf16 v[104:107], a[196:199], a[180:183], v[104:107]
 v_add_f32 v168, v168, v12
 v_mfma_f32_16x16x32_bf16 v[108:111], a[196:199], a[188:191], v[108:111]
 buffer_load_dwordx4 a[196:199], v0, s[12:15], s24 offen offset:1024
 v_mfma_f32_16x16x32_bf16 v[108:111], a[192:195], a[184:187], v[108:111]
 s_waitcnt vmcnt(10)
 v_mfma_f32_16x16x32_bf16 a[244:247], a[200:203], a[184:187], a[244:247]
 ds_read_b128 a[184:187], v1 offset:63488
 v_mfma_f32_16x16x32_bf16 a[244:247], a[204:207], a[188:191], a[244:247]
 buffer_load_dwordx4 a[192:195], v0, s[12:15], s24 offen
 ds_read_b128 a[188:191], v1 offset:64512
 v_mfma_f32_16x16x32_bf16 a[240:243], a[204:207], a[180:183], a[240:243]
 ds_read_b128 a[180:183], v1 offset:60416
 v_mfma_f32_16x16x32_bf16 a[240:243], a[200:203], a[176:179], a[240:243]
 ds_read_b128 a[176:179], v1 offset:59392
 v_mfma_f32_16x16x32_bf16 v[132:135], a[200:203], a[168:171], v[132:135]
 ds_read_b128 a[168:171], v1 offset:55296
 v_mfma_f32_16x16x32_bf16 v[132:135], a[204:207], a[172:175], v[132:135]
 ds_read_b128 a[172:175], v1 offset:56320
 v_mfma_f32_16x16x32_bf16 v[128:131], a[204:207], a[164:167], v[128:131]
 ds_read_b128 a[164:167], v1 offset:52224
 v_mfma_f32_16x16x32_bf16 v[128:131], a[200:203], a[160:163], v[128:131]
 ds_read_b128 a[160:163], v1 offset:51200
 v_mfma_f32_16x16x32_bf16 v[124:127], a[200:203], a[152:155], v[124:127]
 ds_read_b128 a[152:155], v1 offset:47104
 v_mfma_f32_16x16x32_bf16 v[124:127], a[204:207], a[156:159], v[124:127]
 ds_read_b128 a[156:159], v1 offset:48128
 v_mfma_f32_16x16x32_bf16 v[120:123], a[204:207], a[148:151], v[120:123]
 ds_read_b128 v[8:11], v4 offset:384
 ds_read_b128 a[148:151], v1 offset:44032
 v_mfma_f32_16x16x32_bf16 v[120:123], a[200:203], a[144:147], v[120:123]
 ds_read_b128 a[144:147], v1 offset:43008
 v_mfma_f32_16x16x32_bf16 v[116:119], a[200:203], a[136:139], v[116:119]
 ds_read_b128 a[136:139], v1 offset:38912
 v_mfma_f32_16x16x32_bf16 v[116:119], a[204:207], a[140:143], v[116:119]
 ds_read_b128 a[140:143], v1 offset:39936
 v_mfma_f32_16x16x32_bf16 v[112:115], a[204:207], a[132:135], v[112:115]
 ds_read_b128 a[132:135], v1 offset:35840
 v_mfma_f32_16x16x32_bf16 v[112:115], a[200:203], a[128:131], v[112:115]
 ds_read_b128 a[128:131], v1 offset:34816
 s_waitcnt vmcnt(9) lgkmcnt(9)
 v_mfma_f32_16x16x32_bf16 v[44:47], a[208:211], a[184:187], v[44:47]
 v_add_f32 v169, v169, v13
 v_mfma_f32_16x16x32_bf16 v[44:47], a[212:215], a[188:191], v[44:47]
 buffer_load_dwordx4 a[204:207], v0, s[12:15], s24 offen offset:3072
 v_mfma_f32_16x16x32_bf16 v[40:43], a[212:215], a[180:183], v[40:43]
 v_add_f32 v170, v170, v14
 v_mfma_f32_16x16x32_bf16 v[40:43], a[208:211], a[176:179], v[40:43]
 buffer_load_dwordx4 a[200:203], v0, s[12:15], s24 offen offset:2048
 v_mfma_f32_16x16x32_bf16 v[36:39], a[208:211], a[168:171], v[36:39]
 s_add_u32 s24, s24, 4096
 v_mfma_f32_16x16x32_bf16 v[36:39], a[212:215], a[172:175], v[36:39]
 v_add_f32 v171, v171, v15
 v_mfma_f32_16x16x32_bf16 v[32:35], a[212:215], a[164:167], v[32:35]
 v_add_f32 v172, v172, v12
 v_mfma_f32_16x16x32_bf16 v[32:35], a[208:211], a[160:163], v[32:35]
 s_waitcnt lgkmcnt(0)
 v_mfma_f32_16x16x32_bf16 v[28:31], a[208:211], a[152:155], v[28:31]
 v_add_f32 v173, v173, v13
 v_mfma_f32_16x16x32_bf16 v[28:31], a[212:215], a[156:159], v[28:31]
 v_add_f32 v174, v174, v14
 v_mfma_f32_16x16x32_bf16 v[24:27], a[212:215], a[148:151], v[24:27]
 v_add_f32 v175, v175, v15
 v_mfma_f32_16x16x32_bf16 v[24:27], a[208:211], a[144:147], v[24:27]
 v_add_f32 v176, v176, v12
 v_mfma_f32_16x16x32_bf16 v[20:23], a[208:211], a[136:139], v[20:23]
 v_add_f32 v177, v177, v13
 v_mfma_f32_16x16x32_bf16 v[20:23], a[212:215], a[140:143], v[20:23]
 v_add_f32 v178, v178, v14
 v_mfma_f32_16x16x32_bf16 v[16:19], a[212:215], a[132:135], v[16:19]
 v_add_f32 v179, v179, v15
 buffer_load_dwordx4 a[212:215], v0, s[12:15], s24 offen offset:1024
 v_mfma_f32_16x16x32_bf16 v[16:19], a[208:211], a[128:131], v[16:19]
 s_waitcnt vmcnt(10)
 v_mfma_f32_16x16x32_bf16 v[48:51], a[216:219], a[128:131], v[48:51]
 v_add_f32 v180, v180, v12
 v_mfma_f32_16x16x32_bf16 v[48:51], a[220:223], a[132:135], v[48:51]
 buffer_load_dwordx4 a[208:211], v0, s[12:15], s24 offen
 v_mfma_f32_16x16x32_bf16 v[52:55], a[220:223], a[140:143], v[52:55]
 v_add_f32 v181, v181, v13
 v_mfma_f32_16x16x32_bf16 v[52:55], a[216:219], a[136:139], v[52:55]
 v_add_f32 v182, v182, v14
 v_mfma_f32_16x16x32_bf16 v[56:59], a[216:219], a[144:147], v[56:59]
 v_add_f32 v183, v183, v15
 v_mfma_f32_16x16x32_bf16 v[56:59], a[220:223], a[148:151], v[56:59]
 v_add_f32 v184, v184, v12
 v_mfma_f32_16x16x32_bf16 v[60:63], a[220:223], a[156:159], v[60:63]
 v_add_f32 v185, v185, v13
 v_mfma_f32_16x16x32_bf16 v[60:63], a[216:219], a[152:155], v[60:63]
 v_add_f32 v186, v186, v14
 v_mfma_f32_16x16x32_bf16 v[64:67], a[216:219], a[160:163], v[64:67]
 v_add_f32 v187, v187, v15
 v_mfma_f32_16x16x32_bf16 v[64:67], a[220:223], a[164:167], v[64:67]
 v_add_f32 v188, v188, v12
 v_mfma_f32_16x16x32_bf16 v[68:71], a[220:223], a[172:175], v[68:71]
 v_add_f32 v189, v189, v13
 v_mfma_f32_16x16x32_bf16 v[68:71], a[216:219], a[168:171], v[68:71]
 v_add_f32 v190, v190, v14
 v_mfma_f32_16x16x32_bf16 v[72:75], a[216:219], a[176:179], v[72:75]
 v_add_f32 v191, v191, v15
 v_mfma_f32_16x16x32_bf16 v[72:75], a[220:223], a[180:183], v[72:75]
 v_add_f32 v192, v192, v12
 v_mfma_f32_16x16x32_bf16 v[76:79], a[220:223], a[188:191], v[76:79]
 buffer_load_dwordx4 a[220:223], v0, s[12:15], s24 offen offset:3072
 v_mfma_f32_16x16x32_bf16 v[76:79], a[216:219], a[184:187], v[76:79]
 s_waitcnt vmcnt(9)
 v_mfma_f32_16x16x32_bf16 v[108:111], a[224:227], a[184:187], v[108:111]
 v_add_f32 v193, v193, v13
 v_mfma_f32_16x16x32_bf16 v[108:111], a[228:231], a[188:191], v[108:111]
 v_add_f32 v194, v194, v14
 buffer_load_dwordx4 a[216:219], v0, s[12:15], s24 offen offset:2048
 v_mfma_f32_16x16x32_bf16 v[104:107], a[228:231], a[180:183], v[104:107]
 v_add_f32 v195, v195, v15
 v_mfma_f32_16x16x32_bf16 v[104:107], a[224:227], a[176:179], v[104:107]
 s_add_u32 s24, s24, 4096
 v_mfma_f32_16x16x32_bf16 v[100:103], a[224:227], a[168:171], v[100:103]
 v_add_f32 v196, v196, v12
 v_mfma_f32_16x16x32_bf16 v[100:103], a[228:231], a[172:175], v[100:103]
 v_add_f32 v197, v197, v13
 v_mfma_f32_16x16x32_bf16 v[96:99], a[228:231], a[164:167], v[96:99]
 v_add_f32 v198, v198, v14
 v_mfma_f32_16x16x32_bf16 v[96:99], a[224:227], a[160:163], v[96:99]
 v_add_f32 v199, v199, v15
 v_mfma_f32_16x16x32_bf16 v[92:95], a[224:227], a[152:155], v[92:95]
 v_mfma_f32_16x16x32_bf16 v[92:95], a[228:231], a[156:159], v[92:95]
 v_add_f32 v200, v200, v8
 v_mfma_f32_16x16x32_bf16 v[88:91], a[228:231], a[148:151], v[88:91]
 ds_read_b128 v[12:15], v4 offset:400
 v_mfma_f32_16x16x32_bf16 v[88:91], a[224:227], a[144:147], v[88:91]
 v_add_f32 v201, v201, v9
 v_mfma_f32_16x16x32_bf16 v[84:87], a[224:227], a[136:139], v[84:87]
 v_add_f32 v202, v202, v10
 v_mfma_f32_16x16x32_bf16 v[84:87], a[228:231], a[140:143], v[84:87]
 v_add_f32 v203, v203, v11
 v_mfma_f32_16x16x32_bf16 v[80:83], a[228:231], a[132:135], v[80:83]
 buffer_load_dwordx4 a[228:231], v0, s[12:15], s24 offen offset:1024
 v_mfma_f32_16x16x32_bf16 v[80:83], a[224:227], a[128:131], v[80:83]
 s_waitcnt vmcnt(9)
 v_mfma_f32_16x16x32_bf16 v[112:115], a[232:235], a[128:131], v[112:115]
 ds_read_b128 a[128:131], v2 offset:2048
 v_mfma_f32_16x16x32_bf16 v[112:115], a[236:239], a[132:135], v[112:115]
 buffer_load_dwordx4 a[224:227], v0, s[12:15], s24 offen
 ds_read_b128 a[132:135], v2 offset:3072
 v_mfma_f32_16x16x32_bf16 v[116:119], a[236:239], a[140:143], v[116:119]
 ds_read_b128 a[140:143], v2 offset:7168
 v_mfma_f32_16x16x32_bf16 v[116:119], a[232:235], a[136:139], v[116:119]
 ds_read_b128 a[136:139], v2 offset:6144
 v_mfma_f32_16x16x32_bf16 v[120:123], a[232:235], a[144:147], v[120:123]
 ds_read_b128 a[144:147], v2 offset:10240
 v_mfma_f32_16x16x32_bf16 v[120:123], a[236:239], a[148:151], v[120:123]
 v_add_f32 v204, v204, v8
 ds_read_b128 a[148:151], v2 offset:11264
 v_mfma_f32_16x16x32_bf16 v[124:127], a[236:239], a[156:159], v[124:127]
 ds_read_b128 a[156:159], v2 offset:15360
 v_mfma_f32_16x16x32_bf16 v[124:127], a[232:235], a[152:155], v[124:127]
 ds_read_b128 a[152:155], v2 offset:14336
 v_mfma_f32_16x16x32_bf16 v[128:131], a[232:235], a[160:163], v[128:131]
 ds_read_b128 a[160:163], v2 offset:18432
 v_mfma_f32_16x16x32_bf16 v[128:131], a[236:239], a[164:167], v[128:131]
 ds_read_b128 a[164:167], v2 offset:19456
 v_mfma_f32_16x16x32_bf16 v[132:135], a[236:239], a[172:175], v[132:135]
 ds_read_b128 a[172:175], v2 offset:23552
 v_mfma_f32_16x16x32_bf16 v[132:135], a[232:235], a[168:171], v[132:135]
 ds_read_b128 a[168:171], v2 offset:22528
 v_mfma_f32_16x16x32_bf16 a[240:243], a[232:235], a[176:179], a[240:243]
 ds_read_b128 a[176:179], v2 offset:26624
 v_mfma_f32_16x16x32_bf16 a[240:243], a[236:239], a[180:183], a[240:243]
 ds_read_b128 a[180:183], v2 offset:27648
 v_mfma_f32_16x16x32_bf16 a[244:247], a[236:239], a[188:191], a[244:247]
 ds_read_b128 a[188:191], v2 offset:31744
 v_mfma_f32_16x16x32_bf16 a[244:247], a[232:235], a[184:187], a[244:247]
 ds_read_b128 a[184:187], v2 offset:30720
 s_waitcnt vmcnt(8) lgkmcnt(8)
 v_mfma_f32_16x16x32_bf16 v[16:19], a[192:195], a[128:131], v[16:19]
 v_add_f32 v205, v205, v9
 v_mfma_f32_16x16x32_bf16 v[16:19], a[196:199], a[132:135], v[16:19]
 buffer_load_dwordx4 a[236:239], v0, s[12:15], s24 offen offset:3072
 v_mfma_f32_16x16x32_bf16 v[20:23], a[196:199], a[140:143], v[20:23]
 v_add_f32 v206, v206, v10
 v_mfma_f32_16x16x32_bf16 v[20:23], a[192:195], a[136:139], v[20:23]
 buffer_load_dwordx4 a[232:235], v0, s[12:15], s24 offen offset:2048
 v_mfma_f32_16x16x32_bf16 v[24:27], a[192:195], a[144:147], v[24:27]
 s_add_u32 s24, s24, 4096
 v_mfma_f32_16x16x32_bf16 v[24:27], a[196:199], a[148:151], v[24:27]
 v_add_f32 v207, v207, v11
 v_mfma_f32_16x16x32_bf16 v[28:31], a[196:199], a[156:159], v[28:31]
 v_add_f32 v208, v208, v8
 v_mfma_f32_16x16x32_bf16 v[28:31], a[192:195], a[152:155], v[28:31]
 s_waitcnt lgkmcnt(0)
 v_mfma_f32_16x16x32_bf16 v[32:35], a[192:195], a[160:163], v[32:35]
 v_add_f32 v209, v209, v9
 v_mfma_f32_16x16x32_bf16 v[32:35], a[196:199], a[164:167], v[32:35]
 v_add_f32 v210, v210, v10
 v_add_f32 v211, v211, v11
 v_mfma_f32_16x16x32_bf16 v[36:39], a[196:199], a[172:175], v[36:39]
 v_add_f32 v212, v212, v8
 v_mfma_f32_16x16x32_bf16 v[36:39], a[192:195], a[168:171], v[36:39]
 v_add_f32 v213, v213, v9
 v_mfma_f32_16x16x32_bf16 v[40:43], a[192:195], a[176:179], v[40:43]
 v_add_f32 v214, v214, v10
 v_mfma_f32_16x16x32_bf16 v[40:43], a[196:199], a[180:183], v[40:43]
 v_add_f32 v215, v215, v11
 v_mfma_f32_16x16x32_bf16 v[44:47], a[196:199], a[188:191], v[44:47]
 buffer_load_dwordx4 a[196:199], v0, s[12:15], s24 offen offset:1024
 v_mfma_f32_16x16x32_bf16 v[44:47], a[192:195], a[184:187], v[44:47]
 s_waitcnt vmcnt(9)
 v_mfma_f32_16x16x32_bf16 v[76:79], a[200:203], a[184:187], v[76:79]
 v_add_f32 v216, v216, v8
 v_mfma_f32_16x16x32_bf16 v[76:79], a[204:207], a[188:191], v[76:79]
 buffer_load_dwordx4 a[192:195], v0, s[12:15], s24 offen
 v_mfma_f32_16x16x32_bf16 v[72:75], a[204:207], a[180:183], v[72:75]
 v_add_f32 v217, v217, v9
 v_mfma_f32_16x16x32_bf16 v[72:75], a[200:203], a[176:179], v[72:75]
 v_add_f32 v218, v218, v10
 v_mfma_f32_16x16x32_bf16 v[68:71], a[200:203], a[168:171], v[68:71]
 v_add_f32 v219, v219, v11
 v_mfma_f32_16x16x32_bf16 v[68:71], a[204:207], a[172:175], v[68:71]
 v_add_f32 v220, v220, v8
 v_mfma_f32_16x16x32_bf16 v[64:67], a[204:207], a[164:167], v[64:67]
 v_add_f32 v221, v221, v9
 v_mfma_f32_16x16x32_bf16 v[64:67], a[200:203], a[160:163], v[64:67]
 v_add_f32 v222, v222, v10
 v_mfma_f32_16x16x32_bf16 v[60:63], a[200:203], a[152:155], v[60:63]
 v_add_f32 v223, v223, v11
 v_mfma_f32_16x16x32_bf16 v[60:63], a[204:207], a[156:159], v[60:63]
 v_add_f32 v224, v224, v8
 v_mfma_f32_16x16x32_bf16 v[56:59], a[204:207], a[148:151], v[56:59]
 v_add_f32 v225, v225, v9
 v_mfma_f32_16x16x32_bf16 v[56:59], a[200:203], a[144:147], v[56:59]
 v_add_f32 v226, v226, v10
 v_mfma_f32_16x16x32_bf16 v[52:55], a[200:203], a[136:139], v[52:55]
 v_add_f32 v227, v227, v11
 v_add_f32 v228, v228, v8
 v_mfma_f32_16x16x32_bf16 v[52:55], a[204:207], a[140:143], v[52:55]
 v_add_f32 v229, v229, v9
 v_mfma_f32_16x16x32_bf16 v[48:51], a[204:207], a[132:135], v[48:51]
 buffer_load_dwordx4 a[204:207], v0, s[12:15], s24 offen offset:3072
 v_mfma_f32_16x16x32_bf16 v[48:51], a[200:203], a[128:131], v[48:51]
 s_waitcnt vmcnt(9)
 v_mfma_f32_16x16x32_bf16 v[80:83], a[208:211], a[128:131], v[80:83]
 v_add_f32 v230, v230, v10
 v_mfma_f32_16x16x32_bf16 v[80:83], a[212:215], a[132:135], v[80:83]
 buffer_load_dwordx4 a[200:203], v0, s[12:15], s24 offen offset:2048
 v_mfma_f32_16x16x32_bf16 v[84:87], a[212:215], a[140:143], v[84:87]
 v_add_f32 v231, v231, v11
 v_mfma_f32_16x16x32_bf16 v[84:87], a[208:211], a[136:139], v[84:87]
 s_add_u32 s24, s24, 4096
 v_mfma_f32_16x16x32_bf16 v[88:91], a[208:211], a[144:147], v[88:91]
 v_mfma_f32_16x16x32_bf16 v[88:91], a[212:215], a[148:151], v[88:91]
 v_add_f32 v232, v232, v12
 v_mfma_f32_16x16x32_bf16 v[92:95], a[212:215], a[156:159], v[92:95]
 v_add_f32 v233, v233, v13
 v_mfma_f32_16x16x32_bf16 v[92:95], a[208:211], a[152:155], v[92:95]
 v_add_f32 v234, v234, v14
 v_mfma_f32_16x16x32_bf16 v[96:99], a[208:211], a[160:163], v[96:99]
 v_add_f32 v235, v235, v15
 v_mfma_f32_16x16x32_bf16 v[96:99], a[212:215], a[164:167], v[96:99]
 v_add_f32 v236, v236, v12
 v_mfma_f32_16x16x32_bf16 v[100:103], a[212:215], a[172:175], v[100:103]
 v_add_f32 v237, v237, v13
 v_mfma_f32_16x16x32_bf16 v[100:103], a[208:211], a[168:171], v[100:103]
 v_add_f32 v238, v238, v14
 v_mfma_f32_16x16x32_bf16 v[104:107], a[208:211], a[176:179], v[104:107]
 v_add_f32 v239, v239, v15
 v_mfma_f32_16x16x32_bf16 v[104:107], a[212:215], a[180:183], v[104:107]
 v_add_f32 v240, v240, v12
 v_mfma_f32_16x16x32_bf16 v[108:111], a[212:215], a[188:191], v[108:111]
 buffer_load_dwordx4 a[212:215], v0, s[12:15], s24 offen offset:1024
 v_mfma_f32_16x16x32_bf16 v[108:111], a[208:211], a[184:187], v[108:111]
 v_add_f32 v241, v241, v13
 s_waitcnt vmcnt(9)
 v_mfma_f32_16x16x32_bf16 a[244:247], a[216:219], a[184:187], a[244:247]
 ds_read_b128 a[184:187], v2 offset:63488
 v_mfma_f32_16x16x32_bf16 a[244:247], a[220:223], a[188:191], a[244:247]
 buffer_load_dwordx4 a[208:211], v0, s[12:15], s24 offen
 ds_read_b128 a[188:191], v2 offset:64512
 v_mfma_f32_16x16x32_bf16 a[240:243], a[220:223], a[180:183], a[240:243]
 ds_read_b128 a[180:183], v2 offset:60416
 v_mfma_f32_16x16x32_bf16 a[240:243], a[216:219], a[176:179], a[240:243]
 ds_read_b128 a[176:179], v2 offset:59392
 v_mfma_f32_16x16x32_bf16 v[132:135], a[216:219], a[168:171], v[132:135]
 ds_read_b128 a[168:171], v2 offset:55296
 v_mfma_f32_16x16x32_bf16 v[132:135], a[220:223], a[172:175], v[132:135]
 ds_read_b128 a[172:175], v2 offset:56320
 v_mfma_f32_16x16x32_bf16 v[128:131], a[220:223], a[164:167], v[128:131]
 ds_read_b128 a[164:167], v2 offset:52224
 v_mfma_f32_16x16x32_bf16 v[128:131], a[216:219], a[160:163], v[128:131]
 ds_read_b128 a[160:163], v2 offset:51200
 v_mfma_f32_16x16x32_bf16 v[124:127], a[216:219], a[152:155], v[124:127]
 ds_read_b128 a[152:155], v2 offset:47104
 v_mfma_f32_16x16x32_bf16 v[124:127], a[220:223], a[156:159], v[124:127]
 ds_read_b128 a[156:159], v2 offset:48128
 v_mfma_f32_16x16x32_bf16 v[120:123], a[220:223], a[148:151], v[120:123]
 ds_read_b128 a[148:151], v2 offset:44032
 v_mfma_f32_16x16x32_bf16 v[120:123], a[216:219], a[144:147], v[120:123]
 ds_read_b128 a[144:147], v2 offset:43008
 v_mfma_f32_16x16x32_bf16 v[116:119], a[216:219], a[136:139], v[116:119]
 ds_read_b128 a[136:139], v2 offset:38912
 v_mfma_f32_16x16x32_bf16 v[116:119], a[220:223], a[140:143], v[116:119]
 ds_read_b128 a[140:143], v2 offset:39936
 v_mfma_f32_16x16x32_bf16 v[112:115], a[220:223], a[132:135], v[112:115]
 ds_read_b128 a[132:135], v2 offset:35840
 v_mfma_f32_16x16x32_bf16 v[112:115], a[216:219], a[128:131], v[112:115]
 ds_read_b128 a[128:131], v2 offset:34816
 s_waitcnt vmcnt(8) lgkmcnt(8)
 v_mfma_f32_16x16x32_bf16 v[44:47], a[224:227], a[184:187], v[44:47]
 v_add_f32 v242, v242, v14
 v_mfma_f32_16x16x32_bf16 v[44:47], a[228:231], a[188:191], v[44:47]
 buffer_load_dwordx4 a[220:223], v0, s[12:15], s24 offen offset:3072
 v_mfma_f32_16x16x32_bf16 v[40:43], a[228:231], a[180:183], v[40:43]
 v_add_f32 v243, v243, v15
 v_mfma_f32_16x16x32_bf16 v[40:43], a[224:227], a[176:179], v[40:43]
 buffer_load_dwordx4 a[216:219], v0, s[12:15], s24 offen offset:2048
 v_mfma_f32_16x16x32_bf16 v[36:39], a[224:227], a[168:171], v[36:39]
 v_add_f32 v244, v244, v12
 s_add_u32 s24, s24, 4096
 v_mfma_f32_16x16x32_bf16 v[36:39], a[228:231], a[172:175], v[36:39]
 v_add_f32 v245, v245, v13
 v_mfma_f32_16x16x32_bf16 v[32:35], a[228:231], a[164:167], v[32:35]
 v_add_f32 v246, v246, v14
 v_mfma_f32_16x16x32_bf16 v[32:35], a[224:227], a[160:163], v[32:35]
 s_waitcnt lgkmcnt(0)
 v_mfma_f32_16x16x32_bf16 v[28:31], a[224:227], a[152:155], v[28:31]
 v_add_f32 v247, v247, v15
 v_mfma_f32_16x16x32_bf16 v[28:31], a[228:231], a[156:159], v[28:31]
 v_add_f32 v248, v248, v12
 v_mfma_f32_16x16x32_bf16 v[24:27], a[228:231], a[148:151], v[24:27]
 v_add_f32 v249, v249, v13
 v_mfma_f32_16x16x32_bf16 v[24:27], a[224:227], a[144:147], v[24:27]
 v_add_f32 v250, v250, v14
 v_mfma_f32_16x16x32_bf16 v[20:23], a[224:227], a[136:139], v[20:23]
 v_add_f32 v251, v251, v15
 v_mfma_f32_16x16x32_bf16 v[20:23], a[228:231], a[140:143], v[20:23]
 v_add_f32 v252, v252, v12
 v_mfma_f32_16x16x32_bf16 v[16:19], a[228:231], a[132:135], v[16:19]
 buffer_load_dwordx4 a[228:231], v0, s[12:15], s24 offen offset:1024
 v_mfma_f32_16x16x32_bf16 v[16:19], a[224:227], a[128:131], v[16:19]
 s_waitcnt vmcnt(9)
 v_mfma_f32_16x16x32_bf16 v[48:51], a[232:235], a[128:131], v[48:51]
 v_add_f32 v253, v253, v13
 v_mfma_f32_16x16x32_bf16 v[48:51], a[236:239], a[132:135], v[48:51]
 buffer_load_dwordx4 a[224:227], v0, s[12:15], s24 offen
 v_mfma_f32_16x16x32_bf16 v[52:55], a[236:239], a[140:143], v[52:55]
 v_add_f32 v254, v254, v14
 v_mfma_f32_16x16x32_bf16 v[52:55], a[232:235], a[136:139], v[52:55]
 v_add_f32 v255, v255, v15
 v_mfma_f32_16x16x32_bf16 v[56:59], a[232:235], a[144:147], v[56:59]
 v_accvgpr_read_b32 v5, a248
 v_mfma_f32_16x16x32_bf16 v[56:59], a[236:239], a[148:151], v[56:59]
 v_add_f32 v5, v5, v12
 v_mfma_f32_16x16x32_bf16 v[60:63], a[236:239], a[156:159], v[60:63]
 v_accvgpr_write_b32 a248, v5
 v_mfma_f32_16x16x32_bf16 v[60:63], a[232:235], a[152:155], v[60:63]
 v_accvgpr_read_b32 v6, a249
 v_add_f32 v6, v6, v13
 v_mfma_f32_16x16x32_bf16 v[64:67], a[232:235], a[160:163], v[64:67]
 v_accvgpr_write_b32 a249, v6
 v_mfma_f32_16x16x32_bf16 v[64:67], a[236:239], a[164:167], v[64:67]
 v_accvgpr_read_b32 v5, a250
 v_mfma_f32_16x16x32_bf16 v[68:71], a[236:239], a[172:175], v[68:71]
 v_add_f32 v5, v5, v14
 v_mfma_f32_16x16x32_bf16 v[68:71], a[232:235], a[168:171], v[68:71]
 v_accvgpr_write_b32 a250, v5
 v_mfma_f32_16x16x32_bf16 v[72:75], a[232:235], a[176:179], v[72:75]
 v_accvgpr_read_b32 v6, a251
 v_mfma_f32_16x16x32_bf16 v[72:75], a[236:239], a[180:183], v[72:75]
 v_add_f32 v6, v6, v15
 v_mfma_f32_16x16x32_bf16 v[76:79], a[236:239], a[188:191], v[76:79]
 buffer_load_dwordx4 a[236:239], v0, s[12:15], s24 offen offset:3072
 v_mfma_f32_16x16x32_bf16 v[76:79], a[232:235], a[184:187], v[76:79]
 s_waitcnt vmcnt(9)
 v_mfma_f32_16x16x32_bf16 v[108:111], a[192:195], a[184:187], v[108:111]
 v_accvgpr_write_b32 a251, v6
 v_mfma_f32_16x16x32_bf16 v[108:111], a[196:199], a[188:191], v[108:111]
 buffer_load_dwordx4 a[232:235], v0, s[12:15], s24 offen offset:2048
 v_mfma_f32_16x16x32_bf16 v[104:107], a[196:199], a[180:183], v[104:107]
 v_accvgpr_read_b32 v5, a252
 v_mfma_f32_16x16x32_bf16 v[104:107], a[192:195], a[176:179], v[104:107]
 s_add_u32 s24, s24, 4096
 v_mfma_f32_16x16x32_bf16 v[100:103], a[192:195], a[168:171], v[100:103]
 v_add_f32 v5, v5, v12
 v_mfma_f32_16x16x32_bf16 v[100:103], a[196:199], a[172:175], v[100:103]
 v_accvgpr_write_b32 a252, v5
 v_mfma_f32_16x16x32_bf16 v[96:99], a[196:199], a[164:167], v[96:99]
 v_accvgpr_read_b32 v6, a253
 v_mfma_f32_16x16x32_bf16 v[96:99], a[192:195], a[160:163], v[96:99]
 v_add_f32 v6, v6, v13
 v_mfma_f32_16x16x32_bf16 v[92:95], a[192:195], a[152:155], v[92:95]
 v_accvgpr_write_b32 a253, v6
 v_mfma_f32_16x16x32_bf16 v[92:95], a[196:199], a[156:159], v[92:95]
 v_accvgpr_read_b32 v5, a254
 v_mfma_f32_16x16x32_bf16 v[88:91], a[196:199], a[148:151], v[88:91]
 v_add_f32 v5, v5, v14
 v_accvgpr_write_b32 a254, v5
 v_mfma_f32_16x16x32_bf16 v[88:91], a[192:195], a[144:147], v[88:91]
 v_accvgpr_read_b32 v6, a255
 v_mfma_f32_16x16x32_bf16 v[84:87], a[192:195], a[136:139], v[84:87]
 v_add_f32 v6, v6, v15
 v_mfma_f32_16x16x32_bf16 v[84:87], a[196:199], a[140:143], v[84:87]
 v_accvgpr_write_b32 a255, v6
 v_mfma_f32_16x16x32_bf16 v[80:83], a[196:199], a[132:135], v[80:83]
 buffer_load_dwordx4 a[196:199], v0, s[12:15], s24 offen offset:1024
 v_mfma_f32_16x16x32_bf16 v[80:83], a[192:195], a[128:131], v[80:83]
 s_waitcnt vmcnt(9)
 v_mfma_f32_16x16x32_bf16 v[112:115], a[200:203], a[128:131], v[112:115]
 ds_read_b128 a[128:131], v1 offset:2048
 v_mfma_f32_16x16x32_bf16 v[112:115], a[204:207], a[132:135], v[112:115]
 buffer_load_dwordx4 a[192:195], v0, s[12:15], s24 offen
 ds_read_b128 a[132:135], v1 offset:3072
 v_mfma_f32_16x16x32_bf16 v[116:119], a[204:207], a[140:143], v[116:119]
 ds_read_b128 a[140:143], v1 offset:7168
 v_mfma_f32_16x16x32_bf16 v[116:119], a[200:203], a[136:139], v[116:119]
 ds_read_b128 a[136:139], v1 offset:6144
 v_mfma_f32_16x16x32_bf16 v[120:123], a[200:203], a[144:147], v[120:123]
 ds_read_b128 a[144:147], v1 offset:10240
 v_mfma_f32_16x16x32_bf16 v[120:123], a[204:207], a[148:151], v[120:123]
 ds_read_b128 a[148:151], v1 offset:11264
 v_mfma_f32_16x16x32_bf16 v[124:127], a[204:207], a[156:159], v[124:127]
 ds_read_b128 a[156:159], v1 offset:15360
 v_mfma_f32_16x16x32_bf16 v[124:127], a[200:203], a[152:155], v[124:127]
 ds_read_b128 a[152:155], v1 offset:14336
 v_mfma_f32_16x16x32_bf16 v[128:131], a[200:203], a[160:163], v[128:131]
 ds_read_b128 a[160:163], v1 offset:18432
 v_mfma_f32_16x16x32_bf16 v[128:131], a[204:207], a[164:167], v[128:131]
 ds_read_b128 a[164:167], v1 offset:19456
 v_mfma_f32_16x16x32_bf16 v[132:135], a[204:207], a[172:175], v[132:135]
 ds_read_b128 a[172:175], v1 offset:23552
 v_mfma_f32_16x16x32_bf16 v[132:135], a[200:203], a[168:171], v[132:135]
 ds_read_b128 a[168:171], v1 offset:22528
 v_mfma_f32_16x16x32_bf16 a[240:243], a[200:203], a[176:179], a[240:243]
 ds_read_b128 a[176:179], v1 offset:26624
 v_mfma_f32_16x16x32_bf16 a[240:243], a[204:207], a[180:183], a[240:243]
 ds_read_b128 a[180:183], v1 offset:27648
 v_mfma_f32_16x16x32_bf16 a[244:247], a[204:207], a[188:191], a[244:247]
 buffer_load_dwordx4 a[204:207], v0, s[12:15], s24 offen offset:3072
 ds_read_b128 a[188:191], v1 offset:31744
 v_mfma_f32_16x16x32_bf16 a[244:247], a[200:203], a[184:187], a[244:247]
 buffer_load_dwordx4 a[200:203], v0, s[12:15], s24 offen offset:2048
 s_add_u32 s24, s24, 4096
 ds_read_b128 a[184:187], v1 offset:30720
 s_waitcnt vmcnt(10) lgkmcnt(8)
 s_add_u32 s51, s51, 2048
 s_add_u32 s25, s25, 1
 s_cmp_eq_u32 s25, 6
 s_cbranch_scc1 Llast
 v_mfma_f32_16x16x32_bf16 v[136:139], a[208:211], a[128:131], v[136:139]
 v_accvgpr_read_b32 v5, a0
 v_lshlrev_b32 v6, 16, v5
 v_and_b32 v5, s26, v5
 v_mfma_f32_16x16x32_bf16 v[136:139], a[212:215], a[132:135], v[136:139]
 v_mul_f32 v6, v6, v16
 v_mul_f32 v5, v5, v17
 v_mfma_f32_16x16x32_bf16 v[140:143], a[212:215], a[140:143], v[140:143]
 v_cvt_pk_bf16_f32 v8, v6, v5
 v_accvgpr_read_b32 v5, a1
 v_mfma_f32_16x16x32_bf16 v[140:143], a[208:211], a[136:139], v[140:143]
 v_lshlrev_b32 v6, 16, v5
 v_and_b32 v5, s26, v5
 v_mul_f32 v6, v6, v18
 v_mfma_f32_16x16x32_bf16 v[144:147], a[208:211], a[144:147], v[144:147]
 v_mul_f32 v5, v5, v19
 v_cvt_pk_bf16_f32 v9, v6, v5
 v_mfma_f32_16x16x32_bf16 v[144:147], a[212:215], a[148:151], v[144:147]
 v_accvgpr_read_b32 v5, a2
 v_lshlrev_b32 v6, 16, v5
 v_mfma_f32_16x16x32_bf16 v[148:151], a[212:215], a[156:159], v[148:151]
 v_and_b32 v5, s26, v5
 v_mul_f32 v6, v6, v48
 v_mfma_f32_16x16x32_bf16 v[148:151], a[208:211], a[152:155], v[148:151]
 v_mul_f32 v5, v5, v49
 v_cvt_pk_bf16_f32 v10, v6, v5
 s_waitcnt lgkmcnt(0)
 v_mfma_f32_16x16x32_bf16 v[152:155], a[208:211], a[160:163], v[152:155]
 v_accvgpr_read_b32 v5, a3
 v_lshlrev_b32 v6, 16, v5
 v_mfma_f32_16x16x32_bf16 v[152:155], a[212:215], a[164:167], v[152:155]
 v_and_b32 v5, s26, v5
 v_mul_f32 v6, v6, v50
 v_mfma_f32_16x16x32_bf16 v[156:159], a[212:215], a[172:175], v[156:159]
 v_mul_f32 v5, v5, v51
 v_cvt_pk_bf16_f32 v11, v6, v5
 ds_write_b128 v3, v[8:11]
 v_mfma_f32_16x16x32_bf16 v[156:159], a[208:211], a[168:171], v[156:159]
 s_add_u32 s68, s29, 0
 buffer_store_dwordx4 v[8:11], v3, s[32:35], s68 offen sc1
 v_mfma_f32_16x16x32_bf16 v[160:163], a[208:211], a[176:179], v[160:163]
 v_accvgpr_read_b32 v5, a32
 v_lshlrev_b32 v6, 16, v5
 v_mfma_f32_16x16x32_bf16 v[160:163], a[212:215], a[180:183], v[160:163]
 v_and_b32 v5, s26, v5
 v_mul_f32 v6, v6, v80
 v_mfma_f32_16x16x32_bf16 v[164:167], a[212:215], a[188:191], v[164:167]
 v_mul_f32 v5, v5, v81
 v_cvt_pk_bf16_f32 v12, v6, v5
 buffer_load_dwordx4 a[212:215], v0, s[12:15], s24 offen offset:1024
 v_mfma_f32_16x16x32_bf16 v[164:167], a[208:211], a[184:187], v[164:167]
 v_accvgpr_read_b32 v5, a33
 s_waitcnt vmcnt(10)
 v_mfma_f32_16x16x32_bf16 v[196:199], a[216:219], a[184:187], v[196:199]
 v_lshlrev_b32 v6, 16, v5
 v_and_b32 v5, s26, v5
 v_mfma_f32_16x16x32_bf16 v[196:199], a[220:223], a[188:191], v[196:199]
 v_mul_f32 v6, v6, v82
 v_mul_f32 v5, v5, v83
 buffer_load_dwordx4 a[208:211], v0, s[12:15], s24 offen
 v_mfma_f32_16x16x32_bf16 v[192:195], a[220:223], a[180:183], v[192:195]
 v_cvt_pk_bf16_f32 v13, v6, v5
 v_accvgpr_read_b32 v5, a34
 v_mfma_f32_16x16x32_bf16 v[192:195], a[216:219], a[176:179], v[192:195]
 v_lshlrev_b32 v6, 16, v5
 v_and_b32 v5, s26, v5
 v_mfma_f32_16x16x32_bf16 v[188:191], a[216:219], a[168:171], v[188:191]
 v_mul_f32 v6, v6, v112
 v_mul_f32 v5, v5, v113
 v_mfma_f32_16x16x32_bf16 v[188:191], a[220:223], a[172:175], v[188:191]
 v_cvt_pk_bf16_f32 v14, v6, v5
 v_accvgpr_read_b32 v5, a35
 v_lshlrev_b32 v6, 16, v5
 v_mfma_f32_16x16x32_bf16 v[184:187], a[220:223], a[164:167], v[184:187]
 v_and_b32 v5, s26, v5
 v_mul_f32 v6, v6, v114
 v_mfma_f32_16x16x32_bf16 v[184:187], a[216:219], a[160:163], v[184:187]
 v_mul_f32 v5, v5, v115
 v_cvt_pk_bf16_f32 v15, v6, v5
 v_mfma_f32_16x16x32_bf16 v[180:183], a[216:219], a[152:155], v[180:183]
 ds_write_b128 v3, v[12:15] offset:1024
 buffer_store_dwordx4 v[12:15], v3, s[32:35], s68 offen offset:1024 sc1
 v_accvgpr_read_b32 v5, a4
 v_mfma_f32_16x16x32_bf16 v[180:183], a[220:223], a[156:159], v[180:183]
 v_lshlrev_b32 v6, 16, v5
 v_and_b32 v5, s26, v5
 v_mfma_f32_16x16x32_bf16 v[176:179], a[220:223], a[148:151], v[176:179]
 v_mul_f32 v6, v6, v20
 v_mul_f32 v5, v5, v21
 v_mfma_f32_16x16x32_bf16 v[176:179], a[216:219], a[144:147], v[176:179]
 v_cvt_pk_bf16_f32 v8, v6, v5
 v_accvgpr_read_b32 v5, a5
 v_mfma_f32_16x16x32_bf16 v[172:175], a[216:219], a[136:139], v[172:175]
 v_lshlrev_b32 v6, 16, v5
 v_and_b32 v5, s26, v5
 v_mul_f32 v6, v6, v22
 v_mfma_f32_16x16x32_bf16 v[172:175], a[220:223], a[140:143], v[172:175]
 v_mul_f32 v5, v5, v23
 v_cvt_pk_bf16_f32 v9, v6, v5
 v_mfma_f32_16x16x32_bf16 v[168:171], a[220:223], a[132:135], v[168:171]
 v_accvgpr_read_b32 v5, a6
 buffer_load_dwordx4 a[220:223], v0, s[12:15], s24 offen offset:3072
 v_mfma_f32_16x16x32_bf16 v[168:171], a[216:219], a[128:131], v[168:171]
 v_lshlrev_b32 v6, 16, v5
 v_and_b32 v5, s26, v5
 s_waitcnt vmcnt(11)
 v_mfma_f32_16x16x32_bf16 v[200:203], a[224:227], a[128:131], v[200:203]
 v_mul_f32 v6, v6, v52
 v_mul_f32 v5, v5, v53
 v_mfma_f32_16x16x32_bf16 v[200:203], a[228:231], a[132:135], v[200:203]
 v_cvt_pk_bf16_f32 v10, v6, v5
 buffer_load_dwordx4 a[216:219], v0, s[12:15], s24 offen offset:2048
 v_mfma_f32_16x16x32_bf16 v[204:207], a[228:231], a[140:143], v[204:207]
 v_accvgpr_read_b32 v5, a7
 v_lshlrev_b32 v6, 16, v5
 v_mfma_f32_16x16x32_bf16 v[204:207], a[224:227], a[136:139], v[204:207]
 v_and_b32 v5, s26, v5
 v_mul_f32 v6, v6, v54
 s_add_u32 s24, s24, 4096
 v_mfma_f32_16x16x32_bf16 v[208:211], a[224:227], a[144:147], v[208:211]
 v_mul_f32 v5, v5, v55
 v_cvt_pk_bf16_f32 v11, v6, v5
 v_mfma_f32_16x16x32_bf16 v[208:211], a[228:231], a[148:151], v[208:211]
 ds_write_b128 v3, v[8:11] offset:4096
 buffer_store_dwordx4 v[8:11], v3, s[32:35], s68 offen offset:2048 sc1
 v_mfma_f32_16x16x32_bf16 v[212:215], a[228:231], a[156:159], v[212:215]
 v_accvgpr_read_b32 v5, a36
 v_lshlrev_b32 v6, 16, v5
 v_and_b32 v5, s26, v5
 v_mfma_f32_16x16x32_bf16 v[212:215], a[224:227], a[152:155], v[212:215]
 v_mul_f32 v6, v6, v84
 v_mul_f32 v5, v5, v85
 v_mfma_f32_16x16x32_bf16 v[216:219], a[224:227], a[160:163], v[216:219]
 v_cvt_pk_bf16_f32 v12, v6, v5
 v_accvgpr_read_b32 v5, a37
 v_mfma_f32_16x16x32_bf16 v[216:219], a[228:231], a[164:167], v[216:219]
 v_lshlrev_b32 v6, 16, v5
 v_and_b32 v5, s26, v5
 v_mfma_f32_16x16x32_bf16 v[220:223], a[228:231], a[172:175], v[220:223]
 v_mul_f32 v6, v6, v86
 v_mul_f32 v5, v5, v87
 v_cvt_pk_bf16_f32 v13, v6, v5
 v_mfma_f32_16x16x32_bf16 v[220:223], a[224:227], a[168:171], v[220:223]
 v_accvgpr_read_b32 v5, a38
 v_lshlrev_b32 v6, 16, v5
 v_mfma_f32_16x16x32_bf16 v[224:227], a[224:227], a[176:179], v[224:227]
 v_and_b32 v5, s26, v5
 v_mul_f32 v6, v6, v116
 v_mfma_f32_16x16x32_bf16 v[224:227], a[228:231], a[180:183], v[224:227]
 v_mul_f32 v5, v5, v117
 v_cvt_pk_bf16_f32 v14, v6, v5
 v_accvgpr_read_b32 v5, a39
 v_mfma_f32_16x16x32_bf16 v[228:231], a[228:231], a[188:191], v[228:231]
 v_lshlrev_b32 v6, 16, v5
 buffer_load_dwordx4 a[228:231], v0, s[12:15], s24 offen offset:1024
 v_mfma_f32_16x16x32_bf16 v[228:231], a[224:227], a[184:187], v[228:231]
 v_and_b32 v5, s26, v5
 s_waitcnt vmcnt(12)
 v_mfma_f32_16x16x32_bf16 a[252:255], a[232:235], a[184:187], a[252:255]
 v_mul_f32 v6, v6, v118
 ds_read_b128 a[184:187], v1 offset:63488
 v_mfma_f32_16x16x32_bf16 a[252:255], a[236:239], a[188:191], a[252:255]
 v_mul_f32 v5, v5, v119
 buffer_load_dwordx4 a[224:227], v0, s[12:15], s24 offen
 ds_read_b128 a[188:191], v1 offset:64512
 v_mfma_f32_16x16x32_bf16 a[248:251], a[236:239], a[180:183], a[248:251]
 v_cvt_pk_bf16_f32 v15, v6, v5
 ds_read_b128 a[180:183], v1 offset:60416
 v_mfma_f32_16x16x32_bf16 a[248:251], a[232:235], a[176:179], a[248:251]
 ds_write_b128 v3, v[12:15] offset:5120
 ds_read_b128 a[176:179], v1 offset:59392
 v_mfma_f32_16x16x32_bf16 v[252:255], a[232:235], a[168:171], v[252:255]
 buffer_store_dwordx4 v[12:15], v3, s[32:35], s68 offen offset:3072 sc1
 v_accvgpr_read_b32 v5, a8
 ds_read_b128 a[168:171], v1 offset:55296
 v_mfma_f32_16x16x32_bf16 v[252:255], a[236:239], a[172:175], v[252:255]
 v_lshlrev_b32 v6, 16, v5
 ds_read_b128 a[172:175], v1 offset:56320
 v_mfma_f32_16x16x32_bf16 v[248:251], a[236:239], a[164:167], v[248:251]
 v_and_b32 v5, s26, v5
 ds_read_b128 a[164:167], v1 offset:52224
 v_mfma_f32_16x16x32_bf16 v[248:251], a[232:235], a[160:163], v[248:251]
 v_mul_f32 v6, v6, v24
 ds_read_b128 a[160:163], v1 offset:51200
 v_mfma_f32_16x16x32_bf16 v[244:247], a[232:235], a[152:155], v[244:247]
 v_mul_f32 v5, v5, v25
 v_cvt_pk_bf16_f32 v8, v6, v5
 ds_read_b128 a[152:155], v1 offset:47104
 v_mfma_f32_16x16x32_bf16 v[244:247], a[236:239], a[156:159], v[244:247]
 v_accvgpr_read_b32 v5, a9
 ds_read_b128 a[156:159], v1 offset:48128
 v_mfma_f32_16x16x32_bf16 v[240:243], a[236:239], a[148:151], v[240:243]
 v_lshlrev_b32 v6, 16, v5
 ds_read_b128 a[148:151], v1 offset:44032
 v_mfma_f32_16x16x32_bf16 v[240:243], a[232:235], a[144:147], v[240:243]
 v_and_b32 v5, s26, v5
 ds_read_b128 a[144:147], v1 offset:43008
 v_mfma_f32_16x16x32_bf16 v[236:239], a[232:235], a[136:139], v[236:239]
 v_mul_f32 v6, v6, v26
 v_mul_f32 v5, v5, v27
 ds_read_b128 a[136:139], v1 offset:38912
 v_mfma_f32_16x16x32_bf16 v[236:239], a[236:239], a[140:143], v[236:239]
 v_cvt_pk_bf16_f32 v9, v6, v5
 ds_read_b128 a[140:143], v1 offset:39936
 v_mfma_f32_16x16x32_bf16 v[232:235], a[236:239], a[132:135], v[232:235]
 v_accvgpr_read_b32 v5, a10
 ds_read_b128 a[132:135], v1 offset:35840
 v_mfma_f32_16x16x32_bf16 v[232:235], a[232:235], a[128:131], v[232:235]
 v_lshlrev_b32 v6, 16, v5
 ds_read_b128 a[128:131], v1 offset:34816
 s_waitcnt vmcnt(12) lgkmcnt(8)
 v_mfma_f32_16x16x32_bf16 v[164:167], a[192:195], a[184:187], v[164:167]
 v_and_b32 v5, s26, v5
 v_mul_f32 v6, v6, v56
 v_mfma_f32_16x16x32_bf16 v[164:167], a[196:199], a[188:191], v[164:167]
 v_mul_f32 v5, v5, v57
 buffer_load_dwordx4 a[236:239], v0, s[12:15], s24 offen offset:3072
 v_mfma_f32_16x16x32_bf16 v[160:163], a[196:199], a[180:183], v[160:163]
 v_cvt_pk_bf16_f32 v10, v6, v5
 v_accvgpr_read_b32 v5, a11
 v_mfma_f32_16x16x32_bf16 v[160:163], a[192:195], a[176:179], v[160:163]
 v_lshlrev_b32 v6, 16, v5
 v_and_b32 v5, s26, v5
 buffer_load_dwordx4 a[232:235], v0, s[12:15], s24 offen offset:2048
 v_mfma_f32_16x16x32_bf16 v[156:159], a[192:195], a[168:171], v[156:159]
 v_mul_f32 v6, v6, v58
 s_add_u32 s24, s24, 4096
 v_mfma_f32_16x16x32_bf16 v[156:159], a[196:199], a[172:175], v[156:159]
 v_mul_f32 v5, v5, v59
 v_cvt_pk_bf16_f32 v11, v6, v5
 v_mfma_f32_16x16x32_bf16 v[152:155], a[196:199], a[164:167], v[152:155]
 ds_write_b128 v3, v[8:11] offset:8192
 s_add_u32 s68, s29, 4096
 buffer_store_dwordx4 v[8:11], v3, s[32:35], s68 offen sc1
 v_mfma_f32_16x16x32_bf16 v[152:155], a[192:195], a[160:163], v[152:155]
 v_accvgpr_read_b32 v5, a40
 s_waitcnt lgkmcnt(1)
 v_mfma_f32_16x16x32_bf16 v[148:151], a[192:195], a[152:155], v[148:151]
 v_lshlrev_b32 v6, 16, v5
 v_and_b32 v5, s26, v5
 v_mfma_f32_16x16x32_bf16 v[148:151], a[196:199], a[156:159], v[148:151]
 v_mul_f32 v6, v6, v88
 v_mul_f32 v5, v5, v89
 v_mfma_f32_16x16x32_bf16 v[144:147], a[196:199], a[148:151], v[144:147]
 v_cvt_pk_bf16_f32 v12, v6, v5
 v_accvgpr_read_b32 v5, a41
 v_lshlrev_b32 v6, 16, v5
 v_mfma_f32_16x16x32_bf16 v[144:147], a[192:195], a[144:147], v[144:147]
 v_and_b32 v5, s26, v5
 v_mul_f32 v6, v6, v90
 v_mfma_f32_16x16x32_bf16 v[140:143], a[192:195], a[136:139], v[140:143]
 v_mul_f32 v5, v5, v91
 v_cvt_pk_bf16_f32 v13, v6, v5
 v_mfma_f32_16x16x32_bf16 v[140:143], a[196:199], a[140:143], v[140:143]
 v_accvgpr_read_b32 v5, a42
 v_lshlrev_b32 v6, 16, v5
 v_and_b32 v5, s26, v5
 v_mfma_f32_16x16x32_bf16 v[136:139], a[196:199], a[132:135], v[136:139]
 v_mul_f32 v6, v6, v120
 buffer_load_dwordx4 a[196:199], v0, s[12:15], s24 offen offset:1024
 v_mfma_f32_16x16x32_bf16 v[136:139], a[192:195], a[128:131], v[136:139]
 v_mul_f32 v5, v5, v121
 s_waitcnt vmcnt(14)
 v_mfma_f32_16x16x32_bf16 v[168:171], a[200:203], a[128:131], v[168:171]
 v_cvt_pk_bf16_f32 v14, v6, v5
 v_accvgpr_read_b32 v5, a43
 v_mfma_f32_16x16x32_bf16 v[168:171], a[204:207], a[132:135], v[168:171]
 v_lshlrev_b32 v6, 16, v5
 v_and_b32 v5, s26, v5
 buffer_load_dwordx4 a[192:195], v0, s[12:15], s24 offen
 v_mfma_f32_16x16x32_bf16 v[172:175], a[204:207], a[140:143], v[172:175]
 v_mul_f32 v6, v6, v122
 v_mul_f32 v5, v5, v123
 v_mfma_f32_16x16x32_bf16 v[172:175], a[200:203], a[136:139], v[172:175]
 v_cvt_pk_bf16_f32 v15, v6, v5
 ds_write_b128 v3, v[12:15] offset:9216
 v_mfma_f32_16x16x32_bf16 v[176:179], a[200:203], a[144:147], v[176:179]
 v_lshlrev_b32 v4, 2, v1
 v_and_b32 v4, 192, v4
 buffer_load_dword v4, v4, s[44:47], 0 offen sc1
 v_mfma_f32_16x16x32_bf16 v[176:179], a[204:207], a[148:151], v[176:179]
 buffer_store_dwordx4 v[12:15], v3, s[32:35], s68 offen offset:1024 sc1
 v_accvgpr_read_b32 v5, a12
 v_mfma_f32_16x16x32_bf16 v[180:183], a[204:207], a[156:159], v[180:183]
 v_lshlrev_b32 v6, 16, v5
 v_and_b32 v5, s26, v5
 v_mfma_f32_16x16x32_bf16 v[180:183], a[200:203], a[152:155], v[180:183]
 v_mul_f32 v6, v6, v28
 v_mul_f32 v5, v5, v29
 v_mfma_f32_16x16x32_bf16 v[184:187], a[200:203], a[160:163], v[184:187]
 v_cvt_pk_bf16_f32 v8, v6, v5
 v_accvgpr_read_b32 v5, a13
 v_lshlrev_b32 v6, 16, v5
 v_mfma_f32_16x16x32_bf16 v[184:187], a[204:207], a[164:167], v[184:187]
 v_and_b32 v5, s26, v5
 v_mul_f32 v6, v6, v30
 v_mfma_f32_16x16x32_bf16 v[188:191], a[204:207], a[172:175], v[188:191]
 v_mul_f32 v5, v5, v31
 v_cvt_pk_bf16_f32 v9, v6, v5
 v_mfma_f32_16x16x32_bf16 v[188:191], a[200:203], a[168:171], v[188:191]
 v_accvgpr_read_b32 v5, a14
 v_lshlrev_b32 v6, 16, v5
 v_and_b32 v5, s26, v5
 v_mfma_f32_16x16x32_bf16 v[192:195], a[200:203], a[176:179], v[192:195]
 v_mul_f32 v6, v6, v60
 v_mul_f32 v5, v5, v61
 v_mfma_f32_16x16x32_bf16 v[192:195], a[204:207], a[180:183], v[192:195]
 v_cvt_pk_bf16_f32 v10, v6, v5
 v_accvgpr_read_b32 v5, a15
 v_mfma_f32_16x16x32_bf16 v[196:199], a[204:207], a[188:191], v[196:199]
 v_lshlrev_b32 v6, 16, v5
 buffer_load_dwordx4 a[204:207], v0, s[12:15], s24 offen offset:3072
 v_mfma_f32_16x16x32_bf16 v[196:199], a[200:203], a[184:187], v[196:199]
 v_and_b32 v5, s26, v5
 v_mul_f32 v6, v6, v62
 s_waitcnt vmcnt(15)
 v_mfma_f32_16x16x32_bf16 v[228:231], a[208:211], a[184:187], v[228:231]
 v_mul_f32 v5, v5, v63
 v_cvt_pk_bf16_f32 v11, v6, v5
 v_mfma_f32_16x16x32_bf16 v[228:231], a[212:215], a[188:191], v[228:231]
 ds_write_b128 v3, v[8:11] offset:12288
 buffer_load_dwordx4 a[200:203], v0, s[12:15], s24 offen offset:2048
 v_mfma_f32_16x16x32_bf16 v[224:227], a[212:215], a[180:183], v[224:227]
 buffer_store_dwordx4 v[8:11], v3, s[32:35], s68 offen offset:2048 sc1
 v_accvgpr_read_b32 v5, a44
 v_lshlrev_b32 v6, 16, v5
 v_mfma_f32_16x16x32_bf16 v[224:227], a[208:211], a[176:179], v[224:227]
 v_and_b32 v5, s26, v5
 s_add_u32 s24, s24, 4096
 v_mfma_f32_16x16x32_bf16 v[220:223], a[208:211], a[168:171], v[220:223]
 v_mul_f32 v6, v6, v92
 v_mul_f32 v5, v5, v93
 v_mfma_f32_16x16x32_bf16 v[220:223], a[212:215], a[172:175], v[220:223]
 v_cvt_pk_bf16_f32 v12, v6, v5
 v_accvgpr_read_b32 v5, a45
 v_mfma_f32_16x16x32_bf16 v[216:219], a[212:215], a[164:167], v[216:219]
 v_lshlrev_b32 v6, 16, v5
 v_and_b32 v5, s26, v5
 v_mul_f32 v6, v6, v94
 v_mfma_f32_16x16x32_bf16 v[216:219], a[208:211], a[160:163], v[216:219]
 v_mul_f32 v5, v5, v95
 v_cvt_pk_bf16_f32 v13, v6, v5
 v_mfma_f32_16x16x32_bf16 v[212:215], a[208:211], a[152:155], v[212:215]
 v_accvgpr_read_b32 v5, a46
 v_lshlrev_b32 v6, 16, v5
 v_mfma_f32_16x16x32_bf16 v[212:215], a[212:215], a[156:159], v[212:215]
 v_and_b32 v5, s26, v5
 v_mul_f32 v6, v6, v124
 v_mul_f32 v5, v5, v125
 v_mfma_f32_16x16x32_bf16 v[208:211], a[212:215], a[148:151], v[208:211]
 v_cvt_pk_bf16_f32 v14, v6, v5
 v_accvgpr_read_b32 v5, a47
 v_mfma_f32_16x16x32_bf16 v[208:211], a[208:211], a[144:147], v[208:211]
 v_lshlrev_b32 v6, 16, v5
 v_and_b32 v5, s26, v5
 v_mfma_f32_16x16x32_bf16 v[204:207], a[208:211], a[136:139], v[204:207]
 v_mul_f32 v6, v6, v126
 v_mul_f32 v5, v5, v127
 v_mfma_f32_16x16x32_bf16 v[204:207], a[212:215], a[140:143], v[204:207]
 v_cvt_pk_bf16_f32 v15, v6, v5
 ds_write_b128 v3, v[12:15] offset:13312
 buffer_store_dwordx4 v[12:15], v3, s[32:35], s68 offen offset:3072 sc1
 v_mfma_f32_16x16x32_bf16 v[200:203], a[212:215], a[132:135], v[200:203]
 v_accvgpr_read_b32 v5, a16
 buffer_load_dwordx4 a[212:215], v0, s[12:15], s24 offen offset:1024
 v_mfma_f32_16x16x32_bf16 v[200:203], a[208:211], a[128:131], v[200:203]
 v_lshlrev_b32 v6, 16, v5
 s_waitcnt vmcnt(16)
 v_mfma_f32_16x16x32_bf16 v[232:235], a[216:219], a[128:131], v[232:235]
 v_and_b32 v5, s26, v5
 v_mul_f32 v6, v6, v32
 ds_read_b128 a[128:131], v2 offset:2048
 v_mfma_f32_16x16x32_bf16 v[232:235], a[220:223], a[132:135], v[232:235]
 buffer_load_dwordx4 a[208:211], v0, s[12:15], s24 offen
 ds_read_b128 a[132:135], v2 offset:3072
 v_mfma_f32_16x16x32_bf16 v[236:239], a[220:223], a[140:143], v[236:239]
 v_mul_f32 v5, v5, v33
 ds_read_b128 a[140:143], v2 offset:7168
 v_mfma_f32_16x16x32_bf16 v[236:239], a[216:219], a[136:139], v[236:239]
 v_cvt_pk_bf16_f32 v8, v6, v5
 ds_read_b128 a[136:139], v2 offset:6144
 v_mfma_f32_16x16x32_bf16 v[240:243], a[216:219], a[144:147], v[240:243]
 v_accvgpr_read_b32 v5, a17
 v_lshlrev_b32 v6, 16, v5
 ds_read_b128 a[144:147], v2 offset:10240
 v_mfma_f32_16x16x32_bf16 v[240:243], a[220:223], a[148:151], v[240:243]
 v_and_b32 v5, s26, v5
 ds_read_b128 a[148:151], v2 offset:11264
 v_mfma_f32_16x16x32_bf16 v[244:247], a[220:223], a[156:159], v[244:247]
 v_mul_f32 v6, v6, v34
 ds_read_b128 a[156:159], v2 offset:15360
 v_mfma_f32_16x16x32_bf16 v[244:247], a[216:219], a[152:155], v[244:247]
 v_mul_f32 v5, v5, v35
 ds_read_b128 a[152:155], v2 offset:14336
 v_mfma_f32_16x16x32_bf16 v[248:251], a[216:219], a[160:163], v[248:251]
 v_cvt_pk_bf16_f32 v9, v6, v5
 v_accvgpr_read_b32 v5, a18
 ds_read_b128 a[160:163], v2 offset:18432
 v_mfma_f32_16x16x32_bf16 v[248:251], a[220:223], a[164:167], v[248:251]
 v_lshlrev_b32 v6, 16, v5
 ds_read_b128 a[164:167], v2 offset:19456
 v_mfma_f32_16x16x32_bf16 v[252:255], a[220:223], a[172:175], v[252:255]
 v_and_b32 v5, s26, v5
 ds_read_b128 a[172:175], v2 offset:23552
 v_mfma_f32_16x16x32_bf16 v[252:255], a[216:219], a[168:171], v[252:255]
 v_mul_f32 v6, v6, v64
 v_mul_f32 v5, v5, v65
 ds_read_b128 a[168:171], v2 offset:22528
 v_mfma_f32_16x16x32_bf16 a[248:251], a[216:219], a[176:179], a[248:251]
 v_cvt_pk_bf16_f32 v10, v6, v5
 ds_read_b128 a[176:179], v2 offset:26624
 v_mfma_f32_16x16x32_bf16 a[248:251], a[220:223], a[180:183], a[248:251]
 v_accvgpr_read_b32 v5, a19
 ds_read_b128 a[180:183], v2 offset:27648
 v_mfma_f32_16x16x32_bf16 a[252:255], a[220:223], a[188:191], a[252:255]
 v_lshlrev_b32 v6, 16, v5
 ds_read_b128 a[188:191], v2 offset:31744
 v_mfma_f32_16x16x32_bf16 a[252:255], a[216:219], a[184:187], a[252:255]
 v_and_b32 v5, s26, v5
 ds_read_b128 a[184:187], v2 offset:30720
 s_waitcnt vmcnt(14) lgkmcnt(8)
 v_mfma_f32_16x16x32_bf16 v[136:139], a[224:227], a[128:131], v[136:139]
 v_mul_f32 v6, v6, v66
 v_mul_f32 v5, v5, v67
 v_mfma_f32_16x16x32_bf16 v[136:139], a[228:231], a[132:135], v[136:139]
 v_cvt_pk_bf16_f32 v11, v6, v5
 buffer_load_dwordx4 a[220:223], v0, s[12:15], s24 offen offset:3072
 v_mfma_f32_16x16x32_bf16 v[140:143], a[228:231], a[140:143], v[140:143]
 ds_write_b128 v3, v[8:11] offset:16384
 s_add_u32 s68, s29, 8192
 buffer_store_dwordx4 v[8:11], v3, s[32:35], s68 offen sc1
 v_mfma_f32_16x16x32_bf16 v[140:143], a[224:227], a[136:139], v[140:143]
 v_accvgpr_read_b32 v5, a48
 buffer_load_dwordx4 a[216:219], v0, s[12:15], s24 offen offset:2048
 v_mfma_f32_16x16x32_bf16 v[144:147], a[224:227], a[144:147], v[144:147]
 v_lshlrev_b32 v6, 16, v5
 s_add_u32 s24, s24, 4096
 v_mfma_f32_16x16x32_bf16 v[144:147], a[228:231], a[148:151], v[144:147]
 v_and_b32 v5, s26, v5
 v_mul_f32 v6, v6, v96
 v_mfma_f32_16x16x32_bf16 v[148:151], a[228:231], a[156:159], v[148:151]
 v_mul_f32 v5, v5, v97
 v_cvt_pk_bf16_f32 v12, v6, v5
 v_accvgpr_read_b32 v5, a49
 v_mfma_f32_16x16x32_bf16 v[148:151], a[224:227], a[152:155], v[148:151]
 v_lshlrev_b32 v6, 16, v5
 s_waitcnt lgkmcnt(1)
 v_mfma_f32_16x16x32_bf16 v[152:155], a[224:227], a[160:163], v[152:155]
 v_and_b32 v5, s26, v5
 v_mul_f32 v6, v6, v98
 v_mfma_f32_16x16x32_bf16 v[152:155], a[228:231], a[164:167], v[152:155]
 v_mul_f32 v5, v5, v99
 v_cvt_pk_bf16_f32 v13, v6, v5
 v_accvgpr_read_b32 v5, a50
 v_mfma_f32_16x16x32_bf16 v[156:159], a[228:231], a[172:175], v[156:159]
 v_lshlrev_b32 v6, 16, v5
 v_and_b32 v5, s26, v5
 v_mfma_f32_16x16x32_bf16 v[156:159], a[224:227], a[168:171], v[156:159]
 v_mul_f32 v6, v6, v128
 v_mul_f32 v5, v5, v129
 v_mfma_f32_16x16x32_bf16 v[160:163], a[224:227], a[176:179], v[160:163]
 v_cvt_pk_bf16_f32 v14, v6, v5
 v_accvgpr_read_b32 v5, a51
 v_mfma_f32_16x16x32_bf16 v[160:163], a[228:231], a[180:183], v[160:163]
 v_lshlrev_b32 v6, 16, v5
 v_and_b32 v5, s26, v5
 v_mul_f32 v6, v6, v130
 v_mfma_f32_16x16x32_bf16 v[164:167], a[228:231], a[188:191], v[164:167]
 v_mul_f32 v5, v5, v131
 buffer_load_dwordx4 a[228:231], v0, s[12:15], s24 offen offset:1024
 v_mfma_f32_16x16x32_bf16 v[164:167], a[224:227], a[184:187], v[164:167]
 v_cvt_pk_bf16_f32 v15, v6, v5
 s_waitcnt vmcnt(15)
 v_mfma_f32_16x16x32_bf16 v[196:199], a[232:235], a[184:187], v[196:199]
 ds_write_b128 v3, v[12:15] offset:17408
 buffer_store_dwordx4 v[12:15], v3, s[32:35], s68 offen offset:1024 sc1
 v_accvgpr_read_b32 v5, a20
 v_mfma_f32_16x16x32_bf16 v[196:199], a[236:239], a[188:191], v[196:199]
 v_lshlrev_b32 v6, 16, v5
 buffer_load_dwordx4 a[224:227], v0, s[12:15], s24 offen
 v_mfma_f32_16x16x32_bf16 v[192:195], a[236:239], a[180:183], v[192:195]
 v_and_b32 v5, s26, v5
 v_mul_f32 v6, v6, v36
 v_mfma_f32_16x16x32_bf16 v[192:195], a[232:235], a[176:179], v[192:195]
 v_mul_f32 v5, v5, v37
 v_cvt_pk_bf16_f32 v8, v6, v5
 v_mfma_f32_16x16x32_bf16 v[188:191], a[232:235], a[168:171], v[188:191]
 v_accvgpr_read_b32 v5, a21
 v_lshlrev_b32 v6, 16, v5
 v_and_b32 v5, s26, v5
 v_mfma_f32_16x16x32_bf16 v[188:191], a[236:239], a[172:175], v[188:191]
 v_mul_f32 v6, v6, v38
 v_mul_f32 v5, v5, v39
 v_mfma_f32_16x16x32_bf16 v[184:187], a[236:239], a[164:167], v[184:187]
 v_cvt_pk_bf16_f32 v9, v6, v5
 v_accvgpr_read_b32 v5, a22
 v_mfma_f32_16x16x32_bf16 v[184:187], a[232:235], a[160:163], v[184:187]
 v_lshlrev_b32 v6, 16, v5
 v_and_b32 v5, s26, v5
 v_mul_f32 v6, v6, v68
 v_mfma_f32_16x16x32_bf16 v[180:183], a[232:235], a[152:155], v[180:183]
 v_mul_f32 v5, v5, v69
 v_cvt_pk_bf16_f32 v10, v6, v5
 v_mfma_f32_16x16x32_bf16 v[180:183], a[236:239], a[156:159], v[180:183]
 v_accvgpr_read_b32 v5, a23
 v_lshlrev_b32 v6, 16, v5
 v_mfma_f32_16x16x32_bf16 v[176:179], a[236:239], a[148:151], v[176:179]
 v_and_b32 v5, s26, v5
 v_mul_f32 v6, v6, v70
 v_mfma_f32_16x16x32_bf16 v[176:179], a[232:235], a[144:147], v[176:179]
 v_mul_f32 v5, v5, v71
 v_cvt_pk_bf16_f32 v11, v6, v5
 ds_write_b128 v3, v[8:11] offset:20480
 v_mfma_f32_16x16x32_bf16 v[172:175], a[232:235], a[136:139], v[172:175]
 buffer_store_dwordx4 v[8:11], v3, s[32:35], s68 offen offset:2048 sc1
 v_accvgpr_read_b32 v5, a52
 v_mfma_f32_16x16x32_bf16 v[172:175], a[236:239], a[140:143], v[172:175]
 v_lshlrev_b32 v6, 16, v5
 v_and_b32 v5, s26, v5
 v_mfma_f32_16x16x32_bf16 v[168:171], a[236:239], a[132:135], v[168:171]
 v_mul_f32 v6, v6, v100
 v_mul_f32 v5, v5, v101
 buffer_load_dwordx4 a[236:239], v0, s[12:15], s24 offen offset:3072
 v_mfma_f32_16x16x32_bf16 v[168:171], a[232:235], a[128:131], v[168:171]
 v_cvt_pk_bf16_f32 v12, v6, v5
 s_waitcnt vmcnt(16)
 v_mfma_f32_16x16x32_bf16 v[200:203], a[192:195], a[128:131], v[200:203]
 v_accvgpr_read_b32 v5, a53
 v_lshlrev_b32 v6, 16, v5
 v_mfma_f32_16x16x32_bf16 v[200:203], a[196:199], a[132:135], v[200:203]
 v_and_b32 v5, s26, v5
 buffer_load_dwordx4 a[232:235], v0, s[12:15], s24 offen offset:2048
 v_mfma_f32_16x16x32_bf16 v[204:207], a[196:199], a[140:143], v[204:207]
 s_waitcnt vmcnt(16)
 v_cmp_gt_u32 vcc, s27, v4
 s_cbranch_vccnz Lspin_w
Lok_w:
 s_add_u32 s27, s27, 64
 v_mfma_f32_16x16x32_bf16 v[204:207], a[192:195], a[136:139], v[204:207]
 v_mul_f32 v6, v6, v102
 v_mul_f32 v5, v5, v103
 s_add_u32 s24, s24, 1839104
 v_mfma_f32_16x16x32_bf16 v[208:211], a[192:195], a[144:147], v[208:211]
 v_cvt_pk_bf16_f32 v13, v6, v5
 v_accvgpr_read_b32 v5, a54
 v_mfma_f32_16x16x32_bf16 v[208:211], a[196:199], a[148:151], v[208:211]
 v_lshlrev_b32 v6, 16, v5
 v_and_b32 v5, s26, v5
 v_mfma_f32_16x16x32_bf16 v[212:215], a[196:199], a[156:159], v[212:215]
 v_mul_f32 v6, v6, v132
 v_mul_f32 v5, v5, v133
 v_cvt_pk_bf16_f32 v14, v6, v5
 v_mfma_f32_16x16x32_bf16 v[212:215], a[192:195], a[152:155], v[212:215]
 v_accvgpr_read_b32 v5, a55
 v_lshlrev_b32 v6, 16, v5
 v_mfma_f32_16x16x32_bf16 v[216:219], a[192:195], a[160:163], v[216:219]
 v_and_b32 v5, s26, v5
 v_mul_f32 v6, v6, v134
 v_mfma_f32_16x16x32_bf16 v[216:219], a[196:199], a[164:167], v[216:219]
 v_mul_f32 v5, v5, v135
 v_cvt_pk_bf16_f32 v15, v6, v5
 v_mfma_f32_16x16x32_bf16 v[220:223], a[196:199], a[172:175], v[220:223]
 ds_write_b128 v3, v[12:15] offset:21504
 buffer_store_dwordx4 v[12:15], v3, s[32:35], s68 offen offset:3072 sc1
 v_accvgpr_read_b32 v5, a24
 v_mfma_f32_16x16x32_bf16 v[220:223], a[192:195], a[168:171], v[220:223]
 v_lshlrev_b32 v6, 16, v5
 v_and_b32 v5, s26, v5
 v_mfma_f32_16x16x32_bf16 v[224:227], a[192:195], a[176:179], v[224:227]
 v_mul_f32 v6, v6, v40
 v_mul_f32 v5, v5, v41
 v_mfma_f32_16x16x32_bf16 v[224:227], a[196:199], a[180:183], v[224:227]
 v_cvt_pk_bf16_f32 v8, v6, v5
 v_accvgpr_read_b32 v5, a25
 v_lshlrev_b32 v6, 16, v5
 v_mfma_f32_16x16x32_bf16 v[228:231], a[196:199], a[188:191], v[228:231]
 v_and_b32 v5, s26, v5
 buffer_load_dwordx4 a[196:199], v0, s[12:15], s24 offen offset:1024
 v_mfma_f32_16x16x32_bf16 v[228:231], a[192:195], a[184:187], v[228:231]
 v_mul_f32 v6, v6, v42
 s_waitcnt vmcnt(15)
 v_mfma_f32_16x16x32_bf16 a[252:255], a[200:203], a[184:187], a[252:255]
 v_mul_f32 v5, v5, v43
 ds_read_b128 a[184:187], v2 offset:63488
 v_mfma_f32_16x16x32_bf16 a[252:255], a[204:207], a[188:191], a[252:255]
 v_cvt_pk_bf16_f32 v9, v6, v5
 buffer_load_dwordx4 a[192:195], v0, s[12:15], s24 offen
 ds_read_b128 a[188:191], v2 offset:64512
 v_mfma_f32_16x16x32_bf16 a[248:251], a[204:207], a[180:183], a[248:251]
 v_accvgpr_read_b32 v5, a26
 ds_read_b128 a[180:183], v2 offset:60416
 v_mfma_f32_16x16x32_bf16 a[248:251], a[200:203], a[176:179], a[248:251]
 v_lshlrev_b32 v6, 16, v5
 ds_read_b128 a[176:179], v2 offset:59392
 v_mfma_f32_16x16x32_bf16 v[252:255], a[200:203], a[168:171], v[252:255]
 v_and_b32 v5, s26, v5
 ds_read_b128 a[168:171], v2 offset:55296
 v_mfma_f32_16x16x32_bf16 v[252:255], a[204:207], a[172:175], v[252:255]
 v_mul_f32 v6, v6, v72
 v_mul_f32 v5, v5, v73
 ds_read_b128 a[172:175], v2 offset:56320
 v_mfma_f32_16x16x32_bf16 v[248:251], a[204:207], a[164:167], v[248:251]
 v_cvt_pk_bf16_f32 v10, v6, v5
 ds_read_b128 a[164:167], v2 offset:52224
 v_mfma_f32_16x16x32_bf16 v[248:251], a[200:203], a[160:163], v[248:251]
 v_accvgpr_read_b32 v5, a27
 ds_read_b128 a[160:163], v2 offset:51200
 v_mfma_f32_16x16x32_bf16 v[244:247], a[200:203], a[152:155], v[244:247]
 v_lshlrev_b32 v6, 16, v5
 v_and_b32 v5, s26, v5
 ds_read_b128 a[152:155], v2 offset:47104
 v_mfma_f32_16x16x32_bf16 v[244:247], a[204:207], a[156:159], v[244:247]
 v_mul_f32 v6, v6, v74
 ds_read_b128 a[156:159], v2 offset:48128
 v_mfma_f32_16x16x32_bf16 v[240:243], a[204:207], a[148:151], v[240:243]
 v_mul_f32 v5, v5, v75
 ds_read_b128 a[148:151], v2 offset:44032
 v_mfma_f32_16x16x32_bf16 v[240:243], a[200:203], a[144:147], v[240:243]
 v_cvt_pk_bf16_f32 v11, v6, v5
 ds_read_b128 a[144:147], v2 offset:43008
 v_mfma_f32_16x16x32_bf16 v[236:239], a[200:203], a[136:139], v[236:239]
 ds_write_b128 v3, v[8:11] offset:24576
 s_add_u32 s68, s29, 12288
 ds_read_b128 a[136:139], v2 offset:38912
 v_mfma_f32_16x16x32_bf16 v[236:239], a[204:207], a[140:143], v[236:239]
 buffer_store_dwordx4 v[8:11], v3, s[32:35], s68 offen sc1
 ds_read_b128 a[140:143], v2 offset:39936
 v_mfma_f32_16x16x32_bf16 v[232:235], a[204:207], a[132:135], v[232:235]
 v_accvgpr_read_b32 v5, a56
 ds_read_b128 a[132:135], v2 offset:35840
 v_mfma_f32_16x16x32_bf16 v[232:235], a[200:203], a[128:131], v[232:235]
 v_lshlrev_b32 v6, 16, v5
 ds_read_b128 a[128:131], v2 offset:34816
 s_waitcnt vmcnt(13) lgkmcnt(9)
 v_mfma_f32_16x16x32_bf16 v[164:167], a[208:211], a[184:187], v[164:167]
 v_and_b32 v5, s26, v5
 v_mul_f32 v6, v6, v104
 v_mfma_f32_16x16x32_bf16 v[164:167], a[212:215], a[188:191], v[164:167]
 v_mul_f32 v5, v5, v105
 buffer_load_dwordx4 a[204:207], v0, s[12:15], s24 offen offset:3072
 v_mfma_f32_16x16x32_bf16 v[160:163], a[212:215], a[180:183], v[160:163]
 v_cvt_pk_bf16_f32 v12, v6, v5
 v_accvgpr_read_b32 v5, a57
 v_mfma_f32_16x16x32_bf16 v[160:163], a[208:211], a[176:179], v[160:163]
 v_lshlrev_b32 v6, 16, v5
 v_and_b32 v5, s26, v5
 buffer_load_dwordx4 a[200:203], v0, s[12:15], s24 offen offset:2048
 v_mfma_f32_16x16x32_bf16 v[156:159], a[208:211], a[168:171], v[156:159]
 v_mul_f32 v6, v6, v106
 s_add_u32 s24, s24, 4096
 v_mfma_f32_16x16x32_bf16 v[156:159], a[212:215], a[172:175], v[156:159]
 v_mul_f32 v5, v5, v107
 v_cvt_pk_bf16_f32 v13, v6, v5
 v_mfma_f32_16x16x32_bf16 v[152:155], a[212:215], a[164:167], v[152:155]
 v_accvgpr_read_b32 v5, a58
 v_accvgpr_read_b32 v7, a240
 v_lshlrev_b32 v6, 16, v5
 v_mfma_f32_16x16x32_bf16 v[152:155], a[208:211], a[160:163], v[152:155]
 v_and_b32 v5, s26, v5
 s_waitcnt lgkmcnt(0)
 v_mfma_f32_16x16x32_bf16 v[148:151], a[208:211], a[152:155], v[148:151]
 v_mul_f32 v6, v6, v7
 v_accvgpr_read_b32 v7, a241
 v_mfma_f32_16x16x32_bf16 v[148:151], a[212:215], a[156:159], v[148:151]
 v_mul_f32 v5, v5, v7
 v_cvt_pk_bf16_f32 v14, v6, v5
 v_mfma_f32_16x16x32_bf16 v[144:147], a[212:215], a[148:151], v[144:147]
 v_accvgpr_read_b32 v5, a59
 v_accvgpr_read_b32 v7, a242
 v_lshlrev_b32 v6, 16, v5
 v_mfma_f32_16x16x32_bf16 v[144:147], a[208:211], a[144:147], v[144:147]
 v_and_b32 v5, s26, v5
 v_mul_f32 v6, v6, v7
 v_mfma_f32_16x16x32_bf16 v[140:143], a[208:211], a[136:139], v[140:143]
 v_accvgpr_read_b32 v7, a243
 v_mul_f32 v5, v5, v7
 v_mfma_f32_16x16x32_bf16 v[140:143], a[212:215], a[140:143], v[140:143]
 v_cvt_pk_bf16_f32 v15, v6, v5
 ds_write_b128 v3, v[12:15] offset:25600
 buffer_store_dwordx4 v[12:15], v3, s[32:35], s68 offen offset:1024 sc1
 v_mfma_f32_16x16x32_bf16 v[136:139], a[212:215], a[132:135], v[136:139]
 v_accvgpr_read_b32 v5, a28
 buffer_load_dwordx4 a[212:215], v0, s[12:15], s24 offen offset:1024
 v_mfma_f32_16x16x32_bf16 v[136:139], a[208:211], a[128:131], v[136:139]
 v_lshlrev_b32 v6, 16, v5
 s_waitcnt vmcnt(14)
 v_mfma_f32_16x16x32_bf16 v[168:171], a[216:219], a[128:131], v[168:171]
 v_and_b32 v5, s26, v5
 v_mul_f32 v6, v6, v44
 v_mfma_f32_16x16x32_bf16 v[168:171], a[220:223], a[132:135], v[168:171]
 v_mul_f32 v5, v5, v45
 v_cvt_pk_bf16_f32 v8, v6, v5
 buffer_load_dwordx4 a[208:211], v0, s[12:15], s24 offen
 v_mfma_f32_16x16x32_bf16 v[172:175], a[220:223], a[140:143], v[172:175]
 v_accvgpr_read_b32 v5, a29
 v_lshlrev_b32 v6, 16, v5
 v_mfma_f32_16x16x32_bf16 v[172:175], a[216:219], a[136:139], v[172:175]
 v_and_b32 v5, s26, v5
 v_mul_f32 v6, v6, v46
 v_mfma_f32_16x16x32_bf16 v[176:179], a[216:219], a[144:147], v[176:179]
 v_mul_f32 v5, v5, v47
 v_cvt_pk_bf16_f32 v9, v6, v5
 v_accvgpr_read_b32 v5, a30
 v_mfma_f32_16x16x32_bf16 v[176:179], a[220:223], a[148:151], v[176:179]
 v_lshlrev_b32 v6, 16, v5
 v_and_b32 v5, s26, v5
 v_mfma_f32_16x16x32_bf16 v[180:183], a[220:223], a[156:159], v[180:183]
 v_mul_f32 v6, v6, v76
 v_mul_f32 v5, v5, v77
 v_mfma_f32_16x16x32_bf16 v[180:183], a[216:219], a[152:155], v[180:183]
 v_cvt_pk_bf16_f32 v10, v6, v5
 v_accvgpr_read_b32 v5, a31
 v_mfma_f32_16x16x32_bf16 v[184:187], a[216:219], a[160:163], v[184:187]
 v_lshlrev_b32 v6, 16, v5
 v_and_b32 v5, s26, v5
 v_mul_f32 v6, v6, v78
 v_mfma_f32_16x16x32_bf16 v[184:187], a[220:223], a[164:167], v[184:187]
 v_mul_f32 v5, v5, v79
 v_cvt_pk_bf16_f32 v11, v6, v5
 v_mfma_f32_16x16x32_bf16 v[188:191], a[220:223], a[172:175], v[188:191]
 ds_write_b128 v3, v[8:11] offset:28672
 buffer_store_dwordx4 v[8:11], v3, s[32:35], s68 offen offset:2048 sc1
 v_mfma_f32_16x16x32_bf16 v[188:191], a[216:219], a[168:171], v[188:191]
 v_accvgpr_read_b32 v5, a60
 v_lshlrev_b32 v6, 16, v5
 v_and_b32 v5, s26, v5
 v_mfma_f32_16x16x32_bf16 v[192:195], a[216:219], a[176:179], v[192:195]
 v_mul_f32 v6, v6, v108
 v_mul_f32 v5, v5, v109
 v_mfma_f32_16x16x32_bf16 v[192:195], a[220:223], a[180:183], v[192:195]
 v_cvt_pk_bf16_f32 v12, v6, v5
 v_accvgpr_read_b32 v5, a61
 v_mfma_f32_16x16x32_bf16 v[196:199], a[220:223], a[188:191], v[196:199]
 v_lshlrev_b32 v6, 16, v5
 buffer_load_dwordx4 a[220:223], v0, s[12:15], s24 offen offset:3072
 v_mfma_f32_16x16x32_bf16 v[196:199], a[216:219], a[184:187], v[196:199]
 v_and_b32 v5, s26, v5
 v_mul_f32 v6, v6, v110
 s_waitcnt vmcnt(14)
 v_mfma_f32_16x16x32_bf16 v[228:231], a[224:227], a[184:187], v[228:231]
 v_mul_f32 v5, v5, v111
 v_cvt_pk_bf16_f32 v13, v6, v5
 v_mfma_f32_16x16x32_bf16 v[228:231], a[228:231], a[188:191], v[228:231]
 v_accvgpr_read_b32 v5, a62
 buffer_load_dwordx4 a[216:219], v0, s[12:15], s24 offen offset:2048
 v_mfma_f32_16x16x32_bf16 v[224:227], a[228:231], a[180:183], v[224:227]
 v_accvgpr_read_b32 v7, a244
 v_lshlrev_b32 v6, 16, v5
 v_and_b32 v5, s26, v5
 v_mfma_f32_16x16x32_bf16 v[224:227], a[224:227], a[176:179], v[224:227]
 v_mul_f32 v6, v6, v7
 s_add_u32 s24, s24, 4096
 v_mfma_f32_16x16x32_bf16 v[220:223], a[224:227], a[168:171], v[220:223]
 v_accvgpr_read_b32 v7, a245
 v_mul_f32 v5, v5, v7
 v_mfma_f32_16x16x32_bf16 v[220:223], a[228:231], a[172:175], v[220:223]
 v_cvt_pk_bf16_f32 v14, v6, v5
 v_accvgpr_read_b32 v5, a63
 v_mfma_f32_16x16x32_bf16 v[216:219], a[228:231], a[164:167], v[216:219]
 v_accvgpr_read_b32 v7, a246
 v_lshlrev_b32 v6, 16, v5
 v_and_b32 v5, s26, v5
 v_mfma_f32_16x16x32_bf16 v[216:219], a[224:227], a[160:163], v[216:219]
 v_mul_f32 v6, v6, v7
 v_accvgpr_read_b32 v7, a247
 v_mfma_f32_16x16x32_bf16 v[212:215], a[224:227], a[152:155], v[212:215]
 v_mul_f32 v5, v5, v7
 v_cvt_pk_bf16_f32 v15, v6, v5
 v_mfma_f32_16x16x32_bf16 v[212:215], a[228:231], a[156:159], v[212:215]
 ds_write_b128 v3, v[12:15] offset:29696
 buffer_store_dwordx4 v[12:15], v3, s[32:35], s68 offen offset:3072 sc1
 v_mfma_f32_16x16x32_bf16 v[208:211], a[228:231], a[148:151], v[208:211]
 s_waitcnt lgkmcnt(0)
 s_barrier
 v_mfma_f32_16x16x32_bf16 v[208:211], a[224:227], a[144:147], v[208:211]
 v_mfma_f32_16x16x32_bf16 v[204:207], a[224:227], a[136:139], v[204:207]
 v_mfma_f32_16x16x32_bf16 v[204:207], a[228:231], a[140:143], v[204:207]
 v_mfma_f32_16x16x32_bf16 v[200:203], a[228:231], a[132:135], v[200:203]
 buffer_load_dwordx4 a[228:231], v0, s[12:15], s24 offen offset:1024
 v_mfma_f32_16x16x32_bf16 v[200:203], a[224:227], a[128:131], v[200:203]
 s_waitcnt vmcnt(14)
 v_mfma_f32_16x16x32_bf16 v[232:235], a[232:235], a[128:131], v[232:235]
 ds_read_b128 a[128:131], v1
 v_mfma_f32_16x16x32_bf16 v[232:235], a[236:239], a[132:135], v[232:235]
 buffer_load_dwordx4 a[224:227], v0, s[12:15], s24 offen
 ds_read_b128 a[132:135], v1 offset:1024
 v_mfma_f32_16x16x32_bf16 v[236:239], a[236:239], a[140:143], v[236:239]
 ds_read_b128 a[140:143], v1 offset:5120
 v_mfma_f32_16x16x32_bf16 v[236:239], a[232:235], a[136:139], v[236:239]
 ds_read_b128 a[136:139], v1 offset:4096
 v_mfma_f32_16x16x32_bf16 v[240:243], a[232:235], a[144:147], v[240:243]
 ds_read_b128 a[144:147], v1 offset:8192
 v_mfma_f32_16x16x32_bf16 v[240:243], a[236:239], a[148:151], v[240:243]
 ds_read_b128 a[148:151], v1 offset:9216
 v_mfma_f32_16x16x32_bf16 v[244:247], a[236:239], a[156:159], v[244:247]
 ds_read_b128 a[156:159], v1 offset:13312
 v_mfma_f32_16x16x32_bf16 v[244:247], a[232:235], a[152:155], v[244:247]
 ds_read_b128 a[152:155], v1 offset:12288
 v_mfma_f32_16x16x32_bf16 v[248:251], a[232:235], a[160:163], v[248:251]
 ds_read_b128 a[160:163], v1 offset:16384
 v_mfma_f32_16x16x32_bf16 v[248:251], a[236:239], a[164:167], v[248:251]
 ds_read_b128 a[164:167], v1 offset:17408
 v_mfma_f32_16x16x32_bf16 v[252:255], a[236:239], a[172:175], v[252:255]
 ds_read_b128 a[172:175], v1 offset:21504
 v_mfma_f32_16x16x32_bf16 v[252:255], a[232:235], a[168:171], v[252:255]
 ds_read_b128 a[168:171], v1 offset:20480
 v_mfma_f32_16x16x32_bf16 a[248:251], a[232:235], a[176:179], a[248:251]
 ds_read_b128 a[176:179], v1 offset:24576
 v_mfma_f32_16x16x32_bf16 a[248:251], a[236:239], a[180:183], a[248:251]
 ds_read_b128 a[180:183], v1 offset:25600
 v_mfma_f32_16x16x32_bf16 a[252:255], a[236:239], a[188:191], a[252:255]
 buffer_load_dwordx4 a[236:239], v0, s[12:15], s24 offen offset:3072
 ds_read_b128 a[188:191], v1 offset:29696
 v_mfma_f32_16x16x32_bf16 a[252:255], a[232:235], a[184:187], a[252:255]
 buffer_load_dwordx4 a[232:235], v0, s[12:15], s24 offen offset:2048
 s_add_u32 s24, s24, 4096
 ds_read_b128 a[184:187], v1 offset:28672
 s_waitcnt vmcnt(14) lgkmcnt(8)
 v_mfma_f32_16x16x32_bf16 v[16:19], a[192:195], a[128:131], v[16:19]
 v_accvgpr_read_b32 v5, a64
 v_lshlrev_b32 v6, 16, v5
 v_and_b32 v5, s26, v5
 v_mfma_f32_16x16x32_bf16 v[16:19], a[196:199], a[132:135], v[16:19]
 v_mul_f32 v6, v6, v136
 v_mul_f32 v5, v5, v137
 v_mfma_f32_16x16x32_bf16 v[20:23], a[196:199], a[140:143], v[20:23]
 v_cvt_pk_bf16_f32 v8, v6, v5
 v_accvgpr_read_b32 v5, a65
 v_mfma_f32_16x16x32_bf16 v[20:23], a[192:195], a[136:139], v[20:23]
 v_lshlrev_b32 v6, 16, v5
 v_and_b32 v5, s26, v5
 v_mfma_f32_16x16x32_bf16 v[24:27], a[192:195], a[144:147], v[24:27]
 v_mul_f32 v6, v6, v138
 v_mul_f32 v5, v5, v139
 v_mfma_f32_16x16x32_bf16 v[24:27], a[196:199], a[148:151], v[24:27]
 v_cvt_pk_bf16_f32 v9, v6, v5
 v_accvgpr_read_b32 v5, a66
 v_mfma_f32_16x16x32_bf16 v[28:31], a[196:199], a[156:159], v[28:31]
 v_lshlrev_b32 v6, 16, v5
 v_and_b32 v5, s26, v5
 v_mul_f32 v6, v6, v168
 v_mfma_f32_16x16x32_bf16 v[28:31], a[192:195], a[152:155], v[28:31]
 v_mul_f32 v5, v5, v169
 s_waitcnt lgkmcnt(0)
 v_mfma_f32_16x16x32_bf16 v[32:35], a[192:195], a[160:163], v[32:35]
 v_cvt_pk_bf16_f32 v10, v6, v5
 v_accvgpr_read_b32 v5, a67
 v_mfma_f32_16x16x32_bf16 v[32:35], a[196:199], a[164:167], v[32:35]
 v_lshlrev_b32 v6, 16, v5
 v_and_b32 v5, s26, v5
 v_mfma_f32_16x16x32_bf16 v[36:39], a[196:199], a[172:175], v[36:39]
 v_mul_f32 v6, v6, v170
 v_mul_f32 v5, v5, v171
 v_mfma_f32_16x16x32_bf16 v[36:39], a[192:195], a[168:171], v[36:39]
 v_cvt_pk_bf16_f32 v11, v6, v5
 ds_write_b128 v3, v[8:11] offset:2048
 v_mfma_f32_16x16x32_bf16 v[40:43], a[192:195], a[176:179], v[40:43]
 s_add_u32 s68, s29, 16384
 buffer_store_dwordx4 v[8:11], v3, s[32:35], s68 offen sc1
 v_accvgpr_read_b32 v5, a96
 v_mfma_f32_16x16x32_bf16 v[40:43], a[196:199], a[180:183], v[40:43]
 v_lshlrev_b32 v6, 16, v5
 v_and_b32 v5, s26, v5
 v_mfma_f32_16x16x32_bf16 v[44:47], a[196:199], a[188:191], v[44:47]
 v_mul_f32 v6, v6, v200
 buffer_load_dwordx4 a[196:199], v0, s[12:15], s24 offen offset:1024
 v_mfma_f32_16x16x32_bf16 v[44:47], a[192:195], a[184:187], v[44:47]
 v_mul_f32 v5, v5, v201
 s_waitcnt vmcnt(13)
 v_mfma_f32_16x16x32_bf16 v[76:79], a[200:203], a[184:187], v[76:79]
 v_cvt_pk_bf16_f32 v12, v6, v5
 v_accvgpr_read_b32 v5, a97
 v_mfma_f32_16x16x32_bf16 v[76:79], a[204:207], a[188:191], v[76:79]
 v_lshlrev_b32 v6, 16, v5
 buffer_load_dwordx4 a[192:195], v0, s[12:15], s24 offen
 v_mfma_f32_16x16x32_bf16 v[72:75], a[204:207], a[180:183], v[72:75]
 v_and_b32 v5, s26, v5
 v_mul_f32 v6, v6, v202
 v_mul_f32 v5, v5, v203
 v_mfma_f32_16x16x32_bf16 v[72:75], a[200:203], a[176:179], v[72:75]
 v_cvt_pk_bf16_f32 v13, v6, v5
 v_accvgpr_read_b32 v5, a98
 v_mfma_f32_16x16x32_bf16 v[68:71], a[200:203], a[168:171], v[68:71]
 v_lshlrev_b32 v6, 16, v5
 v_and_b32 v5, s26, v5
 v_mfma_f32_16x16x32_bf16 v[68:71], a[204:207], a[172:175], v[68:71]
 v_mul_f32 v6, v6, v232
 v_mul_f32 v5, v5, v233
 v_mfma_f32_16x16x32_bf16 v[64:67], a[204:207], a[164:167], v[64:67]
 v_cvt_pk_bf16_f32 v14, v6, v5
 v_accvgpr_read_b32 v5, a99
 v_mfma_f32_16x16x32_bf16 v[64:67], a[200:203], a[160:163], v[64:67]
 v_lshlrev_b32 v6, 16, v5
 v_and_b32 v5, s26, v5
 v_mfma_f32_16x16x32_bf16 v[60:63], a[200:203], a[152:155], v[60:63]
 v_mul_f32 v6, v6, v234
 v_mul_f32 v5, v5, v235
 v_cvt_pk_bf16_f32 v15, v6, v5
 v_mfma_f32_16x16x32_bf16 v[60:63], a[204:207], a[156:159], v[60:63]
 ds_write_b128 v3, v[12:15] offset:3072
 buffer_store_dwordx4 v[12:15], v3, s[32:35], s68 offen offset:1024 sc1
 v_mfma_f32_16x16x32_bf16 v[56:59], a[204:207], a[148:151], v[56:59]
 v_accvgpr_read_b32 v5, a68
 v_lshlrev_b32 v6, 16, v5
 v_mfma_f32_16x16x32_bf16 v[56:59], a[200:203], a[144:147], v[56:59]
 v_and_b32 v5, s26, v5
 v_mul_f32 v6, v6, v140
 v_mfma_f32_16x16x32_bf16 v[52:55], a[200:203], a[136:139], v[52:55]
 v_mul_f32 v5, v5, v141
 v_cvt_pk_bf16_f32 v8, v6, v5
 v_mfma_f32_16x16x32_bf16 v[52:55], a[204:207], a[140:143], v[52:55]
 v_accvgpr_read_b32 v5, a69
 v_lshlrev_b32 v6, 16, v5
 v_mfma_f32_16x16x32_bf16 v[48:51], a[204:207], a[132:135], v[48:51]
 v_and_b32 v5, s26, v5
 v_mul_f32 v6, v6, v142
 buffer_load_dwordx4 a[204:207], v0, s[12:15], s24 offen offset:3072
 v_mfma_f32_16x16x32_bf16 v[48:51], a[200:203], a[128:131], v[48:51]
 v_mul_f32 v5, v5, v143
 s_waitcnt vmcnt(13)
 v_mfma_f32_16x16x32_bf16 v[80:83], a[208:211], a[128:131], v[80:83]
 v_cvt_pk_bf16_f32 v9, v6, v5
 v_accvgpr_read_b32 v5, a70
 v_mfma_f32_16x16x32_bf16 v[80:83], a[212:215], a[132:135], v[80:83]
 v_lshlrev_b32 v6, 16, v5
 buffer_load_dwordx4 a[200:203], v0, s[12:15], s24 offen offset:2048
 v_mfma_f32_16x16x32_bf16 v[84:87], a[212:215], a[140:143], v[84:87]
 v_and_b32 v5, s26, v5
 v_mul_f32 v6, v6, v172
 v_mfma_f32_16x16x32_bf16 v[84:87], a[208:211], a[136:139], v[84:87]
 v_mul_f32 v5, v5, v173
 s_add_u32 s24, s24, 4096
 v_mfma_f32_16x16x32_bf16 v[88:91], a[208:211], a[144:147], v[88:91]
 v_cvt_pk_bf16_f32 v10, v6, v5
 v_accvgpr_read_b32 v5, a71
 v_lshlrev_b32 v6, 16, v5
 v_mfma_f32_16x16x32_bf16 v[88:91], a[212:215], a[148:151], v[88:91]
 v_and_b32 v5, s26, v5
 v_mul_f32 v6, v6, v174
 v_mfma_f32_16x16x32_bf16 v[92:95], a[212:215], a[156:159], v[92:95]
 v_mul_f32 v5, v5, v175
 v_cvt_pk_bf16_f32 v11, v6, v5
 v_mfma_f32_16x16x32_bf16 v[92:95], a[208:211], a[152:155], v[92:95]
 ds_write_b128 v3, v[8:11] offset:6144
 buffer_store_dwordx4 v[8:11], v3, s[32:35], s68 offen offset:2048 sc1
 v_mfma_f32_16x16x32_bf16 v[96:99], a[208:211], a[160:163], v[96:99]
 v_accvgpr_read_b32 v5, a100
 v_lshlrev_b32 v6, 16, v5
 v_mfma_f32_16x16x32_bf16 v[96:99], a[212:215], a[164:167], v[96:99]
 v_and_b32 v5, s26, v5
 v_mul_f32 v6, v6, v204
 v_mfma_f32_16x16x32_bf16 v[100:103], a[212:215], a[172:175], v[100:103]
 v_mul_f32 v5, v5, v205
 v_cvt_pk_bf16_f32 v12, v6, v5
 v_accvgpr_read_b32 v5, a101
 v_mfma_f32_16x16x32_bf16 v[100:103], a[208:211], a[168:171], v[100:103]
 v_lshlrev_b32 v6, 16, v5
 v_and_b32 v5, s26, v5
 v_mfma_f32_16x16x32_bf16 v[104:107], a[208:211], a[176:179], v[104:107]
 v_mul_f32 v6, v6, v206
 v_mul_f32 v5, v5, v207
 v_mfma_f32_16x16x32_bf16 v[104:107], a[212:215], a[180:183], v[104:107]
 v_cvt_pk_bf16_f32 v13, v6, v5
 v_accvgpr_read_b32 v5, a102
 v_mfma_f32_16x16x32_bf16 v[108:111], a[212:215], a[188:191], v[108:111]
 v_lshlrev_b32 v6, 16, v5
 buffer_load_dwordx4 a[212:215], v0, s[12:15], s24 offen offset:1024
 v_mfma_f32_16x16x32_bf16 v[108:111], a[208:211], a[184:187], v[108:111]
 v_and_b32 v5, s26, v5
 s_waitcnt vmcnt(13)
 v_mfma_f32_16x16x32_bf16 a[244:247], a[216:219], a[184:187], a[244:247]
 v_mul_f32 v6, v6, v236
 v_mul_f32 v5, v5, v237
 ds_read_b128 a[184:187], v1 offset:61440
 v_mfma_f32_16x16x32_bf16 a[244:247], a[220:223], a[188:191], a[244:247]
 buffer_load_dwordx4 a[208:211], v0, s[12:15], s24 offen
 ds_read_b128 a[188:191], v1 offset:62464
 v_mfma_f32_16x16x32_bf16 a[240:243], a[220:223], a[180:183], a[240:243]
 v_cvt_pk_bf16_f32 v14, v6, v5
 ds_read_b128 a[180:183], v1 offset:58368
 v_mfma_f32_16x16x32_bf16 a[240:243], a[216:219], a[176:179], a[240:243]
 v_accvgpr_read_b32 v5, a103
 ds_read_b128 a[176:179], v1 offset:57344
 v_mfma_f32_16x16x32_bf16 v[132:135], a[216:219], a[168:171], v[132:135]
 v_lshlrev_b32 v6, 16, v5
 ds_read_b128 a[168:171], v1 offset:53248
 v_mfma_f32_16x16x32_bf16 v[132:135], a[220:223], a[172:175], v[132:135]
 v_and_b32 v5, s26, v5
 ds_read_b128 a[172:175], v1 offset:54272
 v_mfma_f32_16x16x32_bf16 v[128:131], a[220:223], a[164:167], v[128:131]
 v_mul_f32 v6, v6, v238
 v_mul_f32 v5, v5, v239
 ds_read_b128 a[164:167], v1 offset:50176
 v_mfma_f32_16x16x32_bf16 v[128:131], a[216:219], a[160:163], v[128:131]
 v_cvt_pk_bf16_f32 v15, v6, v5
 ds_read_b128 a[160:163], v1 offset:49152
 v_mfma_f32_16x16x32_bf16 v[124:127], a[216:219], a[152:155], v[124:127]
 ds_write_b128 v3, v[12:15] offset:7168
 ds_read_b128 a[152:155], v1 offset:45056
 v_mfma_f32_16x16x32_bf16 v[124:127], a[220:223], a[156:159], v[124:127]
 buffer_store_dwordx4 v[12:15], v3, s[32:35], s68 offen offset:3072 sc1
 ds_read_b128 a[156:159], v1 offset:46080
 v_mfma_f32_16x16x32_bf16 v[120:123], a[220:223], a[148:151], v[120:123]
 v_accvgpr_read_b32 v5, a72
 ds_read_b128 a[148:151], v1 offset:41984
 v_mfma_f32_16x16x32_bf16 v[120:123], a[216:219], a[144:147], v[120:123]
 v_lshlrev_b32 v6, 16, v5
 ds_read_b128 a[144:147], v1 offset:40960
 v_mfma_f32_16x16x32_bf16 v[116:119], a[216:219], a[136:139], v[116:119]
 v_and_b32 v5, s26, v5
 v_mul_f32 v6, v6, v144
 ds_read_b128 a[136:139], v1 offset:36864
 v_mfma_f32_16x16x32_bf16 v[116:119], a[220:223], a[140:143], v[116:119]
 v_mul_f32 v5, v5, v145
 ds_read_b128 a[140:143], v1 offset:37888
 v_mfma_f32_16x16x32_bf16 v[112:115], a[220:223], a[132:135], v[112:115]
 v_cvt_pk_bf16_f32 v8, v6, v5
 ds_read_b128 a[132:135], v1 offset:33792
 v_mfma_f32_16x16x32_bf16 v[112:115], a[216:219], a[128:131], v[112:115]
 ds_read_b128 a[128:131], v1 offset:32768
 s_waitcnt vmcnt(12) lgkmcnt(9)
 v_mfma_f32_16x16x32_bf16 v[44:47], a[224:227], a[184:187], v[44:47]
 v_accvgpr_read_b32 v5, a73
 v_lshlrev_b32 v6, 16, v5
 v_mfma_f32_16x16x32_bf16 v[44:47], a[228:231], a[188:191], v[44:47]
 v_and_b32 v5, s26, v5
 buffer_load_dwordx4 a[220:223], v0, s[12:15], s24 offen offset:3072
 v_mfma_f32_16x16x32_bf16 v[40:43], a[228:231], a[180:183], v[40:43]
 v_mul_f32 v6, v6, v146
 v_mul_f32 v5, v5, v147
 v_cvt_pk_bf16_f32 v9, v6, v5
 v_mfma_f32_16x16x32_bf16 v[40:43], a[224:227], a[176:179], v[40:43]
 v_accvgpr_read_b32 v5, a74
 buffer_load_dwordx4 a[216:219], v0, s[12:15], s24 offen offset:2048
 v_mfma_f32_16x16x32_bf16 v[36:39], a[224:227], a[168:171], v[36:39]
 v_lshlrev_b32 v6, 16, v5
 s_add_u32 s24, s24, 4096
 v_mfma_f32_16x16x32_bf16 v[36:39], a[228:231], a[172:175], v[36:39]
 v_and_b32 v5, s26, v5
 v_mul_f32 v6, v6, v176
 v_mfma_f32_16x16x32_bf16 v[32:35], a[228:231], a[164:167], v[32:35]
 v_mul_f32 v5, v5, v177
 v_cvt_pk_bf16_f32 v10, v6, v5
 v_mfma_f32_16x16x32_bf16 v[32:35], a[224:227], a[160:163], v[32:35]
 v_accvgpr_read_b32 v5, a75
 s_waitcnt lgkmcnt(0)
 v_mfma_f32_16x16x32_bf16 v[28:31], a[224:227], a[152:155], v[28:31]
 v_lshlrev_b32 v6, 16, v5
 v_and_b32 v5, s26, v5
 v_mul_f32 v6, v6, v178
 v_mfma_f32_16x16x32_bf16 v[28:31], a[228:231], a[156:159], v[28:31]
 v_mul_f32 v5, v5, v179
 v_cvt_pk_bf16_f32 v11, v6, v5
 v_mfma_f32_16x16x32_bf16 v[24:27], a[228:231], a[148:151], v[24:27]
 ds_write_b128 v3, v[8:11] offset:10240
 s_add_u32 s68, s29, 20480
 v_mfma_f32_16x16x32_bf16 v[24:27], a[224:227], a[144:147], v[24:27]
 buffer_store_dwordx4 v[8:11], v3, s[32:35], s68 offen sc1
 v_accvgpr_read_b32 v5, a104
 v_mfma_f32_16x16x32_bf16 v[20:23], a[224:227], a[136:139], v[20:23]
 v_lshlrev_b32 v6, 16, v5
 v_and_b32 v5, s26, v5
 v_mfma_f32_16x16x32_bf16 v[20:23], a[228:231], a[140:143], v[20:23]
 v_mul_f32 v6, v6, v208
 v_mul_f32 v5, v5, v209
 v_mfma_f32_16x16x32_bf16 v[16:19], a[228:231], a[132:135], v[16:19]
 v_cvt_pk_bf16_f32 v12, v6, v5
 v_accvgpr_read_b32 v5, a105
 buffer_load_dwordx4 a[228:231], v0, s[12:15], s24 offen offset:1024
 v_mfma_f32_16x16x32_bf16 v[16:19], a[224:227], a[128:131], v[16:19]
 v_lshlrev_b32 v6, 16, v5
 s_waitcnt vmcnt(14)
 v_mfma_f32_16x16x32_bf16 v[48:51], a[232:235], a[128:131], v[48:51]
 v_and_b32 v5, s26, v5
 v_mul_f32 v6, v6, v210
 v_mfma_f32_16x16x32_bf16 v[48:51], a[236:239], a[132:135], v[48:51]
 v_mul_f32 v5, v5, v211
 buffer_load_dwordx4 a[224:227], v0, s[12:15], s24 offen
 v_mfma_f32_16x16x32_bf16 v[52:55], a[236:239], a[140:143], v[52:55]
 v_cvt_pk_bf16_f32 v13, v6, v5
 v_accvgpr_read_b32 v5, a106
 v_mfma_f32_16x16x32_bf16 v[52:55], a[232:235], a[136:139], v[52:55]
 v_lshlrev_b32 v6, 16, v5
 v_and_b32 v5, s26, v5
 v_mfma_f32_16x16x32_bf16 v[56:59], a[232:235], a[144:147], v[56:59]
 v_mul_f32 v6, v6, v240
 v_mul_f32 v5, v5, v241
 v_mfma_f32_16x16x32_bf16 v[56:59], a[236:239], a[148:151], v[56:59]
 v_cvt_pk_bf16_f32 v14, v6, v5
 v_accvgpr_read_b32 v5, a107
 v_lshlrev_b32 v6, 16, v5
 v_mfma_f32_16x16x32_bf16 v[60:63], a[236:239], a[156:159], v[60:63]
 v_and_b32 v5, s26, v5
 v_mul_f32 v6, v6, v242
 v_mfma_f32_16x16x32_bf16 v[60:63], a[232:235], a[152:155], v[60:63]
 v_mul_f32 v5, v5, v243
 v_cvt_pk_bf16_f32 v15, v6, v5
 v_mfma_f32_16x16x32_bf16 v[64:67], a[232:235], a[160:163], v[64:67]
 ds_write_b128 v3, v[12:15] offset:11264
 buffer_store_dwordx4 v[12:15], v3, s[32:35], s68 offen offset:1024 sc1
 v_mfma_f32_16x16x32_bf16 v[64:67], a[236:239], a[164:167], v[64:67]
 v_accvgpr_read_b32 v5, a76
 v_lshlrev_b32 v6, 16, v5
 v_mfma_f32_16x16x32_bf16 v[68:71], a[236:239], a[172:175], v[68:71]
 v_and_b32 v5, s26, v5
 v_mul_f32 v6, v6, v148
 v_mfma_f32_16x16x32_bf16 v[68:71], a[232:235], a[168:171], v[68:71]
 v_mul_f32 v5, v5, v149
 v_cvt_pk_bf16_f32 v8, v6, v5
 v_accvgpr_read_b32 v5, a77
 v_mfma_f32_16x16x32_bf16 v[72:75], a[232:235], a[176:179], v[72:75]
 v_lshlrev_b32 v6, 16, v5
 v_and_b32 v5, s26, v5
 v_mfma_f32_16x16x32_bf16 v[72:75], a[236:239], a[180:183], v[72:75]
 v_mul_f32 v6, v6, v150
 v_mul_f32 v5, v5, v151
 v_mfma_f32_16x16x32_bf16 v[76:79], a[236:239], a[188:191], v[76:79]
 v_cvt_pk_bf16_f32 v9, v6, v5
 buffer_load_dwordx4 a[236:239], v0, s[12:15], s24 offen offset:3072
 v_mfma_f32_16x16x32_bf16 v[76:79], a[232:235], a[184:187], v[76:79]
 v_accvgpr_read_b32 v5, a78
 s_waitcnt vmcnt(14)
 v_mfma_f32_16x16x32_bf16 v[108:111], a[192:195], a[184:187], v[108:111]
 v_lshlrev_b32 v6, 16, v5
 v_and_b32 v5, s26, v5
 v_mfma_f32_16x16x32_bf16 v[108:111], a[196:199], a[188:191], v[108:111]
 v_mul_f32 v6, v6, v180
 v_mul_f32 v5, v5, v181
 buffer_load_dwordx4 a[232:235], v0, s[12:15], s24 offen offset:2048
 v_mfma_f32_16x16x32_bf16 v[104:107], a[196:199], a[180:183], v[104:107]
 v_cvt_pk_bf16_f32 v10, v6, v5
 v_accvgpr_read_b32 v5, a79
 v_mfma_f32_16x16x32_bf16 v[104:107], a[192:195], a[176:179], v[104:107]
 v_lshlrev_b32 v6, 16, v5
 s_add_u32 s24, s24, 4096
 v_mfma_f32_16x16x32_bf16 v[100:103], a[192:195], a[168:171], v[100:103]
 v_and_b32 v5, s26, v5
 v_mul_f32 v6, v6, v182
 v_mfma_f32_16x16x32_bf16 v[100:103], a[196:199], a[172:175], v[100:103]
 v_mul_f32 v5, v5, v183
 v_cvt_pk_bf16_f32 v11, v6, v5
 v_mfma_f32_16x16x32_bf16 v[96:99], a[196:199], a[164:167], v[96:99]
 ds_write_b128 v3, v[8:11] offset:14336
 buffer_store_dwordx4 v[8:11], v3, s[32:35], s68 offen offset:2048 sc1
 v_mfma_f32_16x16x32_bf16 v[96:99], a[192:195], a[160:163], v[96:99]
 v_accvgpr_read_b32 v5, a108
 v_lshlrev_b32 v6, 16, v5
 v_and_b32 v5, s26, v5
 v_mfma_f32_16x16x32_bf16 v[92:95], a[192:195], a[152:155], v[92:95]
 v_mul_f32 v6, v6, v212
 v_mul_f32 v5, v5, v213
 v_mfma_f32_16x16x32_bf16 v[92:95], a[196:199], a[156:159], v[92:95]
 v_cvt_pk_bf16_f32 v12, v6, v5
 v_accvgpr_read_b32 v5, a109
 v_mfma_f32_16x16x32_bf16 v[88:91], a[196:199], a[148:151], v[88:91]
 v_lshlrev_b32 v6, 16, v5
 v_and_b32 v5, s26, v5
 v_mfma_f32_16x16x32_bf16 v[88:91], a[192:195], a[144:147], v[88:91]
 v_mul_f32 v6, v6, v214
 v_mul_f32 v5, v5, v215
 v_mfma_f32_16x16x32_bf16 v[84:87], a[192:195], a[136:139], v[84:87]
 v_cvt_pk_bf16_f32 v13, v6, v5
 v_accvgpr_read_b32 v5, a110
 v_mfma_f32_16x16x32_bf16 v[84:87], a[196:199], a[140:143], v[84:87]
 v_lshlrev_b32 v6, 16, v5
 v_and_b32 v5, s26, v5
 v_mul_f32 v6, v6, v244
 v_mfma_f32_16x16x32_bf16 v[80:83], a[196:199], a[132:135], v[80:83]
 v_mul_f32 v5, v5, v245
 buffer_load_dwordx4 a[196:199], v0, s[12:15], s24 offen offset:1024
 v_mfma_f32_16x16x32_bf16 v[80:83], a[192:195], a[128:131], v[80:83]
 v_cvt_pk_bf16_f32 v14, v6, v5
 s_waitcnt vmcnt(14)
 v_mfma_f32_16x16x32_bf16 v[112:115], a[200:203], a[128:131], v[112:115]
 v_accvgpr_read_b32 v5, a111
 ds_read_b128 a[128:131], v2
 v_mfma_f32_16x16x32_bf16 v[112:115], a[204:207], a[132:135], v[112:115]
 buffer_load_dwordx4 a[192:195], v0, s[12:15], s24 offen
 ds_read_b128 a[132:135], v2 offset:1024
 v_mfma_f32_16x16x32_bf16 v[116:119], a[204:207], a[140:143], v[116:119]
 v_lshlrev_b32 v6, 16, v5
 ds_read_b128 a[140:143], v2 offset:5120
 v_mfma_f32_16x16x32_bf16 v[116:119], a[200:203], a[136:139], v[116:119]
 v_and_b32 v5, s26, v5
 v_mul_f32 v6, v6, v246
 ds_read_b128 a[136:139], v2 offset:4096
 v_mfma_f32_16x16x32_bf16 v[120:123], a[200:203], a[144:147], v[120:123]
 v_mul_f32 v5, v5, v247
 ds_read_b128 a[144:147], v2 offset:8192
 v_mfma_f32_16x16x32_bf16 v[120:123], a[204:207], a[148:151], v[120:123]
 v_cvt_pk_bf16_f32 v15, v6, v5
 ds_read_b128 a[148:151], v2 offset:9216
 v_mfma_f32_16x16x32_bf16 v[124:127], a[204:207], a[156:159], v[124:127]
 ds_write_b128 v3, v[12:15] offset:15360
 ds_read_b128 a[156:159], v2 offset:13312
 v_mfma_f32_16x16x32_bf16 v[124:127], a[200:203], a[152:155], v[124:127]
 s_add_u32 s31, s31, 1
 ds_read_b128 a[152:155], v2 offset:12288
 v_mfma_f32_16x16x32_bf16 v[128:131], a[200:203], a[160:163], v[128:131]
 ds_read_b128 a[160:163], v2 offset:16384
 v_mfma_f32_16x16x32_bf16 v[128:131], a[204:207], a[164:167], v[128:131]
 v_mov_b32 v7, s31
 buffer_store_dword v7, v1, s[60:63], 0 offen sc1
 ds_read_b128 a[164:167], v2 offset:17408
 v_mfma_f32_16x16x32_bf16 v[132:135], a[204:207], a[172:175], v[132:135]
 buffer_store_dwordx4 v[12:15], v3, s[32:35], s68 offen offset:3072 sc1
 ds_read_b128 a[172:175], v2 offset:21504
 v_mfma_f32_16x16x32_bf16 v[132:135], a[200:203], a[168:171], v[132:135]
 v_accvgpr_read_b32 v5, a80
 ds_read_b128 a[168:171], v2 offset:20480
 v_mfma_f32_16x16x32_bf16 a[240:243], a[200:203], a[176:179], a[240:243]
 v_lshlrev_b32 v6, 16, v5
 ds_read_b128 a[176:179], v2 offset:24576
 v_mfma_f32_16x16x32_bf16 a[240:243], a[204:207], a[180:183], a[240:243]
 v_and_b32 v5, s26, v5
 ds_read_b128 a[180:183], v2 offset:25600
 v_mfma_f32_16x16x32_bf16 a[244:247], a[204:207], a[188:191], a[244:247]
 v_mul_f32 v6, v6, v152
 ds_read_b128 a[188:191], v2 offset:29696
 v_mfma_f32_16x16x32_bf16 a[244:247], a[200:203], a[184:187], a[244:247]
 v_mul_f32 v5, v5, v153
 ds_read_b128 a[184:187], v2 offset:28672
 s_waitcnt vmcnt(14) lgkmcnt(8)
 v_mfma_f32_16x16x32_bf16 v[16:19], a[208:211], a[128:131], v[16:19]
 v_cvt_pk_bf16_f32 v8, v6, v5
 v_accvgpr_read_b32 v5, a81
 v_mfma_f32_16x16x32_bf16 v[16:19], a[212:215], a[132:135], v[16:19]
 v_lshlrev_b32 v6, 16, v5
 buffer_load_dwordx4 a[204:207], v0, s[12:15], s24 offen offset:3072
 v_mfma_f32_16x16x32_bf16 v[20:23], a[212:215], a[140:143], v[20:23]
 v_and_b32 v5, s26, v5
 v_mul_f32 v6, v6, v154
 v_mfma_f32_16x16x32_bf16 v[20:23], a[208:211], a[136:139], v[20:23]
 v_mul_f32 v5, v5, v155
 buffer_load_dwordx4 a[200:203], v0, s[12:15], s24 offen offset:2048
 v_mfma_f32_16x16x32_bf16 v[24:27], a[208:211], a[144:147], v[24:27]
 v_cvt_pk_bf16_f32 v9, v6, v5
 s_add_u32 s24, s24, 4096
 v_mfma_f32_16x16x32_bf16 v[24:27], a[212:215], a[148:151], v[24:27]
 v_accvgpr_read_b32 v5, a82
 v_lshlrev_b32 v6, 16, v5
 v_and_b32 v5, s26, v5
 v_mfma_f32_16x16x32_bf16 v[28:31], a[212:215], a[156:159], v[28:31]
 v_mul_f32 v6, v6, v184
 v_mul_f32 v5, v5, v185
 v_mfma_f32_16x16x32_bf16 v[28:31], a[208:211], a[152:155], v[28:31]
 v_cvt_pk_bf16_f32 v10, v6, v5
 s_waitcnt lgkmcnt(0)
 v_mfma_f32_16x16x32_bf16 v[32:35], a[208:211], a[160:163], v[32:35]
 v_accvgpr_read_b32 v5, a83
 v_lshlrev_b32 v6, 16, v5
 v_mfma_f32_16x16x32_bf16 v[32:35], a[212:215], a[164:167], v[32:35]
 v_and_b32 v5, s26, v5
 v_mul_f32 v6, v6, v186
 v_mfma_f32_16x16x32_bf16 v[36:39], a[212:215], a[172:175], v[36:39]
 v_mul_f32 v5, v5, v187
 v_cvt_pk_bf16_f32 v11, v6, v5
 v_mfma_f32_16x16x32_bf16 v[36:39], a[208:211], a[168:171], v[36:39]
 ds_write_b128 v3, v[8:11] offset:18432
 s_add_u32 s68, s29, 24576
 buffer_store_dwordx4 v[8:11], v3, s[32:35], s68 offen sc1
 v_mfma_f32_16x16x32_bf16 v[40:43], a[208:211], a[176:179], v[40:43]
 v_accvgpr_read_b32 v5, a112
 v_lshlrev_b32 v6, 16, v5
 v_mfma_f32_16x16x32_bf16 v[40:43], a[212:215], a[180:183], v[40:43]
 v_and_b32 v5, s26, v5
 v_mul_f32 v6, v6, v216
 v_mfma_f32_16x16x32_bf16 v[44:47], a[212:215], a[188:191], v[44:47]
 v_mul_f32 v5, v5, v217
 buffer_load_dwordx4 a[212:215], v0, s[12:15], s24 offen offset:1024
 v_mfma_f32_16x16x32_bf16 v[44:47], a[208:211], a[184:187], v[44:47]
 v_cvt_pk_bf16_f32 v12, v6, v5
 s_waitcnt vmcnt(15)
 v_mfma_f32_16x16x32_bf16 v[76:79], a[216:219], a[184:187], v[76:79]
 v_accvgpr_read_b32 v5, a113
 v_lshlrev_b32 v6, 16, v5
 v_mfma_f32_16x16x32_bf16 v[76:79], a[220:223], a[188:191], v[76:79]
 v_and_b32 v5, s26, v5
 v_mul_f32 v6, v6, v218
 buffer_load_dwordx4 a[208:211], v0, s[12:15], s24 offen
 v_mfma_f32_16x16x32_bf16 v[72:75], a[220:223], a[180:183], v[72:75]
 v_mul_f32 v5, v5, v219
 v_cvt_pk_bf16_f32 v13, v6, v5
 v_mfma_f32_16x16x32_bf16 v[72:75], a[216:219], a[176:179], v[72:75]
 v_accvgpr_read_b32 v5, a114
 v_lshlrev_b32 v6, 16, v5
 v_mfma_f32_16x16x32_bf16 v[68:71], a[216:219], a[168:171], v[68:71]
 v_and_b32 v5, s26, v5
 v_mul_f32 v6, v6, v248
 v_mfma_f32_16x16x32_bf16 v[68:71], a[220:223], a[172:175], v[68:71]
 v_mul_f32 v5, v5, v249
 v_cvt_pk_bf16_f32 v14, v6, v5
 v_mfma_f32_16x16x32_bf16 v[64:67], a[220:223], a[164:167], v[64:67]
 v_accvgpr_read_b32 v5, a115
 v_lshlrev_b32 v6, 16, v5
 v_mfma_f32_16x16x32_bf16 v[64:67], a[216:219], a[160:163], v[64:67]
 v_and_b32 v5, s26, v5
 v_mul_f32 v6, v6, v250
 v_mul_f32 v5, v5, v251
 v_mfma_f32_16x16x32_bf16 v[60:63], a[216:219], a[152:155], v[60:63]
 v_cvt_pk_bf16_f32 v15, v6, v5
 ds_write_b128 v3, v[12:15] offset:19456
 v_mfma_f32_16x16x32_bf16 v[60:63], a[220:223], a[156:159], v[60:63]
 buffer_store_dwordx4 v[12:15], v3, s[32:35], s68 offen offset:1024 sc1
 v_accvgpr_read_b32 v5, a84
 v_mfma_f32_16x16x32_bf16 v[56:59], a[220:223], a[148:151], v[56:59]
 v_lshlrev_b32 v6, 16, v5
 v_and_b32 v5, s26, v5
 v_mfma_f32_16x16x32_bf16 v[56:59], a[216:219], a[144:147], v[56:59]
 v_mul_f32 v6, v6, v156
 v_mul_f32 v5, v5, v157
 v_mfma_f32_16x16x32_bf16 v[52:55], a[216:219], a[136:139], v[52:55]
 v_cvt_pk_bf16_f32 v8, v6, v5
 v_accvgpr_read_b32 v5, a85
 v_mfma_f32_16x16x32_bf16 v[52:55], a[220:223], a[140:143], v[52:55]
 v_lshlrev_b32 v6, 16, v5
 v_and_b32 v5, s26, v5
 v_mul_f32 v6, v6, v158
 v_mfma_f32_16x16x32_bf16 v[48:51], a[220:223], a[132:135], v[48:51]
 v_mul_f32 v5, v5, v159
 buffer_load_dwordx4 a[220:223], v0, s[12:15], s24 offen offset:3072
 v_mfma_f32_16x16x32_bf16 v[48:51], a[216:219], a[128:131], v[48:51]
 v_cvt_pk_bf16_f32 v9, v6, v5
 s_waitcnt vmcnt(15)
 v_mfma_f32_16x16x32_bf16 v[80:83], a[224:227], a[128:131], v[80:83]
 v_accvgpr_read_b32 v5, a86
 v_lshlrev_b32 v6, 16, v5
 v_mfma_f32_16x16x32_bf16 v[80:83], a[228:231], a[132:135], v[80:83]
 v_and_b32 v5, s26, v5
 buffer_load_dwordx4 a[216:219], v0, s[12:15], s24 offen offset:2048
 v_mfma_f32_16x16x32_bf16 v[84:87], a[228:231], a[140:143], v[84:87]
 v_mul_f32 v6, v6, v188
 v_mul_f32 v5, v5, v189
 v_mfma_f32_16x16x32_bf16 v[84:87], a[224:227], a[136:139], v[84:87]
 v_cvt_pk_bf16_f32 v10, v6, v5
 v_accvgpr_read_b32 v5, a87
 s_add_u32 s24, s24, 4096
 v_mfma_f32_16x16x32_bf16 v[88:91], a[224:227], a[144:147], v[88:91]
 v_lshlrev_b32 v6, 16, v5
 v_and_b32 v5, s26, v5
 v_mfma_f32_16x16x32_bf16 v[88:91], a[228:231], a[148:151], v[88:91]
 v_mul_f32 v6, v6, v190
 v_mul_f32 v5, v5, v191
 v_mfma_f32_16x16x32_bf16 v[92:95], a[228:231], a[156:159], v[92:95]
 v_cvt_pk_bf16_f32 v11, v6, v5
 ds_write_b128 v3, v[8:11] offset:22528
 v_mfma_f32_16x16x32_bf16 v[92:95], a[224:227], a[152:155], v[92:95]
 buffer_store_dwordx4 v[8:11], v3, s[32:35], s68 offen offset:2048 sc1
 v_accvgpr_read_b32 v5, a116
 v_mfma_f32_16x16x32_bf16 v[96:99], a[224:227], a[160:163], v[96:99]
 v_lshlrev_b32 v6, 16, v5
 v_and_b32 v5, s26, v5
 v_mfma_f32_16x16x32_bf16 v[96:99], a[228:231], a[164:167], v[96:99]
 v_mul_f32 v6, v6, v220
 v_mul_f32 v5, v5, v221
 v_mfma_f32_16x16x32_bf16 v[100:103], a[228:231], a[172:175], v[100:103]
 v_cvt_pk_bf16_f32 v12, v6, v5
 v_accvgpr_read_b32 v5, a117
 v_lshlrev_b32 v6, 16, v5
 v_mfma_f32_16x16x32_bf16 v[100:103], a[224:227], a[168:171], v[100:103]
 v_and_b32 v5, s26, v5
 v_mul_f32 v6, v6, v222
 v_mfma_f32_16x16x32_bf16 v[104:107], a[224:227], a[176:179], v[104:107]
 v_mul_f32 v5, v5, v223
 v_cvt_pk_bf16_f32 v13, v6, v5
 v_mfma_f32_16x16x32_bf16 v[104:107], a[228:231], a[180:183], v[104:107]
 v_accvgpr_read_b32 v5, a118
 v_lshlrev_b32 v6, 16, v5
 v_mfma_f32_16x16x32_bf16 v[108:111], a[228:231], a[188:191], v[108:111]
 v_and_b32 v5, s26, v5
 buffer_load_dwordx4 a[228:231], v0, s[12:15], s24 offen offset:1024
 v_mfma_f32_16x16x32_bf16 v[108:111], a[224:227], a[184:187], v[108:111]
 v_mul_f32 v6, v6, v252
 s_waitcnt vmcnt(15)
 v_mfma_f32_16x16x32_bf16 a[244:247], a[232:235], a[184:187], a[244:247]
 v_mul_f32 v5, v5, v253
 v_cvt_pk_bf16_f32 v14, v6, v5
 ds_read_b128 a[184:187], v2 offset:61440
 v_mfma_f32_16x16x32_bf16 a[244:247], a[236:239], a[188:191], a[244:247]
 buffer_load_dwordx4 a[224:227], v0, s[12:15], s24 offen
 ds_read_b128 a[188:191], v2 offset:62464
 v_mfma_f32_16x16x32_bf16 a[240:243], a[236:239], a[180:183], a[240:243]
 v_accvgpr_read_b32 v5, a119
 ds_read_b128 a[180:183], v2 offset:58368
 v_mfma_f32_16x16x32_bf16 a[240:243], a[232:235], a[176:179], a[240:243]
 v_lshlrev_b32 v6, 16, v5
 ds_read_b128 a[176:179], v2 offset:57344
 v_mfma_f32_16x16x32_bf16 v[132:135], a[232:235], a[168:171], v[132:135]
 v_and_b32 v5, s26, v5
 ds_read_b128 a[168:171], v2 offset:53248
 v_mfma_f32_16x16x32_bf16 v[132:135], a[236:239], a[172:175], v[132:135]
 v_mul_f32 v6, v6, v254
 ds_read_b128 a[172:175], v2 offset:54272
 v_mfma_f32_16x16x32_bf16 v[128:131], a[236:239], a[164:167], v[128:131]
 v_mul_f32 v5, v5, v255
 v_cvt_pk_bf16_f32 v15, v6, v5
 ds_read_b128 a[164:167], v2 offset:50176
 v_mfma_f32_16x16x32_bf16 v[128:131], a[232:235], a[160:163], v[128:131]
 ds_write_b128 v3, v[12:15] offset:23552
 ds_read_b128 a[160:163], v2 offset:49152
 v_mfma_f32_16x16x32_bf16 v[124:127], a[232:235], a[152:155], v[124:127]
 buffer_store_dwordx4 v[12:15], v3, s[32:35], s68 offen offset:3072 sc1
 ds_read_b128 a[152:155], v2 offset:45056
 v_mfma_f32_16x16x32_bf16 v[124:127], a[236:239], a[156:159], v[124:127]
 v_accvgpr_read_b32 v5, a88
 ds_read_b128 a[156:159], v2 offset:46080
 v_mfma_f32_16x16x32_bf16 v[120:123], a[236:239], a[148:151], v[120:123]
 v_lshlrev_b32 v6, 16, v5
 ds_read_b128 a[148:151], v2 offset:41984
 v_mfma_f32_16x16x32_bf16 v[120:123], a[232:235], a[144:147], v[120:123]
 v_and_b32 v5, s26, v5
 ds_read_b128 a[144:147], v2 offset:40960
 v_mfma_f32_16x16x32_bf16 v[116:119], a[232:235], a[136:139], v[116:119]
 v_mul_f32 v6, v6, v160
 v_mul_f32 v5, v5, v161
 ds_read_b128 a[136:139], v2 offset:36864
 v_mfma_f32_16x16x32_bf16 v[116:119], a[236:239], a[140:143], v[116:119]
 v_cvt_pk_bf16_f32 v8, v6, v5
 ds_read_b128 a[140:143], v2 offset:37888
 v_mfma_f32_16x16x32_bf16 v[112:115], a[236:239], a[132:135], v[112:115]
 v_accvgpr_read_b32 v5, a89
 ds_read_b128 a[132:135], v2 offset:33792
 v_mfma_f32_16x16x32_bf16 v[112:115], a[232:235], a[128:131], v[112:115]
 ds_read_b128 a[128:131], v2 offset:32768
 s_waitcnt vmcnt(14) lgkmcnt(8)
 v_mfma_f32_16x16x32_bf16 v[44:47], a[192:195], a[184:187], v[44:47]
 v_lshlrev_b32 v6, 16, v5
 v_and_b32 v5, s26, v5
 v_mfma_f32_16x16x32_bf16 v[44:47], a[196:199], a[188:191], v[44:47]
 v_mul_f32 v6, v6, v162
 buffer_load_dwordx4 a[236:239], v0, s[12:15], s24 offen offset:3072
 v_mfma_f32_16x16x32_bf16 v[40:43], a[196:199], a[180:183], v[40:43]
 v_mul_f32 v5, v5, v163
 v_cvt_pk_bf16_f32 v9, v6, v5
 v_accvgpr_read_b32 v5, a90
 v_mfma_f32_16x16x32_bf16 v[40:43], a[192:195], a[176:179], v[40:43]
 v_lshlrev_b32 v6, 16, v5
 buffer_load_dwordx4 a[232:235], v0, s[12:15], s24 offen offset:2048
 v_mfma_f32_16x16x32_bf16 v[36:39], a[192:195], a[168:171], v[36:39]
 v_and_b32 v5, s26, v5
 s_add_u32 s24, s24, 4096
 v_mfma_f32_16x16x32_bf16 v[36:39], a[196:199], a[172:175], v[36:39]
 v_mul_f32 v6, v6, v192
 v_mul_f32 v5, v5, v193
 v_mfma_f32_16x16x32_bf16 v[32:35], a[196:199], a[164:167], v[32:35]
 v_cvt_pk_bf16_f32 v10, v6, v5
 v_accvgpr_read_b32 v5, a91
 v_mfma_f32_16x16x32_bf16 v[32:35], a[192:195], a[160:163], v[32:35]
 v_lshlrev_b32 v6, 16, v5
 s_waitcnt lgkmcnt(0)
 v_mfma_f32_16x16x32_bf16 v[28:31], a[192:195], a[152:155], v[28:31]
 v_and_b32 v5, s26, v5
 v_mul_f32 v6, v6, v194
 v_mul_f32 v5, v5, v195
 v_mfma_f32_16x16x32_bf16 v[28:31], a[196:199], a[156:159], v[28:31]
 v_cvt_pk_bf16_f32 v11, v6, v5
 ds_write_b128 v3, v[8:11] offset:26624
 v_mfma_f32_16x16x32_bf16 v[24:27], a[196:199], a[148:151], v[24:27]
 s_add_u32 s68, s29, 28672
 buffer_store_dwordx4 v[8:11], v3, s[32:35], s68 offen sc1
 v_mfma_f32_16x16x32_bf16 v[24:27], a[192:195], a[144:147], v[24:27]
 v_accvgpr_read_b32 v5, a120
 v_lshlrev_b32 v6, 16, v5
 v_mfma_f32_16x16x32_bf16 v[20:23], a[192:195], a[136:139], v[20:23]
 v_and_b32 v5, s26, v5
 v_mul_f32 v6, v6, v224
 v_mfma_f32_16x16x32_bf16 v[20:23], a[196:199], a[140:143], v[20:23]
 v_mul_f32 v5, v5, v225
 v_cvt_pk_bf16_f32 v12, v6, v5
 v_mfma_f32_16x16x32_bf16 v[16:19], a[196:199], a[132:135], v[16:19]
 v_accvgpr_read_b32 v5, a121
 v_lshlrev_b32 v6, 16, v5
 buffer_load_dwordx4 a[196:199], v0, s[12:15], s24 offen offset:1024
 v_mfma_f32_16x16x32_bf16 v[16:19], a[192:195], a[128:131], v[16:19]
 v_and_b32 v5, s26, v5
 s_waitcnt vmcnt(14)
 v_mfma_f32_16x16x32_bf16 v[48:51], a[200:203], a[128:131], v[48:51]
 v_mul_f32 v6, v6, v226
 v_mul_f32 v5, v5, v227
 v_mfma_f32_16x16x32_bf16 v[48:51], a[204:207], a[132:135], v[48:51]
 v_cvt_pk_bf16_f32 v13, v6, v5
 buffer_load_dwordx4 a[192:195], v0, s[12:15], s24 offen
 v_mfma_f32_16x16x32_bf16 v[52:55], a[204:207], a[140:143], v[52:55]
 v_accvgpr_read_b32 v5, a122
 v_accvgpr_read_b32 v7, a248
 v_mfma_f32_16x16x32_bf16 v[52:55], a[200:203], a[136:139], v[52:55]
 v_lshlrev_b32 v6, 16, v5
 v_and_b32 v5, s26, v5
 v_mfma_f32_16x16x32_bf16 v[56:59], a[200:203], a[144:147], v[56:59]
 v_mul_f32 v6, v6, v7
 v_accvgpr_read_b32 v7, a249
 v_mul_f32 v5, v5, v7
 v_mfma_f32_16x16x32_bf16 v[56:59], a[204:207], a[148:151], v[56:59]
 v_cvt_pk_bf16_f32 v14, v6, v5
 v_accvgpr_read_b32 v5, a123
 v_mfma_f32_16x16x32_bf16 v[60:63], a[204:207], a[156:159], v[60:63]
 v_accvgpr_read_b32 v7, a250
 v_lshlrev_b32 v6, 16, v5
 v_mfma_f32_16x16x32_bf16 v[60:63], a[200:203], a[152:155], v[60:63]
 v_and_b32 v5, s26, v5
 v_mul_f32 v6, v6, v7
 v_mfma_f32_16x16x32_bf16 v[64:67], a[200:203], a[160:163], v[64:67]
 v_accvgpr_read_b32 v7, a251
 v_mul_f32 v5, v5, v7
 v_mfma_f32_16x16x32_bf16 v[64:67], a[204:207], a[164:167], v[64:67]
 v_cvt_pk_bf16_f32 v15, v6, v5
 ds_write_b128 v3, v[12:15] offset:27648
 v_mfma_f32_16x16x32_bf16 v[68:71], a[204:207], a[172:175], v[68:71]
 buffer_store_dwordx4 v[12:15], v3, s[32:35], s68 offen offset:1024 sc1
 v_accvgpr_read_b32 v5, a92
 v_lshlrev_b32 v6, 16, v5
 v_mfma_f32_16x16x32_bf16 v[68:71], a[200:203], a[168:171], v[68:71]
 v_and_b32 v5, s26, v5
 v_mul_f32 v6, v6, v164
 v_mfma_f32_16x16x32_bf16 v[72:75], a[200:203], a[176:179], v[72:75]
 v_mul_f32 v5, v5, v165
 v_cvt_pk_bf16_f32 v8, v6, v5
 v_mfma_f32_16x16x32_bf16 v[72:75], a[204:207], a[180:183], v[72:75]
 v_accvgpr_read_b32 v5, a93
 v_lshlrev_b32 v6, 16, v5
 v_mfma_f32_16x16x32_bf16 v[76:79], a[204:207], a[188:191], v[76:79]
 v_and_b32 v5, s26, v5
 buffer_load_dwordx4 a[204:207], v0, s[12:15], s24 offen offset:3072
 v_mfma_f32_16x16x32_bf16 v[76:79], a[200:203], a[184:187], v[76:79]
 v_mul_f32 v6, v6, v166
 s_waitcnt vmcnt(14)
 v_mfma_f32_16x16x32_bf16 v[108:111], a[208:211], a[184:187], v[108:111]
 v_mul_f32 v5, v5, v167
 v_cvt_pk_bf16_f32 v9, v6, v5
 v_accvgpr_read_b32 v5, a94
 v_mfma_f32_16x16x32_bf16 v[108:111], a[212:215], a[188:191], v[108:111]
 v_lshlrev_b32 v6, 16, v5
 buffer_load_dwordx4 a[200:203], v0, s[12:15], s24 offen offset:2048
 v_mfma_f32_16x16x32_bf16 v[104:107], a[212:215], a[180:183], v[104:107]
 v_and_b32 v5, s26, v5
 v_mul_f32 v6, v6, v196
 v_mfma_f32_16x16x32_bf16 v[104:107], a[208:211], a[176:179], v[104:107]
 v_mul_f32 v5, v5, v197
 s_add_u32 s24, s24, 4096
 v_mfma_f32_16x16x32_bf16 v[100:103], a[208:211], a[168:171], v[100:103]
 v_cvt_pk_bf16_f32 v10, v6, v5
 v_accvgpr_read_b32 v5, a95
 v_mfma_f32_16x16x32_bf16 v[100:103], a[212:215], a[172:175], v[100:103]
 v_lshlrev_b32 v6, 16, v5
 v_and_b32 v5, s26, v5
 v_mfma_f32_16x16x32_bf16 v[96:99], a[212:215], a[164:167], v[96:99]
 v_mul_f32 v6, v6, v198
 v_mul_f32 v5, v5, v199
 v_cvt_pk_bf16_f32 v11, v6, v5
 v_mfma_f32_16x16x32_bf16 v[96:99], a[208:211], a[160:163], v[96:99]
 ds_write_b128 v3, v[8:11] offset:30720
 buffer_store_dwordx4 v[8:11], v3, s[32:35], s68 offen offset:2048 sc1
 v_mfma_f32_16x16x32_bf16 v[92:95], a[208:211], a[152:155], v[92:95]
 v_accvgpr_read_b32 v5, a124
 v_lshlrev_b32 v6, 16, v5
 v_mfma_f32_16x16x32_bf16 v[92:95], a[212:215], a[156:159], v[92:95]
 v_and_b32 v5, s26, v5
 v_mul_f32 v6, v6, v228
 v_mfma_f32_16x16x32_bf16 v[88:91], a[212:215], a[148:151], v[88:91]
 v_mul_f32 v5, v5, v229
 v_cvt_pk_bf16_f32 v12, v6, v5
 v_mfma_f32_16x16x32_bf16 v[88:91], a[208:211], a[144:147], v[88:91]
 v_accvgpr_read_b32 v5, a125
 v_lshlrev_b32 v6, 16, v5
 v_mfma_f32_16x16x32_bf16 v[84:87], a[208:211], a[136:139], v[84:87]
 v_and_b32 v5, s26, v5
 v_mul_f32 v6, v6, v230
 v_mul_f32 v5, v5, v231
 v_mfma_f32_16x16x32_bf16 v[84:87], a[212:215], a[140:143], v[84:87]
 v_cvt_pk_bf16_f32 v13, v6, v5
 v_accvgpr_read_b32 v5, a126
 v_mfma_f32_16x16x32_bf16 v[80:83], a[212:215], a[132:135], v[80:83]
 v_accvgpr_read_b32 v7, a252
 buffer_load_dwordx4 a[212:215], v0, s[12:15], s24 offen offset:1024
 v_mfma_f32_16x16x32_bf16 v[80:83], a[208:211], a[128:131], v[80:83]
 v_lshlrev_b32 v6, 16, v5
 s_waitcnt vmcnt(14)
 v_mfma_f32_16x16x32_bf16 v[112:115], a[216:219], a[128:131], v[112:115]
 v_and_b32 v5, s26, v5
 ds_read_b128 a[128:131], v1
 v_mfma_f32_16x16x32_bf16 v[112:115], a[220:223], a[132:135], v[112:115]
 buffer_load_dwordx4 a[208:211], v0, s[12:15], s24 offen
 ds_read_b128 a[132:135], v1 offset:1024
 v_mfma_f32_16x16x32_bf16 v[116:119], a[220:223], a[140:143], v[116:119]
 v_mul_f32 v6, v6, v7
 v_accvgpr_read_b32 v7, a253
 ds_read_b128 a[140:143], v1 offset:5120
 v_mfma_f32_16x16x32_bf16 v[116:119], a[216:219], a[136:139], v[116:119]
 v_mul_f32 v5, v5, v7
 ds_read_b128 a[136:139], v1 offset:4096
 v_mfma_f32_16x16x32_bf16 v[120:123], a[216:219], a[144:147], v[120:123]
 v_cvt_pk_bf16_f32 v14, v6, v5
 ds_read_b128 a[144:147], v1 offset:8192
 v_mfma_f32_16x16x32_bf16 v[120:123], a[220:223], a[148:151], v[120:123]
 v_accvgpr_read_b32 v5, a127
 ds_read_b128 a[148:151], v1 offset:9216
 v_mfma_f32_16x16x32_bf16 v[124:127], a[220:223], a[156:159], v[124:127]
 v_accvgpr_read_b32 v7, a254
 ds_read_b128 a[156:159], v1 offset:13312
 v_mfma_f32_16x16x32_bf16 v[124:127], a[216:219], a[152:155], v[124:127]
 v_lshlrev_b32 v6, 16, v5
 ds_read_b128 a[152:155], v1 offset:12288
 v_mfma_f32_16x16x32_bf16 v[128:131], a[216:219], a[160:163], v[128:131]
 v_and_b32 v5, s26, v5
 v_mul_f32 v6, v6, v7
 ds_read_b128 a[160:163], v1 offset:16384
 v_mfma_f32_16x16x32_bf16 v[128:131], a[220:223], a[164:167], v[128:131]
 v_accvgpr_read_b32 v7, a255
 ds_read_b128 a[164:167], v1 offset:17408
 v_mfma_f32_16x16x32_bf16 v[132:135], a[220:223], a[172:175], v[132:135]
 v_mul_f32 v5, v5, v7
 ds_read_b128 a[172:175], v1 offset:21504
 v_mfma_f32_16x16x32_bf16 v[132:135], a[216:219], a[168:171], v[132:135]
 v_cvt_pk_bf16_f32 v15, v6, v5
 ds_read_b128 a[168:171], v1 offset:20480
 v_mfma_f32_16x16x32_bf16 a[240:243], a[216:219], a[176:179], a[240:243]
 ds_write_b128 v3, v[12:15] offset:31744
 ds_read_b128 a[176:179], v1 offset:24576
 v_mfma_f32_16x16x32_bf16 a[240:243], a[220:223], a[180:183], a[240:243]
 buffer_store_dwordx4 v[12:15], v3, s[32:35], s68 offen offset:3072 sc1
 ds_read_b128 a[180:183], v1 offset:25600
 v_mfma_f32_16x16x32_bf16 a[244:247], a[220:223], a[188:191], a[244:247]
 buffer_load_dwordx4 a[220:223], v0, s[12:15], s24 offen offset:3072
 ds_read_b128 a[188:191], v1 offset:29696
 v_mfma_f32_16x16x32_bf16 a[244:247], a[216:219], a[184:187], a[244:247]
 buffer_load_dwordx4 a[216:219], v0, s[12:15], s24 offen offset:2048
 s_add_u32 s24, s24, 4096
 ds_read_b128 a[184:187], v1 offset:28672
 s_waitcnt vmcnt(15) lgkmcnt(9)
Ls1b:
 v_mfma_f32_16x16x32_bf16 v[136:139], a[224:227], a[128:131], v[136:139]
 v_lshrrev_b32 v4, 8, v1
 v_lshl_add_u32 v4, v4, 5, s51
 v_mfma_f32_16x16x32_bf16 v[136:139], a[228:231], a[132:135], v[136:139]
 ds_read_b128 v[8:11], v4
 v_mfma_f32_16x16x32_bf16 v[140:143], a[228:231], a[140:143], v[140:143]
 s_waitcnt lgkmcnt(0)
 v_mfma_f32_16x16x32_bf16 v[140:143], a[224:227], a[136:139], v[140:143]
 v_add_f32 v16, v16, v8
 v_mfma_f32_16x16x32_bf16 v[144:147], a[224:227], a[144:147], v[144:147]
 ds_read_b128 v[12:15], v4 offset:16
 v_mfma_f32_16x16x32_bf16 v[144:147], a[228:231], a[148:151], v[144:147]
 v_add_f32 v17, v17, v9
 v_mfma_f32_16x16x32_bf16 v[148:151], a[228:231], a[156:159], v[148:151]
 v_add_f32 v18, v18, v10
 v_mfma_f32_16x16x32_bf16 v[148:151], a[224:227], a[152:155], v[148:151]
 v_mfma_f32_16x16x32_bf16 v[152:155], a[224:227], a[160:163], v[152:155]
 v_add_f32 v19, v19, v11
 v_mfma_f32_16x16x32_bf16 v[152:155], a[228:231], a[164:167], v[152:155]
 v_add_f32 v20, v20, v8
 v_mfma_f32_16x16x32_bf16 v[156:159], a[228:231], a[172:175], v[156:159]
 v_add_f32 v21, v21, v9
 v_mfma_f32_16x16x32_bf16 v[156:159], a[224:227], a[168:171], v[156:159]
 v_add_f32 v22, v22, v10
 v_mfma_f32_16x16x32_bf16 v[160:163], a[224:227], a[176:179], v[160:163]
 v_add_f32 v23, v23, v11
 v_mfma_f32_16x16x32_bf16 v[160:163], a[228:231], a[180:183], v[160:163]
 v_add_f32 v24, v24, v8
 v_mfma_f32_16x16x32_bf16 v[164:167], a[228:231], a[188:191], v[164:167]
 v_add_f32 v25, v25, v9
 buffer_load_dwordx4 a[228:231], v0, s[12:15], s24 offen offset:1024
 v_mfma_f32_16x16x32_bf16 v[164:167], a[224:227], a[184:187], v[164:167]
 s_waitcnt vmcnt(13)
 v_mfma_f32_16x16x32_bf16 v[196:199], a[232:235], a[184:187], v[196:199]
 v_add_f32 v26, v26, v10
 v_mfma_f32_16x16x32_bf16 v[196:199], a[236:239], a[188:191], v[196:199]
 buffer_load_dwordx4 a[224:227], v0, s[12:15], s24 offen
 v_mfma_f32_16x16x32_bf16 v[192:195], a[236:239], a[180:183], v[192:195]
 v_add_f32 v27, v27, v11
 v_mfma_f32_16x16x32_bf16 v[192:195], a[232:235], a[176:179], v[192:195]
 v_add_f32 v28, v28, v8
 v_mfma_f32_16x16x32_bf16 v[188:191], a[232:235], a[168:171], v[188:191]
 v_add_f32 v29, v29, v9
 v_mfma_f32_16x16x32_bf16 v[188:191], a[236:239], a[172:175], v[188:191]
 v_add_f32 v30, v30, v10
 v_mfma_f32_16x16x32_bf16 v[184:187], a[236:239], a[164:167], v[184:187]
 v_add_f32 v31, v31, v11
 v_mfma_f32_16x16x32_bf16 v[184:187], a[232:235], a[160:163], v[184:187]
 v_add_f32 v32, v32, v8
 v_mfma_f32_16x16x32_bf16 v[180:183], a[232:235], a[152:155], v[180:183]
 v_add_f32 v33, v33, v9
 v_mfma_f32_16x16x32_bf16 v[180:183], a[236:239], a[156:159], v[180:183]
 v_add_f32 v34, v34, v10
 v_mfma_f32_16x16x32_bf16 v[176:179], a[236:239], a[148:151], v[176:179]
 v_add_f32 v35, v35, v11
 v_mfma_f32_16x16x32_bf16 v[176:179], a[232:235], a[144:147], v[176:179]
 v_add_f32 v36, v36, v8
 v_mfma_f32_16x16x32_bf16 v[172:175], a[232:235], a[136:139], v[172:175]
 v_add_f32 v37, v37, v9
 v_add_f32 v38, v38, v10
 v_mfma_f32_16x16x32_bf16 v[172:175], a[236:239], a[140:143], v[172:175]
 v_add_f32 v39, v39, v11
 v_mfma_f32_16x16x32_bf16 v[168:171], a[236:239], a[132:135], v[168:171]
 buffer_load_dwordx4 a[236:239], v0, s[12:15], s24 offen offset:3072
 v_mfma_f32_16x16x32_bf16 v[168:171], a[232:235], a[128:131], v[168:171]
 s_waitcnt vmcnt(12)
 v_mfma_f32_16x16x32_bf16 v[200:203], a[192:195], a[128:131], v[200:203]
 v_add_f32 v40, v40, v8
 v_mfma_f32_16x16x32_bf16 v[200:203], a[196:199], a[132:135], v[200:203]
 buffer_load_dwordx4 a[232:235], v0, s[12:15], s24 offen offset:2048
 v_mfma_f32_16x16x32_bf16 v[204:207], a[196:199], a[140:143], v[204:207]
 v_add_f32 v41, v41, v9
 v_mfma_f32_16x16x32_bf16 v[204:207], a[192:195], a[136:139], v[204:207]
 s_add_u32 s24, s24, 4096
 v_mfma_f32_16x16x32_bf16 v[208:211], a[192:195], a[144:147], v[208:211]
 v_add_f32 v42, v42, v10
 v_mfma_f32_16x16x32_bf16 v[208:211], a[196:199], a[148:151], v[208:211]
 v_add_f32 v43, v43, v11
 v_mfma_f32_16x16x32_bf16 v[212:215], a[196:199], a[156:159], v[212:215]
 v_add_f32 v44, v44, v8
 v_mfma_f32_16x16x32_bf16 v[212:215], a[192:195], a[152:155], v[212:215]
 v_add_f32 v45, v45, v9
 v_mfma_f32_16x16x32_bf16 v[216:219], a[192:195], a[160:163], v[216:219]
 v_add_f32 v46, v46, v10
 v_mfma_f32_16x16x32_bf16 v[216:219], a[196:199], a[164:167], v[216:219]
 v_add_f32 v47, v47, v11
 v_mfma_f32_16x16x32_bf16 v[220:223], a[196:199], a[172:175], v[220:223]
 s_waitcnt lgkmcnt(0)
 v_add_f32 v48, v48, v12
 v_mfma_f32_16x16x32_bf16 v[220:223], a[192:195], a[168:171], v[220:223]
 ds_read_b128 v[8:11], v4 offset:128
 v_mfma_f32_16x16x32_bf16 v[224:227], a[192:195], a[176:179], v[224:227]
 v_add_f32 v49, v49, v13
 v_mfma_f32_16x16x32_bf16 v[224:227], a[196:199], a[180:183], v[224:227]
 v_add_f32 v50, v50, v14
 v_mfma_f32_16x16x32_bf16 v[228:231], a[196:199], a[188:191], v[228:231]
 buffer_load_dwordx4 a[196:199], v0, s[12:15], s24 offen offset:1024
 v_mfma_f32_16x16x32_bf16 v[228:231], a[192:195], a[184:187], v[228:231]
 s_waitcnt vmcnt(11)
 v_mfma_f32_16x16x32_bf16 a[252:255], a[200:203], a[184:187], a[252:255]
 ds_read_b128 a[184:187], v1 offset:61440
 v_mfma_f32_16x16x32_bf16 a[252:255], a[204:207], a[188:191], a[252:255]
 buffer_load_dwordx4 a[192:195], v0, s[12:15], s24 offen
 ds_read_b128 a[188:191], v1 offset:62464
 v_mfma_f32_16x16x32_bf16 a[248:251], a[204:207], a[180:183], a[248:251]
 ds_read_b128 a[180:183], v1 offset:58368
 v_mfma_f32_16x16x32_bf16 a[248:251], a[200:203], a[176:179], a[248:251]
 ds_read_b128 a[176:179], v1 offset:57344
 v_mfma_f32_16x16x32_bf16 v[252:255], a[200:203], a[168:171], v[252:255]
 ds_read_b128 a[168:171], v1 offset:53248
 v_mfma_f32_16x16x32_bf16 v[252:255], a[204:207], a[172:175], v[252:255]
 ds_read_b128 a[172:175], v1 offset:54272
 v_mfma_f32_16x16x32_bf16 v[248:251], a[204:207], a[164:167], v[248:251]
 ds_read_b128 a[164:167], v1 offset:50176
 v_mfma_f32_16x16x32_bf16 v[248:251], a[200:203], a[160:163], v[248:251]
 ds_read_b128 a[160:163], v1 offset:49152
 v_mfma_f32_16x16x32_bf16 v[244:247], a[200:203], a[152:155], v[244:247]
 ds_read_b128 a[152:155], v1 offset:45056
 v_mfma_f32_16x16x32_bf16 v[244:247], a[204:207], a[156:159], v[244:247]
 ds_read_b128 a[156:159], v1 offset:46080
 v_mfma_f32_16x16x32_bf16 v[240:243], a[204:207], a[148:151], v[240:243]
 v_add_f32 v51, v51, v15
 ds_read_b128 a[148:151], v1 offset:41984
 v_mfma_f32_16x16x32_bf16 v[240:243], a[200:203], a[144:147], v[240:243]
 ds_read_b128 a[144:147], v1 offset:40960
 v_mfma_f32_16x16x32_bf16 v[236:239], a[200:203], a[136:139], v[236:239]
 ds_read_b128 a[136:139], v1 offset:36864
 v_mfma_f32_16x16x32_bf16 v[236:239], a[204:207], a[140:143], v[236:239]
 ds_read_b128 a[140:143], v1 offset:37888
 v_mfma_f32_16x16x32_bf16 v[232:235], a[204:207], a[132:135], v[232:235]
 ds_read_b128 a[132:135], v1 offset:33792
 v_mfma_f32_16x16x32_bf16 v[232:235], a[200:203], a[128:131], v[232:235]
 ds_read_b128 a[128:131], v1 offset:32768
 s_waitcnt vmcnt(9) lgkmcnt(8)
 v_mfma_f32_16x16x32_bf16 v[164:167], a[208:211], a[184:187], v[164:167]
 v_add_f32 v52, v52, v12
 v_mfma_f32_16x16x32_bf16 v[164:167], a[212:215], a[188:191], v[164:167]
 buffer_load_dwordx4 a[204:207], v0, s[12:15], s24 offen offset:3072
 v_mfma_f32_16x16x32_bf16 v[160:163], a[212:215], a[180:183], v[160:163]
 v_add_f32 v53, v53, v13
 v_mfma_f32_16x16x32_bf16 v[160:163], a[208:211], a[176:179], v[160:163]
 buffer_load_dwordx4 a[200:203], v0, s[12:15], s24 offen offset:2048
 v_mfma_f32_16x16x32_bf16 v[156:159], a[208:211], a[168:171], v[156:159]
 s_add_u32 s24, s24, 4096
 v_mfma_f32_16x16x32_bf16 v[156:159], a[212:215], a[172:175], v[156:159]
 v_add_f32 v54, v54, v14
 v_mfma_f32_16x16x32_bf16 v[152:155], a[212:215], a[164:167], v[152:155]
 v_add_f32 v55, v55, v15
 v_mfma_f32_16x16x32_bf16 v[152:155], a[208:211], a[160:163], v[152:155]
 s_waitcnt lgkmcnt(0)
 v_mfma_f32_16x16x32_bf16 v[148:151], a[208:211], a[152:155], v[148:151]
 v_add_f32 v56, v56, v12
 v_mfma_f32_16x16x32_bf16 v[148:151], a[212:215], a[156:159], v[148:151]
 v_add_f32 v57, v57, v13
 v_add_f32 v58, v58, v14
 v_mfma_f32_16x16x32_bf16 v[144:147], a[212:215], a[148:151], v[144:147]
 v_add_f32 v59, v59, v15
 v_mfma_f32_16x16x32_bf16 v[144:147], a[208:211], a[144:147], v[144:147]
 v_add_f32 v60, v60, v12
 v_mfma_f32_16x16x32_bf16 v[140:143], a[208:211], a[136:139], v[140:143]
 v_add_f32 v61, v61, v13
 v_mfma_f32_16x16x32_bf16 v[140:143], a[212:215], a[140:143], v[140:143]
 v_add_f32 v62, v62, v14
 v_mfma_f32_16x16x32_bf16 v[136:139], a[212:215], a[132:135], v[136:139]
 buffer_load_dwordx4 a[212:215], v0, s[12:15], s24 offen offset:1024
 v_mfma_f32_16x16x32_bf16 v[136:139], a[208:211], a[128:131], v[136:139]
 s_waitcnt vmcnt(9)
 v_mfma_f32_16x16x32_bf16 v[168:171], a[216:219], a[128:131], v[168:171]
 v_add_f32 v63, v63, v15
 v_mfma_f32_16x16x32_bf16 v[168:171], a[220:223], a[132:135], v[168:171]
 buffer_load_dwordx4 a[208:211], v0, s[12:15], s24 offen
 v_mfma_f32_16x16x32_bf16 v[172:175], a[220:223], a[140:143], v[172:175]
 v_add_f32 v64, v64, v12
 v_mfma_f32_16x16x32_bf16 v[172:175], a[216:219], a[136:139], v[172:175]
 v_add_f32 v65, v65, v13
 v_mfma_f32_16x16x32_bf16 v[176:179], a[216:219], a[144:147], v[176:179]
 v_add_f32 v66, v66, v14
 v_mfma_f32_16x16x32_bf16 v[176:179], a[220:223], a[148:151], v[176:179]
 v_add_f32 v67, v67, v15
 v_mfma_f32_16x16x32_bf16 v[180:183], a[220:223], a[156:159], v[180:183]
 v_add_f32 v68, v68, v12
 v_mfma_f32_16x16x32_bf16 v[180:183], a[216:219], a[152:155], v[180:183]
 v_add_f32 v69, v69, v13
 v_add_f32 v70, v70, v14
 v_mfma_f32_16x16x32_bf16 v[184:187], a[216:219], a[160:163], v[184:187]
 v_add_f32 v71, v71, v15
 v_mfma_f32_16x16x32_bf16 v[184:187], a[220:223], a[164:167], v[184:187]
 v_add_f32 v72, v72, v12
 v_mfma_f32_16x16x32_bf16 v[188:191], a[220:223], a[172:175], v[188:191]
 v_add_f32 v73, v73, v13
 v_mfma_f32_16x16x32_bf16 v[188:191], a[216:219], a[168:171], v[188:191]
 v_add_f32 v74, v74, v14
 v_mfma_f32_16x16x32_bf16 v[192:195], a[216:219], a[176:179], v[192:195]
 v_add_f32 v75, v75, v15
 v_mfma_f32_16x16x32_bf16 v[192:195], a[220:223], a[180:183], v[192:195]
 v_add_f32 v76, v76, v12
 v_mfma_f32_16x16x32_bf16 v[196:199], a[220:223], a[188:191], v[196:199]
 buffer_load_dwordx4 a[220:223], v0, s[12:15], s24 offen offset:3072
 v_mfma_f32_16x16x32_bf16 v[196:199], a[216:219], a[184:187], v[196:199]
 s_waitcnt vmcnt(9)
 v_mfma_f32_16x16x32_bf16 v[228:231], a[224:227], a[184:187], v[228:231]
 v_add_f32 v77, v77, v13
 v_mfma_f32_16x16x32_bf16 v[228:231], a[228:231], a[188:191], v[228:231]
 buffer_load_dwordx4 a[216:219], v0, s[12:15], s24 offen offset:2048
 v_mfma_f32_16x16x32_bf16 v[224:227], a[228:231], a[180:183], v[224:227]
 v_add_f32 v78, v78, v14
 v_mfma_f32_16x16x32_bf16 v[224:227], a[224:227], a[176:179], v[224:227]
 s_add_u32 s24, s24, 4096
 v_mfma_f32_16x16x32_bf16 v[220:223], a[224:227], a[168:171], v[220:223]
 v_add_f32 v79, v79, v15
 v_mfma_f32_16x16x32_bf16 v[220:223], a[228:231], a[172:175], v[220:223]
 v_add_f32 v80, v80, v8
 v_mfma_f32_16x16x32_bf16 v[216:219], a[228:231], a[164:167], v[216:219]
 ds_read_b128 v[12:15], v4 offset:144
 v_mfma_f32_16x16x32_bf16 v[216:219], a[224:227], a[160:163], v[216:219]
 v_add_f32 v81, v81, v9
 v_mfma_f32_16x16x32_bf16 v[212:215], a[224:227], a[152:155], v[212:215]
 v_add_f32 v82, v82, v10
 v_mfma_f32_16x16x32_bf16 v[212:215], a[228:231], a[156:159], v[212:215]
 v_add_f32 v83, v83, v11
 v_mfma_f32_16x16x32_bf16 v[208:211], a[228:231], a[148:151], v[208:211]
 v_add_f32 v84, v84, v8
 v_mfma_f32_16x16x32_bf16 v[208:211], a[224:227], a[144:147], v[208:211]
 v_add_f32 v85, v85, v9
 v_mfma_f32_16x16x32_bf16 v[204:207], a[224:227], a[136:139], v[204:207]
 v_add_f32 v86, v86, v10
 v_mfma_f32_16x16x32_bf16 v[204:207], a[228:231], a[140:143], v[204:207]
 v_add_f32 v87, v87, v11
 v_mfma_f32_16x16x32_bf16 v[200:203], a[228:231], a[132:135], v[200:203]
 buffer_load_dwordx4 a[228:231], v0, s[12:15], s24 offen offset:1024
 v_mfma_f32_16x16x32_bf16 v[200:203], a[224:227], a[128:131], v[200:203]
 s_waitcnt vmcnt(9)
 v_mfma_f32_16x16x32_bf16 v[232:235], a[232:235], a[128:131], v[232:235]
 ds_read_b128 a[128:131], v2
 v_mfma_f32_16x16x32_bf16 v[232:235], a[236:239], a[132:135], v[232:235]
 buffer_load_dwordx4 a[224:227], v0, s[12:15], s24 offen
 ds_read_b128 a[132:135], v2 offset:1024
 v_mfma_f32_16x16x32_bf16 v[236:239], a[236:239], a[140:143], v[236:239]
 ds_read_b128 a[140:143], v2 offset:5120
 v_mfma_f32_16x16x32_bf16 v[236:239], a[232:235], a[136:139], v[236:239]
 ds_read_b128 a[136:139], v2 offset:4096
 v_mfma_f32_16x16x32_bf16 v[240:243], a[232:235], a[144:147], v[240:243]
 ds_read_b128 a[144:147], v2 offset:8192
 v_mfma_f32_16x16x32_bf16 v[240:243], a[236:239], a[148:151], v[240:243]
 v_add_f32 v88, v88, v8
 ds_read_b128 a[148:151], v2 offset:9216
 v_mfma_f32_16x16x32_bf16 v[244:247], a[236:239], a[156:159], v[244:247]
 ds_read_b128 a[156:159], v2 offset:13312
 v_mfma_f32_16x16x32_bf16 v[244:247], a[232:235], a[152:155], v[244:247]
 ds_read_b128 a[152:155], v2 offset:12288
 v_mfma_f32_16x16x32_bf16 v[248:251], a[232:235], a[160:163], v[248:251]
 ds_read_b128 a[160:163], v2 offset:16384
 v_mfma_f32_16x16x32_bf16 v[248:251], a[236:239], a[164:167], v[248:251]
 ds_read_b128 a[164:167], v2 offset:17408
 v_mfma_f32_16x16x32_bf16 v[252:255], a[236:239], a[172:175], v[252:255]
 ds_read_b128 a[172:175], v2 offset:21504
 v_mfma_f32_16x16x32_bf16 v[252:255], a[232:235], a[168:171], v[252:255]
 ds_read_b128 a[168:171], v2 offset:20480
 v_mfma_f32_16x16x32_bf16 a[248:251], a[232:235], a[176:179], a[248:251]
 ds_read_b128 a[176:179], v2 offset:24576
 v_mfma_f32_16x16x32_bf16 a[248:251], a[236:239], a[180:183], a[248:251]
 ds_read_b128 a[180:183], v2 offset:25600
 v_mfma_f32_16x16x32_bf16 a[252:255], a[236:239], a[188:191], a[252:255]
 ds_read_b128 a[188:191], v2 offset:29696
 v_mfma_f32_16x16x32_bf16 a[252:255], a[232:235], a[184:187], a[252:255]
 ds_read_b128 a[184:187], v2 offset:28672
 s_waitcnt vmcnt(8) lgkmcnt(8)
 v_mfma_f32_16x16x32_bf16 v[136:139], a[192:195], a[128:131], v[136:139]
 v_add_f32 v89, v89, v9
 v_mfma_f32_16x16x32_bf16 v[136:139], a[196:199], a[132:135], v[136:139]
 buffer_load_dwordx4 a[236:239], v0, s[12:15], s24 offen offset:3072
 v_mfma_f32_16x16x32_bf16 v[140:143], a[196:199], a[140:143], v[140:143]
 v_add_f32 v90, v90, v10
 v_mfma_f32_16x16x32_bf16 v[140:143], a[192:195], a[136:139], v[140:143]
 buffer_load_dwordx4 a[232:235], v0, s[12:15], s24 offen offset:2048
 v_mfma_f32_16x16x32_bf16 v[144:147], a[192:195], a[144:147], v[144:147]
 v_add_f32 v91, v91, v11
 s_add_u32 s24, s24, 4096
 v_mfma_f32_16x16x32_bf16 v[144:147], a[196:199], a[148:151], v[144:147]
 v_add_f32 v92, v92, v8
 v_mfma_f32_16x16x32_bf16 v[148:151], a[196:199], a[156:159], v[148:151]
 v_add_f32 v93, v93, v9
 v_mfma_f32_16x16x32_bf16 v[148:151], a[192:195], a[152:155], v[148:151]
 s_waitcnt lgkmcnt(0)
 v_mfma_f32_16x16x32_bf16 v[152:155], a[192:195], a[160:163], v[152:155]
 v_add_f32 v94, v94, v10
 v_mfma_f32_16x16x32_bf16 v[152:155], a[196:199], a[164:167], v[152:155]
 v_add_f32 v95, v95, v11
 v_mfma_f32_16x16x32_bf16 v[156:159], a[196:199], a[172:175], v[156:159]
 v_add_f32 v96, v96, v8
 v_mfma_f32_16x16x32_bf16 v[156:159], a[192:195], a[168:171], v[156:159]
 v_add_f32 v97, v97, v9
 v_mfma_f32_16x16x32_bf16 v[160:163], a[192:195], a[176:179], v[160:163]
 v_add_f32 v98, v98, v10
 v_mfma_f32_16x16x32_bf16 v[160:163], a[196:199], a[180:183], v[160:163]
 buffer_load_dword v4, off, s[64:67], 0 sc1
 v_mfma_f32_16x16x32_bf16 v[164:167], a[196:199], a[188:191], v[164:167]
 buffer_load_dwordx4 a[196:199], v0, s[12:15], s24 offen offset:1024
 v_mfma_f32_16x16x32_bf16 v[164:167], a[192:195], a[184:187], v[164:167]
 s_waitcnt vmcnt(10)
 v_mfma_f32_16x16x32_bf16 v[196:199], a[200:203], a[184:187], v[196:199]
 v_add_f32 v99, v99, v11
 v_mfma_f32_16x16x32_bf16 v[196:199], a[204:207], a[188:191], v[196:199]
 buffer_load_dwordx4 a[192:195], v0, s[12:15], s24 offen
 v_mfma_f32_16x16x32_bf16 v[192:195], a[204:207], a[180:183], v[192:195]
 v_add_f32 v100, v100, v8
 v_add_f32 v101, v101, v9
 v_mfma_f32_16x16x32_bf16 v[192:195], a[200:203], a[176:179], v[192:195]
 v_add_f32 v102, v102, v10
 v_mfma_f32_16x16x32_bf16 v[188:191], a[200:203], a[168:171], v[188:191]
 v_add_f32 v103, v103, v11
 v_mfma_f32_16x16x32_bf16 v[188:191], a[204:207], a[172:175], v[188:191]
 v_add_f32 v104, v104, v8
 v_mfma_f32_16x16x32_bf16 v[184:187], a[204:207], a[164:167], v[184:187]
 v_add_f32 v105, v105, v9
 v_mfma_f32_16x16x32_bf16 v[184:187], a[200:203], a[160:163], v[184:187]
 v_add_f32 v106, v106, v10
 v_mfma_f32_16x16x32_bf16 v[180:183], a[200:203], a[152:155], v[180:183]
 v_add_f32 v107, v107, v11
 v_mfma_f32_16x16x32_bf16 v[180:183], a[204:207], a[156:159], v[180:183]
 v_add_f32 v108, v108, v8
 v_mfma_f32_16x16x32_bf16 v[176:179], a[204:207], a[148:151], v[176:179]
 v_add_f32 v109, v109, v9
 v_mfma_f32_16x16x32_bf16 v[176:179], a[200:203], a[144:147], v[176:179]
 v_add_f32 v110, v110, v10
 v_mfma_f32_16x16x32_bf16 v[172:175], a[200:203], a[136:139], v[172:175]
 v_add_f32 v111, v111, v11
 v_mfma_f32_16x16x32_bf16 v[172:175], a[204:207], a[140:143], v[172:175]
 v_mfma_f32_16x16x32_bf16 v[168:171], a[204:207], a[132:135], v[168:171]
 buffer_load_dwordx4 a[204:207], v0, s[12:15], s24 offen offset:3072
 v_mfma_f32_16x16x32_bf16 v[168:171], a[200:203], a[128:131], v[168:171]
 s_waitcnt vmcnt(10)
 v_mfma_f32_16x16x32_bf16 v[200:203], a[208:211], a[128:131], v[200:203]
 v_add_f32 v112, v112, v12
 v_add_f32 v113, v113, v13
 v_mfma_f32_16x16x32_bf16 v[200:203], a[212:215], a[132:135], v[200:203]
 buffer_load_dwordx4 a[200:203], v0, s[12:15], s24 offen offset:2048
 v_mfma_f32_16x16x32_bf16 v[204:207], a[212:215], a[140:143], v[204:207]
 v_add_f32 v114, v114, v14
 v_mfma_f32_16x16x32_bf16 v[204:207], a[208:211], a[136:139], v[204:207]
 s_add_u32 s24, s24, 4096
 v_mfma_f32_16x16x32_bf16 v[208:211], a[208:211], a[144:147], v[208:211]
 v_add_f32 v115, v115, v15
 v_mfma_f32_16x16x32_bf16 v[208:211], a[212:215], a[148:151], v[208:211]
 v_add_f32 v116, v116, v12
 v_mfma_f32_16x16x32_bf16 v[212:215], a[212:215], a[156:159], v[212:215]
 v_add_f32 v117, v117, v13
 v_mfma_f32_16x16x32_bf16 v[212:215], a[208:211], a[152:155], v[212:215]
 v_add_f32 v118, v118, v14
 v_mfma_f32_16x16x32_bf16 v[216:219], a[208:211], a[160:163], v[216:219]
 v_add_f32 v119, v119, v15
 v_mfma_f32_16x16x32_bf16 v[216:219], a[212:215], a[164:167], v[216:219]
 v_add_f32 v120, v120, v12
 v_mfma_f32_16x16x32_bf16 v[220:223], a[212:215], a[172:175], v[220:223]
 v_add_f32 v121, v121, v13
 v_mfma_f32_16x16x32_bf16 v[220:223], a[208:211], a[168:171], v[220:223]
 v_add_f32 v122, v122, v14
 v_mfma_f32_16x16x32_bf16 v[224:227], a[208:211], a[176:179], v[224:227]
 v_add_f32 v123, v123, v15
 v_mfma_f32_16x16x32_bf16 v[224:227], a[212:215], a[180:183], v[224:227]
 v_add_f32 v124, v124, v12
 v_mfma_f32_16x16x32_bf16 v[228:231], a[212:215], a[188:191], v[228:231]
 buffer_load_dwordx4 a[212:215], v0, s[12:15], s24 offen offset:1024
 v_mfma_f32_16x16x32_bf16 v[228:231], a[208:211], a[184:187], v[228:231]
 v_add_f32 v125, v125, v13
 s_waitcnt vmcnt(10)
 v_mfma_f32_16x16x32_bf16 a[252:255], a[216:219], a[184:187], a[252:255]
 ds_read_b128 a[184:187], v2 offset:61440
 v_mfma_f32_16x16x32_bf16 a[252:255], a[220:223], a[188:191], a[252:255]
 buffer_load_dwordx4 a[208:211], v0, s[12:15], s24 offen
 ds_read_b128 a[188:191], v2 offset:62464
 v_mfma_f32_16x16x32_bf16 a[248:251], a[220:223], a[180:183], a[248:251]
 ds_read_b128 a[180:183], v2 offset:58368
 v_mfma_f32_16x16x32_bf16 a[248:251], a[216:219], a[176:179], a[248:251]
 ds_read_b128 a[176:179], v2 offset:57344
 v_mfma_f32_16x16x32_bf16 v[252:255], a[216:219], a[168:171], v[252:255]
 ds_read_b128 a[168:171], v2 offset:53248
 v_mfma_f32_16x16x32_bf16 v[252:255], a[220:223], a[172:175], v[252:255]
 ds_read_b128 a[172:175], v2 offset:54272
 v_mfma_f32_16x16x32_bf16 v[248:251], a[220:223], a[164:167], v[248:251]
 ds_read_b128 a[164:167], v2 offset:50176
 v_mfma_f32_16x16x32_bf16 v[248:251], a[216:219], a[160:163], v[248:251]
 ds_read_b128 a[160:163], v2 offset:49152
 v_mfma_f32_16x16x32_bf16 v[244:247], a[216:219], a[152:155], v[244:247]
 ds_read_b128 a[152:155], v2 offset:45056
 v_mfma_f32_16x16x32_bf16 v[244:247], a[220:223], a[156:159], v[244:247]
 ds_read_b128 a[156:159], v2 offset:46080
 v_mfma_f32_16x16x32_bf16 v[240:243], a[220:223], a[148:151], v[240:243]
 ds_read_b128 a[148:151], v2 offset:41984
 v_mfma_f32_16x16x32_bf16 v[240:243], a[216:219], a[144:147], v[240:243]
 ds_read_b128 a[144:147], v2 offset:40960
 v_mfma_f32_16x16x32_bf16 v[236:239], a[216:219], a[136:139], v[236:239]
 ds_read_b128 a[136:139], v2 offset:36864
 v_mfma_f32_16x16x32_bf16 v[236:239], a[220:223], a[140:143], v[236:239]
 ds_read_b128 a[140:143], v2 offset:37888
 v_mfma_f32_16x16x32_bf16 v[232:235], a[220:223], a[132:135], v[232:235]
 v_add_f32 v126, v126, v14
 ds_read_b128 a[132:135], v2 offset:33792
 v_mfma_f32_16x16x32_bf16 v[232:235], a[216:219], a[128:131], v[232:235]
 ds_read_b128 a[128:131], v2 offset:32768
 s_waitcnt vmcnt(9) lgkmcnt(8)
 v_mfma_f32_16x16x32_bf16 v[164:167], a[224:227], a[184:187], v[164:167]
 v_add_f32 v127, v127, v15
 v_mfma_f32_16x16x32_bf16 v[164:167], a[228:231], a[188:191], v[164:167]
 buffer_load_dwordx4 a[220:223], v0, s[12:15], s24 offen offset:3072
 v_mfma_f32_16x16x32_bf16 v[160:163], a[228:231], a[180:183], v[160:163]
 v_add_f32 v128, v128, v12
 v_mfma_f32_16x16x32_bf16 v[160:163], a[224:227], a[176:179], v[160:163]
 buffer_load_dwordx4 a[216:219], v0, s[12:15], s24 offen offset:2048
 v_mfma_f32_16x16x32_bf16 v[156:159], a[224:227], a[168:171], v[156:159]
 s_add_u32 s24, s24, 4096
 v_mfma_f32_16x16x32_bf16 v[156:159], a[228:231], a[172:175], v[156:159]
 v_add_f32 v129, v129, v13
 v_mfma_f32_16x16x32_bf16 v[152:155], a[228:231], a[164:167], v[152:155]
 v_add_f32 v130, v130, v14
 v_mfma_f32_16x16x32_bf16 v[152:155], a[224:227], a[160:163], v[152:155]
 s_waitcnt lgkmcnt(0)
 v_mfma_f32_16x16x32_bf16 v[148:151], a[224:227], a[152:155], v[148:151]
 v_add_f32 v131, v131, v15
 v_mfma_f32_16x16x32_bf16 v[148:151], a[228:231], a[156:159], v[148:151]
 v_add_f32 v132, v132, v12
 v_mfma_f32_16x16x32_bf16 v[144:147], a[228:231], a[148:151], v[144:147]
 v_add_f32 v133, v133, v13
 v_mfma_f32_16x16x32_bf16 v[144:147], a[224:227], a[144:147], v[144:147]
 v_add_f32 v134, v134, v14
 v_mfma_f32_16x16x32_bf16 v[140:143], a[224:227], a[136:139], v[140:143]
 v_add_f32 v135, v135, v15
 v_mfma_f32_16x16x32_bf16 v[140:143], a[228:231], a[140:143], v[140:143]
 v_accvgpr_read_b32 v5, a240
 v_add_f32 v5, v5, v12
 v_mfma_f32_16x16x32_bf16 v[136:139], a[228:231], a[132:135], v[136:139]
 buffer_load_dwordx4 a[228:231], v0, s[12:15], s24 offen offset:1024
 v_mfma_f32_16x16x32_bf16 v[136:139], a[224:227], a[128:131], v[136:139]
 s_waitcnt vmcnt(10)
 v_mfma_f32_16x16x32_bf16 v[168:171], a[232:235], a[128:131], v[168:171]
 v_accvgpr_write_b32 a240, v5
 v_mfma_f32_16x16x32_bf16 v[168:171], a[236:239], a[132:135], v[168:171]
 buffer_load_dwordx4 a[224:227], v0, s[12:15], s24 offen
 v_mfma_f32_16x16x32_bf16 v[172:175], a[236:239], a[140:143], v[172:175]
 v_accvgpr_read_b32 v6, a241
 v_mfma_f32_16x16x32_bf16 v[172:175], a[232:235], a[136:139], v[172:175]
 v_add_f32 v6, v6, v13
 v_mfma_f32_16x16x32_bf16 v[176:179], a[232:235], a[144:147], v[176:179]
 v_accvgpr_write_b32 a241, v6
 v_mfma_f32_16x16x32_bf16 v[176:179], a[236:239], a[148:151], v[176:179]
 v_accvgpr_read_b32 v5, a242
 v_mfma_f32_16x16x32_bf16 v[180:183], a[236:239], a[156:159], v[180:183]
 v_add_f32 v5, v5, v14
 v_mfma_f32_16x16x32_bf16 v[180:183], a[232:235], a[152:155], v[180:183]
 v_accvgpr_write_b32 a242, v5
 v_mfma_f32_16x16x32_bf16 v[184:187], a[232:235], a[160:163], v[184:187]
 v_accvgpr_read_b32 v6, a243
 v_mfma_f32_16x16x32_bf16 v[184:187], a[236:239], a[164:167], v[184:187]
 v_add_f32 v6, v6, v15
 v_mfma_f32_16x16x32_bf16 v[188:191], a[236:239], a[172:175], v[188:191]
 v_accvgpr_write_b32 a243, v6
 v_mfma_f32_16x16x32_bf16 v[188:191], a[232:235], a[168:171], v[188:191]
 v_accvgpr_read_b32 v5, a244
 v_add_f32 v5, v5, v12
 v_mfma_f32_16x16x32_bf16 v[192:195], a[232:235], a[176:179], v[192:195]
 v_accvgpr_write_b32 a244, v5
 v_mfma_f32_16x16x32_bf16 v[192:195], a[236:239], a[180:183], v[192:195]
 v_accvgpr_read_b32 v6, a245
 v_mfma_f32_16x16x32_bf16 v[196:199], a[236:239], a[188:191], v[196:199]
 buffer_load_dwordx4 a[236:239], v0, s[12:15], s24 offen offset:3072
 v_mfma_f32_16x16x32_bf16 v[196:199], a[232:235], a[184:187], v[196:199]
 s_waitcnt vmcnt(9)
 v_mfma_f32_16x16x32_bf16 v[228:231], a[192:195], a[184:187], v[228:231]
 v_add_f32 v6, v6, v13
 v_mfma_f32_16x16x32_bf16 v[228:231], a[196:199], a[188:191], v[228:231]
 buffer_load_dwordx4 a[232:235], v0, s[12:15], s24 offen offset:2048
 v_mfma_f32_16x16x32_bf16 v[224:227], a[196:199], a[180:183], v[224:227]
 v_accvgpr_write_b32 a245, v6
 v_mfma_f32_16x16x32_bf16 v[224:227], a[192:195], a[176:179], v[224:227]
 s_add_u32 s24, s24, 4096
 v_mfma_f32_16x16x32_bf16 v[220:223], a[192:195], a[168:171], v[220:223]
 v_accvgpr_read_b32 v5, a246
 v_mfma_f32_16x16x32_bf16 v[220:223], a[196:199], a[172:175], v[220:223]
 v_add_f32 v5, v5, v14
 v_mfma_f32_16x16x32_bf16 v[216:219], a[196:199], a[164:167], v[216:219]
 v_accvgpr_write_b32 a246, v5
 v_mfma_f32_16x16x32_bf16 v[216:219], a[192:195], a[160:163], v[216:219]
 v_accvgpr_read_b32 v6, a247
 v_mfma_f32_16x16x32_bf16 v[212:215], a[192:195], a[152:155], v[212:215]
 v_add_f32 v6, v6, v15
 v_mfma_f32_16x16x32_bf16 v[212:215], a[196:199], a[156:159], v[212:215]
 v_accvgpr_write_b32 a247, v6
 v_mfma_f32_16x16x32_bf16 v[208:211], a[196:199], a[148:151], v[208:211]
 v_cmp_gt_u32 vcc, s55, v4
 s_cbranch_vccnz Lspin_pa
Lok_pa:
 s_add_u32 s55, s55, 1
 s_waitcnt lgkmcnt(0)
 s_barrier
 v_mfma_f32_16x16x32_bf16 v[208:211], a[192:195], a[144:147], v[208:211]
 v_mfma_f32_16x16x32_bf16 v[204:207], a[192:195], a[136:139], v[204:207]
 v_mfma_f32_16x16x32_bf16 v[204:207], a[196:199], a[140:143], v[204:207]
 v_mfma_f32_16x16x32_bf16 v[200:203], a[196:199], a[132:135], v[200:203]
 buffer_load_dwordx4 a[196:199], v0, s[12:15], s24 offen offset:1024
 v_mfma_f32_16x16x32_bf16 v[200:203], a[192:195], a[128:131], v[200:203]
 s_waitcnt vmcnt(9)
 v_mfma_f32_16x16x32_bf16 v[232:235], a[200:203], a[128:131], v[232:235]
 ds_read_b128 a[128:131], v1 offset:2048
 v_mfma_f32_16x16x32_bf16 v[232:235], a[204:207], a[132:135], v[232:235]
 buffer_load_dwordx4 a[192:195], v0, s[12:15], s24 offen
 ds_read_b128 a[132:135], v1 offset:3072
 v_mfma_f32_16x16x32_bf16 v[236:239], a[204:207], a[140:143], v[236:239]
 ds_read_b128 a[140:143], v1 offset:7168
 v_mfma_f32_16x16x32_bf16 v[236:239], a[200:203], a[136:139], v[236:239]
 ds_read_b128 a[136:139], v1 offset:6144
 v_mfma_f32_16x16x32_bf16 v[240:243], a[200:203], a[144:147], v[240:243]
 ds_read_b128 a[144:147], v1 offset:10240
 v_mfma_f32_16x16x32_bf16 v[240:243], a[204:207], a[148:151], v[240:243]
 ds_read_b128 a[148:151], v1 offset:11264
 v_mfma_f32_16x16x32_bf16 v[244:247], a[204:207], a[156:159], v[244:247]
 ds_read_b128 a[156:159], v1 offset:15360
 v_mfma_f32_16x16x32_bf16 v[244:247], a[200:203], a[152:155], v[244:247]
 ds_read_b128 a[152:155], v1 offset:14336
 v_mfma_f32_16x16x32_bf16 v[248:251], a[200:203], a[160:163], v[248:251]
 ds_read_b128 a[160:163], v1 offset:18432
 v_mfma_f32_16x16x32_bf16 v[248:251], a[204:207], a[164:167], v[248:251]
 ds_read_b128 a[164:167], v1 offset:19456
 v_mfma_f32_16x16x32_bf16 v[252:255], a[204:207], a[172:175], v[252:255]
 ds_read_b128 a[172:175], v1 offset:23552
 v_mfma_f32_16x16x32_bf16 v[252:255], a[200:203], a[168:171], v[252:255]
 ds_read_b128 a[168:171], v1 offset:22528
 v_mfma_f32_16x16x32_bf16 a[248:251], a[200:203], a[176:179], a[248:251]
 ds_read_b128 a[176:179], v1 offset:26624
 v_mfma_f32_16x16x32_bf16 a[248:251], a[204:207], a[180:183], a[248:251]
 ds_read_b128 a[180:183], v1 offset:27648
 v_mfma_f32_16x16x32_bf16 a[252:255], a[204:207], a[188:191], a[252:255]
 buffer_load_dwordx4 a[204:207], v0, s[12:15], s24 offen offset:3072
 ds_read_b128 a[188:191], v1 offset:31744
 v_mfma_f32_16x16x32_bf16 a[252:255], a[200:203], a[184:187], a[252:255]
 buffer_load_dwordx4 a[200:203], v0, s[12:15], s24 offen offset:2048
 s_add_u32 s24, s24, 4096
 ds_read_b128 a[184:187], v1 offset:30720
 s_waitcnt vmcnt(10) lgkmcnt(8)
 s_branch Lloop
Llast:
 v_mfma_f32_16x16x32_bf16 v[136:139], a[208:211], a[128:131], v[136:139]
 v_accvgpr_read_b32 v5, a0
 v_lshlrev_b32 v6, 16, v5
 v_and_b32 v5, s26, v5
 v_mfma_f32_16x16x32_bf16 v[136:139], a[212:215], a[132:135], v[136:139]
 v_mul_f32 v6, v6, v16
 v_mul_f32 v5, v5, v17
 v_mfma_f32_16x16x32_bf16 v[140:143], a[212:215], a[140:143], v[140:143]
 v_cvt_pk_bf16_f32 v8, v6, v5
 v_accvgpr_read_b32 v5, a1
 v_mfma_f32_16x16x32_bf16 v[140:143], a[208:211], a[136:139], v[140:143]
 v_lshlrev_b32 v6, 16, v5
 v_and_b32 v5, s26, v5
 v_mul_f32 v6, v6, v18
 v_mfma_f32_16x16x32_bf16 v[144:147], a[208:211], a[144:147], v[144:147]
 v_mul_f32 v5, v5, v19
 v_cvt_pk_bf16_f32 v9, v6, v5
 v_mfma_f32_16x16x32_bf16 v[144:147], a[212:215], a[148:151], v[144:147]
 v_accvgpr_read_b32 v5, a2
 v_lshlrev_b32 v6, 16, v5
 v_mfma_f32_16x16x32_bf16 v[148:151], a[212:215], a[156:159], v[148:151]
 v_and_b32 v5, s26, v5
 v_mul_f32 v6, v6, v48
 v_mfma_f32_16x16x32_bf16 v[148:151], a[208:211], a[152:155], v[148:151]
 v_mul_f32 v5, v5, v49
 v_cvt_pk_bf16_f32 v10, v6, v5
 s_waitcnt lgkmcnt(0)
 v_mfma_f32_16x16x32_bf16 v[152:155], a[208:211], a[160:163], v[152:155]
 v_accvgpr_read_b32 v5, a3
 v_lshlrev_b32 v6, 16, v5
 v_mfma_f32_16x16x32_bf16 v[152:155], a[212:215], a[164:167], v[152:155]
 v_and_b32 v5, s26, v5
 v_mul_f32 v6, v6, v50
 v_mfma_f32_16x16x32_bf16 v[156:159], a[212:215], a[172:175], v[156:159]
 v_mul_f32 v5, v5, v51
 v_cvt_pk_bf16_f32 v11, v6, v5
 v_mfma_f32_16x16x32_bf16 v[156:159], a[208:211], a[168:171], v[156:159]
 v_lshrrev_b32 v5, 7, v1
 v_lshlrev_b32 v6, 4, v5
 v_xor_b32 v6, v6, v1
 v_mfma_f32_16x16x32_bf16 v[160:163], a[208:211], a[176:179], v[160:163]
 v_and_b32 v6, 112, v6
 v_lshl_add_u32 v16, v5, 11, v6
 v_mfma_f32_16x16x32_bf16 v[160:163], a[212:215], a[180:183], v[160:163]
 v_lshrrev_b32 v5, 4, v1
 v_and_b32 v5, 48, v5
 v_mfma_f32_16x16x32_bf16 v[164:167], a[212:215], a[188:191], v[164:167]
 v_xor_b32 v5, v5, v1
 buffer_load_dwordx4 a[212:215], v0, s[12:15], s24 offen offset:1024
 v_mfma_f32_16x16x32_bf16 v[164:167], a[208:211], a[184:187], v[164:167]
 v_and_b32 v5, 112, v5
 v_and_b32 v6, 240, v1
 s_waitcnt vmcnt(9)
 v_mfma_f32_16x16x32_bf16 v[196:199], a[216:219], a[184:187], v[196:199]
 v_lshl_add_u32 v5, v6, 3, v5
 v_add_u32 v17, s50, v5
 v_mfma_f32_16x16x32_bf16 v[196:199], a[220:223], a[188:191], v[196:199]
 v_xor_b32 v18, 64, v17
 buffer_load_dwordx4 a[208:211], v0, s[12:15], s24 offen
 v_mfma_f32_16x16x32_bf16 v[192:195], a[220:223], a[180:183], v[192:195]
 ds_write_b128 v17, v[8:11]
 v_accvgpr_read_b32 v5, a32
 v_mfma_f32_16x16x32_bf16 v[192:195], a[216:219], a[176:179], v[192:195]
 v_lshlrev_b32 v6, 16, v5
 v_and_b32 v5, s26, v5
 v_mul_f32 v6, v6, v80
 v_mfma_f32_16x16x32_bf16 v[188:191], a[216:219], a[168:171], v[188:191]
 v_mul_f32 v5, v5, v81
 v_cvt_pk_bf16_f32 v12, v6, v5
 v_mfma_f32_16x16x32_bf16 v[188:191], a[220:223], a[172:175], v[188:191]
 v_accvgpr_read_b32 v5, a33
 v_lshlrev_b32 v6, 16, v5
 v_mfma_f32_16x16x32_bf16 v[184:187], a[220:223], a[164:167], v[184:187]
 v_and_b32 v5, s26, v5
 v_mul_f32 v6, v6, v82
 v_mul_f32 v5, v5, v83
 v_mfma_f32_16x16x32_bf16 v[184:187], a[216:219], a[160:163], v[184:187]
 v_cvt_pk_bf16_f32 v13, v6, v5
 v_accvgpr_read_b32 v5, a34
 v_mfma_f32_16x16x32_bf16 v[180:183], a[216:219], a[152:155], v[180:183]
 v_lshlrev_b32 v6, 16, v5
 v_and_b32 v5, s26, v5
 v_mfma_f32_16x16x32_bf16 v[180:183], a[220:223], a[156:159], v[180:183]
 v_mul_f32 v6, v6, v112
 v_mul_f32 v5, v5, v113
 v_mfma_f32_16x16x32_bf16 v[176:179], a[220:223], a[148:151], v[176:179]
 v_cvt_pk_bf16_f32 v14, v6, v5
 v_accvgpr_read_b32 v5, a35
 v_lshlrev_b32 v6, 16, v5
 v_mfma_f32_16x16x32_bf16 v[176:179], a[216:219], a[144:147], v[176:179]
 v_and_b32 v5, s26, v5
 v_mul_f32 v6, v6, v114
 v_mfma_f32_16x16x32_bf16 v[172:175], a[216:219], a[136:139], v[172:175]
 v_mul_f32 v5, v5, v115
 v_cvt_pk_bf16_f32 v15, v6, v5
 v_mfma_f32_16x16x32_bf16 v[172:175], a[220:223], a[140:143], v[172:175]
 ds_write_b128 v18, v[12:15]
 ds_read_b128 v[48:51], v3
 v_mfma_f32_16x16x32_bf16 v[168:171], a[220:223], a[132:135], v[168:171]
 ds_read_b128 v[80:83], v3 offset:1024
 v_accvgpr_read_b32 v5, a4
 buffer_load_dwordx4 a[220:223], v0, s[12:15], s24 offen offset:3072
 v_mfma_f32_16x16x32_bf16 v[168:171], a[216:219], a[128:131], v[168:171]
 v_lshlrev_b32 v6, 16, v5
 s_waitcnt vmcnt(9)
 v_mfma_f32_16x16x32_bf16 v[200:203], a[224:227], a[128:131], v[200:203]
 v_and_b32 v5, s26, v5
 v_mul_f32 v6, v6, v20
 v_mfma_f32_16x16x32_bf16 v[200:203], a[228:231], a[132:135], v[200:203]
 v_mul_f32 v5, v5, v21
 buffer_load_dwordx4 a[216:219], v0, s[12:15], s24 offen offset:2048
 v_mfma_f32_16x16x32_bf16 v[204:207], a[228:231], a[140:143], v[204:207]
 v_cvt_pk_bf16_f32 v8, v6, v5
 v_accvgpr_read_b32 v5, a5
 v_lshlrev_b32 v6, 16, v5
 v_mfma_f32_16x16x32_bf16 v[204:207], a[224:227], a[136:139], v[204:207]
 v_and_b32 v5, s26, v5
 s_add_u32 s24, s24, 4096
 v_mfma_f32_16x16x32_bf16 v[208:211], a[224:227], a[144:147], v[208:211]
 v_mul_f32 v6, v6, v22
 v_mul_f32 v5, v5, v23
 v_mfma_f32_16x16x32_bf16 v[208:211], a[228:231], a[148:151], v[208:211]
 v_cvt_pk_bf16_f32 v9, v6, v5
 s_waitcnt lgkmcnt(1)
 v_mfma_f32_16x16x32_bf16 v[212:215], a[228:231], a[156:159], v[212:215]
 s_add_u32 s3, s28, 0
 buffer_store_dwordx4 v[48:51], v16, s[16:19], s3 offen nt
 s_waitcnt lgkmcnt(0)
 v_mfma_f32_16x16x32_bf16 v[212:215], a[224:227], a[152:155], v[212:215]
 s_add_u32 s3, s28, 16384
 buffer_store_dwordx4 v[80:83], v16, s[16:19], s3 offen nt
 v_mfma_f32_16x16x32_bf16 v[216:219], a[224:227], a[160:163], v[216:219]
 v_accvgpr_read_b32 v5, a6
 v_lshlrev_b32 v6, 16, v5
 v_mfma_f32_16x16x32_bf16 v[216:219], a[228:231], a[164:167], v[216:219]
 v_and_b32 v5, s26, v5
 v_mul_f32 v6, v6, v52
 v_mul_f32 v5, v5, v53
 v_mfma_f32_16x16x32_bf16 v[220:223], a[228:231], a[172:175], v[220:223]
 v_cvt_pk_bf16_f32 v10, v6, v5
 v_accvgpr_read_b32 v5, a7
 v_mfma_f32_16x16x32_bf16 v[220:223], a[224:227], a[168:171], v[220:223]
 v_lshlrev_b32 v6, 16, v5
 v_and_b32 v5, s26, v5
 v_mfma_f32_16x16x32_bf16 v[224:227], a[224:227], a[176:179], v[224:227]
 v_mul_f32 v6, v6, v54
 v_mul_f32 v5, v5, v55
 v_mfma_f32_16x16x32_bf16 v[224:227], a[228:231], a[180:183], v[224:227]
 v_cvt_pk_bf16_f32 v11, v6, v5
 ds_write_b128 v17, v[8:11] offset:4096
 v_accvgpr_read_b32 v5, a36
 v_mfma_f32_16x16x32_bf16 v[228:231], a[228:231], a[188:191], v[228:231]
 v_lshlrev_b32 v6, 16, v5
 buffer_load_dwordx4 a[228:231], v0, s[12:15], s24 offen offset:1024
 v_mfma_f32_16x16x32_bf16 v[228:231], a[224:227], a[184:187], v[228:231]
 v_and_b32 v5, s26, v5
 s_waitcnt vmcnt(11)
 v_mfma_f32_16x16x32_bf16 a[252:255], a[232:235], a[184:187], a[252:255]
 v_mul_f32 v6, v6, v84
 ds_read_b128 a[184:187], v1 offset:63488
 v_mfma_f32_16x16x32_bf16 a[252:255], a[236:239], a[188:191], a[252:255]
 v_mul_f32 v5, v5, v85
 buffer_load_dwordx4 a[224:227], v0, s[12:15], s24 offen
 ds_read_b128 a[188:191], v1 offset:64512
 v_mfma_f32_16x16x32_bf16 a[248:251], a[236:239], a[180:183], a[248:251]
 v_cvt_pk_bf16_f32 v12, v6, v5
 ds_read_b128 a[180:183], v1 offset:60416
 v_mfma_f32_16x16x32_bf16 a[248:251], a[232:235], a[176:179], a[248:251]
 v_accvgpr_read_b32 v5, a37
 ds_read_b128 a[176:179], v1 offset:59392
 v_mfma_f32_16x16x32_bf16 v[252:255], a[232:235], a[168:171], v[252:255]
 v_lshlrev_b32 v6, 16, v5
 ds_read_b128 a[168:171], v1 offset:55296
 v_mfma_f32_16x16x32_bf16 v[252:255], a[236:239], a[172:175], v[252:255]
 v_and_b32 v5, s26, v5
 v_mul_f32 v6, v6, v86
 ds_read_b128 a[172:175], v1 offset:56320
 v_mfma_f32_16x16x32_bf16 v[248:251], a[236:239], a[164:167], v[248:251]
 v_mul_f32 v5, v5, v87
 ds_read_b128 a[164:167], v1 offset:52224
 v_mfma_f32_16x16x32_bf16 v[248:251], a[232:235], a[160:163], v[248:251]
 v_cvt_pk_bf16_f32 v13, v6, v5
 ds_read_b128 a[160:163], v1 offset:51200
 v_mfma_f32_16x16x32_bf16 v[244:247], a[232:235], a[152:155], v[244:247]
 v_accvgpr_read_b32 v5, a38
 ds_read_b128 a[152:155], v1 offset:47104
 v_mfma_f32_16x16x32_bf16 v[244:247], a[236:239], a[156:159], v[244:247]
 v_lshlrev_b32 v6, 16, v5
 v_and_b32 v5, s26, v5
 ds_read_b128 a[156:159], v1 offset:48128
 v_mfma_f32_16x16x32_bf16 v[240:243], a[236:239], a[148:151], v[240:243]
 v_mul_f32 v6, v6, v116
 ds_read_b128 a[148:151], v1 offset:44032
 v_mfma_f32_16x16x32_bf16 v[240:243], a[232:235], a[144:147], v[240:243]
 v_mul_f32 v5, v5, v117
 ds_read_b128 a[144:147], v1 offset:43008
 v_mfma_f32_16x16x32_bf16 v[236:239], a[232:235], a[136:139], v[236:239]
 v_cvt_pk_bf16_f32 v14, v6, v5
 v_accvgpr_read_b32 v5, a39
 ds_read_b128 a[136:139], v1 offset:38912
 v_mfma_f32_16x16x32_bf16 v[236:239], a[236:239], a[140:143], v[236:239]
 v_lshlrev_b32 v6, 16, v5
 ds_read_b128 a[140:143], v1 offset:39936
 v_mfma_f32_16x16x32_bf16 v[232:235], a[236:239], a[132:135], v[232:235]
 v_and_b32 v5, s26, v5
 ds_read_b128 a[132:135], v1 offset:35840
 v_mfma_f32_16x16x32_bf16 v[232:235], a[232:235], a[128:131], v[232:235]
 ds_read_b128 a[128:131], v1 offset:34816
 s_waitcnt vmcnt(10) lgkmcnt(8)
 v_mfma_f32_16x16x32_bf16 v[164:167], a[192:195], a[184:187], v[164:167]
 v_mul_f32 v6, v6, v118
 v_mul_f32 v5, v5, v119
 v_cvt_pk_bf16_f32 v15, v6, v5
 v_mfma_f32_16x16x32_bf16 v[164:167], a[196:199], a[188:191], v[164:167]
 ds_write_b128 v18, v[12:15] offset:4096
 buffer_load_dwordx4 a[236:239], v0, s[12:15], s24 offen offset:3072
 v_mfma_f32_16x16x32_bf16 v[160:163], a[196:199], a[180:183], v[160:163]
 ds_read_b128 v[48:51], v3 offset:4096
 ds_read_b128 v[80:83], v3 offset:5120
 v_mfma_f32_16x16x32_bf16 v[160:163], a[192:195], a[176:179], v[160:163]
 v_accvgpr_read_b32 v5, a8
 buffer_load_dwordx4 a[232:235], v0, s[12:15], s24 offen offset:2048
 v_mfma_f32_16x16x32_bf16 v[156:159], a[192:195], a[168:171], v[156:159]
 v_lshlrev_b32 v6, 16, v5
 v_and_b32 v5, s26, v5
 s_add_u32 s24, s24, 4096
 v_mfma_f32_16x16x32_bf16 v[156:159], a[196:199], a[172:175], v[156:159]
 v_mul_f32 v6, v6, v24
 v_mul_f32 v5, v5, v25
 v_mfma_f32_16x16x32_bf16 v[152:155], a[196:199], a[164:167], v[152:155]
 v_cvt_pk_bf16_f32 v8, v6, v5
 v_accvgpr_read_b32 v5, a9
 v_mfma_f32_16x16x32_bf16 v[152:155], a[192:195], a[160:163], v[152:155]
 v_lshlrev_b32 v6, 16, v5
 s_waitcnt lgkmcnt(3)
 v_mfma_f32_16x16x32_bf16 v[148:151], a[192:195], a[152:155], v[148:151]
 v_and_b32 v5, s26, v5
 v_mul_f32 v6, v6, v26
 v_mul_f32 v5, v5, v27
 v_mfma_f32_16x16x32_bf16 v[148:151], a[196:199], a[156:159], v[148:151]
 v_cvt_pk_bf16_f32 v9, v6, v5
 s_waitcnt lgkmcnt(1)
 v_mfma_f32_16x16x32_bf16 v[144:147], a[196:199], a[148:151], v[144:147]
 s_add_u32 s3, s28, 32768
 buffer_store_dwordx4 v[48:51], v16, s[16:19], s3 offen nt
 v_mfma_f32_16x16x32_bf16 v[144:147], a[192:195], a[144:147], v[144:147]
 s_waitcnt lgkmcnt(0)
 s_add_u32 s3, s28, 49152
 v_mfma_f32_16x16x32_bf16 v[140:143], a[192:195], a[136:139], v[140:143]
 buffer_store_dwordx4 v[80:83], v16, s[16:19], s3 offen nt
 v_accvgpr_read_b32 v5, a10
 v_lshlrev_b32 v6, 16, v5
 v_mfma_f32_16x16x32_bf16 v[140:143], a[196:199], a[140:143], v[140:143]
 v_and_b32 v5, s26, v5
 v_mul_f32 v6, v6, v56
 v_mfma_f32_16x16x32_bf16 v[136:139], a[196:199], a[132:135], v[136:139]
 v_mul_f32 v5, v5, v57
 buffer_load_dwordx4 a[196:199], v0, s[12:15], s24 offen offset:1024
 v_mfma_f32_16x16x32_bf16 v[136:139], a[192:195], a[128:131], v[136:139]
 v_cvt_pk_bf16_f32 v10, v6, v5
 v_accvgpr_read_b32 v5, a11
 s_waitcnt vmcnt(13)
 v_mfma_f32_16x16x32_bf16 v[168:171], a[200:203], a[128:131], v[168:171]
 v_lshlrev_b32 v6, 16, v5
 v_and_b32 v5, s26, v5
 v_mfma_f32_16x16x32_bf16 v[168:171], a[204:207], a[132:135], v[168:171]
 v_mul_f32 v6, v6, v58
 buffer_load_dwordx4 a[192:195], v0, s[12:15], s24 offen
 v_mfma_f32_16x16x32_bf16 v[172:175], a[204:207], a[140:143], v[172:175]
 v_mul_f32 v5, v5, v59
 v_cvt_pk_bf16_f32 v11, v6, v5
 v_mfma_f32_16x16x32_bf16 v[172:175], a[200:203], a[136:139], v[172:175]
 ds_write_b128 v17, v[8:11] offset:8192
 v_accvgpr_read_b32 v5, a40
 v_lshlrev_b32 v6, 16, v5
 v_mfma_f32_16x16x32_bf16 v[176:179], a[200:203], a[144:147], v[176:179]
 v_and_b32 v5, s26, v5
 v_mul_f32 v6, v6, v88
 v_mfma_f32_16x16x32_bf16 v[176:179], a[204:207], a[148:151], v[176:179]
 v_mul_f32 v5, v5, v89
 v_cvt_pk_bf16_f32 v12, v6, v5
 v_mfma_f32_16x16x32_bf16 v[180:183], a[204:207], a[156:159], v[180:183]
 v_accvgpr_read_b32 v5, a41
 v_lshlrev_b32 v6, 16, v5
 v_mfma_f32_16x16x32_bf16 v[180:183], a[200:203], a[152:155], v[180:183]
 v_and_b32 v5, s26, v5
 v_mul_f32 v6, v6, v90
 v_mul_f32 v5, v5, v91
 v_mfma_f32_16x16x32_bf16 v[184:187], a[200:203], a[160:163], v[184:187]
 v_cvt_pk_bf16_f32 v13, v6, v5
 v_accvgpr_read_b32 v5, a42
 v_mfma_f32_16x16x32_bf16 v[184:187], a[204:207], a[164:167], v[184:187]
 v_lshlrev_b32 v6, 16, v5
 v_and_b32 v5, s26, v5
 v_mfma_f32_16x16x32_bf16 v[188:191], a[204:207], a[172:175], v[188:191]
 v_mul_f32 v6, v6, v120
 v_mul_f32 v5, v5, v121
 v_mfma_f32_16x16x32_bf16 v[188:191], a[200:203], a[168:171], v[188:191]
 v_cvt_pk_bf16_f32 v14, v6, v5
 v_accvgpr_read_b32 v5, a43
 v_lshlrev_b32 v6, 16, v5
 v_mfma_f32_16x16x32_bf16 v[192:195], a[200:203], a[176:179], v[192:195]
 v_and_b32 v5, s26, v5
 v_mul_f32 v6, v6, v122
 v_mfma_f32_16x16x32_bf16 v[192:195], a[204:207], a[180:183], v[192:195]
 v_mul_f32 v5, v5, v123
 v_cvt_pk_bf16_f32 v15, v6, v5
 v_mfma_f32_16x16x32_bf16 v[196:199], a[204:207], a[188:191], v[196:199]
 ds_write_b128 v18, v[12:15] offset:8192
 buffer_load_dwordx4 a[204:207], v0, s[12:15], s24 offen offset:3072
 v_mfma_f32_16x16x32_bf16 v[196:199], a[200:203], a[184:187], v[196:199]
 ds_read_b128 v[48:51], v3 offset:8192
 ds_read_b128 v[80:83], v3 offset:9216
 s_waitcnt vmcnt(13)
 v_mfma_f32_16x16x32_bf16 v[228:231], a[208:211], a[184:187], v[228:231]
 v_accvgpr_read_b32 v5, a12
 v_lshlrev_b32 v6, 16, v5
 v_mfma_f32_16x16x32_bf16 v[228:231], a[212:215], a[188:191], v[228:231]
 v_and_b32 v5, s26, v5
 buffer_load_dwordx4 a[200:203], v0, s[12:15], s24 offen offset:2048
 v_mfma_f32_16x16x32_bf16 v[224:227], a[212:215], a[180:183], v[224:227]
 v_mul_f32 v6, v6, v28
 v_mul_f32 v5, v5, v29
 v_cvt_pk_bf16_f32 v8, v6, v5
 v_mfma_f32_16x16x32_bf16 v[224:227], a[208:211], a[176:179], v[224:227]
 v_accvgpr_read_b32 v5, a13
 s_add_u32 s24, s24, 4096
 v_mfma_f32_16x16x32_bf16 v[220:223], a[208:211], a[168:171], v[220:223]
 v_lshlrev_b32 v6, 16, v5
 v_and_b32 v5, s26, v5
 v_mfma_f32_16x16x32_bf16 v[220:223], a[212:215], a[172:175], v[220:223]
 v_mul_f32 v6, v6, v30
 v_mul_f32 v5, v5, v31
 v_mfma_f32_16x16x32_bf16 v[216:219], a[212:215], a[164:167], v[216:219]
 v_cvt_pk_bf16_f32 v9, v6, v5
 s_waitcnt lgkmcnt(1)
 s_add_u32 s3, s28, 65536
 v_mfma_f32_16x16x32_bf16 v[216:219], a[208:211], a[160:163], v[216:219]
 buffer_store_dwordx4 v[48:51], v16, s[16:19], s3 offen nt
 s_waitcnt lgkmcnt(0)
 v_mfma_f32_16x16x32_bf16 v[212:215], a[208:211], a[152:155], v[212:215]
 s_add_u32 s3, s28, 81920
 buffer_store_dwordx4 v[80:83], v16, s[16:19], s3 offen nt
 v_mfma_f32_16x16x32_bf16 v[212:215], a[212:215], a[156:159], v[212:215]
 v_accvgpr_read_b32 v5, a14
 v_lshlrev_b32 v6, 16, v5
 v_mfma_f32_16x16x32_bf16 v[208:211], a[212:215], a[148:151], v[208:211]
 v_and_b32 v5, s26, v5
 v_mul_f32 v6, v6, v60
 v_mul_f32 v5, v5, v61
 v_mfma_f32_16x16x32_bf16 v[208:211], a[208:211], a[144:147], v[208:211]
 v_cvt_pk_bf16_f32 v10, v6, v5
 v_accvgpr_read_b32 v5, a15
 v_mfma_f32_16x16x32_bf16 v[204:207], a[208:211], a[136:139], v[204:207]
 v_lshlrev_b32 v6, 16, v5
 v_and_b32 v5, s26, v5
 v_mfma_f32_16x16x32_bf16 v[204:207], a[212:215], a[140:143], v[204:207]
 v_mul_f32 v6, v6, v62
 v_mul_f32 v5, v5, v63
 v_mfma_f32_16x16x32_bf16 v[200:203], a[212:215], a[132:135], v[200:203]
 v_cvt_pk_bf16_f32 v11, v6, v5
 ds_write_b128 v17, v[8:11] offset:12288
 buffer_load_dwordx4 a[212:215], v0, s[12:15], s24 offen offset:1024
 v_mfma_f32_16x16x32_bf16 v[200:203], a[208:211], a[128:131], v[200:203]
 v_accvgpr_read_b32 v5, a44
 s_waitcnt vmcnt(15)
 v_mfma_f32_16x16x32_bf16 v[232:235], a[216:219], a[128:131], v[232:235]
 v_lshlrev_b32 v6, 16, v5
 ds_read_b128 a[128:131], v2 offset:2048
 v_mfma_f32_16x16x32_bf16 v[232:235], a[220:223], a[132:135], v[232:235]
 buffer_load_dwordx4 a[208:211], v0, s[12:15], s24 offen
 ds_read_b128 a[132:135], v2 offset:3072
 v_mfma_f32_16x16x32_bf16 v[236:239], a[220:223], a[140:143], v[236:239]
 v_and_b32 v5, s26, v5
 v_mul_f32 v6, v6, v92
 ds_read_b128 a[140:143], v2 offset:7168
 v_mfma_f32_16x16x32_bf16 v[236:239], a[216:219], a[136:139], v[236:239]
 v_mul_f32 v5, v5, v93
 ds_read_b128 a[136:139], v2 offset:6144
 v_mfma_f32_16x16x32_bf16 v[240:243], a[216:219], a[144:147], v[240:243]
 v_cvt_pk_bf16_f32 v12, v6, v5
 ds_read_b128 a[144:147], v2 offset:10240
 v_mfma_f32_16x16x32_bf16 v[240:243], a[220:223], a[148:151], v[240:243]
 v_accvgpr_read_b32 v5, a45
 v_lshlrev_b32 v6, 16, v5
 ds_read_b128 a[148:151], v2 offset:11264
 v_mfma_f32_16x16x32_bf16 v[244:247], a[220:223], a[156:159], v[244:247]
 v_and_b32 v5, s26, v5
 ds_read_b128 a[156:159], v2 offset:15360
 v_mfma_f32_16x16x32_bf16 v[244:247], a[216:219], a[152:155], v[244:247]
 v_mul_f32 v6, v6, v94
 ds_read_b128 a[152:155], v2 offset:14336
 v_mfma_f32_16x16x32_bf16 v[248:251], a[216:219], a[160:163], v[248:251]
 v_mul_f32 v5, v5, v95
 ds_read_b128 a[160:163], v2 offset:18432
 v_mfma_f32_16x16x32_bf16 v[248:251], a[220:223], a[164:167], v[248:251]
 v_cvt_pk_bf16_f32 v13, v6, v5
 v_accvgpr_read_b32 v5, a46
 ds_read_b128 a[164:167], v2 offset:19456
 v_mfma_f32_16x16x32_bf16 v[252:255], a[220:223], a[172:175], v[252:255]
 v_lshlrev_b32 v6, 16, v5
 ds_read_b128 a[172:175], v2 offset:23552
 v_mfma_f32_16x16x32_bf16 v[252:255], a[216:219], a[168:171], v[252:255]
 v_and_b32 v5, s26, v5
 ds_read_b128 a[168:171], v2 offset:22528
 v_mfma_f32_16x16x32_bf16 a[248:251], a[216:219], a[176:179], a[248:251]
 v_mul_f32 v6, v6, v124
 ds_read_b128 a[176:179], v2 offset:26624
 v_mfma_f32_16x16x32_bf16 a[248:251], a[220:223], a[180:183], a[248:251]
 v_mul_f32 v5, v5, v125
 v_cvt_pk_bf16_f32 v14, v6, v5
 ds_read_b128 a[180:183], v2 offset:27648
 v_mfma_f32_16x16x32_bf16 a[252:255], a[220:223], a[188:191], a[252:255]
 v_accvgpr_read_b32 v5, a47
 ds_read_b128 a[188:191], v2 offset:31744
 v_mfma_f32_16x16x32_bf16 a[252:255], a[216:219], a[184:187], a[252:255]
 ds_read_b128 a[184:187], v2 offset:30720
 s_waitcnt vmcnt(12) lgkmcnt(8)
 v_mfma_f32_16x16x32_bf16 v[136:139], a[224:227], a[128:131], v[136:139]
 v_lshlrev_b32 v6, 16, v5
 v_and_b32 v5, s26, v5
 v_mfma_f32_16x16x32_bf16 v[136:139], a[228:231], a[132:135], v[136:139]
 v_mul_f32 v6, v6, v126
 v_mul_f32 v5, v5, v127
 buffer_load_dwordx4 a[220:223], v0, s[12:15], s24 offen offset:3072
 v_mfma_f32_16x16x32_bf16 v[140:143], a[228:231], a[140:143], v[140:143]
 v_cvt_pk_bf16_f32 v15, v6, v5
 ds_write_b128 v18, v[12:15] offset:12288
 v_mfma_f32_16x16x32_bf16 v[140:143], a[224:227], a[136:139], v[140:143]
 ds_read_b128 v[48:51], v3 offset:12288
 buffer_load_dwordx4 a[216:219], v0, s[12:15], s24 offen offset:2048
 v_mfma_f32_16x16x32_bf16 v[144:147], a[224:227], a[144:147], v[144:147]
 ds_read_b128 v[80:83], v3 offset:13312
 s_add_u32 s24, s24, 4096
 v_mfma_f32_16x16x32_bf16 v[144:147], a[228:231], a[148:151], v[144:147]
 v_accvgpr_read_b32 v5, a16
 v_lshlrev_b32 v6, 16, v5
 v_and_b32 v5, s26, v5
 v_mfma_f32_16x16x32_bf16 v[148:151], a[228:231], a[156:159], v[148:151]
 v_mul_f32 v6, v6, v32
 v_mul_f32 v5, v5, v33
 v_mfma_f32_16x16x32_bf16 v[148:151], a[224:227], a[152:155], v[148:151]
 v_cvt_pk_bf16_f32 v8, v6, v5
 s_waitcnt lgkmcnt(3)
 v_mfma_f32_16x16x32_bf16 v[152:155], a[224:227], a[160:163], v[152:155]
 v_accvgpr_read_b32 v5, a17
 v_lshlrev_b32 v6, 16, v5
 v_mfma_f32_16x16x32_bf16 v[152:155], a[228:231], a[164:167], v[152:155]
 v_and_b32 v5, s26, v5
 v_mul_f32 v6, v6, v34
 v_mul_f32 v5, v5, v35
 v_mfma_f32_16x16x32_bf16 v[156:159], a[228:231], a[172:175], v[156:159]
 v_cvt_pk_bf16_f32 v9, v6, v5
 s_waitcnt lgkmcnt(1)
 v_mfma_f32_16x16x32_bf16 v[156:159], a[224:227], a[168:171], v[156:159]
 s_add_u32 s3, s28, 98304
 buffer_store_dwordx4 v[48:51], v16, s[16:19], s3 offen nt
 v_mfma_f32_16x16x32_bf16 v[160:163], a[224:227], a[176:179], v[160:163]
 s_waitcnt lgkmcnt(0)
 s_add_u32 s3, s28, 114688
 buffer_store_dwordx4 v[80:83], v16, s[16:19], s3 offen nt
 v_mfma_f32_16x16x32_bf16 v[160:163], a[228:231], a[180:183], v[160:163]
 v_accvgpr_read_b32 v5, a18
 v_lshlrev_b32 v6, 16, v5
 v_mfma_f32_16x16x32_bf16 v[164:167], a[228:231], a[188:191], v[164:167]
 v_and_b32 v5, s26, v5
 buffer_load_dwordx4 a[228:231], v0, s[12:15], s24 offen offset:1024
 v_mfma_f32_16x16x32_bf16 v[164:167], a[224:227], a[184:187], v[164:167]
 v_mul_f32 v6, v6, v64
 s_waitcnt vmcnt(15)
 v_mfma_f32_16x16x32_bf16 v[196:199], a[232:235], a[184:187], v[196:199]
 v_mul_f32 v5, v5, v65
 v_cvt_pk_bf16_f32 v10, v6, v5
 v_accvgpr_read_b32 v5, a19
 v_mfma_f32_16x16x32_bf16 v[196:199], a[236:239], a[188:191], v[196:199]
 v_lshlrev_b32 v6, 16, v5
 buffer_load_dwordx4 a[224:227], v0, s[12:15], s24 offen
 v_mfma_f32_16x16x32_bf16 v[192:195], a[236:239], a[180:183], v[192:195]
 v_and_b32 v5, s26, v5
 v_mul_f32 v6, v6, v66
 v_mfma_f32_16x16x32_bf16 v[192:195], a[232:235], a[176:179], v[192:195]
 v_mul_f32 v5, v5, v67
 v_cvt_pk_bf16_f32 v11, v6, v5
 v_mfma_f32_16x16x32_bf16 v[188:191], a[232:235], a[168:171], v[188:191]
 ds_write_b128 v17, v[8:11] offset:16384
 v_accvgpr_read_b32 v5, a48
 v_lshlrev_b32 v6, 16, v5
 v_mfma_f32_16x16x32_bf16 v[188:191], a[236:239], a[172:175], v[188:191]
 v_and_b32 v5, s26, v5
 v_mul_f32 v6, v6, v96
 v_mfma_f32_16x16x32_bf16 v[184:187], a[236:239], a[164:167], v[184:187]
 v_mul_f32 v5, v5, v97
 v_cvt_pk_bf16_f32 v12, v6, v5
 v_mfma_f32_16x16x32_bf16 v[184:187], a[232:235], a[160:163], v[184:187]
 v_accvgpr_read_b32 v5, a49
 v_lshlrev_b32 v6, 16, v5
 v_mfma_f32_16x16x32_bf16 v[180:183], a[232:235], a[152:155], v[180:183]
 v_and_b32 v5, s26, v5
 v_mul_f32 v6, v6, v98
 v_mul_f32 v5, v5, v99
 v_mfma_f32_16x16x32_bf16 v[180:183], a[236:239], a[156:159], v[180:183]
 v_cvt_pk_bf16_f32 v13, v6, v5
 v_accvgpr_read_b32 v5, a50
 v_mfma_f32_16x16x32_bf16 v[176:179], a[236:239], a[148:151], v[176:179]
 v_lshlrev_b32 v6, 16, v5
 v_and_b32 v5, s26, v5
 v_mfma_f32_16x16x32_bf16 v[176:179], a[232:235], a[144:147], v[176:179]
 v_mul_f32 v6, v6, v128
 v_mul_f32 v5, v5, v129
 v_mfma_f32_16x16x32_bf16 v[172:175], a[232:235], a[136:139], v[172:175]
 v_cvt_pk_bf16_f32 v14, v6, v5
 v_accvgpr_read_b32 v5, a51
 v_lshlrev_b32 v6, 16, v5
 v_mfma_f32_16x16x32_bf16 v[172:175], a[236:239], a[140:143], v[172:175]
 v_and_b32 v5, s26, v5
 v_mul_f32 v6, v6, v130
 v_mfma_f32_16x16x32_bf16 v[168:171], a[236:239], a[132:135], v[168:171]
 v_mul_f32 v5, v5, v131
 buffer_load_dwordx4 a[236:239], v0, s[12:15], s24 offen offset:3072
 v_mfma_f32_16x16x32_bf16 v[168:171], a[232:235], a[128:131], v[168:171]
 v_cvt_pk_bf16_f32 v15, v6, v5
 ds_write_b128 v18, v[12:15] offset:16384
 s_waitcnt vmcnt(13)
 v_mfma_f32_16x16x32_bf16 v[200:203], a[192:195], a[128:131], v[200:203]
 ds_read_b128 v[48:51], v3 offset:16384
 ds_read_b128 v[80:83], v3 offset:17408
 v_mfma_f32_16x16x32_bf16 v[200:203], a[196:199], a[132:135], v[200:203]
 v_accvgpr_read_b32 v5, a20
 buffer_load_dwordx4 a[232:235], v0, s[12:15], s24 offen offset:2048
 v_mfma_f32_16x16x32_bf16 v[204:207], a[196:199], a[140:143], v[204:207]
 v_lshlrev_b32 v6, 16, v5
 v_and_b32 v5, s26, v5
 v_mfma_f32_16x16x32_bf16 v[204:207], a[192:195], a[136:139], v[204:207]
 v_mul_f32 v6, v6, v36
 v_mul_f32 v5, v5, v37
 s_add_u32 s24, s24, 1839104
 v_mfma_f32_16x16x32_bf16 v[208:211], a[192:195], a[144:147], v[208:211]
 v_cvt_pk_bf16_f32 v8, v6, v5
 v_accvgpr_read_b32 v5, a21
 v_mfma_f32_16x16x32_bf16 v[208:211], a[196:199], a[148:151], v[208:211]
 v_lshlrev_b32 v6, 16, v5
 v_and_b32 v5, s26, v5
 v_mfma_f32_16x16x32_bf16 v[212:215], a[196:199], a[156:159], v[212:215]
 v_mul_f32 v6, v6, v38
 v_mul_f32 v5, v5, v39
 v_mfma_f32_16x16x32_bf16 v[212:215], a[192:195], a[152:155], v[212:215]
 v_cvt_pk_bf16_f32 v9, v6, v5
 s_waitcnt lgkmcnt(1)
 s_add_u32 s3, s28, 131072
 v_mfma_f32_16x16x32_bf16 v[216:219], a[192:195], a[160:163], v[216:219]
 buffer_store_dwordx4 v[48:51], v16, s[16:19], s3 offen nt
 s_waitcnt lgkmcnt(0)
 v_mfma_f32_16x16x32_bf16 v[216:219], a[196:199], a[164:167], v[216:219]
 s_add_u32 s3, s28, 147456
 buffer_store_dwordx4 v[80:83], v16, s[16:19], s3 offen nt
 v_mfma_f32_16x16x32_bf16 v[220:223], a[196:199], a[172:175], v[220:223]
 v_accvgpr_read_b32 v5, a22
 v_lshlrev_b32 v6, 16, v5
 v_mfma_f32_16x16x32_bf16 v[220:223], a[192:195], a[168:171], v[220:223]
 v_and_b32 v5, s26, v5
 v_mul_f32 v6, v6, v68
 v_mul_f32 v5, v5, v69
 v_mfma_f32_16x16x32_bf16 v[224:227], a[192:195], a[176:179], v[224:227]
 v_cvt_pk_bf16_f32 v10, v6, v5
 v_accvgpr_read_b32 v5, a23
 v_mfma_f32_16x16x32_bf16 v[224:227], a[196:199], a[180:183], v[224:227]
 v_lshlrev_b32 v6, 16, v5
 v_and_b32 v5, s26, v5
 v_mfma_f32_16x16x32_bf16 v[228:231], a[196:199], a[188:191], v[228:231]
 v_mul_f32 v6, v6, v70
 v_mul_f32 v5, v5, v71
 v_mfma_f32_16x16x32_bf16 v[228:231], a[192:195], a[184:187], v[228:231]
 v_cvt_pk_bf16_f32 v11, v6, v5
 ds_write_b128 v17, v[8:11] offset:20480
 s_waitcnt vmcnt(14)
 v_mfma_f32_16x16x32_bf16 a[252:255], a[200:203], a[184:187], a[252:255]
 v_accvgpr_read_b32 v5, a52
 ds_read_b128 a[184:187], v2 offset:63488
 v_mfma_f32_16x16x32_bf16 a[252:255], a[204:207], a[188:191], a[252:255]
 v_lshlrev_b32 v6, 16, v5
 ds_read_b128 a[188:191], v2 offset:64512
 v_mfma_f32_16x16x32_bf16 a[248:251], a[204:207], a[180:183], a[248:251]
 v_and_b32 v5, s26, v5
 v_mul_f32 v6, v6, v100
 ds_read_b128 a[180:183], v2 offset:60416
 v_mfma_f32_16x16x32_bf16 a[248:251], a[200:203], a[176:179], a[248:251]
 v_mul_f32 v5, v5, v101
 ds_read_b128 a[176:179], v2 offset:59392
 v_mfma_f32_16x16x32_bf16 v[252:255], a[200:203], a[168:171], v[252:255]
 v_cvt_pk_bf16_f32 v12, v6, v5
 ds_read_b128 a[168:171], v2 offset:55296
 v_mfma_f32_16x16x32_bf16 v[252:255], a[204:207], a[172:175], v[252:255]
 v_accvgpr_read_b32 v5, a53
 ds_read_b128 a[172:175], v2 offset:56320
 v_mfma_f32_16x16x32_bf16 v[248:251], a[204:207], a[164:167], v[248:251]
 v_lshlrev_b32 v6, 16, v5
 v_and_b32 v5, s26, v5
 ds_read_b128 a[164:167], v2 offset:52224
 v_mfma_f32_16x16x32_bf16 v[248:251], a[200:203], a[160:163], v[248:251]
 v_mul_f32 v6, v6, v102
 ds_read_b128 a[160:163], v2 offset:51200
 v_mfma_f32_16x16x32_bf16 v[244:247], a[200:203], a[152:155], v[244:247]
 v_mul_f32 v5, v5, v103
 ds_read_b128 a[152:155], v2 offset:47104
 v_mfma_f32_16x16x32_bf16 v[244:247], a[204:207], a[156:159], v[244:247]
 v_cvt_pk_bf16_f32 v13, v6, v5
 ds_read_b128 a[156:159], v2 offset:48128
 v_mfma_f32_16x16x32_bf16 v[240:243], a[204:207], a[148:151], v[240:243]
 v_accvgpr_read_b32 v5, a54
 v_lshlrev_b32 v6, 16, v5
 ds_read_b128 a[148:151], v2 offset:44032
 v_mfma_f32_16x16x32_bf16 v[240:243], a[200:203], a[144:147], v[240:243]
 v_and_b32 v5, s26, v5
 ds_read_b128 a[144:147], v2 offset:43008
 v_mfma_f32_16x16x32_bf16 v[236:239], a[200:203], a[136:139], v[236:239]
 v_mul_f32 v6, v6, v132
 ds_read_b128 a[136:139], v2 offset:38912
 v_mfma_f32_16x16x32_bf16 v[236:239], a[204:207], a[140:143], v[236:239]
 v_mul_f32 v5, v5, v133
 ds_read_b128 a[140:143], v2 offset:39936
 v_mfma_f32_16x16x32_bf16 v[232:235], a[204:207], a[132:135], v[232:235]
 v_cvt_pk_bf16_f32 v14, v6, v5
 v_accvgpr_read_b32 v5, a55
 ds_read_b128 a[132:135], v2 offset:35840
 v_mfma_f32_16x16x32_bf16 v[232:235], a[200:203], a[128:131], v[232:235]
 ds_read_b128 a[128:131], v2 offset:34816
 s_waitcnt vmcnt(10) lgkmcnt(8)
 v_mfma_f32_16x16x32_bf16 v[164:167], a[208:211], a[184:187], v[164:167]
 v_lshlrev_b32 v6, 16, v5
 v_and_b32 v5, s26, v5
 v_mfma_f32_16x16x32_bf16 v[164:167], a[212:215], a[188:191], v[164:167]
 v_mul_f32 v6, v6, v134
 v_mul_f32 v5, v5, v135
 v_mfma_f32_16x16x32_bf16 v[160:163], a[212:215], a[180:183], v[160:163]
 v_cvt_pk_bf16_f32 v15, v6, v5
 ds_write_b128 v18, v[12:15] offset:20480
 ds_read_b128 v[48:51], v3 offset:20480
 v_mfma_f32_16x16x32_bf16 v[160:163], a[208:211], a[176:179], v[160:163]
 ds_read_b128 v[80:83], v3 offset:21504
 v_accvgpr_read_b32 v5, a24
 v_mfma_f32_16x16x32_bf16 v[156:159], a[208:211], a[168:171], v[156:159]
 v_lshlrev_b32 v6, 16, v5
 v_and_b32 v5, s26, v5
 v_mfma_f32_16x16x32_bf16 v[156:159], a[212:215], a[172:175], v[156:159]
 v_mul_f32 v6, v6, v40
 v_mul_f32 v5, v5, v41
 v_cvt_pk_bf16_f32 v8, v6, v5
 v_mfma_f32_16x16x32_bf16 v[152:155], a[212:215], a[164:167], v[152:155]
 v_accvgpr_read_b32 v5, a25
 v_lshlrev_b32 v6, 16, v5
 v_mfma_f32_16x16x32_bf16 v[152:155], a[208:211], a[160:163], v[152:155]
 v_and_b32 v5, s26, v5
 s_waitcnt lgkmcnt(3)
 v_mfma_f32_16x16x32_bf16 v[148:151], a[208:211], a[152:155], v[148:151]
 v_mul_f32 v6, v6, v42
 v_mul_f32 v5, v5, v43
 v_mfma_f32_16x16x32_bf16 v[148:151], a[212:215], a[156:159], v[148:151]
 v_cvt_pk_bf16_f32 v9, v6, v5
 s_waitcnt lgkmcnt(1)
 s_add_u32 s3, s28, 163840
 v_mfma_f32_16x16x32_bf16 v[144:147], a[212:215], a[148:151], v[144:147]
 buffer_store_dwordx4 v[48:51], v16, s[16:19], s3 offen nt
 s_waitcnt lgkmcnt(0)
 v_mfma_f32_16x16x32_bf16 v[144:147], a[208:211], a[144:147], v[144:147]
 s_add_u32 s3, s28, 180224
 buffer_store_dwordx4 v[80:83], v16, s[16:19], s3 offen nt
 v_mfma_f32_16x16x32_bf16 v[140:143], a[208:211], a[136:139], v[140:143]
 v_accvgpr_read_b32 v5, a26
 v_lshlrev_b32 v6, 16, v5
 v_mfma_f32_16x16x32_bf16 v[140:143], a[212:215], a[140:143], v[140:143]
 v_and_b32 v5, s26, v5
 v_mul_f32 v6, v6, v72
 v_mul_f32 v5, v5, v73
 v_mfma_f32_16x16x32_bf16 v[136:139], a[212:215], a[132:135], v[136:139]
 v_cvt_pk_bf16_f32 v10, v6, v5
 v_accvgpr_read_b32 v5, a27
 v_mfma_f32_16x16x32_bf16 v[136:139], a[208:211], a[128:131], v[136:139]
 v_lshlrev_b32 v6, 16, v5
 s_waitcnt vmcnt(10)
 v_mfma_f32_16x16x32_bf16 v[168:171], a[216:219], a[128:131], v[168:171]
 v_and_b32 v5, s26, v5
 v_mul_f32 v6, v6, v74
 v_mfma_f32_16x16x32_bf16 v[168:171], a[220:223], a[132:135], v[168:171]
 v_mul_f32 v5, v5, v75
 v_cvt_pk_bf16_f32 v11, v6, v5
 ds_write_b128 v17, v[8:11] offset:24576
 v_mfma_f32_16x16x32_bf16 v[172:175], a[220:223], a[140:143], v[172:175]
 v_accvgpr_read_b32 v5, a56
 v_lshlrev_b32 v6, 16, v5
 v_mfma_f32_16x16x32_bf16 v[172:175], a[216:219], a[136:139], v[172:175]
 v_and_b32 v5, s26, v5
 v_mul_f32 v6, v6, v104
 v_mfma_f32_16x16x32_bf16 v[176:179], a[216:219], a[144:147], v[176:179]
 v_mul_f32 v5, v5, v105
 v_cvt_pk_bf16_f32 v12, v6, v5
 v_mfma_f32_16x16x32_bf16 v[176:179], a[220:223], a[148:151], v[176:179]
 v_accvgpr_read_b32 v5, a57
 v_lshlrev_b32 v6, 16, v5
 v_and_b32 v5, s26, v5
 v_mfma_f32_16x16x32_bf16 v[180:183], a[220:223], a[156:159], v[180:183]
 v_mul_f32 v6, v6, v106
 v_mul_f32 v5, v5, v107
 v_mfma_f32_16x16x32_bf16 v[180:183], a[216:219], a[152:155], v[180:183]
 v_cvt_pk_bf16_f32 v13, v6, v5
 v_accvgpr_read_b32 v5, a58
 v_mfma_f32_16x16x32_bf16 v[184:187], a[216:219], a[160:163], v[184:187]
 v_accvgpr_read_b32 v7, a240
 v_lshlrev_b32 v6, 16, v5
 v_and_b32 v5, s26, v5
 v_mfma_f32_16x16x32_bf16 v[184:187], a[220:223], a[164:167], v[184:187]
 v_mul_f32 v6, v6, v7
 v_accvgpr_read_b32 v7, a241
 v_mfma_f32_16x16x32_bf16 v[188:191], a[220:223], a[172:175], v[188:191]
 v_mul_f32 v5, v5, v7
 v_cvt_pk_bf16_f32 v14, v6, v5
 v_mfma_f32_16x16x32_bf16 v[188:191], a[216:219], a[168:171], v[188:191]
 v_accvgpr_read_b32 v5, a59
 v_accvgpr_read_b32 v7, a242
 v_mfma_f32_16x16x32_bf16 v[192:195], a[216:219], a[176:179], v[192:195]
 v_lshlrev_b32 v6, 16, v5
 v_and_b32 v5, s26, v5
 v_mul_f32 v6, v6, v7
 v_mfma_f32_16x16x32_bf16 v[192:195], a[220:223], a[180:183], v[192:195]
 v_accvgpr_read_b32 v7, a243
 v_mul_f32 v5, v5, v7
 v_mfma_f32_16x16x32_bf16 v[196:199], a[220:223], a[188:191], v[196:199]
 v_cvt_pk_bf16_f32 v15, v6, v5
 ds_write_b128 v18, v[12:15] offset:24576
 v_mfma_f32_16x16x32_bf16 v[196:199], a[216:219], a[184:187], v[196:199]
 ds_read_b128 v[48:51], v3 offset:24576
 s_waitcnt vmcnt(6)
 v_mfma_f32_16x16x32_bf16 v[228:231], a[224:227], a[184:187], v[228:231]
 ds_read_b128 v[80:83], v3 offset:25600
 v_accvgpr_read_b32 v5, a28
 v_lshlrev_b32 v6, 16, v5
 v_mfma_f32_16x16x32_bf16 v[228:231], a[228:231], a[188:191], v[228:231]
 v_and_b32 v5, s26, v5
 v_mul_f32 v6, v6, v44
 v_mfma_f32_16x16x32_bf16 v[224:227], a[228:231], a[180:183], v[224:227]
 v_mul_f32 v5, v5, v45
 v_cvt_pk_bf16_f32 v8, v6, v5
 v_mfma_f32_16x16x32_bf16 v[224:227], a[224:227], a[176:179], v[224:227]
 v_accvgpr_read_b32 v5, a29
 v_lshlrev_b32 v6, 16, v5
 v_mfma_f32_16x16x32_bf16 v[220:223], a[224:227], a[168:171], v[220:223]
 v_and_b32 v5, s26, v5
 v_mul_f32 v6, v6, v46
 v_mul_f32 v5, v5, v47
 v_mfma_f32_16x16x32_bf16 v[220:223], a[228:231], a[172:175], v[220:223]
 v_cvt_pk_bf16_f32 v9, v6, v5
 s_waitcnt lgkmcnt(1)
 v_mfma_f32_16x16x32_bf16 v[216:219], a[228:231], a[164:167], v[216:219]
 s_add_u32 s3, s28, 196608
 buffer_store_dwordx4 v[48:51], v16, s[16:19], s3 offen nt
 v_mfma_f32_16x16x32_bf16 v[216:219], a[224:227], a[160:163], v[216:219]
 s_waitcnt lgkmcnt(0)
 s_add_u32 s3, s28, 212992
 v_mfma_f32_16x16x32_bf16 v[212:215], a[224:227], a[152:155], v[212:215]
 buffer_store_dwordx4 v[80:83], v16, s[16:19], s3 offen nt
 v_accvgpr_read_b32 v5, a30
 v_lshlrev_b32 v6, 16, v5
 v_mfma_f32_16x16x32_bf16 v[212:215], a[228:231], a[156:159], v[212:215]
 v_and_b32 v5, s26, v5
 v_mul_f32 v6, v6, v76
 v_mfma_f32_16x16x32_bf16 v[208:211], a[228:231], a[148:151], v[208:211]
 v_mul_f32 v5, v5, v77
 v_cvt_pk_bf16_f32 v10, v6, v5
 v_mfma_f32_16x16x32_bf16 v[208:211], a[224:227], a[144:147], v[208:211]
 v_accvgpr_read_b32 v5, a31
 v_lshlrev_b32 v6, 16, v5
 v_and_b32 v5, s26, v5
 v_mfma_f32_16x16x32_bf16 v[204:207], a[224:227], a[136:139], v[204:207]
 v_mul_f32 v6, v6, v78
 v_mul_f32 v5, v5, v79
 v_mfma_f32_16x16x32_bf16 v[204:207], a[228:231], a[140:143], v[204:207]
 v_cvt_pk_bf16_f32 v11, v6, v5
 ds_write_b128 v17, v[8:11] offset:28672
 v_mfma_f32_16x16x32_bf16 v[200:203], a[228:231], a[132:135], v[200:203]
 v_accvgpr_read_b32 v5, a60
 v_lshlrev_b32 v6, 16, v5
 v_mfma_f32_16x16x32_bf16 v[200:203], a[224:227], a[128:131], v[200:203]
 v_and_b32 v5, s26, v5
 v_mul_f32 v6, v6, v108
 s_waitcnt vmcnt(6)
 v_mfma_f32_16x16x32_bf16 v[232:235], a[232:235], a[128:131], v[232:235]
 v_mul_f32 v5, v5, v109
 v_cvt_pk_bf16_f32 v12, v6, v5
 v_mfma_f32_16x16x32_bf16 v[232:235], a[236:239], a[132:135], v[232:235]
 v_accvgpr_read_b32 v5, a61
 v_lshlrev_b32 v6, 16, v5
 v_mfma_f32_16x16x32_bf16 v[236:239], a[236:239], a[140:143], v[236:239]
 v_and_b32 v5, s26, v5
 v_mul_f32 v6, v6, v110
 v_mfma_f32_16x16x32_bf16 v[236:239], a[232:235], a[136:139], v[236:239]
 v_mul_f32 v5, v5, v111
 v_cvt_pk_bf16_f32 v13, v6, v5
 v_accvgpr_read_b32 v5, a62
 v_mfma_f32_16x16x32_bf16 v[240:243], a[232:235], a[144:147], v[240:243]
 v_accvgpr_read_b32 v7, a244
 v_lshlrev_b32 v6, 16, v5
 v_mfma_f32_16x16x32_bf16 v[240:243], a[236:239], a[148:151], v[240:243]
 v_and_b32 v5, s26, v5
 v_mul_f32 v6, v6, v7
 v_mfma_f32_16x16x32_bf16 v[244:247], a[236:239], a[156:159], v[244:247]
 v_accvgpr_read_b32 v7, a245
 v_mul_f32 v5, v5, v7
 v_mfma_f32_16x16x32_bf16 v[244:247], a[232:235], a[152:155], v[244:247]
 v_cvt_pk_bf16_f32 v14, v6, v5
 v_accvgpr_read_b32 v5, a63
 v_accvgpr_read_b32 v7, a246
 v_mfma_f32_16x16x32_bf16 v[248:251], a[232:235], a[160:163], v[248:251]
 v_lshlrev_b32 v6, 16, v5
 v_and_b32 v5, s26, v5
 v_mfma_f32_16x16x32_bf16 v[248:251], a[236:239], a[164:167], v[248:251]
 v_mul_f32 v6, v6, v7
 v_accvgpr_read_b32 v7, a247
 v_mfma_f32_16x16x32_bf16 v[252:255], a[236:239], a[172:175], v[252:255]
 v_mul_f32 v5, v5, v7
 v_cvt_pk_bf16_f32 v15, v6, v5
 v_mfma_f32_16x16x32_bf16 v[252:255], a[232:235], a[168:171], v[252:255]
 ds_write_b128 v18, v[12:15] offset:28672
 ds_read_b128 v[48:51], v3 offset:28672
 ds_read_b128 v[80:83], v3 offset:29696
 v_mfma_f32_16x16x32_bf16 a[248:251], a[232:235], a[176:179], a[248:251]
 s_waitcnt lgkmcnt(1)
 s_add_u32 s3, s28, 229376
 v_mfma_f32_16x16x32_bf16 a[248:251], a[236:239], a[180:183], a[248:251]
 buffer_store_dwordx4 v[48:51], v16, s[16:19], s3 offen nt
 s_waitcnt lgkmcnt(0)
 v_mfma_f32_16x16x32_bf16 a[252:255], a[236:239], a[188:191], a[252:255]
 s_add_u32 s3, s28, 245760
 buffer_store_dwordx4 v[80:83], v16, s[16:19], s3 offen nt
 v_mfma_f32_16x16x32_bf16 a[252:255], a[232:235], a[184:187], a[252:255]
 s_nop 7
 v_accvgpr_read_b32 v5, a64
 v_lshlrev_b32 v6, 16, v5
 v_and_b32 v5, s26, v5
 v_mul_f32 v6, v6, v136
 v_mul_f32 v5, v5, v137
 v_cvt_pk_bf16_f32 v8, v6, v5
 v_accvgpr_read_b32 v5, a65
 v_lshlrev_b32 v6, 16, v5
 v_and_b32 v5, s26, v5
 v_mul_f32 v6, v6, v138
 v_mul_f32 v5, v5, v139
 v_cvt_pk_bf16_f32 v9, v6, v5
 v_accvgpr_read_b32 v5, a66
 v_lshlrev_b32 v6, 16, v5
 v_and_b32 v5, s26, v5
 v_mul_f32 v6, v6, v168
 v_mul_f32 v5, v5, v169
 v_cvt_pk_bf16_f32 v10, v6, v5
 v_accvgpr_read_b32 v5, a67
 v_lshlrev_b32 v6, 16, v5
 v_and_b32 v5, s26, v5
 v_mul_f32 v6, v6, v170
 v_mul_f32 v5, v5, v171
 v_cvt_pk_bf16_f32 v11, v6, v5
 ds_write_b128 v17, v[8:11]
 v_accvgpr_read_b32 v5, a96
 v_lshlrev_b32 v6, 16, v5
 v_and_b32 v5, s26, v5
 v_mul_f32 v6, v6, v200
 v_mul_f32 v5, v5, v201
 v_cvt_pk_bf16_f32 v12, v6, v5
 v_accvgpr_read_b32 v5, a97
 v_lshlrev_b32 v6, 16, v5
 v_and_b32 v5, s26, v5
 v_mul_f32 v6, v6, v202
 v_mul_f32 v5, v5, v203
 v_cvt_pk_bf16_f32 v13, v6, v5
 v_accvgpr_read_b32 v5, a98
 v_lshlrev_b32 v6, 16, v5
 v_and_b32 v5, s26, v5
 v_mul_f32 v6, v6, v232
 v_mul_f32 v5, v5, v233
 v_cvt_pk_bf16_f32 v14, v6, v5
 v_accvgpr_read_b32 v5, a99
 v_lshlrev_b32 v6, 16, v5
 v_and_b32 v5, s26, v5
 v_mul_f32 v6, v6, v234
 v_mul_f32 v5, v5, v235
 v_cvt_pk_bf16_f32 v15, v6, v5
 ds_write_b128 v18, v[12:15]
 ds_read_b128 v[48:51], v3
 ds_read_b128 v[80:83], v3 offset:1024
 v_accvgpr_read_b32 v5, a68
 v_lshlrev_b32 v6, 16, v5
 v_and_b32 v5, s26, v5
 v_mul_f32 v6, v6, v140
 v_mul_f32 v5, v5, v141
 v_cvt_pk_bf16_f32 v8, v6, v5
 v_accvgpr_read_b32 v5, a69
 v_lshlrev_b32 v6, 16, v5
 v_and_b32 v5, s26, v5
 v_mul_f32 v6, v6, v142
 v_mul_f32 v5, v5, v143
 v_cvt_pk_bf16_f32 v9, v6, v5
 s_waitcnt lgkmcnt(1)
 s_add_u32 s3, s28, 0
 buffer_store_dwordx4 v[48:51], v16, s[16:19], s3 offen offset:128 nt
 s_waitcnt lgkmcnt(0)
 s_add_u32 s3, s28, 16384
 buffer_store_dwordx4 v[80:83], v16, s[16:19], s3 offen offset:128 nt
 v_accvgpr_read_b32 v5, a70
 v_lshlrev_b32 v6, 16, v5
 v_and_b32 v5, s26, v5
 v_mul_f32 v6, v6, v172
 v_mul_f32 v5, v5, v173
 v_cvt_pk_bf16_f32 v10, v6, v5
 v_accvgpr_read_b32 v5, a71
 v_lshlrev_b32 v6, 16, v5
 v_and_b32 v5, s26, v5
 v_mul_f32 v6, v6, v174
 v_mul_f32 v5, v5, v175
 v_cvt_pk_bf16_f32 v11, v6, v5
 ds_write_b128 v17, v[8:11] offset:4096
 v_accvgpr_read_b32 v5, a100
 v_lshlrev_b32 v6, 16, v5
 v_and_b32 v5, s26, v5
 v_mul_f32 v6, v6, v204
 v_mul_f32 v5, v5, v205
 v_cvt_pk_bf16_f32 v12, v6, v5
 v_accvgpr_read_b32 v5, a101
 v_lshlrev_b32 v6, 16, v5
 v_and_b32 v5, s26, v5
 v_mul_f32 v6, v6, v206
 v_mul_f32 v5, v5, v207
 v_cvt_pk_bf16_f32 v13, v6, v5
 v_accvgpr_read_b32 v5, a102
 v_lshlrev_b32 v6, 16, v5
 v_and_b32 v5, s26, v5
 v_mul_f32 v6, v6, v236
 v_mul_f32 v5, v5, v237
 v_cvt_pk_bf16_f32 v14, v6, v5
 v_accvgpr_read_b32 v5, a103
 v_lshlrev_b32 v6, 16, v5
 v_and_b32 v5, s26, v5
 v_mul_f32 v6, v6, v238
 v_mul_f32 v5, v5, v239
 v_cvt_pk_bf16_f32 v15, v6, v5
 ds_write_b128 v18, v[12:15] offset:4096
 ds_read_b128 v[48:51], v3 offset:4096
 ds_read_b128 v[80:83], v3 offset:5120
 v_accvgpr_read_b32 v5, a72
 v_lshlrev_b32 v6, 16, v5
 v_and_b32 v5, s26, v5
 v_mul_f32 v6, v6, v144
 v_mul_f32 v5, v5, v145
 v_cvt_pk_bf16_f32 v8, v6, v5
 v_accvgpr_read_b32 v5, a73
 v_lshlrev_b32 v6, 16, v5
 v_and_b32 v5, s26, v5
 v_mul_f32 v6, v6, v146
 v_mul_f32 v5, v5, v147
 v_cvt_pk_bf16_f32 v9, v6, v5
 s_waitcnt lgkmcnt(1)
 s_add_u32 s3, s28, 32768
 buffer_store_dwordx4 v[48:51], v16, s[16:19], s3 offen offset:128 nt
 s_waitcnt lgkmcnt(0)
 s_add_u32 s3, s28, 49152
 buffer_store_dwordx4 v[80:83], v16, s[16:19], s3 offen offset:128 nt
 v_accvgpr_read_b32 v5, a74
 v_lshlrev_b32 v6, 16, v5
 v_and_b32 v5, s26, v5
 v_mul_f32 v6, v6, v176
 v_mul_f32 v5, v5, v177
 v_cvt_pk_bf16_f32 v10, v6, v5
 v_accvgpr_read_b32 v5, a75
 v_lshlrev_b32 v6, 16, v5
 v_and_b32 v5, s26, v5
 v_mul_f32 v6, v6, v178
 v_mul_f32 v5, v5, v179
 v_cvt_pk_bf16_f32 v11, v6, v5
 ds_write_b128 v17, v[8:11] offset:8192
 v_accvgpr_read_b32 v5, a104
 v_lshlrev_b32 v6, 16, v5
 v_and_b32 v5, s26, v5
 v_mul_f32 v6, v6, v208
 v_mul_f32 v5, v5, v209
 v_cvt_pk_bf16_f32 v12, v6, v5
 v_accvgpr_read_b32 v5, a105
 v_lshlrev_b32 v6, 16, v5
 v_and_b32 v5, s26, v5
 v_mul_f32 v6, v6, v210
 v_mul_f32 v5, v5, v211
 v_cvt_pk_bf16_f32 v13, v6, v5
 v_accvgpr_read_b32 v5, a106
 v_lshlrev_b32 v6, 16, v5
 v_and_b32 v5, s26, v5
 v_mul_f32 v6, v6, v240
 v_mul_f32 v5, v5, v241
 v_cvt_pk_bf16_f32 v14, v6, v5
 v_accvgpr_read_b32 v5, a107
 v_lshlrev_b32 v6, 16, v5
 v_and_b32 v5, s26, v5
 v_mul_f32 v6, v6, v242
 v_mul_f32 v5, v5, v243
 v_cvt_pk_bf16_f32 v15, v6, v5
 ds_write_b128 v18, v[12:15] offset:8192
 ds_read_b128 v[48:51], v3 offset:8192
 ds_read_b128 v[80:83], v3 offset:9216
 v_accvgpr_read_b32 v5, a76
 v_lshlrev_b32 v6, 16, v5
 v_and_b32 v5, s26, v5
 v_mul_f32 v6, v6, v148
 v_mul_f32 v5, v5, v149
 v_cvt_pk_bf16_f32 v8, v6, v5
 v_accvgpr_read_b32 v5, a77
 v_lshlrev_b32 v6, 16, v5
 v_and_b32 v5, s26, v5
 v_mul_f32 v6, v6, v150
 v_mul_f32 v5, v5, v151
 v_cvt_pk_bf16_f32 v9, v6, v5
 s_waitcnt lgkmcnt(1)
 s_add_u32 s3, s28, 65536
 buffer_store_dwordx4 v[48:51], v16, s[16:19], s3 offen offset:128 nt
 s_waitcnt lgkmcnt(0)
 s_add_u32 s3, s28, 81920
 buffer_store_dwordx4 v[80:83], v16, s[16:19], s3 offen offset:128 nt
 v_accvgpr_read_b32 v5, a78
 v_lshlrev_b32 v6, 16, v5
 v_and_b32 v5, s26, v5
 v_mul_f32 v6, v6, v180
 v_mul_f32 v5, v5, v181
 v_cvt_pk_bf16_f32 v10, v6, v5
 v_accvgpr_read_b32 v5, a79
 v_lshlrev_b32 v6, 16, v5
 v_and_b32 v5, s26, v5
 v_mul_f32 v6, v6, v182
 v_mul_f32 v5, v5, v183
 v_cvt_pk_bf16_f32 v11, v6, v5
 ds_write_b128 v17, v[8:11] offset:12288
 v_accvgpr_read_b32 v5, a108
 v_lshlrev_b32 v6, 16, v5
 v_and_b32 v5, s26, v5
 v_mul_f32 v6, v6, v212
 v_mul_f32 v5, v5, v213
 v_cvt_pk_bf16_f32 v12, v6, v5
 v_accvgpr_read_b32 v5, a109
 v_lshlrev_b32 v6, 16, v5
 v_and_b32 v5, s26, v5
 v_mul_f32 v6, v6, v214
 v_mul_f32 v5, v5, v215
 v_cvt_pk_bf16_f32 v13, v6, v5
 v_accvgpr_read_b32 v5, a110
 v_lshlrev_b32 v6, 16, v5
 v_and_b32 v5, s26, v5
 v_mul_f32 v6, v6, v244
 v_mul_f32 v5, v5, v245
 v_cvt_pk_bf16_f32 v14, v6, v5
 v_accvgpr_read_b32 v5, a111
 v_lshlrev_b32 v6, 16, v5
 v_and_b32 v5, s26, v5
 v_mul_f32 v6, v6, v246
 v_mul_f32 v5, v5, v247
 v_cvt_pk_bf16_f32 v15, v6, v5
 ds_write_b128 v18, v[12:15] offset:12288
 ds_read_b128 v[48:51], v3 offset:12288
 ds_read_b128 v[80:83], v3 offset:13312
 v_accvgpr_read_b32 v5, a80
 v_lshlrev_b32 v6, 16, v5
 v_and_b32 v5, s26, v5
 v_mul_f32 v6, v6, v152
 v_mul_f32 v5, v5, v153
 v_cvt_pk_bf16_f32 v8, v6, v5
 v_accvgpr_read_b32 v5, a81
 v_lshlrev_b32 v6, 16, v5
 v_and_b32 v5, s26, v5
 v_mul_f32 v6, v6, v154
 v_mul_f32 v5, v5, v155
 v_cvt_pk_bf16_f32 v9, v6, v5
 s_waitcnt lgkmcnt(1)
 s_add_u32 s3, s28, 98304
 buffer_store_dwordx4 v[48:51], v16, s[16:19], s3 offen offset:128 nt
 s_waitcnt lgkmcnt(0)
 s_add_u32 s3, s28, 114688
 buffer_store_dwordx4 v[80:83], v16, s[16:19], s3 offen offset:128 nt
 v_accvgpr_read_b32 v5, a82
 v_lshlrev_b32 v6, 16, v5
 v_and_b32 v5, s26, v5
 v_mul_f32 v6, v6, v184
 v_mul_f32 v5, v5, v185
 v_cvt_pk_bf16_f32 v10, v6, v5
 v_accvgpr_read_b32 v5, a83
 v_lshlrev_b32 v6, 16, v5
 v_and_b32 v5, s26, v5
 v_mul_f32 v6, v6, v186
 v_mul_f32 v5, v5, v187
 v_cvt_pk_bf16_f32 v11, v6, v5
 ds_write_b128 v17, v[8:11] offset:16384
 v_accvgpr_read_b32 v5, a112
 v_lshlrev_b32 v6, 16, v5
 v_and_b32 v5, s26, v5
 v_mul_f32 v6, v6, v216
 v_mul_f32 v5, v5, v217
 v_cvt_pk_bf16_f32 v12, v6, v5
 v_accvgpr_read_b32 v5, a113
 v_lshlrev_b32 v6, 16, v5
 v_and_b32 v5, s26, v5
 v_mul_f32 v6, v6, v218
 v_mul_f32 v5, v5, v219
 v_cvt_pk_bf16_f32 v13, v6, v5
 v_accvgpr_read_b32 v5, a114
 v_lshlrev_b32 v6, 16, v5
 v_and_b32 v5, s26, v5
 v_mul_f32 v6, v6, v248
 v_mul_f32 v5, v5, v249
 v_cvt_pk_bf16_f32 v14, v6, v5
 v_accvgpr_read_b32 v5, a115
 v_lshlrev_b32 v6, 16, v5
 v_and_b32 v5, s26, v5
 v_mul_f32 v6, v6, v250
 v_mul_f32 v5, v5, v251
 v_cvt_pk_bf16_f32 v15, v6, v5
 ds_write_b128 v18, v[12:15] offset:16384
 ds_read_b128 v[48:51], v3 offset:16384
 ds_read_b128 v[80:83], v3 offset:17408
 v_accvgpr_read_b32 v5, a84
 v_lshlrev_b32 v6, 16, v5
 v_and_b32 v5, s26, v5
 v_mul_f32 v6, v6, v156
 v_mul_f32 v5, v5, v157
 v_cvt_pk_bf16_f32 v8, v6, v5
 v_accvgpr_read_b32 v5, a85
 v_lshlrev_b32 v6, 16, v5
 v_and_b32 v5, s26, v5
 v_mul_f32 v6, v6, v158
 v_mul_f32 v5, v5, v159
 v_cvt_pk_bf16_f32 v9, v6, v5
 s_waitcnt lgkmcnt(1)
 s_add_u32 s3, s28, 131072
 buffer_store_dwordx4 v[48:51], v16, s[16:19], s3 offen offset:128 nt
 s_waitcnt lgkmcnt(0)
 s_add_u32 s3, s28, 147456
 buffer_store_dwordx4 v[80:83], v16, s[16:19], s3 offen offset:128 nt
 v_accvgpr_read_b32 v5, a86
 v_lshlrev_b32 v6, 16, v5
 v_and_b32 v5, s26, v5
 v_mul_f32 v6, v6, v188
 v_mul_f32 v5, v5, v189
 v_cvt_pk_bf16_f32 v10, v6, v5
 v_accvgpr_read_b32 v5, a87
 v_lshlrev_b32 v6, 16, v5
 v_and_b32 v5, s26, v5
 v_mul_f32 v6, v6, v190
 v_mul_f32 v5, v5, v191
 v_cvt_pk_bf16_f32 v11, v6, v5
 ds_write_b128 v17, v[8:11] offset:20480
 v_accvgpr_read_b32 v5, a116
 v_lshlrev_b32 v6, 16, v5
 v_and_b32 v5, s26, v5
 v_mul_f32 v6, v6, v220
 v_mul_f32 v5, v5, v221
 v_cvt_pk_bf16_f32 v12, v6, v5
 v_accvgpr_read_b32 v5, a117
 v_lshlrev_b32 v6, 16, v5
 v_and_b32 v5, s26, v5
 v_mul_f32 v6, v6, v222
 v_mul_f32 v5, v5, v223
 v_cvt_pk_bf16_f32 v13, v6, v5
 v_accvgpr_read_b32 v5, a118
 v_lshlrev_b32 v6, 16, v5
 v_and_b32 v5, s26, v5
 v_mul_f32 v6, v6, v252
 v_mul_f32 v5, v5, v253
 v_cvt_pk_bf16_f32 v14, v6, v5
 v_accvgpr_read_b32 v5, a119
 v_lshlrev_b32 v6, 16, v5
 v_and_b32 v5, s26, v5
 v_mul_f32 v6, v6, v254
 v_mul_f32 v5, v5, v255
 v_cvt_pk_bf16_f32 v15, v6, v5
 ds_write_b128 v18, v[12:15] offset:20480
 ds_read_b128 v[48:51], v3 offset:20480
 ds_read_b128 v[80:83], v3 offset:21504
 v_accvgpr_read_b32 v5, a88
 v_lshlrev_b32 v6, 16, v5
 v_and_b32 v5, s26, v5
 v_mul_f32 v6, v6, v160
 v_mul_f32 v5, v5, v161
 v_cvt_pk_bf16_f32 v8, v6, v5
 v_accvgpr_read_b32 v5, a89
 v_lshlrev_b32 v6, 16, v5
 v_and_b32 v5, s26, v5
 v_mul_f32 v6, v6, v162
 v_mul_f32 v5, v5, v163
 v_cvt_pk_bf16_f32 v9, v6, v5
 s_waitcnt lgkmcnt(1)
 s_add_u32 s3, s28, 163840
 buffer_store_dwordx4 v[48:51], v16, s[16:19], s3 offen offset:128 nt
 s_waitcnt lgkmcnt(0)
 s_add_u32 s3, s28, 180224
 buffer_store_dwordx4 v[80:83], v16, s[16:19], s3 offen offset:128 nt
 v_accvgpr_read_b32 v5, a90
 v_lshlrev_b32 v6, 16, v5
 v_and_b32 v5, s26, v5
 v_mul_f32 v6, v6, v192
 v_mul_f32 v5, v5, v193
 v_cvt_pk_bf16_f32 v10, v6, v5
 v_accvgpr_read_b32 v5, a91
 v_lshlrev_b32 v6, 16, v5
 v_and_b32 v5, s26, v5
 v_mul_f32 v6, v6, v194
 v_mul_f32 v5, v5, v195
 v_cvt_pk_bf16_f32 v11, v6, v5
 ds_write_b128 v17, v[8:11] offset:24576
 v_accvgpr_read_b32 v5, a120
 v_lshlrev_b32 v6, 16, v5
 v_and_b32 v5, s26, v5
 v_mul_f32 v6, v6, v224
 v_mul_f32 v5, v5, v225
 v_cvt_pk_bf16_f32 v12, v6, v5
 v_accvgpr_read_b32 v5, a121
 v_lshlrev_b32 v6, 16, v5
 v_and_b32 v5, s26, v5
 v_mul_f32 v6, v6, v226
 v_mul_f32 v5, v5, v227
 v_cvt_pk_bf16_f32 v13, v6, v5
 v_accvgpr_read_b32 v5, a122
 v_accvgpr_read_b32 v7, a248
 v_lshlrev_b32 v6, 16, v5
 v_and_b32 v5, s26, v5
 v_mul_f32 v6, v6, v7
 v_accvgpr_read_b32 v7, a249
 v_mul_f32 v5, v5, v7
 v_cvt_pk_bf16_f32 v14, v6, v5
 v_accvgpr_read_b32 v5, a123
 v_accvgpr_read_b32 v7, a250
 v_lshlrev_b32 v6, 16, v5
 v_and_b32 v5, s26, v5
 v_mul_f32 v6, v6, v7
 v_accvgpr_read_b32 v7, a251
 v_mul_f32 v5, v5, v7
 v_cvt_pk_bf16_f32 v15, v6, v5
 ds_write_b128 v18, v[12:15] offset:24576
 ds_read_b128 v[48:51], v3 offset:24576
 ds_read_b128 v[80:83], v3 offset:25600
 v_accvgpr_read_b32 v5, a92
 v_lshlrev_b32 v6, 16, v5
 v_and_b32 v5, s26, v5
 v_mul_f32 v6, v6, v164
 v_mul_f32 v5, v5, v165
 v_cvt_pk_bf16_f32 v8, v6, v5
 v_accvgpr_read_b32 v5, a93
 v_lshlrev_b32 v6, 16, v5
 v_and_b32 v5, s26, v5
 v_mul_f32 v6, v6, v166
 v_mul_f32 v5, v5, v167
 v_cvt_pk_bf16_f32 v9, v6, v5
 s_waitcnt lgkmcnt(1)
 s_add_u32 s3, s28, 196608
 buffer_store_dwordx4 v[48:51], v16, s[16:19], s3 offen offset:128 nt
 s_waitcnt lgkmcnt(0)
 s_add_u32 s3, s28, 212992
 buffer_store_dwordx4 v[80:83], v16, s[16:19], s3 offen offset:128 nt
 v_accvgpr_read_b32 v5, a94
 v_lshlrev_b32 v6, 16, v5
 v_and_b32 v5, s26, v5
 v_mul_f32 v6, v6, v196
 v_mul_f32 v5, v5, v197
 v_cvt_pk_bf16_f32 v10, v6, v5
 v_accvgpr_read_b32 v5, a95
 v_lshlrev_b32 v6, 16, v5
 v_and_b32 v5, s26, v5
 v_mul_f32 v6, v6, v198
 v_mul_f32 v5, v5, v199
 v_cvt_pk_bf16_f32 v11, v6, v5
 ds_write_b128 v17, v[8:11] offset:28672
 v_accvgpr_read_b32 v5, a124
 v_lshlrev_b32 v6, 16, v5
 v_and_b32 v5, s26, v5
 v_mul_f32 v6, v6, v228
 v_mul_f32 v5, v5, v229
 v_cvt_pk_bf16_f32 v12, v6, v5
 v_accvgpr_read_b32 v5, a125
 v_lshlrev_b32 v6, 16, v5
 v_and_b32 v5, s26, v5
 v_mul_f32 v6, v6, v230
 v_mul_f32 v5, v5, v231
 v_cvt_pk_bf16_f32 v13, v6, v5
 v_accvgpr_read_b32 v5, a126
 v_accvgpr_read_b32 v7, a252
 v_lshlrev_b32 v6, 16, v5
 v_and_b32 v5, s26, v5
 v_mul_f32 v6, v6, v7
 v_accvgpr_read_b32 v7, a253
 v_mul_f32 v5, v5, v7
 v_cvt_pk_bf16_f32 v14, v6, v5
 v_accvgpr_read_b32 v5, a127
 v_accvgpr_read_b32 v7, a254
 v_lshlrev_b32 v6, 16, v5
 v_and_b32 v5, s26, v5
 v_mul_f32 v6, v6, v7
 v_accvgpr_read_b32 v7, a255
 v_mul_f32 v5, v5, v7
 v_cvt_pk_bf16_f32 v15, v6, v5
 ds_write_b128 v18, v[12:15] offset:28672
 ds_read_b128 v[48:51], v3 offset:28672
 ds_read_b128 v[80:83], v3 offset:29696
 s_waitcnt lgkmcnt(1)
 s_add_u32 s3, s28, 229376
 buffer_store_dwordx4 v[48:51], v16, s[16:19], s3 offen offset:128 nt
 s_waitcnt lgkmcnt(0)
 s_add_u32 s3, s28, 245760
 buffer_store_dwordx4 v[80:83], v16, s[16:19], s3 offen offset:128 nt
Lend:
 s_endpgm
Lspin_pro:
 s_add_u32 s53, s53, 1
 v_lshlrev_b32 v4, 2, v1
 v_and_b32 v4, 192, v4
 buffer_load_dword v4, v4, s[44:47], 0 offen sc1
 s_cmp_ge_u32 s53, 0x400000
 s_cbranch_scc1 Lgiveup_pro
 s_waitcnt vmcnt(0)
 v_cmp_gt_u32 vcc, s27, v4
 s_cbranch_vccnz Lspin_pro
Lgiveup_pro:
 s_waitcnt vmcnt(0)
 s_branch Lok_pro
Lspin_pa0:
 s_add_u32 s53, s53, 1
 buffer_load_dword v4, off, s[64:67], 0 sc1
 s_cmp_ge_u32 s53, 0x400000
 s_cbranch_scc1 Lgiveup_pa0
 s_waitcnt vmcnt(0)
 v_cmp_gt_u32 vcc, s55, v4
 s_cbranch_vccnz Lspin_pa0
Lgiveup_pa0:
 s_waitcnt vmcnt(0)
 s_branch Lok_pa0
Lspin_pa:
 s_add_u32 s53, s53, 1
 buffer_load_dword v4, off, s[64:67], 0 sc1
 s_cmp_ge_u32 s53, 0x400000
 s_cbranch_scc1 Lgiveup_pa
 s_waitcnt vmcnt(0)
 v_cmp_gt_u32 vcc, s55, v4
 s_cbranch_vccnz Lspin_pa
Lgiveup_pa:
 s_waitcnt vmcnt(0)
 s_branch Lok_pa
Lspin_pb:
 s_add_u32 s53, s53, 1
 buffer_load_dword v4, off, s[64:67], 0 sc1
 s_cmp_ge_u32 s53, 0x400000
 s_cbranch_scc1 Lgiveup_pb
 s_waitcnt vmcnt(0)
 v_cmp_gt_u32 vcc, s55, v4
 s_cbranch_vccnz Lspin_pb
Lgiveup_pb:
 s_waitcnt vmcnt(0)
 s_branch Lok_pb
Lspin_w:
 s_add_u32 s53, s53, 1
 v_lshlrev_b32 v4, 2, v1
 v_and_b32 v4, 192, v4
 buffer_load_dword v4, v4, s[44:47], 0 offen sc1
 s_cmp_ge_u32 s53, 0x400000
 s_cbranch_scc1 Lgiveup_w
 s_waitcnt vmcnt(0)
 v_cmp_gt_u32 vcc, s27, v4
 s_cbranch_vccnz Lspin_w
Lgiveup_w:
 s_waitcnt vmcnt(0)
 s_branch Lok_w
.section .rodata,"a"
.p2align 6
.amdhsa_kernel standalone__cross_network_dcn__recsys_kernel
  .amdhsa_next_free_vgpr 512
  .amdhsa_next_free_sgpr 102
  .amdhsa_accum_offset 256
  .amdhsa_group_segment_fixed_size 0
  .amdhsa_kernarg_size 48
  .amdhsa_user_sgpr_count 2
  .amdhsa_user_sgpr_kernarg_segment_ptr 1
  .amdhsa_system_sgpr_workgroup_id_x 1
  .amdhsa_float_denorm_mode_32 3
.end_amdhsa_kernel
```

```asm
; @launch grid=(256,1,1) block=(256,1,1) lds=151552
.amdgcn_target "amdgcn-amd-amdhsa--gfx950"
.text
.globl standalone__cross_network_dcn__recsys_kernel
.p2align 8
.type standalone__cross_network_dcn__recsys_kernel,@function
standalone__cross_network_dcn__recsys_kernel:
 s_cmp_ge_u32 s2, 256
 s_cbranch_scc1 Lend
 s_load_dwordx4 s[56:59], s[0:1], 0
 s_load_dwordx4 s[60:63], s[0:1], 16
 s_load_dwordx4 s[64:67], s[0:1], 32
 v_lshrrev_b32 v9, 6, v0
 v_and_b32 v10, 63, v0
 v_readfirstlane_b32 s54, v9
 v_lshlrev_b32 v1, 4, v10
 s_getpc_b64 s[4:5]
Lpc:
 v_lshlrev_b32 v11, 6, v0
 v_min_u32 v12, Lend-Lpc, v11
 global_load_dword v60, v12, s[4:5]
 v_add_u32 v11, 16384, v11
 v_min_u32 v12, Lend-Lpc, v11
 global_load_dword v61, v12, s[4:5]
 v_add_u32 v11, 16384, v11
 v_min_u32 v12, Lend-Lpc, v11
 global_load_dword v62, v12, s[4:5]
 v_add_u32 v11, 16384, v11
 v_min_u32 v12, Lend-Lpc, v11
 global_load_dword v63, v12, s[4:5]
 v_add_u32 v11, 16384, v11
 v_lshrrev_b32 v11, 7, v0
 v_and_b32 v12, 127, v0
 v_lshlrev_b32 v12, 3, v12
 v_lshl_add_u32 v30, v11, 11, v12
 v_lshlrev_b32 v31, 4, v0
 v_add_u32 v31, 131072, v31
 v_add_u32 v2, 65536, v1
 v_lshl_add_u32 v3, v9, 15, v1
 v_lshl_add_u32 v0, v9, 18, v1
 v_lshrrev_b32 v11, 4, v10
 v_and_b32 v12, 15, v10
 v_xor_b32 v13, v11, v12
 v_lshlrev_b32 v13, 4, v13
 v_lshl_add_u32 v20, v11, 11, v13
 v_xor_b32 v21, 64, v20
 v_xor_b32 v22, 128, v20
 v_xor_b32 v23, 192, v20
 v_lshl_add_u32 v24, v12, 8, v13
 v_lshl_add_u32 v24, v9, 15, v24
 v_xor_b32 v25, 64, v24
 v_xor_b32 v26, 128, v24
 v_xor_b32 v27, 192, v24
 s_and_b32 s7, s2, 1
 s_lshr_b32 s28, s2, 1
 s_lshl_b32 s28, s28, 18
 s_lshl_b32 s6, s7, 10
 s_add_u32 s28, s28, s6
 s_lshl_b32 s6, s54, 8
 s_add_u32 s28, s28, s6
 s_mov_b32 s26, 0xffff0000
 s_lshl_b32 s24, s7, 20
 s_mov_b32 s25, 0
 s_mov_b32 s53, 0
 s_mov_b32 s31, 0
 s_mov_b32 s27, 64
 s_mov_b32 s55, 1
 s_lshl_b32 s50, s54, 15
 s_lshl_b32 s29, s2, 17
 s_add_u32 s29, s29, 33554432
 s_xor_b32 s30, s29, 131072
 s_lshr_b32 s4, s2, 3
 s_and_b32 s5, s2, 7
 s_lshl_b32 s48, s4, 16
 s_lshl_b32 s6, s5, 8
 s_add_u32 s48, s48, s6
 s_lshl_b32 s6, s54, 6
 s_add_u32 s48, s48, s6
 s_lshl_b32 s49, s5, 18
 s_and_b32 s6, s4, 1
 s_lshl_b32 s6, s6, 10
 s_add_u32 s49, s49, s6
 s_lshr_b32 s6, s4, 4
 s_lshr_b32 s5, s5, 2
 s_xor_b32 s5, s5, s6
 s_bfe_u32 s6, s4, 0x10001
 s_lshl_b32 s3, s5, 1
 s_add_u32 s3, s3, s6
 s_lshl_b32 s3, s3, 16
 s_add_u32 s49, s49, s3
 s_bfe_u32 s4, s4, 0x20002
 s_xor_b32 s5, s5, s6
 s_lshr_b32 s3, s54, 1
 s_lshl_b32 s3, s3, 4
 s_lshl_b32 s6, s4, 2
 s_add_u32 s3, s3, s6
 s_and_b32 s6, s54, 1
 s_lshl_b32 s6, s6, 1
 s_add_u32 s3, s3, s6
 s_lshl_b32 s4, s4, 3
 s_lshl_b32 s6, s54, 1
 s_add_u32 s4, s4, s6
 s_cmp_eq_u32 s5, 0
 s_cselect_b32 s3, s3, s4
 s_lshl_b32 s3, s3, 11
 s_add_u32 s49, s49, s3
 s_lshl_b32 s52, s54, 11
 s_add_u32 s52, s52, 143360
 s_lshl_b32 s51, s54, 9
 s_add_u32 s51, s51, 131072
 s_waitcnt lgkmcnt(0)
 s_mov_b32 s40, s58
 s_mov_b32 s41, s59
 s_mov_b32 s42, 0xc00000
 s_mov_b32 s43, 0x20000
 v_lshrrev_b32 v5, 6, v1
 v_and_b32 v6, 48, v1
 v_lshl_add_u32 v5, v5, 11, v6
 s_mov_b32 m0, s52
 s_add_u32 s3, s48, 31744
 buffer_load_dwordx4 v5, s[40:43], s48 offen lds
 buffer_load_dwordx4 v5, s[40:43], s3 offen offset:1024 lds
 s_add_u32 s48, s48, 2097152
 s_mov_b32 s20, s60
 s_mov_b32 s21, s61
 s_mov_b32 s22, 0x3000
 s_mov_b32 s23, 0x20000
 s_lshl_b32 s3, s7, 10
 buffer_load_dwordx2 v[32:33], v30, s[20:23], s3 offen
 s_add_u32 s3, s3, 4096
 buffer_load_dwordx2 v[34:35], v30, s[20:23], s3 offen
 s_add_u32 s3, s3, 4096
 buffer_load_dwordx2 v[36:37], v30, s[20:23], s3 offen
 s_add_u32 s3, s3, 4096
 s_mov_b32 s8, s56
 s_mov_b32 s9, s57
 s_mov_b32 s10, 0x2000000
 s_mov_b32 s11, 0x20000
 s_mov_b32 s16, s62
 s_mov_b32 s17, s63
 s_mov_b32 s18, 0x2000000
 s_mov_b32 s19, 0x20000
 s_mov_b32 s12, s66
 s_mov_b32 s13, s67
 s_mov_b32 s14, 0xc00000
 s_mov_b32 s15, 0x20000
 s_mov_b32 s32, s66
 s_mov_b32 s33, s67
 s_mov_b32 s34, 0x10000000
 s_mov_b32 s35, 0x20000
 s_mov_b32 s44, s64
 s_mov_b32 s45, s65
 s_mov_b32 s46, 0x100
 s_mov_b32 s47, 0x20000
 s_add_u32 s24, s24, 4096
 s_add_u32 s70, s66, s24
 s_addc_u32 s71, s67, 0
 s_sub_u32 s24, s24, 4096
 s_and_b32 s3, s2, 3
 s_lshl_b32 s3, s3, 6
 s_add_u32 s56, s44, s3
 s_addc_u32 s57, s45, 0
 s_mov_b32 s58, 0x4
 s_mov_b32 s59, 0x20000
 s_lshl_b32 s3, s2, 2
 s_add_u32 s3, s3, s54
 s_lshl_b32 s3, s3, 7
 s_add_u32 s3, s3, 15728640
 s_add_u32 s60, s32, s3
 s_addc_u32 s61, s33, 0
 s_mov_b32 s62, 0x4
 s_mov_b32 s63, 0x20000
 s_xor_b32 s3, s3, 512
 s_add_u32 s64, s32, s3
 s_addc_u32 s65, s33, 0
 s_mov_b32 s66, 0x4
 s_mov_b32 s67, 0x20000
 v_mov_b32 v7, 0
 buffer_store_dword v7, v1, s[60:63], 0 offen sc1
 v_mov_b32 v64, 1.0
 v_mov_b32 v65, 1.0
 v_mov_b32 v66, 1.0
 v_mov_b32 v67, 1.0
 v_mov_b32 v68, 1.0
 v_mov_b32 v69, 1.0
 v_mov_b32 v70, 1.0
 v_mov_b32 v71, 1.0
 v_mov_b32 v72, 1.0
 v_mov_b32 v73, 1.0
 v_mov_b32 v74, 1.0
 v_mov_b32 v75, 1.0
 v_mov_b32 v76, 1.0
 v_mov_b32 v77, 1.0
 v_mov_b32 v78, 1.0
 v_mov_b32 v79, 1.0
 v_mov_b32 v80, 1.0
 v_mov_b32 v81, 1.0
 v_mov_b32 v82, 1.0
 v_mov_b32 v83, 1.0
 v_mov_b32 v84, 1.0
 v_mov_b32 v85, 1.0
 v_mov_b32 v86, 1.0
 v_mov_b32 v87, 1.0
 v_mov_b32 v88, 1.0
 v_mov_b32 v89, 1.0
 v_mov_b32 v90, 1.0
 v_mov_b32 v91, 1.0
 v_mov_b32 v92, 1.0
 v_mov_b32 v93, 1.0
 v_mov_b32 v94, 1.0
 v_mov_b32 v95, 1.0
 v_mov_b32 v96, 1.0
 v_mov_b32 v97, 1.0
 v_mov_b32 v98, 1.0
 v_mov_b32 v99, 1.0
 v_mov_b32 v100, 1.0
 v_mov_b32 v101, 1.0
 v_mov_b32 v102, 1.0
 v_mov_b32 v103, 1.0
 v_mov_b32 v104, 1.0
 v_mov_b32 v105, 1.0
 v_mov_b32 v106, 1.0
 v_mov_b32 v107, 1.0
 v_mov_b32 v108, 1.0
 v_mov_b32 v109, 1.0
 v_mov_b32 v110, 1.0
 v_mov_b32 v111, 1.0
 v_mov_b32 v112, 1.0
 v_mov_b32 v113, 1.0
 v_mov_b32 v114, 1.0
 v_mov_b32 v115, 1.0
 v_mov_b32 v116, 1.0
 v_mov_b32 v117, 1.0
 v_mov_b32 v118, 1.0
 v_mov_b32 v119, 1.0
 v_mov_b32 v120, 1.0
 v_mov_b32 v121, 1.0
 v_mov_b32 v122, 1.0
 v_mov_b32 v123, 1.0
 v_mov_b32 v124, 1.0
 v_mov_b32 v125, 1.0
 v_mov_b32 v126, 1.0
 v_mov_b32 v127, 1.0
 v_mov_b32 v128, 1.0
 v_mov_b32 v129, 1.0
 v_mov_b32 v130, 1.0
 v_mov_b32 v131, 1.0
 v_mov_b32 v132, 1.0
 v_mov_b32 v133, 1.0
 v_mov_b32 v134, 1.0
 v_mov_b32 v135, 1.0
 v_accvgpr_write_b32 a240, 1.0
 v_accvgpr_write_b32 a241, 1.0
 v_accvgpr_write_b32 a242, 1.0
 v_accvgpr_write_b32 a243, 1.0
 v_accvgpr_write_b32 a244, 1.0
 v_accvgpr_write_b32 a245, 1.0
 v_accvgpr_write_b32 a246, 1.0
 v_accvgpr_write_b32 a247, 1.0
 v_mov_b32 v136, 1.0
 v_mov_b32 v137, 1.0
 v_mov_b32 v138, 1.0
 v_mov_b32 v139, 1.0
 v_mov_b32 v140, 1.0
 v_mov_b32 v141, 1.0
 v_mov_b32 v142, 1.0
 v_mov_b32 v143, 1.0
 v_mov_b32 v144, 1.0
 v_mov_b32 v145, 1.0
 v_mov_b32 v146, 1.0
 v_mov_b32 v147, 1.0
 v_mov_b32 v148, 1.0
 v_mov_b32 v149, 1.0
 v_mov_b32 v150, 1.0
 v_mov_b32 v151, 1.0
 v_mov_b32 v152, 1.0
 v_mov_b32 v153, 1.0
 v_mov_b32 v154, 1.0
 v_mov_b32 v155, 1.0
 v_mov_b32 v156, 1.0
 v_mov_b32 v157, 1.0
 v_mov_b32 v158, 1.0
 v_mov_b32 v159, 1.0
 v_mov_b32 v160, 1.0
 v_mov_b32 v161, 1.0
 v_mov_b32 v162, 1.0
 v_mov_b32 v163, 1.0
 v_mov_b32 v164, 1.0
 v_mov_b32 v165, 1.0
 v_mov_b32 v166, 1.0
 v_mov_b32 v167, 1.0
 v_mov_b32 v168, 1.0
 v_mov_b32 v169, 1.0
 v_mov_b32 v170, 1.0
 v_mov_b32 v171, 1.0
 v_mov_b32 v172, 1.0
 v_mov_b32 v173, 1.0
 v_mov_b32 v174, 1.0
 v_mov_b32 v175, 1.0
 v_mov_b32 v176, 1.0
 v_mov_b32 v177, 1.0
 v_mov_b32 v178, 1.0
 v_mov_b32 v179, 1.0
 v_mov_b32 v180, 1.0
 v_mov_b32 v181, 1.0
 v_mov_b32 v182, 1.0
 v_mov_b32 v183, 1.0
 v_mov_b32 v184, 1.0
 v_mov_b32 v185, 1.0
 v_mov_b32 v186, 1.0
 v_mov_b32 v187, 1.0
 v_mov_b32 v188, 1.0
 v_mov_b32 v189, 1.0
 v_mov_b32 v190, 1.0
 v_mov_b32 v191, 1.0
 v_mov_b32 v192, 1.0
 v_mov_b32 v193, 1.0
 v_mov_b32 v194, 1.0
 v_mov_b32 v195, 1.0
 v_mov_b32 v196, 1.0
 v_mov_b32 v197, 1.0
 v_mov_b32 v198, 1.0
 v_mov_b32 v199, 1.0
 v_mov_b32 v200, 1.0
 v_mov_b32 v201, 1.0
 v_mov_b32 v202, 1.0
 v_mov_b32 v203, 1.0
 v_mov_b32 v204, 1.0
 v_mov_b32 v205, 1.0
 v_mov_b32 v206, 1.0
 v_mov_b32 v207, 1.0
 v_mov_b32 v208, 1.0
 v_mov_b32 v209, 1.0
 v_mov_b32 v210, 1.0
 v_mov_b32 v211, 1.0
 v_mov_b32 v212, 1.0
 v_mov_b32 v213, 1.0
 v_mov_b32 v214, 1.0
 v_mov_b32 v215, 1.0
 v_mov_b32 v216, 1.0
 v_mov_b32 v217, 1.0
 v_mov_b32 v218, 1.0
 v_mov_b32 v219, 1.0
 v_mov_b32 v220, 1.0
 v_mov_b32 v221, 1.0
 v_mov_b32 v222, 1.0
 v_mov_b32 v223, 1.0
 v_mov_b32 v224, 1.0
 v_mov_b32 v225, 1.0
 v_mov_b32 v226, 1.0
 v_mov_b32 v227, 1.0
 v_mov_b32 v228, 1.0
 v_mov_b32 v229, 1.0
 v_mov_b32 v230, 1.0
 v_mov_b32 v231, 1.0
 v_mov_b32 v232, 1.0
 v_mov_b32 v233, 1.0
 v_mov_b32 v234, 1.0
 v_mov_b32 v235, 1.0
 v_mov_b32 v236, 1.0
 v_mov_b32 v237, 1.0
 v_mov_b32 v238, 1.0
 v_mov_b32 v239, 1.0
 v_mov_b32 v240, 1.0
 v_mov_b32 v241, 1.0
 v_mov_b32 v242, 1.0
 v_mov_b32 v243, 1.0
 v_mov_b32 v244, 1.0
 v_mov_b32 v245, 1.0
 v_mov_b32 v246, 1.0
 v_mov_b32 v247, 1.0
 v_mov_b32 v248, 1.0
 v_mov_b32 v249, 1.0
 v_mov_b32 v250, 1.0
 v_mov_b32 v251, 1.0
 v_mov_b32 v252, 1.0
 v_mov_b32 v253, 1.0
 v_mov_b32 v254, 1.0
 v_mov_b32 v255, 1.0
 v_accvgpr_write_b32 a248, 1.0
 v_accvgpr_write_b32 a249, 1.0
 v_accvgpr_write_b32 a250, 1.0
 v_accvgpr_write_b32 a251, 1.0
 v_accvgpr_write_b32 a252, 1.0
 v_accvgpr_write_b32 a253, 1.0
 v_accvgpr_write_b32 a254, 1.0
 v_accvgpr_write_b32 a255, 1.0
 v_and_b32 v5, 768, v1
 v_add3_u32 v5, v5, v1, s52
 s_waitcnt vmcnt(4)
 ds_read_b64_tr_b16 v[8:9], v5 offset:0
 ds_read_b64_tr_b16 v[10:11], v5 offset:256
 ds_read_b64_tr_b16 v[12:13], v5 offset:8
 ds_read_b64_tr_b16 v[14:15], v5 offset:264
 s_waitcnt lgkmcnt(2)
 buffer_store_dwordx4 v[8:11], v1, s[12:15], s49 offen sc1
 s_waitcnt lgkmcnt(0)
 buffer_store_dwordx4 v[12:15], v1, s[12:15], s49 offen offset:2048 sc1
 s_add_u32 s49, s49, 2097152
 s_add_u32 m0, s50, 0
 s_add_u32 s3, s28, 0
 buffer_load_dwordx4 v20, s[8:11], s3 offen nt lds
 s_add_u32 m0, s50, 1024
 s_add_u32 s3, s28, 8192
 buffer_load_dwordx4 v21, s[8:11], s3 offen nt lds
 s_add_u32 m0, s50, 2048
 s_add_u32 s3, s28, 16384
 buffer_load_dwordx4 v22, s[8:11], s3 offen nt lds
 s_add_u32 m0, s50, 3072
 s_add_u32 s3, s28, 24576
 buffer_load_dwordx4 v23, s[8:11], s3 offen nt lds
 s_waitcnt vmcnt(9)
 v_lshlrev_b32 v40, 16, v32
 v_and_b32 v41, s26, v32
 v_lshlrev_b32 v42, 16, v33
 v_and_b32 v43, s26, v33
 ds_write_b128 v31, v[40:43]
 s_waitcnt vmcnt(8)
 v_lshlrev_b32 v44, 16, v34
 v_and_b32 v45, s26, v34
 v_lshlrev_b32 v46, 16, v35
 v_and_b32 v47, s26, v35
 ds_write_b128 v31, v[44:47] offset:4096
 s_waitcnt vmcnt(7)
 v_lshlrev_b32 v48, 16, v36
 v_and_b32 v49, s26, v36
 v_lshlrev_b32 v50, 16, v37
 v_and_b32 v51, s26, v37
 ds_write_b128 v31, v[48:51] offset:8192
 s_waitcnt lgkmcnt(0)
 v_mov_b32 v32, 1.0
 v_mov_b32 v33, 1.0
 v_mov_b32 v34, 1.0
 v_mov_b32 v35, 1.0
 v_mov_b32 v36, 1.0
 v_mov_b32 v37, 1.0
 v_mov_b32 v38, 1.0
 v_mov_b32 v39, 1.0
 v_mov_b32 v40, 1.0
 v_mov_b32 v41, 1.0
 v_mov_b32 v42, 1.0
 v_mov_b32 v43, 1.0
 v_mov_b32 v44, 1.0
 v_mov_b32 v45, 1.0
 v_mov_b32 v46, 1.0
 v_mov_b32 v47, 1.0
 v_mov_b32 v48, 1.0
 v_mov_b32 v49, 1.0
 v_mov_b32 v50, 1.0
 v_mov_b32 v51, 1.0
 v_mov_b32 v52, 1.0
 v_mov_b32 v53, 1.0
 v_mov_b32 v54, 1.0
 v_mov_b32 v55, 1.0
 v_mov_b32 v56, 1.0
 v_mov_b32 v57, 1.0
 v_mov_b32 v58, 1.0
 v_mov_b32 v59, 1.0
 v_mov_b32 v60, 1.0
 v_mov_b32 v61, 1.0
 v_mov_b32 v62, 1.0
 v_mov_b32 v63, 1.0
 s_waitcnt vmcnt(4)
 s_barrier
 v_mov_b32 v7, 1
 buffer_atomic_add v7, v0, s[56:59], 0 offen sc1
 s_add_u32 m0, s50, 4096
 s_add_u32 s3, s28, 32768
 buffer_load_dwordx4 v20, s[8:11], s3 offen nt lds
 s_add_u32 m0, s50, 5120
 s_add_u32 s3, s28, 40960
 buffer_load_dwordx4 v21, s[8:11], s3 offen nt lds
 s_add_u32 m0, s50, 6144
 s_add_u32 s3, s28, 49152
 buffer_load_dwordx4 v22, s[8:11], s3 offen nt lds
 s_add_u32 m0, s50, 7168
 s_add_u32 s3, s28, 57344
 buffer_load_dwordx4 v23, s[8:11], s3 offen nt lds
 s_add_u32 m0, s50, 8192
 s_add_u32 s3, s28, 65536
 buffer_load_dwordx4 v20, s[8:11], s3 offen nt lds
 s_add_u32 m0, s50, 9216
 s_add_u32 s3, s28, 73728
 buffer_load_dwordx4 v21, s[8:11], s3 offen nt lds
 s_add_u32 m0, s50, 10240
 s_add_u32 s3, s28, 81920
 buffer_load_dwordx4 v22, s[8:11], s3 offen nt lds
 s_add_u32 m0, s50, 11264
 s_add_u32 s3, s28, 90112
 buffer_load_dwordx4 v23, s[8:11], s3 offen nt lds
 s_add_u32 m0, s50, 12288
 s_add_u32 s3, s28, 98304
 buffer_load_dwordx4 v20, s[8:11], s3 offen nt lds
 s_add_u32 m0, s50, 13312
 s_add_u32 s3, s28, 106496
 buffer_load_dwordx4 v21, s[8:11], s3 offen nt lds
 s_add_u32 m0, s50, 14336
 s_add_u32 s3, s28, 114688
 buffer_load_dwordx4 v22, s[8:11], s3 offen nt lds
 s_add_u32 m0, s50, 15360
 s_add_u32 s3, s28, 122880
 buffer_load_dwordx4 v23, s[8:11], s3 offen nt lds
 s_waitcnt vmcnt(13)
 ds_read_b128 a[0:3], v24
 ds_read_b128 a[32:35], v25
 ds_read_b128 a[64:67], v26
 ds_read_b128 a[96:99], v27
 s_waitcnt lgkmcnt(0)
 ds_write_b128 v3, a[0:3]
 ds_write_b128 v3, a[32:35] offset:1024
 ds_write_b128 v3, a[64:67] offset:2048
 ds_write_b128 v3, a[96:99] offset:3072
 s_add_u32 m0, s50, 16384
 s_add_u32 s3, s28, 131072
 buffer_load_dwordx4 v20, s[8:11], s3 offen nt lds
 s_add_u32 m0, s50, 17408
 s_add_u32 s3, s28, 139264
 buffer_load_dwordx4 v21, s[8:11], s3 offen nt lds
 s_add_u32 m0, s50, 18432
 s_add_u32 s3, s28, 147456
 buffer_load_dwordx4 v22, s[8:11], s3 offen nt lds
 s_add_u32 m0, s50, 19456
 s_add_u32 s3, s28, 155648
 buffer_load_dwordx4 v23, s[8:11], s3 offen nt lds
 s_waitcnt vmcnt(12)
 ds_read_b128 a[4:7], v24 offset:4096
 ds_read_b128 a[36:39], v25 offset:4096
 ds_read_b128 a[68:71], v26 offset:4096
 ds_read_b128 a[100:103], v27 offset:4096
 s_waitcnt lgkmcnt(0)
 ds_write_b128 v3, a[4:7] offset:4096
 ds_write_b128 v3, a[36:39] offset:5120
 ds_write_b128 v3, a[68:71] offset:6144
 ds_write_b128 v3, a[100:103] offset:7168
 v_lshlrev_b32 v4, 2, v1
 v_and_b32 v4, 192, v4
 buffer_load_dword v4, v4, s[44:47], 0 offen sc1
 s_add_u32 m0, s50, 20480
 s_add_u32 s3, s28, 163840
 buffer_load_dwordx4 v20, s[8:11], s3 offen nt lds
 s_add_u32 m0, s50, 21504
 s_add_u32 s3, s28, 172032
 buffer_load_dwordx4 v21, s[8:11], s3 offen nt lds
 s_add_u32 m0, s50, 22528
 s_add_u32 s3, s28, 180224
 buffer_load_dwordx4 v22, s[8:11], s3 offen nt lds
 s_add_u32 m0, s50, 23552
 s_add_u32 s3, s28, 188416
 buffer_load_dwordx4 v23, s[8:11], s3 offen nt lds
 s_waitcnt vmcnt(13)
 ds_read_b128 a[8:11], v24 offset:8192
 ds_read_b128 a[40:43], v25 offset:8192
 ds_read_b128 a[72:75], v26 offset:8192
 ds_read_b128 a[104:107], v27 offset:8192
 s_waitcnt lgkmcnt(0)
 ds_write_b128 v3, a[8:11] offset:8192
 ds_write_b128 v3, a[40:43] offset:9216
 ds_write_b128 v3, a[72:75] offset:10240
 ds_write_b128 v3, a[104:107] offset:11264
 s_add_u32 m0, s50, 24576
 s_add_u32 s3, s28, 196608
 buffer_load_dwordx4 v20, s[8:11], s3 offen nt lds
 s_add_u32 m0, s50, 25600
 s_add_u32 s3, s28, 204800
 buffer_load_dwordx4 v21, s[8:11], s3 offen nt lds
 s_add_u32 m0, s50, 26624
 s_add_u32 s3, s28, 212992
 buffer_load_dwordx4 v22, s[8:11], s3 offen nt lds
 s_add_u32 m0, s50, 27648
 s_add_u32 s3, s28, 221184
 buffer_load_dwordx4 v23, s[8:11], s3 offen nt lds
 s_waitcnt vmcnt(13)
 ds_read_b128 a[12:15], v24 offset:12288
 ds_read_b128 a[44:47], v25 offset:12288
 ds_read_b128 a[76:79], v26 offset:12288
 ds_read_b128 a[108:111], v27 offset:12288
 s_waitcnt lgkmcnt(0)
 ds_write_b128 v3, a[12:15] offset:12288
 ds_write_b128 v3, a[44:47] offset:13312
 ds_write_b128 v3, a[76:79] offset:14336
 ds_write_b128 v3, a[108:111] offset:15360
 s_add_u32 m0, s50, 28672
 s_add_u32 s3, s28, 229376
 buffer_load_dwordx4 v20, s[8:11], s3 offen nt lds
 s_add_u32 m0, s50, 29696
 s_add_u32 s3, s28, 237568
 buffer_load_dwordx4 v21, s[8:11], s3 offen nt lds
 s_add_u32 m0, s50, 30720
 s_add_u32 s3, s28, 245760
 buffer_load_dwordx4 v22, s[8:11], s3 offen nt lds
 s_add_u32 m0, s50, 31744
 s_add_u32 s3, s28, 253952
 buffer_load_dwordx4 v23, s[8:11], s3 offen nt lds
 s_waitcnt vmcnt(13)
 ds_read_b128 a[16:19], v24 offset:16384
 ds_read_b128 a[48:51], v25 offset:16384
 ds_read_b128 a[80:83], v26 offset:16384
 ds_read_b128 a[112:115], v27 offset:16384
 s_waitcnt lgkmcnt(0)
 ds_write_b128 v3, a[16:19] offset:16384
 ds_write_b128 v3, a[48:51] offset:17408
 ds_write_b128 v3, a[80:83] offset:18432
 ds_write_b128 v3, a[112:115] offset:19456
 s_waitcnt vmcnt(12)
 v_cmp_gt_u32 vcc, s27, v4
 s_cbranch_vccnz Lspin_pro
Lok_pro:
 s_add_u32 s27, s27, 64
 global_load_dwordx4 a[196:199], v0, s[70:71] offset:-3072
 global_load_dwordx4 a[192:195], v0, s[70:71] offset:-4096
 global_load_dwordx4 a[204:207], v0, s[70:71] offset:-1024
 global_load_dwordx4 a[200:203], v0, s[70:71] offset:-2048
 global_load_dwordx4 a[212:215], v0, s[70:71] offset:1024
 global_load_dwordx4 a[208:211], v0, s[70:71] offset:0
 global_load_dwordx4 a[220:223], v0, s[70:71] offset:3072
 global_load_dwordx4 a[216:219], v0, s[70:71] offset:2048
 s_add_u32 s70, s70, 8192
 s_addc_u32 s71, s71, 0
 global_load_dwordx4 a[228:231], v0, s[70:71] offset:-3072
 global_load_dwordx4 a[224:227], v0, s[70:71] offset:-4096
 global_load_dwordx4 a[236:239], v0, s[70:71] offset:-1024
 global_load_dwordx4 a[232:235], v0, s[70:71] offset:-2048
 s_waitcnt vmcnt(20)
 ds_read_b128 a[20:23], v24 offset:20480
 ds_read_b128 a[52:55], v25 offset:20480
 ds_read_b128 a[84:87], v26 offset:20480
 ds_read_b128 a[116:119], v27 offset:20480
 s_waitcnt lgkmcnt(0)
 ds_write_b128 v3, a[20:23] offset:20480
 ds_write_b128 v3, a[52:55] offset:21504
 ds_write_b128 v3, a[84:87] offset:22528
 ds_write_b128 v3, a[116:119] offset:23552
 s_waitcnt vmcnt(16)
 ds_read_b128 a[24:27], v24 offset:24576
 ds_read_b128 a[56:59], v25 offset:24576
 ds_read_b128 a[88:91], v26 offset:24576
 ds_read_b128 a[120:123], v27 offset:24576
 s_waitcnt lgkmcnt(0)
 ds_write_b128 v3, a[24:27] offset:24576
 ds_write_b128 v3, a[56:59] offset:25600
 ds_write_b128 v3, a[88:91] offset:26624
 ds_write_b128 v3, a[120:123] offset:27648
 s_waitcnt vmcnt(12)
 ds_read_b128 a[28:31], v24 offset:28672
 ds_read_b128 a[60:63], v25 offset:28672
 ds_read_b128 a[92:95], v26 offset:28672
 ds_read_b128 a[124:127], v27 offset:28672
 s_waitcnt lgkmcnt(0)
 ds_write_b128 v3, a[28:31] offset:28672
 ds_write_b128 v3, a[60:63] offset:29696
 ds_write_b128 v3, a[92:95] offset:30720
 ds_write_b128 v3, a[124:127] offset:31744
 v_mov_b32 v16, 1.0
 v_mov_b32 v17, 1.0
 v_mov_b32 v18, 1.0
 v_mov_b32 v19, 1.0
 v_mov_b32 v20, 1.0
 v_mov_b32 v21, 1.0
 v_mov_b32 v22, 1.0
 v_mov_b32 v23, 1.0
 v_mov_b32 v24, 1.0
 v_mov_b32 v25, 1.0
 v_mov_b32 v26, 1.0
 v_mov_b32 v27, 1.0
 v_mov_b32 v28, 1.0
 v_mov_b32 v29, 1.0
 v_mov_b32 v30, 1.0
 v_mov_b32 v31, 1.0
 s_waitcnt lgkmcnt(0)
 s_barrier
 ds_read_b128 a[128:131], v1
 ds_read_b128 a[132:135], v1 offset:1024
 ds_read_b128 a[140:143], v1 offset:5120
 ds_read_b128 a[136:139], v1 offset:4096
 ds_read_b128 a[144:147], v1 offset:8192
 ds_read_b128 a[148:151], v1 offset:9216
 ds_read_b128 a[156:159], v1 offset:13312
 ds_read_b128 a[152:155], v1 offset:12288
 ds_read_b128 a[160:163], v1 offset:16384
 ds_read_b128 a[164:167], v1 offset:17408
 ds_read_b128 a[172:175], v1 offset:21504
 ds_read_b128 a[168:171], v1 offset:20480
 ds_read_b128 a[176:179], v1 offset:24576
 ds_read_b128 a[180:183], v1 offset:25600
 ds_read_b128 a[188:191], v1 offset:29696
 ds_read_b128 a[184:187], v1 offset:28672
 s_waitcnt vmcnt(10) lgkmcnt(8)
 v_mfma_f32_16x16x32_bf16 v[16:19], a[192:195], a[128:131], v[16:19]
 v_mfma_f32_16x16x32_bf16 v[16:19], a[196:199], a[132:135], v[16:19]
 v_mfma_f32_16x16x32_bf16 v[20:23], a[196:199], a[140:143], v[20:23]
 v_mfma_f32_16x16x32_bf16 v[20:23], a[192:195], a[136:139], v[20:23]
 v_mfma_f32_16x16x32_bf16 v[24:27], a[192:195], a[144:147], v[24:27]
 v_mfma_f32_16x16x32_bf16 v[24:27], a[196:199], a[148:151], v[24:27]
 v_mfma_f32_16x16x32_bf16 v[28:31], a[196:199], a[156:159], v[28:31]
 s_add_u32 s68, s29, 0
 v_mfma_f32_16x16x32_bf16 v[28:31], a[192:195], a[152:155], v[28:31]
 s_waitcnt lgkmcnt(0)
 v_mfma_f32_16x16x32_bf16 v[32:35], a[192:195], a[160:163], v[32:35]
 v_mfma_f32_16x16x32_bf16 v[32:35], a[196:199], a[164:167], v[32:35]
 v_mfma_f32_16x16x32_bf16 v[36:39], a[196:199], a[172:175], v[36:39]
 v_mfma_f32_16x16x32_bf16 v[36:39], a[192:195], a[168:171], v[36:39]
 v_mfma_f32_16x16x32_bf16 v[40:43], a[192:195], a[176:179], v[40:43]
 v_mfma_f32_16x16x32_bf16 v[40:43], a[196:199], a[180:183], v[40:43]
 v_mfma_f32_16x16x32_bf16 v[44:47], a[196:199], a[188:191], v[44:47]
 v_mfma_f32_16x16x32_bf16 v[44:47], a[192:195], a[184:187], v[44:47]
 s_waitcnt vmcnt(8)
 v_mfma_f32_16x16x32_bf16 v[76:79], a[200:203], a[184:187], v[76:79]
 v_mfma_f32_16x16x32_bf16 v[76:79], a[204:207], a[188:191], v[76:79]
 global_load_dwordx4 a[196:199], v0, s[70:71] offset:1024
 v_mfma_f32_16x16x32_bf16 v[72:75], a[204:207], a[180:183], v[72:75]
 v_mfma_f32_16x16x32_bf16 v[72:75], a[200:203], a[176:179], v[72:75]
 global_load_dwordx4 a[192:195], v0, s[70:71] offset:0
 v_mfma_f32_16x16x32_bf16 v[68:71], a[200:203], a[168:171], v[68:71]
 buffer_store_dwordx4 a[0:3], v3, s[32:35], s68 offen sc1
 v_mfma_f32_16x16x32_bf16 v[68:71], a[204:207], a[172:175], v[68:71]
 v_mfma_f32_16x16x32_bf16 v[64:67], a[204:207], a[164:167], v[64:67]
 v_mfma_f32_16x16x32_bf16 v[64:67], a[200:203], a[160:163], v[64:67]
 v_mfma_f32_16x16x32_bf16 v[60:63], a[200:203], a[152:155], v[60:63]
 v_mfma_f32_16x16x32_bf16 v[60:63], a[204:207], a[156:159], v[60:63]
 v_mfma_f32_16x16x32_bf16 v[56:59], a[204:207], a[148:151], v[56:59]
 v_mfma_f32_16x16x32_bf16 v[56:59], a[200:203], a[144:147], v[56:59]
 v_mfma_f32_16x16x32_bf16 v[52:55], a[200:203], a[136:139], v[52:55]
 v_mfma_f32_16x16x32_bf16 v[52:55], a[204:207], a[140:143], v[52:55]
 v_mfma_f32_16x16x32_bf16 v[48:51], a[204:207], a[132:135], v[48:51]
 buffer_store_dwordx4 a[32:35], v3, s[32:35], s68 offen offset:1024 sc1
 v_mfma_f32_16x16x32_bf16 v[48:51], a[200:203], a[128:131], v[48:51]
 s_waitcnt vmcnt(10)
 v_mfma_f32_16x16x32_bf16 v[80:83], a[208:211], a[128:131], v[80:83]
 v_mfma_f32_16x16x32_bf16 v[80:83], a[212:215], a[132:135], v[80:83]
 global_load_dwordx4 a[204:207], v0, s[70:71] offset:3072
 v_mfma_f32_16x16x32_bf16 v[84:87], a[212:215], a[140:143], v[84:87]
 v_mfma_f32_16x16x32_bf16 v[84:87], a[208:211], a[136:139], v[84:87]
 global_load_dwordx4 a[200:203], v0, s[70:71] offset:2048
 v_mfma_f32_16x16x32_bf16 v[88:91], a[208:211], a[144:147], v[88:91]
 s_add_u32 s70, s70, 8192
 s_addc_u32 s71, s71, 0
 v_mfma_f32_16x16x32_bf16 v[88:91], a[212:215], a[148:151], v[88:91]
 v_mfma_f32_16x16x32_bf16 v[92:95], a[212:215], a[156:159], v[92:95]
 v_mfma_f32_16x16x32_bf16 v[92:95], a[208:211], a[152:155], v[92:95]
 v_mfma_f32_16x16x32_bf16 v[96:99], a[208:211], a[160:163], v[96:99]
 v_mfma_f32_16x16x32_bf16 v[96:99], a[212:215], a[164:167], v[96:99]
 v_mfma_f32_16x16x32_bf16 v[100:103], a[212:215], a[172:175], v[100:103]
 v_mfma_f32_16x16x32_bf16 v[100:103], a[208:211], a[168:171], v[100:103]
 buffer_store_dwordx4 a[4:7], v3, s[32:35], s68 offen offset:2048 sc1
 v_mfma_f32_16x16x32_bf16 v[104:107], a[208:211], a[176:179], v[104:107]
 v_mfma_f32_16x16x32_bf16 v[104:107], a[212:215], a[180:183], v[104:107]
 v_mfma_f32_16x16x32_bf16 v[108:111], a[212:215], a[188:191], v[108:111]
 v_mfma_f32_16x16x32_bf16 v[108:111], a[208:211], a[184:187], v[108:111]
 s_waitcnt vmcnt(11)
 v_mfma_f32_16x16x32_bf16 a[244:247], a[216:219], a[184:187], a[244:247]
 ds_read_b128 a[184:187], v1 offset:61440
 v_mfma_f32_16x16x32_bf16 a[244:247], a[220:223], a[188:191], a[244:247]
 global_load_dwordx4 a[212:215], v0, s[70:71] offset:-3072
 ds_read_b128 a[188:191], v1 offset:62464
 v_mfma_f32_16x16x32_bf16 a[240:243], a[220:223], a[180:183], a[240:243]
 ds_read_b128 a[180:183], v1 offset:58368
 v_mfma_f32_16x16x32_bf16 a[240:243], a[216:219], a[176:179], a[240:243]
 global_load_dwordx4 a[208:211], v0, s[70:71] offset:-4096
 ds_read_b128 a[176:179], v1 offset:57344
 v_mfma_f32_16x16x32_bf16 v[132:135], a[216:219], a[168:171], v[132:135]
 ds_read_b128 a[168:171], v1 offset:53248
 v_mfma_f32_16x16x32_bf16 v[132:135], a[220:223], a[172:175], v[132:135]
 ds_read_b128 a[172:175], v1 offset:54272
 v_mfma_f32_16x16x32_bf16 v[128:131], a[220:223], a[164:167], v[128:131]
 ds_read_b128 a[164:167], v1 offset:50176
 v_mfma_f32_16x16x32_bf16 v[128:131], a[216:219], a[160:163], v[128:131]
 ds_read_b128 a[160:163], v1 offset:49152
 v_mfma_f32_16x16x32_bf16 v[124:127], a[216:219], a[152:155], v[124:127]
 buffer_store_dwordx4 a[36:39], v3, s[32:35], s68 offen offset:3072 sc1
 ds_read_b128 a[152:155], v1 offset:45056
 v_mfma_f32_16x16x32_bf16 v[124:127], a[220:223], a[156:159], v[124:127]
 ds_read_b128 a[156:159], v1 offset:46080
 v_mfma_f32_16x16x32_bf16 v[120:123], a[220:223], a[148:151], v[120:123]
 ds_read_b128 a[148:151], v1 offset:41984
 v_mfma_f32_16x16x32_bf16 v[120:123], a[216:219], a[144:147], v[120:123]
 ds_read_b128 a[144:147], v1 offset:40960
 v_mfma_f32_16x16x32_bf16 v[116:119], a[216:219], a[136:139], v[116:119]
 ds_read_b128 a[136:139], v1 offset:36864
 v_mfma_f32_16x16x32_bf16 v[116:119], a[220:223], a[140:143], v[116:119]
 ds_read_b128 a[140:143], v1 offset:37888
 v_mfma_f32_16x16x32_bf16 v[112:115], a[220:223], a[132:135], v[112:115]
 ds_read_b128 a[132:135], v1 offset:33792
 v_mfma_f32_16x16x32_bf16 v[112:115], a[216:219], a[128:131], v[112:115]
 ds_read_b128 a[128:131], v1 offset:32768
 s_waitcnt vmcnt(12) lgkmcnt(8)
 v_mfma_f32_16x16x32_bf16 v[44:47], a[224:227], a[184:187], v[44:47]
 v_mfma_f32_16x16x32_bf16 v[44:47], a[228:231], a[188:191], v[44:47]
 global_load_dwordx4 a[220:223], v0, s[70:71] offset:-1024
 v_mfma_f32_16x16x32_bf16 v[40:43], a[228:231], a[180:183], v[40:43]
 v_mfma_f32_16x16x32_bf16 v[40:43], a[224:227], a[176:179], v[40:43]
 global_load_dwordx4 a[216:219], v0, s[70:71] offset:-2048
 v_mfma_f32_16x16x32_bf16 v[36:39], a[224:227], a[168:171], v[36:39]
 s_add_u32 s68, s29, 4096
 v_mfma_f32_16x16x32_bf16 v[36:39], a[228:231], a[172:175], v[36:39]
 v_mfma_f32_16x16x32_bf16 v[32:35], a[228:231], a[164:167], v[32:35]
 v_mfma_f32_16x16x32_bf16 v[32:35], a[224:227], a[160:163], v[32:35]
 s_waitcnt lgkmcnt(0)
 v_mfma_f32_16x16x32_bf16 v[28:31], a[224:227], a[152:155], v[28:31]
 v_mfma_f32_16x16x32_bf16 v[28:31], a[228:231], a[156:159], v[28:31]
 v_mfma_f32_16x16x32_bf16 v[24:27], a[228:231], a[148:151], v[24:27]
 v_mfma_f32_16x16x32_bf16 v[24:27], a[224:227], a[144:147], v[24:27]
 v_mfma_f32_16x16x32_bf16 v[20:23], a[224:227], a[136:139], v[20:23]
 v_mfma_f32_16x16x32_bf16 v[20:23], a[228:231], a[140:143], v[20:23]
 v_mfma_f32_16x16x32_bf16 v[16:19], a[228:231], a[132:135], v[16:19]
 buffer_store_dwordx4 a[8:11], v3, s[32:35], s68 offen sc1
 v_mfma_f32_16x16x32_bf16 v[16:19], a[224:227], a[128:131], v[16:19]
 s_waitcnt vmcnt(13)
 v_mfma_f32_16x16x32_bf16 v[48:51], a[232:235], a[128:131], v[48:51]
 v_mfma_f32_16x16x32_bf16 v[48:51], a[236:239], a[132:135], v[48:51]
 global_load_dwordx4 a[228:231], v0, s[70:71] offset:1024
 v_mfma_f32_16x16x32_bf16 v[52:55], a[236:239], a[140:143], v[52:55]
 v_mfma_f32_16x16x32_bf16 v[52:55], a[232:235], a[136:139], v[52:55]
 global_load_dwordx4 a[224:227], v0, s[70:71] offset:0
 v_mfma_f32_16x16x32_bf16 v[56:59], a[232:235], a[144:147], v[56:59]
 v_mfma_f32_16x16x32_bf16 v[56:59], a[236:239], a[148:151], v[56:59]
 v_mfma_f32_16x16x32_bf16 v[60:63], a[236:239], a[156:159], v[60:63]
 v_mfma_f32_16x16x32_bf16 v[60:63], a[232:235], a[152:155], v[60:63]
 v_mfma_f32_16x16x32_bf16 v[64:67], a[232:235], a[160:163], v[64:67]
 v_mfma_f32_16x16x32_bf16 v[64:67], a[236:239], a[164:167], v[64:67]
 v_mfma_f32_16x16x32_bf16 v[68:71], a[236:239], a[172:175], v[68:71]
 v_mfma_f32_16x16x32_bf16 v[68:71], a[232:235], a[168:171], v[68:71]
 v_mfma_f32_16x16x32_bf16 v[72:75], a[232:235], a[176:179], v[72:75]
 v_mfma_f32_16x16x32_bf16 v[72:75], a[236:239], a[180:183], v[72:75]
 buffer_store_dwordx4 a[40:43], v3, s[32:35], s68 offen offset:1024 sc1
 v_mfma_f32_16x16x32_bf16 v[76:79], a[236:239], a[188:191], v[76:79]
 v_mfma_f32_16x16x32_bf16 v[76:79], a[232:235], a[184:187], v[76:79]
 s_waitcnt vmcnt(14)
 v_mfma_f32_16x16x32_bf16 v[108:111], a[192:195], a[184:187], v[108:111]
 v_mfma_f32_16x16x32_bf16 v[108:111], a[196:199], a[188:191], v[108:111]
 global_load_dwordx4 a[236:239], v0, s[70:71] offset:3072
 v_mfma_f32_16x16x32_bf16 v[104:107], a[196:199], a[180:183], v[104:107]
 v_mfma_f32_16x16x32_bf16 v[104:107], a[192:195], a[176:179], v[104:107]
 global_load_dwordx4 a[232:235], v0, s[70:71] offset:2048
 v_mfma_f32_16x16x32_bf16 v[100:103], a[192:195], a[168:171], v[100:103]
 s_add_u32 s70, s70, 8192
 s_addc_u32 s71, s71, 0
 v_mfma_f32_16x16x32_bf16 v[100:103], a[196:199], a[172:175], v[100:103]
 v_mfma_f32_16x16x32_bf16 v[96:99], a[196:199], a[164:167], v[96:99]
 v_mfma_f32_16x16x32_bf16 v[96:99], a[192:195], a[160:163], v[96:99]
 v_mfma_f32_16x16x32_bf16 v[92:95], a[192:195], a[152:155], v[92:95]
 v_mfma_f32_16x16x32_bf16 v[92:95], a[196:199], a[156:159], v[92:95]
 v_mfma_f32_16x16x32_bf16 v[88:91], a[196:199], a[148:151], v[88:91]
 buffer_store_dwordx4 a[12:15], v3, s[32:35], s68 offen offset:2048 sc1
 v_mfma_f32_16x16x32_bf16 v[88:91], a[192:195], a[144:147], v[88:91]
 v_mfma_f32_16x16x32_bf16 v[84:87], a[192:195], a[136:139], v[84:87]
 v_mfma_f32_16x16x32_bf16 v[84:87], a[196:199], a[140:143], v[84:87]
 v_mfma_f32_16x16x32_bf16 v[80:83], a[196:199], a[132:135], v[80:83]
 v_mfma_f32_16x16x32_bf16 v[80:83], a[192:195], a[128:131], v[80:83]
 s_waitcnt vmcnt(13)
 v_mfma_f32_16x16x32_bf16 v[112:115], a[200:203], a[128:131], v[112:115]
 ds_read_b128 a[128:131], v2
 v_mfma_f32_16x16x32_bf16 v[112:115], a[204:207], a[132:135], v[112:115]
 global_load_dwordx4 a[196:199], v0, s[70:71] offset:-3072
 ds_read_b128 a[132:135], v2 offset:1024
 v_mfma_f32_16x16x32_bf16 v[116:119], a[204:207], a[140:143], v[116:119]
 ds_read_b128 a[140:143], v2 offset:5120
 v_mfma_f32_16x16x32_bf16 v[116:119], a[200:203], a[136:139], v[116:119]
 global_load_dwordx4 a[192:195], v0, s[70:71] offset:-4096
 ds_read_b128 a[136:139], v2 offset:4096
 v_mfma_f32_16x16x32_bf16 v[120:123], a[200:203], a[144:147], v[120:123]
 ds_read_b128 a[144:147], v2 offset:8192
 v_mfma_f32_16x16x32_bf16 v[120:123], a[204:207], a[148:151], v[120:123]
 ds_read_b128 a[148:151], v2 offset:9216
 v_mfma_f32_16x16x32_bf16 v[124:127], a[204:207], a[156:159], v[124:127]
 buffer_store_dwordx4 a[44:47], v3, s[32:35], s68 offen offset:3072 sc1
 ds_read_b128 a[156:159], v2 offset:13312
 v_mfma_f32_16x16x32_bf16 v[124:127], a[200:203], a[152:155], v[124:127]
 ds_read_b128 a[152:155], v2 offset:12288
 v_mfma_f32_16x16x32_bf16 v[128:131], a[200:203], a[160:163], v[128:131]
 ds_read_b128 a[160:163], v2 offset:16384
 v_mfma_f32_16x16x32_bf16 v[128:131], a[204:207], a[164:167], v[128:131]
 ds_read_b128 a[164:167], v2 offset:17408
 v_mfma_f32_16x16x32_bf16 v[132:135], a[204:207], a[172:175], v[132:135]
 ds_read_b128 a[172:175], v2 offset:21504
 v_mfma_f32_16x16x32_bf16 v[132:135], a[200:203], a[168:171], v[132:135]
 ds_read_b128 a[168:171], v2 offset:20480
 v_mfma_f32_16x16x32_bf16 a[240:243], a[200:203], a[176:179], a[240:243]
 ds_read_b128 a[176:179], v2 offset:24576
 v_mfma_f32_16x16x32_bf16 a[240:243], a[204:207], a[180:183], a[240:243]
 ds_read_b128 a[180:183], v2 offset:25600
 v_mfma_f32_16x16x32_bf16 a[244:247], a[204:207], a[188:191], a[244:247]
 ds_read_b128 a[188:191], v2 offset:29696
 v_mfma_f32_16x16x32_bf16 a[244:247], a[200:203], a[184:187], a[244:247]
 ds_read_b128 a[184:187], v2 offset:28672
 s_waitcnt vmcnt(13) lgkmcnt(8)
 v_mfma_f32_16x16x32_bf16 v[16:19], a[208:211], a[128:131], v[16:19]
 v_mfma_f32_16x16x32_bf16 v[16:19], a[212:215], a[132:135], v[16:19]
 global_load_dwordx4 a[204:207], v0, s[70:71] offset:-1024
 v_mfma_f32_16x16x32_bf16 v[20:23], a[212:215], a[140:143], v[20:23]
 v_mfma_f32_16x16x32_bf16 v[20:23], a[208:211], a[136:139], v[20:23]
 global_load_dwordx4 a[200:203], v0, s[70:71] offset:-2048
 s_add_u32 s68, s29, 8192
 v_mfma_f32_16x16x32_bf16 v[24:27], a[208:211], a[144:147], v[24:27]
 v_mfma_f32_16x16x32_bf16 v[24:27], a[212:215], a[148:151], v[24:27]
 v_mfma_f32_16x16x32_bf16 v[28:31], a[212:215], a[156:159], v[28:31]
 v_mfma_f32_16x16x32_bf16 v[28:31], a[208:211], a[152:155], v[28:31]
 s_waitcnt lgkmcnt(0)
 v_mfma_f32_16x16x32_bf16 v[32:35], a[208:211], a[160:163], v[32:35]
 v_mfma_f32_16x16x32_bf16 v[32:35], a[212:215], a[164:167], v[32:35]
 v_mfma_f32_16x16x32_bf16 v[36:39], a[212:215], a[172:175], v[36:39]
 v_mfma_f32_16x16x32_bf16 v[36:39], a[208:211], a[168:171], v[36:39]
 v_mfma_f32_16x16x32_bf16 v[40:43], a[208:211], a[176:179], v[40:43]
 v_mfma_f32_16x16x32_bf16 v[40:43], a[212:215], a[180:183], v[40:43]
 v_mfma_f32_16x16x32_bf16 v[44:47], a[212:215], a[188:191], v[44:47]
 buffer_store_dwordx4 a[16:19], v3, s[32:35], s68 offen sc1
 v_mfma_f32_16x16x32_bf16 v[44:47], a[208:211], a[184:187], v[44:47]
 s_waitcnt vmcnt(13)
 v_mfma_f32_16x16x32_bf16 v[76:79], a[216:219], a[184:187], v[76:79]
 v_mfma_f32_16x16x32_bf16 v[76:79], a[220:223], a[188:191], v[76:79]
 global_load_dwordx4 a[212:215], v0, s[70:71] offset:1024
 v_mfma_f32_16x16x32_bf16 v[72:75], a[220:223], a[180:183], v[72:75]
 v_mfma_f32_16x16x32_bf16 v[72:75], a[216:219], a[176:179], v[72:75]
 global_load_dwordx4 a[208:211], v0, s[70:71] offset:0
 v_mfma_f32_16x16x32_bf16 v[68:71], a[216:219], a[168:171], v[68:71]
 v_mfma_f32_16x16x32_bf16 v[68:71], a[220:223], a[172:175], v[68:71]
 v_mfma_f32_16x16x32_bf16 v[64:67], a[220:223], a[164:167], v[64:67]
 v_mfma_f32_16x16x32_bf16 v[64:67], a[216:219], a[160:163], v[64:67]
 v_mfma_f32_16x16x32_bf16 v[60:63], a[216:219], a[152:155], v[60:63]
 v_mfma_f32_16x16x32_bf16 v[60:63], a[220:223], a[156:159], v[60:63]
 v_mfma_f32_16x16x32_bf16 v[56:59], a[220:223], a[148:151], v[56:59]
 v_mfma_f32_16x16x32_bf16 v[56:59], a[216:219], a[144:147], v[56:59]
 v_mfma_f32_16x16x32_bf16 v[52:55], a[216:219], a[136:139], v[52:55]
 buffer_store_dwordx4 a[48:51], v3, s[32:35], s68 offen offset:1024 sc1
 v_mfma_f32_16x16x32_bf16 v[52:55], a[220:223], a[140:143], v[52:55]
 v_mfma_f32_16x16x32_bf16 v[48:51], a[220:223], a[132:135], v[48:51]
 v_mfma_f32_16x16x32_bf16 v[48:51], a[216:219], a[128:131], v[48:51]
 s_waitcnt vmcnt(13)
 v_mfma_f32_16x16x32_bf16 v[80:83], a[224:227], a[128:131], v[80:83]
 v_mfma_f32_16x16x32_bf16 v[80:83], a[228:231], a[132:135], v[80:83]
 global_load_dwordx4 a[220:223], v0, s[70:71] offset:3072
 v_mfma_f32_16x16x32_bf16 v[84:87], a[228:231], a[140:143], v[84:87]
 v_mfma_f32_16x16x32_bf16 v[84:87], a[224:227], a[136:139], v[84:87]
 global_load_dwordx4 a[216:219], v0, s[70:71] offset:2048
 v_mfma_f32_16x16x32_bf16 v[88:91], a[224:227], a[144:147], v[88:91]
 s_add_u32 s70, s70, 8192
 s_addc_u32 s71, s71, 0
 v_mfma_f32_16x16x32_bf16 v[88:91], a[228:231], a[148:151], v[88:91]
 v_mfma_f32_16x16x32_bf16 v[92:95], a[228:231], a[156:159], v[92:95]
 v_mfma_f32_16x16x32_bf16 v[92:95], a[224:227], a[152:155], v[92:95]
 v_mfma_f32_16x16x32_bf16 v[96:99], a[224:227], a[160:163], v[96:99]
 buffer_store_dwordx4 a[20:23], v3, s[32:35], s68 offen offset:2048 sc1
 v_mfma_f32_16x16x32_bf16 v[96:99], a[228:231], a[164:167], v[96:99]
 v_mfma_f32_16x16x32_bf16 v[100:103], a[228:231], a[172:175], v[100:103]
 v_mfma_f32_16x16x32_bf16 v[100:103], a[224:227], a[168:171], v[100:103]
 v_mfma_f32_16x16x32_bf16 v[104:107], a[224:227], a[176:179], v[104:107]
 v_mfma_f32_16x16x32_bf16 v[104:107], a[228:231], a[180:183], v[104:107]
 v_mfma_f32_16x16x32_bf16 v[108:111], a[228:231], a[188:191], v[108:111]
 v_mfma_f32_16x16x32_bf16 v[108:111], a[224:227], a[184:187], v[108:111]
 s_waitcnt vmcnt(13)
 v_mfma_f32_16x16x32_bf16 a[244:247], a[232:235], a[184:187], a[244:247]
 ds_read_b128 a[184:187], v2 offset:61440
 v_mfma_f32_16x16x32_bf16 a[244:247], a[236:239], a[188:191], a[244:247]
 global_load_dwordx4 a[228:231], v0, s[70:71] offset:-3072
 ds_read_b128 a[188:191], v2 offset:62464
 v_mfma_f32_16x16x32_bf16 a[240:243], a[236:239], a[180:183], a[240:243]
 ds_read_b128 a[180:183], v2 offset:58368
 v_mfma_f32_16x16x32_bf16 a[240:243], a[232:235], a[176:179], a[240:243]
 global_load_dwordx4 a[224:227], v0, s[70:71] offset:-4096
 ds_read_b128 a[176:179], v2 offset:57344
 v_mfma_f32_16x16x32_bf16 v[132:135], a[232:235], a[168:171], v[132:135]
 ds_read_b128 a[168:171], v2 offset:53248
 v_mfma_f32_16x16x32_bf16 v[132:135], a[236:239], a[172:175], v[132:135]
 buffer_store_dwordx4 a[52:55], v3, s[32:35], s68 offen offset:3072 sc1
 ds_read_b128 a[172:175], v2 offset:54272
 v_mfma_f32_16x16x32_bf16 v[128:131], a[236:239], a[164:167], v[128:131]
 ds_read_b128 a[164:167], v2 offset:50176
 v_mfma_f32_16x16x32_bf16 v[128:131], a[232:235], a[160:163], v[128:131]
 ds_read_b128 a[160:163], v2 offset:49152
 v_mfma_f32_16x16x32_bf16 v[124:127], a[232:235], a[152:155], v[124:127]
 ds_read_b128 a[152:155], v2 offset:45056
 v_mfma_f32_16x16x32_bf16 v[124:127], a[236:239], a[156:159], v[124:127]
 ds_read_b128 a[156:159], v2 offset:46080
 v_mfma_f32_16x16x32_bf16 v[120:123], a[236:239], a[148:151], v[120:123]
 ds_read_b128 a[148:151], v2 offset:41984
 v_mfma_f32_16x16x32_bf16 v[120:123], a[232:235], a[144:147], v[120:123]
 ds_read_b128 a[144:147], v2 offset:40960
 v_mfma_f32_16x16x32_bf16 v[116:119], a[232:235], a[136:139], v[116:119]
 ds_read_b128 a[136:139], v2 offset:36864
 v_mfma_f32_16x16x32_bf16 v[116:119], a[236:239], a[140:143], v[116:119]
 ds_read_b128 a[140:143], v2 offset:37888
 v_mfma_f32_16x16x32_bf16 v[112:115], a[236:239], a[132:135], v[112:115]
 ds_read_b128 a[132:135], v2 offset:33792
 v_mfma_f32_16x16x32_bf16 v[112:115], a[232:235], a[128:131], v[112:115]
 ds_read_b128 a[128:131], v2 offset:32768
 s_waitcnt vmcnt(13) lgkmcnt(8)
 v_mfma_f32_16x16x32_bf16 v[44:47], a[192:195], a[184:187], v[44:47]
 v_mfma_f32_16x16x32_bf16 v[44:47], a[196:199], a[188:191], v[44:47]
 global_load_dwordx4 a[236:239], v0, s[70:71] offset:-1024
 s_add_u32 s68, s29, 12288
 v_mfma_f32_16x16x32_bf16 v[40:43], a[196:199], a[180:183], v[40:43]
 v_mfma_f32_16x16x32_bf16 v[40:43], a[192:195], a[176:179], v[40:43]
 global_load_dwordx4 a[232:235], v0, s[70:71] offset:-2048
 v_mfma_f32_16x16x32_bf16 v[36:39], a[192:195], a[168:171], v[36:39]
 v_mfma_f32_16x16x32_bf16 v[36:39], a[196:199], a[172:175], v[36:39]
 v_mfma_f32_16x16x32_bf16 v[32:35], a[196:199], a[164:167], v[32:35]
 v_mfma_f32_16x16x32_bf16 v[32:35], a[192:195], a[160:163], v[32:35]
 s_waitcnt lgkmcnt(0)
 v_mfma_f32_16x16x32_bf16 v[28:31], a[192:195], a[152:155], v[28:31]
 v_mfma_f32_16x16x32_bf16 v[28:31], a[196:199], a[156:159], v[28:31]
 v_mfma_f32_16x16x32_bf16 v[24:27], a[196:199], a[148:151], v[24:27]
 v_mfma_f32_16x16x32_bf16 v[24:27], a[192:195], a[144:147], v[24:27]
 v_mfma_f32_16x16x32_bf16 v[20:23], a[192:195], a[136:139], v[20:23]
 v_mfma_f32_16x16x32_bf16 v[20:23], a[196:199], a[140:143], v[20:23]
 v_mfma_f32_16x16x32_bf16 v[16:19], a[196:199], a[132:135], v[16:19]
 buffer_store_dwordx4 a[24:27], v3, s[32:35], s68 offen sc1
 v_mfma_f32_16x16x32_bf16 v[16:19], a[192:195], a[128:131], v[16:19]
 s_waitcnt vmcnt(13)
 v_mfma_f32_16x16x32_bf16 v[48:51], a[200:203], a[128:131], v[48:51]
 v_mfma_f32_16x16x32_bf16 v[48:51], a[204:207], a[132:135], v[48:51]
 global_load_dwordx4 a[196:199], v0, s[70:71] offset:1024
 v_mfma_f32_16x16x32_bf16 v[52:55], a[204:207], a[140:143], v[52:55]
 v_mfma_f32_16x16x32_bf16 v[52:55], a[200:203], a[136:139], v[52:55]
 global_load_dwordx4 a[192:195], v0, s[70:71] offset:0
 v_mfma_f32_16x16x32_bf16 v[56:59], a[200:203], a[144:147], v[56:59]
 v_mfma_f32_16x16x32_bf16 v[56:59], a[204:207], a[148:151], v[56:59]
 v_mfma_f32_16x16x32_bf16 v[60:63], a[204:207], a[156:159], v[60:63]
 v_mfma_f32_16x16x32_bf16 v[60:63], a[200:203], a[152:155], v[60:63]
 v_mfma_f32_16x16x32_bf16 v[64:67], a[200:203], a[160:163], v[64:67]
 v_mfma_f32_16x16x32_bf16 v[64:67], a[204:207], a[164:167], v[64:67]
 v_mfma_f32_16x16x32_bf16 v[68:71], a[204:207], a[172:175], v[68:71]
 buffer_store_dwordx4 a[56:59], v3, s[32:35], s68 offen offset:1024 sc1
 v_mfma_f32_16x16x32_bf16 v[68:71], a[200:203], a[168:171], v[68:71]
 v_mfma_f32_16x16x32_bf16 v[72:75], a[200:203], a[176:179], v[72:75]
 v_mfma_f32_16x16x32_bf16 v[72:75], a[204:207], a[180:183], v[72:75]
 v_mfma_f32_16x16x32_bf16 v[76:79], a[204:207], a[188:191], v[76:79]
 v_mfma_f32_16x16x32_bf16 v[76:79], a[200:203], a[184:187], v[76:79]
 s_waitcnt vmcnt(13)
 v_mfma_f32_16x16x32_bf16 v[108:111], a[208:211], a[184:187], v[108:111]
 v_mfma_f32_16x16x32_bf16 v[108:111], a[212:215], a[188:191], v[108:111]
 global_load_dwordx4 a[204:207], v0, s[70:71] offset:3072
 v_mfma_f32_16x16x32_bf16 v[104:107], a[212:215], a[180:183], v[104:107]
 v_mfma_f32_16x16x32_bf16 v[104:107], a[208:211], a[176:179], v[104:107]
 global_load_dwordx4 a[200:203], v0, s[70:71] offset:2048
 v_mfma_f32_16x16x32_bf16 v[100:103], a[208:211], a[168:171], v[100:103]
 s_add_u32 s70, s70, 8192
 s_addc_u32 s71, s71, 0
 v_mfma_f32_16x16x32_bf16 v[100:103], a[212:215], a[172:175], v[100:103]
 v_mfma_f32_16x16x32_bf16 v[96:99], a[212:215], a[164:167], v[96:99]
 v_mfma_f32_16x16x32_bf16 v[96:99], a[208:211], a[160:163], v[96:99]
 buffer_store_dwordx4 a[28:31], v3, s[32:35], s68 offen offset:2048 sc1
 v_mfma_f32_16x16x32_bf16 v[92:95], a[208:211], a[152:155], v[92:95]
 v_mfma_f32_16x16x32_bf16 v[92:95], a[212:215], a[156:159], v[92:95]
 v_mfma_f32_16x16x32_bf16 v[88:91], a[212:215], a[148:151], v[88:91]
 v_mfma_f32_16x16x32_bf16 v[88:91], a[208:211], a[144:147], v[88:91]
 v_mfma_f32_16x16x32_bf16 v[84:87], a[208:211], a[136:139], v[84:87]
 v_mfma_f32_16x16x32_bf16 v[84:87], a[212:215], a[140:143], v[84:87]
 v_mfma_f32_16x16x32_bf16 v[80:83], a[212:215], a[132:135], v[80:83]
 v_mfma_f32_16x16x32_bf16 v[80:83], a[208:211], a[128:131], v[80:83]
 s_waitcnt vmcnt(13)
 v_mfma_f32_16x16x32_bf16 v[112:115], a[216:219], a[128:131], v[112:115]
 ds_read_b128 a[128:131], v1
 v_mfma_f32_16x16x32_bf16 v[112:115], a[220:223], a[132:135], v[112:115]
 global_load_dwordx4 a[212:215], v0, s[70:71] offset:-3072
 ds_read_b128 a[132:135], v1 offset:1024
 v_mfma_f32_16x16x32_bf16 v[116:119], a[220:223], a[140:143], v[116:119]
 ds_read_b128 a[140:143], v1 offset:5120
 v_mfma_f32_16x16x32_bf16 v[116:119], a[216:219], a[136:139], v[116:119]
 global_load_dwordx4 a[208:211], v0, s[70:71] offset:-4096
 ds_read_b128 a[136:139], v1 offset:4096
 v_mfma_f32_16x16x32_bf16 v[120:123], a[216:219], a[144:147], v[120:123]
 buffer_store_dwordx4 a[60:63], v3, s[32:35], s68 offen offset:3072 sc1
 ds_read_b128 a[144:147], v1 offset:8192
 v_mfma_f32_16x16x32_bf16 v[120:123], a[220:223], a[148:151], v[120:123]
 ds_read_b128 a[148:151], v1 offset:9216
 v_mfma_f32_16x16x32_bf16 v[124:127], a[220:223], a[156:159], v[124:127]
 ds_read_b128 a[156:159], v1 offset:13312
 v_mfma_f32_16x16x32_bf16 v[124:127], a[216:219], a[152:155], v[124:127]
 ds_read_b128 a[152:155], v1 offset:12288
 v_mfma_f32_16x16x32_bf16 v[128:131], a[216:219], a[160:163], v[128:131]
 ds_read_b128 a[160:163], v1 offset:16384
 v_mfma_f32_16x16x32_bf16 v[128:131], a[220:223], a[164:167], v[128:131]
 ds_read_b128 a[164:167], v1 offset:17408
 v_mfma_f32_16x16x32_bf16 v[132:135], a[220:223], a[172:175], v[132:135]
 ds_read_b128 a[172:175], v1 offset:21504
 v_mfma_f32_16x16x32_bf16 v[132:135], a[216:219], a[168:171], v[132:135]
 ds_read_b128 a[168:171], v1 offset:20480
 v_mfma_f32_16x16x32_bf16 a[240:243], a[216:219], a[176:179], a[240:243]
 ds_read_b128 a[176:179], v1 offset:24576
 v_mfma_f32_16x16x32_bf16 a[240:243], a[220:223], a[180:183], a[240:243]
 ds_read_b128 a[180:183], v1 offset:25600
 v_mfma_f32_16x16x32_bf16 a[244:247], a[220:223], a[188:191], a[244:247]
 global_load_dwordx4 a[220:223], v0, s[70:71] offset:-1024
 ds_read_b128 a[188:191], v1 offset:29696
 v_mfma_f32_16x16x32_bf16 a[244:247], a[216:219], a[184:187], a[244:247]
 global_load_dwordx4 a[216:219], v0, s[70:71] offset:-2048
 ds_read_b128 a[184:187], v1 offset:28672
 s_waitcnt vmcnt(15) lgkmcnt(8)
 v_mfma_f32_16x16x32_bf16 v[136:139], a[224:227], a[128:131], v[136:139]
 v_lshrrev_b32 v4, 8, v1
 v_mfma_f32_16x16x32_bf16 v[136:139], a[228:231], a[132:135], v[136:139]
 v_mfma_f32_16x16x32_bf16 v[140:143], a[228:231], a[140:143], v[140:143]
 v_lshl_add_u32 v4, v4, 5, s51
 v_mfma_f32_16x16x32_bf16 v[140:143], a[224:227], a[136:139], v[140:143]
 ds_read_b128 v[8:11], v4
 v_mfma_f32_16x16x32_bf16 v[144:147], a[224:227], a[144:147], v[144:147]
 v_mfma_f32_16x16x32_bf16 v[144:147], a[228:231], a[148:151], v[144:147]
 s_add_u32 s68, s29, 16384
 v_mfma_f32_16x16x32_bf16 v[148:151], a[228:231], a[156:159], v[148:151]
 v_mfma_f32_16x16x32_bf16 v[148:151], a[224:227], a[152:155], v[148:151]
 s_waitcnt lgkmcnt(1)
 v_mfma_f32_16x16x32_bf16 v[152:155], a[224:227], a[160:163], v[152:155]
 v_mfma_f32_16x16x32_bf16 v[152:155], a[228:231], a[164:167], v[152:155]
 v_mfma_f32_16x16x32_bf16 v[156:159], a[228:231], a[172:175], v[156:159]
 v_mfma_f32_16x16x32_bf16 v[156:159], a[224:227], a[168:171], v[156:159]
 v_mfma_f32_16x16x32_bf16 v[160:163], a[224:227], a[176:179], v[160:163]
 v_mfma_f32_16x16x32_bf16 v[160:163], a[228:231], a[180:183], v[160:163]
 v_mfma_f32_16x16x32_bf16 v[164:167], a[228:231], a[188:191], v[164:167]
 buffer_store_dwordx4 a[64:67], v3, s[32:35], s68 offen sc1
 v_mfma_f32_16x16x32_bf16 v[164:167], a[224:227], a[184:187], v[164:167]
 s_waitcnt vmcnt(13)
 v_mfma_f32_16x16x32_bf16 v[196:199], a[232:235], a[184:187], v[196:199]
 s_waitcnt lgkmcnt(0)
 v_mfma_f32_16x16x32_bf16 v[196:199], a[236:239], a[188:191], v[196:199]
 global_load_dwordx4 a[228:231], v0, s[70:71] offset:1024
 v_add_f32 v16, v16, v8
 v_mfma_f32_16x16x32_bf16 v[192:195], a[236:239], a[180:183], v[192:195]
 ds_read_b128 v[12:15], v4 offset:16
 v_mfma_f32_16x16x32_bf16 v[192:195], a[232:235], a[176:179], v[192:195]
 global_load_dwordx4 a[224:227], v0, s[70:71] offset:0
 v_mfma_f32_16x16x32_bf16 v[188:191], a[232:235], a[168:171], v[188:191]
 v_add_f32 v17, v17, v9
 v_mfma_f32_16x16x32_bf16 v[188:191], a[236:239], a[172:175], v[188:191]
 v_add_f32 v18, v18, v10
 v_mfma_f32_16x16x32_bf16 v[184:187], a[236:239], a[164:167], v[184:187]
 v_mfma_f32_16x16x32_bf16 v[184:187], a[232:235], a[160:163], v[184:187]
 s_add_u32 s31, s31, 1
 v_mfma_f32_16x16x32_bf16 v[180:183], a[232:235], a[152:155], v[180:183]
 s_waitcnt vmcnt(5)
 v_mfma_f32_16x16x32_bf16 v[180:183], a[236:239], a[156:159], v[180:183]
 v_mov_b32 v7, s31
 v_mfma_f32_16x16x32_bf16 v[176:179], a[236:239], a[148:151], v[176:179]
 v_mfma_f32_16x16x32_bf16 v[176:179], a[232:235], a[144:147], v[176:179]
 buffer_store_dword v7, v1, s[60:63], 0 offen sc1
 v_mfma_f32_16x16x32_bf16 v[172:175], a[232:235], a[136:139], v[172:175]
 buffer_store_dwordx4 a[96:99], v3, s[32:35], s68 offen offset:1024 sc1
 v_mfma_f32_16x16x32_bf16 v[172:175], a[236:239], a[140:143], v[172:175]
 v_add_f32 v19, v19, v11
 v_mfma_f32_16x16x32_bf16 v[168:171], a[236:239], a[132:135], v[168:171]
 v_add_f32 v20, v20, v8
 v_mfma_f32_16x16x32_bf16 v[168:171], a[232:235], a[128:131], v[168:171]
 v_add_f32 v21, v21, v9
 v_mfma_f32_16x16x32_bf16 v[200:203], a[192:195], a[128:131], v[200:203]
 v_add_f32 v22, v22, v10
 v_mfma_f32_16x16x32_bf16 v[200:203], a[196:199], a[132:135], v[200:203]
 global_load_dwordx4 a[236:239], v0, s[70:71] offset:3072
 v_mfma_f32_16x16x32_bf16 v[204:207], a[196:199], a[140:143], v[204:207]
 v_add_f32 v23, v23, v11
 v_mfma_f32_16x16x32_bf16 v[204:207], a[192:195], a[136:139], v[204:207]
 global_load_dwordx4 a[232:235], v0, s[70:71] offset:2048
 v_add_f32 v24, v24, v8
 v_mfma_f32_16x16x32_bf16 v[208:211], a[192:195], a[144:147], v[208:211]
 s_add_u32 s70, s70, 8192
 s_addc_u32 s71, s71, 0
 v_mfma_f32_16x16x32_bf16 v[208:211], a[196:199], a[148:151], v[208:211]
 v_add_f32 v25, v25, v9
 v_mfma_f32_16x16x32_bf16 v[212:215], a[196:199], a[156:159], v[212:215]
 v_add_f32 v26, v26, v10
 v_mfma_f32_16x16x32_bf16 v[212:215], a[192:195], a[152:155], v[212:215]
 v_add_f32 v27, v27, v11
 v_mfma_f32_16x16x32_bf16 v[216:219], a[192:195], a[160:163], v[216:219]
 buffer_store_dwordx4 a[68:71], v3, s[32:35], s68 offen offset:2048 sc1
 v_mfma_f32_16x16x32_bf16 v[216:219], a[196:199], a[164:167], v[216:219]
 v_add_f32 v28, v28, v8
 v_mfma_f32_16x16x32_bf16 v[220:223], a[196:199], a[172:175], v[220:223]
 v_add_f32 v29, v29, v9
 v_mfma_f32_16x16x32_bf16 v[220:223], a[192:195], a[168:171], v[220:223]
 v_mfma_f32_16x16x32_bf16 v[224:227], a[192:195], a[176:179], v[224:227]
 v_add_f32 v30, v30, v10
 v_mfma_f32_16x16x32_bf16 v[224:227], a[196:199], a[180:183], v[224:227]
 v_add_f32 v31, v31, v11
 v_mfma_f32_16x16x32_bf16 v[228:231], a[196:199], a[188:191], v[228:231]
 v_add_f32 v32, v32, v8
 v_mfma_f32_16x16x32_bf16 v[228:231], a[192:195], a[184:187], v[228:231]
 v_add_f32 v33, v33, v9
 v_mfma_f32_16x16x32_bf16 a[252:255], a[200:203], a[184:187], a[252:255]
 ds_read_b128 a[184:187], v1 offset:61440
 v_add_f32 v34, v34, v10
 v_mfma_f32_16x16x32_bf16 a[252:255], a[204:207], a[188:191], a[252:255]
 global_load_dwordx4 a[196:199], v0, s[70:71] offset:-3072
 ds_read_b128 a[188:191], v1 offset:62464
 v_mfma_f32_16x16x32_bf16 a[248:251], a[204:207], a[180:183], a[248:251]
 ds_read_b128 a[180:183], v1 offset:58368
 v_add_f32 v35, v35, v11
 v_mfma_f32_16x16x32_bf16 a[248:251], a[200:203], a[176:179], a[248:251]
 global_load_dwordx4 a[192:195], v0, s[70:71] offset:-4096
 ds_read_b128 a[176:179], v1 offset:57344
 v_mfma_f32_16x16x32_bf16 v[252:255], a[200:203], a[168:171], v[252:255]
 buffer_store_dwordx4 a[100:103], v3, s[32:35], s68 offen offset:3072 sc1
 ds_read_b128 a[168:171], v1 offset:53248
 v_mfma_f32_16x16x32_bf16 v[252:255], a[204:207], a[172:175], v[252:255]
 ds_read_b128 a[172:175], v1 offset:54272
 v_add_f32 v36, v36, v8
 v_mfma_f32_16x16x32_bf16 v[248:251], a[204:207], a[164:167], v[248:251]
 ds_read_b128 a[164:167], v1 offset:50176
 v_add_f32 v37, v37, v9
 v_mfma_f32_16x16x32_bf16 v[248:251], a[200:203], a[160:163], v[248:251]
 ds_read_b128 a[160:163], v1 offset:49152
 v_add_f32 v38, v38, v10
 v_mfma_f32_16x16x32_bf16 v[244:247], a[200:203], a[152:155], v[244:247]
 ds_read_b128 a[152:155], v1 offset:45056
 v_add_f32 v39, v39, v11
 v_mfma_f32_16x16x32_bf16 v[244:247], a[204:207], a[156:159], v[244:247]
 ds_read_b128 a[156:159], v1 offset:46080
 v_mfma_f32_16x16x32_bf16 v[240:243], a[204:207], a[148:151], v[240:243]
 ds_read_b128 a[148:151], v1 offset:41984
 v_add_f32 v40, v40, v8
 v_mfma_f32_16x16x32_bf16 v[240:243], a[200:203], a[144:147], v[240:243]
 ds_read_b128 a[144:147], v1 offset:40960
 v_add_f32 v41, v41, v9
 v_mfma_f32_16x16x32_bf16 v[236:239], a[200:203], a[136:139], v[236:239]
 ds_read_b128 a[136:139], v1 offset:36864
 v_add_f32 v42, v42, v10
 v_mfma_f32_16x16x32_bf16 v[236:239], a[204:207], a[140:143], v[236:239]
 ds_read_b128 a[140:143], v1 offset:37888
 v_mfma_f32_16x16x32_bf16 v[232:235], a[204:207], a[132:135], v[232:235]
 ds_read_b128 a[132:135], v1 offset:33792
 v_add_f32 v43, v43, v11
 v_mfma_f32_16x16x32_bf16 v[232:235], a[200:203], a[128:131], v[232:235]
 ds_read_b128 a[128:131], v1 offset:32768
 v_add_f32 v44, v44, v8
 s_add_u32 s68, s29, 20480
 s_waitcnt lgkmcnt(8)
 v_mfma_f32_16x16x32_bf16 v[164:167], a[208:211], a[184:187], v[164:167]
 v_mfma_f32_16x16x32_bf16 v[164:167], a[212:215], a[188:191], v[164:167]
 global_load_dwordx4 a[204:207], v0, s[70:71] offset:-1024
 v_add_f32 v45, v45, v9
 v_mfma_f32_16x16x32_bf16 v[160:163], a[212:215], a[180:183], v[160:163]
 v_add_f32 v46, v46, v10
 v_mfma_f32_16x16x32_bf16 v[160:163], a[208:211], a[176:179], v[160:163]
 global_load_dwordx4 a[200:203], v0, s[70:71] offset:-2048
 v_add_f32 v47, v47, v11
 v_mfma_f32_16x16x32_bf16 v[156:159], a[208:211], a[168:171], v[156:159]
 v_mfma_f32_16x16x32_bf16 v[156:159], a[212:215], a[172:175], v[156:159]
 v_mfma_f32_16x16x32_bf16 v[152:155], a[212:215], a[164:167], v[152:155]
 v_add_f32 v48, v48, v12
 v_mfma_f32_16x16x32_bf16 v[152:155], a[208:211], a[160:163], v[152:155]
 s_waitcnt lgkmcnt(0)
 v_mfma_f32_16x16x32_bf16 v[148:151], a[208:211], a[152:155], v[148:151]
 ds_read_b128 v[8:11], v4 offset:128
 v_mfma_f32_16x16x32_bf16 v[148:151], a[212:215], a[156:159], v[148:151]
 v_add_f32 v49, v49, v13
 v_mfma_f32_16x16x32_bf16 v[144:147], a[212:215], a[148:151], v[144:147]
 buffer_store_dwordx4 a[72:75], v3, s[32:35], s68 offen sc1
 v_mfma_f32_16x16x32_bf16 v[144:147], a[208:211], a[144:147], v[144:147]
 v_add_f32 v50, v50, v14
 v_mfma_f32_16x16x32_bf16 v[140:143], a[208:211], a[136:139], v[140:143]
 v_add_f32 v51, v51, v15
 v_mfma_f32_16x16x32_bf16 v[140:143], a[212:215], a[140:143], v[140:143]
 v_add_f32 v52, v52, v12
 v_mfma_f32_16x16x32_bf16 v[136:139], a[212:215], a[132:135], v[136:139]
 v_mfma_f32_16x16x32_bf16 v[136:139], a[208:211], a[128:131], v[136:139]
 v_add_f32 v53, v53, v13
 s_waitcnt vmcnt(14)
 v_mfma_f32_16x16x32_bf16 v[168:171], a[216:219], a[128:131], v[168:171]
 v_add_f32 v54, v54, v14
 v_mfma_f32_16x16x32_bf16 v[168:171], a[220:223], a[132:135], v[168:171]
 global_load_dwordx4 a[212:215], v0, s[70:71] offset:1024
 v_add_f32 v55, v55, v15
 v_mfma_f32_16x16x32_bf16 v[172:175], a[220:223], a[140:143], v[172:175]
 v_mfma_f32_16x16x32_bf16 v[172:175], a[216:219], a[136:139], v[172:175]
 global_load_dwordx4 a[208:211], v0, s[70:71] offset:0
 v_add_f32 v56, v56, v12
 v_mfma_f32_16x16x32_bf16 v[176:179], a[216:219], a[144:147], v[176:179]
 v_add_f32 v57, v57, v13
 v_mfma_f32_16x16x32_bf16 v[176:179], a[220:223], a[148:151], v[176:179]
 v_add_f32 v58, v58, v14
 v_mfma_f32_16x16x32_bf16 v[180:183], a[220:223], a[156:159], v[180:183]
 buffer_store_dwordx4 a[104:107], v3, s[32:35], s68 offen offset:1024 sc1
 v_mfma_f32_16x16x32_bf16 v[180:183], a[216:219], a[152:155], v[180:183]
 v_add_f32 v59, v59, v15
 v_mfma_f32_16x16x32_bf16 v[184:187], a[216:219], a[160:163], v[184:187]
 v_add_f32 v60, v60, v12
 v_mfma_f32_16x16x32_bf16 v[184:187], a[220:223], a[164:167], v[184:187]
 v_mfma_f32_16x16x32_bf16 v[188:191], a[220:223], a[172:175], v[188:191]
 v_add_f32 v61, v61, v13
 v_mfma_f32_16x16x32_bf16 v[188:191], a[216:219], a[168:171], v[188:191]
 v_add_f32 v62, v62, v14
 v_mfma_f32_16x16x32_bf16 v[192:195], a[216:219], a[176:179], v[192:195]
 v_mfma_f32_16x16x32_bf16 v[192:195], a[220:223], a[180:183], v[192:195]
 v_add_f32 v63, v63, v15
 v_mfma_f32_16x16x32_bf16 v[196:199], a[220:223], a[188:191], v[196:199]
 v_add_f32 v64, v64, v12
 v_mfma_f32_16x16x32_bf16 v[196:199], a[216:219], a[184:187], v[196:199]
 v_add_f32 v65, v65, v13
 s_waitcnt vmcnt(14)
 v_mfma_f32_16x16x32_bf16 v[228:231], a[224:227], a[184:187], v[228:231]
 v_mfma_f32_16x16x32_bf16 v[228:231], a[228:231], a[188:191], v[228:231]
 global_load_dwordx4 a[220:223], v0, s[70:71] offset:3072
 v_add_f32 v66, v66, v14
 v_mfma_f32_16x16x32_bf16 v[224:227], a[228:231], a[180:183], v[224:227]
 v_add_f32 v67, v67, v15
 v_mfma_f32_16x16x32_bf16 v[224:227], a[224:227], a[176:179], v[224:227]
 global_load_dwordx4 a[216:219], v0, s[70:71] offset:2048
 v_add_f32 v68, v68, v12
 v_mfma_f32_16x16x32_bf16 v[220:223], a[224:227], a[168:171], v[220:223]
 buffer_store_dwordx4 a[76:79], v3, s[32:35], s68 offen offset:2048 sc1
 s_add_u32 s70, s70, 8192
 s_addc_u32 s71, s71, 0
 v_mfma_f32_16x16x32_bf16 v[220:223], a[228:231], a[172:175], v[220:223]
 v_add_f32 v69, v69, v13
 v_mfma_f32_16x16x32_bf16 v[216:219], a[228:231], a[164:167], v[216:219]
 v_add_f32 v70, v70, v14
 v_mfma_f32_16x16x32_bf16 v[216:219], a[224:227], a[160:163], v[216:219]
 v_mfma_f32_16x16x32_bf16 v[212:215], a[224:227], a[152:155], v[212:215]
 v_add_f32 v71, v71, v15
 v_mfma_f32_16x16x32_bf16 v[212:215], a[228:231], a[156:159], v[212:215]
 v_add_f32 v72, v72, v12
 v_mfma_f32_16x16x32_bf16 v[208:211], a[228:231], a[148:151], v[208:211]
 v_mfma_f32_16x16x32_bf16 v[208:211], a[224:227], a[144:147], v[208:211]
 v_add_f32 v73, v73, v13
 v_mfma_f32_16x16x32_bf16 v[204:207], a[224:227], a[136:139], v[204:207]
 v_add_f32 v74, v74, v14
 v_mfma_f32_16x16x32_bf16 v[204:207], a[228:231], a[140:143], v[204:207]
 buffer_store_dwordx4 a[108:111], v3, s[32:35], s68 offen offset:3072 sc1
 v_mfma_f32_16x16x32_bf16 v[200:203], a[228:231], a[132:135], v[200:203]
 v_add_f32 v75, v75, v15
 v_mfma_f32_16x16x32_bf16 v[200:203], a[224:227], a[128:131], v[200:203]
 v_add_f32 v76, v76, v12
 s_waitcnt vmcnt(14)
 v_mfma_f32_16x16x32_bf16 v[232:235], a[232:235], a[128:131], v[232:235]
 ds_read_b128 a[128:131], v2
 v_add_f32 v77, v77, v13
 v_mfma_f32_16x16x32_bf16 v[232:235], a[236:239], a[132:135], v[232:235]
 global_load_dwordx4 a[228:231], v0, s[70:71] offset:-3072
 ds_read_b128 a[132:135], v2 offset:1024
 v_mfma_f32_16x16x32_bf16 v[236:239], a[236:239], a[140:143], v[236:239]
 ds_read_b128 a[140:143], v2 offset:5120
 v_add_f32 v78, v78, v14
 v_mfma_f32_16x16x32_bf16 v[236:239], a[232:235], a[136:139], v[236:239]
 global_load_dwordx4 a[224:227], v0, s[70:71] offset:-4096
 ds_read_b128 a[136:139], v2 offset:4096
 v_mfma_f32_16x16x32_bf16 v[240:243], a[232:235], a[144:147], v[240:243]
 ds_read_b128 a[144:147], v2 offset:8192
 v_add_f32 v79, v79, v15
 v_mfma_f32_16x16x32_bf16 v[240:243], a[236:239], a[148:151], v[240:243]
 ds_read_b128 a[148:151], v2 offset:9216
 s_waitcnt lgkmcnt(6)
 v_mfma_f32_16x16x32_bf16 v[244:247], a[236:239], a[156:159], v[244:247]
 ds_read_b128 a[156:159], v2 offset:13312
 v_add_f32 v80, v80, v8
 v_mfma_f32_16x16x32_bf16 v[244:247], a[232:235], a[152:155], v[244:247]
 ds_read_b128 a[152:155], v2 offset:12288
 ds_read_b128 v[12:15], v4 offset:144
 v_mfma_f32_16x16x32_bf16 v[248:251], a[232:235], a[160:163], v[248:251]
 ds_read_b128 a[160:163], v2 offset:16384
 s_add_u32 s68, s29, 24576
 v_mfma_f32_16x16x32_bf16 v[248:251], a[236:239], a[164:167], v[248:251]
 ds_read_b128 a[164:167], v2 offset:17408
 v_add_f32 v81, v81, v9
 v_mfma_f32_16x16x32_bf16 v[252:255], a[236:239], a[172:175], v[252:255]
 ds_read_b128 a[172:175], v2 offset:21504
 v_add_f32 v82, v82, v10
 v_mfma_f32_16x16x32_bf16 v[252:255], a[232:235], a[168:171], v[252:255]
 ds_read_b128 a[168:171], v2 offset:20480
 v_mfma_f32_16x16x32_bf16 a[248:251], a[232:235], a[176:179], a[248:251]
 ds_read_b128 a[176:179], v2 offset:24576
 v_add_f32 v83, v83, v11
 v_mfma_f32_16x16x32_bf16 a[248:251], a[236:239], a[180:183], a[248:251]
 ds_read_b128 a[180:183], v2 offset:25600
 v_add_f32 v84, v84, v8
 v_mfma_f32_16x16x32_bf16 a[252:255], a[236:239], a[188:191], a[252:255]
 ds_read_b128 a[188:191], v2 offset:29696
 v_add_f32 v85, v85, v9
 v_mfma_f32_16x16x32_bf16 a[252:255], a[232:235], a[184:187], a[252:255]
 ds_read_b128 a[184:187], v2 offset:28672
 s_waitcnt vmcnt(13) lgkmcnt(9)
 v_mfma_f32_16x16x32_bf16 v[136:139], a[192:195], a[128:131], v[136:139]
 v_add_f32 v86, v86, v10
 v_mfma_f32_16x16x32_bf16 v[136:139], a[196:199], a[132:135], v[136:139]
 global_load_dwordx4 a[236:239], v0, s[70:71] offset:-1024
 v_add_f32 v87, v87, v11
 v_mfma_f32_16x16x32_bf16 v[140:143], a[196:199], a[140:143], v[140:143]
 v_add_f32 v88, v88, v8
 v_mfma_f32_16x16x32_bf16 v[140:143], a[192:195], a[136:139], v[140:143]
 global_load_dwordx4 a[232:235], v0, s[70:71] offset:-2048
 v_add_f32 v89, v89, v9
 v_mfma_f32_16x16x32_bf16 v[144:147], a[192:195], a[144:147], v[144:147]
 buffer_store_dwordx4 a[80:83], v3, s[32:35], s68 offen sc1
 v_mfma_f32_16x16x32_bf16 v[144:147], a[196:199], a[148:151], v[144:147]
 v_add_f32 v90, v90, v10
 v_mfma_f32_16x16x32_bf16 v[148:151], a[196:199], a[156:159], v[148:151]
 v_mfma_f32_16x16x32_bf16 v[148:151], a[192:195], a[152:155], v[148:151]
 v_add_f32 v91, v91, v11
 s_waitcnt lgkmcnt(0)
 v_mfma_f32_16x16x32_bf16 v[152:155], a[192:195], a[160:163], v[152:155]
 v_add_f32 v92, v92, v8
 v_mfma_f32_16x16x32_bf16 v[152:155], a[196:199], a[164:167], v[152:155]
 v_mfma_f32_16x16x32_bf16 v[156:159], a[196:199], a[172:175], v[156:159]
 v_add_f32 v93, v93, v9
 v_mfma_f32_16x16x32_bf16 v[156:159], a[192:195], a[168:171], v[156:159]
 v_add_f32 v94, v94, v10
 v_mfma_f32_16x16x32_bf16 v[160:163], a[192:195], a[176:179], v[160:163]
 v_add_f32 v95, v95, v11
 v_mfma_f32_16x16x32_bf16 v[160:163], a[196:199], a[180:183], v[160:163]
 v_add_f32 v96, v96, v8
 v_mfma_f32_16x16x32_bf16 v[164:167], a[196:199], a[188:191], v[164:167]
 buffer_store_dwordx4 a[112:115], v3, s[32:35], s68 offen offset:1024 sc1
 v_mfma_f32_16x16x32_bf16 v[164:167], a[192:195], a[184:187], v[164:167]
 v_add_f32 v97, v97, v9
 s_waitcnt vmcnt(14)
 v_mfma_f32_16x16x32_bf16 v[196:199], a[200:203], a[184:187], v[196:199]
 v_mfma_f32_16x16x32_bf16 v[196:199], a[204:207], a[188:191], v[196:199]
 global_load_dwordx4 a[196:199], v0, s[70:71] offset:1024
 v_add_f32 v98, v98, v10
 v_mfma_f32_16x16x32_bf16 v[192:195], a[204:207], a[180:183], v[192:195]
 v_add_f32 v99, v99, v11
 v_mfma_f32_16x16x32_bf16 v[192:195], a[200:203], a[176:179], v[192:195]
 global_load_dwordx4 a[192:195], v0, s[70:71] offset:0
 v_add_f32 v100, v100, v8
 v_mfma_f32_16x16x32_bf16 v[188:191], a[200:203], a[168:171], v[188:191]
 v_mfma_f32_16x16x32_bf16 v[188:191], a[204:207], a[172:175], v[188:191]
 v_add_f32 v101, v101, v9
 v_mfma_f32_16x16x32_bf16 v[184:187], a[204:207], a[164:167], v[184:187]
 v_add_f32 v102, v102, v10
 v_mfma_f32_16x16x32_bf16 v[184:187], a[200:203], a[160:163], v[184:187]
 v_mfma_f32_16x16x32_bf16 v[180:183], a[200:203], a[152:155], v[180:183]
 v_add_f32 v103, v103, v11
 v_mfma_f32_16x16x32_bf16 v[180:183], a[204:207], a[156:159], v[180:183]
 v_add_f32 v104, v104, v8
 v_mfma_f32_16x16x32_bf16 v[176:179], a[204:207], a[148:151], v[176:179]
 v_add_f32 v105, v105, v9
 v_mfma_f32_16x16x32_bf16 v[176:179], a[200:203], a[144:147], v[176:179]
 buffer_store_dwordx4 a[84:87], v3, s[32:35], s68 offen offset:2048 sc1
 v_mfma_f32_16x16x32_bf16 v[172:175], a[200:203], a[136:139], v[172:175]
 v_add_f32 v106, v106, v10
 v_mfma_f32_16x16x32_bf16 v[172:175], a[204:207], a[140:143], v[172:175]
 v_add_f32 v107, v107, v11
 v_mfma_f32_16x16x32_bf16 v[168:171], a[204:207], a[132:135], v[168:171]
 v_mfma_f32_16x16x32_bf16 v[168:171], a[200:203], a[128:131], v[168:171]
 v_add_f32 v108, v108, v8
 s_waitcnt vmcnt(14)
 v_mfma_f32_16x16x32_bf16 v[200:203], a[208:211], a[128:131], v[200:203]
 v_add_f32 v109, v109, v9
 v_mfma_f32_16x16x32_bf16 v[200:203], a[212:215], a[132:135], v[200:203]
 global_load_dwordx4 a[204:207], v0, s[70:71] offset:3072
 v_add_f32 v110, v110, v10
 v_mfma_f32_16x16x32_bf16 v[204:207], a[212:215], a[140:143], v[204:207]
 buffer_load_dword v4, off, s[64:67], 0 sc1
 v_mfma_f32_16x16x32_bf16 v[204:207], a[208:211], a[136:139], v[204:207]
 global_load_dwordx4 a[200:203], v0, s[70:71] offset:2048
 v_mfma_f32_16x16x32_bf16 v[208:211], a[208:211], a[144:147], v[208:211]
 v_add_f32 v111, v111, v11
 s_add_u32 s70, s70, 8192
 s_addc_u32 s71, s71, 0
 v_mfma_f32_16x16x32_bf16 v[208:211], a[212:215], a[148:151], v[208:211]
 v_mfma_f32_16x16x32_bf16 v[212:215], a[212:215], a[156:159], v[212:215]
 buffer_store_dwordx4 a[116:119], v3, s[32:35], s68 offen offset:3072 sc1
 v_mfma_f32_16x16x32_bf16 v[212:215], a[208:211], a[152:155], v[212:215]
 v_add_f32 v112, v112, v12
 v_mfma_f32_16x16x32_bf16 v[216:219], a[208:211], a[160:163], v[216:219]
 v_add_f32 v113, v113, v13
 v_mfma_f32_16x16x32_bf16 v[216:219], a[212:215], a[164:167], v[216:219]
 v_mfma_f32_16x16x32_bf16 v[220:223], a[212:215], a[172:175], v[220:223]
 v_add_f32 v114, v114, v14
 v_mfma_f32_16x16x32_bf16 v[220:223], a[208:211], a[168:171], v[220:223]
 v_add_f32 v115, v115, v15
 v_mfma_f32_16x16x32_bf16 v[224:227], a[208:211], a[176:179], v[224:227]
 v_mfma_f32_16x16x32_bf16 v[224:227], a[212:215], a[180:183], v[224:227]
 v_add_f32 v116, v116, v12
 v_mfma_f32_16x16x32_bf16 v[228:231], a[212:215], a[188:191], v[228:231]
 v_add_f32 v117, v117, v13
 v_mfma_f32_16x16x32_bf16 v[228:231], a[208:211], a[184:187], v[228:231]
 v_add_f32 v118, v118, v14
 s_waitcnt vmcnt(15)
 v_mfma_f32_16x16x32_bf16 a[252:255], a[216:219], a[184:187], a[252:255]
 ds_read_b128 a[184:187], v2 offset:61440
 v_add_f32 v119, v119, v15
 v_mfma_f32_16x16x32_bf16 a[252:255], a[220:223], a[188:191], a[252:255]
 global_load_dwordx4 a[212:215], v0, s[70:71] offset:-3072
 ds_read_b128 a[188:191], v2 offset:62464
 v_mfma_f32_16x16x32_bf16 a[248:251], a[220:223], a[180:183], a[248:251]
 ds_read_b128 a[180:183], v2 offset:58368
 v_add_f32 v120, v120, v12
 s_add_u32 s68, s29, 28672
 v_mfma_f32_16x16x32_bf16 a[248:251], a[216:219], a[176:179], a[248:251]
 global_load_dwordx4 a[208:211], v0, s[70:71] offset:-4096
 ds_read_b128 a[176:179], v2 offset:57344
 v_mfma_f32_16x16x32_bf16 v[252:255], a[216:219], a[168:171], v[252:255]
 ds_read_b128 a[168:171], v2 offset:53248
 v_add_f32 v121, v121, v13
 v_mfma_f32_16x16x32_bf16 v[252:255], a[220:223], a[172:175], v[252:255]
 ds_read_b128 a[172:175], v2 offset:54272
 v_add_f32 v122, v122, v14
 v_mfma_f32_16x16x32_bf16 v[248:251], a[220:223], a[164:167], v[248:251]
 ds_read_b128 a[164:167], v2 offset:50176
 v_add_f32 v123, v123, v15
 v_mfma_f32_16x16x32_bf16 v[248:251], a[216:219], a[160:163], v[248:251]
 ds_read_b128 a[160:163], v2 offset:49152
 v_mfma_f32_16x16x32_bf16 v[244:247], a[216:219], a[152:155], v[244:247]
 ds_read_b128 a[152:155], v2 offset:45056
 v_add_f32 v124, v124, v12
 v_mfma_f32_16x16x32_bf16 v[244:247], a[220:223], a[156:159], v[244:247]
 ds_read_b128 a[156:159], v2 offset:46080
 v_add_f32 v125, v125, v13
 v_mfma_f32_16x16x32_bf16 v[240:243], a[220:223], a[148:151], v[240:243]
 ds_read_b128 a[148:151], v2 offset:41984
 v_mfma_f32_16x16x32_bf16 v[240:243], a[216:219], a[144:147], v[240:243]
 ds_read_b128 a[144:147], v2 offset:40960
 v_add_f32 v126, v126, v14
 v_mfma_f32_16x16x32_bf16 v[236:239], a[216:219], a[136:139], v[236:239]
 ds_read_b128 a[136:139], v2 offset:36864
 v_add_f32 v127, v127, v15
 v_mfma_f32_16x16x32_bf16 v[236:239], a[220:223], a[140:143], v[236:239]
 buffer_store_dwordx4 a[88:91], v3, s[32:35], s68 offen sc1
 ds_read_b128 a[140:143], v2 offset:37888
 v_mfma_f32_16x16x32_bf16 v[232:235], a[220:223], a[132:135], v[232:235]
 ds_read_b128 a[132:135], v2 offset:33792
 v_add_f32 v128, v128, v12
 v_mfma_f32_16x16x32_bf16 v[232:235], a[216:219], a[128:131], v[232:235]
 ds_read_b128 a[128:131], v2 offset:32768
 v_add_f32 v129, v129, v13
 s_waitcnt vmcnt(14) lgkmcnt(8)
 v_mfma_f32_16x16x32_bf16 v[164:167], a[224:227], a[184:187], v[164:167]
 v_add_f32 v130, v130, v14
 v_mfma_f32_16x16x32_bf16 v[164:167], a[228:231], a[188:191], v[164:167]
 global_load_dwordx4 a[220:223], v0, s[70:71] offset:-1024
 v_mfma_f32_16x16x32_bf16 v[160:163], a[228:231], a[180:183], v[160:163]
 v_add_f32 v131, v131, v15
 v_mfma_f32_16x16x32_bf16 v[160:163], a[224:227], a[176:179], v[160:163]
 global_load_dwordx4 a[216:219], v0, s[70:71] offset:-2048
 v_add_f32 v132, v132, v12
 v_mfma_f32_16x16x32_bf16 v[156:159], a[224:227], a[168:171], v[156:159]
 v_add_f32 v133, v133, v13
 v_mfma_f32_16x16x32_bf16 v[156:159], a[228:231], a[172:175], v[156:159]
 v_mfma_f32_16x16x32_bf16 v[152:155], a[228:231], a[164:167], v[152:155]
 v_add_f32 v134, v134, v14
 v_mfma_f32_16x16x32_bf16 v[152:155], a[224:227], a[160:163], v[152:155]
 v_add_f32 v135, v135, v15
 s_waitcnt lgkmcnt(0)
 v_mfma_f32_16x16x32_bf16 v[148:151], a[224:227], a[152:155], v[148:151]
 v_accvgpr_read_b32 v5, a240
 v_mfma_f32_16x16x32_bf16 v[148:151], a[228:231], a[156:159], v[148:151]
 buffer_store_dwordx4 a[120:123], v3, s[32:35], s68 offen offset:1024 sc1
 v_mfma_f32_16x16x32_bf16 v[144:147], a[228:231], a[148:151], v[144:147]
 v_add_f32 v5, v5, v12
 v_mfma_f32_16x16x32_bf16 v[144:147], a[224:227], a[144:147], v[144:147]
 v_accvgpr_write_b32 a240, v5
 v_mfma_f32_16x16x32_bf16 v[140:143], a[224:227], a[136:139], v[140:143]
 v_mfma_f32_16x16x32_bf16 v[140:143], a[228:231], a[140:143], v[140:143]
 v_accvgpr_read_b32 v6, a241
 v_mfma_f32_16x16x32_bf16 v[136:139], a[228:231], a[132:135], v[136:139]
 v_add_f32 v6, v6, v13
 v_mfma_f32_16x16x32_bf16 v[136:139], a[224:227], a[128:131], v[136:139]
 s_waitcnt vmcnt(15)
 v_mfma_f32_16x16x32_bf16 v[168:171], a[232:235], a[128:131], v[168:171]
 v_accvgpr_write_b32 a241, v6
 v_mfma_f32_16x16x32_bf16 v[168:171], a[236:239], a[132:135], v[168:171]
 global_load_dwordx4 a[228:231], v0, s[70:71] offset:1024
 v_accvgpr_read_b32 v5, a242
 v_mfma_f32_16x16x32_bf16 v[172:175], a[236:239], a[140:143], v[172:175]
 v_add_f32 v5, v5, v14
 v_mfma_f32_16x16x32_bf16 v[172:175], a[232:235], a[136:139], v[172:175]
 global_load_dwordx4 a[224:227], v0, s[70:71] offset:0
 v_accvgpr_write_b32 a242, v5
 v_mfma_f32_16x16x32_bf16 v[176:179], a[232:235], a[144:147], v[176:179]
 buffer_store_dwordx4 a[92:95], v3, s[32:35], s68 offen offset:2048 sc1
 v_mfma_f32_16x16x32_bf16 v[176:179], a[236:239], a[148:151], v[176:179]
 v_accvgpr_read_b32 v6, a243
 v_mfma_f32_16x16x32_bf16 v[180:183], a[236:239], a[156:159], v[180:183]
 v_mfma_f32_16x16x32_bf16 v[180:183], a[232:235], a[152:155], v[180:183]
 v_add_f32 v6, v6, v15
 v_mfma_f32_16x16x32_bf16 v[184:187], a[232:235], a[160:163], v[184:187]
 v_accvgpr_write_b32 a243, v6
 v_mfma_f32_16x16x32_bf16 v[184:187], a[236:239], a[164:167], v[184:187]
 v_accvgpr_read_b32 v5, a244
 v_mfma_f32_16x16x32_bf16 v[188:191], a[236:239], a[172:175], v[188:191]
 v_mfma_f32_16x16x32_bf16 v[188:191], a[232:235], a[168:171], v[188:191]
 v_add_f32 v5, v5, v12
 v_mfma_f32_16x16x32_bf16 v[192:195], a[232:235], a[176:179], v[192:195]
 v_accvgpr_write_b32 a244, v5
 v_mfma_f32_16x16x32_bf16 v[192:195], a[236:239], a[180:183], v[192:195]
 v_accvgpr_read_b32 v6, a245
 v_mfma_f32_16x16x32_bf16 v[196:199], a[236:239], a[188:191], v[196:199]
 buffer_store_dwordx4 a[124:127], v3, s[32:35], s68 offen offset:3072 sc1
 v_mfma_f32_16x16x32_bf16 v[196:199], a[232:235], a[184:187], v[196:199]
 v_add_f32 v6, v6, v13
 s_waitcnt vmcnt(15)
 v_mfma_f32_16x16x32_bf16 v[228:231], a[192:195], a[184:187], v[228:231]
 v_accvgpr_write_b32 a245, v6
 v_mfma_f32_16x16x32_bf16 v[228:231], a[196:199], a[188:191], v[228:231]
 global_load_dwordx4 a[236:239], v0, s[70:71] offset:3072
 v_mfma_f32_16x16x32_bf16 v[224:227], a[196:199], a[180:183], v[224:227]
 v_accvgpr_read_b32 v5, a246
 v_mfma_f32_16x16x32_bf16 v[224:227], a[192:195], a[176:179], v[224:227]
 global_load_dwordx4 a[232:235], v0, s[70:71] offset:2048
 v_add_f32 v5, v5, v14
 v_mfma_f32_16x16x32_bf16 v[220:223], a[192:195], a[168:171], v[220:223]
 s_add_u32 s70, s70, 8192
 s_addc_u32 s71, s71, 0
 v_mfma_f32_16x16x32_bf16 v[220:223], a[196:199], a[172:175], v[220:223]
 v_accvgpr_write_b32 a246, v5
 v_mfma_f32_16x16x32_bf16 v[216:219], a[196:199], a[164:167], v[216:219]
 v_accvgpr_read_b32 v6, a247
 v_mfma_f32_16x16x32_bf16 v[216:219], a[192:195], a[160:163], v[216:219]
 v_add_f32 v6, v6, v15
 v_mfma_f32_16x16x32_bf16 v[212:215], a[192:195], a[152:155], v[212:215]
 v_mfma_f32_16x16x32_bf16 v[212:215], a[196:199], a[156:159], v[212:215]
 v_accvgpr_write_b32 a247, v6
 v_mfma_f32_16x16x32_bf16 v[208:211], a[196:199], a[148:151], v[208:211]
 s_waitcnt vmcnt(14)
 v_cmp_gt_u32 vcc, s55, v4
 s_cbranch_vccnz Lspin_pa0
Lok_pa0:
 s_add_u32 s55, s55, 1
 s_waitcnt lgkmcnt(0)
 s_barrier
 v_mfma_f32_16x16x32_bf16 v[208:211], a[192:195], a[144:147], v[208:211]
 v_mfma_f32_16x16x32_bf16 v[204:207], a[192:195], a[136:139], v[204:207]
 v_mfma_f32_16x16x32_bf16 v[204:207], a[196:199], a[140:143], v[204:207]
 v_mfma_f32_16x16x32_bf16 v[200:203], a[196:199], a[132:135], v[200:203]
 v_mfma_f32_16x16x32_bf16 v[200:203], a[192:195], a[128:131], v[200:203]
 s_waitcnt vmcnt(13)
 v_mfma_f32_16x16x32_bf16 v[232:235], a[200:203], a[128:131], v[232:235]
 ds_read_b128 a[128:131], v1 offset:2048
 v_mfma_f32_16x16x32_bf16 v[232:235], a[204:207], a[132:135], v[232:235]
 global_load_dwordx4 a[196:199], v0, s[70:71] offset:-3072
 ds_read_b128 a[132:135], v1 offset:3072
 v_mfma_f32_16x16x32_bf16 v[236:239], a[204:207], a[140:143], v[236:239]
 ds_read_b128 a[140:143], v1 offset:7168
 v_mfma_f32_16x16x32_bf16 v[236:239], a[200:203], a[136:139], v[236:239]
 global_load_dwordx4 a[192:195], v0, s[70:71] offset:-4096
 ds_read_b128 a[136:139], v1 offset:6144
 v_mfma_f32_16x16x32_bf16 v[240:243], a[200:203], a[144:147], v[240:243]
 ds_read_b128 a[144:147], v1 offset:10240
 v_mfma_f32_16x16x32_bf16 v[240:243], a[204:207], a[148:151], v[240:243]
 ds_read_b128 a[148:151], v1 offset:11264
 v_mfma_f32_16x16x32_bf16 v[244:247], a[204:207], a[156:159], v[244:247]
 ds_read_b128 a[156:159], v1 offset:15360
 v_mfma_f32_16x16x32_bf16 v[244:247], a[200:203], a[152:155], v[244:247]
 ds_read_b128 a[152:155], v1 offset:14336
 v_mfma_f32_16x16x32_bf16 v[248:251], a[200:203], a[160:163], v[248:251]
 ds_read_b128 a[160:163], v1 offset:18432
 v_mfma_f32_16x16x32_bf16 v[248:251], a[204:207], a[164:167], v[248:251]
 ds_read_b128 a[164:167], v1 offset:19456
 v_mfma_f32_16x16x32_bf16 v[252:255], a[204:207], a[172:175], v[252:255]
 ds_read_b128 a[172:175], v1 offset:23552
 v_mfma_f32_16x16x32_bf16 v[252:255], a[200:203], a[168:171], v[252:255]
 ds_read_b128 a[168:171], v1 offset:22528
 v_mfma_f32_16x16x32_bf16 a[248:251], a[200:203], a[176:179], a[248:251]
 ds_read_b128 a[176:179], v1 offset:26624
 v_mfma_f32_16x16x32_bf16 a[248:251], a[204:207], a[180:183], a[248:251]
 ds_read_b128 a[180:183], v1 offset:27648
 v_mfma_f32_16x16x32_bf16 a[252:255], a[204:207], a[188:191], a[252:255]
 global_load_dwordx4 a[204:207], v0, s[70:71] offset:-1024
 ds_read_b128 a[188:191], v1 offset:31744
 v_mfma_f32_16x16x32_bf16 a[252:255], a[200:203], a[184:187], a[252:255]
 global_load_dwordx4 a[200:203], v0, s[70:71] offset:-2048
 ds_read_b128 a[184:187], v1 offset:30720
 s_waitcnt vmcnt(14) lgkmcnt(8)
Lloop:
 v_mfma_f32_16x16x32_bf16 v[16:19], a[208:211], a[128:131], v[16:19]
 v_mfma_f32_16x16x32_bf16 v[16:19], a[212:215], a[132:135], v[16:19]
 s_add_u32 s29, s29, 0x2000000
 v_mfma_f32_16x16x32_bf16 v[20:23], a[212:215], a[140:143], v[20:23]
 v_mfma_f32_16x16x32_bf16 v[20:23], a[208:211], a[136:139], v[20:23]
 v_mfma_f32_16x16x32_bf16 v[24:27], a[208:211], a[144:147], v[24:27]
 s_add_u32 m0, s50, 0
 v_mfma_f32_16x16x32_bf16 v[24:27], a[212:215], a[148:151], v[24:27]
 v_mfma_f32_16x16x32_bf16 v[28:31], a[212:215], a[156:159], v[28:31]
 v_mfma_f32_16x16x32_bf16 v[28:31], a[208:211], a[152:155], v[28:31]
 s_waitcnt lgkmcnt(0)
 v_mfma_f32_16x16x32_bf16 v[32:35], a[208:211], a[160:163], v[32:35]
 v_mfma_f32_16x16x32_bf16 v[32:35], a[212:215], a[164:167], v[32:35]
 v_mfma_f32_16x16x32_bf16 v[36:39], a[212:215], a[172:175], v[36:39]
 v_mfma_f32_16x16x32_bf16 v[36:39], a[208:211], a[168:171], v[36:39]
 v_mfma_f32_16x16x32_bf16 v[40:43], a[208:211], a[176:179], v[40:43]
 v_mfma_f32_16x16x32_bf16 v[40:43], a[212:215], a[180:183], v[40:43]
 v_mfma_f32_16x16x32_bf16 v[44:47], a[212:215], a[188:191], v[44:47]
 v_mfma_f32_16x16x32_bf16 v[44:47], a[208:211], a[184:187], v[44:47]
 s_waitcnt vmcnt(8)
 v_mfma_f32_16x16x32_bf16 v[76:79], a[216:219], a[184:187], v[76:79]
 v_mfma_f32_16x16x32_bf16 v[76:79], a[220:223], a[188:191], v[76:79]
 global_load_dwordx4 a[212:215], v0, s[70:71] offset:1024
 v_mfma_f32_16x16x32_bf16 v[72:75], a[220:223], a[180:183], v[72:75]
 v_mfma_f32_16x16x32_bf16 v[72:75], a[216:219], a[176:179], v[72:75]
 global_load_dwordx4 a[208:211], v0, s[70:71] offset:0
 v_mfma_f32_16x16x32_bf16 v[68:71], a[216:219], a[168:171], v[68:71]
 v_mfma_f32_16x16x32_bf16 v[68:71], a[220:223], a[172:175], v[68:71]
 v_mfma_f32_16x16x32_bf16 v[64:67], a[220:223], a[164:167], v[64:67]
 v_mfma_f32_16x16x32_bf16 v[64:67], a[216:219], a[160:163], v[64:67]
 v_mfma_f32_16x16x32_bf16 v[60:63], a[216:219], a[152:155], v[60:63]
 buffer_load_dwordx4 v3, s[32:35], s30 offen sc1 lds
 v_mfma_f32_16x16x32_bf16 v[60:63], a[220:223], a[156:159], v[60:63]
 v_mfma_f32_16x16x32_bf16 v[56:59], a[220:223], a[148:151], v[56:59]
 v_mfma_f32_16x16x32_bf16 v[56:59], a[216:219], a[144:147], v[56:59]
 v_mfma_f32_16x16x32_bf16 v[52:55], a[216:219], a[136:139], v[52:55]
 v_mfma_f32_16x16x32_bf16 v[52:55], a[220:223], a[140:143], v[52:55]
 v_mfma_f32_16x16x32_bf16 v[48:51], a[220:223], a[132:135], v[48:51]
 v_mfma_f32_16x16x32_bf16 v[48:51], a[216:219], a[128:131], v[48:51]
 s_waitcnt vmcnt(9)
 v_mfma_f32_16x16x32_bf16 v[80:83], a[224:227], a[128:131], v[80:83]
 v_mfma_f32_16x16x32_bf16 v[80:83], a[228:231], a[132:135], v[80:83]
 global_load_dwordx4 a[220:223], v0, s[70:71] offset:3072
 v_mfma_f32_16x16x32_bf16 v[84:87], a[228:231], a[140:143], v[84:87]
 buffer_load_dwordx4 v3, s[32:35], s30 offen offset:1024 sc1 lds
 v_mfma_f32_16x16x32_bf16 v[84:87], a[224:227], a[136:139], v[84:87]
 global_load_dwordx4 a[216:219], v0, s[70:71] offset:2048
 v_mfma_f32_16x16x32_bf16 v[88:91], a[224:227], a[144:147], v[88:91]
 s_add_u32 s70, s70, 8192
 s_addc_u32 s71, s71, 0
 v_mfma_f32_16x16x32_bf16 v[88:91], a[228:231], a[148:151], v[88:91]
 v_mfma_f32_16x16x32_bf16 v[92:95], a[228:231], a[156:159], v[92:95]
 v_mfma_f32_16x16x32_bf16 v[92:95], a[224:227], a[152:155], v[92:95]
 v_mfma_f32_16x16x32_bf16 v[96:99], a[224:227], a[160:163], v[96:99]
 v_mfma_f32_16x16x32_bf16 v[96:99], a[228:231], a[164:167], v[96:99]
 v_mfma_f32_16x16x32_bf16 v[100:103], a[228:231], a[172:175], v[100:103]
 v_mfma_f32_16x16x32_bf16 v[100:103], a[224:227], a[168:171], v[100:103]
 s_add_u32 m0, m0, 4096
 v_mfma_f32_16x16x32_bf16 v[104:107], a[224:227], a[176:179], v[104:107]
 v_mfma_f32_16x16x32_bf16 v[104:107], a[228:231], a[180:183], v[104:107]
 v_mfma_f32_16x16x32_bf16 v[108:111], a[228:231], a[188:191], v[108:111]
 v_mfma_f32_16x16x32_bf16 v[108:111], a[224:227], a[184:187], v[108:111]
 s_waitcnt vmcnt(10)
 v_mfma_f32_16x16x32_bf16 a[244:247], a[232:235], a[184:187], a[244:247]
 v_mfma_f32_16x16x32_bf16 a[244:247], a[236:239], a[188:191], a[244:247]
 global_load_dwordx4 a[228:231], v0, s[70:71] offset:-3072
 v_mfma_f32_16x16x32_bf16 a[240:243], a[236:239], a[180:183], a[240:243]
 v_mfma_f32_16x16x32_bf16 a[240:243], a[232:235], a[176:179], a[240:243]
 global_load_dwordx4 a[224:227], v0, s[70:71] offset:-4096
 v_mfma_f32_16x16x32_bf16 v[132:135], a[232:235], a[168:171], v[132:135]
 v_mfma_f32_16x16x32_bf16 v[132:135], a[236:239], a[172:175], v[132:135]
 s_add_u32 s30, s30, 2048
 v_mfma_f32_16x16x32_bf16 v[128:131], a[236:239], a[164:167], v[128:131]
 v_mfma_f32_16x16x32_bf16 v[128:131], a[232:235], a[160:163], v[128:131]
 v_mfma_f32_16x16x32_bf16 v[124:127], a[232:235], a[152:155], v[124:127]
 v_mfma_f32_16x16x32_bf16 v[124:127], a[236:239], a[156:159], v[124:127]
 v_mfma_f32_16x16x32_bf16 v[120:123], a[236:239], a[148:151], v[120:123]
 v_mfma_f32_16x16x32_bf16 v[120:123], a[232:235], a[144:147], v[120:123]
 v_mfma_f32_16x16x32_bf16 v[116:119], a[232:235], a[136:139], v[116:119]
 v_mfma_f32_16x16x32_bf16 v[116:119], a[236:239], a[140:143], v[116:119]
 v_mfma_f32_16x16x32_bf16 v[112:115], a[236:239], a[132:135], v[112:115]
 v_mfma_f32_16x16x32_bf16 v[112:115], a[232:235], a[128:131], v[112:115]
 buffer_load_dwordx4 v3, s[32:35], s30 offen sc1 lds
 s_waitcnt vmcnt(11)
 v_mfma_f32_16x16x32_bf16 v[136:139], a[192:195], a[128:131], v[136:139]
 v_mfma_f32_16x16x32_bf16 v[136:139], a[196:199], a[132:135], v[136:139]
 global_load_dwordx4 a[236:239], v0, s[70:71] offset:-1024
 v_mfma_f32_16x16x32_bf16 v[140:143], a[196:199], a[140:143], v[140:143]
 v_mfma_f32_16x16x32_bf16 v[140:143], a[192:195], a[136:139], v[140:143]
 global_load_dwordx4 a[232:235], v0, s[70:71] offset:-2048
 v_mfma_f32_16x16x32_bf16 v[144:147], a[192:195], a[144:147], v[144:147]
 v_mfma_f32_16x16x32_bf16 v[144:147], a[196:199], a[148:151], v[144:147]
 v_mfma_f32_16x16x32_bf16 v[148:151], a[196:199], a[156:159], v[148:151]
 v_mfma_f32_16x16x32_bf16 v[148:151], a[192:195], a[152:155], v[148:151]
 v_mfma_f32_16x16x32_bf16 v[152:155], a[192:195], a[160:163], v[152:155]
 buffer_load_dwordx4 v3, s[32:35], s30 offen offset:1024 sc1 lds
 v_mfma_f32_16x16x32_bf16 v[152:155], a[196:199], a[164:167], v[152:155]
 v_mfma_f32_16x16x32_bf16 v[156:159], a[196:199], a[172:175], v[156:159]
 v_mfma_f32_16x16x32_bf16 v[156:159], a[192:195], a[168:171], v[156:159]
 v_mfma_f32_16x16x32_bf16 v[160:163], a[192:195], a[176:179], v[160:163]
 v_mfma_f32_16x16x32_bf16 v[160:163], a[196:199], a[180:183], v[160:163]
 v_mfma_f32_16x16x32_bf16 v[164:167], a[196:199], a[188:191], v[164:167]
 v_mfma_f32_16x16x32_bf16 v[164:167], a[192:195], a[184:187], v[164:167]
 s_waitcnt vmcnt(12)
 v_mfma_f32_16x16x32_bf16 v[196:199], a[200:203], a[184:187], v[196:199]
 v_mfma_f32_16x16x32_bf16 v[196:199], a[204:207], a[188:191], v[196:199]
 global_load_dwordx4 a[196:199], v0, s[70:71] offset:1024
 v_mfma_f32_16x16x32_bf16 v[192:195], a[204:207], a[180:183], v[192:195]
 s_add_u32 m0, m0, 4096
 s_add_u32 s31, s31, 1
 v_mov_b32 v7, s31
 buffer_store_dword v7, v1, s[60:63], 0 offen sc1
 v_mfma_f32_16x16x32_bf16 v[192:195], a[200:203], a[176:179], v[192:195]
 global_load_dwordx4 a[192:195], v0, s[70:71] offset:0
 v_mfma_f32_16x16x32_bf16 v[188:191], a[200:203], a[168:171], v[188:191]
 v_mfma_f32_16x16x32_bf16 v[188:191], a[204:207], a[172:175], v[188:191]
 v_mfma_f32_16x16x32_bf16 v[184:187], a[204:207], a[164:167], v[184:187]
 v_mfma_f32_16x16x32_bf16 v[184:187], a[200:203], a[160:163], v[184:187]
 v_mfma_f32_16x16x32_bf16 v[180:183], a[200:203], a[152:155], v[180:183]
 v_mfma_f32_16x16x32_bf16 v[180:183], a[204:207], a[156:159], v[180:183]
 v_mfma_f32_16x16x32_bf16 v[176:179], a[204:207], a[148:151], v[176:179]
 v_mfma_f32_16x16x32_bf16 v[176:179], a[200:203], a[144:147], v[176:179]
 v_mfma_f32_16x16x32_bf16 v[172:175], a[200:203], a[136:139], v[172:175]
 s_add_u32 s30, s30, 2048
 v_mfma_f32_16x16x32_bf16 v[172:175], a[204:207], a[140:143], v[172:175]
 v_mfma_f32_16x16x32_bf16 v[168:171], a[204:207], a[132:135], v[168:171]
 v_mfma_f32_16x16x32_bf16 v[168:171], a[200:203], a[128:131], v[168:171]
 s_waitcnt vmcnt(13)
 v_mfma_f32_16x16x32_bf16 v[200:203], a[208:211], a[128:131], v[200:203]
 v_mfma_f32_16x16x32_bf16 v[200:203], a[212:215], a[132:135], v[200:203]
 global_load_dwordx4 a[204:207], v0, s[70:71] offset:3072
 v_mfma_f32_16x16x32_bf16 v[204:207], a[212:215], a[140:143], v[204:207]
 v_mfma_f32_16x16x32_bf16 v[204:207], a[208:211], a[136:139], v[204:207]
 global_load_dwordx4 a[200:203], v0, s[70:71] offset:2048
 v_mfma_f32_16x16x32_bf16 v[208:211], a[208:211], a[144:147], v[208:211]
 s_add_u32 s70, s70, 8192
 s_addc_u32 s71, s71, 0
 v_mfma_f32_16x16x32_bf16 v[208:211], a[212:215], a[148:151], v[208:211]
 buffer_load_dwordx4 v3, s[32:35], s30 offen sc1 lds
 v_mfma_f32_16x16x32_bf16 v[212:215], a[212:215], a[156:159], v[212:215]
 v_mfma_f32_16x16x32_bf16 v[212:215], a[208:211], a[152:155], v[212:215]
 v_mfma_f32_16x16x32_bf16 v[216:219], a[208:211], a[160:163], v[216:219]
 v_mfma_f32_16x16x32_bf16 v[216:219], a[212:215], a[164:167], v[216:219]
 v_mfma_f32_16x16x32_bf16 v[220:223], a[212:215], a[172:175], v[220:223]
 v_mfma_f32_16x16x32_bf16 v[220:223], a[208:211], a[168:171], v[220:223]
 v_mfma_f32_16x16x32_bf16 v[224:227], a[208:211], a[176:179], v[224:227]
 v_mfma_f32_16x16x32_bf16 v[224:227], a[212:215], a[180:183], v[224:227]
 v_mfma_f32_16x16x32_bf16 v[228:231], a[212:215], a[188:191], v[228:231]
 v_mfma_f32_16x16x32_bf16 v[228:231], a[208:211], a[184:187], v[228:231]
 buffer_load_dwordx4 v3, s[32:35], s30 offen offset:1024 sc1 lds
 s_waitcnt vmcnt(13)
 v_mfma_f32_16x16x32_bf16 a[252:255], a[216:219], a[184:187], a[252:255]
 ds_read_b128 a[184:187], v1 offset:63488
 v_mfma_f32_16x16x32_bf16 a[252:255], a[220:223], a[188:191], a[252:255]
 global_load_dwordx4 a[212:215], v0, s[70:71] offset:-3072
 ds_read_b128 a[188:191], v1 offset:64512
 v_mfma_f32_16x16x32_bf16 a[248:251], a[220:223], a[180:183], a[248:251]
 ds_read_b128 a[180:183], v1 offset:60416
 v_mfma_f32_16x16x32_bf16 a[248:251], a[216:219], a[176:179], a[248:251]
 global_load_dwordx4 a[208:211], v0, s[70:71] offset:-4096
 ds_read_b128 a[176:179], v1 offset:59392
 v_mfma_f32_16x16x32_bf16 v[252:255], a[216:219], a[168:171], v[252:255]
 ds_read_b128 a[168:171], v1 offset:55296
 v_mfma_f32_16x16x32_bf16 v[252:255], a[220:223], a[172:175], v[252:255]
 ds_read_b128 a[172:175], v1 offset:56320
 v_mfma_f32_16x16x32_bf16 v[248:251], a[220:223], a[164:167], v[248:251]
 ds_read_b128 a[164:167], v1 offset:52224
 v_mfma_f32_16x16x32_bf16 v[248:251], a[216:219], a[160:163], v[248:251]
 ds_read_b128 a[160:163], v1 offset:51200
 v_mfma_f32_16x16x32_bf16 v[244:247], a[216:219], a[152:155], v[244:247]
 ds_read_b128 a[152:155], v1 offset:47104
 v_mfma_f32_16x16x32_bf16 v[244:247], a[220:223], a[156:159], v[244:247]
 ds_read_b128 a[156:159], v1 offset:48128
 s_add_u32 m0, m0, 4096
 v_mfma_f32_16x16x32_bf16 v[240:243], a[220:223], a[148:151], v[240:243]
 ds_read_b128 a[148:151], v1 offset:44032
 v_mfma_f32_16x16x32_bf16 v[240:243], a[216:219], a[144:147], v[240:243]
 ds_read_b128 a[144:147], v1 offset:43008
 v_mfma_f32_16x16x32_bf16 v[236:239], a[216:219], a[136:139], v[236:239]
 ds_read_b128 a[136:139], v1 offset:38912
 v_mfma_f32_16x16x32_bf16 v[236:239], a[220:223], a[140:143], v[236:239]
 ds_read_b128 a[140:143], v1 offset:39936
 v_mfma_f32_16x16x32_bf16 v[232:235], a[220:223], a[132:135], v[232:235]
 ds_read_b128 a[132:135], v1 offset:35840
 v_mfma_f32_16x16x32_bf16 v[232:235], a[216:219], a[128:131], v[232:235]
 ds_read_b128 a[128:131], v1 offset:34816
 s_waitcnt vmcnt(13) lgkmcnt(8)
 v_mfma_f32_16x16x32_bf16 v[44:47], a[224:227], a[184:187], v[44:47]
 v_mfma_f32_16x16x32_bf16 v[44:47], a[228:231], a[188:191], v[44:47]
 global_load_dwordx4 a[220:223], v0, s[70:71] offset:-1024
 v_mfma_f32_16x16x32_bf16 v[40:43], a[228:231], a[180:183], v[40:43]
 s_add_u32 s30, s30, 2048
 v_mfma_f32_16x16x32_bf16 v[40:43], a[224:227], a[176:179], v[40:43]
 global_load_dwordx4 a[216:219], v0, s[70:71] offset:-2048
 v_mfma_f32_16x16x32_bf16 v[36:39], a[224:227], a[168:171], v[36:39]
 v_mfma_f32_16x16x32_bf16 v[36:39], a[228:231], a[172:175], v[36:39]
 v_mfma_f32_16x16x32_bf16 v[32:35], a[228:231], a[164:167], v[32:35]
 v_mfma_f32_16x16x32_bf16 v[32:35], a[224:227], a[160:163], v[32:35]
 s_waitcnt lgkmcnt(0)
 v_mfma_f32_16x16x32_bf16 v[28:31], a[224:227], a[152:155], v[28:31]
 v_mfma_f32_16x16x32_bf16 v[28:31], a[228:231], a[156:159], v[28:31]
 v_mfma_f32_16x16x32_bf16 v[24:27], a[228:231], a[148:151], v[24:27]
 v_mfma_f32_16x16x32_bf16 v[24:27], a[224:227], a[144:147], v[24:27]
 v_mfma_f32_16x16x32_bf16 v[20:23], a[224:227], a[136:139], v[20:23]
 buffer_load_dwordx4 v3, s[32:35], s30 offen sc1 lds
 v_mfma_f32_16x16x32_bf16 v[20:23], a[228:231], a[140:143], v[20:23]
 v_mfma_f32_16x16x32_bf16 v[16:19], a[228:231], a[132:135], v[16:19]
 v_mfma_f32_16x16x32_bf16 v[16:19], a[224:227], a[128:131], v[16:19]
 s_waitcnt vmcnt(13)
 v_mfma_f32_16x16x32_bf16 v[48:51], a[232:235], a[128:131], v[48:51]
 v_mfma_f32_16x16x32_bf16 v[48:51], a[236:239], a[132:135], v[48:51]
 global_load_dwordx4 a[228:231], v0, s[70:71] offset:1024
 v_mfma_f32_16x16x32_bf16 v[52:55], a[236:239], a[140:143], v[52:55]
 v_mfma_f32_16x16x32_bf16 v[52:55], a[232:235], a[136:139], v[52:55]
 global_load_dwordx4 a[224:227], v0, s[70:71] offset:0
 v_mfma_f32_16x16x32_bf16 v[56:59], a[232:235], a[144:147], v[56:59]
 v_mfma_f32_16x16x32_bf16 v[56:59], a[236:239], a[148:151], v[56:59]
 v_mfma_f32_16x16x32_bf16 v[60:63], a[236:239], a[156:159], v[60:63]
 buffer_load_dwordx4 v3, s[32:35], s30 offen offset:1024 sc1 lds
 v_mfma_f32_16x16x32_bf16 v[60:63], a[232:235], a[152:155], v[60:63]
 v_mfma_f32_16x16x32_bf16 v[64:67], a[232:235], a[160:163], v[64:67]
 v_mfma_f32_16x16x32_bf16 v[64:67], a[236:239], a[164:167], v[64:67]
 v_mfma_f32_16x16x32_bf16 v[68:71], a[236:239], a[172:175], v[68:71]
 v_mfma_f32_16x16x32_bf16 v[68:71], a[232:235], a[168:171], v[68:71]
 v_mfma_f32_16x16x32_bf16 v[72:75], a[232:235], a[176:179], v[72:75]
 v_mfma_f32_16x16x32_bf16 v[72:75], a[236:239], a[180:183], v[72:75]
 v_mfma_f32_16x16x32_bf16 v[76:79], a[236:239], a[188:191], v[76:79]
 v_mfma_f32_16x16x32_bf16 v[76:79], a[232:235], a[184:187], v[76:79]
 s_waitcnt vmcnt(12)
 v_mfma_f32_16x16x32_bf16 v[108:111], a[192:195], a[184:187], v[108:111]
 s_add_u32 m0, m0, 4096
 v_mfma_f32_16x16x32_bf16 v[108:111], a[196:199], a[188:191], v[108:111]
 global_load_dwordx4 a[236:239], v0, s[70:71] offset:3072
 v_mfma_f32_16x16x32_bf16 v[104:107], a[196:199], a[180:183], v[104:107]
 v_mfma_f32_16x16x32_bf16 v[104:107], a[192:195], a[176:179], v[104:107]
 global_load_dwordx4 a[232:235], v0, s[70:71] offset:2048
 v_mfma_f32_16x16x32_bf16 v[100:103], a[192:195], a[168:171], v[100:103]
 s_add_u32 s70, s70, 8192
 s_addc_u32 s71, s71, 0
 v_mfma_f32_16x16x32_bf16 v[100:103], a[196:199], a[172:175], v[100:103]
 v_mfma_f32_16x16x32_bf16 v[96:99], a[196:199], a[164:167], v[96:99]
 v_mfma_f32_16x16x32_bf16 v[96:99], a[192:195], a[160:163], v[96:99]
 v_mfma_f32_16x16x32_bf16 v[92:95], a[192:195], a[152:155], v[92:95]
 v_mfma_f32_16x16x32_bf16 v[92:95], a[196:199], a[156:159], v[92:95]
 s_add_u32 s30, s30, 2048
 v_mfma_f32_16x16x32_bf16 v[88:91], a[196:199], a[148:151], v[88:91]
 v_mfma_f32_16x16x32_bf16 v[88:91], a[192:195], a[144:147], v[88:91]
 v_mfma_f32_16x16x32_bf16 v[84:87], a[192:195], a[136:139], v[84:87]
 v_mfma_f32_16x16x32_bf16 v[84:87], a[196:199], a[140:143], v[84:87]
 v_mfma_f32_16x16x32_bf16 v[80:83], a[196:199], a[132:135], v[80:83]
 v_mfma_f32_16x16x32_bf16 v[80:83], a[192:195], a[128:131], v[80:83]
 s_waitcnt vmcnt(12)
 v_mfma_f32_16x16x32_bf16 v[112:115], a[200:203], a[128:131], v[112:115]
 v_mfma_f32_16x16x32_bf16 v[112:115], a[204:207], a[132:135], v[112:115]
 global_load_dwordx4 a[196:199], v0, s[70:71] offset:-3072
 v_mfma_f32_16x16x32_bf16 v[116:119], a[204:207], a[140:143], v[116:119]
 buffer_load_dwordx4 v3, s[32:35], s30 offen sc1 lds
 v_mfma_f32_16x16x32_bf16 v[116:119], a[200:203], a[136:139], v[116:119]
 global_load_dwordx4 a[192:195], v0, s[70:71] offset:-4096
 v_mfma_f32_16x16x32_bf16 v[120:123], a[200:203], a[144:147], v[120:123]
 v_mfma_f32_16x16x32_bf16 v[120:123], a[204:207], a[148:151], v[120:123]
 v_mfma_f32_16x16x32_bf16 v[124:127], a[204:207], a[156:159], v[124:127]
 v_mfma_f32_16x16x32_bf16 v[124:127], a[200:203], a[152:155], v[124:127]
 v_mfma_f32_16x16x32_bf16 v[128:131], a[200:203], a[160:163], v[128:131]
 v_mfma_f32_16x16x32_bf16 v[128:131], a[204:207], a[164:167], v[128:131]
 v_mfma_f32_16x16x32_bf16 v[132:135], a[204:207], a[172:175], v[132:135]
 v_mfma_f32_16x16x32_bf16 v[132:135], a[200:203], a[168:171], v[132:135]
 v_mfma_f32_16x16x32_bf16 a[240:243], a[200:203], a[176:179], a[240:243]
 v_mfma_f32_16x16x32_bf16 a[240:243], a[204:207], a[180:183], a[240:243]
 buffer_load_dwordx4 v3, s[32:35], s30 offen offset:1024 sc1 lds
 v_mfma_f32_16x16x32_bf16 a[244:247], a[204:207], a[188:191], a[244:247]
 v_mfma_f32_16x16x32_bf16 a[244:247], a[200:203], a[184:187], a[244:247]
 s_waitcnt vmcnt(12)
 v_mfma_f32_16x16x32_bf16 v[164:167], a[208:211], a[184:187], v[164:167]
 v_mfma_f32_16x16x32_bf16 v[164:167], a[212:215], a[188:191], v[164:167]
 global_load_dwordx4 a[204:207], v0, s[70:71] offset:-1024
 v_mfma_f32_16x16x32_bf16 v[160:163], a[212:215], a[180:183], v[160:163]
 v_mfma_f32_16x16x32_bf16 v[160:163], a[208:211], a[176:179], v[160:163]
 global_load_dwordx4 a[200:203], v0, s[70:71] offset:-2048
 v_mfma_f32_16x16x32_bf16 v[156:159], a[208:211], a[168:171], v[156:159]
 v_mfma_f32_16x16x32_bf16 v[156:159], a[212:215], a[172:175], v[156:159]
 v_mfma_f32_16x16x32_bf16 v[152:155], a[212:215], a[164:167], v[152:155]
 s_add_u32 m0, m0, 4096
 v_mfma_f32_16x16x32_bf16 v[152:155], a[208:211], a[160:163], v[152:155]
 v_mfma_f32_16x16x32_bf16 v[148:151], a[208:211], a[152:155], v[148:151]
 v_mfma_f32_16x16x32_bf16 v[148:151], a[212:215], a[156:159], v[148:151]
 v_mfma_f32_16x16x32_bf16 v[144:147], a[212:215], a[148:151], v[144:147]
 v_mfma_f32_16x16x32_bf16 v[144:147], a[208:211], a[144:147], v[144:147]
 v_mfma_f32_16x16x32_bf16 v[140:143], a[208:211], a[136:139], v[140:143]
 v_mfma_f32_16x16x32_bf16 v[140:143], a[212:215], a[140:143], v[140:143]
 v_mfma_f32_16x16x32_bf16 v[136:139], a[212:215], a[132:135], v[136:139]
 v_mfma_f32_16x16x32_bf16 v[136:139], a[208:211], a[128:131], v[136:139]
 s_waitcnt vmcnt(12)
 v_mfma_f32_16x16x32_bf16 v[168:171], a[216:219], a[128:131], v[168:171]
 s_add_u32 s30, s30, 2048
 v_mfma_f32_16x16x32_bf16 v[168:171], a[220:223], a[132:135], v[168:171]
 global_load_dwordx4 a[212:215], v0, s[70:71] offset:1024
 v_mfma_f32_16x16x32_bf16 v[172:175], a[220:223], a[140:143], v[172:175]
 v_mfma_f32_16x16x32_bf16 v[172:175], a[216:219], a[136:139], v[172:175]
 global_load_dwordx4 a[208:211], v0, s[70:71] offset:0
 v_mfma_f32_16x16x32_bf16 v[176:179], a[216:219], a[144:147], v[176:179]
 v_mfma_f32_16x16x32_bf16 v[176:179], a[220:223], a[148:151], v[176:179]
 v_mfma_f32_16x16x32_bf16 v[180:183], a[220:223], a[156:159], v[180:183]
 v_mfma_f32_16x16x32_bf16 v[180:183], a[216:219], a[152:155], v[180:183]
 v_mfma_f32_16x16x32_bf16 v[184:187], a[216:219], a[160:163], v[184:187]
 v_mfma_f32_16x16x32_bf16 v[184:187], a[220:223], a[164:167], v[184:187]
 v_mfma_f32_16x16x32_bf16 v[188:191], a[220:223], a[172:175], v[188:191]
 buffer_load_dwordx4 v3, s[32:35], s30 offen sc1 lds
 v_mfma_f32_16x16x32_bf16 v[188:191], a[216:219], a[168:171], v[188:191]
 v_mfma_f32_16x16x32_bf16 v[192:195], a[216:219], a[176:179], v[192:195]
 v_mfma_f32_16x16x32_bf16 v[192:195], a[220:223], a[180:183], v[192:195]
 v_mfma_f32_16x16x32_bf16 v[196:199], a[220:223], a[188:191], v[196:199]
 v_mfma_f32_16x16x32_bf16 v[196:199], a[216:219], a[184:187], v[196:199]
 s_waitcnt vmcnt(12)
 v_mfma_f32_16x16x32_bf16 v[228:231], a[224:227], a[184:187], v[228:231]
 v_mfma_f32_16x16x32_bf16 v[228:231], a[228:231], a[188:191], v[228:231]
 global_load_dwordx4 a[220:223], v0, s[70:71] offset:3072
 v_mfma_f32_16x16x32_bf16 v[224:227], a[228:231], a[180:183], v[224:227]
 v_mfma_f32_16x16x32_bf16 v[224:227], a[224:227], a[176:179], v[224:227]
 global_load_dwordx4 a[216:219], v0, s[70:71] offset:2048
 v_mfma_f32_16x16x32_bf16 v[220:223], a[224:227], a[168:171], v[220:223]
 buffer_load_dwordx4 v3, s[32:35], s30 offen offset:1024 sc1 lds
 s_add_u32 s70, s70, 8192
 s_addc_u32 s71, s71, 0
 v_mfma_f32_16x16x32_bf16 v[220:223], a[228:231], a[172:175], v[220:223]
 v_mfma_f32_16x16x32_bf16 v[216:219], a[228:231], a[164:167], v[216:219]
 v_mfma_f32_16x16x32_bf16 v[216:219], a[224:227], a[160:163], v[216:219]
 v_mfma_f32_16x16x32_bf16 v[212:215], a[224:227], a[152:155], v[212:215]
 v_mfma_f32_16x16x32_bf16 v[212:215], a[228:231], a[156:159], v[212:215]
 v_mfma_f32_16x16x32_bf16 v[208:211], a[228:231], a[148:151], v[208:211]
 v_mfma_f32_16x16x32_bf16 v[208:211], a[224:227], a[144:147], v[208:211]
 v_mfma_f32_16x16x32_bf16 v[204:207], a[224:227], a[136:139], v[204:207]
 v_mfma_f32_16x16x32_bf16 v[204:207], a[228:231], a[140:143], v[204:207]
 s_add_u32 m0, m0, 4096
 v_mfma_f32_16x16x32_bf16 v[200:203], a[228:231], a[132:135], v[200:203]
 v_mfma_f32_16x16x32_bf16 v[200:203], a[224:227], a[128:131], v[200:203]
 s_waitcnt vmcnt(12)
 v_mfma_f32_16x16x32_bf16 v[232:235], a[232:235], a[128:131], v[232:235]
 ds_read_b128 a[128:131], v2 offset:2048
 v_mfma_f32_16x16x32_bf16 v[232:235], a[236:239], a[132:135], v[232:235]
 global_load_dwordx4 a[228:231], v0, s[70:71] offset:-3072
 ds_read_b128 a[132:135], v2 offset:3072
 v_mfma_f32_16x16x32_bf16 v[236:239], a[236:239], a[140:143], v[236:239]
 ds_read_b128 a[140:143], v2 offset:7168
 v_mfma_f32_16x16x32_bf16 v[236:239], a[232:235], a[136:139], v[236:239]
 global_load_dwordx4 a[224:227], v0, s[70:71] offset:-4096
 ds_read_b128 a[136:139], v2 offset:6144
 v_mfma_f32_16x16x32_bf16 v[240:243], a[232:235], a[144:147], v[240:243]
 ds_read_b128 a[144:147], v2 offset:10240
 v_mfma_f32_16x16x32_bf16 v[240:243], a[236:239], a[148:151], v[240:243]
 ds_read_b128 a[148:151], v2 offset:11264
 v_mfma_f32_16x16x32_bf16 v[244:247], a[236:239], a[156:159], v[244:247]
 ds_read_b128 a[156:159], v2 offset:15360
 v_mfma_f32_16x16x32_bf16 v[244:247], a[232:235], a[152:155], v[244:247]
 ds_read_b128 a[152:155], v2 offset:14336
 s_add_u32 s30, s30, 2048
 v_mfma_f32_16x16x32_bf16 v[248:251], a[232:235], a[160:163], v[248:251]
 ds_read_b128 a[160:163], v2 offset:18432
 v_mfma_f32_16x16x32_bf16 v[248:251], a[236:239], a[164:167], v[248:251]
 ds_read_b128 a[164:167], v2 offset:19456
 v_mfma_f32_16x16x32_bf16 v[252:255], a[236:239], a[172:175], v[252:255]
 ds_read_b128 a[172:175], v2 offset:23552
 v_mfma_f32_16x16x32_bf16 v[252:255], a[232:235], a[168:171], v[252:255]
 ds_read_b128 a[168:171], v2 offset:22528
 v_mfma_f32_16x16x32_bf16 a[248:251], a[232:235], a[176:179], a[248:251]
 ds_read_b128 a[176:179], v2 offset:26624
 v_mfma_f32_16x16x32_bf16 a[248:251], a[236:239], a[180:183], a[248:251]
 ds_read_b128 a[180:183], v2 offset:27648
 v_mfma_f32_16x16x32_bf16 a[252:255], a[236:239], a[188:191], a[252:255]
 ds_read_b128 a[188:191], v2 offset:31744
 v_mfma_f32_16x16x32_bf16 a[252:255], a[232:235], a[184:187], a[252:255]
 ds_read_b128 a[184:187], v2 offset:30720
 s_waitcnt vmcnt(11) lgkmcnt(8)
 v_mfma_f32_16x16x32_bf16 v[16:19], a[192:195], a[128:131], v[16:19]
 buffer_load_dwordx4 v3, s[32:35], s30 offen sc1 lds
 v_mfma_f32_16x16x32_bf16 v[16:19], a[196:199], a[132:135], v[16:19]
 global_load_dwordx4 a[236:239], v0, s[70:71] offset:-1024
 v_mfma_f32_16x16x32_bf16 v[20:23], a[196:199], a[140:143], v[20:23]
 v_mfma_f32_16x16x32_bf16 v[20:23], a[192:195], a[136:139], v[20:23]
 global_load_dwordx4 a[232:235], v0, s[70:71] offset:-2048
 v_mfma_f32_16x16x32_bf16 v[24:27], a[192:195], a[144:147], v[24:27]
 v_mfma_f32_16x16x32_bf16 v[24:27], a[196:199], a[148:151], v[24:27]
 v_mfma_f32_16x16x32_bf16 v[28:31], a[196:199], a[156:159], v[28:31]
 v_mfma_f32_16x16x32_bf16 v[28:31], a[192:195], a[152:155], v[28:31]
 s_waitcnt lgkmcnt(0)
 v_mfma_f32_16x16x32_bf16 v[32:35], a[192:195], a[160:163], v[32:35]
 v_mfma_f32_16x16x32_bf16 v[32:35], a[196:199], a[164:167], v[32:35]
 v_mfma_f32_16x16x32_bf16 v[36:39], a[196:199], a[172:175], v[36:39]
 buffer_load_dwordx4 v3, s[32:35], s30 offen offset:1024 sc1 lds
 v_mfma_f32_16x16x32_bf16 v[36:39], a[192:195], a[168:171], v[36:39]
 v_mfma_f32_16x16x32_bf16 v[40:43], a[192:195], a[176:179], v[40:43]
 v_mfma_f32_16x16x32_bf16 v[40:43], a[196:199], a[180:183], v[40:43]
 v_mfma_f32_16x16x32_bf16 v[44:47], a[196:199], a[188:191], v[44:47]
 v_mfma_f32_16x16x32_bf16 v[44:47], a[192:195], a[184:187], v[44:47]
 s_waitcnt vmcnt(12)
 v_mfma_f32_16x16x32_bf16 v[76:79], a[200:203], a[184:187], v[76:79]
 v_mfma_f32_16x16x32_bf16 v[76:79], a[204:207], a[188:191], v[76:79]
 global_load_dwordx4 a[196:199], v0, s[70:71] offset:1024
 v_mfma_f32_16x16x32_bf16 v[72:75], a[204:207], a[180:183], v[72:75]
 v_mfma_f32_16x16x32_bf16 v[72:75], a[200:203], a[176:179], v[72:75]
 global_load_dwordx4 a[192:195], v0, s[70:71] offset:0
 v_mfma_f32_16x16x32_bf16 v[68:71], a[200:203], a[168:171], v[68:71]
 s_add_u32 m0, m0, 4096
 v_mfma_f32_16x16x32_bf16 v[68:71], a[204:207], a[172:175], v[68:71]
 v_mfma_f32_16x16x32_bf16 v[64:67], a[204:207], a[164:167], v[64:67]
 v_mfma_f32_16x16x32_bf16 v[64:67], a[200:203], a[160:163], v[64:67]
 v_mfma_f32_16x16x32_bf16 v[60:63], a[200:203], a[152:155], v[60:63]
 v_mfma_f32_16x16x32_bf16 v[60:63], a[204:207], a[156:159], v[60:63]
 v_mfma_f32_16x16x32_bf16 v[56:59], a[204:207], a[148:151], v[56:59]
 v_mfma_f32_16x16x32_bf16 v[56:59], a[200:203], a[144:147], v[56:59]
 v_mfma_f32_16x16x32_bf16 v[52:55], a[200:203], a[136:139], v[52:55]
 v_mfma_f32_16x16x32_bf16 v[52:55], a[204:207], a[140:143], v[52:55]
 v_mfma_f32_16x16x32_bf16 v[48:51], a[204:207], a[132:135], v[48:51]
 s_add_u32 s30, s30, 2048
 v_mfma_f32_16x16x32_bf16 v[48:51], a[200:203], a[128:131], v[48:51]
 s_waitcnt vmcnt(12)
 v_mfma_f32_16x16x32_bf16 v[80:83], a[208:211], a[128:131], v[80:83]
 v_mfma_f32_16x16x32_bf16 v[80:83], a[212:215], a[132:135], v[80:83]
 global_load_dwordx4 a[204:207], v0, s[70:71] offset:3072
 v_mfma_f32_16x16x32_bf16 v[84:87], a[212:215], a[140:143], v[84:87]
 v_mfma_f32_16x16x32_bf16 v[84:87], a[208:211], a[136:139], v[84:87]
 global_load_dwordx4 a[200:203], v0, s[70:71] offset:2048
 v_mfma_f32_16x16x32_bf16 v[88:91], a[208:211], a[144:147], v[88:91]
 s_add_u32 s70, s70, 8192
 s_addc_u32 s71, s71, 0
 v_mfma_f32_16x16x32_bf16 v[88:91], a[212:215], a[148:151], v[88:91]
 v_mfma_f32_16x16x32_bf16 v[92:95], a[212:215], a[156:159], v[92:95]
 v_mfma_f32_16x16x32_bf16 v[92:95], a[208:211], a[152:155], v[92:95]
 buffer_load_dwordx4 v3, s[32:35], s30 offen sc1 lds
 v_mfma_f32_16x16x32_bf16 v[96:99], a[208:211], a[160:163], v[96:99]
 v_mfma_f32_16x16x32_bf16 v[96:99], a[212:215], a[164:167], v[96:99]
 v_mfma_f32_16x16x32_bf16 v[100:103], a[212:215], a[172:175], v[100:103]
 v_mfma_f32_16x16x32_bf16 v[100:103], a[208:211], a[168:171], v[100:103]
 v_mfma_f32_16x16x32_bf16 v[104:107], a[208:211], a[176:179], v[104:107]
 v_mfma_f32_16x16x32_bf16 v[104:107], a[212:215], a[180:183], v[104:107]
 v_mfma_f32_16x16x32_bf16 v[108:111], a[212:215], a[188:191], v[108:111]
 v_mfma_f32_16x16x32_bf16 v[108:111], a[208:211], a[184:187], v[108:111]
 s_waitcnt vmcnt(12)
 v_mfma_f32_16x16x32_bf16 a[244:247], a[216:219], a[184:187], a[244:247]
 buffer_load_dwordx4 v3, s[32:35], s30 offen offset:1024 sc1 lds
 v_mfma_f32_16x16x32_bf16 a[244:247], a[220:223], a[188:191], a[244:247]
 global_load_dwordx4 a[212:215], v0, s[70:71] offset:-3072
 v_mfma_f32_16x16x32_bf16 a[240:243], a[220:223], a[180:183], a[240:243]
 v_mfma_f32_16x16x32_bf16 a[240:243], a[216:219], a[176:179], a[240:243]
 global_load_dwordx4 a[208:211], v0, s[70:71] offset:-4096
 v_mfma_f32_16x16x32_bf16 v[132:135], a[216:219], a[168:171], v[132:135]
 v_mfma_f32_16x16x32_bf16 v[132:135], a[220:223], a[172:175], v[132:135]
 v_mfma_f32_16x16x32_bf16 v[128:131], a[220:223], a[164:167], v[128:131]
 v_mfma_f32_16x16x32_bf16 v[128:131], a[216:219], a[160:163], v[128:131]
 v_mfma_f32_16x16x32_bf16 v[124:127], a[216:219], a[152:155], v[124:127]
 v_mfma_f32_16x16x32_bf16 v[124:127], a[220:223], a[156:159], v[124:127]
 v_mfma_f32_16x16x32_bf16 v[120:123], a[220:223], a[148:151], v[120:123]
 v_mfma_f32_16x16x32_bf16 v[120:123], a[216:219], a[144:147], v[120:123]
 s_add_u32 s30, s30, 2048
 v_mfma_f32_16x16x32_bf16 v[116:119], a[216:219], a[136:139], v[116:119]
 v_mfma_f32_16x16x32_bf16 v[116:119], a[220:223], a[140:143], v[116:119]
 v_mfma_f32_16x16x32_bf16 v[112:115], a[220:223], a[132:135], v[112:115]
 v_mfma_f32_16x16x32_bf16 v[112:115], a[216:219], a[128:131], v[112:115]
 s_waitcnt vmcnt(12)
 v_mfma_f32_16x16x32_bf16 v[136:139], a[224:227], a[128:131], v[136:139]
 v_mfma_f32_16x16x32_bf16 v[136:139], a[228:231], a[132:135], v[136:139]
 global_load_dwordx4 a[220:223], v0, s[70:71] offset:-1024
 v_mfma_f32_16x16x32_bf16 v[140:143], a[228:231], a[140:143], v[140:143]
 v_mfma_f32_16x16x32_bf16 v[140:143], a[224:227], a[136:139], v[140:143]
 global_load_dwordx4 a[216:219], v0, s[70:71] offset:-2048
 v_mfma_f32_16x16x32_bf16 v[144:147], a[224:227], a[144:147], v[144:147]
 v_mfma_f32_16x16x32_bf16 v[144:147], a[228:231], a[148:151], v[144:147]
 v_mfma_f32_16x16x32_bf16 v[148:151], a[228:231], a[156:159], v[148:151]
 v_mfma_f32_16x16x32_bf16 v[148:151], a[224:227], a[152:155], v[148:151]
 v_mfma_f32_16x16x32_bf16 v[152:155], a[224:227], a[160:163], v[152:155]
 v_mfma_f32_16x16x32_bf16 v[152:155], a[228:231], a[164:167], v[152:155]
 v_mfma_f32_16x16x32_bf16 v[156:159], a[228:231], a[172:175], v[156:159]
 v_mfma_f32_16x16x32_bf16 v[156:159], a[224:227], a[168:171], v[156:159]
 v_mfma_f32_16x16x32_bf16 v[160:163], a[224:227], a[176:179], v[160:163]
 v_mfma_f32_16x16x32_bf16 v[160:163], a[228:231], a[180:183], v[160:163]
 v_mfma_f32_16x16x32_bf16 v[164:167], a[228:231], a[188:191], v[164:167]
 v_mfma_f32_16x16x32_bf16 v[164:167], a[224:227], a[184:187], v[164:167]
 s_waitcnt vmcnt(11)
 v_mfma_f32_16x16x32_bf16 v[196:199], a[232:235], a[184:187], v[196:199]
 v_mfma_f32_16x16x32_bf16 v[196:199], a[236:239], a[188:191], v[196:199]
 global_load_dwordx4 a[228:231], v0, s[70:71] offset:1024
 v_mfma_f32_16x16x32_bf16 v[192:195], a[236:239], a[180:183], v[192:195]
 v_mfma_f32_16x16x32_bf16 v[192:195], a[232:235], a[176:179], v[192:195]
 global_load_dwordx4 a[224:227], v0, s[70:71] offset:0
 v_mfma_f32_16x16x32_bf16 v[188:191], a[232:235], a[168:171], v[188:191]
 v_mfma_f32_16x16x32_bf16 v[188:191], a[236:239], a[172:175], v[188:191]
 v_mfma_f32_16x16x32_bf16 v[184:187], a[236:239], a[164:167], v[184:187]
 v_mfma_f32_16x16x32_bf16 v[184:187], a[232:235], a[160:163], v[184:187]
 v_mfma_f32_16x16x32_bf16 v[180:183], a[232:235], a[152:155], v[180:183]
 v_mfma_f32_16x16x32_bf16 v[180:183], a[236:239], a[156:159], v[180:183]
 v_mfma_f32_16x16x32_bf16 v[176:179], a[236:239], a[148:151], v[176:179]
 v_mfma_f32_16x16x32_bf16 v[176:179], a[232:235], a[144:147], v[176:179]
 v_mfma_f32_16x16x32_bf16 v[172:175], a[232:235], a[136:139], v[172:175]
 v_mfma_f32_16x16x32_bf16 v[172:175], a[236:239], a[140:143], v[172:175]
 v_mfma_f32_16x16x32_bf16 v[168:171], a[236:239], a[132:135], v[168:171]
 v_mfma_f32_16x16x32_bf16 v[168:171], a[232:235], a[128:131], v[168:171]
 s_waitcnt vmcnt(10)
 v_mfma_f32_16x16x32_bf16 v[200:203], a[192:195], a[128:131], v[200:203]
 v_mfma_f32_16x16x32_bf16 v[200:203], a[196:199], a[132:135], v[200:203]
 global_load_dwordx4 a[236:239], v0, s[70:71] offset:3072
 v_mfma_f32_16x16x32_bf16 v[204:207], a[196:199], a[140:143], v[204:207]
 v_mfma_f32_16x16x32_bf16 v[204:207], a[192:195], a[136:139], v[204:207]
 global_load_dwordx4 a[232:235], v0, s[70:71] offset:2048
 v_mfma_f32_16x16x32_bf16 v[208:211], a[192:195], a[144:147], v[208:211]
 s_add_u32 s70, s70, 8192
 s_addc_u32 s71, s71, 0
 v_mfma_f32_16x16x32_bf16 v[208:211], a[196:199], a[148:151], v[208:211]
 v_mfma_f32_16x16x32_bf16 v[212:215], a[196:199], a[156:159], v[212:215]
 v_mfma_f32_16x16x32_bf16 v[212:215], a[192:195], a[152:155], v[212:215]
 v_mfma_f32_16x16x32_bf16 v[216:219], a[192:195], a[160:163], v[216:219]
 v_mfma_f32_16x16x32_bf16 v[216:219], a[196:199], a[164:167], v[216:219]
 v_mfma_f32_16x16x32_bf16 v[220:223], a[196:199], a[172:175], v[220:223]
 v_mfma_f32_16x16x32_bf16 v[220:223], a[192:195], a[168:171], v[220:223]
 v_mfma_f32_16x16x32_bf16 v[224:227], a[192:195], a[176:179], v[224:227]
 v_mfma_f32_16x16x32_bf16 v[224:227], a[196:199], a[180:183], v[224:227]
 v_mfma_f32_16x16x32_bf16 v[228:231], a[196:199], a[188:191], v[228:231]
 v_mfma_f32_16x16x32_bf16 v[228:231], a[192:195], a[184:187], v[228:231]
 s_waitcnt vmcnt(10)
 v_mfma_f32_16x16x32_bf16 a[252:255], a[200:203], a[184:187], a[252:255]
 ds_read_b128 a[184:187], v2 offset:63488
 v_mfma_f32_16x16x32_bf16 a[252:255], a[204:207], a[188:191], a[252:255]
 global_load_dwordx4 a[196:199], v0, s[70:71] offset:-3072
 ds_read_b128 a[188:191], v2 offset:64512
 v_mfma_f32_16x16x32_bf16 a[248:251], a[204:207], a[180:183], a[248:251]
 ds_read_b128 a[180:183], v2 offset:60416
 v_mfma_f32_16x16x32_bf16 a[248:251], a[200:203], a[176:179], a[248:251]
 global_load_dwordx4 a[192:195], v0, s[70:71] offset:-4096
 ds_read_b128 a[176:179], v2 offset:59392
 v_mfma_f32_16x16x32_bf16 v[252:255], a[200:203], a[168:171], v[252:255]
 ds_read_b128 a[168:171], v2 offset:55296
 v_mfma_f32_16x16x32_bf16 v[252:255], a[204:207], a[172:175], v[252:255]
 ds_read_b128 a[172:175], v2 offset:56320
 v_mfma_f32_16x16x32_bf16 v[248:251], a[204:207], a[164:167], v[248:251]
 ds_read_b128 a[164:167], v2 offset:52224
 v_mfma_f32_16x16x32_bf16 v[248:251], a[200:203], a[160:163], v[248:251]
 ds_read_b128 a[160:163], v2 offset:51200
 v_mfma_f32_16x16x32_bf16 v[244:247], a[200:203], a[152:155], v[244:247]
 ds_read_b128 a[152:155], v2 offset:47104
 v_mfma_f32_16x16x32_bf16 v[244:247], a[204:207], a[156:159], v[244:247]
 ds_read_b128 a[156:159], v2 offset:48128
 v_mfma_f32_16x16x32_bf16 v[240:243], a[204:207], a[148:151], v[240:243]
 ds_read_b128 a[148:151], v2 offset:44032
 v_mfma_f32_16x16x32_bf16 v[240:243], a[200:203], a[144:147], v[240:243]
 ds_read_b128 a[144:147], v2 offset:43008
 v_mfma_f32_16x16x32_bf16 v[236:239], a[200:203], a[136:139], v[236:239]
 ds_read_b128 a[136:139], v2 offset:38912
 v_mfma_f32_16x16x32_bf16 v[236:239], a[204:207], a[140:143], v[236:239]
 ds_read_b128 a[140:143], v2 offset:39936
 v_mfma_f32_16x16x32_bf16 v[232:235], a[204:207], a[132:135], v[232:235]
 ds_read_b128 a[132:135], v2 offset:35840
 v_mfma_f32_16x16x32_bf16 v[232:235], a[200:203], a[128:131], v[232:235]
 ds_read_b128 a[128:131], v2 offset:34816
 s_waitcnt vmcnt(8) lgkmcnt(8)
 v_mfma_f32_16x16x32_bf16 v[44:47], a[208:211], a[184:187], v[44:47]
 v_mfma_f32_16x16x32_bf16 v[44:47], a[212:215], a[188:191], v[44:47]
 global_load_dwordx4 a[204:207], v0, s[70:71] offset:-1024
 v_mfma_f32_16x16x32_bf16 v[40:43], a[212:215], a[180:183], v[40:43]
 buffer_load_dword v4, off, s[64:67], 0 sc1
 v_mfma_f32_16x16x32_bf16 v[40:43], a[208:211], a[176:179], v[40:43]
 global_load_dwordx4 a[200:203], v0, s[70:71] offset:-2048
 v_mfma_f32_16x16x32_bf16 v[36:39], a[208:211], a[168:171], v[36:39]
 v_mfma_f32_16x16x32_bf16 v[36:39], a[212:215], a[172:175], v[36:39]
 v_mfma_f32_16x16x32_bf16 v[32:35], a[212:215], a[164:167], v[32:35]
 v_mfma_f32_16x16x32_bf16 v[32:35], a[208:211], a[160:163], v[32:35]
 s_waitcnt lgkmcnt(0)
 v_mfma_f32_16x16x32_bf16 v[28:31], a[208:211], a[152:155], v[28:31]
 v_mfma_f32_16x16x32_bf16 v[28:31], a[212:215], a[156:159], v[28:31]
 v_mfma_f32_16x16x32_bf16 v[24:27], a[212:215], a[148:151], v[24:27]
 v_mfma_f32_16x16x32_bf16 v[24:27], a[208:211], a[144:147], v[24:27]
 v_mfma_f32_16x16x32_bf16 v[20:23], a[208:211], a[136:139], v[20:23]
 v_mfma_f32_16x16x32_bf16 v[20:23], a[212:215], a[140:143], v[20:23]
 v_mfma_f32_16x16x32_bf16 v[16:19], a[212:215], a[132:135], v[16:19]
 v_mfma_f32_16x16x32_bf16 v[16:19], a[208:211], a[128:131], v[16:19]
 s_waitcnt vmcnt(9)
 v_mfma_f32_16x16x32_bf16 v[48:51], a[216:219], a[128:131], v[48:51]
 v_lshrrev_b32 v5, 6, v1
 v_mfma_f32_16x16x32_bf16 v[48:51], a[220:223], a[132:135], v[48:51]
 global_load_dwordx4 a[212:215], v0, s[70:71] offset:1024
 v_mfma_f32_16x16x32_bf16 v[52:55], a[220:223], a[140:143], v[52:55]
 v_and_b32 v6, 48, v1
 v_mfma_f32_16x16x32_bf16 v[52:55], a[216:219], a[136:139], v[52:55]
 global_load_dwordx4 a[208:211], v0, s[70:71] offset:0
 v_lshl_add_u32 v5, v5, 11, v6
 v_mfma_f32_16x16x32_bf16 v[56:59], a[216:219], a[144:147], v[56:59]
 v_mfma_f32_16x16x32_bf16 v[56:59], a[220:223], a[148:151], v[56:59]
 s_mov_b32 m0, s52
 v_mfma_f32_16x16x32_bf16 v[60:63], a[220:223], a[156:159], v[60:63]
 s_add_u32 s3, s48, 31744
 v_mfma_f32_16x16x32_bf16 v[60:63], a[216:219], a[152:155], v[60:63]
 v_mfma_f32_16x16x32_bf16 v[64:67], a[216:219], a[160:163], v[64:67]
 buffer_load_dwordx4 v5, s[40:43], s48 offen lds
 v_mfma_f32_16x16x32_bf16 v[64:67], a[220:223], a[164:167], v[64:67]
 buffer_load_dwordx4 v5, s[40:43], s3 offen offset:1024 lds
 v_mfma_f32_16x16x32_bf16 v[68:71], a[220:223], a[172:175], v[68:71]
 v_mfma_f32_16x16x32_bf16 v[68:71], a[216:219], a[168:171], v[68:71]
 s_add_u32 s48, s48, 2097152
 v_mfma_f32_16x16x32_bf16 v[72:75], a[216:219], a[176:179], v[72:75]
 v_mfma_f32_16x16x32_bf16 v[72:75], a[220:223], a[180:183], v[72:75]
 v_mfma_f32_16x16x32_bf16 v[76:79], a[220:223], a[188:191], v[76:79]
 v_mfma_f32_16x16x32_bf16 v[76:79], a[216:219], a[184:187], v[76:79]
 s_waitcnt vmcnt(11)
 v_mfma_f32_16x16x32_bf16 v[108:111], a[224:227], a[184:187], v[108:111]
 v_mfma_f32_16x16x32_bf16 v[108:111], a[228:231], a[188:191], v[108:111]
 global_load_dwordx4 a[220:223], v0, s[70:71] offset:3072
 v_mfma_f32_16x16x32_bf16 v[104:107], a[228:231], a[180:183], v[104:107]
 v_mfma_f32_16x16x32_bf16 v[104:107], a[224:227], a[176:179], v[104:107]
 global_load_dwordx4 a[216:219], v0, s[70:71] offset:2048
 v_mfma_f32_16x16x32_bf16 v[100:103], a[224:227], a[168:171], v[100:103]
 s_add_u32 s70, s70, 8192
 s_addc_u32 s71, s71, 0
 v_mfma_f32_16x16x32_bf16 v[100:103], a[228:231], a[172:175], v[100:103]
 v_mfma_f32_16x16x32_bf16 v[96:99], a[228:231], a[164:167], v[96:99]
 v_mfma_f32_16x16x32_bf16 v[96:99], a[224:227], a[160:163], v[96:99]
 v_mfma_f32_16x16x32_bf16 v[92:95], a[224:227], a[152:155], v[92:95]
 v_mfma_f32_16x16x32_bf16 v[92:95], a[228:231], a[156:159], v[92:95]
 v_mfma_f32_16x16x32_bf16 v[88:91], a[228:231], a[148:151], v[88:91]
 v_mfma_f32_16x16x32_bf16 v[88:91], a[224:227], a[144:147], v[88:91]
 v_mfma_f32_16x16x32_bf16 v[84:87], a[224:227], a[136:139], v[84:87]
 v_mfma_f32_16x16x32_bf16 v[84:87], a[228:231], a[140:143], v[84:87]
 v_mfma_f32_16x16x32_bf16 v[80:83], a[228:231], a[132:135], v[80:83]
 v_mfma_f32_16x16x32_bf16 v[80:83], a[224:227], a[128:131], v[80:83]
 s_waitcnt vmcnt(11)
 v_mfma_f32_16x16x32_bf16 v[112:115], a[232:235], a[128:131], v[112:115]
 v_mfma_f32_16x16x32_bf16 v[112:115], a[236:239], a[132:135], v[112:115]
 global_load_dwordx4 a[228:231], v0, s[70:71] offset:-3072
 v_mfma_f32_16x16x32_bf16 v[116:119], a[236:239], a[140:143], v[116:119]
 v_mfma_f32_16x16x32_bf16 v[116:119], a[232:235], a[136:139], v[116:119]
 global_load_dwordx4 a[224:227], v0, s[70:71] offset:-4096
 v_mfma_f32_16x16x32_bf16 v[120:123], a[232:235], a[144:147], v[120:123]
 v_mfma_f32_16x16x32_bf16 v[120:123], a[236:239], a[148:151], v[120:123]
 v_mfma_f32_16x16x32_bf16 v[124:127], a[236:239], a[156:159], v[124:127]
 v_mfma_f32_16x16x32_bf16 v[124:127], a[232:235], a[152:155], v[124:127]
 v_mfma_f32_16x16x32_bf16 v[128:131], a[232:235], a[160:163], v[128:131]
 v_mfma_f32_16x16x32_bf16 v[128:131], a[236:239], a[164:167], v[128:131]
 v_mfma_f32_16x16x32_bf16 v[132:135], a[236:239], a[172:175], v[132:135]
 v_mfma_f32_16x16x32_bf16 v[132:135], a[232:235], a[168:171], v[132:135]
 v_mfma_f32_16x16x32_bf16 a[240:243], a[232:235], a[176:179], a[240:243]
 v_mfma_f32_16x16x32_bf16 a[240:243], a[236:239], a[180:183], a[240:243]
 v_mfma_f32_16x16x32_bf16 a[244:247], a[236:239], a[188:191], a[244:247]
 v_mfma_f32_16x16x32_bf16 a[244:247], a[232:235], a[184:187], a[244:247]
 s_waitcnt vmcnt(11)
 v_mfma_f32_16x16x32_bf16 v[164:167], a[192:195], a[184:187], v[164:167]
 v_mfma_f32_16x16x32_bf16 v[164:167], a[196:199], a[188:191], v[164:167]
 global_load_dwordx4 a[236:239], v0, s[70:71] offset:-1024
 v_mfma_f32_16x16x32_bf16 v[160:163], a[196:199], a[180:183], v[160:163]
 v_mfma_f32_16x16x32_bf16 v[160:163], a[192:195], a[176:179], v[160:163]
 global_load_dwordx4 a[232:235], v0, s[70:71] offset:-2048
 v_mfma_f32_16x16x32_bf16 v[156:159], a[192:195], a[168:171], v[156:159]
 v_mfma_f32_16x16x32_bf16 v[156:159], a[196:199], a[172:175], v[156:159]
 v_mfma_f32_16x16x32_bf16 v[152:155], a[196:199], a[164:167], v[152:155]
 v_mfma_f32_16x16x32_bf16 v[152:155], a[192:195], a[160:163], v[152:155]
 v_mfma_f32_16x16x32_bf16 v[148:151], a[192:195], a[152:155], v[148:151]
 v_mfma_f32_16x16x32_bf16 v[148:151], a[196:199], a[156:159], v[148:151]
 v_mfma_f32_16x16x32_bf16 v[144:147], a[196:199], a[148:151], v[144:147]
 v_mfma_f32_16x16x32_bf16 v[144:147], a[192:195], a[144:147], v[144:147]
 v_mfma_f32_16x16x32_bf16 v[140:143], a[192:195], a[136:139], v[140:143]
 v_mfma_f32_16x16x32_bf16 v[140:143], a[196:199], a[140:143], v[140:143]
 v_mfma_f32_16x16x32_bf16 v[136:139], a[196:199], a[132:135], v[136:139]
 v_mfma_f32_16x16x32_bf16 v[136:139], a[192:195], a[128:131], v[136:139]
 s_waitcnt vmcnt(10)
 v_mfma_f32_16x16x32_bf16 v[168:171], a[200:203], a[128:131], v[168:171]
 v_mfma_f32_16x16x32_bf16 v[168:171], a[204:207], a[132:135], v[168:171]
 global_load_dwordx4 a[196:199], v0, s[70:71] offset:1024
 v_mfma_f32_16x16x32_bf16 v[172:175], a[204:207], a[140:143], v[172:175]
 v_mfma_f32_16x16x32_bf16 v[172:175], a[200:203], a[136:139], v[172:175]
 global_load_dwordx4 a[192:195], v0, s[70:71] offset:0
 v_mfma_f32_16x16x32_bf16 v[176:179], a[200:203], a[144:147], v[176:179]
 v_mfma_f32_16x16x32_bf16 v[176:179], a[204:207], a[148:151], v[176:179]
 v_mfma_f32_16x16x32_bf16 v[180:183], a[204:207], a[156:159], v[180:183]
 v_mfma_f32_16x16x32_bf16 v[180:183], a[200:203], a[152:155], v[180:183]
 v_mfma_f32_16x16x32_bf16 v[184:187], a[200:203], a[160:163], v[184:187]
 v_mfma_f32_16x16x32_bf16 v[184:187], a[204:207], a[164:167], v[184:187]
 v_mfma_f32_16x16x32_bf16 v[188:191], a[204:207], a[172:175], v[188:191]
 v_mfma_f32_16x16x32_bf16 v[188:191], a[200:203], a[168:171], v[188:191]
 v_mfma_f32_16x16x32_bf16 v[192:195], a[200:203], a[176:179], v[192:195]
 v_mfma_f32_16x16x32_bf16 v[192:195], a[204:207], a[180:183], v[192:195]
 v_mfma_f32_16x16x32_bf16 v[196:199], a[204:207], a[188:191], v[196:199]
 v_mfma_f32_16x16x32_bf16 v[196:199], a[200:203], a[184:187], v[196:199]
 s_waitcnt vmcnt(10)
 v_mfma_f32_16x16x32_bf16 v[228:231], a[208:211], a[184:187], v[228:231]
 v_mfma_f32_16x16x32_bf16 v[228:231], a[212:215], a[188:191], v[228:231]
 global_load_dwordx4 a[204:207], v0, s[70:71] offset:3072
 v_mfma_f32_16x16x32_bf16 v[224:227], a[212:215], a[180:183], v[224:227]
 v_mfma_f32_16x16x32_bf16 v[224:227], a[208:211], a[176:179], v[224:227]
 global_load_dwordx4 a[200:203], v0, s[70:71] offset:2048
 v_mfma_f32_16x16x32_bf16 v[220:223], a[208:211], a[168:171], v[220:223]
 s_add_u32 s70, s70, 8192
 s_addc_u32 s71, s71, 0
 v_mfma_f32_16x16x32_bf16 v[220:223], a[212:215], a[172:175], v[220:223]
 v_mfma_f32_16x16x32_bf16 v[216:219], a[212:215], a[164:167], v[216:219]
 v_mfma_f32_16x16x32_bf16 v[216:219], a[208:211], a[160:163], v[216:219]
 v_mfma_f32_16x16x32_bf16 v[212:215], a[208:211], a[152:155], v[212:215]
 v_mfma_f32_16x16x32_bf16 v[212:215], a[212:215], a[156:159], v[212:215]
 v_mfma_f32_16x16x32_bf16 v[208:211], a[212:215], a[148:151], v[208:211]
 v_cmp_gt_u32 vcc, s55, v4
 s_cbranch_vccnz Lspin_pb
Lok_pb:
 s_add_u32 s55, s55, 1
 s_waitcnt lgkmcnt(0)
 s_barrier
 v_mfma_f32_16x16x32_bf16 v[208:211], a[208:211], a[144:147], v[208:211]
 v_mfma_f32_16x16x32_bf16 v[204:207], a[208:211], a[136:139], v[204:207]
 v_mfma_f32_16x16x32_bf16 v[204:207], a[212:215], a[140:143], v[204:207]
 v_mfma_f32_16x16x32_bf16 v[200:203], a[212:215], a[132:135], v[200:203]
 v_mfma_f32_16x16x32_bf16 v[200:203], a[208:211], a[128:131], v[200:203]
 s_waitcnt vmcnt(8)
 v_mfma_f32_16x16x32_bf16 v[232:235], a[216:219], a[128:131], v[232:235]
 ds_read_b128 a[128:131], v1
 v_mfma_f32_16x16x32_bf16 v[232:235], a[220:223], a[132:135], v[232:235]
 global_load_dwordx4 a[212:215], v0, s[70:71] offset:-3072
 ds_read_b128 a[132:135], v1 offset:1024
 v_mfma_f32_16x16x32_bf16 v[236:239], a[220:223], a[140:143], v[236:239]
 ds_read_b128 a[140:143], v1 offset:5120
 v_mfma_f32_16x16x32_bf16 v[236:239], a[216:219], a[136:139], v[236:239]
 global_load_dwordx4 a[208:211], v0, s[70:71] offset:-4096
 ds_read_b128 a[136:139], v1 offset:4096
 v_mfma_f32_16x16x32_bf16 v[240:243], a[216:219], a[144:147], v[240:243]
 ds_read_b128 a[144:147], v1 offset:8192
 v_mfma_f32_16x16x32_bf16 v[240:243], a[220:223], a[148:151], v[240:243]
 ds_read_b128 a[148:151], v1 offset:9216
 v_mfma_f32_16x16x32_bf16 v[244:247], a[220:223], a[156:159], v[244:247]
 ds_read_b128 a[156:159], v1 offset:13312
 v_mfma_f32_16x16x32_bf16 v[244:247], a[216:219], a[152:155], v[244:247]
 ds_read_b128 a[152:155], v1 offset:12288
 v_mfma_f32_16x16x32_bf16 v[248:251], a[216:219], a[160:163], v[248:251]
 ds_read_b128 a[160:163], v1 offset:16384
 v_mfma_f32_16x16x32_bf16 v[248:251], a[220:223], a[164:167], v[248:251]
 ds_read_b128 a[164:167], v1 offset:17408
 v_mfma_f32_16x16x32_bf16 v[252:255], a[220:223], a[172:175], v[252:255]
 ds_read_b128 a[172:175], v1 offset:21504
 v_mfma_f32_16x16x32_bf16 v[252:255], a[216:219], a[168:171], v[252:255]
 ds_read_b128 a[168:171], v1 offset:20480
 v_mfma_f32_16x16x32_bf16 a[248:251], a[216:219], a[176:179], a[248:251]
 ds_read_b128 a[176:179], v1 offset:24576
 v_mfma_f32_16x16x32_bf16 a[248:251], a[220:223], a[180:183], a[248:251]
 ds_read_b128 a[180:183], v1 offset:25600
 v_mfma_f32_16x16x32_bf16 a[252:255], a[220:223], a[188:191], a[252:255]
 global_load_dwordx4 a[220:223], v0, s[70:71] offset:-1024
 ds_read_b128 a[188:191], v1 offset:29696
 v_mfma_f32_16x16x32_bf16 a[252:255], a[216:219], a[184:187], a[252:255]
 global_load_dwordx4 a[216:219], v0, s[70:71] offset:-2048
 ds_read_b128 a[184:187], v1 offset:28672
 s_waitcnt vmcnt(10) lgkmcnt(8)
 v_mfma_f32_16x16x32_bf16 v[16:19], a[224:227], a[128:131], v[16:19]
 v_mfma_f32_16x16x32_bf16 v[16:19], a[228:231], a[132:135], v[16:19]
 v_mfma_f32_16x16x32_bf16 v[20:23], a[228:231], a[140:143], v[20:23]
 v_mfma_f32_16x16x32_bf16 v[20:23], a[224:227], a[136:139], v[20:23]
 v_mfma_f32_16x16x32_bf16 v[24:27], a[224:227], a[144:147], v[24:27]
 s_add_u32 m0, s50, 2048
 v_mfma_f32_16x16x32_bf16 v[24:27], a[228:231], a[148:151], v[24:27]
 v_mfma_f32_16x16x32_bf16 v[28:31], a[228:231], a[156:159], v[28:31]
 v_mfma_f32_16x16x32_bf16 v[28:31], a[224:227], a[152:155], v[28:31]
 s_waitcnt lgkmcnt(0)
 v_mfma_f32_16x16x32_bf16 v[32:35], a[224:227], a[160:163], v[32:35]
 v_mfma_f32_16x16x32_bf16 v[32:35], a[228:231], a[164:167], v[32:35]
 v_mfma_f32_16x16x32_bf16 v[36:39], a[228:231], a[172:175], v[36:39]
 v_mfma_f32_16x16x32_bf16 v[36:39], a[224:227], a[168:171], v[36:39]
 v_mfma_f32_16x16x32_bf16 v[40:43], a[224:227], a[176:179], v[40:43]
 v_mfma_f32_16x16x32_bf16 v[40:43], a[228:231], a[180:183], v[40:43]
 v_mfma_f32_16x16x32_bf16 v[44:47], a[228:231], a[188:191], v[44:47]
 v_mfma_f32_16x16x32_bf16 v[44:47], a[224:227], a[184:187], v[44:47]
 s_waitcnt vmcnt(8)
 v_mfma_f32_16x16x32_bf16 v[76:79], a[232:235], a[184:187], v[76:79]
 v_mfma_f32_16x16x32_bf16 v[76:79], a[236:239], a[188:191], v[76:79]
 global_load_dwordx4 a[228:231], v0, s[70:71] offset:1024
 v_mfma_f32_16x16x32_bf16 v[72:75], a[236:239], a[180:183], v[72:75]
 v_mfma_f32_16x16x32_bf16 v[72:75], a[232:235], a[176:179], v[72:75]
 global_load_dwordx4 a[224:227], v0, s[70:71] offset:0
 v_mfma_f32_16x16x32_bf16 v[68:71], a[232:235], a[168:171], v[68:71]
 v_mfma_f32_16x16x32_bf16 v[68:71], a[236:239], a[172:175], v[68:71]
 v_mfma_f32_16x16x32_bf16 v[64:67], a[236:239], a[164:167], v[64:67]
 v_mfma_f32_16x16x32_bf16 v[64:67], a[232:235], a[160:163], v[64:67]
 v_mfma_f32_16x16x32_bf16 v[60:63], a[232:235], a[152:155], v[60:63]
 buffer_load_dwordx4 v3, s[32:35], s30 offen sc1 lds
 v_mfma_f32_16x16x32_bf16 v[60:63], a[236:239], a[156:159], v[60:63]
 v_mfma_f32_16x16x32_bf16 v[56:59], a[236:239], a[148:151], v[56:59]
 v_mfma_f32_16x16x32_bf16 v[56:59], a[232:235], a[144:147], v[56:59]
 v_mfma_f32_16x16x32_bf16 v[52:55], a[232:235], a[136:139], v[52:55]
 v_mfma_f32_16x16x32_bf16 v[52:55], a[236:239], a[140:143], v[52:55]
 v_mfma_f32_16x16x32_bf16 v[48:51], a[236:239], a[132:135], v[48:51]
 v_mfma_f32_16x16x32_bf16 v[48:51], a[232:235], a[128:131], v[48:51]
 s_waitcnt vmcnt(9)
 v_mfma_f32_16x16x32_bf16 v[80:83], a[192:195], a[128:131], v[80:83]
 v_mfma_f32_16x16x32_bf16 v[80:83], a[196:199], a[132:135], v[80:83]
 global_load_dwordx4 a[236:239], v0, s[70:71] offset:3072
 v_mfma_f32_16x16x32_bf16 v[84:87], a[196:199], a[140:143], v[84:87]
 buffer_load_dwordx4 v3, s[32:35], s30 offen offset:1024 sc1 lds
 v_mfma_f32_16x16x32_bf16 v[84:87], a[192:195], a[136:139], v[84:87]
 global_load_dwordx4 a[232:235], v0, s[70:71] offset:2048
 v_mfma_f32_16x16x32_bf16 v[88:91], a[192:195], a[144:147], v[88:91]
 s_add_u32 s70, s70, 8192
 s_addc_u32 s71, s71, 0
 v_mfma_f32_16x16x32_bf16 v[88:91], a[196:199], a[148:151], v[88:91]
 v_mfma_f32_16x16x32_bf16 v[92:95], a[196:199], a[156:159], v[92:95]
 v_mfma_f32_16x16x32_bf16 v[92:95], a[192:195], a[152:155], v[92:95]
 v_mfma_f32_16x16x32_bf16 v[96:99], a[192:195], a[160:163], v[96:99]
 v_mfma_f32_16x16x32_bf16 v[96:99], a[196:199], a[164:167], v[96:99]
 v_mfma_f32_16x16x32_bf16 v[100:103], a[196:199], a[172:175], v[100:103]
 v_mfma_f32_16x16x32_bf16 v[100:103], a[192:195], a[168:171], v[100:103]
 s_add_u32 m0, m0, 4096
 v_mfma_f32_16x16x32_bf16 v[104:107], a[192:195], a[176:179], v[104:107]
 v_mfma_f32_16x16x32_bf16 v[104:107], a[196:199], a[180:183], v[104:107]
 v_mfma_f32_16x16x32_bf16 v[108:111], a[196:199], a[188:191], v[108:111]
 v_mfma_f32_16x16x32_bf16 v[108:111], a[192:195], a[184:187], v[108:111]
 s_waitcnt vmcnt(10)
 v_mfma_f32_16x16x32_bf16 a[244:247], a[200:203], a[184:187], a[244:247]
 v_mfma_f32_16x16x32_bf16 a[244:247], a[204:207], a[188:191], a[244:247]
 global_load_dwordx4 a[196:199], v0, s[70:71] offset:-3072
 v_mfma_f32_16x16x32_bf16 a[240:243], a[204:207], a[180:183], a[240:243]
 v_mfma_f32_16x16x32_bf16 a[240:243], a[200:203], a[176:179], a[240:243]
 global_load_dwordx4 a[192:195], v0, s[70:71] offset:-4096
 v_mfma_f32_16x16x32_bf16 v[132:135], a[200:203], a[168:171], v[132:135]
 v_mfma_f32_16x16x32_bf16 v[132:135], a[204:207], a[172:175], v[132:135]
 s_add_u32 s30, s30, 2048
 v_mfma_f32_16x16x32_bf16 v[128:131], a[204:207], a[164:167], v[128:131]
 v_mfma_f32_16x16x32_bf16 v[128:131], a[200:203], a[160:163], v[128:131]
 v_mfma_f32_16x16x32_bf16 v[124:127], a[200:203], a[152:155], v[124:127]
 v_mfma_f32_16x16x32_bf16 v[124:127], a[204:207], a[156:159], v[124:127]
 v_mfma_f32_16x16x32_bf16 v[120:123], a[204:207], a[148:151], v[120:123]
 v_mfma_f32_16x16x32_bf16 v[120:123], a[200:203], a[144:147], v[120:123]
 v_mfma_f32_16x16x32_bf16 v[116:119], a[200:203], a[136:139], v[116:119]
 v_mfma_f32_16x16x32_bf16 v[116:119], a[204:207], a[140:143], v[116:119]
 v_mfma_f32_16x16x32_bf16 v[112:115], a[204:207], a[132:135], v[112:115]
 v_mfma_f32_16x16x32_bf16 v[112:115], a[200:203], a[128:131], v[112:115]
 buffer_load_dwordx4 v3, s[32:35], s30 offen sc1 lds
 s_waitcnt vmcnt(11)
 v_mfma_f32_16x16x32_bf16 v[136:139], a[208:211], a[128:131], v[136:139]
 v_mfma_f32_16x16x32_bf16 v[136:139], a[212:215], a[132:135], v[136:139]
 global_load_dwordx4 a[204:207], v0, s[70:71] offset:-1024
 v_mfma_f32_16x16x32_bf16 v[140:143], a[212:215], a[140:143], v[140:143]
 v_mfma_f32_16x16x32_bf16 v[140:143], a[208:211], a[136:139], v[140:143]
 global_load_dwordx4 a[200:203], v0, s[70:71] offset:-2048
 v_mfma_f32_16x16x32_bf16 v[144:147], a[208:211], a[144:147], v[144:147]
 v_mfma_f32_16x16x32_bf16 v[144:147], a[212:215], a[148:151], v[144:147]
 v_mfma_f32_16x16x32_bf16 v[148:151], a[212:215], a[156:159], v[148:151]
 v_mfma_f32_16x16x32_bf16 v[148:151], a[208:211], a[152:155], v[148:151]
 v_mfma_f32_16x16x32_bf16 v[152:155], a[208:211], a[160:163], v[152:155]
 buffer_load_dwordx4 v3, s[32:35], s30 offen offset:1024 sc1 lds
 v_mfma_f32_16x16x32_bf16 v[152:155], a[212:215], a[164:167], v[152:155]
 v_mfma_f32_16x16x32_bf16 v[156:159], a[212:215], a[172:175], v[156:159]
 v_mfma_f32_16x16x32_bf16 v[156:159], a[208:211], a[168:171], v[156:159]
 v_mfma_f32_16x16x32_bf16 v[160:163], a[208:211], a[176:179], v[160:163]
 v_mfma_f32_16x16x32_bf16 v[160:163], a[212:215], a[180:183], v[160:163]
 v_mfma_f32_16x16x32_bf16 v[164:167], a[212:215], a[188:191], v[164:167]
 v_mfma_f32_16x16x32_bf16 v[164:167], a[208:211], a[184:187], v[164:167]
 s_waitcnt vmcnt(12)
 v_mfma_f32_16x16x32_bf16 v[196:199], a[216:219], a[184:187], v[196:199]
 v_mfma_f32_16x16x32_bf16 v[196:199], a[220:223], a[188:191], v[196:199]
 global_load_dwordx4 a[212:215], v0, s[70:71] offset:1024
 v_mfma_f32_16x16x32_bf16 v[192:195], a[220:223], a[180:183], v[192:195]
 s_add_u32 m0, m0, 4096
 v_mfma_f32_16x16x32_bf16 v[192:195], a[216:219], a[176:179], v[192:195]
 global_load_dwordx4 a[208:211], v0, s[70:71] offset:0
 v_mfma_f32_16x16x32_bf16 v[188:191], a[216:219], a[168:171], v[188:191]
 v_mfma_f32_16x16x32_bf16 v[188:191], a[220:223], a[172:175], v[188:191]
 v_mfma_f32_16x16x32_bf16 v[184:187], a[220:223], a[164:167], v[184:187]
 v_mfma_f32_16x16x32_bf16 v[184:187], a[216:219], a[160:163], v[184:187]
 v_mfma_f32_16x16x32_bf16 v[180:183], a[216:219], a[152:155], v[180:183]
 v_mfma_f32_16x16x32_bf16 v[180:183], a[220:223], a[156:159], v[180:183]
 v_mfma_f32_16x16x32_bf16 v[176:179], a[220:223], a[148:151], v[176:179]
 v_mfma_f32_16x16x32_bf16 v[176:179], a[216:219], a[144:147], v[176:179]
 v_mfma_f32_16x16x32_bf16 v[172:175], a[216:219], a[136:139], v[172:175]
 s_add_u32 s30, s30, 2048
 v_mfma_f32_16x16x32_bf16 v[172:175], a[220:223], a[140:143], v[172:175]
 v_mfma_f32_16x16x32_bf16 v[168:171], a[220:223], a[132:135], v[168:171]
 v_mfma_f32_16x16x32_bf16 v[168:171], a[216:219], a[128:131], v[168:171]
 s_waitcnt vmcnt(12)
 v_mfma_f32_16x16x32_bf16 v[200:203], a[224:227], a[128:131], v[200:203]
 v_mfma_f32_16x16x32_bf16 v[200:203], a[228:231], a[132:135], v[200:203]
 global_load_dwordx4 a[220:223], v0, s[70:71] offset:3072
 v_mfma_f32_16x16x32_bf16 v[204:207], a[228:231], a[140:143], v[204:207]
 v_mfma_f32_16x16x32_bf16 v[204:207], a[224:227], a[136:139], v[204:207]
 global_load_dwordx4 a[216:219], v0, s[70:71] offset:2048
 v_mfma_f32_16x16x32_bf16 v[208:211], a[224:227], a[144:147], v[208:211]
 s_add_u32 s70, s70, 8192
 s_addc_u32 s71, s71, 0
 v_mfma_f32_16x16x32_bf16 v[208:211], a[228:231], a[148:151], v[208:211]
 buffer_load_dwordx4 v3, s[32:35], s30 offen sc1 lds
 v_mfma_f32_16x16x32_bf16 v[212:215], a[228:231], a[156:159], v[212:215]
 v_mfma_f32_16x16x32_bf16 v[212:215], a[224:227], a[152:155], v[212:215]
 v_mfma_f32_16x16x32_bf16 v[216:219], a[224:227], a[160:163], v[216:219]
 v_mfma_f32_16x16x32_bf16 v[216:219], a[228:231], a[164:167], v[216:219]
 v_mfma_f32_16x16x32_bf16 v[220:223], a[228:231], a[172:175], v[220:223]
 v_mfma_f32_16x16x32_bf16 v[220:223], a[224:227], a[168:171], v[220:223]
 v_mfma_f32_16x16x32_bf16 v[224:227], a[224:227], a[176:179], v[224:227]
 v_mfma_f32_16x16x32_bf16 v[224:227], a[228:231], a[180:183], v[224:227]
 v_mfma_f32_16x16x32_bf16 v[228:231], a[228:231], a[188:191], v[228:231]
 v_mfma_f32_16x16x32_bf16 v[228:231], a[224:227], a[184:187], v[228:231]
 buffer_load_dwordx4 v3, s[32:35], s30 offen offset:1024 sc1 lds
 s_waitcnt vmcnt(12)
 v_mfma_f32_16x16x32_bf16 a[252:255], a[232:235], a[184:187], a[252:255]
 ds_read_b128 a[184:187], v1 offset:61440
 v_mfma_f32_16x16x32_bf16 a[252:255], a[236:239], a[188:191], a[252:255]
 global_load_dwordx4 a[228:231], v0, s[70:71] offset:-3072
 ds_read_b128 a[188:191], v1 offset:62464
 v_mfma_f32_16x16x32_bf16 a[248:251], a[236:239], a[180:183], a[248:251]
 ds_read_b128 a[180:183], v1 offset:58368
 v_mfma_f32_16x16x32_bf16 a[248:251], a[232:235], a[176:179], a[248:251]
 global_load_dwordx4 a[224:227], v0, s[70:71] offset:-4096
 ds_read_b128 a[176:179], v1 offset:57344
 v_mfma_f32_16x16x32_bf16 v[252:255], a[232:235], a[168:171], v[252:255]
 ds_read_b128 a[168:171], v1 offset:53248
 v_mfma_f32_16x16x32_bf16 v[252:255], a[236:239], a[172:175], v[252:255]
 ds_read_b128 a[172:175], v1 offset:54272
 v_mfma_f32_16x16x32_bf16 v[248:251], a[236:239], a[164:167], v[248:251]
 ds_read_b128 a[164:167], v1 offset:50176
 v_mfma_f32_16x16x32_bf16 v[248:251], a[232:235], a[160:163], v[248:251]
 ds_read_b128 a[160:163], v1 offset:49152
 v_mfma_f32_16x16x32_bf16 v[244:247], a[232:235], a[152:155], v[244:247]
 ds_read_b128 a[152:155], v1 offset:45056
 v_mfma_f32_16x16x32_bf16 v[244:247], a[236:239], a[156:159], v[244:247]
 ds_read_b128 a[156:159], v1 offset:46080
 s_add_u32 m0, m0, 4096
 v_mfma_f32_16x16x32_bf16 v[240:243], a[236:239], a[148:151], v[240:243]
 ds_read_b128 a[148:151], v1 offset:41984
 v_mfma_f32_16x16x32_bf16 v[240:243], a[232:235], a[144:147], v[240:243]
 ds_read_b128 a[144:147], v1 offset:40960
 v_mfma_f32_16x16x32_bf16 v[236:239], a[232:235], a[136:139], v[236:239]
 ds_read_b128 a[136:139], v1 offset:36864
 v_mfma_f32_16x16x32_bf16 v[236:239], a[236:239], a[140:143], v[236:239]
 ds_read_b128 a[140:143], v1 offset:37888
 v_mfma_f32_16x16x32_bf16 v[232:235], a[236:239], a[132:135], v[232:235]
 ds_read_b128 a[132:135], v1 offset:33792
 v_mfma_f32_16x16x32_bf16 v[232:235], a[232:235], a[128:131], v[232:235]
 ds_read_b128 a[128:131], v1 offset:32768
 s_waitcnt vmcnt(12) lgkmcnt(8)
 v_mfma_f32_16x16x32_bf16 v[44:47], a[192:195], a[184:187], v[44:47]
 v_mfma_f32_16x16x32_bf16 v[44:47], a[196:199], a[188:191], v[44:47]
 v_mfma_f32_16x16x32_bf16 v[40:43], a[196:199], a[180:183], v[40:43]
 s_add_u32 s30, s30, 2048
 v_mfma_f32_16x16x32_bf16 v[40:43], a[192:195], a[176:179], v[40:43]
 v_mfma_f32_16x16x32_bf16 v[36:39], a[192:195], a[168:171], v[36:39]
 v_mfma_f32_16x16x32_bf16 v[36:39], a[196:199], a[172:175], v[36:39]
 v_mfma_f32_16x16x32_bf16 v[32:35], a[196:199], a[164:167], v[32:35]
 v_mfma_f32_16x16x32_bf16 v[32:35], a[192:195], a[160:163], v[32:35]
 s_waitcnt lgkmcnt(0)
 v_mfma_f32_16x16x32_bf16 v[28:31], a[192:195], a[152:155], v[28:31]
 v_mfma_f32_16x16x32_bf16 v[28:31], a[196:199], a[156:159], v[28:31]
 v_mfma_f32_16x16x32_bf16 v[24:27], a[196:199], a[148:151], v[24:27]
 v_mfma_f32_16x16x32_bf16 v[24:27], a[192:195], a[144:147], v[24:27]
 v_mfma_f32_16x16x32_bf16 v[20:23], a[192:195], a[136:139], v[20:23]
 buffer_load_dwordx4 v3, s[32:35], s30 offen sc1 lds
 v_mfma_f32_16x16x32_bf16 v[20:23], a[196:199], a[140:143], v[20:23]
 v_mfma_f32_16x16x32_bf16 v[16:19], a[196:199], a[132:135], v[16:19]
 v_mfma_f32_16x16x32_bf16 v[16:19], a[192:195], a[128:131], v[16:19]
 s_waitcnt vmcnt(10)
 v_mfma_f32_16x16x32_bf16 v[48:51], a[200:203], a[128:131], v[48:51]
 v_mfma_f32_16x16x32_bf16 v[48:51], a[204:207], a[132:135], v[48:51]
 global_load_dwordx4 a[196:199], v0, s[70:71] offset:-1024
 v_mfma_f32_16x16x32_bf16 v[52:55], a[204:207], a[140:143], v[52:55]
 v_mfma_f32_16x16x32_bf16 v[52:55], a[200:203], a[136:139], v[52:55]
 global_load_dwordx4 a[192:195], v0, s[70:71] offset:-2048
 v_mfma_f32_16x16x32_bf16 v[56:59], a[200:203], a[144:147], v[56:59]
 v_mfma_f32_16x16x32_bf16 v[56:59], a[204:207], a[148:151], v[56:59]
 v_mfma_f32_16x16x32_bf16 v[60:63], a[204:207], a[156:159], v[60:63]
 buffer_load_dwordx4 v3, s[32:35], s30 offen offset:1024 sc1 lds
 v_mfma_f32_16x16x32_bf16 v[60:63], a[200:203], a[152:155], v[60:63]
 v_mfma_f32_16x16x32_bf16 v[64:67], a[200:203], a[160:163], v[64:67]
 v_mfma_f32_16x16x32_bf16 v[64:67], a[204:207], a[164:167], v[64:67]
 v_mfma_f32_16x16x32_bf16 v[68:71], a[204:207], a[172:175], v[68:71]
 v_mfma_f32_16x16x32_bf16 v[68:71], a[200:203], a[168:171], v[68:71]
 v_mfma_f32_16x16x32_bf16 v[72:75], a[200:203], a[176:179], v[72:75]
 v_mfma_f32_16x16x32_bf16 v[72:75], a[204:207], a[180:183], v[72:75]
 v_mfma_f32_16x16x32_bf16 v[76:79], a[204:207], a[188:191], v[76:79]
 v_mfma_f32_16x16x32_bf16 v[76:79], a[200:203], a[184:187], v[76:79]
 s_waitcnt vmcnt(10)
 v_mfma_f32_16x16x32_bf16 v[108:111], a[208:211], a[184:187], v[108:111]
 s_add_u32 m0, m0, 4096
 v_mfma_f32_16x16x32_bf16 v[108:111], a[212:215], a[188:191], v[108:111]
 global_load_dwordx4 a[204:207], v0, s[70:71] offset:1024
 v_mfma_f32_16x16x32_bf16 v[104:107], a[212:215], a[180:183], v[104:107]
 v_mfma_f32_16x16x32_bf16 v[104:107], a[208:211], a[176:179], v[104:107]
 global_load_dwordx4 a[200:203], v0, s[70:71] offset:0
 v_mfma_f32_16x16x32_bf16 v[100:103], a[208:211], a[168:171], v[100:103]
 v_mfma_f32_16x16x32_bf16 v[100:103], a[212:215], a[172:175], v[100:103]
 v_mfma_f32_16x16x32_bf16 v[96:99], a[212:215], a[164:167], v[96:99]
 v_mfma_f32_16x16x32_bf16 v[96:99], a[208:211], a[160:163], v[96:99]
 v_mfma_f32_16x16x32_bf16 v[92:95], a[208:211], a[152:155], v[92:95]
 v_mfma_f32_16x16x32_bf16 v[92:95], a[212:215], a[156:159], v[92:95]
 s_add_u32 s30, s30, 2048
 v_mfma_f32_16x16x32_bf16 v[88:91], a[212:215], a[148:151], v[88:91]
 v_mfma_f32_16x16x32_bf16 v[88:91], a[208:211], a[144:147], v[88:91]
 v_mfma_f32_16x16x32_bf16 v[84:87], a[208:211], a[136:139], v[84:87]
 v_mfma_f32_16x16x32_bf16 v[84:87], a[212:215], a[140:143], v[84:87]
 v_mfma_f32_16x16x32_bf16 v[80:83], a[212:215], a[132:135], v[80:83]
 v_mfma_f32_16x16x32_bf16 v[80:83], a[208:211], a[128:131], v[80:83]
 s_waitcnt vmcnt(10)
 v_mfma_f32_16x16x32_bf16 v[112:115], a[216:219], a[128:131], v[112:115]
 v_mfma_f32_16x16x32_bf16 v[112:115], a[220:223], a[132:135], v[112:115]
 global_load_dwordx4 a[212:215], v0, s[70:71] offset:3072
 v_mfma_f32_16x16x32_bf16 v[116:119], a[220:223], a[140:143], v[116:119]
 buffer_load_dwordx4 v3, s[32:35], s30 offen sc1 lds
 v_mfma_f32_16x16x32_bf16 v[116:119], a[216:219], a[136:139], v[116:119]
 global_load_dwordx4 a[208:211], v0, s[70:71] offset:2048
 v_mfma_f32_16x16x32_bf16 v[120:123], a[216:219], a[144:147], v[120:123]
 s_add_u32 s70, s70, 8192
 s_addc_u32 s71, s71, 0
 v_mfma_f32_16x16x32_bf16 v[120:123], a[220:223], a[148:151], v[120:123]
 v_mfma_f32_16x16x32_bf16 v[124:127], a[220:223], a[156:159], v[124:127]
 v_mfma_f32_16x16x32_bf16 v[124:127], a[216:219], a[152:155], v[124:127]
 v_mfma_f32_16x16x32_bf16 v[128:131], a[216:219], a[160:163], v[128:131]
 v_mfma_f32_16x16x32_bf16 v[128:131], a[220:223], a[164:167], v[128:131]
 v_mfma_f32_16x16x32_bf16 v[132:135], a[220:223], a[172:175], v[132:135]
 v_mfma_f32_16x16x32_bf16 v[132:135], a[216:219], a[168:171], v[132:135]
 v_mfma_f32_16x16x32_bf16 a[240:243], a[216:219], a[176:179], a[240:243]
 v_mfma_f32_16x16x32_bf16 a[240:243], a[220:223], a[180:183], a[240:243]
 buffer_load_dwordx4 v3, s[32:35], s30 offen offset:1024 sc1 lds
 v_mfma_f32_16x16x32_bf16 a[244:247], a[220:223], a[188:191], a[244:247]
 v_mfma_f32_16x16x32_bf16 a[244:247], a[216:219], a[184:187], a[244:247]
 s_waitcnt vmcnt(10)
 v_mfma_f32_16x16x32_bf16 v[164:167], a[224:227], a[184:187], v[164:167]
 v_mfma_f32_16x16x32_bf16 v[164:167], a[228:231], a[188:191], v[164:167]
 global_load_dwordx4 a[220:223], v0, s[70:71] offset:-3072
 v_mfma_f32_16x16x32_bf16 v[160:163], a[228:231], a[180:183], v[160:163]
 v_mfma_f32_16x16x32_bf16 v[160:163], a[224:227], a[176:179], v[160:163]
 global_load_dwordx4 a[216:219], v0, s[70:71] offset:-4096
 v_mfma_f32_16x16x32_bf16 v[156:159], a[224:227], a[168:171], v[156:159]
 v_mfma_f32_16x16x32_bf16 v[156:159], a[228:231], a[172:175], v[156:159]
 v_mfma_f32_16x16x32_bf16 v[152:155], a[228:231], a[164:167], v[152:155]
 s_add_u32 m0, m0, 4096
 v_mfma_f32_16x16x32_bf16 v[152:155], a[224:227], a[160:163], v[152:155]
 v_mfma_f32_16x16x32_bf16 v[148:151], a[224:227], a[152:155], v[148:151]
 v_mfma_f32_16x16x32_bf16 v[148:151], a[228:231], a[156:159], v[148:151]
 v_mfma_f32_16x16x32_bf16 v[144:147], a[228:231], a[148:151], v[144:147]
 v_mfma_f32_16x16x32_bf16 v[144:147], a[224:227], a[144:147], v[144:147]
 v_mfma_f32_16x16x32_bf16 v[140:143], a[224:227], a[136:139], v[140:143]
 v_mfma_f32_16x16x32_bf16 v[140:143], a[228:231], a[140:143], v[140:143]
 v_mfma_f32_16x16x32_bf16 v[136:139], a[228:231], a[132:135], v[136:139]
 v_mfma_f32_16x16x32_bf16 v[136:139], a[224:227], a[128:131], v[136:139]
 s_waitcnt vmcnt(9)
 v_mfma_f32_16x16x32_bf16 v[168:171], a[192:195], a[128:131], v[168:171]
 s_add_u32 s30, s30, 2048
 v_mfma_f32_16x16x32_bf16 v[168:171], a[196:199], a[132:135], v[168:171]
 global_load_dwordx4 a[228:231], v0, s[70:71] offset:-1024
 v_mfma_f32_16x16x32_bf16 v[172:175], a[196:199], a[140:143], v[172:175]
 v_mfma_f32_16x16x32_bf16 v[172:175], a[192:195], a[136:139], v[172:175]
 global_load_dwordx4 a[224:227], v0, s[70:71] offset:-2048
 v_mfma_f32_16x16x32_bf16 v[176:179], a[192:195], a[144:147], v[176:179]
 v_mfma_f32_16x16x32_bf16 v[176:179], a[196:199], a[148:151], v[176:179]
 v_mfma_f32_16x16x32_bf16 v[180:183], a[196:199], a[156:159], v[180:183]
 v_mfma_f32_16x16x32_bf16 v[180:183], a[192:195], a[152:155], v[180:183]
 v_mfma_f32_16x16x32_bf16 v[184:187], a[192:195], a[160:163], v[184:187]
 v_mfma_f32_16x16x32_bf16 v[184:187], a[196:199], a[164:167], v[184:187]
 v_mfma_f32_16x16x32_bf16 v[188:191], a[196:199], a[172:175], v[188:191]
 buffer_load_dwordx4 v3, s[32:35], s30 offen sc1 lds
 v_mfma_f32_16x16x32_bf16 v[188:191], a[192:195], a[168:171], v[188:191]
 v_mfma_f32_16x16x32_bf16 v[192:195], a[192:195], a[176:179], v[192:195]
 v_mfma_f32_16x16x32_bf16 v[192:195], a[196:199], a[180:183], v[192:195]
 v_mfma_f32_16x16x32_bf16 v[196:199], a[196:199], a[188:191], v[196:199]
 v_mfma_f32_16x16x32_bf16 v[196:199], a[192:195], a[184:187], v[196:199]
 s_waitcnt vmcnt(9)
 v_mfma_f32_16x16x32_bf16 v[228:231], a[200:203], a[184:187], v[228:231]
 v_mfma_f32_16x16x32_bf16 v[228:231], a[204:207], a[188:191], v[228:231]
 global_load_dwordx4 a[196:199], v0, s[70:71] offset:1024
 v_mfma_f32_16x16x32_bf16 v[224:227], a[204:207], a[180:183], v[224:227]
 v_mfma_f32_16x16x32_bf16 v[224:227], a[200:203], a[176:179], v[224:227]
 global_load_dwordx4 a[192:195], v0, s[70:71] offset:0
 v_mfma_f32_16x16x32_bf16 v[220:223], a[200:203], a[168:171], v[220:223]
 buffer_load_dwordx4 v3, s[32:35], s30 offen offset:1024 sc1 lds
 v_mfma_f32_16x16x32_bf16 v[220:223], a[204:207], a[172:175], v[220:223]
 v_mfma_f32_16x16x32_bf16 v[216:219], a[204:207], a[164:167], v[216:219]
 v_mfma_f32_16x16x32_bf16 v[216:219], a[200:203], a[160:163], v[216:219]
 v_mfma_f32_16x16x32_bf16 v[212:215], a[200:203], a[152:155], v[212:215]
 v_mfma_f32_16x16x32_bf16 v[212:215], a[204:207], a[156:159], v[212:215]
 v_mfma_f32_16x16x32_bf16 v[208:211], a[204:207], a[148:151], v[208:211]
 v_mfma_f32_16x16x32_bf16 v[208:211], a[200:203], a[144:147], v[208:211]
 v_mfma_f32_16x16x32_bf16 v[204:207], a[200:203], a[136:139], v[204:207]
 v_mfma_f32_16x16x32_bf16 v[204:207], a[204:207], a[140:143], v[204:207]
 s_add_u32 m0, m0, 4096
 v_mfma_f32_16x16x32_bf16 v[200:203], a[204:207], a[132:135], v[200:203]
 v_mfma_f32_16x16x32_bf16 v[200:203], a[200:203], a[128:131], v[200:203]
 s_waitcnt vmcnt(9)
 v_mfma_f32_16x16x32_bf16 v[232:235], a[208:211], a[128:131], v[232:235]
 ds_read_b128 a[128:131], v2
 v_mfma_f32_16x16x32_bf16 v[232:235], a[212:215], a[132:135], v[232:235]
 global_load_dwordx4 a[204:207], v0, s[70:71] offset:3072
 ds_read_b128 a[132:135], v2 offset:1024
 v_mfma_f32_16x16x32_bf16 v[236:239], a[212:215], a[140:143], v[236:239]
 ds_read_b128 a[140:143], v2 offset:5120
 v_mfma_f32_16x16x32_bf16 v[236:239], a[208:211], a[136:139], v[236:239]
 global_load_dwordx4 a[200:203], v0, s[70:71] offset:2048
 ds_read_b128 a[136:139], v2 offset:4096
 v_mfma_f32_16x16x32_bf16 v[240:243], a[208:211], a[144:147], v[240:243]
 s_add_u32 s70, s70, 8192
 s_addc_u32 s71, s71, 0
 ds_read_b128 a[144:147], v2 offset:8192
 v_mfma_f32_16x16x32_bf16 v[240:243], a[212:215], a[148:151], v[240:243]
 ds_read_b128 a[148:151], v2 offset:9216
 v_mfma_f32_16x16x32_bf16 v[244:247], a[212:215], a[156:159], v[244:247]
 ds_read_b128 a[156:159], v2 offset:13312
 v_mfma_f32_16x16x32_bf16 v[244:247], a[208:211], a[152:155], v[244:247]
 ds_read_b128 a[152:155], v2 offset:12288
 s_add_u32 s30, s30, 2048
 v_mfma_f32_16x16x32_bf16 v[248:251], a[208:211], a[160:163], v[248:251]
 ds_read_b128 a[160:163], v2 offset:16384
 v_mfma_f32_16x16x32_bf16 v[248:251], a[212:215], a[164:167], v[248:251]
 ds_read_b128 a[164:167], v2 offset:17408
 v_mfma_f32_16x16x32_bf16 v[252:255], a[212:215], a[172:175], v[252:255]
 ds_read_b128 a[172:175], v2 offset:21504
 v_mfma_f32_16x16x32_bf16 v[252:255], a[208:211], a[168:171], v[252:255]
 ds_read_b128 a[168:171], v2 offset:20480
 v_mfma_f32_16x16x32_bf16 a[248:251], a[208:211], a[176:179], a[248:251]
 ds_read_b128 a[176:179], v2 offset:24576
 v_mfma_f32_16x16x32_bf16 a[248:251], a[212:215], a[180:183], a[248:251]
 ds_read_b128 a[180:183], v2 offset:25600
 v_mfma_f32_16x16x32_bf16 a[252:255], a[212:215], a[188:191], a[252:255]
 ds_read_b128 a[188:191], v2 offset:29696
 v_mfma_f32_16x16x32_bf16 a[252:255], a[208:211], a[184:187], a[252:255]
 ds_read_b128 a[184:187], v2 offset:28672
 s_waitcnt vmcnt(8) lgkmcnt(8)
 v_mfma_f32_16x16x32_bf16 v[16:19], a[216:219], a[128:131], v[16:19]
 buffer_load_dwordx4 v3, s[32:35], s30 offen sc1 lds
 v_mfma_f32_16x16x32_bf16 v[16:19], a[220:223], a[132:135], v[16:19]
 global_load_dwordx4 a[212:215], v0, s[70:71] offset:-3072
 v_mfma_f32_16x16x32_bf16 v[20:23], a[220:223], a[140:143], v[20:23]
 v_mfma_f32_16x16x32_bf16 v[20:23], a[216:219], a[136:139], v[20:23]
 global_load_dwordx4 a[208:211], v0, s[70:71] offset:-4096
 v_mfma_f32_16x16x32_bf16 v[24:27], a[216:219], a[144:147], v[24:27]
 v_mfma_f32_16x16x32_bf16 v[24:27], a[220:223], a[148:151], v[24:27]
 v_mfma_f32_16x16x32_bf16 v[28:31], a[220:223], a[156:159], v[28:31]
 v_mfma_f32_16x16x32_bf16 v[28:31], a[216:219], a[152:155], v[28:31]
 s_waitcnt lgkmcnt(0)
 v_mfma_f32_16x16x32_bf16 v[32:35], a[216:219], a[160:163], v[32:35]
 v_mfma_f32_16x16x32_bf16 v[32:35], a[220:223], a[164:167], v[32:35]
 v_mfma_f32_16x16x32_bf16 v[36:39], a[220:223], a[172:175], v[36:39]
 buffer_load_dwordx4 v3, s[32:35], s30 offen offset:1024 sc1 lds
 v_mfma_f32_16x16x32_bf16 v[36:39], a[216:219], a[168:171], v[36:39]
 v_mfma_f32_16x16x32_bf16 v[40:43], a[216:219], a[176:179], v[40:43]
 v_mfma_f32_16x16x32_bf16 v[40:43], a[220:223], a[180:183], v[40:43]
 v_mfma_f32_16x16x32_bf16 v[44:47], a[220:223], a[188:191], v[44:47]
 v_mfma_f32_16x16x32_bf16 v[44:47], a[216:219], a[184:187], v[44:47]
 s_waitcnt vmcnt(10)
 v_mfma_f32_16x16x32_bf16 v[76:79], a[224:227], a[184:187], v[76:79]
 v_mfma_f32_16x16x32_bf16 v[76:79], a[228:231], a[188:191], v[76:79]
 global_load_dwordx4 a[220:223], v0, s[70:71] offset:-1024
 v_mfma_f32_16x16x32_bf16 v[72:75], a[228:231], a[180:183], v[72:75]
 v_mfma_f32_16x16x32_bf16 v[72:75], a[224:227], a[176:179], v[72:75]
 global_load_dwordx4 a[216:219], v0, s[70:71] offset:-2048
 v_mfma_f32_16x16x32_bf16 v[68:71], a[224:227], a[168:171], v[68:71]
 s_add_u32 m0, m0, 4096
 v_mfma_f32_16x16x32_bf16 v[68:71], a[228:231], a[172:175], v[68:71]
 v_mfma_f32_16x16x32_bf16 v[64:67], a[228:231], a[164:167], v[64:67]
 v_mfma_f32_16x16x32_bf16 v[64:67], a[224:227], a[160:163], v[64:67]
 v_mfma_f32_16x16x32_bf16 v[60:63], a[224:227], a[152:155], v[60:63]
 v_mfma_f32_16x16x32_bf16 v[60:63], a[228:231], a[156:159], v[60:63]
 v_mfma_f32_16x16x32_bf16 v[56:59], a[228:231], a[148:151], v[56:59]
 v_mfma_f32_16x16x32_bf16 v[56:59], a[224:227], a[144:147], v[56:59]
 v_mfma_f32_16x16x32_bf16 v[52:55], a[224:227], a[136:139], v[52:55]
 v_mfma_f32_16x16x32_bf16 v[52:55], a[228:231], a[140:143], v[52:55]
 v_mfma_f32_16x16x32_bf16 v[48:51], a[228:231], a[132:135], v[48:51]
 s_add_u32 s30, s30, 2048
 v_mfma_f32_16x16x32_bf16 v[48:51], a[224:227], a[128:131], v[48:51]
 s_waitcnt vmcnt(9)
 v_mfma_f32_16x16x32_bf16 v[80:83], a[192:195], a[128:131], v[80:83]
 v_mfma_f32_16x16x32_bf16 v[80:83], a[196:199], a[132:135], v[80:83]
 global_load_dwordx4 a[228:231], v0, s[70:71] offset:1024
 v_mfma_f32_16x16x32_bf16 v[84:87], a[196:199], a[140:143], v[84:87]
 v_mfma_f32_16x16x32_bf16 v[84:87], a[192:195], a[136:139], v[84:87]
 global_load_dwordx4 a[224:227], v0, s[70:71] offset:0
 v_mfma_f32_16x16x32_bf16 v[88:91], a[192:195], a[144:147], v[88:91]
 v_mfma_f32_16x16x32_bf16 v[88:91], a[196:199], a[148:151], v[88:91]
 v_mfma_f32_16x16x32_bf16 v[92:95], a[196:199], a[156:159], v[92:95]
 v_mfma_f32_16x16x32_bf16 v[92:95], a[192:195], a[152:155], v[92:95]
 buffer_load_dwordx4 v3, s[32:35], s30 offen sc1 lds
 v_mfma_f32_16x16x32_bf16 v[96:99], a[192:195], a[160:163], v[96:99]
 v_mfma_f32_16x16x32_bf16 v[96:99], a[196:199], a[164:167], v[96:99]
 v_mfma_f32_16x16x32_bf16 v[100:103], a[196:199], a[172:175], v[100:103]
 v_mfma_f32_16x16x32_bf16 v[100:103], a[192:195], a[168:171], v[100:103]
 v_mfma_f32_16x16x32_bf16 v[104:107], a[192:195], a[176:179], v[104:107]
 v_mfma_f32_16x16x32_bf16 v[104:107], a[196:199], a[180:183], v[104:107]
 v_mfma_f32_16x16x32_bf16 v[108:111], a[196:199], a[188:191], v[108:111]
 v_mfma_f32_16x16x32_bf16 v[108:111], a[192:195], a[184:187], v[108:111]
 s_waitcnt vmcnt(9)
 v_mfma_f32_16x16x32_bf16 a[244:247], a[200:203], a[184:187], a[244:247]
 buffer_load_dwordx4 v3, s[32:35], s30 offen offset:1024 sc1 lds
 v_mfma_f32_16x16x32_bf16 a[244:247], a[204:207], a[188:191], a[244:247]
 global_load_dwordx4 a[196:199], v0, s[70:71] offset:3072
 v_mfma_f32_16x16x32_bf16 a[240:243], a[204:207], a[180:183], a[240:243]
 v_mfma_f32_16x16x32_bf16 a[240:243], a[200:203], a[176:179], a[240:243]
 global_load_dwordx4 a[192:195], v0, s[70:71] offset:2048
 v_mfma_f32_16x16x32_bf16 v[132:135], a[200:203], a[168:171], v[132:135]
 s_add_u32 s70, s70, 8192
 s_addc_u32 s71, s71, 0
 v_mfma_f32_16x16x32_bf16 v[132:135], a[204:207], a[172:175], v[132:135]
 v_mfma_f32_16x16x32_bf16 v[128:131], a[204:207], a[164:167], v[128:131]
 v_mfma_f32_16x16x32_bf16 v[128:131], a[200:203], a[160:163], v[128:131]
 v_mfma_f32_16x16x32_bf16 v[124:127], a[200:203], a[152:155], v[124:127]
 v_mfma_f32_16x16x32_bf16 v[124:127], a[204:207], a[156:159], v[124:127]
 v_mfma_f32_16x16x32_bf16 v[120:123], a[204:207], a[148:151], v[120:123]
 v_mfma_f32_16x16x32_bf16 v[120:123], a[200:203], a[144:147], v[120:123]
 s_add_u32 s30, s30, 0x1ff8800
 v_mfma_f32_16x16x32_bf16 v[116:119], a[200:203], a[136:139], v[116:119]
 v_mfma_f32_16x16x32_bf16 v[116:119], a[204:207], a[140:143], v[116:119]
 v_mfma_f32_16x16x32_bf16 v[112:115], a[204:207], a[132:135], v[112:115]
 v_mfma_f32_16x16x32_bf16 v[112:115], a[200:203], a[128:131], v[112:115]
 s_waitcnt vmcnt(9)
 v_mfma_f32_16x16x32_bf16 v[136:139], a[208:211], a[128:131], v[136:139]
 v_mfma_f32_16x16x32_bf16 v[136:139], a[212:215], a[132:135], v[136:139]
 global_load_dwordx4 a[204:207], v0, s[70:71] offset:-3072
 v_mfma_f32_16x16x32_bf16 v[140:143], a[212:215], a[140:143], v[140:143]
 v_mfma_f32_16x16x32_bf16 v[140:143], a[208:211], a[136:139], v[140:143]
 global_load_dwordx4 a[200:203], v0, s[70:71] offset:-4096
 v_mfma_f32_16x16x32_bf16 v[144:147], a[208:211], a[144:147], v[144:147]
 v_mfma_f32_16x16x32_bf16 v[144:147], a[212:215], a[148:151], v[144:147]
 v_mfma_f32_16x16x32_bf16 v[148:151], a[212:215], a[156:159], v[148:151]
 v_mfma_f32_16x16x32_bf16 v[148:151], a[208:211], a[152:155], v[148:151]
 v_mfma_f32_16x16x32_bf16 v[152:155], a[208:211], a[160:163], v[152:155]
 v_mfma_f32_16x16x32_bf16 v[152:155], a[212:215], a[164:167], v[152:155]
 v_mfma_f32_16x16x32_bf16 v[156:159], a[212:215], a[172:175], v[156:159]
 v_and_b32 v5, 768, v1
 v_mfma_f32_16x16x32_bf16 v[156:159], a[208:211], a[168:171], v[156:159]
 v_mfma_f32_16x16x32_bf16 v[160:163], a[208:211], a[176:179], v[160:163]
 v_add3_u32 v5, v5, v1, s52
 v_mfma_f32_16x16x32_bf16 v[160:163], a[212:215], a[180:183], v[160:163]
 v_mfma_f32_16x16x32_bf16 v[164:167], a[212:215], a[188:191], v[164:167]
 ds_read_b64_tr_b16 v[8:9], v5 offset:0
 v_mfma_f32_16x16x32_bf16 v[164:167], a[208:211], a[184:187], v[164:167]
 s_waitcnt vmcnt(8)
 v_mfma_f32_16x16x32_bf16 v[196:199], a[216:219], a[184:187], v[196:199]
 ds_read_b64_tr_b16 v[10:11], v5 offset:256
 v_mfma_f32_16x16x32_bf16 v[196:199], a[220:223], a[188:191], v[196:199]
 global_load_dwordx4 a[212:215], v0, s[70:71] offset:-1024
 ds_read_b64_tr_b16 v[12:13], v5 offset:8
 v_mfma_f32_16x16x32_bf16 v[192:195], a[220:223], a[180:183], v[192:195]
 ds_read_b64_tr_b16 v[14:15], v5 offset:264
 v_mfma_f32_16x16x32_bf16 v[192:195], a[216:219], a[176:179], v[192:195]
 global_load_dwordx4 a[208:211], v0, s[70:71] offset:-2048
 v_mfma_f32_16x16x32_bf16 v[188:191], a[216:219], a[168:171], v[188:191]
 v_mfma_f32_16x16x32_bf16 v[188:191], a[220:223], a[172:175], v[188:191]
 v_mfma_f32_16x16x32_bf16 v[184:187], a[220:223], a[164:167], v[184:187]
 v_mfma_f32_16x16x32_bf16 v[184:187], a[216:219], a[160:163], v[184:187]
 v_mfma_f32_16x16x32_bf16 v[180:183], a[216:219], a[152:155], v[180:183]
 v_mfma_f32_16x16x32_bf16 v[180:183], a[220:223], a[156:159], v[180:183]
 v_mfma_f32_16x16x32_bf16 v[176:179], a[220:223], a[148:151], v[176:179]
 v_mfma_f32_16x16x32_bf16 v[176:179], a[216:219], a[144:147], v[176:179]
 v_mfma_f32_16x16x32_bf16 v[172:175], a[216:219], a[136:139], v[172:175]
 v_mfma_f32_16x16x32_bf16 v[172:175], a[220:223], a[140:143], v[172:175]
 v_mfma_f32_16x16x32_bf16 v[168:171], a[220:223], a[132:135], v[168:171]
 v_mfma_f32_16x16x32_bf16 v[168:171], a[216:219], a[128:131], v[168:171]
 s_waitcnt vmcnt(8)
 v_mfma_f32_16x16x32_bf16 v[200:203], a[224:227], a[128:131], v[200:203]
 v_mfma_f32_16x16x32_bf16 v[200:203], a[228:231], a[132:135], v[200:203]
 global_load_dwordx4 a[220:223], v0, s[70:71] offset:1024
 s_waitcnt lgkmcnt(2)
 v_mfma_f32_16x16x32_bf16 v[204:207], a[228:231], a[140:143], v[204:207]
 v_mfma_f32_16x16x32_bf16 v[204:207], a[224:227], a[136:139], v[204:207]
 global_load_dwordx4 a[216:219], v0, s[70:71] offset:0
 v_mfma_f32_16x16x32_bf16 v[208:211], a[224:227], a[144:147], v[208:211]
 buffer_store_dwordx4 v[8:11], v1, s[12:15], s49 offen sc1
 s_waitcnt lgkmcnt(0)
 v_mfma_f32_16x16x32_bf16 v[208:211], a[228:231], a[148:151], v[208:211]
 buffer_store_dwordx4 v[12:15], v1, s[12:15], s49 offen offset:2048 sc1
 v_mfma_f32_16x16x32_bf16 v[212:215], a[228:231], a[156:159], v[212:215]
 v_mfma_f32_16x16x32_bf16 v[212:215], a[224:227], a[152:155], v[212:215]
 s_add_u32 s49, s49, 2097152
 v_mfma_f32_16x16x32_bf16 v[216:219], a[224:227], a[160:163], v[216:219]
 v_mfma_f32_16x16x32_bf16 v[216:219], a[228:231], a[164:167], v[216:219]
 v_mfma_f32_16x16x32_bf16 v[220:223], a[228:231], a[172:175], v[220:223]
 v_mfma_f32_16x16x32_bf16 v[220:223], a[224:227], a[168:171], v[220:223]
 v_mfma_f32_16x16x32_bf16 v[224:227], a[224:227], a[176:179], v[224:227]
 v_mfma_f32_16x16x32_bf16 v[224:227], a[228:231], a[180:183], v[224:227]
 v_mfma_f32_16x16x32_bf16 v[228:231], a[228:231], a[188:191], v[228:231]
 v_mfma_f32_16x16x32_bf16 v[228:231], a[224:227], a[184:187], v[228:231]
 s_waitcnt vmcnt(8)
 v_mfma_f32_16x16x32_bf16 a[252:255], a[192:195], a[184:187], a[252:255]
 ds_read_b128 a[184:187], v2 offset:61440
 v_mfma_f32_16x16x32_bf16 a[252:255], a[196:199], a[188:191], a[252:255]
 global_load_dwordx4 a[228:231], v0, s[70:71] offset:3072
 ds_read_b128 a[188:191], v2 offset:62464
 v_mfma_f32_16x16x32_bf16 a[248:251], a[196:199], a[180:183], a[248:251]
 ds_read_b128 a[180:183], v2 offset:58368
 v_mfma_f32_16x16x32_bf16 a[248:251], a[192:195], a[176:179], a[248:251]
 global_load_dwordx4 a[224:227], v0, s[70:71] offset:2048
 ds_read_b128 a[176:179], v2 offset:57344
 v_mfma_f32_16x16x32_bf16 v[252:255], a[192:195], a[168:171], v[252:255]
 s_add_u32 s70, s70, 8192
 s_addc_u32 s71, s71, 0
 ds_read_b128 a[168:171], v2 offset:53248
 v_mfma_f32_16x16x32_bf16 v[252:255], a[196:199], a[172:175], v[252:255]
 ds_read_b128 a[172:175], v2 offset:54272
 v_mfma_f32_16x16x32_bf16 v[248:251], a[196:199], a[164:167], v[248:251]
 ds_read_b128 a[164:167], v2 offset:50176
 v_mfma_f32_16x16x32_bf16 v[248:251], a[192:195], a[160:163], v[248:251]
 ds_read_b128 a[160:163], v2 offset:49152
 v_mfma_f32_16x16x32_bf16 v[244:247], a[192:195], a[152:155], v[244:247]
 ds_read_b128 a[152:155], v2 offset:45056
 v_mfma_f32_16x16x32_bf16 v[244:247], a[196:199], a[156:159], v[244:247]
 ds_read_b128 a[156:159], v2 offset:46080
 v_mfma_f32_16x16x32_bf16 v[240:243], a[196:199], a[148:151], v[240:243]
 ds_read_b128 a[148:151], v2 offset:41984
 v_mfma_f32_16x16x32_bf16 v[240:243], a[192:195], a[144:147], v[240:243]
 ds_read_b128 a[144:147], v2 offset:40960
 v_mfma_f32_16x16x32_bf16 v[236:239], a[192:195], a[136:139], v[236:239]
 ds_read_b128 a[136:139], v2 offset:36864
 v_mfma_f32_16x16x32_bf16 v[236:239], a[196:199], a[140:143], v[236:239]
 ds_read_b128 a[140:143], v2 offset:37888
 v_mfma_f32_16x16x32_bf16 v[232:235], a[196:199], a[132:135], v[232:235]
 ds_read_b128 a[132:135], v2 offset:33792
 v_mfma_f32_16x16x32_bf16 v[232:235], a[192:195], a[128:131], v[232:235]
 ds_read_b128 a[128:131], v2 offset:32768
 s_waitcnt vmcnt(8) lgkmcnt(8)
 v_mfma_f32_16x16x32_bf16 v[44:47], a[200:203], a[184:187], v[44:47]
 v_mfma_f32_16x16x32_bf16 v[44:47], a[204:207], a[188:191], v[44:47]
 global_load_dwordx4 a[196:199], v0, s[70:71] offset:-3072
 v_mfma_f32_16x16x32_bf16 v[40:43], a[204:207], a[180:183], v[40:43]
 v_mfma_f32_16x16x32_bf16 v[40:43], a[200:203], a[176:179], v[40:43]
 global_load_dwordx4 a[192:195], v0, s[70:71] offset:-4096
 v_mfma_f32_16x16x32_bf16 v[36:39], a[200:203], a[168:171], v[36:39]
 v_mfma_f32_16x16x32_bf16 v[36:39], a[204:207], a[172:175], v[36:39]
 v_mfma_f32_16x16x32_bf16 v[32:35], a[204:207], a[164:167], v[32:35]
 v_mfma_f32_16x16x32_bf16 v[32:35], a[200:203], a[160:163], v[32:35]
 s_waitcnt lgkmcnt(0)
 v_mfma_f32_16x16x32_bf16 v[28:31], a[200:203], a[152:155], v[28:31]
 v_mfma_f32_16x16x32_bf16 v[28:31], a[204:207], a[156:159], v[28:31]
 v_mfma_f32_16x16x32_bf16 v[24:27], a[204:207], a[148:151], v[24:27]
 v_mfma_f32_16x16x32_bf16 v[24:27], a[200:203], a[144:147], v[24:27]
 v_mfma_f32_16x16x32_bf16 v[20:23], a[200:203], a[136:139], v[20:23]
 v_mfma_f32_16x16x32_bf16 v[20:23], a[204:207], a[140:143], v[20:23]
 v_mfma_f32_16x16x32_bf16 v[16:19], a[204:207], a[132:135], v[16:19]
 v_mfma_f32_16x16x32_bf16 v[16:19], a[200:203], a[128:131], v[16:19]
 s_waitcnt vmcnt(8)
 v_mfma_f32_16x16x32_bf16 v[48:51], a[208:211], a[128:131], v[48:51]
 v_mfma_f32_16x16x32_bf16 v[48:51], a[212:215], a[132:135], v[48:51]
 global_load_dwordx4 a[204:207], v0, s[70:71] offset:-1024
 v_mfma_f32_16x16x32_bf16 v[52:55], a[212:215], a[140:143], v[52:55]
 v_mfma_f32_16x16x32_bf16 v[52:55], a[208:211], a[136:139], v[52:55]
 global_load_dwordx4 a[200:203], v0, s[70:71] offset:-2048
 v_mfma_f32_16x16x32_bf16 v[56:59], a[208:211], a[144:147], v[56:59]
 v_mfma_f32_16x16x32_bf16 v[56:59], a[212:215], a[148:151], v[56:59]
 v_mfma_f32_16x16x32_bf16 v[60:63], a[212:215], a[156:159], v[60:63]
 v_mfma_f32_16x16x32_bf16 v[60:63], a[208:211], a[152:155], v[60:63]
 v_mfma_f32_16x16x32_bf16 v[64:67], a[208:211], a[160:163], v[64:67]
 v_mfma_f32_16x16x32_bf16 v[64:67], a[212:215], a[164:167], v[64:67]
 v_mfma_f32_16x16x32_bf16 v[68:71], a[212:215], a[172:175], v[68:71]
 v_mfma_f32_16x16x32_bf16 v[68:71], a[208:211], a[168:171], v[68:71]
 v_mfma_f32_16x16x32_bf16 v[72:75], a[208:211], a[176:179], v[72:75]
 v_mfma_f32_16x16x32_bf16 v[72:75], a[212:215], a[180:183], v[72:75]
 v_mfma_f32_16x16x32_bf16 v[76:79], a[212:215], a[188:191], v[76:79]
 v_mfma_f32_16x16x32_bf16 v[76:79], a[208:211], a[184:187], v[76:79]
 s_waitcnt vmcnt(8)
 v_mfma_f32_16x16x32_bf16 v[108:111], a[216:219], a[184:187], v[108:111]
 v_mfma_f32_16x16x32_bf16 v[108:111], a[220:223], a[188:191], v[108:111]
 global_load_dwordx4 a[212:215], v0, s[70:71] offset:1024
 v_mfma_f32_16x16x32_bf16 v[104:107], a[220:223], a[180:183], v[104:107]
 v_mfma_f32_16x16x32_bf16 v[104:107], a[216:219], a[176:179], v[104:107]
 global_load_dwordx4 a[208:211], v0, s[70:71] offset:0
 v_mfma_f32_16x16x32_bf16 v[100:103], a[216:219], a[168:171], v[100:103]
 v_mfma_f32_16x16x32_bf16 v[100:103], a[220:223], a[172:175], v[100:103]
 v_mfma_f32_16x16x32_bf16 v[96:99], a[220:223], a[164:167], v[96:99]
 v_mfma_f32_16x16x32_bf16 v[96:99], a[216:219], a[160:163], v[96:99]
 v_mfma_f32_16x16x32_bf16 v[92:95], a[216:219], a[152:155], v[92:95]
 v_mfma_f32_16x16x32_bf16 v[92:95], a[220:223], a[156:159], v[92:95]
 v_mfma_f32_16x16x32_bf16 v[88:91], a[220:223], a[148:151], v[88:91]
 v_mfma_f32_16x16x32_bf16 v[88:91], a[216:219], a[144:147], v[88:91]
 v_mfma_f32_16x16x32_bf16 v[84:87], a[216:219], a[136:139], v[84:87]
 v_mfma_f32_16x16x32_bf16 v[84:87], a[220:223], a[140:143], v[84:87]
 v_mfma_f32_16x16x32_bf16 v[80:83], a[220:223], a[132:135], v[80:83]
 v_mfma_f32_16x16x32_bf16 v[80:83], a[216:219], a[128:131], v[80:83]
 s_waitcnt vmcnt(6)
 v_mfma_f32_16x16x32_bf16 v[112:115], a[224:227], a[128:131], v[112:115]
 v_mfma_f32_16x16x32_bf16 v[112:115], a[228:231], a[132:135], v[112:115]
 global_load_dwordx4 a[220:223], v0, s[70:71] offset:3072
 v_mfma_f32_16x16x32_bf16 v[116:119], a[228:231], a[140:143], v[116:119]
 v_mfma_f32_16x16x32_bf16 v[116:119], a[224:227], a[136:139], v[116:119]
 global_load_dwordx4 a[216:219], v0, s[70:71] offset:2048
 v_mfma_f32_16x16x32_bf16 v[120:123], a[224:227], a[144:147], v[120:123]
 s_add_u32 s70, s70, 8192
 s_addc_u32 s71, s71, 0
 v_mfma_f32_16x16x32_bf16 v[120:123], a[228:231], a[148:151], v[120:123]
 v_mfma_f32_16x16x32_bf16 v[124:127], a[228:231], a[156:159], v[124:127]
 v_mfma_f32_16x16x32_bf16 v[124:127], a[224:227], a[152:155], v[124:127]
 v_mfma_f32_16x16x32_bf16 v[128:131], a[224:227], a[160:163], v[128:131]
 v_mfma_f32_16x16x32_bf16 v[128:131], a[228:231], a[164:167], v[128:131]
 v_mfma_f32_16x16x32_bf16 v[132:135], a[228:231], a[172:175], v[132:135]
 v_mfma_f32_16x16x32_bf16 v[132:135], a[224:227], a[168:171], v[132:135]
 v_mfma_f32_16x16x32_bf16 a[240:243], a[224:227], a[176:179], a[240:243]
 v_mfma_f32_16x16x32_bf16 a[240:243], a[228:231], a[180:183], a[240:243]
 v_mfma_f32_16x16x32_bf16 a[244:247], a[228:231], a[188:191], a[244:247]
 v_mfma_f32_16x16x32_bf16 a[244:247], a[224:227], a[184:187], a[244:247]
 s_waitcnt vmcnt(6)
 v_mfma_f32_16x16x32_bf16 v[164:167], a[192:195], a[184:187], v[164:167]
 v_mfma_f32_16x16x32_bf16 v[164:167], a[196:199], a[188:191], v[164:167]
 global_load_dwordx4 a[228:231], v0, s[70:71] offset:-3072
 v_mfma_f32_16x16x32_bf16 v[160:163], a[196:199], a[180:183], v[160:163]
 v_mfma_f32_16x16x32_bf16 v[160:163], a[192:195], a[176:179], v[160:163]
 global_load_dwordx4 a[224:227], v0, s[70:71] offset:-4096
 v_mfma_f32_16x16x32_bf16 v[156:159], a[192:195], a[168:171], v[156:159]
 v_mfma_f32_16x16x32_bf16 v[156:159], a[196:199], a[172:175], v[156:159]
 global_load_dwordx4 a[236:239], v0, s[70:71] offset:-1024
 v_mfma_f32_16x16x32_bf16 v[152:155], a[196:199], a[164:167], v[152:155]
 v_mfma_f32_16x16x32_bf16 v[152:155], a[192:195], a[160:163], v[152:155]
 global_load_dwordx4 a[232:235], v0, s[70:71] offset:-2048
 v_mfma_f32_16x16x32_bf16 v[148:151], a[192:195], a[152:155], v[148:151]
 v_mfma_f32_16x16x32_bf16 v[148:151], a[196:199], a[156:159], v[148:151]
 v_mfma_f32_16x16x32_bf16 v[144:147], a[196:199], a[148:151], v[144:147]
 v_mfma_f32_16x16x32_bf16 v[144:147], a[192:195], a[144:147], v[144:147]
 v_mfma_f32_16x16x32_bf16 v[140:143], a[192:195], a[136:139], v[140:143]
 v_mfma_f32_16x16x32_bf16 v[140:143], a[196:199], a[140:143], v[140:143]
 v_mfma_f32_16x16x32_bf16 v[136:139], a[196:199], a[132:135], v[136:139]
 v_mfma_f32_16x16x32_bf16 v[136:139], a[192:195], a[128:131], v[136:139]
 s_waitcnt vmcnt(8)
 v_mfma_f32_16x16x32_bf16 v[168:171], a[200:203], a[128:131], v[168:171]
 v_mfma_f32_16x16x32_bf16 v[168:171], a[204:207], a[132:135], v[168:171]
 global_load_dwordx4 a[196:199], v0, s[70:71] offset:1024
 v_mfma_f32_16x16x32_bf16 v[172:175], a[204:207], a[140:143], v[172:175]
 v_mfma_f32_16x16x32_bf16 v[172:175], a[200:203], a[136:139], v[172:175]
 global_load_dwordx4 a[192:195], v0, s[70:71] offset:0
 v_mfma_f32_16x16x32_bf16 v[176:179], a[200:203], a[144:147], v[176:179]
 v_mfma_f32_16x16x32_bf16 v[176:179], a[204:207], a[148:151], v[176:179]
 v_mfma_f32_16x16x32_bf16 v[180:183], a[204:207], a[156:159], v[180:183]
 v_mfma_f32_16x16x32_bf16 v[180:183], a[200:203], a[152:155], v[180:183]
 v_mfma_f32_16x16x32_bf16 v[184:187], a[200:203], a[160:163], v[184:187]
 v_mfma_f32_16x16x32_bf16 v[184:187], a[204:207], a[164:167], v[184:187]
 v_mfma_f32_16x16x32_bf16 v[188:191], a[204:207], a[172:175], v[188:191]
 v_mfma_f32_16x16x32_bf16 v[188:191], a[200:203], a[168:171], v[188:191]
 v_mfma_f32_16x16x32_bf16 v[192:195], a[200:203], a[176:179], v[192:195]
 v_mfma_f32_16x16x32_bf16 v[192:195], a[204:207], a[180:183], v[192:195]
 v_mfma_f32_16x16x32_bf16 v[196:199], a[204:207], a[188:191], v[196:199]
 v_mfma_f32_16x16x32_bf16 v[196:199], a[200:203], a[184:187], v[196:199]
 s_waitcnt vmcnt(8)
 v_mfma_f32_16x16x32_bf16 v[228:231], a[208:211], a[184:187], v[228:231]
 v_mfma_f32_16x16x32_bf16 v[228:231], a[212:215], a[188:191], v[228:231]
 global_load_dwordx4 a[204:207], v0, s[70:71] offset:3072
 v_mfma_f32_16x16x32_bf16 v[224:227], a[212:215], a[180:183], v[224:227]
 v_mfma_f32_16x16x32_bf16 v[224:227], a[208:211], a[176:179], v[224:227]
 global_load_dwordx4 a[200:203], v0, s[70:71] offset:2048
 v_mfma_f32_16x16x32_bf16 v[220:223], a[208:211], a[168:171], v[220:223]
 s_add_u32 s70, s70, 8192
 s_addc_u32 s71, s71, 0
 v_mfma_f32_16x16x32_bf16 v[220:223], a[212:215], a[172:175], v[220:223]
 v_mfma_f32_16x16x32_bf16 v[216:219], a[212:215], a[164:167], v[216:219]
 v_mfma_f32_16x16x32_bf16 v[216:219], a[208:211], a[160:163], v[216:219]
 v_mfma_f32_16x16x32_bf16 v[212:215], a[208:211], a[152:155], v[212:215]
 v_mfma_f32_16x16x32_bf16 v[212:215], a[212:215], a[156:159], v[212:215]
 v_mfma_f32_16x16x32_bf16 v[208:211], a[212:215], a[148:151], v[208:211]
 s_waitcnt lgkmcnt(0)
 s_barrier
 v_mfma_f32_16x16x32_bf16 v[208:211], a[208:211], a[144:147], v[208:211]
 v_mfma_f32_16x16x32_bf16 v[204:207], a[208:211], a[136:139], v[204:207]
 v_mfma_f32_16x16x32_bf16 v[204:207], a[212:215], a[140:143], v[204:207]
 v_mfma_f32_16x16x32_bf16 v[200:203], a[212:215], a[132:135], v[200:203]
 v_mfma_f32_16x16x32_bf16 v[200:203], a[208:211], a[128:131], v[200:203]
 s_waitcnt vmcnt(8)
 v_mfma_f32_16x16x32_bf16 v[232:235], a[216:219], a[128:131], v[232:235]
 ds_read_b128 a[128:131], v1 offset:2048
 v_mfma_f32_16x16x32_bf16 v[232:235], a[220:223], a[132:135], v[232:235]
 global_load_dwordx4 a[212:215], v0, s[70:71] offset:-3072
 ds_read_b128 a[132:135], v1 offset:3072
 v_mfma_f32_16x16x32_bf16 v[236:239], a[220:223], a[140:143], v[236:239]
 ds_read_b128 a[140:143], v1 offset:7168
 v_mfma_f32_16x16x32_bf16 v[236:239], a[216:219], a[136:139], v[236:239]
 global_load_dwordx4 a[208:211], v0, s[70:71] offset:-4096
 ds_read_b128 a[136:139], v1 offset:6144
 v_mfma_f32_16x16x32_bf16 v[240:243], a[216:219], a[144:147], v[240:243]
 ds_read_b128 a[144:147], v1 offset:10240
 v_mfma_f32_16x16x32_bf16 v[240:243], a[220:223], a[148:151], v[240:243]
 ds_read_b128 a[148:151], v1 offset:11264
 v_mfma_f32_16x16x32_bf16 v[244:247], a[220:223], a[156:159], v[244:247]
 ds_read_b128 a[156:159], v1 offset:15360
 v_mfma_f32_16x16x32_bf16 v[244:247], a[216:219], a[152:155], v[244:247]
 ds_read_b128 a[152:155], v1 offset:14336
 v_mfma_f32_16x16x32_bf16 v[248:251], a[216:219], a[160:163], v[248:251]
 ds_read_b128 a[160:163], v1 offset:18432
 v_mfma_f32_16x16x32_bf16 v[248:251], a[220:223], a[164:167], v[248:251]
 ds_read_b128 a[164:167], v1 offset:19456
 v_mfma_f32_16x16x32_bf16 v[252:255], a[220:223], a[172:175], v[252:255]
 ds_read_b128 a[172:175], v1 offset:23552
 v_mfma_f32_16x16x32_bf16 v[252:255], a[216:219], a[168:171], v[252:255]
 ds_read_b128 a[168:171], v1 offset:22528
 v_mfma_f32_16x16x32_bf16 a[248:251], a[216:219], a[176:179], a[248:251]
 ds_read_b128 a[176:179], v1 offset:26624
 v_mfma_f32_16x16x32_bf16 a[248:251], a[220:223], a[180:183], a[248:251]
 ds_read_b128 a[180:183], v1 offset:27648
 v_mfma_f32_16x16x32_bf16 a[252:255], a[220:223], a[188:191], a[252:255]
 global_load_dwordx4 a[220:223], v0, s[70:71] offset:-1024
 ds_read_b128 a[188:191], v1 offset:31744
 v_mfma_f32_16x16x32_bf16 a[252:255], a[216:219], a[184:187], a[252:255]
 global_load_dwordx4 a[216:219], v0, s[70:71] offset:-2048
 ds_read_b128 a[184:187], v1 offset:30720
 s_waitcnt vmcnt(10) lgkmcnt(8)
 v_mfma_f32_16x16x32_bf16 v[16:19], a[224:227], a[128:131], v[16:19]
 v_mov_b32 v7, 1
 v_mfma_f32_16x16x32_bf16 v[16:19], a[228:231], a[132:135], v[16:19]
 v_mfma_f32_16x16x32_bf16 v[20:23], a[228:231], a[140:143], v[20:23]
 buffer_atomic_add v7, v0, s[56:59], 0 offen sc1
 v_mfma_f32_16x16x32_bf16 v[20:23], a[224:227], a[136:139], v[20:23]
 v_lshrrev_b32 v4, 8, v1
 v_mfma_f32_16x16x32_bf16 v[24:27], a[224:227], a[144:147], v[24:27]
 v_mfma_f32_16x16x32_bf16 v[24:27], a[228:231], a[148:151], v[24:27]
 v_lshl_add_u32 v4, v4, 5, s51
 v_mfma_f32_16x16x32_bf16 v[28:31], a[228:231], a[156:159], v[28:31]
 ds_read_b128 v[8:11], v4 offset:256
 v_mfma_f32_16x16x32_bf16 v[28:31], a[224:227], a[152:155], v[28:31]
 s_waitcnt lgkmcnt(1)
 v_mfma_f32_16x16x32_bf16 v[32:35], a[224:227], a[160:163], v[32:35]
 v_mfma_f32_16x16x32_bf16 v[32:35], a[228:231], a[164:167], v[32:35]
 v_mfma_f32_16x16x32_bf16 v[36:39], a[228:231], a[172:175], v[36:39]
 v_mfma_f32_16x16x32_bf16 v[36:39], a[224:227], a[168:171], v[36:39]
 v_mfma_f32_16x16x32_bf16 v[40:43], a[224:227], a[176:179], v[40:43]
 v_mfma_f32_16x16x32_bf16 v[40:43], a[228:231], a[180:183], v[40:43]
 v_mfma_f32_16x16x32_bf16 v[44:47], a[228:231], a[188:191], v[44:47]
 v_mfma_f32_16x16x32_bf16 v[44:47], a[224:227], a[184:187], v[44:47]
 s_waitcnt vmcnt(9)
 v_mfma_f32_16x16x32_bf16 v[76:79], a[232:235], a[184:187], v[76:79]
 v_mfma_f32_16x16x32_bf16 v[76:79], a[236:239], a[188:191], v[76:79]
 global_load_dwordx4 a[228:231], v0, s[70:71] offset:1024
 v_mfma_f32_16x16x32_bf16 v[72:75], a[236:239], a[180:183], v[72:75]
 v_mfma_f32_16x16x32_bf16 v[72:75], a[232:235], a[176:179], v[72:75]
 global_load_dwordx4 a[224:227], v0, s[70:71] offset:0
 v_mfma_f32_16x16x32_bf16 v[68:71], a[232:235], a[168:171], v[68:71]
 s_waitcnt lgkmcnt(0)
 v_mfma_f32_16x16x32_bf16 v[68:71], a[236:239], a[172:175], v[68:71]
 v_mfma_f32_16x16x32_bf16 v[64:67], a[236:239], a[164:167], v[64:67]
 v_add_f32 v136, v136, v8
 v_mfma_f32_16x16x32_bf16 v[64:67], a[232:235], a[160:163], v[64:67]
 v_mfma_f32_16x16x32_bf16 v[60:63], a[232:235], a[152:155], v[60:63]
 ds_read_b128 v[12:15], v4 offset:272
 v_mfma_f32_16x16x32_bf16 v[60:63], a[236:239], a[156:159], v[60:63]
 v_add_f32 v137, v137, v9
 v_mfma_f32_16x16x32_bf16 v[56:59], a[236:239], a[148:151], v[56:59]
 v_mfma_f32_16x16x32_bf16 v[56:59], a[232:235], a[144:147], v[56:59]
 v_add_f32 v138, v138, v10
 v_mfma_f32_16x16x32_bf16 v[52:55], a[232:235], a[136:139], v[52:55]
 v_add_f32 v139, v139, v11
 v_mfma_f32_16x16x32_bf16 v[52:55], a[236:239], a[140:143], v[52:55]
 v_mfma_f32_16x16x32_bf16 v[48:51], a[236:239], a[132:135], v[48:51]
 v_add_f32 v140, v140, v8
 v_mfma_f32_16x16x32_bf16 v[48:51], a[232:235], a[128:131], v[48:51]
 v_add_f32 v141, v141, v9
 s_waitcnt vmcnt(9)
 v_mfma_f32_16x16x32_bf16 v[80:83], a[192:195], a[128:131], v[80:83]
 v_mfma_f32_16x16x32_bf16 v[80:83], a[196:199], a[132:135], v[80:83]
 global_load_dwordx4 a[236:239], v0, s[70:71] offset:3072
 v_add_f32 v142, v142, v10
 v_mfma_f32_16x16x32_bf16 v[84:87], a[196:199], a[140:143], v[84:87]
 v_add_f32 v143, v143, v11
 v_mfma_f32_16x16x32_bf16 v[84:87], a[192:195], a[136:139], v[84:87]
 global_load_dwordx4 a[232:235], v0, s[70:71] offset:2048
 v_mfma_f32_16x16x32_bf16 v[88:91], a[192:195], a[144:147], v[88:91]
 v_add_f32 v144, v144, v8
 s_add_u32 s70, s70, 8192
 s_addc_u32 s71, s71, 0
 v_mfma_f32_16x16x32_bf16 v[88:91], a[196:199], a[148:151], v[88:91]
 v_mfma_f32_16x16x32_bf16 v[92:95], a[196:199], a[156:159], v[92:95]
 v_add_f32 v145, v145, v9
 v_mfma_f32_16x16x32_bf16 v[92:95], a[192:195], a[152:155], v[92:95]
 v_add_f32 v146, v146, v10
 v_mfma_f32_16x16x32_bf16 v[96:99], a[192:195], a[160:163], v[96:99]
 v_mfma_f32_16x16x32_bf16 v[96:99], a[196:199], a[164:167], v[96:99]
 v_add_f32 v147, v147, v11
 v_mfma_f32_16x16x32_bf16 v[100:103], a[196:199], a[172:175], v[100:103]
 v_add_f32 v148, v148, v8
 v_mfma_f32_16x16x32_bf16 v[100:103], a[192:195], a[168:171], v[100:103]
 v_mfma_f32_16x16x32_bf16 v[104:107], a[192:195], a[176:179], v[104:107]
 v_add_f32 v149, v149, v9
 v_mfma_f32_16x16x32_bf16 v[104:107], a[196:199], a[180:183], v[104:107]
 v_add_f32 v150, v150, v10
 v_mfma_f32_16x16x32_bf16 v[108:111], a[196:199], a[188:191], v[108:111]
 v_mfma_f32_16x16x32_bf16 v[108:111], a[192:195], a[184:187], v[108:111]
 v_add_f32 v151, v151, v11
 s_waitcnt vmcnt(9)
 v_mfma_f32_16x16x32_bf16 a[244:247], a[200:203], a[184:187], a[244:247]
 ds_read_b128 a[184:187], v1 offset:63488
 v_add_f32 v152, v152, v8
 v_mfma_f32_16x16x32_bf16 a[244:247], a[204:207], a[188:191], a[244:247]
 global_load_dwordx4 a[196:199], v0, s[70:71] offset:-3072
 ds_read_b128 a[188:191], v1 offset:64512
 v_mfma_f32_16x16x32_bf16 a[240:243], a[204:207], a[180:183], a[240:243]
 ds_read_b128 a[180:183], v1 offset:60416
 v_add_f32 v153, v153, v9
 v_mfma_f32_16x16x32_bf16 a[240:243], a[200:203], a[176:179], a[240:243]
 global_load_dwordx4 a[192:195], v0, s[70:71] offset:-4096
 ds_read_b128 a[176:179], v1 offset:59392
 v_mfma_f32_16x16x32_bf16 v[132:135], a[200:203], a[168:171], v[132:135]
 ds_read_b128 a[168:171], v1 offset:55296
 v_add_f32 v154, v154, v10
 v_mfma_f32_16x16x32_bf16 v[132:135], a[204:207], a[172:175], v[132:135]
 ds_read_b128 a[172:175], v1 offset:56320
 v_add_f32 v155, v155, v11
 v_mfma_f32_16x16x32_bf16 v[128:131], a[204:207], a[164:167], v[128:131]
 ds_read_b128 a[164:167], v1 offset:52224
 v_mfma_f32_16x16x32_bf16 v[128:131], a[200:203], a[160:163], v[128:131]
 ds_read_b128 a[160:163], v1 offset:51200
 v_add_f32 v156, v156, v8
 v_mfma_f32_16x16x32_bf16 v[124:127], a[200:203], a[152:155], v[124:127]
 ds_read_b128 a[152:155], v1 offset:47104
 v_add_f32 v157, v157, v9
 v_mfma_f32_16x16x32_bf16 v[124:127], a[204:207], a[156:159], v[124:127]
 ds_read_b128 a[156:159], v1 offset:48128
 v_mfma_f32_16x16x32_bf16 v[120:123], a[204:207], a[148:151], v[120:123]
 ds_read_b128 a[148:151], v1 offset:44032
 v_add_f32 v158, v158, v10
 v_mfma_f32_16x16x32_bf16 v[120:123], a[200:203], a[144:147], v[120:123]
 ds_read_b128 a[144:147], v1 offset:43008
 v_add_f32 v159, v159, v11
 v_mfma_f32_16x16x32_bf16 v[116:119], a[200:203], a[136:139], v[116:119]
 ds_read_b128 a[136:139], v1 offset:38912
 v_mfma_f32_16x16x32_bf16 v[116:119], a[204:207], a[140:143], v[116:119]
 ds_read_b128 a[140:143], v1 offset:39936
 v_add_f32 v160, v160, v8
 v_mfma_f32_16x16x32_bf16 v[112:115], a[204:207], a[132:135], v[112:115]
 ds_read_b128 a[132:135], v1 offset:35840
 v_add_f32 v161, v161, v9
 v_mfma_f32_16x16x32_bf16 v[112:115], a[200:203], a[128:131], v[112:115]
 ds_read_b128 a[128:131], v1 offset:34816
 s_waitcnt vmcnt(9) lgkmcnt(8)
 v_mfma_f32_16x16x32_bf16 v[44:47], a[208:211], a[184:187], v[44:47]
 v_add_f32 v162, v162, v10
 v_mfma_f32_16x16x32_bf16 v[44:47], a[212:215], a[188:191], v[44:47]
 global_load_dwordx4 a[204:207], v0, s[70:71] offset:-1024
 v_mfma_f32_16x16x32_bf16 v[40:43], a[212:215], a[180:183], v[40:43]
 v_add_f32 v163, v163, v11
 v_mfma_f32_16x16x32_bf16 v[40:43], a[208:211], a[176:179], v[40:43]
 global_load_dwordx4 a[200:203], v0, s[70:71] offset:-2048
 v_add_f32 v164, v164, v8
 v_mfma_f32_16x16x32_bf16 v[36:39], a[208:211], a[168:171], v[36:39]
 v_mfma_f32_16x16x32_bf16 v[36:39], a[212:215], a[172:175], v[36:39]
 v_add_f32 v165, v165, v9
 v_mfma_f32_16x16x32_bf16 v[32:35], a[212:215], a[164:167], v[32:35]
 v_add_f32 v166, v166, v10
 v_mfma_f32_16x16x32_bf16 v[32:35], a[208:211], a[160:163], v[32:35]
 s_waitcnt lgkmcnt(0)
 v_mfma_f32_16x16x32_bf16 v[28:31], a[208:211], a[152:155], v[28:31]
 v_add_f32 v167, v167, v11
 v_mfma_f32_16x16x32_bf16 v[28:31], a[212:215], a[156:159], v[28:31]
 v_mfma_f32_16x16x32_bf16 v[24:27], a[212:215], a[148:151], v[24:27]
 v_mfma_f32_16x16x32_bf16 v[24:27], a[208:211], a[144:147], v[24:27]
 v_add_f32 v168, v168, v12
 v_mfma_f32_16x16x32_bf16 v[20:23], a[208:211], a[136:139], v[20:23]
 ds_read_b128 v[8:11], v4 offset:384
 v_mfma_f32_16x16x32_bf16 v[20:23], a[212:215], a[140:143], v[20:23]
 v_mfma_f32_16x16x32_bf16 v[16:19], a[212:215], a[132:135], v[16:19]
 v_add_f32 v169, v169, v13
 v_mfma_f32_16x16x32_bf16 v[16:19], a[208:211], a[128:131], v[16:19]
 s_waitcnt vmcnt(9)
 v_mfma_f32_16x16x32_bf16 v[48:51], a[216:219], a[128:131], v[48:51]
 v_add_f32 v170, v170, v14
 v_mfma_f32_16x16x32_bf16 v[48:51], a[220:223], a[132:135], v[48:51]
 global_load_dwordx4 a[212:215], v0, s[70:71] offset:1024
 v_add_f32 v171, v171, v15
 v_mfma_f32_16x16x32_bf16 v[52:55], a[220:223], a[140:143], v[52:55]
 v_mfma_f32_16x16x32_bf16 v[52:55], a[216:219], a[136:139], v[52:55]
 global_load_dwordx4 a[208:211], v0, s[70:71] offset:0
 v_add_f32 v172, v172, v12
 v_mfma_f32_16x16x32_bf16 v[56:59], a[216:219], a[144:147], v[56:59]
 v_add_f32 v173, v173, v13
 v_mfma_f32_16x16x32_bf16 v[56:59], a[220:223], a[148:151], v[56:59]
 v_mfma_f32_16x16x32_bf16 v[60:63], a[220:223], a[156:159], v[60:63]
 v_add_f32 v174, v174, v14
 v_mfma_f32_16x16x32_bf16 v[60:63], a[216:219], a[152:155], v[60:63]
 v_add_f32 v175, v175, v15
 v_mfma_f32_16x16x32_bf16 v[64:67], a[216:219], a[160:163], v[64:67]
 v_mfma_f32_16x16x32_bf16 v[64:67], a[220:223], a[164:167], v[64:67]
 v_add_f32 v176, v176, v12
 v_mfma_f32_16x16x32_bf16 v[68:71], a[220:223], a[172:175], v[68:71]
 v_add_f32 v177, v177, v13
 v_mfma_f32_16x16x32_bf16 v[68:71], a[216:219], a[168:171], v[68:71]
 v_mfma_f32_16x16x32_bf16 v[72:75], a[216:219], a[176:179], v[72:75]
 v_add_f32 v178, v178, v14
 v_mfma_f32_16x16x32_bf16 v[72:75], a[220:223], a[180:183], v[72:75]
 v_mfma_f32_16x16x32_bf16 v[76:79], a[220:223], a[188:191], v[76:79]
 v_add_f32 v179, v179, v15
 v_mfma_f32_16x16x32_bf16 v[76:79], a[216:219], a[184:187], v[76:79]
 v_add_f32 v180, v180, v12
 s_waitcnt vmcnt(8)
 v_mfma_f32_16x16x32_bf16 v[108:111], a[224:227], a[184:187], v[108:111]
 v_mfma_f32_16x16x32_bf16 v[108:111], a[228:231], a[188:191], v[108:111]
 global_load_dwordx4 a[220:223], v0, s[70:71] offset:3072
 v_add_f32 v181, v181, v13
 v_mfma_f32_16x16x32_bf16 v[104:107], a[228:231], a[180:183], v[104:107]
 v_add_f32 v182, v182, v14
 v_mfma_f32_16x16x32_bf16 v[104:107], a[224:227], a[176:179], v[104:107]
 global_load_dwordx4 a[216:219], v0, s[70:71] offset:2048
 v_mfma_f32_16x16x32_bf16 v[100:103], a[224:227], a[168:171], v[100:103]
 v_add_f32 v183, v183, v15
 s_add_u32 s70, s70, 8192
 s_addc_u32 s71, s71, 0
 v_mfma_f32_16x16x32_bf16 v[100:103], a[228:231], a[172:175], v[100:103]
 v_add_f32 v184, v184, v12
 v_mfma_f32_16x16x32_bf16 v[96:99], a[228:231], a[164:167], v[96:99]
 v_mfma_f32_16x16x32_bf16 v[96:99], a[224:227], a[160:163], v[96:99]
 v_add_f32 v185, v185, v13
 v_mfma_f32_16x16x32_bf16 v[92:95], a[224:227], a[152:155], v[92:95]
 v_add_f32 v186, v186, v14
 v_mfma_f32_16x16x32_bf16 v[92:95], a[228:231], a[156:159], v[92:95]
 v_mfma_f32_16x16x32_bf16 v[88:91], a[228:231], a[148:151], v[88:91]
 v_add_f32 v187, v187, v15
 v_mfma_f32_16x16x32_bf16 v[88:91], a[224:227], a[144:147], v[88:91]
 v_mfma_f32_16x16x32_bf16 v[84:87], a[224:227], a[136:139], v[84:87]
 v_add_f32 v188, v188, v12
 v_mfma_f32_16x16x32_bf16 v[84:87], a[228:231], a[140:143], v[84:87]
 v_add_f32 v189, v189, v13
 v_mfma_f32_16x16x32_bf16 v[80:83], a[228:231], a[132:135], v[80:83]
 v_mfma_f32_16x16x32_bf16 v[80:83], a[224:227], a[128:131], v[80:83]
 v_add_f32 v190, v190, v14
 s_waitcnt vmcnt(8)
 v_mfma_f32_16x16x32_bf16 v[112:115], a[232:235], a[128:131], v[112:115]
 ds_read_b128 a[128:131], v2 offset:2048
 v_add_f32 v191, v191, v15
 v_mfma_f32_16x16x32_bf16 v[112:115], a[236:239], a[132:135], v[112:115]
 global_load_dwordx4 a[228:231], v0, s[70:71] offset:-3072
 ds_read_b128 a[132:135], v2 offset:3072
 v_mfma_f32_16x16x32_bf16 v[116:119], a[236:239], a[140:143], v[116:119]
 ds_read_b128 a[140:143], v2 offset:7168
 v_add_f32 v192, v192, v12
 v_mfma_f32_16x16x32_bf16 v[116:119], a[232:235], a[136:139], v[116:119]
 global_load_dwordx4 a[224:227], v0, s[70:71] offset:-4096
 ds_read_b128 a[136:139], v2 offset:6144
 v_mfma_f32_16x16x32_bf16 v[120:123], a[232:235], a[144:147], v[120:123]
 ds_read_b128 a[144:147], v2 offset:10240
 v_add_f32 v193, v193, v13
 v_mfma_f32_16x16x32_bf16 v[120:123], a[236:239], a[148:151], v[120:123]
 ds_read_b128 a[148:151], v2 offset:11264
 v_add_f32 v194, v194, v14
 v_mfma_f32_16x16x32_bf16 v[124:127], a[236:239], a[156:159], v[124:127]
 ds_read_b128 a[156:159], v2 offset:15360
 v_add_f32 v195, v195, v15
 v_mfma_f32_16x16x32_bf16 v[124:127], a[232:235], a[152:155], v[124:127]
 ds_read_b128 a[152:155], v2 offset:14336
 v_mfma_f32_16x16x32_bf16 v[128:131], a[232:235], a[160:163], v[128:131]
 ds_read_b128 a[160:163], v2 offset:18432
 v_add_f32 v196, v196, v12
 v_mfma_f32_16x16x32_bf16 v[128:131], a[236:239], a[164:167], v[128:131]
 ds_read_b128 a[164:167], v2 offset:19456
 v_mfma_f32_16x16x32_bf16 v[132:135], a[236:239], a[172:175], v[132:135]
 ds_read_b128 a[172:175], v2 offset:23552
 v_add_f32 v197, v197, v13
 v_mfma_f32_16x16x32_bf16 v[132:135], a[232:235], a[168:171], v[132:135]
 ds_read_b128 a[168:171], v2 offset:22528
 v_add_f32 v198, v198, v14
 v_mfma_f32_16x16x32_bf16 a[240:243], a[232:235], a[176:179], a[240:243]
 ds_read_b128 a[176:179], v2 offset:26624
 v_mfma_f32_16x16x32_bf16 a[240:243], a[236:239], a[180:183], a[240:243]
 ds_read_b128 a[180:183], v2 offset:27648
 v_add_f32 v199, v199, v15
 v_mfma_f32_16x16x32_bf16 a[244:247], a[236:239], a[188:191], a[244:247]
 ds_read_b128 a[188:191], v2 offset:31744
 s_waitcnt lgkmcnt(15)
 v_mfma_f32_16x16x32_bf16 a[244:247], a[232:235], a[184:187], a[244:247]
 ds_read_b128 a[184:187], v2 offset:30720
 s_waitcnt vmcnt(8) lgkmcnt(8)
 v_mfma_f32_16x16x32_bf16 v[16:19], a[192:195], a[128:131], v[16:19]
 v_add_f32 v200, v200, v8
 v_mfma_f32_16x16x32_bf16 v[16:19], a[196:199], a[132:135], v[16:19]
 global_load_dwordx4 a[236:239], v0, s[70:71] offset:-1024
 ds_read_b128 v[12:15], v4 offset:400
 v_mfma_f32_16x16x32_bf16 v[20:23], a[196:199], a[140:143], v[20:23]
 v_mfma_f32_16x16x32_bf16 v[20:23], a[192:195], a[136:139], v[20:23]
 global_load_dwordx4 a[232:235], v0, s[70:71] offset:-2048
 v_add_f32 v201, v201, v9
 v_mfma_f32_16x16x32_bf16 v[24:27], a[192:195], a[144:147], v[24:27]
 v_add_f32 v202, v202, v10
 v_mfma_f32_16x16x32_bf16 v[24:27], a[196:199], a[148:151], v[24:27]
 v_mfma_f32_16x16x32_bf16 v[28:31], a[196:199], a[156:159], v[28:31]
 v_add_f32 v203, v203, v11
 v_mfma_f32_16x16x32_bf16 v[28:31], a[192:195], a[152:155], v[28:31]
 s_waitcnt lgkmcnt(1)
 v_mfma_f32_16x16x32_bf16 v[32:35], a[192:195], a[160:163], v[32:35]
 v_add_f32 v204, v204, v8
 v_mfma_f32_16x16x32_bf16 v[32:35], a[196:199], a[164:167], v[32:35]
 v_add_f32 v205, v205, v9
 v_mfma_f32_16x16x32_bf16 v[36:39], a[196:199], a[172:175], v[36:39]
 v_mfma_f32_16x16x32_bf16 v[36:39], a[192:195], a[168:171], v[36:39]
 v_add_f32 v206, v206, v10
 v_mfma_f32_16x16x32_bf16 v[40:43], a[192:195], a[176:179], v[40:43]
 v_add_f32 v207, v207, v11
 v_mfma_f32_16x16x32_bf16 v[40:43], a[196:199], a[180:183], v[40:43]
 v_mfma_f32_16x16x32_bf16 v[44:47], a[196:199], a[188:191], v[44:47]
 v_add_f32 v208, v208, v8
 v_mfma_f32_16x16x32_bf16 v[44:47], a[192:195], a[184:187], v[44:47]
 v_add_f32 v209, v209, v9
 s_waitcnt vmcnt(8)
 v_mfma_f32_16x16x32_bf16 v[76:79], a[200:203], a[184:187], v[76:79]
 v_mfma_f32_16x16x32_bf16 v[76:79], a[204:207], a[188:191], v[76:79]
 global_load_dwordx4 a[196:199], v0, s[70:71] offset:1024
 v_add_f32 v210, v210, v10
 v_mfma_f32_16x16x32_bf16 v[72:75], a[204:207], a[180:183], v[72:75]
 v_add_f32 v211, v211, v11
 v_mfma_f32_16x16x32_bf16 v[72:75], a[200:203], a[176:179], v[72:75]
 global_load_dwordx4 a[192:195], v0, s[70:71] offset:0
 v_mfma_f32_16x16x32_bf16 v[68:71], a[200:203], a[168:171], v[68:71]
 v_add_f32 v212, v212, v8
 v_mfma_f32_16x16x32_bf16 v[68:71], a[204:207], a[172:175], v[68:71]
 v_mfma_f32_16x16x32_bf16 v[64:67], a[204:207], a[164:167], v[64:67]
 v_add_f32 v213, v213, v9
 v_mfma_f32_16x16x32_bf16 v[64:67], a[200:203], a[160:163], v[64:67]
 v_add_f32 v214, v214, v10
 v_mfma_f32_16x16x32_bf16 v[60:63], a[200:203], a[152:155], v[60:63]
 v_mfma_f32_16x16x32_bf16 v[60:63], a[204:207], a[156:159], v[60:63]
 v_add_f32 v215, v215, v11
 v_mfma_f32_16x16x32_bf16 v[56:59], a[204:207], a[148:151], v[56:59]
 v_add_f32 v216, v216, v8
 v_mfma_f32_16x16x32_bf16 v[56:59], a[200:203], a[144:147], v[56:59]
 v_mfma_f32_16x16x32_bf16 v[52:55], a[200:203], a[136:139], v[52:55]
 v_add_f32 v217, v217, v9
 v_mfma_f32_16x16x32_bf16 v[52:55], a[204:207], a[140:143], v[52:55]
 v_add_f32 v218, v218, v10
 v_mfma_f32_16x16x32_bf16 v[48:51], a[204:207], a[132:135], v[48:51]
 v_mfma_f32_16x16x32_bf16 v[48:51], a[200:203], a[128:131], v[48:51]
 v_add_f32 v219, v219, v11
 s_waitcnt vmcnt(8)
 v_mfma_f32_16x16x32_bf16 v[80:83], a[208:211], a[128:131], v[80:83]
 v_add_f32 v220, v220, v8
 v_mfma_f32_16x16x32_bf16 v[80:83], a[212:215], a[132:135], v[80:83]
 global_load_dwordx4 a[204:207], v0, s[70:71] offset:3072
 v_mfma_f32_16x16x32_bf16 v[84:87], a[212:215], a[140:143], v[84:87]
 v_add_f32 v221, v221, v9
 v_mfma_f32_16x16x32_bf16 v[84:87], a[208:211], a[136:139], v[84:87]
 global_load_dwordx4 a[200:203], v0, s[70:71] offset:2048
 v_mfma_f32_16x16x32_bf16 v[88:91], a[208:211], a[144:147], v[88:91]
 v_add_f32 v222, v222, v10
 s_add_u32 s70, s70, 8192
 s_addc_u32 s71, s71, 0
 v_mfma_f32_16x16x32_bf16 v[88:91], a[212:215], a[148:151], v[88:91]
 v_add_f32 v223, v223, v11
 v_mfma_f32_16x16x32_bf16 v[92:95], a[212:215], a[156:159], v[92:95]
 v_mfma_f32_16x16x32_bf16 v[92:95], a[208:211], a[152:155], v[92:95]
 v_add_f32 v224, v224, v8
 v_mfma_f32_16x16x32_bf16 v[96:99], a[208:211], a[160:163], v[96:99]
 v_add_f32 v225, v225, v9
 v_mfma_f32_16x16x32_bf16 v[96:99], a[212:215], a[164:167], v[96:99]
 v_mfma_f32_16x16x32_bf16 v[100:103], a[212:215], a[172:175], v[100:103]
 v_add_f32 v226, v226, v10
 v_mfma_f32_16x16x32_bf16 v[100:103], a[208:211], a[168:171], v[100:103]
 v_add_f32 v227, v227, v11
 v_mfma_f32_16x16x32_bf16 v[104:107], a[208:211], a[176:179], v[104:107]
 v_mfma_f32_16x16x32_bf16 v[104:107], a[212:215], a[180:183], v[104:107]
 v_add_f32 v228, v228, v8
 v_mfma_f32_16x16x32_bf16 v[108:111], a[212:215], a[188:191], v[108:111]
 v_add_f32 v229, v229, v9
 v_mfma_f32_16x16x32_bf16 v[108:111], a[208:211], a[184:187], v[108:111]
 s_waitcnt vmcnt(8)
 v_mfma_f32_16x16x32_bf16 a[244:247], a[216:219], a[184:187], a[244:247]
 ds_read_b128 a[184:187], v2 offset:63488
 v_add_f32 v230, v230, v10
 v_mfma_f32_16x16x32_bf16 a[244:247], a[220:223], a[188:191], a[244:247]
 global_load_dwordx4 a[212:215], v0, s[70:71] offset:-3072
 ds_read_b128 a[188:191], v2 offset:64512
 v_mfma_f32_16x16x32_bf16 a[240:243], a[220:223], a[180:183], a[240:243]
 ds_read_b128 a[180:183], v2 offset:60416
 v_add_f32 v231, v231, v11
 v_mfma_f32_16x16x32_bf16 a[240:243], a[216:219], a[176:179], a[240:243]
 global_load_dwordx4 a[208:211], v0, s[70:71] offset:-4096
 ds_read_b128 a[176:179], v2 offset:59392
 s_waitcnt lgkmcnt(4)
 v_mfma_f32_16x16x32_bf16 v[132:135], a[216:219], a[168:171], v[132:135]
 ds_read_b128 a[168:171], v2 offset:55296
 v_mfma_f32_16x16x32_bf16 v[132:135], a[220:223], a[172:175], v[132:135]
 ds_read_b128 a[172:175], v2 offset:56320
 v_add_f32 v232, v232, v12
 v_mfma_f32_16x16x32_bf16 v[128:131], a[220:223], a[164:167], v[128:131]
 ds_read_b128 a[164:167], v2 offset:52224
 v_add_f32 v233, v233, v13
 v_mfma_f32_16x16x32_bf16 v[128:131], a[216:219], a[160:163], v[128:131]
 ds_read_b128 a[160:163], v2 offset:51200
 v_mfma_f32_16x16x32_bf16 v[124:127], a[216:219], a[152:155], v[124:127]
 ds_read_b128 a[152:155], v2 offset:47104
 v_add_f32 v234, v234, v14
 v_mfma_f32_16x16x32_bf16 v[124:127], a[220:223], a[156:159], v[124:127]
 ds_read_b128 a[156:159], v2 offset:48128
 v_add_f32 v235, v235, v15
 v_mfma_f32_16x16x32_bf16 v[120:123], a[220:223], a[148:151], v[120:123]
 ds_read_b128 a[148:151], v2 offset:44032
 v_mfma_f32_16x16x32_bf16 v[120:123], a[216:219], a[144:147], v[120:123]
 ds_read_b128 a[144:147], v2 offset:43008
 v_add_f32 v236, v236, v12
 v_mfma_f32_16x16x32_bf16 v[116:119], a[216:219], a[136:139], v[116:119]
 ds_read_b128 a[136:139], v2 offset:38912
 v_add_f32 v237, v237, v13
 v_mfma_f32_16x16x32_bf16 v[116:119], a[220:223], a[140:143], v[116:119]
 ds_read_b128 a[140:143], v2 offset:39936
 v_mfma_f32_16x16x32_bf16 v[112:115], a[220:223], a[132:135], v[112:115]
 ds_read_b128 a[132:135], v2 offset:35840
 v_add_f32 v238, v238, v14
 v_mfma_f32_16x16x32_bf16 v[112:115], a[216:219], a[128:131], v[112:115]
 ds_read_b128 a[128:131], v2 offset:34816
 s_waitcnt vmcnt(8) lgkmcnt(8)
 v_mfma_f32_16x16x32_bf16 v[44:47], a[224:227], a[184:187], v[44:47]
 v_add_f32 v239, v239, v15
 v_mfma_f32_16x16x32_bf16 v[44:47], a[228:231], a[188:191], v[44:47]
 global_load_dwordx4 a[220:223], v0, s[70:71] offset:-1024
 v_add_f32 v240, v240, v12
 v_mfma_f32_16x16x32_bf16 v[40:43], a[228:231], a[180:183], v[40:43]
 v_mfma_f32_16x16x32_bf16 v[40:43], a[224:227], a[176:179], v[40:43]
 global_load_dwordx4 a[216:219], v0, s[70:71] offset:-2048
 v_add_f32 v241, v241, v13
 v_mfma_f32_16x16x32_bf16 v[36:39], a[224:227], a[168:171], v[36:39]
 v_add_f32 v242, v242, v14
 v_mfma_f32_16x16x32_bf16 v[36:39], a[228:231], a[172:175], v[36:39]
 v_mfma_f32_16x16x32_bf16 v[32:35], a[228:231], a[164:167], v[32:35]
 v_add_f32 v243, v243, v15
 v_mfma_f32_16x16x32_bf16 v[32:35], a[224:227], a[160:163], v[32:35]
 v_add_f32 v244, v244, v12
 s_waitcnt lgkmcnt(0)
 v_mfma_f32_16x16x32_bf16 v[28:31], a[224:227], a[152:155], v[28:31]
 v_mfma_f32_16x16x32_bf16 v[28:31], a[228:231], a[156:159], v[28:31]
 v_add_f32 v245, v245, v13
 v_mfma_f32_16x16x32_bf16 v[24:27], a[228:231], a[148:151], v[24:27]
 v_add_f32 v246, v246, v14
 v_mfma_f32_16x16x32_bf16 v[24:27], a[224:227], a[144:147], v[24:27]
 v_mfma_f32_16x16x32_bf16 v[20:23], a[224:227], a[136:139], v[20:23]
 v_add_f32 v247, v247, v15
 v_mfma_f32_16x16x32_bf16 v[20:23], a[228:231], a[140:143], v[20:23]
 v_mfma_f32_16x16x32_bf16 v[16:19], a[228:231], a[132:135], v[16:19]
 v_add_f32 v248, v248, v12
 v_mfma_f32_16x16x32_bf16 v[16:19], a[224:227], a[128:131], v[16:19]
 v_add_f32 v249, v249, v13
 s_waitcnt vmcnt(8)
 v_mfma_f32_16x16x32_bf16 v[48:51], a[232:235], a[128:131], v[48:51]
 v_mfma_f32_16x16x32_bf16 v[48:51], a[236:239], a[132:135], v[48:51]
 global_load_dwordx4 a[228:231], v0, s[70:71] offset:1024
 v_add_f32 v250, v250, v14
 v_mfma_f32_16x16x32_bf16 v[52:55], a[236:239], a[140:143], v[52:55]
 v_add_f32 v251, v251, v15
 v_mfma_f32_16x16x32_bf16 v[52:55], a[232:235], a[136:139], v[52:55]
 global_load_dwordx4 a[224:227], v0, s[70:71] offset:0
 v_mfma_f32_16x16x32_bf16 v[56:59], a[232:235], a[144:147], v[56:59]
 v_add_f32 v252, v252, v12
 v_mfma_f32_16x16x32_bf16 v[56:59], a[236:239], a[148:151], v[56:59]
 v_add_f32 v253, v253, v13
 v_mfma_f32_16x16x32_bf16 v[60:63], a[236:239], a[156:159], v[60:63]
 v_mfma_f32_16x16x32_bf16 v[60:63], a[232:235], a[152:155], v[60:63]
 v_add_f32 v254, v254, v14
 v_mfma_f32_16x16x32_bf16 v[64:67], a[232:235], a[160:163], v[64:67]
 v_add_f32 v255, v255, v15
 v_mfma_f32_16x16x32_bf16 v[64:67], a[236:239], a[164:167], v[64:67]
 v_mfma_f32_16x16x32_bf16 v[68:71], a[236:239], a[172:175], v[68:71]
 v_accvgpr_read_b32 v5, a248
 v_mfma_f32_16x16x32_bf16 v[68:71], a[232:235], a[168:171], v[68:71]
 v_mfma_f32_16x16x32_bf16 v[72:75], a[232:235], a[176:179], v[72:75]
 v_add_f32 v5, v5, v12
 v_mfma_f32_16x16x32_bf16 v[72:75], a[236:239], a[180:183], v[72:75]
 v_accvgpr_write_b32 a248, v5
 v_mfma_f32_16x16x32_bf16 v[76:79], a[236:239], a[188:191], v[76:79]
 v_mfma_f32_16x16x32_bf16 v[76:79], a[232:235], a[184:187], v[76:79]
 v_accvgpr_read_b32 v6, a249
 s_waitcnt vmcnt(8)
 v_mfma_f32_16x16x32_bf16 v[108:111], a[192:195], a[184:187], v[108:111]
 v_add_f32 v6, v6, v13
 v_mfma_f32_16x16x32_bf16 v[108:111], a[196:199], a[188:191], v[108:111]
 global_load_dwordx4 a[236:239], v0, s[70:71] offset:3072
 v_mfma_f32_16x16x32_bf16 v[104:107], a[196:199], a[180:183], v[104:107]
 v_accvgpr_write_b32 a249, v6
 v_mfma_f32_16x16x32_bf16 v[104:107], a[192:195], a[176:179], v[104:107]
 global_load_dwordx4 a[232:235], v0, s[70:71] offset:2048
 v_accvgpr_read_b32 v5, a250
 v_mfma_f32_16x16x32_bf16 v[100:103], a[192:195], a[168:171], v[100:103]
 s_add_u32 s70, s70, 8192
 s_addc_u32 s71, s71, 0
 v_mfma_f32_16x16x32_bf16 v[100:103], a[196:199], a[172:175], v[100:103]
 v_add_f32 v5, v5, v14
 v_mfma_f32_16x16x32_bf16 v[96:99], a[196:199], a[164:167], v[96:99]
 v_accvgpr_write_b32 a250, v5
 v_mfma_f32_16x16x32_bf16 v[96:99], a[192:195], a[160:163], v[96:99]
 v_mfma_f32_16x16x32_bf16 v[92:95], a[192:195], a[152:155], v[92:95]
 v_accvgpr_read_b32 v6, a251
 v_mfma_f32_16x16x32_bf16 v[92:95], a[196:199], a[156:159], v[92:95]
 v_mfma_f32_16x16x32_bf16 v[88:91], a[196:199], a[148:151], v[88:91]
 v_add_f32 v6, v6, v15
 v_mfma_f32_16x16x32_bf16 v[88:91], a[192:195], a[144:147], v[88:91]
 v_accvgpr_write_b32 a251, v6
 v_mfma_f32_16x16x32_bf16 v[84:87], a[192:195], a[136:139], v[84:87]
 v_mfma_f32_16x16x32_bf16 v[84:87], a[196:199], a[140:143], v[84:87]
 v_accvgpr_read_b32 v5, a252
 v_mfma_f32_16x16x32_bf16 v[80:83], a[196:199], a[132:135], v[80:83]
 v_add_f32 v5, v5, v12
 v_mfma_f32_16x16x32_bf16 v[80:83], a[192:195], a[128:131], v[80:83]
 s_waitcnt vmcnt(8)
 v_mfma_f32_16x16x32_bf16 v[112:115], a[200:203], a[128:131], v[112:115]
 ds_read_b128 a[128:131], v1 offset:2048
 v_accvgpr_write_b32 a252, v5
 v_mfma_f32_16x16x32_bf16 v[112:115], a[204:207], a[132:135], v[112:115]
 global_load_dwordx4 a[196:199], v0, s[70:71] offset:-3072
 ds_read_b128 a[132:135], v1 offset:3072
 v_mfma_f32_16x16x32_bf16 v[116:119], a[204:207], a[140:143], v[116:119]
 ds_read_b128 a[140:143], v1 offset:7168
 v_accvgpr_read_b32 v6, a253
 v_mfma_f32_16x16x32_bf16 v[116:119], a[200:203], a[136:139], v[116:119]
 global_load_dwordx4 a[192:195], v0, s[70:71] offset:-4096
 ds_read_b128 a[136:139], v1 offset:6144
 v_mfma_f32_16x16x32_bf16 v[120:123], a[200:203], a[144:147], v[120:123]
 ds_read_b128 a[144:147], v1 offset:10240
 v_add_f32 v6, v6, v13
 v_mfma_f32_16x16x32_bf16 v[120:123], a[204:207], a[148:151], v[120:123]
 ds_read_b128 a[148:151], v1 offset:11264
 v_accvgpr_write_b32 a253, v6
 v_mfma_f32_16x16x32_bf16 v[124:127], a[204:207], a[156:159], v[124:127]
 ds_read_b128 a[156:159], v1 offset:15360
 v_accvgpr_read_b32 v5, a254
 v_mfma_f32_16x16x32_bf16 v[124:127], a[200:203], a[152:155], v[124:127]
 ds_read_b128 a[152:155], v1 offset:14336
 v_mfma_f32_16x16x32_bf16 v[128:131], a[200:203], a[160:163], v[128:131]
 ds_read_b128 a[160:163], v1 offset:18432
 v_add_f32 v5, v5, v14
 v_mfma_f32_16x16x32_bf16 v[128:131], a[204:207], a[164:167], v[128:131]
 ds_read_b128 a[164:167], v1 offset:19456
 v_accvgpr_write_b32 a254, v5
 v_mfma_f32_16x16x32_bf16 v[132:135], a[204:207], a[172:175], v[132:135]
 ds_read_b128 a[172:175], v1 offset:23552
 v_mfma_f32_16x16x32_bf16 v[132:135], a[200:203], a[168:171], v[132:135]
 ds_read_b128 a[168:171], v1 offset:22528
 v_accvgpr_read_b32 v6, a255
 v_mfma_f32_16x16x32_bf16 a[240:243], a[200:203], a[176:179], a[240:243]
 ds_read_b128 a[176:179], v1 offset:26624
 v_add_f32 v6, v6, v15
 v_mfma_f32_16x16x32_bf16 a[240:243], a[204:207], a[180:183], a[240:243]
 ds_read_b128 a[180:183], v1 offset:27648
 v_accvgpr_write_b32 a255, v6
 v_mfma_f32_16x16x32_bf16 a[244:247], a[204:207], a[188:191], a[244:247]
 global_load_dwordx4 a[204:207], v0, s[70:71] offset:-1024
 ds_read_b128 a[188:191], v1 offset:31744
 v_mfma_f32_16x16x32_bf16 a[244:247], a[200:203], a[184:187], a[244:247]
 global_load_dwordx4 a[200:203], v0, s[70:71] offset:-2048
 ds_read_b128 a[184:187], v1 offset:30720
 s_waitcnt vmcnt(10) lgkmcnt(8)
 s_add_u32 s51, s51, 2048
 s_add_u32 s25, s25, 1
 s_cmp_eq_u32 s25, 6
 s_cbranch_scc1 Llast
 v_mfma_f32_16x16x32_bf16 v[136:139], a[208:211], a[128:131], v[136:139]
 v_accvgpr_read_b32 v5, a0
 v_lshlrev_b32 v6, 16, v5
 v_mfma_f32_16x16x32_bf16 v[136:139], a[212:215], a[132:135], v[136:139]
 v_and_b32 v5, s26, v5
 v_mul_f32 v6, v6, v16
 v_mfma_f32_16x16x32_bf16 v[140:143], a[212:215], a[140:143], v[140:143]
 v_mul_f32 v5, v5, v17
 v_cvt_pk_bf16_f32 v8, v6, v5
 v_mfma_f32_16x16x32_bf16 v[140:143], a[208:211], a[136:139], v[140:143]
 v_accvgpr_read_b32 v5, a1
 v_mfma_f32_16x16x32_bf16 v[144:147], a[208:211], a[144:147], v[144:147]
 v_lshlrev_b32 v6, 16, v5
 v_and_b32 v5, s26, v5
 v_mfma_f32_16x16x32_bf16 v[144:147], a[212:215], a[148:151], v[144:147]
 v_mul_f32 v6, v6, v18
 v_mul_f32 v5, v5, v19
 v_mfma_f32_16x16x32_bf16 v[148:151], a[212:215], a[156:159], v[148:151]
 v_cvt_pk_bf16_f32 v9, v6, v5
 v_accvgpr_read_b32 v5, a2
 v_mfma_f32_16x16x32_bf16 v[148:151], a[208:211], a[152:155], v[148:151]
 v_lshlrev_b32 v6, 16, v5
 v_and_b32 v5, s26, v5
 s_waitcnt lgkmcnt(0)
 v_mfma_f32_16x16x32_bf16 v[152:155], a[208:211], a[160:163], v[152:155]
 v_mul_f32 v6, v6, v48
 v_mul_f32 v5, v5, v49
 v_mfma_f32_16x16x32_bf16 v[152:155], a[212:215], a[164:167], v[152:155]
 v_cvt_pk_bf16_f32 v10, v6, v5
 v_mfma_f32_16x16x32_bf16 v[156:159], a[212:215], a[172:175], v[156:159]
 v_accvgpr_read_b32 v5, a3
 v_lshlrev_b32 v6, 16, v5
 v_mfma_f32_16x16x32_bf16 v[156:159], a[208:211], a[168:171], v[156:159]
 v_and_b32 v5, s26, v5
 v_mul_f32 v6, v6, v50
 v_mfma_f32_16x16x32_bf16 v[160:163], a[208:211], a[176:179], v[160:163]
 v_mul_f32 v5, v5, v51
 v_cvt_pk_bf16_f32 v11, v6, v5
 v_mfma_f32_16x16x32_bf16 v[160:163], a[212:215], a[180:183], v[160:163]
 ds_write_b128 v3, v[8:11]
 s_add_u32 s68, s29, 0
 v_mfma_f32_16x16x32_bf16 v[164:167], a[212:215], a[188:191], v[164:167]
 buffer_store_dwordx4 v[8:11], v3, s[32:35], s68 offen sc1
 v_accvgpr_read_b32 v5, a32
 v_mfma_f32_16x16x32_bf16 v[164:167], a[208:211], a[184:187], v[164:167]
 v_lshlrev_b32 v6, 16, v5
 v_and_b32 v5, s26, v5
 s_waitcnt vmcnt(9)
 v_mfma_f32_16x16x32_bf16 v[196:199], a[216:219], a[184:187], v[196:199]
 v_mul_f32 v6, v6, v80
 v_mul_f32 v5, v5, v81
 v_mfma_f32_16x16x32_bf16 v[196:199], a[220:223], a[188:191], v[196:199]
 global_load_dwordx4 a[212:215], v0, s[70:71] offset:1024
 v_cvt_pk_bf16_f32 v12, v6, v5
 v_mfma_f32_16x16x32_bf16 v[192:195], a[220:223], a[180:183], v[192:195]
 v_accvgpr_read_b32 v5, a33
 v_lshlrev_b32 v6, 16, v5
 v_mfma_f32_16x16x32_bf16 v[192:195], a[216:219], a[176:179], v[192:195]
 global_load_dwordx4 a[208:211], v0, s[70:71] offset:0
 v_and_b32 v5, s26, v5
 v_mfma_f32_16x16x32_bf16 v[188:191], a[216:219], a[168:171], v[188:191]
 v_mul_f32 v6, v6, v82
 v_mul_f32 v5, v5, v83
 v_mfma_f32_16x16x32_bf16 v[188:191], a[220:223], a[172:175], v[188:191]
 v_cvt_pk_bf16_f32 v13, v6, v5
 v_accvgpr_read_b32 v5, a34
 v_mfma_f32_16x16x32_bf16 v[184:187], a[220:223], a[164:167], v[184:187]
 v_lshlrev_b32 v6, 16, v5
 v_and_b32 v5, s26, v5
 v_mfma_f32_16x16x32_bf16 v[184:187], a[216:219], a[160:163], v[184:187]
 v_mul_f32 v6, v6, v112
 v_mul_f32 v5, v5, v113
 v_mfma_f32_16x16x32_bf16 v[180:183], a[216:219], a[152:155], v[180:183]
 v_cvt_pk_bf16_f32 v14, v6, v5
 v_accvgpr_read_b32 v5, a35
 v_mfma_f32_16x16x32_bf16 v[180:183], a[220:223], a[156:159], v[180:183]
 v_lshlrev_b32 v6, 16, v5
 v_and_b32 v5, s26, v5
 v_mfma_f32_16x16x32_bf16 v[176:179], a[220:223], a[148:151], v[176:179]
 v_mul_f32 v6, v6, v114
 v_mul_f32 v5, v5, v115
 v_mfma_f32_16x16x32_bf16 v[176:179], a[216:219], a[144:147], v[176:179]
 v_cvt_pk_bf16_f32 v15, v6, v5
 v_mfma_f32_16x16x32_bf16 v[172:175], a[216:219], a[136:139], v[172:175]
 ds_write_b128 v3, v[12:15] offset:1024
 v_mfma_f32_16x16x32_bf16 v[172:175], a[220:223], a[140:143], v[172:175]
 buffer_store_dwordx4 v[12:15], v3, s[32:35], s68 offen offset:1024 sc1
 v_accvgpr_read_b32 v5, a4
 v_lshlrev_b32 v6, 16, v5
 v_and_b32 v5, s26, v5
 v_mul_f32 v6, v6, v20
 v_mfma_f32_16x16x32_bf16 v[168:171], a[220:223], a[132:135], v[168:171]
 v_mul_f32 v5, v5, v21
 v_cvt_pk_bf16_f32 v8, v6, v5
 v_mfma_f32_16x16x32_bf16 v[168:171], a[216:219], a[128:131], v[168:171]
 v_accvgpr_read_b32 v5, a5
 v_lshlrev_b32 v6, 16, v5
 s_waitcnt vmcnt(10)
 v_mfma_f32_16x16x32_bf16 v[200:203], a[224:227], a[128:131], v[200:203]
 v_and_b32 v5, s26, v5
 v_mul_f32 v6, v6, v22
 v_mfma_f32_16x16x32_bf16 v[200:203], a[228:231], a[132:135], v[200:203]
 global_load_dwordx4 a[220:223], v0, s[70:71] offset:3072
 v_mul_f32 v5, v5, v23
 v_mfma_f32_16x16x32_bf16 v[204:207], a[228:231], a[140:143], v[204:207]
 v_cvt_pk_bf16_f32 v9, v6, v5
 v_accvgpr_read_b32 v5, a6
 v_mfma_f32_16x16x32_bf16 v[204:207], a[224:227], a[136:139], v[204:207]
 global_load_dwordx4 a[216:219], v0, s[70:71] offset:2048
 v_lshlrev_b32 v6, 16, v5
 v_mfma_f32_16x16x32_bf16 v[208:211], a[224:227], a[144:147], v[208:211]
 v_and_b32 v5, s26, v5
 v_mul_f32 v6, v6, v52
 s_add_u32 s70, s70, 8192
 s_addc_u32 s71, s71, 0
 v_mfma_f32_16x16x32_bf16 v[208:211], a[228:231], a[148:151], v[208:211]
 v_mul_f32 v5, v5, v53
 v_cvt_pk_bf16_f32 v10, v6, v5
 v_mfma_f32_16x16x32_bf16 v[212:215], a[228:231], a[156:159], v[212:215]
 v_accvgpr_read_b32 v5, a7
 v_lshlrev_b32 v6, 16, v5
 v_mfma_f32_16x16x32_bf16 v[212:215], a[224:227], a[152:155], v[212:215]
 v_and_b32 v5, s26, v5
 v_mul_f32 v6, v6, v54
 v_mfma_f32_16x16x32_bf16 v[216:219], a[224:227], a[160:163], v[216:219]
 v_mul_f32 v5, v5, v55
 v_cvt_pk_bf16_f32 v11, v6, v5
 v_mfma_f32_16x16x32_bf16 v[216:219], a[228:231], a[164:167], v[216:219]
 ds_write_b128 v3, v[8:11] offset:4096
 v_mfma_f32_16x16x32_bf16 v[220:223], a[228:231], a[172:175], v[220:223]
 buffer_store_dwordx4 v[8:11], v3, s[32:35], s68 offen offset:2048 sc1
 v_accvgpr_read_b32 v5, a36
 v_lshlrev_b32 v6, 16, v5
 v_and_b32 v5, s26, v5
 v_mul_f32 v6, v6, v84
 v_mfma_f32_16x16x32_bf16 v[220:223], a[224:227], a[168:171], v[220:223]
 v_mul_f32 v5, v5, v85
 v_cvt_pk_bf16_f32 v12, v6, v5
 v_mfma_f32_16x16x32_bf16 v[224:227], a[224:227], a[176:179], v[224:227]
 v_accvgpr_read_b32 v5, a37
 v_lshlrev_b32 v6, 16, v5
 v_mfma_f32_16x16x32_bf16 v[224:227], a[228:231], a[180:183], v[224:227]
 v_and_b32 v5, s26, v5
 v_mul_f32 v6, v6, v86
 v_mfma_f32_16x16x32_bf16 v[228:231], a[228:231], a[188:191], v[228:231]
 v_mul_f32 v5, v5, v87
 v_cvt_pk_bf16_f32 v13, v6, v5
 v_mfma_f32_16x16x32_bf16 v[228:231], a[224:227], a[184:187], v[228:231]
 v_accvgpr_read_b32 v5, a38
 v_lshlrev_b32 v6, 16, v5
 s_waitcnt vmcnt(11)
 v_mfma_f32_16x16x32_bf16 a[252:255], a[232:235], a[184:187], a[252:255]
 ds_read_b128 a[184:187], v1 offset:63488
 v_and_b32 v5, s26, v5
 v_mfma_f32_16x16x32_bf16 a[252:255], a[236:239], a[188:191], a[252:255]
 global_load_dwordx4 a[228:231], v0, s[70:71] offset:-3072
 ds_read_b128 a[188:191], v1 offset:64512
 v_mfma_f32_16x16x32_bf16 a[248:251], a[236:239], a[180:183], a[248:251]
 ds_read_b128 a[180:183], v1 offset:60416
 v_mul_f32 v6, v6, v116
 v_mfma_f32_16x16x32_bf16 a[248:251], a[232:235], a[176:179], a[248:251]
 global_load_dwordx4 a[224:227], v0, s[70:71] offset:-4096
 ds_read_b128 a[176:179], v1 offset:59392
 v_mul_f32 v5, v5, v117
 v_mfma_f32_16x16x32_bf16 v[252:255], a[232:235], a[168:171], v[252:255]
 ds_read_b128 a[168:171], v1 offset:55296
 v_cvt_pk_bf16_f32 v14, v6, v5
 v_accvgpr_read_b32 v5, a39
 v_mfma_f32_16x16x32_bf16 v[252:255], a[236:239], a[172:175], v[252:255]
 ds_read_b128 a[172:175], v1 offset:56320
 v_lshlrev_b32 v6, 16, v5
 v_mfma_f32_16x16x32_bf16 v[248:251], a[236:239], a[164:167], v[248:251]
 ds_read_b128 a[164:167], v1 offset:52224
 v_and_b32 v5, s26, v5
 v_mul_f32 v6, v6, v118
 v_mfma_f32_16x16x32_bf16 v[248:251], a[232:235], a[160:163], v[248:251]
 ds_read_b128 a[160:163], v1 offset:51200
 v_mul_f32 v5, v5, v119
 v_cvt_pk_bf16_f32 v15, v6, v5
 v_mfma_f32_16x16x32_bf16 v[244:247], a[232:235], a[152:155], v[244:247]
 ds_read_b128 a[152:155], v1 offset:47104
 ds_write_b128 v3, v[12:15] offset:5120
 v_mfma_f32_16x16x32_bf16 v[244:247], a[236:239], a[156:159], v[244:247]
 buffer_store_dwordx4 v[12:15], v3, s[32:35], s68 offen offset:3072 sc1
 ds_read_b128 a[156:159], v1 offset:48128
 v_accvgpr_read_b32 v5, a8
 v_lshlrev_b32 v6, 16, v5
 v_and_b32 v5, s26, v5
 v_mfma_f32_16x16x32_bf16 v[240:243], a[236:239], a[148:151], v[240:243]
 ds_read_b128 a[148:151], v1 offset:44032
 v_mul_f32 v6, v6, v24
 v_mfma_f32_16x16x32_bf16 v[240:243], a[232:235], a[144:147], v[240:243]
 ds_read_b128 a[144:147], v1 offset:43008
 v_mul_f32 v5, v5, v25
 v_cvt_pk_bf16_f32 v8, v6, v5
 v_mfma_f32_16x16x32_bf16 v[236:239], a[232:235], a[136:139], v[236:239]
 ds_read_b128 a[136:139], v1 offset:38912
 v_accvgpr_read_b32 v5, a9
 v_mfma_f32_16x16x32_bf16 v[236:239], a[236:239], a[140:143], v[236:239]
 ds_read_b128 a[140:143], v1 offset:39936
 v_lshlrev_b32 v6, 16, v5
 v_mfma_f32_16x16x32_bf16 v[232:235], a[236:239], a[132:135], v[232:235]
 ds_read_b128 a[132:135], v1 offset:35840
 v_and_b32 v5, s26, v5
 v_mfma_f32_16x16x32_bf16 v[232:235], a[232:235], a[128:131], v[232:235]
 ds_read_b128 a[128:131], v1 offset:34816
 v_mul_f32 v6, v6, v26
 s_waitcnt vmcnt(12) lgkmcnt(9)
 v_mfma_f32_16x16x32_bf16 v[164:167], a[192:195], a[184:187], v[164:167]
 v_mul_f32 v5, v5, v27
 v_cvt_pk_bf16_f32 v9, v6, v5
 v_mfma_f32_16x16x32_bf16 v[164:167], a[196:199], a[188:191], v[164:167]
 global_load_dwordx4 a[236:239], v0, s[70:71] offset:-1024
 v_accvgpr_read_b32 v5, a10
 v_mfma_f32_16x16x32_bf16 v[160:163], a[196:199], a[180:183], v[160:163]
 v_lshlrev_b32 v6, 16, v5
 v_and_b32 v5, s26, v5
 v_mfma_f32_16x16x32_bf16 v[160:163], a[192:195], a[176:179], v[160:163]
 global_load_dwordx4 a[232:235], v0, s[70:71] offset:-2048
 v_mul_f32 v6, v6, v56
 v_mfma_f32_16x16x32_bf16 v[156:159], a[192:195], a[168:171], v[156:159]
 v_mul_f32 v5, v5, v57
 v_cvt_pk_bf16_f32 v10, v6, v5
 v_mfma_f32_16x16x32_bf16 v[156:159], a[196:199], a[172:175], v[156:159]
 v_accvgpr_read_b32 v5, a11
 v_lshlrev_b32 v6, 16, v5
 v_mfma_f32_16x16x32_bf16 v[152:155], a[196:199], a[164:167], v[152:155]
 v_and_b32 v5, s26, v5
 v_mul_f32 v6, v6, v58
 v_mfma_f32_16x16x32_bf16 v[152:155], a[192:195], a[160:163], v[152:155]
 v_mul_f32 v5, v5, v59
 v_cvt_pk_bf16_f32 v11, v6, v5
 s_waitcnt lgkmcnt(0)
 v_mfma_f32_16x16x32_bf16 v[148:151], a[192:195], a[152:155], v[148:151]
 ds_write_b128 v3, v[8:11] offset:8192
 s_add_u32 s68, s29, 4096
 v_mfma_f32_16x16x32_bf16 v[148:151], a[196:199], a[156:159], v[148:151]
 buffer_store_dwordx4 v[8:11], v3, s[32:35], s68 offen sc1
 v_accvgpr_read_b32 v5, a40
 v_lshlrev_b32 v6, 16, v5
 v_and_b32 v5, s26, v5
 v_mul_f32 v6, v6, v88
 v_mfma_f32_16x16x32_bf16 v[144:147], a[196:199], a[148:151], v[144:147]
 v_mul_f32 v5, v5, v89
 v_cvt_pk_bf16_f32 v12, v6, v5
 v_mfma_f32_16x16x32_bf16 v[144:147], a[192:195], a[144:147], v[144:147]
 v_accvgpr_read_b32 v5, a41
 v_lshlrev_b32 v6, 16, v5
 v_mfma_f32_16x16x32_bf16 v[140:143], a[192:195], a[136:139], v[140:143]
 v_and_b32 v5, s26, v5
 v_mul_f32 v6, v6, v90
 v_mfma_f32_16x16x32_bf16 v[140:143], a[196:199], a[140:143], v[140:143]
 v_mul_f32 v5, v5, v91
 v_cvt_pk_bf16_f32 v13, v6, v5
 v_mfma_f32_16x16x32_bf16 v[136:139], a[196:199], a[132:135], v[136:139]
 v_accvgpr_read_b32 v5, a42
 v_lshlrev_b32 v6, 16, v5
 v_mfma_f32_16x16x32_bf16 v[136:139], a[192:195], a[128:131], v[136:139]
 v_and_b32 v5, s26, v5
 v_mul_f32 v6, v6, v120
 s_waitcnt vmcnt(13)
 v_mfma_f32_16x16x32_bf16 v[168:171], a[200:203], a[128:131], v[168:171]
 v_mul_f32 v5, v5, v121
 v_cvt_pk_bf16_f32 v14, v6, v5
 v_mfma_f32_16x16x32_bf16 v[168:171], a[204:207], a[132:135], v[168:171]
 global_load_dwordx4 a[196:199], v0, s[70:71] offset:1024
 v_accvgpr_read_b32 v5, a43
 v_mfma_f32_16x16x32_bf16 v[172:175], a[204:207], a[140:143], v[172:175]
 v_lshlrev_b32 v6, 16, v5
 v_and_b32 v5, s26, v5
 v_mfma_f32_16x16x32_bf16 v[172:175], a[200:203], a[136:139], v[172:175]
 global_load_dwordx4 a[192:195], v0, s[70:71] offset:0
 v_mul_f32 v6, v6, v122
 v_mfma_f32_16x16x32_bf16 v[176:179], a[200:203], a[144:147], v[176:179]
 v_mul_f32 v5, v5, v123
 v_cvt_pk_bf16_f32 v15, v6, v5
 v_mfma_f32_16x16x32_bf16 v[176:179], a[204:207], a[148:151], v[176:179]
 ds_write_b128 v3, v[12:15] offset:9216
 v_mfma_f32_16x16x32_bf16 v[180:183], a[204:207], a[156:159], v[180:183]
 v_lshlrev_b32 v4, 2, v1
 v_and_b32 v4, 192, v4
 v_mfma_f32_16x16x32_bf16 v[180:183], a[200:203], a[152:155], v[180:183]
 buffer_load_dword v4, v4, s[44:47], 0 offen sc1
 v_mfma_f32_16x16x32_bf16 v[184:187], a[200:203], a[160:163], v[184:187]
 buffer_store_dwordx4 v[12:15], v3, s[32:35], s68 offen offset:1024 sc1
 v_accvgpr_read_b32 v5, a12
 v_lshlrev_b32 v6, 16, v5
 v_and_b32 v5, s26, v5
 v_mul_f32 v6, v6, v28
 v_mfma_f32_16x16x32_bf16 v[184:187], a[204:207], a[164:167], v[184:187]
 v_mul_f32 v5, v5, v29
 v_cvt_pk_bf16_f32 v8, v6, v5
 v_mfma_f32_16x16x32_bf16 v[188:191], a[204:207], a[172:175], v[188:191]
 v_accvgpr_read_b32 v5, a13
 v_lshlrev_b32 v6, 16, v5
 v_mfma_f32_16x16x32_bf16 v[188:191], a[200:203], a[168:171], v[188:191]
 v_and_b32 v5, s26, v5
 v_mul_f32 v6, v6, v30
 v_mfma_f32_16x16x32_bf16 v[192:195], a[200:203], a[176:179], v[192:195]
 v_mul_f32 v5, v5, v31
 v_cvt_pk_bf16_f32 v9, v6, v5
 v_mfma_f32_16x16x32_bf16 v[192:195], a[204:207], a[180:183], v[192:195]
 v_accvgpr_read_b32 v5, a14
 v_lshlrev_b32 v6, 16, v5
 v_mfma_f32_16x16x32_bf16 v[196:199], a[204:207], a[188:191], v[196:199]
 v_and_b32 v5, s26, v5
 v_mul_f32 v6, v6, v60
 v_mfma_f32_16x16x32_bf16 v[196:199], a[200:203], a[184:187], v[196:199]
 v_mul_f32 v5, v5, v61
 v_cvt_pk_bf16_f32 v10, v6, v5
 s_waitcnt vmcnt(14)
 v_mfma_f32_16x16x32_bf16 v[228:231], a[208:211], a[184:187], v[228:231]
 v_accvgpr_read_b32 v5, a15
 v_lshlrev_b32 v6, 16, v5
 v_mfma_f32_16x16x32_bf16 v[228:231], a[212:215], a[188:191], v[228:231]
 global_load_dwordx4 a[204:207], v0, s[70:71] offset:3072
 v_and_b32 v5, s26, v5
 v_mfma_f32_16x16x32_bf16 v[224:227], a[212:215], a[180:183], v[224:227]
 v_mul_f32 v6, v6, v62
 v_mul_f32 v5, v5, v63
 v_mfma_f32_16x16x32_bf16 v[224:227], a[208:211], a[176:179], v[224:227]
 global_load_dwordx4 a[200:203], v0, s[70:71] offset:2048
 v_cvt_pk_bf16_f32 v11, v6, v5
 v_mfma_f32_16x16x32_bf16 v[220:223], a[208:211], a[168:171], v[220:223]
 ds_write_b128 v3, v[8:11] offset:12288
 s_add_u32 s70, s70, 8192
 s_addc_u32 s71, s71, 0
 v_mfma_f32_16x16x32_bf16 v[220:223], a[212:215], a[172:175], v[220:223]
 buffer_store_dwordx4 v[8:11], v3, s[32:35], s68 offen offset:2048 sc1
 v_accvgpr_read_b32 v5, a44
 v_lshlrev_b32 v6, 16, v5
 v_and_b32 v5, s26, v5
 v_mfma_f32_16x16x32_bf16 v[216:219], a[212:215], a[164:167], v[216:219]
 v_mul_f32 v6, v6, v92
 v_mul_f32 v5, v5, v93
 v_mfma_f32_16x16x32_bf16 v[216:219], a[208:211], a[160:163], v[216:219]
 v_cvt_pk_bf16_f32 v12, v6, v5
 v_accvgpr_read_b32 v5, a45
 v_mfma_f32_16x16x32_bf16 v[212:215], a[208:211], a[152:155], v[212:215]
 v_lshlrev_b32 v6, 16, v5
 v_and_b32 v5, s26, v5
 v_mfma_f32_16x16x32_bf16 v[212:215], a[212:215], a[156:159], v[212:215]
 v_mul_f32 v6, v6, v94
 v_mul_f32 v5, v5, v95
 v_mfma_f32_16x16x32_bf16 v[208:211], a[212:215], a[148:151], v[208:211]
 v_cvt_pk_bf16_f32 v13, v6, v5
 v_accvgpr_read_b32 v5, a46
 v_mfma_f32_16x16x32_bf16 v[208:211], a[208:211], a[144:147], v[208:211]
 v_lshlrev_b32 v6, 16, v5
 v_and_b32 v5, s26, v5
 v_mfma_f32_16x16x32_bf16 v[204:207], a[208:211], a[136:139], v[204:207]
 v_mul_f32 v6, v6, v124
 v_mul_f32 v5, v5, v125
 v_mfma_f32_16x16x32_bf16 v[204:207], a[212:215], a[140:143], v[204:207]
 v_cvt_pk_bf16_f32 v14, v6, v5
 v_accvgpr_read_b32 v5, a47
 v_mfma_f32_16x16x32_bf16 v[200:203], a[212:215], a[132:135], v[200:203]
 v_lshlrev_b32 v6, 16, v5
 v_and_b32 v5, s26, v5
 v_mfma_f32_16x16x32_bf16 v[200:203], a[208:211], a[128:131], v[200:203]
 v_mul_f32 v6, v6, v126
 v_mul_f32 v5, v5, v127
 s_waitcnt vmcnt(14)
 v_mfma_f32_16x16x32_bf16 v[232:235], a[216:219], a[128:131], v[232:235]
 ds_read_b128 a[128:131], v2 offset:2048
 v_cvt_pk_bf16_f32 v15, v6, v5
 v_mfma_f32_16x16x32_bf16 v[232:235], a[220:223], a[132:135], v[232:235]
 global_load_dwordx4 a[212:215], v0, s[70:71] offset:-3072
 ds_read_b128 a[132:135], v2 offset:3072
 v_mfma_f32_16x16x32_bf16 v[236:239], a[220:223], a[140:143], v[236:239]
 ds_read_b128 a[140:143], v2 offset:7168
 ds_write_b128 v3, v[12:15] offset:13312
 v_mfma_f32_16x16x32_bf16 v[236:239], a[216:219], a[136:139], v[236:239]
 global_load_dwordx4 a[208:211], v0, s[70:71] offset:-4096
 ds_read_b128 a[136:139], v2 offset:6144
 v_mfma_f32_16x16x32_bf16 v[240:243], a[216:219], a[144:147], v[240:243]
 buffer_store_dwordx4 v[12:15], v3, s[32:35], s68 offen offset:3072 sc1
 ds_read_b128 a[144:147], v2 offset:10240
 v_accvgpr_read_b32 v5, a16
 v_lshlrev_b32 v6, 16, v5
 v_and_b32 v5, s26, v5
 v_mfma_f32_16x16x32_bf16 v[240:243], a[220:223], a[148:151], v[240:243]
 ds_read_b128 a[148:151], v2 offset:11264
 v_mul_f32 v6, v6, v32
 v_mfma_f32_16x16x32_bf16 v[244:247], a[220:223], a[156:159], v[244:247]
 ds_read_b128 a[156:159], v2 offset:15360
 v_mul_f32 v5, v5, v33
 v_cvt_pk_bf16_f32 v8, v6, v5
 v_mfma_f32_16x16x32_bf16 v[244:247], a[216:219], a[152:155], v[244:247]
 ds_read_b128 a[152:155], v2 offset:14336
 v_accvgpr_read_b32 v5, a17
 v_lshlrev_b32 v6, 16, v5
 v_mfma_f32_16x16x32_bf16 v[248:251], a[216:219], a[160:163], v[248:251]
 ds_read_b128 a[160:163], v2 offset:18432
 v_and_b32 v5, s26, v5
 v_mul_f32 v6, v6, v34
 v_mfma_f32_16x16x32_bf16 v[248:251], a[220:223], a[164:167], v[248:251]
 ds_read_b128 a[164:167], v2 offset:19456
 v_mul_f32 v5, v5, v35
 v_cvt_pk_bf16_f32 v9, v6, v5
 v_mfma_f32_16x16x32_bf16 v[252:255], a[220:223], a[172:175], v[252:255]
 ds_read_b128 a[172:175], v2 offset:23552
 v_accvgpr_read_b32 v5, a18
 v_mfma_f32_16x16x32_bf16 v[252:255], a[216:219], a[168:171], v[252:255]
 ds_read_b128 a[168:171], v2 offset:22528
 v_lshlrev_b32 v6, 16, v5
 v_mfma_f32_16x16x32_bf16 a[248:251], a[216:219], a[176:179], a[248:251]
 ds_read_b128 a[176:179], v2 offset:26624
 v_and_b32 v5, s26, v5
 v_mfma_f32_16x16x32_bf16 a[248:251], a[220:223], a[180:183], a[248:251]
 ds_read_b128 a[180:183], v2 offset:27648
 v_mul_f32 v6, v6, v64
 v_mfma_f32_16x16x32_bf16 a[252:255], a[220:223], a[188:191], a[252:255]
 ds_read_b128 a[188:191], v2 offset:31744
 v_mul_f32 v5, v5, v65
 v_mfma_f32_16x16x32_bf16 a[252:255], a[216:219], a[184:187], a[252:255]
 ds_read_b128 a[184:187], v2 offset:30720
 v_cvt_pk_bf16_f32 v10, v6, v5
 s_waitcnt vmcnt(14) lgkmcnt(8)
 v_mfma_f32_16x16x32_bf16 v[136:139], a[224:227], a[128:131], v[136:139]
 v_accvgpr_read_b32 v5, a19
 v_lshlrev_b32 v6, 16, v5
 v_mfma_f32_16x16x32_bf16 v[136:139], a[228:231], a[132:135], v[136:139]
 global_load_dwordx4 a[220:223], v0, s[70:71] offset:-1024
 v_and_b32 v5, s26, v5
 v_mfma_f32_16x16x32_bf16 v[140:143], a[228:231], a[140:143], v[140:143]
 v_mul_f32 v6, v6, v66
 v_mul_f32 v5, v5, v67
 v_mfma_f32_16x16x32_bf16 v[140:143], a[224:227], a[136:139], v[140:143]
 global_load_dwordx4 a[216:219], v0, s[70:71] offset:-2048
 v_cvt_pk_bf16_f32 v11, v6, v5
 v_mfma_f32_16x16x32_bf16 v[144:147], a[224:227], a[144:147], v[144:147]
 ds_write_b128 v3, v[8:11] offset:16384
 s_add_u32 s68, s29, 8192
 v_mfma_f32_16x16x32_bf16 v[144:147], a[228:231], a[148:151], v[144:147]
 buffer_store_dwordx4 v[8:11], v3, s[32:35], s68 offen sc1
 v_accvgpr_read_b32 v5, a48
 v_lshlrev_b32 v6, 16, v5
 v_and_b32 v5, s26, v5
 v_mul_f32 v6, v6, v96
 v_mfma_f32_16x16x32_bf16 v[148:151], a[228:231], a[156:159], v[148:151]
 v_mul_f32 v5, v5, v97
 v_cvt_pk_bf16_f32 v12, v6, v5
 v_mfma_f32_16x16x32_bf16 v[148:151], a[224:227], a[152:155], v[148:151]
 v_accvgpr_read_b32 v5, a49
 v_lshlrev_b32 v6, 16, v5
 s_waitcnt lgkmcnt(1)
 v_mfma_f32_16x16x32_bf16 v[152:155], a[224:227], a[160:163], v[152:155]
 v_and_b32 v5, s26, v5
 v_mul_f32 v6, v6, v98
 v_mfma_f32_16x16x32_bf16 v[152:155], a[228:231], a[164:167], v[152:155]
 v_mul_f32 v5, v5, v99
 v_cvt_pk_bf16_f32 v13, v6, v5
 v_mfma_f32_16x16x32_bf16 v[156:159], a[228:231], a[172:175], v[156:159]
 v_accvgpr_read_b32 v5, a50
 v_lshlrev_b32 v6, 16, v5
 v_mfma_f32_16x16x32_bf16 v[156:159], a[224:227], a[168:171], v[156:159]
 v_and_b32 v5, s26, v5
 v_mul_f32 v6, v6, v128
 v_mfma_f32_16x16x32_bf16 v[160:163], a[224:227], a[176:179], v[160:163]
 v_mul_f32 v5, v5, v129
 v_cvt_pk_bf16_f32 v14, v6, v5
 v_mfma_f32_16x16x32_bf16 v[160:163], a[228:231], a[180:183], v[160:163]
 v_accvgpr_read_b32 v5, a51
 v_lshlrev_b32 v6, 16, v5
 v_mfma_f32_16x16x32_bf16 v[164:167], a[228:231], a[188:191], v[164:167]
 v_and_b32 v5, s26, v5
 v_mul_f32 v6, v6, v130
 v_mfma_f32_16x16x32_bf16 v[164:167], a[224:227], a[184:187], v[164:167]
 v_mul_f32 v5, v5, v131
 v_cvt_pk_bf16_f32 v15, v6, v5
 s_waitcnt vmcnt(14)
 v_mfma_f32_16x16x32_bf16 v[196:199], a[232:235], a[184:187], v[196:199]
 ds_write_b128 v3, v[12:15] offset:17408
 v_mfma_f32_16x16x32_bf16 v[196:199], a[236:239], a[188:191], v[196:199]
 buffer_store_dwordx4 v[12:15], v3, s[32:35], s68 offen offset:1024 sc1
 global_load_dwordx4 a[228:231], v0, s[70:71] offset:1024
 v_accvgpr_read_b32 v5, a20
 v_lshlrev_b32 v6, 16, v5
 v_and_b32 v5, s26, v5
 v_mfma_f32_16x16x32_bf16 v[192:195], a[236:239], a[180:183], v[192:195]
 v_mul_f32 v6, v6, v36
 v_mul_f32 v5, v5, v37
 v_mfma_f32_16x16x32_bf16 v[192:195], a[232:235], a[176:179], v[192:195]
 global_load_dwordx4 a[224:227], v0, s[70:71] offset:0
 v_cvt_pk_bf16_f32 v8, v6, v5
 v_mfma_f32_16x16x32_bf16 v[188:191], a[232:235], a[168:171], v[188:191]
 v_accvgpr_read_b32 v5, a21
 v_lshlrev_b32 v6, 16, v5
 v_mfma_f32_16x16x32_bf16 v[188:191], a[236:239], a[172:175], v[188:191]
 v_and_b32 v5, s26, v5
 v_mul_f32 v6, v6, v38
 v_mfma_f32_16x16x32_bf16 v[184:187], a[236:239], a[164:167], v[184:187]
 v_mul_f32 v5, v5, v39
 v_cvt_pk_bf16_f32 v9, v6, v5
 v_mfma_f32_16x16x32_bf16 v[184:187], a[232:235], a[160:163], v[184:187]
 v_accvgpr_read_b32 v5, a22
 v_lshlrev_b32 v6, 16, v5
 v_mfma_f32_16x16x32_bf16 v[180:183], a[232:235], a[152:155], v[180:183]
 v_and_b32 v5, s26, v5
 v_mul_f32 v6, v6, v68
 v_mfma_f32_16x16x32_bf16 v[180:183], a[236:239], a[156:159], v[180:183]
 v_mul_f32 v5, v5, v69
 v_cvt_pk_bf16_f32 v10, v6, v5
 v_mfma_f32_16x16x32_bf16 v[176:179], a[236:239], a[148:151], v[176:179]
 v_accvgpr_read_b32 v5, a23
 v_lshlrev_b32 v6, 16, v5
 v_mfma_f32_16x16x32_bf16 v[176:179], a[232:235], a[144:147], v[176:179]
 v_and_b32 v5, s26, v5
 v_mul_f32 v6, v6, v70
 v_mfma_f32_16x16x32_bf16 v[172:175], a[232:235], a[136:139], v[172:175]
 v_mul_f32 v5, v5, v71
 v_cvt_pk_bf16_f32 v11, v6, v5
 v_mfma_f32_16x16x32_bf16 v[172:175], a[236:239], a[140:143], v[172:175]
 ds_write_b128 v3, v[8:11] offset:20480
 v_mfma_f32_16x16x32_bf16 v[168:171], a[236:239], a[132:135], v[168:171]
 buffer_store_dwordx4 v[8:11], v3, s[32:35], s68 offen offset:2048 sc1
 v_accvgpr_read_b32 v5, a52
 v_lshlrev_b32 v6, 16, v5
 v_and_b32 v5, s26, v5
 v_mfma_f32_16x16x32_bf16 v[168:171], a[232:235], a[128:131], v[168:171]
 v_mul_f32 v6, v6, v100
 v_mul_f32 v5, v5, v101
 s_waitcnt vmcnt(15)
 v_mfma_f32_16x16x32_bf16 v[200:203], a[192:195], a[128:131], v[200:203]
 v_cvt_pk_bf16_f32 v12, v6, v5
 v_accvgpr_read_b32 v5, a53
 v_mfma_f32_16x16x32_bf16 v[200:203], a[196:199], a[132:135], v[200:203]
 global_load_dwordx4 a[236:239], v0, s[70:71] offset:3072
 v_lshlrev_b32 v6, 16, v5
 v_mfma_f32_16x16x32_bf16 v[204:207], a[196:199], a[140:143], v[204:207]
 v_and_b32 v5, s26, v5
 s_waitcnt vmcnt(15)
 v_cmp_gt_u32 vcc, s27, v4
 s_cbranch_vccnz Lspin_w
Lok_w:
 s_add_u32 s27, s27, 64
 v_mfma_f32_16x16x32_bf16 v[204:207], a[192:195], a[136:139], v[204:207]
 global_load_dwordx4 a[232:235], v0, s[70:71] offset:2048
 v_mul_f32 v6, v6, v102
 v_mfma_f32_16x16x32_bf16 v[208:211], a[192:195], a[144:147], v[208:211]
 v_mul_f32 v5, v5, v103
 v_cvt_pk_bf16_f32 v13, v6, v5
 s_add_u32 s70, s70, 1843200
 s_addc_u32 s71, s71, 0
 v_mfma_f32_16x16x32_bf16 v[208:211], a[196:199], a[148:151], v[208:211]
 v_accvgpr_read_b32 v5, a54
 v_lshlrev_b32 v6, 16, v5
 v_mfma_f32_16x16x32_bf16 v[212:215], a[196:199], a[156:159], v[212:215]
 v_and_b32 v5, s26, v5
 v_mul_f32 v6, v6, v132
 v_mfma_f32_16x16x32_bf16 v[212:215], a[192:195], a[152:155], v[212:215]
 v_mul_f32 v5, v5, v133
 v_cvt_pk_bf16_f32 v14, v6, v5
 v_mfma_f32_16x16x32_bf16 v[216:219], a[192:195], a[160:163], v[216:219]
 v_accvgpr_read_b32 v5, a55
 v_lshlrev_b32 v6, 16, v5
 v_mfma_f32_16x16x32_bf16 v[216:219], a[196:199], a[164:167], v[216:219]
 v_and_b32 v5, s26, v5
 v_mul_f32 v6, v6, v134
 v_mfma_f32_16x16x32_bf16 v[220:223], a[196:199], a[172:175], v[220:223]
 v_mul_f32 v5, v5, v135
 v_cvt_pk_bf16_f32 v15, v6, v5
 v_mfma_f32_16x16x32_bf16 v[220:223], a[192:195], a[168:171], v[220:223]
 ds_write_b128 v3, v[12:15] offset:21504
 v_mfma_f32_16x16x32_bf16 v[224:227], a[192:195], a[176:179], v[224:227]
 buffer_store_dwordx4 v[12:15], v3, s[32:35], s68 offen offset:3072 sc1
 v_accvgpr_read_b32 v5, a24
 v_lshlrev_b32 v6, 16, v5
 v_and_b32 v5, s26, v5
 v_mul_f32 v6, v6, v40
 v_mfma_f32_16x16x32_bf16 v[224:227], a[196:199], a[180:183], v[224:227]
 v_mul_f32 v5, v5, v41
 v_cvt_pk_bf16_f32 v8, v6, v5
 v_mfma_f32_16x16x32_bf16 v[228:231], a[196:199], a[188:191], v[228:231]
 v_accvgpr_read_b32 v5, a25
 v_lshlrev_b32 v6, 16, v5
 v_mfma_f32_16x16x32_bf16 v[228:231], a[192:195], a[184:187], v[228:231]
 v_and_b32 v5, s26, v5
 v_mul_f32 v6, v6, v42
 s_waitcnt vmcnt(14)
 v_mfma_f32_16x16x32_bf16 a[252:255], a[200:203], a[184:187], a[252:255]
 ds_read_b128 a[184:187], v2 offset:63488
 v_mul_f32 v5, v5, v43
 v_mfma_f32_16x16x32_bf16 a[252:255], a[204:207], a[188:191], a[252:255]
 global_load_dwordx4 a[196:199], v0, s[70:71] offset:-3072
 ds_read_b128 a[188:191], v2 offset:64512
 v_mfma_f32_16x16x32_bf16 a[248:251], a[204:207], a[180:183], a[248:251]
 ds_read_b128 a[180:183], v2 offset:60416
 v_cvt_pk_bf16_f32 v9, v6, v5
 v_mfma_f32_16x16x32_bf16 a[248:251], a[200:203], a[176:179], a[248:251]
 global_load_dwordx4 a[192:195], v0, s[70:71] offset:-4096
 ds_read_b128 a[176:179], v2 offset:59392
 v_accvgpr_read_b32 v5, a26
 v_lshlrev_b32 v6, 16, v5
 v_mfma_f32_16x16x32_bf16 v[252:255], a[200:203], a[168:171], v[252:255]
 ds_read_b128 a[168:171], v2 offset:55296
 v_and_b32 v5, s26, v5
 v_mfma_f32_16x16x32_bf16 v[252:255], a[204:207], a[172:175], v[252:255]
 ds_read_b128 a[172:175], v2 offset:56320
 v_mul_f32 v6, v6, v72
 v_mfma_f32_16x16x32_bf16 v[248:251], a[204:207], a[164:167], v[248:251]
 ds_read_b128 a[164:167], v2 offset:52224
 v_mul_f32 v5, v5, v73
 v_mfma_f32_16x16x32_bf16 v[248:251], a[200:203], a[160:163], v[248:251]
 ds_read_b128 a[160:163], v2 offset:51200
 v_cvt_pk_bf16_f32 v10, v6, v5
 v_mfma_f32_16x16x32_bf16 v[244:247], a[200:203], a[152:155], v[244:247]
 ds_read_b128 a[152:155], v2 offset:47104
 v_accvgpr_read_b32 v5, a27
 v_mfma_f32_16x16x32_bf16 v[244:247], a[204:207], a[156:159], v[244:247]
 ds_read_b128 a[156:159], v2 offset:48128
 v_lshlrev_b32 v6, 16, v5
 v_mfma_f32_16x16x32_bf16 v[240:243], a[204:207], a[148:151], v[240:243]
 ds_read_b128 a[148:151], v2 offset:44032
 v_and_b32 v5, s26, v5
 v_mfma_f32_16x16x32_bf16 v[240:243], a[200:203], a[144:147], v[240:243]
 ds_read_b128 a[144:147], v2 offset:43008
 v_mul_f32 v6, v6, v74
 v_mfma_f32_16x16x32_bf16 v[236:239], a[200:203], a[136:139], v[236:239]
 ds_read_b128 a[136:139], v2 offset:38912
 v_mul_f32 v5, v5, v75
 v_mfma_f32_16x16x32_bf16 v[236:239], a[204:207], a[140:143], v[236:239]
 ds_read_b128 a[140:143], v2 offset:39936
 v_cvt_pk_bf16_f32 v11, v6, v5
 v_mfma_f32_16x16x32_bf16 v[232:235], a[204:207], a[132:135], v[232:235]
 ds_read_b128 a[132:135], v2 offset:35840
 ds_write_b128 v3, v[8:11] offset:24576
 s_add_u32 s68, s29, 12288
 buffer_store_dwordx4 v[8:11], v3, s[32:35], s68 offen sc1
 v_accvgpr_read_b32 v5, a56
 v_lshlrev_b32 v6, 16, v5
 v_and_b32 v5, s26, v5
 v_mul_f32 v6, v6, v104
 v_mfma_f32_16x16x32_bf16 v[232:235], a[200:203], a[128:131], v[232:235]
 ds_read_b128 a[128:131], v2 offset:34816
 v_mul_f32 v5, v5, v105
 v_cvt_pk_bf16_f32 v12, v6, v5
 s_waitcnt vmcnt(14) lgkmcnt(9)
 v_mfma_f32_16x16x32_bf16 v[164:167], a[208:211], a[184:187], v[164:167]
 v_accvgpr_read_b32 v5, a57
 v_lshlrev_b32 v6, 16, v5
 v_mfma_f32_16x16x32_bf16 v[164:167], a[212:215], a[188:191], v[164:167]
 global_load_dwordx4 a[204:207], v0, s[70:71] offset:-1024
 v_and_b32 v5, s26, v5
 v_mfma_f32_16x16x32_bf16 v[160:163], a[212:215], a[180:183], v[160:163]
 v_mul_f32 v6, v6, v106
 v_mul_f32 v5, v5, v107
 v_mfma_f32_16x16x32_bf16 v[160:163], a[208:211], a[176:179], v[160:163]
 global_load_dwordx4 a[200:203], v0, s[70:71] offset:-2048
 v_cvt_pk_bf16_f32 v13, v6, v5
 v_mfma_f32_16x16x32_bf16 v[156:159], a[208:211], a[168:171], v[156:159]
 v_accvgpr_read_b32 v5, a58
 v_accvgpr_read_b32 v7, a240
 v_mfma_f32_16x16x32_bf16 v[156:159], a[212:215], a[172:175], v[156:159]
 v_lshlrev_b32 v6, 16, v5
 v_and_b32 v5, s26, v5
 v_mfma_f32_16x16x32_bf16 v[152:155], a[212:215], a[164:167], v[152:155]
 v_mul_f32 v6, v6, v7
 v_accvgpr_read_b32 v7, a241
 v_mfma_f32_16x16x32_bf16 v[152:155], a[208:211], a[160:163], v[152:155]
 v_mul_f32 v5, v5, v7
 v_cvt_pk_bf16_f32 v14, v6, v5
 s_waitcnt lgkmcnt(0)
 v_mfma_f32_16x16x32_bf16 v[148:151], a[208:211], a[152:155], v[148:151]
 v_accvgpr_read_b32 v5, a59
 v_accvgpr_read_b32 v7, a242
 v_mfma_f32_16x16x32_bf16 v[148:151], a[212:215], a[156:159], v[148:151]
 v_lshlrev_b32 v6, 16, v5
 v_and_b32 v5, s26, v5
 v_mfma_f32_16x16x32_bf16 v[144:147], a[212:215], a[148:151], v[144:147]
 v_mul_f32 v6, v6, v7
 v_accvgpr_read_b32 v7, a243
 v_mfma_f32_16x16x32_bf16 v[144:147], a[208:211], a[144:147], v[144:147]
 v_mul_f32 v5, v5, v7
 v_cvt_pk_bf16_f32 v15, v6, v5
 v_mfma_f32_16x16x32_bf16 v[140:143], a[208:211], a[136:139], v[140:143]
 ds_write_b128 v3, v[12:15] offset:25600
 v_mfma_f32_16x16x32_bf16 v[140:143], a[212:215], a[140:143], v[140:143]
 buffer_store_dwordx4 v[12:15], v3, s[32:35], s68 offen offset:1024 sc1
 v_accvgpr_read_b32 v5, a28
 v_lshlrev_b32 v6, 16, v5
 v_and_b32 v5, s26, v5
 v_mul_f32 v6, v6, v44
 v_mfma_f32_16x16x32_bf16 v[136:139], a[212:215], a[132:135], v[136:139]
 v_mul_f32 v5, v5, v45
 v_cvt_pk_bf16_f32 v8, v6, v5
 v_mfma_f32_16x16x32_bf16 v[136:139], a[208:211], a[128:131], v[136:139]
 v_accvgpr_read_b32 v5, a29
 v_lshlrev_b32 v6, 16, v5
 s_waitcnt vmcnt(14)
 v_mfma_f32_16x16x32_bf16 v[168:171], a[216:219], a[128:131], v[168:171]
 v_and_b32 v5, s26, v5
 v_mul_f32 v6, v6, v46
 v_mfma_f32_16x16x32_bf16 v[168:171], a[220:223], a[132:135], v[168:171]
 global_load_dwordx4 a[212:215], v0, s[70:71] offset:1024
 v_mul_f32 v5, v5, v47
 v_mfma_f32_16x16x32_bf16 v[172:175], a[220:223], a[140:143], v[172:175]
 v_cvt_pk_bf16_f32 v9, v6, v5
 v_accvgpr_read_b32 v5, a30
 v_mfma_f32_16x16x32_bf16 v[172:175], a[216:219], a[136:139], v[172:175]
 global_load_dwordx4 a[208:211], v0, s[70:71] offset:0
 v_lshlrev_b32 v6, 16, v5
 v_mfma_f32_16x16x32_bf16 v[176:179], a[216:219], a[144:147], v[176:179]
 v_and_b32 v5, s26, v5
 v_mul_f32 v6, v6, v76
 v_mfma_f32_16x16x32_bf16 v[176:179], a[220:223], a[148:151], v[176:179]
 v_mul_f32 v5, v5, v77
 v_cvt_pk_bf16_f32 v10, v6, v5
 v_mfma_f32_16x16x32_bf16 v[180:183], a[220:223], a[156:159], v[180:183]
 v_accvgpr_read_b32 v5, a31
 v_lshlrev_b32 v6, 16, v5
 v_mfma_f32_16x16x32_bf16 v[180:183], a[216:219], a[152:155], v[180:183]
 v_and_b32 v5, s26, v5
 v_mul_f32 v6, v6, v78
 v_mfma_f32_16x16x32_bf16 v[184:187], a[216:219], a[160:163], v[184:187]
 v_mul_f32 v5, v5, v79
 v_cvt_pk_bf16_f32 v11, v6, v5
 v_mfma_f32_16x16x32_bf16 v[184:187], a[220:223], a[164:167], v[184:187]
 ds_write_b128 v3, v[8:11] offset:28672
 v_mfma_f32_16x16x32_bf16 v[188:191], a[220:223], a[172:175], v[188:191]
 buffer_store_dwordx4 v[8:11], v3, s[32:35], s68 offen offset:2048 sc1
 v_accvgpr_read_b32 v5, a60
 v_lshlrev_b32 v6, 16, v5
 v_and_b32 v5, s26, v5
 v_mul_f32 v6, v6, v108
 v_mfma_f32_16x16x32_bf16 v[188:191], a[216:219], a[168:171], v[188:191]
 v_mul_f32 v5, v5, v109
 v_cvt_pk_bf16_f32 v12, v6, v5
 v_mfma_f32_16x16x32_bf16 v[192:195], a[216:219], a[176:179], v[192:195]
 v_accvgpr_read_b32 v5, a61
 v_lshlrev_b32 v6, 16, v5
 v_mfma_f32_16x16x32_bf16 v[192:195], a[220:223], a[180:183], v[192:195]
 v_and_b32 v5, s26, v5
 v_mul_f32 v6, v6, v110
 v_mfma_f32_16x16x32_bf16 v[196:199], a[220:223], a[188:191], v[196:199]
 v_mul_f32 v5, v5, v111
 v_cvt_pk_bf16_f32 v13, v6, v5
 v_mfma_f32_16x16x32_bf16 v[196:199], a[216:219], a[184:187], v[196:199]
 v_accvgpr_read_b32 v5, a62
 v_accvgpr_read_b32 v7, a244
 s_waitcnt vmcnt(13)
 v_mfma_f32_16x16x32_bf16 v[228:231], a[224:227], a[184:187], v[228:231]
 v_lshlrev_b32 v6, 16, v5
 v_and_b32 v5, s26, v5
 v_mfma_f32_16x16x32_bf16 v[228:231], a[228:231], a[188:191], v[228:231]
 global_load_dwordx4 a[220:223], v0, s[70:71] offset:3072
 v_mul_f32 v6, v6, v7
 v_mfma_f32_16x16x32_bf16 v[224:227], a[228:231], a[180:183], v[224:227]
 v_accvgpr_read_b32 v7, a245
 v_mul_f32 v5, v5, v7
 v_mfma_f32_16x16x32_bf16 v[224:227], a[224:227], a[176:179], v[224:227]
 global_load_dwordx4 a[216:219], v0, s[70:71] offset:2048
 v_cvt_pk_bf16_f32 v14, v6, v5
 v_mfma_f32_16x16x32_bf16 v[220:223], a[224:227], a[168:171], v[220:223]
 v_accvgpr_read_b32 v5, a63
 v_accvgpr_read_b32 v7, a246
 s_add_u32 s70, s70, 8192
 s_addc_u32 s71, s71, 0
 v_mfma_f32_16x16x32_bf16 v[220:223], a[228:231], a[172:175], v[220:223]
 v_lshlrev_b32 v6, 16, v5
 v_and_b32 v5, s26, v5
 v_mfma_f32_16x16x32_bf16 v[216:219], a[228:231], a[164:167], v[216:219]
 v_mul_f32 v6, v6, v7
 v_accvgpr_read_b32 v7, a247
 v_mfma_f32_16x16x32_bf16 v[216:219], a[224:227], a[160:163], v[216:219]
 v_mul_f32 v5, v5, v7
 v_cvt_pk_bf16_f32 v15, v6, v5
 v_mfma_f32_16x16x32_bf16 v[212:215], a[224:227], a[152:155], v[212:215]
 ds_write_b128 v3, v[12:15] offset:29696
 v_mfma_f32_16x16x32_bf16 v[212:215], a[228:231], a[156:159], v[212:215]
 buffer_store_dwordx4 v[12:15], v3, s[32:35], s68 offen offset:3072 sc1
 v_mfma_f32_16x16x32_bf16 v[208:211], a[228:231], a[148:151], v[208:211]
 s_waitcnt lgkmcnt(0)
 s_barrier
 v_mfma_f32_16x16x32_bf16 v[208:211], a[224:227], a[144:147], v[208:211]
 v_mfma_f32_16x16x32_bf16 v[204:207], a[224:227], a[136:139], v[204:207]
 v_mfma_f32_16x16x32_bf16 v[204:207], a[228:231], a[140:143], v[204:207]
 v_mfma_f32_16x16x32_bf16 v[200:203], a[228:231], a[132:135], v[200:203]
 v_mfma_f32_16x16x32_bf16 v[200:203], a[224:227], a[128:131], v[200:203]
 s_waitcnt vmcnt(13)
 v_mfma_f32_16x16x32_bf16 v[232:235], a[232:235], a[128:131], v[232:235]
 ds_read_b128 a[128:131], v1
 v_mfma_f32_16x16x32_bf16 v[232:235], a[236:239], a[132:135], v[232:235]
 global_load_dwordx4 a[228:231], v0, s[70:71] offset:-3072
 ds_read_b128 a[132:135], v1 offset:1024
 v_mfma_f32_16x16x32_bf16 v[236:239], a[236:239], a[140:143], v[236:239]
 ds_read_b128 a[140:143], v1 offset:5120
 v_mfma_f32_16x16x32_bf16 v[236:239], a[232:235], a[136:139], v[236:239]
 global_load_dwordx4 a[224:227], v0, s[70:71] offset:-4096
 ds_read_b128 a[136:139], v1 offset:4096
 v_mfma_f32_16x16x32_bf16 v[240:243], a[232:235], a[144:147], v[240:243]
 ds_read_b128 a[144:147], v1 offset:8192
 v_mfma_f32_16x16x32_bf16 v[240:243], a[236:239], a[148:151], v[240:243]
 ds_read_b128 a[148:151], v1 offset:9216
 v_mfma_f32_16x16x32_bf16 v[244:247], a[236:239], a[156:159], v[244:247]
 ds_read_b128 a[156:159], v1 offset:13312
 v_mfma_f32_16x16x32_bf16 v[244:247], a[232:235], a[152:155], v[244:247]
 ds_read_b128 a[152:155], v1 offset:12288
 v_mfma_f32_16x16x32_bf16 v[248:251], a[232:235], a[160:163], v[248:251]
 ds_read_b128 a[160:163], v1 offset:16384
 v_mfma_f32_16x16x32_bf16 v[248:251], a[236:239], a[164:167], v[248:251]
 ds_read_b128 a[164:167], v1 offset:17408
 v_mfma_f32_16x16x32_bf16 v[252:255], a[236:239], a[172:175], v[252:255]
 ds_read_b128 a[172:175], v1 offset:21504
 v_mfma_f32_16x16x32_bf16 v[252:255], a[232:235], a[168:171], v[252:255]
 ds_read_b128 a[168:171], v1 offset:20480
 v_mfma_f32_16x16x32_bf16 a[248:251], a[232:235], a[176:179], a[248:251]
 ds_read_b128 a[176:179], v1 offset:24576
 v_mfma_f32_16x16x32_bf16 a[248:251], a[236:239], a[180:183], a[248:251]
 ds_read_b128 a[180:183], v1 offset:25600
 v_mfma_f32_16x16x32_bf16 a[252:255], a[236:239], a[188:191], a[252:255]
 global_load_dwordx4 a[236:239], v0, s[70:71] offset:-1024
 ds_read_b128 a[188:191], v1 offset:29696
 v_mfma_f32_16x16x32_bf16 a[252:255], a[232:235], a[184:187], a[252:255]
 global_load_dwordx4 a[232:235], v0, s[70:71] offset:-2048
 ds_read_b128 a[184:187], v1 offset:28672
 s_waitcnt vmcnt(14) lgkmcnt(8)
 v_mfma_f32_16x16x32_bf16 v[16:19], a[192:195], a[128:131], v[16:19]
 v_accvgpr_read_b32 v5, a64
 v_lshlrev_b32 v6, 16, v5
 v_mfma_f32_16x16x32_bf16 v[16:19], a[196:199], a[132:135], v[16:19]
 v_and_b32 v5, s26, v5
 v_mfma_f32_16x16x32_bf16 v[20:23], a[196:199], a[140:143], v[20:23]
 v_mul_f32 v6, v6, v136
 v_mul_f32 v5, v5, v137
 v_mfma_f32_16x16x32_bf16 v[20:23], a[192:195], a[136:139], v[20:23]
 v_cvt_pk_bf16_f32 v8, v6, v5
 v_accvgpr_read_b32 v5, a65
 v_mfma_f32_16x16x32_bf16 v[24:27], a[192:195], a[144:147], v[24:27]
 v_lshlrev_b32 v6, 16, v5
 v_mfma_f32_16x16x32_bf16 v[24:27], a[196:199], a[148:151], v[24:27]
 v_and_b32 v5, s26, v5
 v_mul_f32 v6, v6, v138
 v_mfma_f32_16x16x32_bf16 v[28:31], a[196:199], a[156:159], v[28:31]
 v_mul_f32 v5, v5, v139
 v_cvt_pk_bf16_f32 v9, v6, v5
 v_mfma_f32_16x16x32_bf16 v[28:31], a[192:195], a[152:155], v[28:31]
 v_accvgpr_read_b32 v5, a66
 v_lshlrev_b32 v6, 16, v5
 s_waitcnt lgkmcnt(0)
 v_mfma_f32_16x16x32_bf16 v[32:35], a[192:195], a[160:163], v[32:35]
 v_and_b32 v5, s26, v5
 v_mul_f32 v6, v6, v168
 v_mfma_f32_16x16x32_bf16 v[32:35], a[196:199], a[164:167], v[32:35]
 v_mul_f32 v5, v5, v169
 v_cvt_pk_bf16_f32 v10, v6, v5
 v_mfma_f32_16x16x32_bf16 v[36:39], a[196:199], a[172:175], v[36:39]
 v_accvgpr_read_b32 v5, a67
 v_lshlrev_b32 v6, 16, v5
 v_mfma_f32_16x16x32_bf16 v[36:39], a[192:195], a[168:171], v[36:39]
 v_and_b32 v5, s26, v5
 v_mul_f32 v6, v6, v170
 v_mfma_f32_16x16x32_bf16 v[40:43], a[192:195], a[176:179], v[40:43]
 v_mul_f32 v5, v5, v171
 v_cvt_pk_bf16_f32 v11, v6, v5
 v_mfma_f32_16x16x32_bf16 v[40:43], a[196:199], a[180:183], v[40:43]
 ds_write_b128 v3, v[8:11] offset:2048
 v_mfma_f32_16x16x32_bf16 v[44:47], a[196:199], a[188:191], v[44:47]
 s_add_u32 s68, s29, 16384
 buffer_store_dwordx4 v[8:11], v3, s[32:35], s68 offen sc1
 v_mfma_f32_16x16x32_bf16 v[44:47], a[192:195], a[184:187], v[44:47]
 v_accvgpr_read_b32 v5, a96
 s_waitcnt vmcnt(12)
 v_mfma_f32_16x16x32_bf16 v[76:79], a[200:203], a[184:187], v[76:79]
 v_lshlrev_b32 v6, 16, v5
 v_mfma_f32_16x16x32_bf16 v[76:79], a[204:207], a[188:191], v[76:79]
 global_load_dwordx4 a[196:199], v0, s[70:71] offset:1024
 v_and_b32 v5, s26, v5
 v_mfma_f32_16x16x32_bf16 v[72:75], a[204:207], a[180:183], v[72:75]
 v_mul_f32 v6, v6, v200
 v_mul_f32 v5, v5, v201
 v_mfma_f32_16x16x32_bf16 v[72:75], a[200:203], a[176:179], v[72:75]
 global_load_dwordx4 a[192:195], v0, s[70:71] offset:0
 v_cvt_pk_bf16_f32 v12, v6, v5
 v_mfma_f32_16x16x32_bf16 v[68:71], a[200:203], a[168:171], v[68:71]
 v_accvgpr_read_b32 v5, a97
 v_lshlrev_b32 v6, 16, v5
 v_mfma_f32_16x16x32_bf16 v[68:71], a[204:207], a[172:175], v[68:71]
 v_and_b32 v5, s26, v5
 v_mul_f32 v6, v6, v202
 v_mfma_f32_16x16x32_bf16 v[64:67], a[204:207], a[164:167], v[64:67]
 v_mul_f32 v5, v5, v203
 v_cvt_pk_bf16_f32 v13, v6, v5
 v_mfma_f32_16x16x32_bf16 v[64:67], a[200:203], a[160:163], v[64:67]
 v_accvgpr_read_b32 v5, a98
 v_lshlrev_b32 v6, 16, v5
 v_mfma_f32_16x16x32_bf16 v[60:63], a[200:203], a[152:155], v[60:63]
 v_and_b32 v5, s26, v5
 v_mul_f32 v6, v6, v232
 v_mfma_f32_16x16x32_bf16 v[60:63], a[204:207], a[156:159], v[60:63]
 v_mul_f32 v5, v5, v233
 v_cvt_pk_bf16_f32 v14, v6, v5
 v_mfma_f32_16x16x32_bf16 v[56:59], a[204:207], a[148:151], v[56:59]
 v_accvgpr_read_b32 v5, a99
 v_lshlrev_b32 v6, 16, v5
 v_mfma_f32_16x16x32_bf16 v[56:59], a[200:203], a[144:147], v[56:59]
 v_and_b32 v5, s26, v5
 v_mul_f32 v6, v6, v234
 v_mfma_f32_16x16x32_bf16 v[52:55], a[200:203], a[136:139], v[52:55]
 v_mul_f32 v5, v5, v235
 v_cvt_pk_bf16_f32 v15, v6, v5
 v_mfma_f32_16x16x32_bf16 v[52:55], a[204:207], a[140:143], v[52:55]
 ds_write_b128 v3, v[12:15] offset:3072
 v_mfma_f32_16x16x32_bf16 v[48:51], a[204:207], a[132:135], v[48:51]
 buffer_store_dwordx4 v[12:15], v3, s[32:35], s68 offen offset:1024 sc1
 v_mfma_f32_16x16x32_bf16 v[48:51], a[200:203], a[128:131], v[48:51]
 v_accvgpr_read_b32 v5, a68
 v_lshlrev_b32 v6, 16, v5
 s_waitcnt vmcnt(12)
 v_mfma_f32_16x16x32_bf16 v[80:83], a[208:211], a[128:131], v[80:83]
 v_and_b32 v5, s26, v5
 v_mul_f32 v6, v6, v140
 v_mfma_f32_16x16x32_bf16 v[80:83], a[212:215], a[132:135], v[80:83]
 global_load_dwordx4 a[204:207], v0, s[70:71] offset:3072
 v_mul_f32 v5, v5, v141
 v_mfma_f32_16x16x32_bf16 v[84:87], a[212:215], a[140:143], v[84:87]
 v_cvt_pk_bf16_f32 v8, v6, v5
 v_accvgpr_read_b32 v5, a69
 v_mfma_f32_16x16x32_bf16 v[84:87], a[208:211], a[136:139], v[84:87]
 global_load_dwordx4 a[200:203], v0, s[70:71] offset:2048
 v_lshlrev_b32 v6, 16, v5
 v_mfma_f32_16x16x32_bf16 v[88:91], a[208:211], a[144:147], v[88:91]
 v_and_b32 v5, s26, v5
 v_mul_f32 v6, v6, v142
 s_add_u32 s70, s70, 8192
 s_addc_u32 s71, s71, 0
 v_mfma_f32_16x16x32_bf16 v[88:91], a[212:215], a[148:151], v[88:91]
 v_mul_f32 v5, v5, v143
 v_cvt_pk_bf16_f32 v9, v6, v5
 v_mfma_f32_16x16x32_bf16 v[92:95], a[212:215], a[156:159], v[92:95]
 v_accvgpr_read_b32 v5, a70
 v_lshlrev_b32 v6, 16, v5
 v_mfma_f32_16x16x32_bf16 v[92:95], a[208:211], a[152:155], v[92:95]
 v_and_b32 v5, s26, v5
 v_mul_f32 v6, v6, v172
 v_mfma_f32_16x16x32_bf16 v[96:99], a[208:211], a[160:163], v[96:99]
 v_mul_f32 v5, v5, v173
 v_cvt_pk_bf16_f32 v10, v6, v5
 v_mfma_f32_16x16x32_bf16 v[96:99], a[212:215], a[164:167], v[96:99]
 v_accvgpr_read_b32 v5, a71
 v_lshlrev_b32 v6, 16, v5
 v_mfma_f32_16x16x32_bf16 v[100:103], a[212:215], a[172:175], v[100:103]
 v_and_b32 v5, s26, v5
 v_mul_f32 v6, v6, v174
 v_mfma_f32_16x16x32_bf16 v[100:103], a[208:211], a[168:171], v[100:103]
 v_mul_f32 v5, v5, v175
 v_cvt_pk_bf16_f32 v11, v6, v5
 v_mfma_f32_16x16x32_bf16 v[104:107], a[208:211], a[176:179], v[104:107]
 ds_write_b128 v3, v[8:11] offset:6144
 v_mfma_f32_16x16x32_bf16 v[104:107], a[212:215], a[180:183], v[104:107]
 buffer_store_dwordx4 v[8:11], v3, s[32:35], s68 offen offset:2048 sc1
 v_accvgpr_read_b32 v5, a100
 v_lshlrev_b32 v6, 16, v5
 v_and_b32 v5, s26, v5
 v_mul_f32 v6, v6, v204
 v_mfma_f32_16x16x32_bf16 v[108:111], a[212:215], a[188:191], v[108:111]
 v_mul_f32 v5, v5, v205
 v_cvt_pk_bf16_f32 v12, v6, v5
 v_mfma_f32_16x16x32_bf16 v[108:111], a[208:211], a[184:187], v[108:111]
 v_accvgpr_read_b32 v5, a101
 v_lshlrev_b32 v6, 16, v5
 s_waitcnt vmcnt(12)
 v_mfma_f32_16x16x32_bf16 a[244:247], a[216:219], a[184:187], a[244:247]
 ds_read_b128 a[184:187], v1 offset:61440
 v_and_b32 v5, s26, v5
 v_mfma_f32_16x16x32_bf16 a[244:247], a[220:223], a[188:191], a[244:247]
 global_load_dwordx4 a[212:215], v0, s[70:71] offset:-3072
 ds_read_b128 a[188:191], v1 offset:62464
 v_mfma_f32_16x16x32_bf16 a[240:243], a[220:223], a[180:183], a[240:243]
 ds_read_b128 a[180:183], v1 offset:58368
 v_mul_f32 v6, v6, v206
 v_mfma_f32_16x16x32_bf16 a[240:243], a[216:219], a[176:179], a[240:243]
 global_load_dwordx4 a[208:211], v0, s[70:71] offset:-4096
 ds_read_b128 a[176:179], v1 offset:57344
 v_mfma_f32_16x16x32_bf16 v[132:135], a[216:219], a[168:171], v[132:135]
 ds_read_b128 a[168:171], v1 offset:53248
 v_mul_f32 v5, v5, v207
 v_mfma_f32_16x16x32_bf16 v[132:135], a[220:223], a[172:175], v[132:135]
 ds_read_b128 a[172:175], v1 offset:54272
 v_cvt_pk_bf16_f32 v13, v6, v5
 v_mfma_f32_16x16x32_bf16 v[128:131], a[220:223], a[164:167], v[128:131]
 ds_read_b128 a[164:167], v1 offset:50176
 v_accvgpr_read_b32 v5, a102
 v_lshlrev_b32 v6, 16, v5
 v_mfma_f32_16x16x32_bf16 v[128:131], a[216:219], a[160:163], v[128:131]
 ds_read_b128 a[160:163], v1 offset:49152
 v_and_b32 v5, s26, v5
 v_mul_f32 v6, v6, v236
 v_mfma_f32_16x16x32_bf16 v[124:127], a[216:219], a[152:155], v[124:127]
 ds_read_b128 a[152:155], v1 offset:45056
 v_mul_f32 v5, v5, v237
 v_mfma_f32_16x16x32_bf16 v[124:127], a[220:223], a[156:159], v[124:127]
 ds_read_b128 a[156:159], v1 offset:46080
 v_cvt_pk_bf16_f32 v14, v6, v5
 v_mfma_f32_16x16x32_bf16 v[120:123], a[220:223], a[148:151], v[120:123]
 ds_read_b128 a[148:151], v1 offset:41984
 v_accvgpr_read_b32 v5, a103
 v_mfma_f32_16x16x32_bf16 v[120:123], a[216:219], a[144:147], v[120:123]
 ds_read_b128 a[144:147], v1 offset:40960
 v_lshlrev_b32 v6, 16, v5
 v_mfma_f32_16x16x32_bf16 v[116:119], a[216:219], a[136:139], v[116:119]
 ds_read_b128 a[136:139], v1 offset:36864
 v_and_b32 v5, s26, v5
 v_mfma_f32_16x16x32_bf16 v[116:119], a[220:223], a[140:143], v[116:119]
 ds_read_b128 a[140:143], v1 offset:37888
 v_mul_f32 v6, v6, v238
 v_mfma_f32_16x16x32_bf16 v[112:115], a[220:223], a[132:135], v[112:115]
 ds_read_b128 a[132:135], v1 offset:33792
 v_mul_f32 v5, v5, v239
 v_mfma_f32_16x16x32_bf16 v[112:115], a[216:219], a[128:131], v[112:115]
 ds_read_b128 a[128:131], v1 offset:32768
 v_cvt_pk_bf16_f32 v15, v6, v5
 s_waitcnt vmcnt(11) lgkmcnt(8)
 v_mfma_f32_16x16x32_bf16 v[44:47], a[224:227], a[184:187], v[44:47]
 ds_write_b128 v3, v[12:15] offset:7168
 v_mfma_f32_16x16x32_bf16 v[44:47], a[228:231], a[188:191], v[44:47]
 buffer_store_dwordx4 v[12:15], v3, s[32:35], s68 offen offset:3072 sc1
 global_load_dwordx4 a[220:223], v0, s[70:71] offset:-1024
 v_accvgpr_read_b32 v5, a72
 v_lshlrev_b32 v6, 16, v5
 v_and_b32 v5, s26, v5
 v_mfma_f32_16x16x32_bf16 v[40:43], a[228:231], a[180:183], v[40:43]
 v_mul_f32 v6, v6, v144
 v_mul_f32 v5, v5, v145
 v_mfma_f32_16x16x32_bf16 v[40:43], a[224:227], a[176:179], v[40:43]
 global_load_dwordx4 a[216:219], v0, s[70:71] offset:-2048
 v_cvt_pk_bf16_f32 v8, v6, v5
 v_mfma_f32_16x16x32_bf16 v[36:39], a[224:227], a[168:171], v[36:39]
 v_accvgpr_read_b32 v5, a73
 v_lshlrev_b32 v6, 16, v5
 v_mfma_f32_16x16x32_bf16 v[36:39], a[228:231], a[172:175], v[36:39]
 v_and_b32 v5, s26, v5
 v_mul_f32 v6, v6, v146
 v_mfma_f32_16x16x32_bf16 v[32:35], a[228:231], a[164:167], v[32:35]
 v_mul_f32 v5, v5, v147
 v_cvt_pk_bf16_f32 v9, v6, v5
 v_mfma_f32_16x16x32_bf16 v[32:35], a[224:227], a[160:163], v[32:35]
 v_accvgpr_read_b32 v5, a74
 v_lshlrev_b32 v6, 16, v5
 s_waitcnt lgkmcnt(1)
 v_mfma_f32_16x16x32_bf16 v[28:31], a[224:227], a[152:155], v[28:31]
 v_and_b32 v5, s26, v5
 v_mul_f32 v6, v6, v176
 v_mfma_f32_16x16x32_bf16 v[28:31], a[228:231], a[156:159], v[28:31]
 v_mul_f32 v5, v5, v177
 v_cvt_pk_bf16_f32 v10, v6, v5
 v_mfma_f32_16x16x32_bf16 v[24:27], a[228:231], a[148:151], v[24:27]
 v_accvgpr_read_b32 v5, a75
 v_lshlrev_b32 v6, 16, v5
 v_mfma_f32_16x16x32_bf16 v[24:27], a[224:227], a[144:147], v[24:27]
 v_and_b32 v5, s26, v5
 v_mul_f32 v6, v6, v178
 v_mfma_f32_16x16x32_bf16 v[20:23], a[224:227], a[136:139], v[20:23]
 v_mul_f32 v5, v5, v179
 v_cvt_pk_bf16_f32 v11, v6, v5
 v_mfma_f32_16x16x32_bf16 v[20:23], a[228:231], a[140:143], v[20:23]
 ds_write_b128 v3, v[8:11] offset:10240
 s_add_u32 s68, s29, 20480
 v_mfma_f32_16x16x32_bf16 v[16:19], a[228:231], a[132:135], v[16:19]
 buffer_store_dwordx4 v[8:11], v3, s[32:35], s68 offen sc1
 v_accvgpr_read_b32 v5, a104
 v_lshlrev_b32 v6, 16, v5
 v_mfma_f32_16x16x32_bf16 v[16:19], a[224:227], a[128:131], v[16:19]
 v_and_b32 v5, s26, v5
 v_mul_f32 v6, v6, v208
 s_waitcnt vmcnt(13)
 v_mfma_f32_16x16x32_bf16 v[48:51], a[232:235], a[128:131], v[48:51]
 v_mul_f32 v5, v5, v209
 v_cvt_pk_bf16_f32 v12, v6, v5
 v_mfma_f32_16x16x32_bf16 v[48:51], a[236:239], a[132:135], v[48:51]
 global_load_dwordx4 a[228:231], v0, s[70:71] offset:1024
 v_accvgpr_read_b32 v5, a105
 v_mfma_f32_16x16x32_bf16 v[52:55], a[236:239], a[140:143], v[52:55]
 v_lshlrev_b32 v6, 16, v5
 v_and_b32 v5, s26, v5
 v_mfma_f32_16x16x32_bf16 v[52:55], a[232:235], a[136:139], v[52:55]
 global_load_dwordx4 a[224:227], v0, s[70:71] offset:0
 v_mul_f32 v6, v6, v210
 v_mfma_f32_16x16x32_bf16 v[56:59], a[232:235], a[144:147], v[56:59]
 v_mul_f32 v5, v5, v211
 v_cvt_pk_bf16_f32 v13, v6, v5
 v_mfma_f32_16x16x32_bf16 v[56:59], a[236:239], a[148:151], v[56:59]
 v_accvgpr_read_b32 v5, a106
 v_lshlrev_b32 v6, 16, v5
 v_mfma_f32_16x16x32_bf16 v[60:63], a[236:239], a[156:159], v[60:63]
 v_and_b32 v5, s26, v5
 v_mfma_f32_16x16x32_bf16 v[60:63], a[232:235], a[152:155], v[60:63]
 v_mul_f32 v6, v6, v240
 v_mul_f32 v5, v5, v241
 v_mfma_f32_16x16x32_bf16 v[64:67], a[232:235], a[160:163], v[64:67]
 v_cvt_pk_bf16_f32 v14, v6, v5
 v_accvgpr_read_b32 v5, a107
 v_mfma_f32_16x16x32_bf16 v[64:67], a[236:239], a[164:167], v[64:67]
 v_lshlrev_b32 v6, 16, v5
 v_mfma_f32_16x16x32_bf16 v[68:71], a[236:239], a[172:175], v[68:71]
 v_and_b32 v5, s26, v5
 v_mul_f32 v6, v6, v242
 v_mfma_f32_16x16x32_bf16 v[68:71], a[232:235], a[168:171], v[68:71]
 v_mul_f32 v5, v5, v243
 v_cvt_pk_bf16_f32 v15, v6, v5
 v_mfma_f32_16x16x32_bf16 v[72:75], a[232:235], a[176:179], v[72:75]
 ds_write_b128 v3, v[12:15] offset:11264
 v_mfma_f32_16x16x32_bf16 v[72:75], a[236:239], a[180:183], v[72:75]
 buffer_store_dwordx4 v[12:15], v3, s[32:35], s68 offen offset:1024 sc1
 v_accvgpr_read_b32 v5, a76
 v_lshlrev_b32 v6, 16, v5
 v_mfma_f32_16x16x32_bf16 v[76:79], a[236:239], a[188:191], v[76:79]
 v_and_b32 v5, s26, v5
 v_mul_f32 v6, v6, v148
 v_mfma_f32_16x16x32_bf16 v[76:79], a[232:235], a[184:187], v[76:79]
 v_mul_f32 v5, v5, v149
 v_cvt_pk_bf16_f32 v8, v6, v5
 s_waitcnt vmcnt(13)
 v_mfma_f32_16x16x32_bf16 v[108:111], a[192:195], a[184:187], v[108:111]
 v_accvgpr_read_b32 v5, a77
 v_lshlrev_b32 v6, 16, v5
 v_mfma_f32_16x16x32_bf16 v[108:111], a[196:199], a[188:191], v[108:111]
 global_load_dwordx4 a[236:239], v0, s[70:71] offset:3072
 v_and_b32 v5, s26, v5
 v_mfma_f32_16x16x32_bf16 v[104:107], a[196:199], a[180:183], v[104:107]
 v_mul_f32 v6, v6, v150
 v_mul_f32 v5, v5, v151
 v_mfma_f32_16x16x32_bf16 v[104:107], a[192:195], a[176:179], v[104:107]
 global_load_dwordx4 a[232:235], v0, s[70:71] offset:2048
 v_cvt_pk_bf16_f32 v9, v6, v5
 v_mfma_f32_16x16x32_bf16 v[100:103], a[192:195], a[168:171], v[100:103]
 v_accvgpr_read_b32 v5, a78
 v_lshlrev_b32 v6, 16, v5
 s_add_u32 s70, s70, 8192
 s_addc_u32 s71, s71, 0
 v_mfma_f32_16x16x32_bf16 v[100:103], a[196:199], a[172:175], v[100:103]
 v_and_b32 v5, s26, v5
 v_mul_f32 v6, v6, v180
 v_mfma_f32_16x16x32_bf16 v[96:99], a[196:199], a[164:167], v[96:99]
 v_mul_f32 v5, v5, v181
 v_cvt_pk_bf16_f32 v10, v6, v5
 v_mfma_f32_16x16x32_bf16 v[96:99], a[192:195], a[160:163], v[96:99]
 v_accvgpr_read_b32 v5, a79
 v_lshlrev_b32 v6, 16, v5
 v_mfma_f32_16x16x32_bf16 v[92:95], a[192:195], a[152:155], v[92:95]
 v_and_b32 v5, s26, v5
 v_mul_f32 v6, v6, v182
 v_mfma_f32_16x16x32_bf16 v[92:95], a[196:199], a[156:159], v[92:95]
 v_mul_f32 v5, v5, v183
 v_cvt_pk_bf16_f32 v11, v6, v5
 v_mfma_f32_16x16x32_bf16 v[88:91], a[196:199], a[148:151], v[88:91]
 ds_write_b128 v3, v[8:11] offset:14336
 v_mfma_f32_16x16x32_bf16 v[88:91], a[192:195], a[144:147], v[88:91]
 buffer_store_dwordx4 v[8:11], v3, s[32:35], s68 offen offset:2048 sc1
 v_accvgpr_read_b32 v5, a108
 v_lshlrev_b32 v6, 16, v5
 v_and_b32 v5, s26, v5
 v_mul_f32 v6, v6, v212
 v_mfma_f32_16x16x32_bf16 v[84:87], a[192:195], a[136:139], v[84:87]
 v_mul_f32 v5, v5, v213
 v_cvt_pk_bf16_f32 v12, v6, v5
 v_mfma_f32_16x16x32_bf16 v[84:87], a[196:199], a[140:143], v[84:87]
 v_accvgpr_read_b32 v5, a109
 v_lshlrev_b32 v6, 16, v5
 v_mfma_f32_16x16x32_bf16 v[80:83], a[196:199], a[132:135], v[80:83]
 v_and_b32 v5, s26, v5
 v_mul_f32 v6, v6, v214
 v_mfma_f32_16x16x32_bf16 v[80:83], a[192:195], a[128:131], v[80:83]
 v_mul_f32 v5, v5, v215
 v_cvt_pk_bf16_f32 v13, v6, v5
 s_waitcnt vmcnt(13)
 v_mfma_f32_16x16x32_bf16 v[112:115], a[200:203], a[128:131], v[112:115]
 ds_read_b128 a[128:131], v2
 v_accvgpr_read_b32 v5, a110
 v_mfma_f32_16x16x32_bf16 v[112:115], a[204:207], a[132:135], v[112:115]
 global_load_dwordx4 a[196:199], v0, s[70:71] offset:-3072
 ds_read_b128 a[132:135], v2 offset:1024
 v_mfma_f32_16x16x32_bf16 v[116:119], a[204:207], a[140:143], v[116:119]
 ds_read_b128 a[140:143], v2 offset:5120
 v_lshlrev_b32 v6, 16, v5
 v_mfma_f32_16x16x32_bf16 v[116:119], a[200:203], a[136:139], v[116:119]
 global_load_dwordx4 a[192:195], v0, s[70:71] offset:-4096
 ds_read_b128 a[136:139], v2 offset:4096
 v_mfma_f32_16x16x32_bf16 v[120:123], a[200:203], a[144:147], v[120:123]
 ds_read_b128 a[144:147], v2 offset:8192
 v_and_b32 v5, s26, v5
 v_mfma_f32_16x16x32_bf16 v[120:123], a[204:207], a[148:151], v[120:123]
 ds_read_b128 a[148:151], v2 offset:9216
 v_mul_f32 v6, v6, v244
 v_mfma_f32_16x16x32_bf16 v[124:127], a[204:207], a[156:159], v[124:127]
 ds_read_b128 a[156:159], v2 offset:13312
 v_mul_f32 v5, v5, v245
 v_cvt_pk_bf16_f32 v14, v6, v5
 v_mfma_f32_16x16x32_bf16 v[124:127], a[200:203], a[152:155], v[124:127]
 ds_read_b128 a[152:155], v2 offset:12288
 v_accvgpr_read_b32 v5, a111
 v_mfma_f32_16x16x32_bf16 v[128:131], a[200:203], a[160:163], v[128:131]
 ds_read_b128 a[160:163], v2 offset:16384
 v_lshlrev_b32 v6, 16, v5
 v_mfma_f32_16x16x32_bf16 v[128:131], a[204:207], a[164:167], v[128:131]
 ds_read_b128 a[164:167], v2 offset:17408
 v_and_b32 v5, s26, v5
 v_mfma_f32_16x16x32_bf16 v[132:135], a[204:207], a[172:175], v[132:135]
 ds_read_b128 a[172:175], v2 offset:21504
 v_mul_f32 v6, v6, v246
 v_mfma_f32_16x16x32_bf16 v[132:135], a[200:203], a[168:171], v[132:135]
 ds_read_b128 a[168:171], v2 offset:20480
 v_mul_f32 v5, v5, v247
 v_mfma_f32_16x16x32_bf16 a[240:243], a[200:203], a[176:179], a[240:243]
 ds_read_b128 a[176:179], v2 offset:24576
 v_cvt_pk_bf16_f32 v15, v6, v5
 v_mfma_f32_16x16x32_bf16 a[240:243], a[204:207], a[180:183], a[240:243]
 ds_read_b128 a[180:183], v2 offset:25600
 ds_write_b128 v3, v[12:15] offset:15360
 s_add_u32 s31, s31, 1
 v_mov_b32 v7, s31
 v_mfma_f32_16x16x32_bf16 a[244:247], a[204:207], a[188:191], a[244:247]
 buffer_store_dword v7, v1, s[60:63], 0 offen sc1
 ds_read_b128 a[188:191], v2 offset:29696
 v_mfma_f32_16x16x32_bf16 a[244:247], a[200:203], a[184:187], a[244:247]
 buffer_store_dwordx4 v[12:15], v3, s[32:35], s68 offen offset:3072 sc1
 ds_read_b128 a[184:187], v2 offset:28672
 v_accvgpr_read_b32 v5, a80
 v_lshlrev_b32 v6, 16, v5
 v_and_b32 v5, s26, v5
 s_waitcnt vmcnt(14) lgkmcnt(9)
 v_mfma_f32_16x16x32_bf16 v[16:19], a[208:211], a[128:131], v[16:19]
 v_mul_f32 v6, v6, v152
 v_mul_f32 v5, v5, v153
 v_mfma_f32_16x16x32_bf16 v[16:19], a[212:215], a[132:135], v[16:19]
 global_load_dwordx4 a[204:207], v0, s[70:71] offset:-1024
 v_cvt_pk_bf16_f32 v8, v6, v5
 v_mfma_f32_16x16x32_bf16 v[20:23], a[212:215], a[140:143], v[20:23]
 v_accvgpr_read_b32 v5, a81
 v_lshlrev_b32 v6, 16, v5
 v_mfma_f32_16x16x32_bf16 v[20:23], a[208:211], a[136:139], v[20:23]
 global_load_dwordx4 a[200:203], v0, s[70:71] offset:-2048
 v_and_b32 v5, s26, v5
 v_mfma_f32_16x16x32_bf16 v[24:27], a[208:211], a[144:147], v[24:27]
 v_mul_f32 v6, v6, v154
 v_mul_f32 v5, v5, v155
 v_mfma_f32_16x16x32_bf16 v[24:27], a[212:215], a[148:151], v[24:27]
 v_cvt_pk_bf16_f32 v9, v6, v5
 v_accvgpr_read_b32 v5, a82
 v_mfma_f32_16x16x32_bf16 v[28:31], a[212:215], a[156:159], v[28:31]
 v_lshlrev_b32 v6, 16, v5
 v_and_b32 v5, s26, v5
 v_mfma_f32_16x16x32_bf16 v[28:31], a[208:211], a[152:155], v[28:31]
 v_mul_f32 v6, v6, v184
 s_waitcnt lgkmcnt(0)
 v_mfma_f32_16x16x32_bf16 v[32:35], a[208:211], a[160:163], v[32:35]
 v_mul_f32 v5, v5, v185
 v_cvt_pk_bf16_f32 v10, v6, v5
 v_mfma_f32_16x16x32_bf16 v[32:35], a[212:215], a[164:167], v[32:35]
 v_accvgpr_read_b32 v5, a83
 v_lshlrev_b32 v6, 16, v5
 v_mfma_f32_16x16x32_bf16 v[36:39], a[212:215], a[172:175], v[36:39]
 v_and_b32 v5, s26, v5
 v_mul_f32 v6, v6, v186
 v_mfma_f32_16x16x32_bf16 v[36:39], a[208:211], a[168:171], v[36:39]
 v_mul_f32 v5, v5, v187
 v_cvt_pk_bf16_f32 v11, v6, v5
 v_mfma_f32_16x16x32_bf16 v[40:43], a[208:211], a[176:179], v[40:43]
 ds_write_b128 v3, v[8:11] offset:18432
 v_mfma_f32_16x16x32_bf16 v[40:43], a[212:215], a[180:183], v[40:43]
 s_add_u32 s68, s29, 24576
 buffer_store_dwordx4 v[8:11], v3, s[32:35], s68 offen sc1
 v_mfma_f32_16x16x32_bf16 v[44:47], a[212:215], a[188:191], v[44:47]
 v_accvgpr_read_b32 v5, a112
 v_mfma_f32_16x16x32_bf16 v[44:47], a[208:211], a[184:187], v[44:47]
 v_lshlrev_b32 v6, 16, v5
 v_and_b32 v5, s26, v5
 s_waitcnt vmcnt(14)
 v_mfma_f32_16x16x32_bf16 v[76:79], a[216:219], a[184:187], v[76:79]
 v_mul_f32 v6, v6, v216
 v_mul_f32 v5, v5, v217
 v_mfma_f32_16x16x32_bf16 v[76:79], a[220:223], a[188:191], v[76:79]
 global_load_dwordx4 a[212:215], v0, s[70:71] offset:1024
 v_cvt_pk_bf16_f32 v12, v6, v5
 v_mfma_f32_16x16x32_bf16 v[72:75], a[220:223], a[180:183], v[72:75]
 v_accvgpr_read_b32 v5, a113
 v_lshlrev_b32 v6, 16, v5
 v_mfma_f32_16x16x32_bf16 v[72:75], a[216:219], a[176:179], v[72:75]
 global_load_dwordx4 a[208:211], v0, s[70:71] offset:0
 v_and_b32 v5, s26, v5
 v_mfma_f32_16x16x32_bf16 v[68:71], a[216:219], a[168:171], v[68:71]
 v_mul_f32 v6, v6, v218
 v_mul_f32 v5, v5, v219
 v_mfma_f32_16x16x32_bf16 v[68:71], a[220:223], a[172:175], v[68:71]
 v_cvt_pk_bf16_f32 v13, v6, v5
 v_accvgpr_read_b32 v5, a114
 v_mfma_f32_16x16x32_bf16 v[64:67], a[220:223], a[164:167], v[64:67]
 v_lshlrev_b32 v6, 16, v5
 v_and_b32 v5, s26, v5
 v_mfma_f32_16x16x32_bf16 v[64:67], a[216:219], a[160:163], v[64:67]
 v_mul_f32 v6, v6, v248
 v_mul_f32 v5, v5, v249
 v_mfma_f32_16x16x32_bf16 v[60:63], a[216:219], a[152:155], v[60:63]
 v_cvt_pk_bf16_f32 v14, v6, v5
 v_mfma_f32_16x16x32_bf16 v[60:63], a[220:223], a[156:159], v[60:63]
 v_accvgpr_read_b32 v5, a115
 v_lshlrev_b32 v6, 16, v5
 v_mfma_f32_16x16x32_bf16 v[56:59], a[220:223], a[148:151], v[56:59]
 v_and_b32 v5, s26, v5
 v_mul_f32 v6, v6, v250
 v_mfma_f32_16x16x32_bf16 v[56:59], a[216:219], a[144:147], v[56:59]
 v_mul_f32 v5, v5, v251
 v_cvt_pk_bf16_f32 v15, v6, v5
 v_mfma_f32_16x16x32_bf16 v[52:55], a[216:219], a[136:139], v[52:55]
 ds_write_b128 v3, v[12:15] offset:19456
 v_mfma_f32_16x16x32_bf16 v[52:55], a[220:223], a[140:143], v[52:55]
 buffer_store_dwordx4 v[12:15], v3, s[32:35], s68 offen offset:1024 sc1
 v_accvgpr_read_b32 v5, a84
 v_mfma_f32_16x16x32_bf16 v[48:51], a[220:223], a[132:135], v[48:51]
 v_lshlrev_b32 v6, 16, v5
 v_mfma_f32_16x16x32_bf16 v[48:51], a[216:219], a[128:131], v[48:51]
 v_and_b32 v5, s26, v5
 v_mul_f32 v6, v6, v156
 s_waitcnt vmcnt(14)
 v_mfma_f32_16x16x32_bf16 v[80:83], a[224:227], a[128:131], v[80:83]
 v_mul_f32 v5, v5, v157
 v_cvt_pk_bf16_f32 v8, v6, v5
 v_mfma_f32_16x16x32_bf16 v[80:83], a[228:231], a[132:135], v[80:83]
 global_load_dwordx4 a[220:223], v0, s[70:71] offset:3072
 v_accvgpr_read_b32 v5, a85
 v_mfma_f32_16x16x32_bf16 v[84:87], a[228:231], a[140:143], v[84:87]
 v_lshlrev_b32 v6, 16, v5
 v_and_b32 v5, s26, v5
 v_mfma_f32_16x16x32_bf16 v[84:87], a[224:227], a[136:139], v[84:87]
 global_load_dwordx4 a[216:219], v0, s[70:71] offset:2048
 v_mul_f32 v6, v6, v158
 v_mfma_f32_16x16x32_bf16 v[88:91], a[224:227], a[144:147], v[88:91]
 v_mul_f32 v5, v5, v159
 v_cvt_pk_bf16_f32 v9, v6, v5
 s_add_u32 s70, s70, 8192
 s_addc_u32 s71, s71, 0
 v_mfma_f32_16x16x32_bf16 v[88:91], a[228:231], a[148:151], v[88:91]
 v_accvgpr_read_b32 v5, a86
 v_lshlrev_b32 v6, 16, v5
 v_mfma_f32_16x16x32_bf16 v[92:95], a[228:231], a[156:159], v[92:95]
 v_and_b32 v5, s26, v5
 v_mul_f32 v6, v6, v188
 v_mfma_f32_16x16x32_bf16 v[92:95], a[224:227], a[152:155], v[92:95]
 v_mul_f32 v5, v5, v189
 v_cvt_pk_bf16_f32 v10, v6, v5
 v_mfma_f32_16x16x32_bf16 v[96:99], a[224:227], a[160:163], v[96:99]
 v_accvgpr_read_b32 v5, a87
 v_lshlrev_b32 v6, 16, v5
 v_mfma_f32_16x16x32_bf16 v[96:99], a[228:231], a[164:167], v[96:99]
 v_and_b32 v5, s26, v5
 v_mul_f32 v6, v6, v190
 v_mfma_f32_16x16x32_bf16 v[100:103], a[228:231], a[172:175], v[100:103]
 v_mul_f32 v5, v5, v191
 v_cvt_pk_bf16_f32 v11, v6, v5
 v_mfma_f32_16x16x32_bf16 v[100:103], a[224:227], a[168:171], v[100:103]
 ds_write_b128 v3, v[8:11] offset:22528
 v_mfma_f32_16x16x32_bf16 v[104:107], a[224:227], a[176:179], v[104:107]
 buffer_store_dwordx4 v[8:11], v3, s[32:35], s68 offen offset:2048 sc1
 v_accvgpr_read_b32 v5, a116
 v_lshlrev_b32 v6, 16, v5
 v_and_b32 v5, s26, v5
 v_mul_f32 v6, v6, v220
 v_mfma_f32_16x16x32_bf16 v[104:107], a[228:231], a[180:183], v[104:107]
 v_mul_f32 v5, v5, v221
 v_cvt_pk_bf16_f32 v12, v6, v5
 v_mfma_f32_16x16x32_bf16 v[108:111], a[228:231], a[188:191], v[108:111]
 v_accvgpr_read_b32 v5, a117
 v_lshlrev_b32 v6, 16, v5
 v_mfma_f32_16x16x32_bf16 v[108:111], a[224:227], a[184:187], v[108:111]
 v_and_b32 v5, s26, v5
 v_mul_f32 v6, v6, v222
 s_waitcnt vmcnt(14)
 v_mfma_f32_16x16x32_bf16 a[244:247], a[232:235], a[184:187], a[244:247]
 ds_read_b128 a[184:187], v2 offset:61440
 v_mul_f32 v5, v5, v223
 v_mfma_f32_16x16x32_bf16 a[244:247], a[236:239], a[188:191], a[244:247]
 global_load_dwordx4 a[228:231], v0, s[70:71] offset:-3072
 ds_read_b128 a[188:191], v2 offset:62464
 v_mfma_f32_16x16x32_bf16 a[240:243], a[236:239], a[180:183], a[240:243]
 ds_read_b128 a[180:183], v2 offset:58368
 v_cvt_pk_bf16_f32 v13, v6, v5
 v_mfma_f32_16x16x32_bf16 a[240:243], a[232:235], a[176:179], a[240:243]
 global_load_dwordx4 a[224:227], v0, s[70:71] offset:-4096
 ds_read_b128 a[176:179], v2 offset:57344
 v_accvgpr_read_b32 v5, a118
 v_mfma_f32_16x16x32_bf16 v[132:135], a[232:235], a[168:171], v[132:135]
 ds_read_b128 a[168:171], v2 offset:53248
 v_lshlrev_b32 v6, 16, v5
 v_mfma_f32_16x16x32_bf16 v[132:135], a[236:239], a[172:175], v[132:135]
 ds_read_b128 a[172:175], v2 offset:54272
 v_and_b32 v5, s26, v5
 v_mfma_f32_16x16x32_bf16 v[128:131], a[236:239], a[164:167], v[128:131]
 ds_read_b128 a[164:167], v2 offset:50176
 v_mul_f32 v6, v6, v252
 v_mfma_f32_16x16x32_bf16 v[128:131], a[232:235], a[160:163], v[128:131]
 ds_read_b128 a[160:163], v2 offset:49152
 v_mul_f32 v5, v5, v253
 v_mfma_f32_16x16x32_bf16 v[124:127], a[232:235], a[152:155], v[124:127]
 ds_read_b128 a[152:155], v2 offset:45056
 v_cvt_pk_bf16_f32 v14, v6, v5
 v_mfma_f32_16x16x32_bf16 v[124:127], a[236:239], a[156:159], v[124:127]
 ds_read_b128 a[156:159], v2 offset:46080
 v_accvgpr_read_b32 v5, a119
 v_mfma_f32_16x16x32_bf16 v[120:123], a[236:239], a[148:151], v[120:123]
 ds_read_b128 a[148:151], v2 offset:41984
 v_lshlrev_b32 v6, 16, v5
 v_mfma_f32_16x16x32_bf16 v[120:123], a[232:235], a[144:147], v[120:123]
 ds_read_b128 a[144:147], v2 offset:40960
 v_and_b32 v5, s26, v5
 v_mfma_f32_16x16x32_bf16 v[116:119], a[232:235], a[136:139], v[116:119]
 ds_read_b128 a[136:139], v2 offset:36864
 v_mul_f32 v6, v6, v254
 v_mfma_f32_16x16x32_bf16 v[116:119], a[236:239], a[140:143], v[116:119]
 ds_read_b128 a[140:143], v2 offset:37888
 v_mul_f32 v5, v5, v255
 v_mfma_f32_16x16x32_bf16 v[112:115], a[236:239], a[132:135], v[112:115]
 ds_read_b128 a[132:135], v2 offset:33792
 v_cvt_pk_bf16_f32 v15, v6, v5
 v_mfma_f32_16x16x32_bf16 v[112:115], a[232:235], a[128:131], v[112:115]
 ds_read_b128 a[128:131], v2 offset:32768
 ds_write_b128 v3, v[12:15] offset:23552
 buffer_store_dwordx4 v[12:15], v3, s[32:35], s68 offen offset:3072 sc1
 v_accvgpr_read_b32 v5, a88
 v_lshlrev_b32 v6, 16, v5
 v_and_b32 v5, s26, v5
 s_waitcnt vmcnt(14) lgkmcnt(9)
 v_mfma_f32_16x16x32_bf16 v[44:47], a[192:195], a[184:187], v[44:47]
 v_mul_f32 v6, v6, v160
 v_mul_f32 v5, v5, v161
 v_mfma_f32_16x16x32_bf16 v[44:47], a[196:199], a[188:191], v[44:47]
 global_load_dwordx4 a[236:239], v0, s[70:71] offset:-1024
 v_cvt_pk_bf16_f32 v8, v6, v5
 v_mfma_f32_16x16x32_bf16 v[40:43], a[196:199], a[180:183], v[40:43]
 v_accvgpr_read_b32 v5, a89
 v_lshlrev_b32 v6, 16, v5
 v_mfma_f32_16x16x32_bf16 v[40:43], a[192:195], a[176:179], v[40:43]
 global_load_dwordx4 a[232:235], v0, s[70:71] offset:-2048
 v_and_b32 v5, s26, v5
 v_mfma_f32_16x16x32_bf16 v[36:39], a[192:195], a[168:171], v[36:39]
 v_mul_f32 v6, v6, v162
 v_mul_f32 v5, v5, v163
 v_mfma_f32_16x16x32_bf16 v[36:39], a[196:199], a[172:175], v[36:39]
 v_cvt_pk_bf16_f32 v9, v6, v5
 v_accvgpr_read_b32 v5, a90
 v_mfma_f32_16x16x32_bf16 v[32:35], a[196:199], a[164:167], v[32:35]
 v_lshlrev_b32 v6, 16, v5
 v_and_b32 v5, s26, v5
 v_mfma_f32_16x16x32_bf16 v[32:35], a[192:195], a[160:163], v[32:35]
 v_mul_f32 v6, v6, v192
 v_mul_f32 v5, v5, v193
 s_waitcnt lgkmcnt(1)
 v_mfma_f32_16x16x32_bf16 v[28:31], a[192:195], a[152:155], v[28:31]
 v_cvt_pk_bf16_f32 v10, v6, v5
 v_accvgpr_read_b32 v5, a91
 v_mfma_f32_16x16x32_bf16 v[28:31], a[196:199], a[156:159], v[28:31]
 v_lshlrev_b32 v6, 16, v5
 v_and_b32 v5, s26, v5
 v_mfma_f32_16x16x32_bf16 v[24:27], a[196:199], a[148:151], v[24:27]
 v_mul_f32 v6, v6, v194
 v_mul_f32 v5, v5, v195
 v_mfma_f32_16x16x32_bf16 v[24:27], a[192:195], a[144:147], v[24:27]
 v_cvt_pk_bf16_f32 v11, v6, v5
 v_mfma_f32_16x16x32_bf16 v[20:23], a[192:195], a[136:139], v[20:23]
 ds_write_b128 v3, v[8:11] offset:26624
 s_add_u32 s68, s29, 28672
 v_mfma_f32_16x16x32_bf16 v[20:23], a[196:199], a[140:143], v[20:23]
 buffer_store_dwordx4 v[8:11], v3, s[32:35], s68 offen sc1
 v_accvgpr_read_b32 v5, a120
 v_lshlrev_b32 v6, 16, v5
 v_and_b32 v5, s26, v5
 v_mfma_f32_16x16x32_bf16 v[16:19], a[196:199], a[132:135], v[16:19]
 v_mul_f32 v6, v6, v224
 v_mul_f32 v5, v5, v225
 v_mfma_f32_16x16x32_bf16 v[16:19], a[192:195], a[128:131], v[16:19]
 v_cvt_pk_bf16_f32 v12, v6, v5
 v_accvgpr_read_b32 v5, a121
 s_waitcnt vmcnt(13)
 v_mfma_f32_16x16x32_bf16 v[48:51], a[200:203], a[128:131], v[48:51]
 v_lshlrev_b32 v6, 16, v5
 v_and_b32 v5, s26, v5
 v_mfma_f32_16x16x32_bf16 v[48:51], a[204:207], a[132:135], v[48:51]
 global_load_dwordx4 a[196:199], v0, s[70:71] offset:1024
 v_mul_f32 v6, v6, v226
 v_mfma_f32_16x16x32_bf16 v[52:55], a[204:207], a[140:143], v[52:55]
 v_mul_f32 v5, v5, v227
 v_cvt_pk_bf16_f32 v13, v6, v5
 v_mfma_f32_16x16x32_bf16 v[52:55], a[200:203], a[136:139], v[52:55]
 global_load_dwordx4 a[192:195], v0, s[70:71] offset:0
 v_accvgpr_read_b32 v5, a122
 v_mfma_f32_16x16x32_bf16 v[56:59], a[200:203], a[144:147], v[56:59]
 v_accvgpr_read_b32 v7, a248
 v_lshlrev_b32 v6, 16, v5
 v_mfma_f32_16x16x32_bf16 v[56:59], a[204:207], a[148:151], v[56:59]
 v_and_b32 v5, s26, v5
 v_mul_f32 v6, v6, v7
 v_mfma_f32_16x16x32_bf16 v[60:63], a[204:207], a[156:159], v[60:63]
 v_accvgpr_read_b32 v7, a249
 v_mfma_f32_16x16x32_bf16 v[60:63], a[200:203], a[152:155], v[60:63]
 v_mul_f32 v5, v5, v7
 v_cvt_pk_bf16_f32 v14, v6, v5
 v_mfma_f32_16x16x32_bf16 v[64:67], a[200:203], a[160:163], v[64:67]
 v_accvgpr_read_b32 v5, a123
 v_accvgpr_read_b32 v7, a250
 v_mfma_f32_16x16x32_bf16 v[64:67], a[204:207], a[164:167], v[64:67]
 v_lshlrev_b32 v6, 16, v5
 v_mfma_f32_16x16x32_bf16 v[68:71], a[204:207], a[172:175], v[68:71]
 v_and_b32 v5, s26, v5
 v_mul_f32 v6, v6, v7
 v_mfma_f32_16x16x32_bf16 v[68:71], a[200:203], a[168:171], v[68:71]
 v_accvgpr_read_b32 v7, a251
 v_mul_f32 v5, v5, v7
 v_mfma_f32_16x16x32_bf16 v[72:75], a[200:203], a[176:179], v[72:75]
 v_cvt_pk_bf16_f32 v15, v6, v5
 v_mfma_f32_16x16x32_bf16 v[72:75], a[204:207], a[180:183], v[72:75]
 ds_write_b128 v3, v[12:15] offset:27648
 v_mfma_f32_16x16x32_bf16 v[76:79], a[204:207], a[188:191], v[76:79]
 buffer_store_dwordx4 v[12:15], v3, s[32:35], s68 offen offset:1024 sc1
 v_accvgpr_read_b32 v5, a92
 v_lshlrev_b32 v6, 16, v5
 v_mfma_f32_16x16x32_bf16 v[76:79], a[200:203], a[184:187], v[76:79]
 v_and_b32 v5, s26, v5
 v_mul_f32 v6, v6, v164
 s_waitcnt vmcnt(13)
 v_mfma_f32_16x16x32_bf16 v[108:111], a[208:211], a[184:187], v[108:111]
 v_mul_f32 v5, v5, v165
 v_cvt_pk_bf16_f32 v8, v6, v5
 v_mfma_f32_16x16x32_bf16 v[108:111], a[212:215], a[188:191], v[108:111]
 global_load_dwordx4 a[204:207], v0, s[70:71] offset:3072
 v_accvgpr_read_b32 v5, a93
 v_mfma_f32_16x16x32_bf16 v[104:107], a[212:215], a[180:183], v[104:107]
 v_lshlrev_b32 v6, 16, v5
 v_and_b32 v5, s26, v5
 v_mfma_f32_16x16x32_bf16 v[104:107], a[208:211], a[176:179], v[104:107]
 global_load_dwordx4 a[200:203], v0, s[70:71] offset:2048
 v_mul_f32 v6, v6, v166
 v_mfma_f32_16x16x32_bf16 v[100:103], a[208:211], a[168:171], v[100:103]
 v_mul_f32 v5, v5, v167
 v_cvt_pk_bf16_f32 v9, v6, v5
 s_add_u32 s70, s70, 8192
 s_addc_u32 s71, s71, 0
 v_mfma_f32_16x16x32_bf16 v[100:103], a[212:215], a[172:175], v[100:103]
 v_accvgpr_read_b32 v5, a94
 v_lshlrev_b32 v6, 16, v5
 v_mfma_f32_16x16x32_bf16 v[96:99], a[212:215], a[164:167], v[96:99]
 v_and_b32 v5, s26, v5
 v_mul_f32 v6, v6, v196
 v_mfma_f32_16x16x32_bf16 v[96:99], a[208:211], a[160:163], v[96:99]
 v_mul_f32 v5, v5, v197
 v_cvt_pk_bf16_f32 v10, v6, v5
 v_mfma_f32_16x16x32_bf16 v[92:95], a[208:211], a[152:155], v[92:95]
 v_accvgpr_read_b32 v5, a95
 v_lshlrev_b32 v6, 16, v5
 v_mfma_f32_16x16x32_bf16 v[92:95], a[212:215], a[156:159], v[92:95]
 v_and_b32 v5, s26, v5
 v_mul_f32 v6, v6, v198
 v_mfma_f32_16x16x32_bf16 v[88:91], a[212:215], a[148:151], v[88:91]
 v_mul_f32 v5, v5, v199
 v_cvt_pk_bf16_f32 v11, v6, v5
 v_mfma_f32_16x16x32_bf16 v[88:91], a[208:211], a[144:147], v[88:91]
 ds_write_b128 v3, v[8:11] offset:30720
 v_mfma_f32_16x16x32_bf16 v[84:87], a[208:211], a[136:139], v[84:87]
 buffer_store_dwordx4 v[8:11], v3, s[32:35], s68 offen offset:2048 sc1
 v_accvgpr_read_b32 v5, a124
 v_lshlrev_b32 v6, 16, v5
 v_and_b32 v5, s26, v5
 v_mul_f32 v6, v6, v228
 v_mfma_f32_16x16x32_bf16 v[84:87], a[212:215], a[140:143], v[84:87]
 v_mul_f32 v5, v5, v229
 v_cvt_pk_bf16_f32 v12, v6, v5
 v_mfma_f32_16x16x32_bf16 v[80:83], a[212:215], a[132:135], v[80:83]
 v_accvgpr_read_b32 v5, a125
 v_lshlrev_b32 v6, 16, v5
 v_mfma_f32_16x16x32_bf16 v[80:83], a[208:211], a[128:131], v[80:83]
 v_and_b32 v5, s26, v5
 v_mul_f32 v6, v6, v230
 s_waitcnt vmcnt(13)
 v_mfma_f32_16x16x32_bf16 v[112:115], a[216:219], a[128:131], v[112:115]
 ds_read_b128 a[128:131], v1
 v_mul_f32 v5, v5, v231
 v_mfma_f32_16x16x32_bf16 v[112:115], a[220:223], a[132:135], v[112:115]
 global_load_dwordx4 a[212:215], v0, s[70:71] offset:-3072
 ds_read_b128 a[132:135], v1 offset:1024
 v_mfma_f32_16x16x32_bf16 v[116:119], a[220:223], a[140:143], v[116:119]
 ds_read_b128 a[140:143], v1 offset:5120
 v_cvt_pk_bf16_f32 v13, v6, v5
 v_mfma_f32_16x16x32_bf16 v[116:119], a[216:219], a[136:139], v[116:119]
 global_load_dwordx4 a[208:211], v0, s[70:71] offset:-4096
 ds_read_b128 a[136:139], v1 offset:4096
 v_mfma_f32_16x16x32_bf16 v[120:123], a[216:219], a[144:147], v[120:123]
 ds_read_b128 a[144:147], v1 offset:8192
 v_accvgpr_read_b32 v5, a126
 v_mfma_f32_16x16x32_bf16 v[120:123], a[220:223], a[148:151], v[120:123]
 ds_read_b128 a[148:151], v1 offset:9216
 v_accvgpr_read_b32 v7, a252
 v_lshlrev_b32 v6, 16, v5
 v_mfma_f32_16x16x32_bf16 v[124:127], a[220:223], a[156:159], v[124:127]
 ds_read_b128 a[156:159], v1 offset:13312
 v_and_b32 v5, s26, v5
 v_mfma_f32_16x16x32_bf16 v[124:127], a[216:219], a[152:155], v[124:127]
 ds_read_b128 a[152:155], v1 offset:12288
 v_mul_f32 v6, v6, v7
 v_accvgpr_read_b32 v7, a253
 v_mfma_f32_16x16x32_bf16 v[128:131], a[216:219], a[160:163], v[128:131]
 ds_read_b128 a[160:163], v1 offset:16384
 v_mul_f32 v5, v5, v7
 v_cvt_pk_bf16_f32 v14, v6, v5
 v_mfma_f32_16x16x32_bf16 v[128:131], a[220:223], a[164:167], v[128:131]
 ds_read_b128 a[164:167], v1 offset:17408
 v_accvgpr_read_b32 v5, a127
 v_accvgpr_read_b32 v7, a254
 v_mfma_f32_16x16x32_bf16 v[132:135], a[220:223], a[172:175], v[132:135]
 ds_read_b128 a[172:175], v1 offset:21504
 v_lshlrev_b32 v6, 16, v5
 v_mfma_f32_16x16x32_bf16 v[132:135], a[216:219], a[168:171], v[132:135]
 ds_read_b128 a[168:171], v1 offset:20480
 v_and_b32 v5, s26, v5
 v_mul_f32 v6, v6, v7
 v_mfma_f32_16x16x32_bf16 a[240:243], a[216:219], a[176:179], a[240:243]
 ds_read_b128 a[176:179], v1 offset:24576
 v_accvgpr_read_b32 v7, a255
 v_mul_f32 v5, v5, v7
 v_cvt_pk_bf16_f32 v15, v6, v5
 v_mfma_f32_16x16x32_bf16 a[240:243], a[220:223], a[180:183], a[240:243]
 ds_read_b128 a[180:183], v1 offset:25600
 ds_write_b128 v3, v[12:15] offset:31744
 v_mfma_f32_16x16x32_bf16 a[244:247], a[220:223], a[188:191], a[244:247]
 buffer_store_dwordx4 v[12:15], v3, s[32:35], s68 offen offset:3072 sc1
 global_load_dwordx4 a[220:223], v0, s[70:71] offset:-1024
 ds_read_b128 a[188:191], v1 offset:29696
 v_mfma_f32_16x16x32_bf16 a[244:247], a[216:219], a[184:187], a[244:247]
 global_load_dwordx4 a[216:219], v0, s[70:71] offset:-2048
 ds_read_b128 a[184:187], v1 offset:28672
 s_waitcnt vmcnt(15) lgkmcnt(9)
Ls1b:
 v_mfma_f32_16x16x32_bf16 v[136:139], a[224:227], a[128:131], v[136:139]
 v_lshrrev_b32 v4, 8, v1
 v_mfma_f32_16x16x32_bf16 v[136:139], a[228:231], a[132:135], v[136:139]
 v_mfma_f32_16x16x32_bf16 v[140:143], a[228:231], a[140:143], v[140:143]
 v_lshl_add_u32 v4, v4, 5, s51
 v_mfma_f32_16x16x32_bf16 v[140:143], a[224:227], a[136:139], v[140:143]
 ds_read_b128 v[8:11], v4
 v_mfma_f32_16x16x32_bf16 v[144:147], a[224:227], a[144:147], v[144:147]
 v_mfma_f32_16x16x32_bf16 v[144:147], a[228:231], a[148:151], v[144:147]
 v_mfma_f32_16x16x32_bf16 v[148:151], a[228:231], a[156:159], v[148:151]
 v_mfma_f32_16x16x32_bf16 v[148:151], a[224:227], a[152:155], v[148:151]
 s_waitcnt lgkmcnt(1)
 v_mfma_f32_16x16x32_bf16 v[152:155], a[224:227], a[160:163], v[152:155]
 v_mfma_f32_16x16x32_bf16 v[152:155], a[228:231], a[164:167], v[152:155]
 v_mfma_f32_16x16x32_bf16 v[156:159], a[228:231], a[172:175], v[156:159]
 v_mfma_f32_16x16x32_bf16 v[156:159], a[224:227], a[168:171], v[156:159]
 v_mfma_f32_16x16x32_bf16 v[160:163], a[224:227], a[176:179], v[160:163]
 v_mfma_f32_16x16x32_bf16 v[160:163], a[228:231], a[180:183], v[160:163]
 v_mfma_f32_16x16x32_bf16 v[164:167], a[228:231], a[188:191], v[164:167]
 v_mfma_f32_16x16x32_bf16 v[164:167], a[224:227], a[184:187], v[164:167]
 s_waitcnt vmcnt(12)
 v_mfma_f32_16x16x32_bf16 v[196:199], a[232:235], a[184:187], v[196:199]
 s_waitcnt lgkmcnt(0)
 v_mfma_f32_16x16x32_bf16 v[196:199], a[236:239], a[188:191], v[196:199]
 global_load_dwordx4 a[228:231], v0, s[70:71] offset:1024
 v_add_f32 v16, v16, v8
 v_mfma_f32_16x16x32_bf16 v[192:195], a[236:239], a[180:183], v[192:195]
 v_mfma_f32_16x16x32_bf16 v[192:195], a[232:235], a[176:179], v[192:195]
 global_load_dwordx4 a[224:227], v0, s[70:71] offset:0
 ds_read_b128 v[12:15], v4 offset:16
 v_mfma_f32_16x16x32_bf16 v[188:191], a[232:235], a[168:171], v[188:191]
 v_add_f32 v17, v17, v9
 v_mfma_f32_16x16x32_bf16 v[188:191], a[236:239], a[172:175], v[188:191]
 v_mfma_f32_16x16x32_bf16 v[184:187], a[236:239], a[164:167], v[184:187]
 v_add_f32 v18, v18, v10
 v_mfma_f32_16x16x32_bf16 v[184:187], a[232:235], a[160:163], v[184:187]
 v_add_f32 v19, v19, v11
 v_mfma_f32_16x16x32_bf16 v[180:183], a[232:235], a[152:155], v[180:183]
 v_mfma_f32_16x16x32_bf16 v[180:183], a[236:239], a[156:159], v[180:183]
 v_add_f32 v20, v20, v8
 v_mfma_f32_16x16x32_bf16 v[176:179], a[236:239], a[148:151], v[176:179]
 v_add_f32 v21, v21, v9
 v_mfma_f32_16x16x32_bf16 v[176:179], a[232:235], a[144:147], v[176:179]
 v_add_f32 v22, v22, v10
 v_mfma_f32_16x16x32_bf16 v[172:175], a[232:235], a[136:139], v[172:175]
 v_mfma_f32_16x16x32_bf16 v[172:175], a[236:239], a[140:143], v[172:175]
 v_add_f32 v23, v23, v11
 v_mfma_f32_16x16x32_bf16 v[168:171], a[236:239], a[132:135], v[168:171]
 v_add_f32 v24, v24, v8
 v_mfma_f32_16x16x32_bf16 v[168:171], a[232:235], a[128:131], v[168:171]
 s_waitcnt vmcnt(11)
 v_mfma_f32_16x16x32_bf16 v[200:203], a[192:195], a[128:131], v[200:203]
 v_add_f32 v25, v25, v9
 v_mfma_f32_16x16x32_bf16 v[200:203], a[196:199], a[132:135], v[200:203]
 global_load_dwordx4 a[236:239], v0, s[70:71] offset:3072
 v_add_f32 v26, v26, v10
 v_mfma_f32_16x16x32_bf16 v[204:207], a[196:199], a[140:143], v[204:207]
 v_mfma_f32_16x16x32_bf16 v[204:207], a[192:195], a[136:139], v[204:207]
 global_load_dwordx4 a[232:235], v0, s[70:71] offset:2048
 v_add_f32 v27, v27, v11
 v_mfma_f32_16x16x32_bf16 v[208:211], a[192:195], a[144:147], v[208:211]
 v_add_f32 v28, v28, v8
 s_add_u32 s70, s70, 8192
 s_addc_u32 s71, s71, 0
 v_mfma_f32_16x16x32_bf16 v[208:211], a[196:199], a[148:151], v[208:211]
 v_mfma_f32_16x16x32_bf16 v[212:215], a[196:199], a[156:159], v[212:215]
 v_add_f32 v29, v29, v9
 v_mfma_f32_16x16x32_bf16 v[212:215], a[192:195], a[152:155], v[212:215]
 v_add_f32 v30, v30, v10
 v_mfma_f32_16x16x32_bf16 v[216:219], a[192:195], a[160:163], v[216:219]
 v_add_f32 v31, v31, v11
 v_mfma_f32_16x16x32_bf16 v[216:219], a[196:199], a[164:167], v[216:219]
 v_mfma_f32_16x16x32_bf16 v[220:223], a[196:199], a[172:175], v[220:223]
 v_add_f32 v32, v32, v8
 v_mfma_f32_16x16x32_bf16 v[220:223], a[192:195], a[168:171], v[220:223]
 v_add_f32 v33, v33, v9
 v_mfma_f32_16x16x32_bf16 v[224:227], a[192:195], a[176:179], v[224:227]
 v_mfma_f32_16x16x32_bf16 v[224:227], a[196:199], a[180:183], v[224:227]
 v_add_f32 v34, v34, v10
 v_mfma_f32_16x16x32_bf16 v[228:231], a[196:199], a[188:191], v[228:231]
 v_add_f32 v35, v35, v11
 v_mfma_f32_16x16x32_bf16 v[228:231], a[192:195], a[184:187], v[228:231]
 v_add_f32 v36, v36, v8
 s_waitcnt vmcnt(10)
 v_mfma_f32_16x16x32_bf16 a[252:255], a[200:203], a[184:187], a[252:255]
 ds_read_b128 a[184:187], v1 offset:61440
 v_add_f32 v37, v37, v9
 v_mfma_f32_16x16x32_bf16 a[252:255], a[204:207], a[188:191], a[252:255]
 global_load_dwordx4 a[196:199], v0, s[70:71] offset:-3072
 ds_read_b128 a[188:191], v1 offset:62464
 v_mfma_f32_16x16x32_bf16 a[248:251], a[204:207], a[180:183], a[248:251]
 ds_read_b128 a[180:183], v1 offset:58368
 v_add_f32 v38, v38, v10
 v_mfma_f32_16x16x32_bf16 a[248:251], a[200:203], a[176:179], a[248:251]
 global_load_dwordx4 a[192:195], v0, s[70:71] offset:-4096
 ds_read_b128 a[176:179], v1 offset:57344
 v_mfma_f32_16x16x32_bf16 v[252:255], a[200:203], a[168:171], v[252:255]
 ds_read_b128 a[168:171], v1 offset:53248
 v_add_f32 v39, v39, v11
 v_mfma_f32_16x16x32_bf16 v[252:255], a[204:207], a[172:175], v[252:255]
 ds_read_b128 a[172:175], v1 offset:54272
 v_add_f32 v40, v40, v8
 v_mfma_f32_16x16x32_bf16 v[248:251], a[204:207], a[164:167], v[248:251]
 ds_read_b128 a[164:167], v1 offset:50176
 v_mfma_f32_16x16x32_bf16 v[248:251], a[200:203], a[160:163], v[248:251]
 ds_read_b128 a[160:163], v1 offset:49152
 v_add_f32 v41, v41, v9
 v_mfma_f32_16x16x32_bf16 v[244:247], a[200:203], a[152:155], v[244:247]
 ds_read_b128 a[152:155], v1 offset:45056
 v_add_f32 v42, v42, v10
 v_mfma_f32_16x16x32_bf16 v[244:247], a[204:207], a[156:159], v[244:247]
 ds_read_b128 a[156:159], v1 offset:46080
 v_mfma_f32_16x16x32_bf16 v[240:243], a[204:207], a[148:151], v[240:243]
 ds_read_b128 a[148:151], v1 offset:41984
 v_add_f32 v43, v43, v11
 v_mfma_f32_16x16x32_bf16 v[240:243], a[200:203], a[144:147], v[240:243]
 ds_read_b128 a[144:147], v1 offset:40960
 v_add_f32 v44, v44, v8
 v_mfma_f32_16x16x32_bf16 v[236:239], a[200:203], a[136:139], v[236:239]
 ds_read_b128 a[136:139], v1 offset:36864
 v_mfma_f32_16x16x32_bf16 v[236:239], a[204:207], a[140:143], v[236:239]
 ds_read_b128 a[140:143], v1 offset:37888
 v_add_f32 v45, v45, v9
 v_mfma_f32_16x16x32_bf16 v[232:235], a[204:207], a[132:135], v[232:235]
 ds_read_b128 a[132:135], v1 offset:33792
 v_add_f32 v46, v46, v10
 v_mfma_f32_16x16x32_bf16 v[232:235], a[200:203], a[128:131], v[232:235]
 ds_read_b128 a[128:131], v1 offset:32768
 v_add_f32 v47, v47, v11
 s_waitcnt vmcnt(9) lgkmcnt(8)
 v_mfma_f32_16x16x32_bf16 v[164:167], a[208:211], a[184:187], v[164:167]
 v_mfma_f32_16x16x32_bf16 v[164:167], a[212:215], a[188:191], v[164:167]
 global_load_dwordx4 a[204:207], v0, s[70:71] offset:-1024
 v_mfma_f32_16x16x32_bf16 v[160:163], a[212:215], a[180:183], v[160:163]
 v_add_f32 v48, v48, v12
 v_mfma_f32_16x16x32_bf16 v[160:163], a[208:211], a[176:179], v[160:163]
 global_load_dwordx4 a[200:203], v0, s[70:71] offset:-2048
 v_mfma_f32_16x16x32_bf16 v[156:159], a[208:211], a[168:171], v[156:159]
 ds_read_b128 v[8:11], v4 offset:128
 v_mfma_f32_16x16x32_bf16 v[156:159], a[212:215], a[172:175], v[156:159]
 v_add_f32 v49, v49, v13
 v_mfma_f32_16x16x32_bf16 v[152:155], a[212:215], a[164:167], v[152:155]
 v_mfma_f32_16x16x32_bf16 v[152:155], a[208:211], a[160:163], v[152:155]
 v_add_f32 v50, v50, v14
 s_waitcnt lgkmcnt(1)
 v_mfma_f32_16x16x32_bf16 v[148:151], a[208:211], a[152:155], v[148:151]
 v_add_f32 v51, v51, v15
 v_mfma_f32_16x16x32_bf16 v[148:151], a[212:215], a[156:159], v[148:151]
 v_add_f32 v52, v52, v12
 v_mfma_f32_16x16x32_bf16 v[144:147], a[212:215], a[148:151], v[144:147]
 v_mfma_f32_16x16x32_bf16 v[144:147], a[208:211], a[144:147], v[144:147]
 v_add_f32 v53, v53, v13
 v_mfma_f32_16x16x32_bf16 v[140:143], a[208:211], a[136:139], v[140:143]
 v_add_f32 v54, v54, v14
 v_mfma_f32_16x16x32_bf16 v[140:143], a[212:215], a[140:143], v[140:143]
 v_mfma_f32_16x16x32_bf16 v[136:139], a[212:215], a[132:135], v[136:139]
 v_add_f32 v55, v55, v15
 v_mfma_f32_16x16x32_bf16 v[136:139], a[208:211], a[128:131], v[136:139]
 v_add_f32 v56, v56, v12
 s_waitcnt vmcnt(8)
 v_mfma_f32_16x16x32_bf16 v[168:171], a[216:219], a[128:131], v[168:171]
 v_mfma_f32_16x16x32_bf16 v[168:171], a[220:223], a[132:135], v[168:171]
 global_load_dwordx4 a[212:215], v0, s[70:71] offset:1024
 v_add_f32 v57, v57, v13
 v_mfma_f32_16x16x32_bf16 v[172:175], a[220:223], a[140:143], v[172:175]
 v_add_f32 v58, v58, v14
 v_mfma_f32_16x16x32_bf16 v[172:175], a[216:219], a[136:139], v[172:175]
 global_load_dwordx4 a[208:211], v0, s[70:71] offset:0
 v_add_f32 v59, v59, v15
 v_mfma_f32_16x16x32_bf16 v[176:179], a[216:219], a[144:147], v[176:179]
 v_mfma_f32_16x16x32_bf16 v[176:179], a[220:223], a[148:151], v[176:179]
 v_add_f32 v60, v60, v12
 v_mfma_f32_16x16x32_bf16 v[180:183], a[220:223], a[156:159], v[180:183]
 v_add_f32 v61, v61, v13
 v_mfma_f32_16x16x32_bf16 v[180:183], a[216:219], a[152:155], v[180:183]
 v_mfma_f32_16x16x32_bf16 v[184:187], a[216:219], a[160:163], v[184:187]
 v_add_f32 v62, v62, v14
 v_mfma_f32_16x16x32_bf16 v[184:187], a[220:223], a[164:167], v[184:187]
 v_add_f32 v63, v63, v15
 v_mfma_f32_16x16x32_bf16 v[188:191], a[220:223], a[172:175], v[188:191]
 v_mfma_f32_16x16x32_bf16 v[188:191], a[216:219], a[168:171], v[188:191]
 v_add_f32 v64, v64, v12
 v_mfma_f32_16x16x32_bf16 v[192:195], a[216:219], a[176:179], v[192:195]
 v_add_f32 v65, v65, v13
 v_mfma_f32_16x16x32_bf16 v[192:195], a[220:223], a[180:183], v[192:195]
 v_mfma_f32_16x16x32_bf16 v[196:199], a[220:223], a[188:191], v[196:199]
 v_add_f32 v66, v66, v14
 v_mfma_f32_16x16x32_bf16 v[196:199], a[216:219], a[184:187], v[196:199]
 v_add_f32 v67, v67, v15
 s_waitcnt vmcnt(8)
 v_mfma_f32_16x16x32_bf16 v[228:231], a[224:227], a[184:187], v[228:231]
 v_add_f32 v68, v68, v12
 v_mfma_f32_16x16x32_bf16 v[228:231], a[228:231], a[188:191], v[228:231]
 global_load_dwordx4 a[220:223], v0, s[70:71] offset:3072
 v_mfma_f32_16x16x32_bf16 v[224:227], a[228:231], a[180:183], v[224:227]
 v_add_f32 v69, v69, v13
 v_mfma_f32_16x16x32_bf16 v[224:227], a[224:227], a[176:179], v[224:227]
 global_load_dwordx4 a[216:219], v0, s[70:71] offset:2048
 v_add_f32 v70, v70, v14
 v_mfma_f32_16x16x32_bf16 v[220:223], a[224:227], a[168:171], v[220:223]
 s_add_u32 s70, s70, 8192
 s_addc_u32 s71, s71, 0
 v_mfma_f32_16x16x32_bf16 v[220:223], a[228:231], a[172:175], v[220:223]
 v_add_f32 v71, v71, v15
 v_mfma_f32_16x16x32_bf16 v[216:219], a[228:231], a[164:167], v[216:219]
 v_add_f32 v72, v72, v12
 v_mfma_f32_16x16x32_bf16 v[216:219], a[224:227], a[160:163], v[216:219]
 v_mfma_f32_16x16x32_bf16 v[212:215], a[224:227], a[152:155], v[212:215]
 v_add_f32 v73, v73, v13
 v_mfma_f32_16x16x32_bf16 v[212:215], a[228:231], a[156:159], v[212:215]
 v_add_f32 v74, v74, v14
 v_mfma_f32_16x16x32_bf16 v[208:211], a[228:231], a[148:151], v[208:211]
 v_add_f32 v75, v75, v15
 v_mfma_f32_16x16x32_bf16 v[208:211], a[224:227], a[144:147], v[208:211]
 v_mfma_f32_16x16x32_bf16 v[204:207], a[224:227], a[136:139], v[204:207]
 v_add_f32 v76, v76, v12
 v_mfma_f32_16x16x32_bf16 v[204:207], a[228:231], a[140:143], v[204:207]
 v_add_f32 v77, v77, v13
 v_mfma_f32_16x16x32_bf16 v[200:203], a[228:231], a[132:135], v[200:203]
 v_mfma_f32_16x16x32_bf16 v[200:203], a[224:227], a[128:131], v[200:203]
 v_add_f32 v78, v78, v14
 s_waitcnt vmcnt(8)
 v_mfma_f32_16x16x32_bf16 v[232:235], a[232:235], a[128:131], v[232:235]
 ds_read_b128 a[128:131], v2
 v_add_f32 v79, v79, v15
 v_mfma_f32_16x16x32_bf16 v[232:235], a[236:239], a[132:135], v[232:235]
 global_load_dwordx4 a[228:231], v0, s[70:71] offset:-3072
 ds_read_b128 a[132:135], v2 offset:1024
 v_mfma_f32_16x16x32_bf16 v[236:239], a[236:239], a[140:143], v[236:239]
 ds_read_b128 a[140:143], v2 offset:5120
 s_waitcnt lgkmcnt(3)
 v_mfma_f32_16x16x32_bf16 v[236:239], a[232:235], a[136:139], v[236:239]
 global_load_dwordx4 a[224:227], v0, s[70:71] offset:-4096
 ds_read_b128 a[136:139], v2 offset:4096
 v_mfma_f32_16x16x32_bf16 v[240:243], a[232:235], a[144:147], v[240:243]
 ds_read_b128 a[144:147], v2 offset:8192
 v_add_f32 v80, v80, v8
 v_mfma_f32_16x16x32_bf16 v[240:243], a[236:239], a[148:151], v[240:243]
 ds_read_b128 a[148:151], v2 offset:9216
 ds_read_b128 v[12:15], v4 offset:144
 v_mfma_f32_16x16x32_bf16 v[244:247], a[236:239], a[156:159], v[244:247]
 ds_read_b128 a[156:159], v2 offset:13312
 v_add_f32 v81, v81, v9
 v_mfma_f32_16x16x32_bf16 v[244:247], a[232:235], a[152:155], v[244:247]
 ds_read_b128 a[152:155], v2 offset:12288
 v_add_f32 v82, v82, v10
 v_mfma_f32_16x16x32_bf16 v[248:251], a[232:235], a[160:163], v[248:251]
 ds_read_b128 a[160:163], v2 offset:16384
 v_mfma_f32_16x16x32_bf16 v[248:251], a[236:239], a[164:167], v[248:251]
 ds_read_b128 a[164:167], v2 offset:17408
 v_add_f32 v83, v83, v11
 v_mfma_f32_16x16x32_bf16 v[252:255], a[236:239], a[172:175], v[252:255]
 ds_read_b128 a[172:175], v2 offset:21504
 v_add_f32 v84, v84, v8
 v_mfma_f32_16x16x32_bf16 v[252:255], a[232:235], a[168:171], v[252:255]
 ds_read_b128 a[168:171], v2 offset:20480
 v_mfma_f32_16x16x32_bf16 a[248:251], a[232:235], a[176:179], a[248:251]
 ds_read_b128 a[176:179], v2 offset:24576
 v_add_f32 v85, v85, v9
 v_mfma_f32_16x16x32_bf16 a[248:251], a[236:239], a[180:183], a[248:251]
 ds_read_b128 a[180:183], v2 offset:25600
 v_add_f32 v86, v86, v10
 v_mfma_f32_16x16x32_bf16 a[252:255], a[236:239], a[188:191], a[252:255]
 ds_read_b128 a[188:191], v2 offset:29696
 v_mfma_f32_16x16x32_bf16 a[252:255], a[232:235], a[184:187], a[252:255]
 ds_read_b128 a[184:187], v2 offset:28672
 v_add_f32 v87, v87, v11
 s_waitcnt vmcnt(8) lgkmcnt(8)
 v_mfma_f32_16x16x32_bf16 v[136:139], a[192:195], a[128:131], v[136:139]
 v_add_f32 v88, v88, v8
 v_mfma_f32_16x16x32_bf16 v[136:139], a[196:199], a[132:135], v[136:139]
 global_load_dwordx4 a[236:239], v0, s[70:71] offset:-1024
 v_add_f32 v89, v89, v9
 v_mfma_f32_16x16x32_bf16 v[140:143], a[196:199], a[140:143], v[140:143]
 v_mfma_f32_16x16x32_bf16 v[140:143], a[192:195], a[136:139], v[140:143]
 global_load_dwordx4 a[232:235], v0, s[70:71] offset:-2048
 v_add_f32 v90, v90, v10
 v_mfma_f32_16x16x32_bf16 v[144:147], a[192:195], a[144:147], v[144:147]
 v_add_f32 v91, v91, v11
 v_mfma_f32_16x16x32_bf16 v[144:147], a[196:199], a[148:151], v[144:147]
 v_mfma_f32_16x16x32_bf16 v[148:151], a[196:199], a[156:159], v[148:151]
 v_add_f32 v92, v92, v8
 v_mfma_f32_16x16x32_bf16 v[148:151], a[192:195], a[152:155], v[148:151]
 v_add_f32 v93, v93, v9
 s_waitcnt lgkmcnt(0)
 v_mfma_f32_16x16x32_bf16 v[152:155], a[192:195], a[160:163], v[152:155]
 v_mfma_f32_16x16x32_bf16 v[152:155], a[196:199], a[164:167], v[152:155]
 v_add_f32 v94, v94, v10
 v_mfma_f32_16x16x32_bf16 v[156:159], a[196:199], a[172:175], v[156:159]
 v_add_f32 v95, v95, v11
 v_mfma_f32_16x16x32_bf16 v[156:159], a[192:195], a[168:171], v[156:159]
 buffer_load_dword v4, off, s[64:67], 0 sc1
 v_mfma_f32_16x16x32_bf16 v[160:163], a[192:195], a[176:179], v[160:163]
 v_mfma_f32_16x16x32_bf16 v[160:163], a[196:199], a[180:183], v[160:163]
 v_add_f32 v96, v96, v8
 v_mfma_f32_16x16x32_bf16 v[164:167], a[196:199], a[188:191], v[164:167]
 v_add_f32 v97, v97, v9
 v_mfma_f32_16x16x32_bf16 v[164:167], a[192:195], a[184:187], v[164:167]
 s_waitcnt vmcnt(9)
 v_mfma_f32_16x16x32_bf16 v[196:199], a[200:203], a[184:187], v[196:199]
 v_add_f32 v98, v98, v10
 v_mfma_f32_16x16x32_bf16 v[196:199], a[204:207], a[188:191], v[196:199]
 global_load_dwordx4 a[196:199], v0, s[70:71] offset:1024
 v_add_f32 v99, v99, v11
 v_mfma_f32_16x16x32_bf16 v[192:195], a[204:207], a[180:183], v[192:195]
 v_mfma_f32_16x16x32_bf16 v[192:195], a[200:203], a[176:179], v[192:195]
 global_load_dwordx4 a[192:195], v0, s[70:71] offset:0
 v_add_f32 v100, v100, v8
 v_mfma_f32_16x16x32_bf16 v[188:191], a[200:203], a[168:171], v[188:191]
 v_add_f32 v101, v101, v9
 v_mfma_f32_16x16x32_bf16 v[188:191], a[204:207], a[172:175], v[188:191]
 v_mfma_f32_16x16x32_bf16 v[184:187], a[204:207], a[164:167], v[184:187]
 v_add_f32 v102, v102, v10
 v_mfma_f32_16x16x32_bf16 v[184:187], a[200:203], a[160:163], v[184:187]
 v_add_f32 v103, v103, v11
 v_mfma_f32_16x16x32_bf16 v[180:183], a[200:203], a[152:155], v[180:183]
 v_add_f32 v104, v104, v8
 v_mfma_f32_16x16x32_bf16 v[180:183], a[204:207], a[156:159], v[180:183]
 v_mfma_f32_16x16x32_bf16 v[176:179], a[204:207], a[148:151], v[176:179]
 v_add_f32 v105, v105, v9
 v_mfma_f32_16x16x32_bf16 v[176:179], a[200:203], a[144:147], v[176:179]
 v_add_f32 v106, v106, v10
 v_mfma_f32_16x16x32_bf16 v[172:175], a[200:203], a[136:139], v[172:175]
 v_mfma_f32_16x16x32_bf16 v[172:175], a[204:207], a[140:143], v[172:175]
 v_add_f32 v107, v107, v11
 v_mfma_f32_16x16x32_bf16 v[168:171], a[204:207], a[132:135], v[168:171]
 v_add_f32 v108, v108, v8
 v_mfma_f32_16x16x32_bf16 v[168:171], a[200:203], a[128:131], v[168:171]
 s_waitcnt vmcnt(9)
 v_mfma_f32_16x16x32_bf16 v[200:203], a[208:211], a[128:131], v[200:203]
 v_add_f32 v109, v109, v9
 v_mfma_f32_16x16x32_bf16 v[200:203], a[212:215], a[132:135], v[200:203]
 global_load_dwordx4 a[204:207], v0, s[70:71] offset:3072
 v_add_f32 v110, v110, v10
 v_mfma_f32_16x16x32_bf16 v[204:207], a[212:215], a[140:143], v[204:207]
 v_add_f32 v111, v111, v11
 v_mfma_f32_16x16x32_bf16 v[204:207], a[208:211], a[136:139], v[204:207]
 global_load_dwordx4 a[200:203], v0, s[70:71] offset:2048
 v_mfma_f32_16x16x32_bf16 v[208:211], a[208:211], a[144:147], v[208:211]
 s_add_u32 s70, s70, 8192
 s_addc_u32 s71, s71, 0
 v_mfma_f32_16x16x32_bf16 v[208:211], a[212:215], a[148:151], v[208:211]
 v_add_f32 v112, v112, v12
 v_mfma_f32_16x16x32_bf16 v[212:215], a[212:215], a[156:159], v[212:215]
 v_mfma_f32_16x16x32_bf16 v[212:215], a[208:211], a[152:155], v[212:215]
 v_add_f32 v113, v113, v13
 v_mfma_f32_16x16x32_bf16 v[216:219], a[208:211], a[160:163], v[216:219]
 v_add_f32 v114, v114, v14
 v_mfma_f32_16x16x32_bf16 v[216:219], a[212:215], a[164:167], v[216:219]
 v_mfma_f32_16x16x32_bf16 v[220:223], a[212:215], a[172:175], v[220:223]
 v_add_f32 v115, v115, v15
 v_mfma_f32_16x16x32_bf16 v[220:223], a[208:211], a[168:171], v[220:223]
 v_add_f32 v116, v116, v12
 v_mfma_f32_16x16x32_bf16 v[224:227], a[208:211], a[176:179], v[224:227]
 v_add_f32 v117, v117, v13
 v_mfma_f32_16x16x32_bf16 v[224:227], a[212:215], a[180:183], v[224:227]
 v_mfma_f32_16x16x32_bf16 v[228:231], a[212:215], a[188:191], v[228:231]
 v_add_f32 v118, v118, v14
 v_mfma_f32_16x16x32_bf16 v[228:231], a[208:211], a[184:187], v[228:231]
 v_add_f32 v119, v119, v15
 s_waitcnt vmcnt(9)
 v_mfma_f32_16x16x32_bf16 a[252:255], a[216:219], a[184:187], a[252:255]
 ds_read_b128 a[184:187], v2 offset:61440
 v_add_f32 v120, v120, v12
 v_mfma_f32_16x16x32_bf16 a[252:255], a[220:223], a[188:191], a[252:255]
 global_load_dwordx4 a[212:215], v0, s[70:71] offset:-3072
 ds_read_b128 a[188:191], v2 offset:62464
 v_mfma_f32_16x16x32_bf16 a[248:251], a[220:223], a[180:183], a[248:251]
 ds_read_b128 a[180:183], v2 offset:58368
 v_add_f32 v121, v121, v13
 v_mfma_f32_16x16x32_bf16 a[248:251], a[216:219], a[176:179], a[248:251]
 global_load_dwordx4 a[208:211], v0, s[70:71] offset:-4096
 ds_read_b128 a[176:179], v2 offset:57344
 v_mfma_f32_16x16x32_bf16 v[252:255], a[216:219], a[168:171], v[252:255]
 ds_read_b128 a[168:171], v2 offset:53248
 v_add_f32 v122, v122, v14
 v_mfma_f32_16x16x32_bf16 v[252:255], a[220:223], a[172:175], v[252:255]
 ds_read_b128 a[172:175], v2 offset:54272
 v_add_f32 v123, v123, v15
 v_mfma_f32_16x16x32_bf16 v[248:251], a[220:223], a[164:167], v[248:251]
 ds_read_b128 a[164:167], v2 offset:50176
 v_mfma_f32_16x16x32_bf16 v[248:251], a[216:219], a[160:163], v[248:251]
 ds_read_b128 a[160:163], v2 offset:49152
 v_add_f32 v124, v124, v12
 v_mfma_f32_16x16x32_bf16 v[244:247], a[216:219], a[152:155], v[244:247]
 ds_read_b128 a[152:155], v2 offset:45056
 v_add_f32 v125, v125, v13
 v_mfma_f32_16x16x32_bf16 v[244:247], a[220:223], a[156:159], v[244:247]
 ds_read_b128 a[156:159], v2 offset:46080
 v_add_f32 v126, v126, v14
 v_mfma_f32_16x16x32_bf16 v[240:243], a[220:223], a[148:151], v[240:243]
 ds_read_b128 a[148:151], v2 offset:41984
 v_mfma_f32_16x16x32_bf16 v[240:243], a[216:219], a[144:147], v[240:243]
 ds_read_b128 a[144:147], v2 offset:40960
 v_add_f32 v127, v127, v15
 v_mfma_f32_16x16x32_bf16 v[236:239], a[216:219], a[136:139], v[236:239]
 ds_read_b128 a[136:139], v2 offset:36864
 v_add_f32 v128, v128, v12
 v_mfma_f32_16x16x32_bf16 v[236:239], a[220:223], a[140:143], v[236:239]
 ds_read_b128 a[140:143], v2 offset:37888
 v_mfma_f32_16x16x32_bf16 v[232:235], a[220:223], a[132:135], v[232:235]
 ds_read_b128 a[132:135], v2 offset:33792
 v_add_f32 v129, v129, v13
 v_mfma_f32_16x16x32_bf16 v[232:235], a[216:219], a[128:131], v[232:235]
 ds_read_b128 a[128:131], v2 offset:32768
 v_add_f32 v130, v130, v14
 s_waitcnt vmcnt(9) lgkmcnt(8)
 v_mfma_f32_16x16x32_bf16 v[164:167], a[224:227], a[184:187], v[164:167]
 v_mfma_f32_16x16x32_bf16 v[164:167], a[228:231], a[188:191], v[164:167]
 global_load_dwordx4 a[220:223], v0, s[70:71] offset:-1024
 v_add_f32 v131, v131, v15
 v_mfma_f32_16x16x32_bf16 v[160:163], a[228:231], a[180:183], v[160:163]
 v_add_f32 v132, v132, v12
 v_mfma_f32_16x16x32_bf16 v[160:163], a[224:227], a[176:179], v[160:163]
 global_load_dwordx4 a[216:219], v0, s[70:71] offset:-2048
 v_add_f32 v133, v133, v13
 v_mfma_f32_16x16x32_bf16 v[156:159], a[224:227], a[168:171], v[156:159]
 v_mfma_f32_16x16x32_bf16 v[156:159], a[228:231], a[172:175], v[156:159]
 v_add_f32 v134, v134, v14
 v_mfma_f32_16x16x32_bf16 v[152:155], a[228:231], a[164:167], v[152:155]
 v_add_f32 v135, v135, v15
 v_mfma_f32_16x16x32_bf16 v[152:155], a[224:227], a[160:163], v[152:155]
 s_waitcnt lgkmcnt(0)
 v_mfma_f32_16x16x32_bf16 v[148:151], a[224:227], a[152:155], v[148:151]
 v_accvgpr_read_b32 v5, a240
 v_mfma_f32_16x16x32_bf16 v[148:151], a[228:231], a[156:159], v[148:151]
 v_add_f32 v5, v5, v12
 v_mfma_f32_16x16x32_bf16 v[144:147], a[228:231], a[148:151], v[144:147]
 v_mfma_f32_16x16x32_bf16 v[144:147], a[224:227], a[144:147], v[144:147]
 v_accvgpr_write_b32 a240, v5
 v_mfma_f32_16x16x32_bf16 v[140:143], a[224:227], a[136:139], v[140:143]
 v_accvgpr_read_b32 v6, a241
 v_mfma_f32_16x16x32_bf16 v[140:143], a[228:231], a[140:143], v[140:143]
 v_mfma_f32_16x16x32_bf16 v[136:139], a[228:231], a[132:135], v[136:139]
 v_add_f32 v6, v6, v13
 v_mfma_f32_16x16x32_bf16 v[136:139], a[224:227], a[128:131], v[136:139]
 v_accvgpr_write_b32 a241, v6
 s_waitcnt vmcnt(9)
 v_mfma_f32_16x16x32_bf16 v[168:171], a[232:235], a[128:131], v[168:171]
 v_accvgpr_read_b32 v5, a242
 v_mfma_f32_16x16x32_bf16 v[168:171], a[236:239], a[132:135], v[168:171]
 global_load_dwordx4 a[228:231], v0, s[70:71] offset:1024
 v_mfma_f32_16x16x32_bf16 v[172:175], a[236:239], a[140:143], v[172:175]
 v_add_f32 v5, v5, v14
 v_mfma_f32_16x16x32_bf16 v[172:175], a[232:235], a[136:139], v[172:175]
 global_load_dwordx4 a[224:227], v0, s[70:71] offset:0
 v_accvgpr_write_b32 a242, v5
 v_mfma_f32_16x16x32_bf16 v[176:179], a[232:235], a[144:147], v[176:179]
 v_mfma_f32_16x16x32_bf16 v[176:179], a[236:239], a[148:151], v[176:179]
 v_accvgpr_read_b32 v6, a243
 v_mfma_f32_16x16x32_bf16 v[180:183], a[236:239], a[156:159], v[180:183]
 v_add_f32 v6, v6, v15
 v_mfma_f32_16x16x32_bf16 v[180:183], a[232:235], a[152:155], v[180:183]
 v_mfma_f32_16x16x32_bf16 v[184:187], a[232:235], a[160:163], v[184:187]
 v_accvgpr_write_b32 a243, v6
 v_mfma_f32_16x16x32_bf16 v[184:187], a[236:239], a[164:167], v[184:187]
 v_accvgpr_read_b32 v5, a244
 v_mfma_f32_16x16x32_bf16 v[188:191], a[236:239], a[172:175], v[188:191]
 v_add_f32 v5, v5, v12
 v_mfma_f32_16x16x32_bf16 v[188:191], a[232:235], a[168:171], v[188:191]
 v_mfma_f32_16x16x32_bf16 v[192:195], a[232:235], a[176:179], v[192:195]
 v_accvgpr_write_b32 a244, v5
 v_mfma_f32_16x16x32_bf16 v[192:195], a[236:239], a[180:183], v[192:195]
 v_accvgpr_read_b32 v6, a245
 v_mfma_f32_16x16x32_bf16 v[196:199], a[236:239], a[188:191], v[196:199]
 v_mfma_f32_16x16x32_bf16 v[196:199], a[232:235], a[184:187], v[196:199]
 v_add_f32 v6, v6, v13
 s_waitcnt vmcnt(8)
 v_mfma_f32_16x16x32_bf16 v[228:231], a[192:195], a[184:187], v[228:231]
 v_accvgpr_write_b32 a245, v6
 v_mfma_f32_16x16x32_bf16 v[228:231], a[196:199], a[188:191], v[228:231]
 global_load_dwordx4 a[236:239], v0, s[70:71] offset:3072
 v_mfma_f32_16x16x32_bf16 v[224:227], a[196:199], a[180:183], v[224:227]
 v_accvgpr_read_b32 v5, a246
 v_mfma_f32_16x16x32_bf16 v[224:227], a[192:195], a[176:179], v[224:227]
 global_load_dwordx4 a[232:235], v0, s[70:71] offset:2048
 v_add_f32 v5, v5, v14
 v_mfma_f32_16x16x32_bf16 v[220:223], a[192:195], a[168:171], v[220:223]
 v_accvgpr_write_b32 a246, v5
 s_add_u32 s70, s70, 8192
 s_addc_u32 s71, s71, 0
 v_mfma_f32_16x16x32_bf16 v[220:223], a[196:199], a[172:175], v[220:223]
 v_mfma_f32_16x16x32_bf16 v[216:219], a[196:199], a[164:167], v[216:219]
 v_accvgpr_read_b32 v6, a247
 v_mfma_f32_16x16x32_bf16 v[216:219], a[192:195], a[160:163], v[216:219]
 v_add_f32 v6, v6, v15
 v_mfma_f32_16x16x32_bf16 v[212:215], a[192:195], a[152:155], v[212:215]
 v_mfma_f32_16x16x32_bf16 v[212:215], a[196:199], a[156:159], v[212:215]
 v_accvgpr_write_b32 a247, v6
 v_mfma_f32_16x16x32_bf16 v[208:211], a[196:199], a[148:151], v[208:211]
 v_cmp_gt_u32 vcc, s55, v4
 s_cbranch_vccnz Lspin_pa
Lok_pa:
 s_add_u32 s55, s55, 1
 s_waitcnt lgkmcnt(0)
 s_barrier
 v_mfma_f32_16x16x32_bf16 v[208:211], a[192:195], a[144:147], v[208:211]
 v_mfma_f32_16x16x32_bf16 v[204:207], a[192:195], a[136:139], v[204:207]
 v_mfma_f32_16x16x32_bf16 v[204:207], a[196:199], a[140:143], v[204:207]
 v_mfma_f32_16x16x32_bf16 v[200:203], a[196:199], a[132:135], v[200:203]
 v_mfma_f32_16x16x32_bf16 v[200:203], a[192:195], a[128:131], v[200:203]
 s_waitcnt vmcnt(8)
 v_mfma_f32_16x16x32_bf16 v[232:235], a[200:203], a[128:131], v[232:235]
 ds_read_b128 a[128:131], v1 offset:2048
 v_mfma_f32_16x16x32_bf16 v[232:235], a[204:207], a[132:135], v[232:235]
 global_load_dwordx4 a[196:199], v0, s[70:71] offset:-3072
 ds_read_b128 a[132:135], v1 offset:3072
 v_mfma_f32_16x16x32_bf16 v[236:239], a[204:207], a[140:143], v[236:239]
 ds_read_b128 a[140:143], v1 offset:7168
 v_mfma_f32_16x16x32_bf16 v[236:239], a[200:203], a[136:139], v[236:239]
 global_load_dwordx4 a[192:195], v0, s[70:71] offset:-4096
 ds_read_b128 a[136:139], v1 offset:6144
 v_mfma_f32_16x16x32_bf16 v[240:243], a[200:203], a[144:147], v[240:243]
 ds_read_b128 a[144:147], v1 offset:10240
 v_mfma_f32_16x16x32_bf16 v[240:243], a[204:207], a[148:151], v[240:243]
 ds_read_b128 a[148:151], v1 offset:11264
 v_mfma_f32_16x16x32_bf16 v[244:247], a[204:207], a[156:159], v[244:247]
 ds_read_b128 a[156:159], v1 offset:15360
 v_mfma_f32_16x16x32_bf16 v[244:247], a[200:203], a[152:155], v[244:247]
 ds_read_b128 a[152:155], v1 offset:14336
 v_mfma_f32_16x16x32_bf16 v[248:251], a[200:203], a[160:163], v[248:251]
 ds_read_b128 a[160:163], v1 offset:18432
 v_mfma_f32_16x16x32_bf16 v[248:251], a[204:207], a[164:167], v[248:251]
 ds_read_b128 a[164:167], v1 offset:19456
 v_mfma_f32_16x16x32_bf16 v[252:255], a[204:207], a[172:175], v[252:255]
 ds_read_b128 a[172:175], v1 offset:23552
 v_mfma_f32_16x16x32_bf16 v[252:255], a[200:203], a[168:171], v[252:255]
 ds_read_b128 a[168:171], v1 offset:22528
 v_mfma_f32_16x16x32_bf16 a[248:251], a[200:203], a[176:179], a[248:251]
 ds_read_b128 a[176:179], v1 offset:26624
 v_mfma_f32_16x16x32_bf16 a[248:251], a[204:207], a[180:183], a[248:251]
 ds_read_b128 a[180:183], v1 offset:27648
 v_mfma_f32_16x16x32_bf16 a[252:255], a[204:207], a[188:191], a[252:255]
 global_load_dwordx4 a[204:207], v0, s[70:71] offset:-1024
 ds_read_b128 a[188:191], v1 offset:31744
 v_mfma_f32_16x16x32_bf16 a[252:255], a[200:203], a[184:187], a[252:255]
 global_load_dwordx4 a[200:203], v0, s[70:71] offset:-2048
 ds_read_b128 a[184:187], v1 offset:30720
 s_waitcnt vmcnt(10) lgkmcnt(8)
 s_branch Lloop
Llast:
 v_mfma_f32_16x16x32_bf16 v[136:139], a[208:211], a[128:131], v[136:139]
 v_accvgpr_read_b32 v5, a0
 v_lshlrev_b32 v6, 16, v5
 v_mfma_f32_16x16x32_bf16 v[136:139], a[212:215], a[132:135], v[136:139]
 v_and_b32 v5, s26, v5
 v_mul_f32 v6, v6, v16
 v_mfma_f32_16x16x32_bf16 v[140:143], a[212:215], a[140:143], v[140:143]
 v_mul_f32 v5, v5, v17
 v_cvt_pk_bf16_f32 v8, v6, v5
 v_mfma_f32_16x16x32_bf16 v[140:143], a[208:211], a[136:139], v[140:143]
 v_accvgpr_read_b32 v5, a1
 v_lshlrev_b32 v6, 16, v5
 v_mfma_f32_16x16x32_bf16 v[144:147], a[208:211], a[144:147], v[144:147]
 v_and_b32 v5, s26, v5
 v_mul_f32 v6, v6, v18
 v_mfma_f32_16x16x32_bf16 v[144:147], a[212:215], a[148:151], v[144:147]
 v_mul_f32 v5, v5, v19
 v_cvt_pk_bf16_f32 v9, v6, v5
 v_mfma_f32_16x16x32_bf16 v[148:151], a[212:215], a[156:159], v[148:151]
 v_accvgpr_read_b32 v5, a2
 v_lshlrev_b32 v6, 16, v5
 v_mfma_f32_16x16x32_bf16 v[148:151], a[208:211], a[152:155], v[148:151]
 v_and_b32 v5, s26, v5
 v_mul_f32 v6, v6, v48
 s_waitcnt lgkmcnt(0)
 v_mfma_f32_16x16x32_bf16 v[152:155], a[208:211], a[160:163], v[152:155]
 v_mul_f32 v5, v5, v49
 v_cvt_pk_bf16_f32 v10, v6, v5
 v_mfma_f32_16x16x32_bf16 v[152:155], a[212:215], a[164:167], v[152:155]
 v_accvgpr_read_b32 v5, a3
 v_lshlrev_b32 v6, 16, v5
 v_mfma_f32_16x16x32_bf16 v[156:159], a[212:215], a[172:175], v[156:159]
 v_and_b32 v5, s26, v5
 v_mul_f32 v6, v6, v50
 v_mfma_f32_16x16x32_bf16 v[156:159], a[208:211], a[168:171], v[156:159]
 v_mul_f32 v5, v5, v51
 v_cvt_pk_bf16_f32 v11, v6, v5
 v_mfma_f32_16x16x32_bf16 v[160:163], a[208:211], a[176:179], v[160:163]
 v_lshrrev_b32 v5, 7, v1
 v_lshlrev_b32 v6, 4, v5
 v_mfma_f32_16x16x32_bf16 v[160:163], a[212:215], a[180:183], v[160:163]
 v_xor_b32 v6, v6, v1
 v_and_b32 v6, 112, v6
 v_mfma_f32_16x16x32_bf16 v[164:167], a[212:215], a[188:191], v[164:167]
 v_lshl_add_u32 v16, v5, 11, v6
 v_lshrrev_b32 v5, 4, v1
 v_mfma_f32_16x16x32_bf16 v[164:167], a[208:211], a[184:187], v[164:167]
 v_and_b32 v5, 48, v5
 v_xor_b32 v5, v5, v1
 s_waitcnt vmcnt(8)
 v_mfma_f32_16x16x32_bf16 v[196:199], a[216:219], a[184:187], v[196:199]
 v_and_b32 v5, 112, v5
 v_and_b32 v6, 240, v1
 v_mfma_f32_16x16x32_bf16 v[196:199], a[220:223], a[188:191], v[196:199]
 global_load_dwordx4 a[212:215], v0, s[70:71] offset:1024
 v_lshl_add_u32 v5, v6, 3, v5
 v_mfma_f32_16x16x32_bf16 v[192:195], a[220:223], a[180:183], v[192:195]
 v_add_u32 v17, s50, v5
 v_xor_b32 v18, 64, v17
 v_mfma_f32_16x16x32_bf16 v[192:195], a[216:219], a[176:179], v[192:195]
 global_load_dwordx4 a[208:211], v0, s[70:71] offset:0
 ds_write_b128 v17, v[8:11]
 v_mfma_f32_16x16x32_bf16 v[188:191], a[216:219], a[168:171], v[188:191]
 v_accvgpr_read_b32 v5, a32
 v_lshlrev_b32 v6, 16, v5
 v_mfma_f32_16x16x32_bf16 v[188:191], a[220:223], a[172:175], v[188:191]
 v_and_b32 v5, s26, v5
 v_mul_f32 v6, v6, v80
 v_mfma_f32_16x16x32_bf16 v[184:187], a[220:223], a[164:167], v[184:187]
 v_mul_f32 v5, v5, v81
 v_cvt_pk_bf16_f32 v12, v6, v5
 v_mfma_f32_16x16x32_bf16 v[184:187], a[216:219], a[160:163], v[184:187]
 v_accvgpr_read_b32 v5, a33
 v_lshlrev_b32 v6, 16, v5
 v_mfma_f32_16x16x32_bf16 v[180:183], a[216:219], a[152:155], v[180:183]
 v_and_b32 v5, s26, v5
 v_mul_f32 v6, v6, v82
 v_mfma_f32_16x16x32_bf16 v[180:183], a[220:223], a[156:159], v[180:183]
 v_mul_f32 v5, v5, v83
 v_cvt_pk_bf16_f32 v13, v6, v5
 v_mfma_f32_16x16x32_bf16 v[176:179], a[220:223], a[148:151], v[176:179]
 v_accvgpr_read_b32 v5, a34
 v_lshlrev_b32 v6, 16, v5
 v_mfma_f32_16x16x32_bf16 v[176:179], a[216:219], a[144:147], v[176:179]
 v_and_b32 v5, s26, v5
 v_mul_f32 v6, v6, v112
 v_mfma_f32_16x16x32_bf16 v[172:175], a[216:219], a[136:139], v[172:175]
 v_mul_f32 v5, v5, v113
 v_cvt_pk_bf16_f32 v14, v6, v5
 v_mfma_f32_16x16x32_bf16 v[172:175], a[220:223], a[140:143], v[172:175]
 v_accvgpr_read_b32 v5, a35
 v_lshlrev_b32 v6, 16, v5
 v_mfma_f32_16x16x32_bf16 v[168:171], a[220:223], a[132:135], v[168:171]
 v_and_b32 v5, s26, v5
 v_mul_f32 v6, v6, v114
 v_mfma_f32_16x16x32_bf16 v[168:171], a[216:219], a[128:131], v[168:171]
 v_mul_f32 v5, v5, v115
 v_cvt_pk_bf16_f32 v15, v6, v5
 s_waitcnt vmcnt(8)
 v_mfma_f32_16x16x32_bf16 v[200:203], a[224:227], a[128:131], v[200:203]
 ds_write_b128 v18, v[12:15]
 v_mfma_f32_16x16x32_bf16 v[200:203], a[228:231], a[132:135], v[200:203]
 global_load_dwordx4 a[220:223], v0, s[70:71] offset:3072
 ds_read_b128 v[48:51], v3
 v_mfma_f32_16x16x32_bf16 v[204:207], a[228:231], a[140:143], v[204:207]
 ds_read_b128 v[80:83], v3 offset:1024
 v_accvgpr_read_b32 v5, a4
 v_mfma_f32_16x16x32_bf16 v[204:207], a[224:227], a[136:139], v[204:207]
 global_load_dwordx4 a[216:219], v0, s[70:71] offset:2048
 v_lshlrev_b32 v6, 16, v5
 v_mfma_f32_16x16x32_bf16 v[208:211], a[224:227], a[144:147], v[208:211]
 v_and_b32 v5, s26, v5
 v_mul_f32 v6, v6, v20
 s_add_u32 s70, s70, 8192
 s_addc_u32 s71, s71, 0
 v_mfma_f32_16x16x32_bf16 v[208:211], a[228:231], a[148:151], v[208:211]
 v_mul_f32 v5, v5, v21
 v_cvt_pk_bf16_f32 v8, v6, v5
 v_mfma_f32_16x16x32_bf16 v[212:215], a[228:231], a[156:159], v[212:215]
 v_accvgpr_read_b32 v5, a5
 v_lshlrev_b32 v6, 16, v5
 v_mfma_f32_16x16x32_bf16 v[212:215], a[224:227], a[152:155], v[212:215]
 v_and_b32 v5, s26, v5
 v_mul_f32 v6, v6, v22
 v_mfma_f32_16x16x32_bf16 v[216:219], a[224:227], a[160:163], v[216:219]
 v_mul_f32 v5, v5, v23
 v_cvt_pk_bf16_f32 v9, v6, v5
 s_waitcnt lgkmcnt(1)
 s_add_u32 s3, s28, 0
 v_mfma_f32_16x16x32_bf16 v[216:219], a[228:231], a[164:167], v[216:219]
 buffer_store_dwordx4 v[48:51], v16, s[16:19], s3 offen nt
 s_waitcnt lgkmcnt(0)
 s_add_u32 s3, s28, 16384
 buffer_store_dwordx4 v[80:83], v16, s[16:19], s3 offen nt
 v_accvgpr_read_b32 v5, a6
 v_lshlrev_b32 v6, 16, v5
 v_and_b32 v5, s26, v5
 v_mul_f32 v6, v6, v52
 v_mfma_f32_16x16x32_bf16 v[220:223], a[228:231], a[172:175], v[220:223]
 v_mul_f32 v5, v5, v53
 v_cvt_pk_bf16_f32 v10, v6, v5
 v_mfma_f32_16x16x32_bf16 v[220:223], a[224:227], a[168:171], v[220:223]
 v_accvgpr_read_b32 v5, a7
 v_lshlrev_b32 v6, 16, v5
 v_mfma_f32_16x16x32_bf16 v[224:227], a[224:227], a[176:179], v[224:227]
 v_and_b32 v5, s26, v5
 v_mul_f32 v6, v6, v54
 v_mul_f32 v5, v5, v55
 v_cvt_pk_bf16_f32 v11, v6, v5
 v_mfma_f32_16x16x32_bf16 v[224:227], a[228:231], a[180:183], v[224:227]
 ds_write_b128 v17, v[8:11] offset:4096
 v_mfma_f32_16x16x32_bf16 v[228:231], a[228:231], a[188:191], v[228:231]
 v_accvgpr_read_b32 v5, a36
 v_lshlrev_b32 v6, 16, v5
 v_mfma_f32_16x16x32_bf16 v[228:231], a[224:227], a[184:187], v[228:231]
 v_and_b32 v5, s26, v5
 v_mul_f32 v6, v6, v84
 s_waitcnt vmcnt(10)
 v_mfma_f32_16x16x32_bf16 a[252:255], a[232:235], a[184:187], a[252:255]
 ds_read_b128 a[184:187], v1 offset:63488
 v_mul_f32 v5, v5, v85
 v_mfma_f32_16x16x32_bf16 a[252:255], a[236:239], a[188:191], a[252:255]
 global_load_dwordx4 a[228:231], v0, s[70:71] offset:-3072
 ds_read_b128 a[188:191], v1 offset:64512
 v_mfma_f32_16x16x32_bf16 a[248:251], a[236:239], a[180:183], a[248:251]
 ds_read_b128 a[180:183], v1 offset:60416
 v_cvt_pk_bf16_f32 v12, v6, v5
 v_mfma_f32_16x16x32_bf16 a[248:251], a[232:235], a[176:179], a[248:251]
 global_load_dwordx4 a[224:227], v0, s[70:71] offset:-4096
 ds_read_b128 a[176:179], v1 offset:59392
 v_mfma_f32_16x16x32_bf16 v[252:255], a[232:235], a[168:171], v[252:255]
 ds_read_b128 a[168:171], v1 offset:55296
 v_accvgpr_read_b32 v5, a37
 v_mfma_f32_16x16x32_bf16 v[252:255], a[236:239], a[172:175], v[252:255]
 ds_read_b128 a[172:175], v1 offset:56320
 v_lshlrev_b32 v6, 16, v5
 v_mfma_f32_16x16x32_bf16 v[248:251], a[236:239], a[164:167], v[248:251]
 ds_read_b128 a[164:167], v1 offset:52224
 v_and_b32 v5, s26, v5
 v_mfma_f32_16x16x32_bf16 v[248:251], a[232:235], a[160:163], v[248:251]
 ds_read_b128 a[160:163], v1 offset:51200
 v_mul_f32 v6, v6, v86
 v_mul_f32 v5, v5, v87
 v_mfma_f32_16x16x32_bf16 v[244:247], a[232:235], a[152:155], v[244:247]
 ds_read_b128 a[152:155], v1 offset:47104
 v_cvt_pk_bf16_f32 v13, v6, v5
 v_mfma_f32_16x16x32_bf16 v[244:247], a[236:239], a[156:159], v[244:247]
 ds_read_b128 a[156:159], v1 offset:48128
 v_accvgpr_read_b32 v5, a38
 v_lshlrev_b32 v6, 16, v5
 v_mfma_f32_16x16x32_bf16 v[240:243], a[236:239], a[148:151], v[240:243]
 ds_read_b128 a[148:151], v1 offset:44032
 v_and_b32 v5, s26, v5
 v_mul_f32 v6, v6, v116
 v_mfma_f32_16x16x32_bf16 v[240:243], a[232:235], a[144:147], v[240:243]
 ds_read_b128 a[144:147], v1 offset:43008
 v_mul_f32 v5, v5, v117
 v_mfma_f32_16x16x32_bf16 v[236:239], a[232:235], a[136:139], v[236:239]
 ds_read_b128 a[136:139], v1 offset:38912
 v_cvt_pk_bf16_f32 v14, v6, v5
 v_mfma_f32_16x16x32_bf16 v[236:239], a[236:239], a[140:143], v[236:239]
 ds_read_b128 a[140:143], v1 offset:39936
 v_accvgpr_read_b32 v5, a39
 v_mfma_f32_16x16x32_bf16 v[232:235], a[236:239], a[132:135], v[232:235]
 ds_read_b128 a[132:135], v1 offset:35840
 v_lshlrev_b32 v6, 16, v5
 v_mfma_f32_16x16x32_bf16 v[232:235], a[232:235], a[128:131], v[232:235]
 ds_read_b128 a[128:131], v1 offset:34816
 v_and_b32 v5, s26, v5
 s_waitcnt vmcnt(10) lgkmcnt(8)
 v_mfma_f32_16x16x32_bf16 v[164:167], a[192:195], a[184:187], v[164:167]
 v_mul_f32 v6, v6, v118
 v_mul_f32 v5, v5, v119
 v_mfma_f32_16x16x32_bf16 v[164:167], a[196:199], a[188:191], v[164:167]
 global_load_dwordx4 a[236:239], v0, s[70:71] offset:-1024
 v_cvt_pk_bf16_f32 v15, v6, v5
 v_mfma_f32_16x16x32_bf16 v[160:163], a[196:199], a[180:183], v[160:163]
 ds_write_b128 v18, v[12:15] offset:4096
 ds_read_b128 v[48:51], v3 offset:4096
 v_mfma_f32_16x16x32_bf16 v[160:163], a[192:195], a[176:179], v[160:163]
 global_load_dwordx4 a[232:235], v0, s[70:71] offset:-2048
 ds_read_b128 v[80:83], v3 offset:5120
 v_mfma_f32_16x16x32_bf16 v[156:159], a[192:195], a[168:171], v[156:159]
 v_accvgpr_read_b32 v5, a8
 v_lshlrev_b32 v6, 16, v5
 v_mfma_f32_16x16x32_bf16 v[156:159], a[196:199], a[172:175], v[156:159]
 v_and_b32 v5, s26, v5
 v_mul_f32 v6, v6, v24
 v_mfma_f32_16x16x32_bf16 v[152:155], a[196:199], a[164:167], v[152:155]
 v_mul_f32 v5, v5, v25
 v_cvt_pk_bf16_f32 v8, v6, v5
 v_mfma_f32_16x16x32_bf16 v[152:155], a[192:195], a[160:163], v[152:155]
 v_accvgpr_read_b32 v5, a9
 v_lshlrev_b32 v6, 16, v5
 s_waitcnt lgkmcnt(3)
 v_mfma_f32_16x16x32_bf16 v[148:151], a[192:195], a[152:155], v[148:151]
 v_and_b32 v5, s26, v5
 v_mul_f32 v6, v6, v26
 v_mfma_f32_16x16x32_bf16 v[148:151], a[196:199], a[156:159], v[148:151]
 v_mul_f32 v5, v5, v27
 v_cvt_pk_bf16_f32 v9, v6, v5
 s_waitcnt lgkmcnt(1)
 s_add_u32 s3, s28, 32768
 v_mfma_f32_16x16x32_bf16 v[144:147], a[196:199], a[148:151], v[144:147]
 buffer_store_dwordx4 v[48:51], v16, s[16:19], s3 offen nt
 s_waitcnt lgkmcnt(0)
 s_add_u32 s3, s28, 49152
 buffer_store_dwordx4 v[80:83], v16, s[16:19], s3 offen nt
 v_accvgpr_read_b32 v5, a10
 v_lshlrev_b32 v6, 16, v5
 v_and_b32 v5, s26, v5
 v_mul_f32 v6, v6, v56
 v_mfma_f32_16x16x32_bf16 v[144:147], a[192:195], a[144:147], v[144:147]
 v_mul_f32 v5, v5, v57
 v_cvt_pk_bf16_f32 v10, v6, v5
 v_mfma_f32_16x16x32_bf16 v[140:143], a[192:195], a[136:139], v[140:143]
 v_accvgpr_read_b32 v5, a11
 v_lshlrev_b32 v6, 16, v5
 v_mfma_f32_16x16x32_bf16 v[140:143], a[196:199], a[140:143], v[140:143]
 v_and_b32 v5, s26, v5
 v_mul_f32 v6, v6, v58
 v_mfma_f32_16x16x32_bf16 v[136:139], a[196:199], a[132:135], v[136:139]
 v_mul_f32 v5, v5, v59
 v_cvt_pk_bf16_f32 v11, v6, v5
 v_mfma_f32_16x16x32_bf16 v[136:139], a[192:195], a[128:131], v[136:139]
 ds_write_b128 v17, v[8:11] offset:8192
 s_waitcnt vmcnt(12)
 v_mfma_f32_16x16x32_bf16 v[168:171], a[200:203], a[128:131], v[168:171]
 v_accvgpr_read_b32 v5, a40
 v_lshlrev_b32 v6, 16, v5
 v_mfma_f32_16x16x32_bf16 v[168:171], a[204:207], a[132:135], v[168:171]
 global_load_dwordx4 a[196:199], v0, s[70:71] offset:1024
 v_and_b32 v5, s26, v5
 v_mfma_f32_16x16x32_bf16 v[172:175], a[204:207], a[140:143], v[172:175]
 v_mul_f32 v6, v6, v88
 v_mul_f32 v5, v5, v89
 v_mfma_f32_16x16x32_bf16 v[172:175], a[200:203], a[136:139], v[172:175]
 global_load_dwordx4 a[192:195], v0, s[70:71] offset:0
 v_cvt_pk_bf16_f32 v12, v6, v5
 v_mfma_f32_16x16x32_bf16 v[176:179], a[200:203], a[144:147], v[176:179]
 v_accvgpr_read_b32 v5, a41
 v_lshlrev_b32 v6, 16, v5
 v_mfma_f32_16x16x32_bf16 v[176:179], a[204:207], a[148:151], v[176:179]
 v_and_b32 v5, s26, v5
 v_mul_f32 v6, v6, v90
 v_mfma_f32_16x16x32_bf16 v[180:183], a[204:207], a[156:159], v[180:183]
 v_mul_f32 v5, v5, v91
 v_cvt_pk_bf16_f32 v13, v6, v5
 v_mfma_f32_16x16x32_bf16 v[180:183], a[200:203], a[152:155], v[180:183]
 v_accvgpr_read_b32 v5, a42
 v_lshlrev_b32 v6, 16, v5
 v_mfma_f32_16x16x32_bf16 v[184:187], a[200:203], a[160:163], v[184:187]
 v_and_b32 v5, s26, v5
 v_mul_f32 v6, v6, v120
 v_mfma_f32_16x16x32_bf16 v[184:187], a[204:207], a[164:167], v[184:187]
 v_mul_f32 v5, v5, v121
 v_cvt_pk_bf16_f32 v14, v6, v5
 v_mfma_f32_16x16x32_bf16 v[188:191], a[204:207], a[172:175], v[188:191]
 v_accvgpr_read_b32 v5, a43
 v_lshlrev_b32 v6, 16, v5
 v_mfma_f32_16x16x32_bf16 v[188:191], a[200:203], a[168:171], v[188:191]
 v_and_b32 v5, s26, v5
 v_mul_f32 v6, v6, v122
 v_mfma_f32_16x16x32_bf16 v[192:195], a[200:203], a[176:179], v[192:195]
 v_mul_f32 v5, v5, v123
 v_cvt_pk_bf16_f32 v15, v6, v5
 v_mfma_f32_16x16x32_bf16 v[192:195], a[204:207], a[180:183], v[192:195]
 ds_write_b128 v18, v[12:15] offset:8192
 v_mfma_f32_16x16x32_bf16 v[196:199], a[204:207], a[188:191], v[196:199]
 ds_read_b128 v[48:51], v3 offset:8192
 ds_read_b128 v[80:83], v3 offset:9216
 v_mfma_f32_16x16x32_bf16 v[196:199], a[200:203], a[184:187], v[196:199]
 v_accvgpr_read_b32 v5, a12
 v_lshlrev_b32 v6, 16, v5
 s_waitcnt vmcnt(12)
 v_mfma_f32_16x16x32_bf16 v[228:231], a[208:211], a[184:187], v[228:231]
 v_and_b32 v5, s26, v5
 v_mul_f32 v6, v6, v28
 v_mfma_f32_16x16x32_bf16 v[228:231], a[212:215], a[188:191], v[228:231]
 global_load_dwordx4 a[204:207], v0, s[70:71] offset:3072
 v_mul_f32 v5, v5, v29
 v_mfma_f32_16x16x32_bf16 v[224:227], a[212:215], a[180:183], v[224:227]
 v_cvt_pk_bf16_f32 v8, v6, v5
 v_accvgpr_read_b32 v5, a13
 v_mfma_f32_16x16x32_bf16 v[224:227], a[208:211], a[176:179], v[224:227]
 global_load_dwordx4 a[200:203], v0, s[70:71] offset:2048
 v_lshlrev_b32 v6, 16, v5
 v_mfma_f32_16x16x32_bf16 v[220:223], a[208:211], a[168:171], v[220:223]
 v_and_b32 v5, s26, v5
 v_mul_f32 v6, v6, v30
 s_add_u32 s70, s70, 8192
 s_addc_u32 s71, s71, 0
 v_mfma_f32_16x16x32_bf16 v[220:223], a[212:215], a[172:175], v[220:223]
 v_mul_f32 v5, v5, v31
 v_cvt_pk_bf16_f32 v9, v6, v5
 s_waitcnt lgkmcnt(1)
 v_mfma_f32_16x16x32_bf16 v[216:219], a[212:215], a[164:167], v[216:219]
 s_add_u32 s3, s28, 65536
 buffer_store_dwordx4 v[48:51], v16, s[16:19], s3 offen nt
 s_waitcnt lgkmcnt(0)
 v_mfma_f32_16x16x32_bf16 v[216:219], a[208:211], a[160:163], v[216:219]
 s_add_u32 s3, s28, 81920
 buffer_store_dwordx4 v[80:83], v16, s[16:19], s3 offen nt
 v_accvgpr_read_b32 v5, a14
 v_lshlrev_b32 v6, 16, v5
 v_and_b32 v5, s26, v5
 v_mul_f32 v6, v6, v60
 v_mfma_f32_16x16x32_bf16 v[212:215], a[208:211], a[152:155], v[212:215]
 v_mul_f32 v5, v5, v61
 v_cvt_pk_bf16_f32 v10, v6, v5
 v_mfma_f32_16x16x32_bf16 v[212:215], a[212:215], a[156:159], v[212:215]
 v_accvgpr_read_b32 v5, a15
 v_lshlrev_b32 v6, 16, v5
 v_mfma_f32_16x16x32_bf16 v[208:211], a[212:215], a[148:151], v[208:211]
 v_and_b32 v5, s26, v5
 v_mul_f32 v6, v6, v62
 v_mfma_f32_16x16x32_bf16 v[208:211], a[208:211], a[144:147], v[208:211]
 v_mul_f32 v5, v5, v63
 v_cvt_pk_bf16_f32 v11, v6, v5
 v_mfma_f32_16x16x32_bf16 v[204:207], a[208:211], a[136:139], v[204:207]
 ds_write_b128 v17, v[8:11] offset:12288
 v_mfma_f32_16x16x32_bf16 v[204:207], a[212:215], a[140:143], v[204:207]
 v_accvgpr_read_b32 v5, a44
 v_lshlrev_b32 v6, 16, v5
 v_mfma_f32_16x16x32_bf16 v[200:203], a[212:215], a[132:135], v[200:203]
 v_and_b32 v5, s26, v5
 v_mul_f32 v6, v6, v92
 v_mfma_f32_16x16x32_bf16 v[200:203], a[208:211], a[128:131], v[200:203]
 v_mul_f32 v5, v5, v93
 v_cvt_pk_bf16_f32 v12, v6, v5
 s_waitcnt vmcnt(14)
 v_mfma_f32_16x16x32_bf16 v[232:235], a[216:219], a[128:131], v[232:235]
 ds_read_b128 a[128:131], v2 offset:2048
 v_accvgpr_read_b32 v5, a45
 v_mfma_f32_16x16x32_bf16 v[232:235], a[220:223], a[132:135], v[232:235]
 global_load_dwordx4 a[212:215], v0, s[70:71] offset:-3072
 ds_read_b128 a[132:135], v2 offset:3072
 v_mfma_f32_16x16x32_bf16 v[236:239], a[220:223], a[140:143], v[236:239]
 ds_read_b128 a[140:143], v2 offset:7168
 v_lshlrev_b32 v6, 16, v5
 v_mfma_f32_16x16x32_bf16 v[236:239], a[216:219], a[136:139], v[236:239]
 global_load_dwordx4 a[208:211], v0, s[70:71] offset:-4096
 ds_read_b128 a[136:139], v2 offset:6144
 v_and_b32 v5, s26, v5
 v_mfma_f32_16x16x32_bf16 v[240:243], a[216:219], a[144:147], v[240:243]
 ds_read_b128 a[144:147], v2 offset:10240
 v_mul_f32 v6, v6, v94
 v_mul_f32 v5, v5, v95
 v_mfma_f32_16x16x32_bf16 v[240:243], a[220:223], a[148:151], v[240:243]
 ds_read_b128 a[148:151], v2 offset:11264
 v_cvt_pk_bf16_f32 v13, v6, v5
 v_mfma_f32_16x16x32_bf16 v[244:247], a[220:223], a[156:159], v[244:247]
 ds_read_b128 a[156:159], v2 offset:15360
 v_accvgpr_read_b32 v5, a46
 v_lshlrev_b32 v6, 16, v5
 v_mfma_f32_16x16x32_bf16 v[244:247], a[216:219], a[152:155], v[244:247]
 ds_read_b128 a[152:155], v2 offset:14336
 v_and_b32 v5, s26, v5
 v_mul_f32 v6, v6, v124
 v_mfma_f32_16x16x32_bf16 v[248:251], a[216:219], a[160:163], v[248:251]
 ds_read_b128 a[160:163], v2 offset:18432
 v_mul_f32 v5, v5, v125
 v_mfma_f32_16x16x32_bf16 v[248:251], a[220:223], a[164:167], v[248:251]
 ds_read_b128 a[164:167], v2 offset:19456
 v_cvt_pk_bf16_f32 v14, v6, v5
 v_mfma_f32_16x16x32_bf16 v[252:255], a[220:223], a[172:175], v[252:255]
 ds_read_b128 a[172:175], v2 offset:23552
 v_accvgpr_read_b32 v5, a47
 v_mfma_f32_16x16x32_bf16 v[252:255], a[216:219], a[168:171], v[252:255]
 ds_read_b128 a[168:171], v2 offset:22528
 v_lshlrev_b32 v6, 16, v5
 v_mfma_f32_16x16x32_bf16 a[248:251], a[216:219], a[176:179], a[248:251]
 ds_read_b128 a[176:179], v2 offset:26624
 v_and_b32 v5, s26, v5
 v_mfma_f32_16x16x32_bf16 a[248:251], a[220:223], a[180:183], a[248:251]
 ds_read_b128 a[180:183], v2 offset:27648
 v_mul_f32 v6, v6, v126
 v_mfma_f32_16x16x32_bf16 a[252:255], a[220:223], a[188:191], a[252:255]
 ds_read_b128 a[188:191], v2 offset:31744
 v_mul_f32 v5, v5, v127
 v_mfma_f32_16x16x32_bf16 a[252:255], a[216:219], a[184:187], a[252:255]
 ds_read_b128 a[184:187], v2 offset:30720
 v_cvt_pk_bf16_f32 v15, v6, v5
 s_waitcnt vmcnt(12) lgkmcnt(8)
 v_mfma_f32_16x16x32_bf16 v[136:139], a[224:227], a[128:131], v[136:139]
 ds_write_b128 v18, v[12:15] offset:12288
 ds_read_b128 v[48:51], v3 offset:12288
 ds_read_b128 v[80:83], v3 offset:13312
 v_mfma_f32_16x16x32_bf16 v[136:139], a[228:231], a[132:135], v[136:139]
 global_load_dwordx4 a[220:223], v0, s[70:71] offset:-1024
 v_accvgpr_read_b32 v5, a16
 v_mfma_f32_16x16x32_bf16 v[140:143], a[228:231], a[140:143], v[140:143]
 v_lshlrev_b32 v6, 16, v5
 v_and_b32 v5, s26, v5
 v_mfma_f32_16x16x32_bf16 v[140:143], a[224:227], a[136:139], v[140:143]
 global_load_dwordx4 a[216:219], v0, s[70:71] offset:-2048
 v_mul_f32 v6, v6, v32
 v_mfma_f32_16x16x32_bf16 v[144:147], a[224:227], a[144:147], v[144:147]
 v_mul_f32 v5, v5, v33
 v_cvt_pk_bf16_f32 v8, v6, v5
 v_mfma_f32_16x16x32_bf16 v[144:147], a[228:231], a[148:151], v[144:147]
 v_accvgpr_read_b32 v5, a17
 v_lshlrev_b32 v6, 16, v5
 v_mfma_f32_16x16x32_bf16 v[148:151], a[228:231], a[156:159], v[148:151]
 v_and_b32 v5, s26, v5
 v_mul_f32 v6, v6, v34
 v_mfma_f32_16x16x32_bf16 v[148:151], a[224:227], a[152:155], v[148:151]
 v_mul_f32 v5, v5, v35
 v_cvt_pk_bf16_f32 v9, v6, v5
 s_waitcnt lgkmcnt(1)
 s_add_u32 s3, s28, 98304
 v_mfma_f32_16x16x32_bf16 v[152:155], a[224:227], a[160:163], v[152:155]
 buffer_store_dwordx4 v[48:51], v16, s[16:19], s3 offen nt
 s_waitcnt lgkmcnt(0)
 s_add_u32 s3, s28, 114688
 buffer_store_dwordx4 v[80:83], v16, s[16:19], s3 offen nt
 v_accvgpr_read_b32 v5, a18
 v_lshlrev_b32 v6, 16, v5
 v_and_b32 v5, s26, v5
 v_mul_f32 v6, v6, v64
 v_mfma_f32_16x16x32_bf16 v[152:155], a[228:231], a[164:167], v[152:155]
 v_mul_f32 v5, v5, v65
 v_cvt_pk_bf16_f32 v10, v6, v5
 v_mfma_f32_16x16x32_bf16 v[156:159], a[228:231], a[172:175], v[156:159]
 v_accvgpr_read_b32 v5, a19
 v_lshlrev_b32 v6, 16, v5
 v_mfma_f32_16x16x32_bf16 v[156:159], a[224:227], a[168:171], v[156:159]
 v_and_b32 v5, s26, v5
 v_mul_f32 v6, v6, v66
 v_mfma_f32_16x16x32_bf16 v[160:163], a[224:227], a[176:179], v[160:163]
 v_mul_f32 v5, v5, v67
 v_cvt_pk_bf16_f32 v11, v6, v5
 v_mfma_f32_16x16x32_bf16 v[160:163], a[228:231], a[180:183], v[160:163]
 ds_write_b128 v17, v[8:11] offset:16384
 v_mfma_f32_16x16x32_bf16 v[164:167], a[228:231], a[188:191], v[164:167]
 v_accvgpr_read_b32 v5, a48
 v_lshlrev_b32 v6, 16, v5
 v_mfma_f32_16x16x32_bf16 v[164:167], a[224:227], a[184:187], v[164:167]
 v_and_b32 v5, s26, v5
 v_mul_f32 v6, v6, v96
 s_waitcnt vmcnt(14)
 v_mfma_f32_16x16x32_bf16 v[196:199], a[232:235], a[184:187], v[196:199]
 v_mul_f32 v5, v5, v97
 v_cvt_pk_bf16_f32 v12, v6, v5
 v_mfma_f32_16x16x32_bf16 v[196:199], a[236:239], a[188:191], v[196:199]
 global_load_dwordx4 a[228:231], v0, s[70:71] offset:1024
 v_accvgpr_read_b32 v5, a49
 v_mfma_f32_16x16x32_bf16 v[192:195], a[236:239], a[180:183], v[192:195]
 v_lshlrev_b32 v6, 16, v5
 v_and_b32 v5, s26, v5
 v_mfma_f32_16x16x32_bf16 v[192:195], a[232:235], a[176:179], v[192:195]
 global_load_dwordx4 a[224:227], v0, s[70:71] offset:0
 v_mul_f32 v6, v6, v98
 v_mfma_f32_16x16x32_bf16 v[188:191], a[232:235], a[168:171], v[188:191]
 v_mul_f32 v5, v5, v99
 v_cvt_pk_bf16_f32 v13, v6, v5
 v_mfma_f32_16x16x32_bf16 v[188:191], a[236:239], a[172:175], v[188:191]
 v_accvgpr_read_b32 v5, a50
 v_lshlrev_b32 v6, 16, v5
 v_mfma_f32_16x16x32_bf16 v[184:187], a[236:239], a[164:167], v[184:187]
 v_and_b32 v5, s26, v5
 v_mul_f32 v6, v6, v128
 v_mfma_f32_16x16x32_bf16 v[184:187], a[232:235], a[160:163], v[184:187]
 v_mul_f32 v5, v5, v129
 v_cvt_pk_bf16_f32 v14, v6, v5
 v_mfma_f32_16x16x32_bf16 v[180:183], a[232:235], a[152:155], v[180:183]
 v_accvgpr_read_b32 v5, a51
 v_lshlrev_b32 v6, 16, v5
 v_mfma_f32_16x16x32_bf16 v[180:183], a[236:239], a[156:159], v[180:183]
 v_and_b32 v5, s26, v5
 v_mul_f32 v6, v6, v130
 v_mfma_f32_16x16x32_bf16 v[176:179], a[236:239], a[148:151], v[176:179]
 v_mul_f32 v5, v5, v131
 v_cvt_pk_bf16_f32 v15, v6, v5
 v_mfma_f32_16x16x32_bf16 v[176:179], a[232:235], a[144:147], v[176:179]
 ds_write_b128 v18, v[12:15] offset:16384
 v_mfma_f32_16x16x32_bf16 v[172:175], a[232:235], a[136:139], v[172:175]
 ds_read_b128 v[48:51], v3 offset:16384
 ds_read_b128 v[80:83], v3 offset:17408
 v_mfma_f32_16x16x32_bf16 v[172:175], a[236:239], a[140:143], v[172:175]
 v_accvgpr_read_b32 v5, a20
 v_lshlrev_b32 v6, 16, v5
 v_mfma_f32_16x16x32_bf16 v[168:171], a[236:239], a[132:135], v[168:171]
 v_and_b32 v5, s26, v5
 v_mul_f32 v6, v6, v36
 v_mfma_f32_16x16x32_bf16 v[168:171], a[232:235], a[128:131], v[168:171]
 v_mul_f32 v5, v5, v37
 v_cvt_pk_bf16_f32 v8, v6, v5
 s_waitcnt vmcnt(12)
 v_mfma_f32_16x16x32_bf16 v[200:203], a[192:195], a[128:131], v[200:203]
 v_accvgpr_read_b32 v5, a21
 v_lshlrev_b32 v6, 16, v5
 v_mfma_f32_16x16x32_bf16 v[200:203], a[196:199], a[132:135], v[200:203]
 global_load_dwordx4 a[236:239], v0, s[70:71] offset:3072
 v_and_b32 v5, s26, v5
 v_mfma_f32_16x16x32_bf16 v[204:207], a[196:199], a[140:143], v[204:207]
 v_mul_f32 v6, v6, v38
 v_mul_f32 v5, v5, v39
 v_mfma_f32_16x16x32_bf16 v[204:207], a[192:195], a[136:139], v[204:207]
 global_load_dwordx4 a[232:235], v0, s[70:71] offset:2048
 v_cvt_pk_bf16_f32 v9, v6, v5
 s_waitcnt lgkmcnt(1)
 s_add_u32 s3, s28, 131072
 v_mfma_f32_16x16x32_bf16 v[208:211], a[192:195], a[144:147], v[208:211]
 buffer_store_dwordx4 v[48:51], v16, s[16:19], s3 offen nt
 s_waitcnt lgkmcnt(0)
 s_add_u32 s3, s28, 147456
 s_add_u32 s70, s70, 1843200
 s_addc_u32 s71, s71, 0
 v_mfma_f32_16x16x32_bf16 v[208:211], a[196:199], a[148:151], v[208:211]
 buffer_store_dwordx4 v[80:83], v16, s[16:19], s3 offen nt
 v_accvgpr_read_b32 v5, a22
 v_lshlrev_b32 v6, 16, v5
 v_and_b32 v5, s26, v5
 v_mul_f32 v6, v6, v68
 v_mfma_f32_16x16x32_bf16 v[212:215], a[196:199], a[156:159], v[212:215]
 v_mul_f32 v5, v5, v69
 v_cvt_pk_bf16_f32 v10, v6, v5
 v_mfma_f32_16x16x32_bf16 v[212:215], a[192:195], a[152:155], v[212:215]
 v_accvgpr_read_b32 v5, a23
 v_lshlrev_b32 v6, 16, v5
 v_mfma_f32_16x16x32_bf16 v[216:219], a[192:195], a[160:163], v[216:219]
 v_and_b32 v5, s26, v5
 v_mul_f32 v6, v6, v70
 v_mfma_f32_16x16x32_bf16 v[216:219], a[196:199], a[164:167], v[216:219]
 v_mul_f32 v5, v5, v71
 v_cvt_pk_bf16_f32 v11, v6, v5
 v_mfma_f32_16x16x32_bf16 v[220:223], a[196:199], a[172:175], v[220:223]
 ds_write_b128 v17, v[8:11] offset:20480
 v_mfma_f32_16x16x32_bf16 v[220:223], a[192:195], a[168:171], v[220:223]
 v_accvgpr_read_b32 v5, a52
 v_lshlrev_b32 v6, 16, v5
 v_mfma_f32_16x16x32_bf16 v[224:227], a[192:195], a[176:179], v[224:227]
 v_and_b32 v5, s26, v5
 v_mul_f32 v6, v6, v100
 v_mfma_f32_16x16x32_bf16 v[224:227], a[196:199], a[180:183], v[224:227]
 v_mul_f32 v5, v5, v101
 v_cvt_pk_bf16_f32 v12, v6, v5
 v_mfma_f32_16x16x32_bf16 v[228:231], a[196:199], a[188:191], v[228:231]
 v_accvgpr_read_b32 v5, a53
 v_lshlrev_b32 v6, 16, v5
 v_mfma_f32_16x16x32_bf16 v[228:231], a[192:195], a[184:187], v[228:231]
 v_and_b32 v5, s26, v5
 v_mul_f32 v6, v6, v102
 s_waitcnt vmcnt(14)
 v_mfma_f32_16x16x32_bf16 a[252:255], a[200:203], a[184:187], a[252:255]
 ds_read_b128 a[184:187], v2 offset:63488
 v_mul_f32 v5, v5, v103
 v_mfma_f32_16x16x32_bf16 a[252:255], a[204:207], a[188:191], a[252:255]
 ds_read_b128 a[188:191], v2 offset:64512
 v_cvt_pk_bf16_f32 v13, v6, v5
 v_mfma_f32_16x16x32_bf16 a[248:251], a[204:207], a[180:183], a[248:251]
 ds_read_b128 a[180:183], v2 offset:60416
 v_accvgpr_read_b32 v5, a54
 v_mfma_f32_16x16x32_bf16 a[248:251], a[200:203], a[176:179], a[248:251]
 ds_read_b128 a[176:179], v2 offset:59392
 v_lshlrev_b32 v6, 16, v5
 v_mfma_f32_16x16x32_bf16 v[252:255], a[200:203], a[168:171], v[252:255]
 ds_read_b128 a[168:171], v2 offset:55296
 v_and_b32 v5, s26, v5
 v_mfma_f32_16x16x32_bf16 v[252:255], a[204:207], a[172:175], v[252:255]
 ds_read_b128 a[172:175], v2 offset:56320
 v_mul_f32 v6, v6, v132
 v_mfma_f32_16x16x32_bf16 v[248:251], a[204:207], a[164:167], v[248:251]
 ds_read_b128 a[164:167], v2 offset:52224
 v_mul_f32 v5, v5, v133
 v_mfma_f32_16x16x32_bf16 v[248:251], a[200:203], a[160:163], v[248:251]
 ds_read_b128 a[160:163], v2 offset:51200
 v_cvt_pk_bf16_f32 v14, v6, v5
 v_mfma_f32_16x16x32_bf16 v[244:247], a[200:203], a[152:155], v[244:247]
 ds_read_b128 a[152:155], v2 offset:47104
 v_accvgpr_read_b32 v5, a55
 v_mfma_f32_16x16x32_bf16 v[244:247], a[204:207], a[156:159], v[244:247]
 ds_read_b128 a[156:159], v2 offset:48128
 v_lshlrev_b32 v6, 16, v5
 v_mfma_f32_16x16x32_bf16 v[240:243], a[204:207], a[148:151], v[240:243]
 ds_read_b128 a[148:151], v2 offset:44032
 v_and_b32 v5, s26, v5
 v_mfma_f32_16x16x32_bf16 v[240:243], a[200:203], a[144:147], v[240:243]
 ds_read_b128 a[144:147], v2 offset:43008
 v_mul_f32 v6, v6, v134
 v_mfma_f32_16x16x32_bf16 v[236:239], a[200:203], a[136:139], v[236:239]
 ds_read_b128 a[136:139], v2 offset:38912
 v_mul_f32 v5, v5, v135
 v_mfma_f32_16x16x32_bf16 v[236:239], a[204:207], a[140:143], v[236:239]
 ds_read_b128 a[140:143], v2 offset:39936
 v_cvt_pk_bf16_f32 v15, v6, v5
 v_mfma_f32_16x16x32_bf16 v[232:235], a[204:207], a[132:135], v[232:235]
 ds_read_b128 a[132:135], v2 offset:35840
 v_mfma_f32_16x16x32_bf16 v[232:235], a[200:203], a[128:131], v[232:235]
 ds_read_b128 a[128:131], v2 offset:34816
 ds_write_b128 v18, v[12:15] offset:20480
 ds_read_b128 v[48:51], v3 offset:20480
 ds_read_b128 v[80:83], v3 offset:21504
 v_accvgpr_read_b32 v5, a24
 v_lshlrev_b32 v6, 16, v5
 s_waitcnt vmcnt(10) lgkmcnt(11)
 v_mfma_f32_16x16x32_bf16 v[164:167], a[208:211], a[184:187], v[164:167]
 v_and_b32 v5, s26, v5
 v_mul_f32 v6, v6, v40
 v_mfma_f32_16x16x32_bf16 v[164:167], a[212:215], a[188:191], v[164:167]
 v_mul_f32 v5, v5, v41
 v_cvt_pk_bf16_f32 v8, v6, v5
 v_mfma_f32_16x16x32_bf16 v[160:163], a[212:215], a[180:183], v[160:163]
 v_accvgpr_read_b32 v5, a25
 v_lshlrev_b32 v6, 16, v5
 v_mfma_f32_16x16x32_bf16 v[160:163], a[208:211], a[176:179], v[160:163]
 v_and_b32 v5, s26, v5
 v_mul_f32 v6, v6, v42
 v_mfma_f32_16x16x32_bf16 v[156:159], a[208:211], a[168:171], v[156:159]
 v_mul_f32 v5, v5, v43
 v_cvt_pk_bf16_f32 v9, v6, v5
 s_waitcnt lgkmcnt(1)
 s_add_u32 s3, s28, 163840
 v_mfma_f32_16x16x32_bf16 v[156:159], a[212:215], a[172:175], v[156:159]
 buffer_store_dwordx4 v[48:51], v16, s[16:19], s3 offen nt
 s_waitcnt lgkmcnt(0)
 s_add_u32 s3, s28, 180224
 buffer_store_dwordx4 v[80:83], v16, s[16:19], s3 offen nt
 v_accvgpr_read_b32 v5, a26
 v_lshlrev_b32 v6, 16, v5
 v_and_b32 v5, s26, v5
 v_mul_f32 v6, v6, v72
 v_mfma_f32_16x16x32_bf16 v[152:155], a[212:215], a[164:167], v[152:155]
 v_mul_f32 v5, v5, v73
 v_cvt_pk_bf16_f32 v10, v6, v5
 v_mfma_f32_16x16x32_bf16 v[152:155], a[208:211], a[160:163], v[152:155]
 v_accvgpr_read_b32 v5, a27
 v_lshlrev_b32 v6, 16, v5
 v_mfma_f32_16x16x32_bf16 v[148:151], a[208:211], a[152:155], v[148:151]
 v_and_b32 v5, s26, v5
 v_mul_f32 v6, v6, v74
 v_mfma_f32_16x16x32_bf16 v[148:151], a[212:215], a[156:159], v[148:151]
 v_mul_f32 v5, v5, v75
 v_cvt_pk_bf16_f32 v11, v6, v5
 v_mfma_f32_16x16x32_bf16 v[144:147], a[212:215], a[148:151], v[144:147]
 ds_write_b128 v17, v[8:11] offset:24576
 v_mfma_f32_16x16x32_bf16 v[144:147], a[208:211], a[144:147], v[144:147]
 v_accvgpr_read_b32 v5, a56
 v_lshlrev_b32 v6, 16, v5
 v_mfma_f32_16x16x32_bf16 v[140:143], a[208:211], a[136:139], v[140:143]
 v_and_b32 v5, s26, v5
 v_mul_f32 v6, v6, v104
 v_mfma_f32_16x16x32_bf16 v[140:143], a[212:215], a[140:143], v[140:143]
 v_mul_f32 v5, v5, v105
 v_cvt_pk_bf16_f32 v12, v6, v5
 v_mfma_f32_16x16x32_bf16 v[136:139], a[212:215], a[132:135], v[136:139]
 v_accvgpr_read_b32 v5, a57
 v_lshlrev_b32 v6, 16, v5
 v_mfma_f32_16x16x32_bf16 v[136:139], a[208:211], a[128:131], v[136:139]
 v_and_b32 v5, s26, v5
 v_mul_f32 v6, v6, v106
 s_waitcnt vmcnt(10)
 v_mfma_f32_16x16x32_bf16 v[168:171], a[216:219], a[128:131], v[168:171]
 v_mul_f32 v5, v5, v107
 v_cvt_pk_bf16_f32 v13, v6, v5
 v_mfma_f32_16x16x32_bf16 v[168:171], a[220:223], a[132:135], v[168:171]
 v_accvgpr_read_b32 v5, a58
 v_accvgpr_read_b32 v7, a240
 v_mfma_f32_16x16x32_bf16 v[172:175], a[220:223], a[140:143], v[172:175]
 v_lshlrev_b32 v6, 16, v5
 v_and_b32 v5, s26, v5
 v_mfma_f32_16x16x32_bf16 v[172:175], a[216:219], a[136:139], v[172:175]
 v_mul_f32 v6, v6, v7
 v_accvgpr_read_b32 v7, a241
 v_mfma_f32_16x16x32_bf16 v[176:179], a[216:219], a[144:147], v[176:179]
 v_mul_f32 v5, v5, v7
 v_cvt_pk_bf16_f32 v14, v6, v5
 v_mfma_f32_16x16x32_bf16 v[176:179], a[220:223], a[148:151], v[176:179]
 v_accvgpr_read_b32 v5, a59
 v_accvgpr_read_b32 v7, a242
 v_mfma_f32_16x16x32_bf16 v[180:183], a[220:223], a[156:159], v[180:183]
 v_lshlrev_b32 v6, 16, v5
 v_and_b32 v5, s26, v5
 v_mfma_f32_16x16x32_bf16 v[180:183], a[216:219], a[152:155], v[180:183]
 v_mul_f32 v6, v6, v7
 v_accvgpr_read_b32 v7, a243
 v_mfma_f32_16x16x32_bf16 v[184:187], a[216:219], a[160:163], v[184:187]
 v_mul_f32 v5, v5, v7
 v_cvt_pk_bf16_f32 v15, v6, v5
 v_mfma_f32_16x16x32_bf16 v[184:187], a[220:223], a[164:167], v[184:187]
 ds_write_b128 v18, v[12:15] offset:24576
 v_mfma_f32_16x16x32_bf16 v[188:191], a[220:223], a[172:175], v[188:191]
 ds_read_b128 v[48:51], v3 offset:24576
 ds_read_b128 v[80:83], v3 offset:25600
 v_mfma_f32_16x16x32_bf16 v[188:191], a[216:219], a[168:171], v[188:191]
 v_accvgpr_read_b32 v5, a28
 v_mfma_f32_16x16x32_bf16 v[192:195], a[216:219], a[176:179], v[192:195]
 v_lshlrev_b32 v6, 16, v5
 v_and_b32 v5, s26, v5
 v_mfma_f32_16x16x32_bf16 v[192:195], a[220:223], a[180:183], v[192:195]
 v_mul_f32 v6, v6, v44
 v_mul_f32 v5, v5, v45
 v_mfma_f32_16x16x32_bf16 v[196:199], a[220:223], a[188:191], v[196:199]
 v_cvt_pk_bf16_f32 v8, v6, v5
 v_accvgpr_read_b32 v5, a29
 v_mfma_f32_16x16x32_bf16 v[196:199], a[216:219], a[184:187], v[196:199]
 v_lshlrev_b32 v6, 16, v5
 v_and_b32 v5, s26, v5
 s_waitcnt vmcnt(6)
 v_mfma_f32_16x16x32_bf16 v[228:231], a[224:227], a[184:187], v[228:231]
 v_mul_f32 v6, v6, v46
 v_mul_f32 v5, v5, v47
 v_mfma_f32_16x16x32_bf16 v[228:231], a[228:231], a[188:191], v[228:231]
 v_cvt_pk_bf16_f32 v9, v6, v5
 s_waitcnt lgkmcnt(1)
 v_mfma_f32_16x16x32_bf16 v[224:227], a[228:231], a[180:183], v[224:227]
 s_add_u32 s3, s28, 196608
 buffer_store_dwordx4 v[48:51], v16, s[16:19], s3 offen nt
 v_mfma_f32_16x16x32_bf16 v[224:227], a[224:227], a[176:179], v[224:227]
 s_waitcnt lgkmcnt(0)
 s_add_u32 s3, s28, 212992
 v_mfma_f32_16x16x32_bf16 v[220:223], a[224:227], a[168:171], v[220:223]
 buffer_store_dwordx4 v[80:83], v16, s[16:19], s3 offen nt
 v_accvgpr_read_b32 v5, a30
 v_mfma_f32_16x16x32_bf16 v[220:223], a[228:231], a[172:175], v[220:223]
 v_lshlrev_b32 v6, 16, v5
 v_mfma_f32_16x16x32_bf16 v[216:219], a[228:231], a[164:167], v[216:219]
 v_and_b32 v5, s26, v5
 v_mul_f32 v6, v6, v76
 v_mfma_f32_16x16x32_bf16 v[216:219], a[224:227], a[160:163], v[216:219]
 v_mul_f32 v5, v5, v77
 v_cvt_pk_bf16_f32 v10, v6, v5
 v_mfma_f32_16x16x32_bf16 v[212:215], a[224:227], a[152:155], v[212:215]
 v_accvgpr_read_b32 v5, a31
 v_lshlrev_b32 v6, 16, v5
 v_mfma_f32_16x16x32_bf16 v[212:215], a[228:231], a[156:159], v[212:215]
 v_and_b32 v5, s26, v5
 v_mul_f32 v6, v6, v78
 v_mfma_f32_16x16x32_bf16 v[208:211], a[228:231], a[148:151], v[208:211]
 v_mul_f32 v5, v5, v79
 v_cvt_pk_bf16_f32 v11, v6, v5
 v_mfma_f32_16x16x32_bf16 v[208:211], a[224:227], a[144:147], v[208:211]
 ds_write_b128 v17, v[8:11] offset:28672
 v_mfma_f32_16x16x32_bf16 v[204:207], a[224:227], a[136:139], v[204:207]
 v_accvgpr_read_b32 v5, a60
 v_lshlrev_b32 v6, 16, v5
 v_mfma_f32_16x16x32_bf16 v[204:207], a[228:231], a[140:143], v[204:207]
 v_and_b32 v5, s26, v5
 v_mul_f32 v6, v6, v108
 v_mfma_f32_16x16x32_bf16 v[200:203], a[228:231], a[132:135], v[200:203]
 v_mul_f32 v5, v5, v109
 v_cvt_pk_bf16_f32 v12, v6, v5
 v_mfma_f32_16x16x32_bf16 v[200:203], a[224:227], a[128:131], v[200:203]
 v_accvgpr_read_b32 v5, a61
 v_lshlrev_b32 v6, 16, v5
 s_waitcnt vmcnt(6)
 v_mfma_f32_16x16x32_bf16 v[232:235], a[232:235], a[128:131], v[232:235]
 v_and_b32 v5, s26, v5
 v_mul_f32 v6, v6, v110
 v_mfma_f32_16x16x32_bf16 v[232:235], a[236:239], a[132:135], v[232:235]
 v_mul_f32 v5, v5, v111
 v_cvt_pk_bf16_f32 v13, v6, v5
 v_mfma_f32_16x16x32_bf16 v[236:239], a[236:239], a[140:143], v[236:239]
 v_accvgpr_read_b32 v5, a62
 v_accvgpr_read_b32 v7, a244
 v_mfma_f32_16x16x32_bf16 v[236:239], a[232:235], a[136:139], v[236:239]
 v_lshlrev_b32 v6, 16, v5
 v_and_b32 v5, s26, v5
 v_mfma_f32_16x16x32_bf16 v[240:243], a[232:235], a[144:147], v[240:243]
 v_mul_f32 v6, v6, v7
 v_accvgpr_read_b32 v7, a245
 v_mfma_f32_16x16x32_bf16 v[240:243], a[236:239], a[148:151], v[240:243]
 v_mul_f32 v5, v5, v7
 v_cvt_pk_bf16_f32 v14, v6, v5
 v_mfma_f32_16x16x32_bf16 v[244:247], a[236:239], a[156:159], v[244:247]
 v_accvgpr_read_b32 v5, a63
 v_accvgpr_read_b32 v7, a246
 v_mfma_f32_16x16x32_bf16 v[244:247], a[232:235], a[152:155], v[244:247]
 v_lshlrev_b32 v6, 16, v5
 v_and_b32 v5, s26, v5
 v_mfma_f32_16x16x32_bf16 v[248:251], a[232:235], a[160:163], v[248:251]
 v_mul_f32 v6, v6, v7
 v_accvgpr_read_b32 v7, a247
 v_mfma_f32_16x16x32_bf16 v[248:251], a[236:239], a[164:167], v[248:251]
 v_mul_f32 v5, v5, v7
 v_cvt_pk_bf16_f32 v15, v6, v5
 v_mfma_f32_16x16x32_bf16 v[252:255], a[236:239], a[172:175], v[252:255]
 ds_write_b128 v18, v[12:15] offset:28672
 v_mfma_f32_16x16x32_bf16 v[252:255], a[232:235], a[168:171], v[252:255]
 ds_read_b128 v[48:51], v3 offset:28672
 ds_read_b128 v[80:83], v3 offset:29696
 v_mfma_f32_16x16x32_bf16 a[248:251], a[232:235], a[176:179], a[248:251]
 s_waitcnt lgkmcnt(1)
 s_add_u32 s3, s28, 229376
 v_mfma_f32_16x16x32_bf16 a[248:251], a[236:239], a[180:183], a[248:251]
 buffer_store_dwordx4 v[48:51], v16, s[16:19], s3 offen nt
 s_waitcnt lgkmcnt(0)
 v_mfma_f32_16x16x32_bf16 a[252:255], a[236:239], a[188:191], a[252:255]
 s_add_u32 s3, s28, 245760
 buffer_store_dwordx4 v[80:83], v16, s[16:19], s3 offen nt
 v_mfma_f32_16x16x32_bf16 a[252:255], a[232:235], a[184:187], a[252:255]
 s_nop 7
 v_accvgpr_read_b32 v5, a64
 v_lshlrev_b32 v6, 16, v5
 v_and_b32 v5, s26, v5
 v_mul_f32 v6, v6, v136
 v_mul_f32 v5, v5, v137
 v_cvt_pk_bf16_f32 v8, v6, v5
 v_accvgpr_read_b32 v5, a65
 v_lshlrev_b32 v6, 16, v5
 v_and_b32 v5, s26, v5
 v_mul_f32 v6, v6, v138
 v_mul_f32 v5, v5, v139
 v_cvt_pk_bf16_f32 v9, v6, v5
 v_accvgpr_read_b32 v5, a66
 v_lshlrev_b32 v6, 16, v5
 v_and_b32 v5, s26, v5
 v_mul_f32 v6, v6, v168
 v_mul_f32 v5, v5, v169
 v_cvt_pk_bf16_f32 v10, v6, v5
 v_accvgpr_read_b32 v5, a67
 v_lshlrev_b32 v6, 16, v5
 v_and_b32 v5, s26, v5
 v_mul_f32 v6, v6, v170
 v_mul_f32 v5, v5, v171
 v_cvt_pk_bf16_f32 v11, v6, v5
 ds_write_b128 v17, v[8:11]
 v_accvgpr_read_b32 v5, a96
 v_lshlrev_b32 v6, 16, v5
 v_and_b32 v5, s26, v5
 v_mul_f32 v6, v6, v200
 v_mul_f32 v5, v5, v201
 v_cvt_pk_bf16_f32 v12, v6, v5
 v_accvgpr_read_b32 v5, a97
 v_lshlrev_b32 v6, 16, v5
 v_and_b32 v5, s26, v5
 v_mul_f32 v6, v6, v202
 v_mul_f32 v5, v5, v203
 v_cvt_pk_bf16_f32 v13, v6, v5
 v_accvgpr_read_b32 v5, a98
 v_lshlrev_b32 v6, 16, v5
 v_and_b32 v5, s26, v5
 v_mul_f32 v6, v6, v232
 v_mul_f32 v5, v5, v233
 v_cvt_pk_bf16_f32 v14, v6, v5
 v_accvgpr_read_b32 v5, a99
 v_lshlrev_b32 v6, 16, v5
 v_and_b32 v5, s26, v5
 v_mul_f32 v6, v6, v234
 v_mul_f32 v5, v5, v235
 v_cvt_pk_bf16_f32 v15, v6, v5
 ds_write_b128 v18, v[12:15]
 ds_read_b128 v[48:51], v3
 ds_read_b128 v[80:83], v3 offset:1024
 v_accvgpr_read_b32 v5, a68
 v_lshlrev_b32 v6, 16, v5
 v_and_b32 v5, s26, v5
 v_mul_f32 v6, v6, v140
 v_mul_f32 v5, v5, v141
 v_cvt_pk_bf16_f32 v8, v6, v5
 v_accvgpr_read_b32 v5, a69
 v_lshlrev_b32 v6, 16, v5
 v_and_b32 v5, s26, v5
 v_mul_f32 v6, v6, v142
 v_mul_f32 v5, v5, v143
 v_cvt_pk_bf16_f32 v9, v6, v5
 s_waitcnt lgkmcnt(1)
 s_add_u32 s3, s28, 0
 buffer_store_dwordx4 v[48:51], v16, s[16:19], s3 offen offset:128 nt
 s_waitcnt lgkmcnt(0)
 s_add_u32 s3, s28, 16384
 buffer_store_dwordx4 v[80:83], v16, s[16:19], s3 offen offset:128 nt
 v_accvgpr_read_b32 v5, a70
 v_lshlrev_b32 v6, 16, v5
 v_and_b32 v5, s26, v5
 v_mul_f32 v6, v6, v172
 v_mul_f32 v5, v5, v173
 v_cvt_pk_bf16_f32 v10, v6, v5
 v_accvgpr_read_b32 v5, a71
 v_lshlrev_b32 v6, 16, v5
 v_and_b32 v5, s26, v5
 v_mul_f32 v6, v6, v174
 v_mul_f32 v5, v5, v175
 v_cvt_pk_bf16_f32 v11, v6, v5
 ds_write_b128 v17, v[8:11] offset:4096
 v_accvgpr_read_b32 v5, a100
 v_lshlrev_b32 v6, 16, v5
 v_and_b32 v5, s26, v5
 v_mul_f32 v6, v6, v204
 v_mul_f32 v5, v5, v205
 v_cvt_pk_bf16_f32 v12, v6, v5
 v_accvgpr_read_b32 v5, a101
 v_lshlrev_b32 v6, 16, v5
 v_and_b32 v5, s26, v5
 v_mul_f32 v6, v6, v206
 v_mul_f32 v5, v5, v207
 v_cvt_pk_bf16_f32 v13, v6, v5
 v_accvgpr_read_b32 v5, a102
 v_lshlrev_b32 v6, 16, v5
 v_and_b32 v5, s26, v5
 v_mul_f32 v6, v6, v236
 v_mul_f32 v5, v5, v237
 v_cvt_pk_bf16_f32 v14, v6, v5
 v_accvgpr_read_b32 v5, a103
 v_lshlrev_b32 v6, 16, v5
 v_and_b32 v5, s26, v5
 v_mul_f32 v6, v6, v238
 v_mul_f32 v5, v5, v239
 v_cvt_pk_bf16_f32 v15, v6, v5
 ds_write_b128 v18, v[12:15] offset:4096
 ds_read_b128 v[48:51], v3 offset:4096
 ds_read_b128 v[80:83], v3 offset:5120
 v_accvgpr_read_b32 v5, a72
 v_lshlrev_b32 v6, 16, v5
 v_and_b32 v5, s26, v5
 v_mul_f32 v6, v6, v144
 v_mul_f32 v5, v5, v145
 v_cvt_pk_bf16_f32 v8, v6, v5
 v_accvgpr_read_b32 v5, a73
 v_lshlrev_b32 v6, 16, v5
 v_and_b32 v5, s26, v5
 v_mul_f32 v6, v6, v146
 v_mul_f32 v5, v5, v147
 v_cvt_pk_bf16_f32 v9, v6, v5
 s_waitcnt lgkmcnt(1)
 s_add_u32 s3, s28, 32768
 buffer_store_dwordx4 v[48:51], v16, s[16:19], s3 offen offset:128 nt
 s_waitcnt lgkmcnt(0)
 s_add_u32 s3, s28, 49152
 buffer_store_dwordx4 v[80:83], v16, s[16:19], s3 offen offset:128 nt
 v_accvgpr_read_b32 v5, a74
 v_lshlrev_b32 v6, 16, v5
 v_and_b32 v5, s26, v5
 v_mul_f32 v6, v6, v176
 v_mul_f32 v5, v5, v177
 v_cvt_pk_bf16_f32 v10, v6, v5
 v_accvgpr_read_b32 v5, a75
 v_lshlrev_b32 v6, 16, v5
 v_and_b32 v5, s26, v5
 v_mul_f32 v6, v6, v178
 v_mul_f32 v5, v5, v179
 v_cvt_pk_bf16_f32 v11, v6, v5
 ds_write_b128 v17, v[8:11] offset:8192
 v_accvgpr_read_b32 v5, a104
 v_lshlrev_b32 v6, 16, v5
 v_and_b32 v5, s26, v5
 v_mul_f32 v6, v6, v208
 v_mul_f32 v5, v5, v209
 v_cvt_pk_bf16_f32 v12, v6, v5
 v_accvgpr_read_b32 v5, a105
 v_lshlrev_b32 v6, 16, v5
 v_and_b32 v5, s26, v5
 v_mul_f32 v6, v6, v210
 v_mul_f32 v5, v5, v211
 v_cvt_pk_bf16_f32 v13, v6, v5
 v_accvgpr_read_b32 v5, a106
 v_lshlrev_b32 v6, 16, v5
 v_and_b32 v5, s26, v5
 v_mul_f32 v6, v6, v240
 v_mul_f32 v5, v5, v241
 v_cvt_pk_bf16_f32 v14, v6, v5
 v_accvgpr_read_b32 v5, a107
 v_lshlrev_b32 v6, 16, v5
 v_and_b32 v5, s26, v5
 v_mul_f32 v6, v6, v242
 v_mul_f32 v5, v5, v243
 v_cvt_pk_bf16_f32 v15, v6, v5
 ds_write_b128 v18, v[12:15] offset:8192
 ds_read_b128 v[48:51], v3 offset:8192
 ds_read_b128 v[80:83], v3 offset:9216
 v_accvgpr_read_b32 v5, a76
 v_lshlrev_b32 v6, 16, v5
 v_and_b32 v5, s26, v5
 v_mul_f32 v6, v6, v148
 v_mul_f32 v5, v5, v149
 v_cvt_pk_bf16_f32 v8, v6, v5
 v_accvgpr_read_b32 v5, a77
 v_lshlrev_b32 v6, 16, v5
 v_and_b32 v5, s26, v5
 v_mul_f32 v6, v6, v150
 v_mul_f32 v5, v5, v151
 v_cvt_pk_bf16_f32 v9, v6, v5
 s_waitcnt lgkmcnt(1)
 s_add_u32 s3, s28, 65536
 buffer_store_dwordx4 v[48:51], v16, s[16:19], s3 offen offset:128 nt
 s_waitcnt lgkmcnt(0)
 s_add_u32 s3, s28, 81920
 buffer_store_dwordx4 v[80:83], v16, s[16:19], s3 offen offset:128 nt
 v_accvgpr_read_b32 v5, a78
 v_lshlrev_b32 v6, 16, v5
 v_and_b32 v5, s26, v5
 v_mul_f32 v6, v6, v180
 v_mul_f32 v5, v5, v181
 v_cvt_pk_bf16_f32 v10, v6, v5
 v_accvgpr_read_b32 v5, a79
 v_lshlrev_b32 v6, 16, v5
 v_and_b32 v5, s26, v5
 v_mul_f32 v6, v6, v182
 v_mul_f32 v5, v5, v183
 v_cvt_pk_bf16_f32 v11, v6, v5
 ds_write_b128 v17, v[8:11] offset:12288
 v_accvgpr_read_b32 v5, a108
 v_lshlrev_b32 v6, 16, v5
 v_and_b32 v5, s26, v5
 v_mul_f32 v6, v6, v212
 v_mul_f32 v5, v5, v213
 v_cvt_pk_bf16_f32 v12, v6, v5
 v_accvgpr_read_b32 v5, a109
 v_lshlrev_b32 v6, 16, v5
 v_and_b32 v5, s26, v5
 v_mul_f32 v6, v6, v214
 v_mul_f32 v5, v5, v215
 v_cvt_pk_bf16_f32 v13, v6, v5
 v_accvgpr_read_b32 v5, a110
 v_lshlrev_b32 v6, 16, v5
 v_and_b32 v5, s26, v5
 v_mul_f32 v6, v6, v244
 v_mul_f32 v5, v5, v245
 v_cvt_pk_bf16_f32 v14, v6, v5
 v_accvgpr_read_b32 v5, a111
 v_lshlrev_b32 v6, 16, v5
 v_and_b32 v5, s26, v5
 v_mul_f32 v6, v6, v246
 v_mul_f32 v5, v5, v247
 v_cvt_pk_bf16_f32 v15, v6, v5
 ds_write_b128 v18, v[12:15] offset:12288
 ds_read_b128 v[48:51], v3 offset:12288
 ds_read_b128 v[80:83], v3 offset:13312
 v_accvgpr_read_b32 v5, a80
 v_lshlrev_b32 v6, 16, v5
 v_and_b32 v5, s26, v5
 v_mul_f32 v6, v6, v152
 v_mul_f32 v5, v5, v153
 v_cvt_pk_bf16_f32 v8, v6, v5
 v_accvgpr_read_b32 v5, a81
 v_lshlrev_b32 v6, 16, v5
 v_and_b32 v5, s26, v5
 v_mul_f32 v6, v6, v154
 v_mul_f32 v5, v5, v155
 v_cvt_pk_bf16_f32 v9, v6, v5
 s_waitcnt lgkmcnt(1)
 s_add_u32 s3, s28, 98304
 buffer_store_dwordx4 v[48:51], v16, s[16:19], s3 offen offset:128 nt
 s_waitcnt lgkmcnt(0)
 s_add_u32 s3, s28, 114688
 buffer_store_dwordx4 v[80:83], v16, s[16:19], s3 offen offset:128 nt
 v_accvgpr_read_b32 v5, a82
 v_lshlrev_b32 v6, 16, v5
 v_and_b32 v5, s26, v5
 v_mul_f32 v6, v6, v184
 v_mul_f32 v5, v5, v185
 v_cvt_pk_bf16_f32 v10, v6, v5
 v_accvgpr_read_b32 v5, a83
 v_lshlrev_b32 v6, 16, v5
 v_and_b32 v5, s26, v5
 v_mul_f32 v6, v6, v186
 v_mul_f32 v5, v5, v187
 v_cvt_pk_bf16_f32 v11, v6, v5
 ds_write_b128 v17, v[8:11] offset:16384
 v_accvgpr_read_b32 v5, a112
 v_lshlrev_b32 v6, 16, v5
 v_and_b32 v5, s26, v5
 v_mul_f32 v6, v6, v216
 v_mul_f32 v5, v5, v217
 v_cvt_pk_bf16_f32 v12, v6, v5
 v_accvgpr_read_b32 v5, a113
 v_lshlrev_b32 v6, 16, v5
 v_and_b32 v5, s26, v5
 v_mul_f32 v6, v6, v218
 v_mul_f32 v5, v5, v219
 v_cvt_pk_bf16_f32 v13, v6, v5
 v_accvgpr_read_b32 v5, a114
 v_lshlrev_b32 v6, 16, v5
 v_and_b32 v5, s26, v5
 v_mul_f32 v6, v6, v248
 v_mul_f32 v5, v5, v249
 v_cvt_pk_bf16_f32 v14, v6, v5
 v_accvgpr_read_b32 v5, a115
 v_lshlrev_b32 v6, 16, v5
 v_and_b32 v5, s26, v5
 v_mul_f32 v6, v6, v250
 v_mul_f32 v5, v5, v251
 v_cvt_pk_bf16_f32 v15, v6, v5
 ds_write_b128 v18, v[12:15] offset:16384
 ds_read_b128 v[48:51], v3 offset:16384
 ds_read_b128 v[80:83], v3 offset:17408
 v_accvgpr_read_b32 v5, a84
 v_lshlrev_b32 v6, 16, v5
 v_and_b32 v5, s26, v5
 v_mul_f32 v6, v6, v156
 v_mul_f32 v5, v5, v157
 v_cvt_pk_bf16_f32 v8, v6, v5
 v_accvgpr_read_b32 v5, a85
 v_lshlrev_b32 v6, 16, v5
 v_and_b32 v5, s26, v5
 v_mul_f32 v6, v6, v158
 v_mul_f32 v5, v5, v159
 v_cvt_pk_bf16_f32 v9, v6, v5
 s_waitcnt lgkmcnt(1)
 s_add_u32 s3, s28, 131072
 buffer_store_dwordx4 v[48:51], v16, s[16:19], s3 offen offset:128 nt
 s_waitcnt lgkmcnt(0)
 s_add_u32 s3, s28, 147456
 buffer_store_dwordx4 v[80:83], v16, s[16:19], s3 offen offset:128 nt
 v_accvgpr_read_b32 v5, a86
 v_lshlrev_b32 v6, 16, v5
 v_and_b32 v5, s26, v5
 v_mul_f32 v6, v6, v188
 v_mul_f32 v5, v5, v189
 v_cvt_pk_bf16_f32 v10, v6, v5
 v_accvgpr_read_b32 v5, a87
 v_lshlrev_b32 v6, 16, v5
 v_and_b32 v5, s26, v5
 v_mul_f32 v6, v6, v190
 v_mul_f32 v5, v5, v191
 v_cvt_pk_bf16_f32 v11, v6, v5
 ds_write_b128 v17, v[8:11] offset:20480
 v_accvgpr_read_b32 v5, a116
 v_lshlrev_b32 v6, 16, v5
 v_and_b32 v5, s26, v5
 v_mul_f32 v6, v6, v220
 v_mul_f32 v5, v5, v221
 v_cvt_pk_bf16_f32 v12, v6, v5
 v_accvgpr_read_b32 v5, a117
 v_lshlrev_b32 v6, 16, v5
 v_and_b32 v5, s26, v5
 v_mul_f32 v6, v6, v222
 v_mul_f32 v5, v5, v223
 v_cvt_pk_bf16_f32 v13, v6, v5
 v_accvgpr_read_b32 v5, a118
 v_lshlrev_b32 v6, 16, v5
 v_and_b32 v5, s26, v5
 v_mul_f32 v6, v6, v252
 v_mul_f32 v5, v5, v253
 v_cvt_pk_bf16_f32 v14, v6, v5
 v_accvgpr_read_b32 v5, a119
 v_lshlrev_b32 v6, 16, v5
 v_and_b32 v5, s26, v5
 v_mul_f32 v6, v6, v254
 v_mul_f32 v5, v5, v255
 v_cvt_pk_bf16_f32 v15, v6, v5
 ds_write_b128 v18, v[12:15] offset:20480
 ds_read_b128 v[48:51], v3 offset:20480
 ds_read_b128 v[80:83], v3 offset:21504
 v_accvgpr_read_b32 v5, a88
 v_lshlrev_b32 v6, 16, v5
 v_and_b32 v5, s26, v5
 v_mul_f32 v6, v6, v160
 v_mul_f32 v5, v5, v161
 v_cvt_pk_bf16_f32 v8, v6, v5
 v_accvgpr_read_b32 v5, a89
 v_lshlrev_b32 v6, 16, v5
 v_and_b32 v5, s26, v5
 v_mul_f32 v6, v6, v162
 v_mul_f32 v5, v5, v163
 v_cvt_pk_bf16_f32 v9, v6, v5
 s_waitcnt lgkmcnt(1)
 s_add_u32 s3, s28, 163840
 buffer_store_dwordx4 v[48:51], v16, s[16:19], s3 offen offset:128 nt
 s_waitcnt lgkmcnt(0)
 s_add_u32 s3, s28, 180224
 buffer_store_dwordx4 v[80:83], v16, s[16:19], s3 offen offset:128 nt
 v_accvgpr_read_b32 v5, a90
 v_lshlrev_b32 v6, 16, v5
 v_and_b32 v5, s26, v5
 v_mul_f32 v6, v6, v192
 v_mul_f32 v5, v5, v193
 v_cvt_pk_bf16_f32 v10, v6, v5
 v_accvgpr_read_b32 v5, a91
 v_lshlrev_b32 v6, 16, v5
 v_and_b32 v5, s26, v5
 v_mul_f32 v6, v6, v194
 v_mul_f32 v5, v5, v195
 v_cvt_pk_bf16_f32 v11, v6, v5
 ds_write_b128 v17, v[8:11] offset:24576
 v_accvgpr_read_b32 v5, a120
 v_lshlrev_b32 v6, 16, v5
 v_and_b32 v5, s26, v5
 v_mul_f32 v6, v6, v224
 v_mul_f32 v5, v5, v225
 v_cvt_pk_bf16_f32 v12, v6, v5
 v_accvgpr_read_b32 v5, a121
 v_lshlrev_b32 v6, 16, v5
 v_and_b32 v5, s26, v5
 v_mul_f32 v6, v6, v226
 v_mul_f32 v5, v5, v227
 v_cvt_pk_bf16_f32 v13, v6, v5
 v_accvgpr_read_b32 v5, a122
 v_accvgpr_read_b32 v7, a248
 v_lshlrev_b32 v6, 16, v5
 v_and_b32 v5, s26, v5
 v_mul_f32 v6, v6, v7
 v_accvgpr_read_b32 v7, a249
 v_mul_f32 v5, v5, v7
 v_cvt_pk_bf16_f32 v14, v6, v5
 v_accvgpr_read_b32 v5, a123
 v_accvgpr_read_b32 v7, a250
 v_lshlrev_b32 v6, 16, v5
 v_and_b32 v5, s26, v5
 v_mul_f32 v6, v6, v7
 v_accvgpr_read_b32 v7, a251
 v_mul_f32 v5, v5, v7
 v_cvt_pk_bf16_f32 v15, v6, v5
 ds_write_b128 v18, v[12:15] offset:24576
 ds_read_b128 v[48:51], v3 offset:24576
 ds_read_b128 v[80:83], v3 offset:25600
 v_accvgpr_read_b32 v5, a92
 v_lshlrev_b32 v6, 16, v5
 v_and_b32 v5, s26, v5
 v_mul_f32 v6, v6, v164
 v_mul_f32 v5, v5, v165
 v_cvt_pk_bf16_f32 v8, v6, v5
 v_accvgpr_read_b32 v5, a93
 v_lshlrev_b32 v6, 16, v5
 v_and_b32 v5, s26, v5
 v_mul_f32 v6, v6, v166
 v_mul_f32 v5, v5, v167
 v_cvt_pk_bf16_f32 v9, v6, v5
 s_waitcnt lgkmcnt(1)
 s_add_u32 s3, s28, 196608
 buffer_store_dwordx4 v[48:51], v16, s[16:19], s3 offen offset:128 nt
 s_waitcnt lgkmcnt(0)
 s_add_u32 s3, s28, 212992
 buffer_store_dwordx4 v[80:83], v16, s[16:19], s3 offen offset:128 nt
 v_accvgpr_read_b32 v5, a94
 v_lshlrev_b32 v6, 16, v5
 v_and_b32 v5, s26, v5
 v_mul_f32 v6, v6, v196
 v_mul_f32 v5, v5, v197
 v_cvt_pk_bf16_f32 v10, v6, v5
 v_accvgpr_read_b32 v5, a95
 v_lshlrev_b32 v6, 16, v5
 v_and_b32 v5, s26, v5
 v_mul_f32 v6, v6, v198
 v_mul_f32 v5, v5, v199
 v_cvt_pk_bf16_f32 v11, v6, v5
 ds_write_b128 v17, v[8:11] offset:28672
 v_accvgpr_read_b32 v5, a124
 v_lshlrev_b32 v6, 16, v5
 v_and_b32 v5, s26, v5
 v_mul_f32 v6, v6, v228
 v_mul_f32 v5, v5, v229
 v_cvt_pk_bf16_f32 v12, v6, v5
 v_accvgpr_read_b32 v5, a125
 v_lshlrev_b32 v6, 16, v5
 v_and_b32 v5, s26, v5
 v_mul_f32 v6, v6, v230
 v_mul_f32 v5, v5, v231
 v_cvt_pk_bf16_f32 v13, v6, v5
 v_accvgpr_read_b32 v5, a126
 v_accvgpr_read_b32 v7, a252
 v_lshlrev_b32 v6, 16, v5
 v_and_b32 v5, s26, v5
 v_mul_f32 v6, v6, v7
 v_accvgpr_read_b32 v7, a253
 v_mul_f32 v5, v5, v7
 v_cvt_pk_bf16_f32 v14, v6, v5
 v_accvgpr_read_b32 v5, a127
 v_accvgpr_read_b32 v7, a254
 v_lshlrev_b32 v6, 16, v5
 v_and_b32 v5, s26, v5
 v_mul_f32 v6, v6, v7
 v_accvgpr_read_b32 v7, a255
 v_mul_f32 v5, v5, v7
 v_cvt_pk_bf16_f32 v15, v6, v5
 ds_write_b128 v18, v[12:15] offset:28672
 ds_read_b128 v[48:51], v3 offset:28672
 ds_read_b128 v[80:83], v3 offset:29696
 s_waitcnt lgkmcnt(1)
 s_add_u32 s3, s28, 229376
 buffer_store_dwordx4 v[48:51], v16, s[16:19], s3 offen offset:128 nt
 s_waitcnt lgkmcnt(0)
 s_add_u32 s3, s28, 245760
 buffer_store_dwordx4 v[80:83], v16, s[16:19], s3 offen offset:128 nt
Lend:
 s_endpgm
Lspin_pro:
 s_add_u32 s53, s53, 1
 v_lshlrev_b32 v4, 2, v1
 v_and_b32 v4, 192, v4
 buffer_load_dword v4, v4, s[44:47], 0 offen sc1
 s_cmp_ge_u32 s53, 0x400000
 s_cbranch_scc1 Lgiveup_pro
 s_waitcnt vmcnt(0)
 v_cmp_gt_u32 vcc, s27, v4
 s_cbranch_vccnz Lspin_pro
Lgiveup_pro:
 s_waitcnt vmcnt(0)
 s_branch Lok_pro
Lspin_pa0:
 s_add_u32 s53, s53, 1
 buffer_load_dword v4, off, s[64:67], 0 sc1
 s_cmp_ge_u32 s53, 0x400000
 s_cbranch_scc1 Lgiveup_pa0
 s_waitcnt vmcnt(0)
 v_cmp_gt_u32 vcc, s55, v4
 s_cbranch_vccnz Lspin_pa0
Lgiveup_pa0:
 s_waitcnt vmcnt(0)
 s_branch Lok_pa0
Lspin_pa:
 s_add_u32 s53, s53, 1
 buffer_load_dword v4, off, s[64:67], 0 sc1
 s_cmp_ge_u32 s53, 0x400000
 s_cbranch_scc1 Lgiveup_pa
 s_waitcnt vmcnt(0)
 v_cmp_gt_u32 vcc, s55, v4
 s_cbranch_vccnz Lspin_pa
Lgiveup_pa:
 s_waitcnt vmcnt(0)
 s_branch Lok_pa
Lspin_pb:
 s_add_u32 s53, s53, 1
 buffer_load_dword v4, off, s[64:67], 0 sc1
 s_cmp_ge_u32 s53, 0x400000
 s_cbranch_scc1 Lgiveup_pb
 s_waitcnt vmcnt(0)
 v_cmp_gt_u32 vcc, s55, v4
 s_cbranch_vccnz Lspin_pb
Lgiveup_pb:
 s_waitcnt vmcnt(0)
 s_branch Lok_pb
Lspin_w:
 s_add_u32 s53, s53, 1
 v_lshlrev_b32 v4, 2, v1
 v_and_b32 v4, 192, v4
 buffer_load_dword v4, v4, s[44:47], 0 offen sc1
 s_cmp_ge_u32 s53, 0x400000
 s_cbranch_scc1 Lgiveup_w
 s_waitcnt vmcnt(0)
 v_cmp_gt_u32 vcc, s27, v4
 s_cbranch_vccnz Lspin_w
Lgiveup_w:
 s_waitcnt vmcnt(0)
 s_branch Lok_w
.section .rodata,"a"
.p2align 6
.amdhsa_kernel standalone__cross_network_dcn__recsys_kernel
  .amdhsa_next_free_vgpr 512
  .amdhsa_next_free_sgpr 102
  .amdhsa_accum_offset 256
  .amdhsa_group_segment_fixed_size 0
  .amdhsa_kernarg_size 48
  .amdhsa_user_sgpr_count 2
  .amdhsa_user_sgpr_kernarg_segment_ptr 1
  .amdhsa_system_sgpr_workgroup_id_x 1
  .amdhsa_float_denorm_mode_32 3
.end_amdhsa_kernel
```

```asm
; @launch grid=(256,1,1) block=(256,1,1) lds=151552
.amdgcn_target "amdgcn-amd-amdhsa--gfx950"
.text
.globl standalone__cross_network_dcn__recsys_kernel
.p2align 8
.type standalone__cross_network_dcn__recsys_kernel,@function
standalone__cross_network_dcn__recsys_kernel:
 s_cmp_ge_u32 s2, 256
 s_cbranch_scc1 Lend
 s_load_dwordx4 s[56:59], s[0:1], 0
 s_load_dwordx4 s[60:63], s[0:1], 16
 s_load_dwordx4 s[64:67], s[0:1], 32
 v_lshrrev_b32 v9, 6, v0
 v_and_b32 v10, 63, v0
 v_readfirstlane_b32 s54, v9
 v_lshlrev_b32 v1, 4, v10
 s_getpc_b64 s[4:5]
Lpc:
 v_lshlrev_b32 v11, 6, v0
 v_min_u32 v12, Lend-Lpc, v11
 global_load_dword v60, v12, s[4:5]
 v_add_u32 v11, 16384, v11
 v_min_u32 v12, Lend-Lpc, v11
 global_load_dword v61, v12, s[4:5]
 v_add_u32 v11, 16384, v11
 v_min_u32 v12, Lend-Lpc, v11
 global_load_dword v62, v12, s[4:5]
 v_add_u32 v11, 16384, v11
 v_min_u32 v12, Lend-Lpc, v11
 global_load_dword v63, v12, s[4:5]
 v_add_u32 v11, 16384, v11
 v_lshrrev_b32 v11, 7, v0
 v_and_b32 v12, 127, v0
 v_lshlrev_b32 v12, 3, v12
 v_lshl_add_u32 v30, v11, 11, v12
 v_lshlrev_b32 v31, 4, v0
 v_add_u32 v31, 131072, v31
 v_add_u32 v2, 65536, v1
 v_lshl_add_u32 v3, v9, 15, v1
 v_lshl_add_u32 v0, v9, 18, v1
 v_lshrrev_b32 v11, 4, v10
 v_and_b32 v12, 15, v10
 v_xor_b32 v13, v11, v12
 v_lshlrev_b32 v13, 4, v13
 v_lshl_add_u32 v20, v11, 11, v13
 v_xor_b32 v21, 64, v20
 v_xor_b32 v22, 128, v20
 v_xor_b32 v23, 192, v20
 v_lshl_add_u32 v24, v12, 8, v13
 v_lshl_add_u32 v24, v9, 15, v24
 v_xor_b32 v25, 64, v24
 v_xor_b32 v26, 128, v24
 v_xor_b32 v27, 192, v24
 s_and_b32 s7, s2, 1
 s_lshr_b32 s28, s2, 1
 s_lshl_b32 s28, s28, 18
 s_lshl_b32 s6, s7, 10
 s_add_u32 s28, s28, s6
 s_lshl_b32 s6, s54, 8
 s_add_u32 s28, s28, s6
 s_mov_b32 s26, 0xffff0000
 s_lshl_b32 s24, s7, 20
 s_mov_b32 s25, 0
 s_mov_b32 s53, 0
 s_mov_b32 s31, -1
 s_mov_b32 s27, 64
 s_mov_b32 s55, -1
 s_lshl_b32 s50, s54, 15
 s_lshl_b32 s29, s2, 17
 s_add_u32 s29, s29, 33554432
 s_xor_b32 s30, s29, 131072
 s_lshr_b32 s4, s2, 3
 s_and_b32 s5, s2, 7
 s_lshl_b32 s48, s4, 16
 s_lshl_b32 s6, s5, 8
 s_add_u32 s48, s48, s6
 s_lshl_b32 s6, s54, 6
 s_add_u32 s48, s48, s6
 s_lshl_b32 s49, s5, 18
 s_and_b32 s6, s4, 1
 s_lshl_b32 s6, s6, 10
 s_add_u32 s49, s49, s6
 s_lshr_b32 s6, s4, 4
 s_lshr_b32 s5, s5, 2
 s_xor_b32 s5, s5, s6
 s_bfe_u32 s6, s4, 0x10001
 s_lshl_b32 s3, s5, 1
 s_add_u32 s3, s3, s6
 s_lshl_b32 s3, s3, 16
 s_add_u32 s49, s49, s3
 s_bfe_u32 s4, s4, 0x20002
 s_xor_b32 s5, s5, s6
 s_lshr_b32 s3, s54, 1
 s_lshl_b32 s3, s3, 4
 s_lshl_b32 s6, s4, 2
 s_add_u32 s3, s3, s6
 s_and_b32 s6, s54, 1
 s_lshl_b32 s6, s6, 1
 s_add_u32 s3, s3, s6
 s_lshl_b32 s4, s4, 3
 s_lshl_b32 s6, s54, 1
 s_add_u32 s4, s4, s6
 s_cmp_eq_u32 s5, 0
 s_cselect_b32 s3, s3, s4
 s_lshl_b32 s3, s3, 11
 s_add_u32 s49, s49, s3
 s_lshl_b32 s52, s54, 11
 s_add_u32 s52, s52, 143360
 s_lshl_b32 s51, s54, 9
 s_add_u32 s51, s51, 131072
 s_waitcnt lgkmcnt(0)
 s_mov_b32 s40, s58
 s_mov_b32 s41, s59
 s_mov_b32 s42, 0xc00000
 s_mov_b32 s43, 0x20000
 v_lshrrev_b32 v5, 6, v1
 v_and_b32 v6, 48, v1
 v_lshl_add_u32 v5, v5, 11, v6
 s_mov_b32 m0, s52
 s_add_u32 s3, s48, 31744
 buffer_load_dwordx4 v5, s[40:43], s48 offen lds
 buffer_load_dwordx4 v5, s[40:43], s3 offen offset:1024 lds
 s_add_u32 s48, s48, 2097152
 s_mov_b32 s20, s60
 s_mov_b32 s21, s61
 s_mov_b32 s22, 0x3000
 s_mov_b32 s23, 0x20000
 s_lshl_b32 s3, s7, 10
 buffer_load_dwordx2 v[32:33], v30, s[20:23], s3 offen
 s_add_u32 s3, s3, 4096
 buffer_load_dwordx2 v[34:35], v30, s[20:23], s3 offen
 s_add_u32 s3, s3, 4096
 buffer_load_dwordx2 v[36:37], v30, s[20:23], s3 offen
 s_add_u32 s3, s3, 4096
 s_mov_b32 s8, s56
 s_mov_b32 s9, s57
 s_mov_b32 s10, 0x2000000
 s_mov_b32 s11, 0x20000
 s_mov_b32 s16, s62
 s_mov_b32 s17, s63
 s_mov_b32 s18, 0x2000000
 s_mov_b32 s19, 0x20000
 s_mov_b32 s12, s66
 s_mov_b32 s13, s67
 s_mov_b32 s14, 0xc00000
 s_mov_b32 s15, 0x20000
 s_mov_b32 s32, s66
 s_mov_b32 s33, s67
 s_mov_b32 s34, 0x10000000
 s_mov_b32 s35, 0x20000
 s_mov_b32 s44, s64
 s_mov_b32 s45, s65
 s_mov_b32 s46, 0x100
 s_mov_b32 s47, 0x20000
 s_add_u32 s24, s24, 4096
 s_add_u32 s70, s66, s24
 s_addc_u32 s71, s67, 0
 s_sub_u32 s24, s24, 4096
 s_and_b32 s3, s2, 3
 s_lshl_b32 s3, s3, 6
 s_add_u32 s56, s44, s3
 s_addc_u32 s57, s45, 0
 s_mov_b32 s58, 0x4
 s_mov_b32 s59, 0x20000
 s_lshl_b32 s3, s2, 2
 s_add_u32 s3, s3, s54
 s_lshl_b32 s3, s3, 7
 s_add_u32 s3, s3, 15728640
 s_add_u32 s60, s32, s3
 s_addc_u32 s61, s33, 0
 s_mov_b32 s62, 0x4
 s_mov_b32 s63, 0x20000
 s_xor_b32 s3, s3, 512
 s_add_u32 s64, s32, s3
 s_addc_u32 s65, s33, 0
 s_mov_b32 s66, 0x4
 s_mov_b32 s67, 0x20000
 v_mov_b32 v7, 0
 buffer_store_dword v7, v1, s[60:63], 0 offen sc1
 s_add_u32 m0, s50, 0
 s_add_u32 s3, s28, 0
 buffer_load_dwordx4 v20, s[8:11], s3 offen lds
 s_add_u32 m0, s50, 1024
 s_add_u32 s3, s28, 8192
 buffer_load_dwordx4 v21, s[8:11], s3 offen lds
 s_add_u32 m0, s50, 2048
 s_add_u32 s3, s28, 16384
 buffer_load_dwordx4 v22, s[8:11], s3 offen lds
 s_add_u32 m0, s50, 3072
 s_add_u32 s3, s28, 24576
 buffer_load_dwordx4 v23, s[8:11], s3 offen lds
 v_mov_b32 v64, 1.0
 v_mov_b32 v65, 1.0
 v_mov_b32 v66, 1.0
 v_mov_b32 v67, 1.0
 v_mov_b32 v68, 1.0
 v_mov_b32 v69, 1.0
 v_mov_b32 v70, 1.0
 v_mov_b32 v71, 1.0
 v_mov_b32 v72, 1.0
 v_mov_b32 v73, 1.0
 v_mov_b32 v74, 1.0
 v_mov_b32 v75, 1.0
 v_mov_b32 v76, 1.0
 v_mov_b32 v77, 1.0
 v_mov_b32 v78, 1.0
 v_mov_b32 v79, 1.0
 v_mov_b32 v80, 1.0
 v_mov_b32 v81, 1.0
 v_mov_b32 v82, 1.0
 v_mov_b32 v83, 1.0
 v_mov_b32 v84, 1.0
 v_mov_b32 v85, 1.0
 v_mov_b32 v86, 1.0
 v_mov_b32 v87, 1.0
 v_mov_b32 v88, 1.0
 v_mov_b32 v89, 1.0
 v_mov_b32 v90, 1.0
 v_mov_b32 v91, 1.0
 v_mov_b32 v92, 1.0
 v_mov_b32 v93, 1.0
 v_mov_b32 v94, 1.0
 v_mov_b32 v95, 1.0
 v_mov_b32 v96, 1.0
 v_mov_b32 v97, 1.0
 v_mov_b32 v98, 1.0
 v_mov_b32 v99, 1.0
 v_mov_b32 v100, 1.0
 v_mov_b32 v101, 1.0
 v_mov_b32 v102, 1.0
 v_mov_b32 v103, 1.0
 v_mov_b32 v104, 1.0
 v_mov_b32 v105, 1.0
 v_mov_b32 v106, 1.0
 v_mov_b32 v107, 1.0
 v_mov_b32 v108, 1.0
 v_mov_b32 v109, 1.0
 v_mov_b32 v110, 1.0
 v_mov_b32 v111, 1.0
 v_mov_b32 v112, 1.0
 v_mov_b32 v113, 1.0
 v_mov_b32 v114, 1.0
 v_mov_b32 v115, 1.0
 v_mov_b32 v116, 1.0
 v_mov_b32 v117, 1.0
 v_mov_b32 v118, 1.0
 v_mov_b32 v119, 1.0
 v_mov_b32 v120, 1.0
 v_mov_b32 v121, 1.0
 v_mov_b32 v122, 1.0
 v_mov_b32 v123, 1.0
 v_mov_b32 v124, 1.0
 v_mov_b32 v125, 1.0
 v_mov_b32 v126, 1.0
 v_mov_b32 v127, 1.0
 v_mov_b32 v128, 1.0
 v_mov_b32 v129, 1.0
 v_mov_b32 v130, 1.0
 v_mov_b32 v131, 1.0
 v_mov_b32 v132, 1.0
 v_mov_b32 v133, 1.0
 v_mov_b32 v134, 1.0
 v_mov_b32 v135, 1.0
 v_accvgpr_write_b32 a240, 1.0
 v_accvgpr_write_b32 a241, 1.0
 v_accvgpr_write_b32 a242, 1.0
 v_accvgpr_write_b32 a243, 1.0
 v_accvgpr_write_b32 a244, 1.0
 v_accvgpr_write_b32 a245, 1.0
 v_accvgpr_write_b32 a246, 1.0
 v_accvgpr_write_b32 a247, 1.0
 v_mov_b32 v136, 1.0
 v_mov_b32 v137, 1.0
 v_mov_b32 v138, 1.0
 v_mov_b32 v139, 1.0
 v_mov_b32 v140, 1.0
 v_mov_b32 v141, 1.0
 v_mov_b32 v142, 1.0
 v_mov_b32 v143, 1.0
 v_mov_b32 v144, 1.0
 v_mov_b32 v145, 1.0
 v_mov_b32 v146, 1.0
 v_mov_b32 v147, 1.0
 v_mov_b32 v148, 1.0
 v_mov_b32 v149, 1.0
 v_mov_b32 v150, 1.0
 v_mov_b32 v151, 1.0
 v_mov_b32 v152, 1.0
 v_mov_b32 v153, 1.0
 v_mov_b32 v154, 1.0
 v_mov_b32 v155, 1.0
 v_mov_b32 v156, 1.0
 v_mov_b32 v157, 1.0
 v_mov_b32 v158, 1.0
 v_mov_b32 v159, 1.0
 v_mov_b32 v160, 1.0
 v_mov_b32 v161, 1.0
 v_mov_b32 v162, 1.0
 v_mov_b32 v163, 1.0
 v_mov_b32 v164, 1.0
 v_mov_b32 v165, 1.0
 v_mov_b32 v166, 1.0
 v_mov_b32 v167, 1.0
 v_mov_b32 v168, 1.0
 v_mov_b32 v169, 1.0
 v_mov_b32 v170, 1.0
 v_mov_b32 v171, 1.0
 v_mov_b32 v172, 1.0
 v_mov_b32 v173, 1.0
 v_mov_b32 v174, 1.0
 v_mov_b32 v175, 1.0
 v_mov_b32 v176, 1.0
 v_mov_b32 v177, 1.0
 v_mov_b32 v178, 1.0
 v_mov_b32 v179, 1.0
 v_mov_b32 v180, 1.0
 v_mov_b32 v181, 1.0
 v_mov_b32 v182, 1.0
 v_mov_b32 v183, 1.0
 v_mov_b32 v184, 1.0
 v_mov_b32 v185, 1.0
 v_mov_b32 v186, 1.0
 v_mov_b32 v187, 1.0
 v_mov_b32 v188, 1.0
 v_mov_b32 v189, 1.0
 v_mov_b32 v190, 1.0
 v_mov_b32 v191, 1.0
 v_mov_b32 v192, 1.0
 v_mov_b32 v193, 1.0
 v_mov_b32 v194, 1.0
 v_mov_b32 v195, 1.0
 v_mov_b32 v196, 1.0
 v_mov_b32 v197, 1.0
 v_mov_b32 v198, 1.0
 v_mov_b32 v199, 1.0
 v_mov_b32 v200, 1.0
 v_mov_b32 v201, 1.0
 v_mov_b32 v202, 1.0
 v_mov_b32 v203, 1.0
 v_mov_b32 v204, 1.0
 v_mov_b32 v205, 1.0
 v_mov_b32 v206, 1.0
 v_mov_b32 v207, 1.0
 v_mov_b32 v208, 1.0
 v_mov_b32 v209, 1.0
 v_mov_b32 v210, 1.0
 v_mov_b32 v211, 1.0
 v_mov_b32 v212, 1.0
 v_mov_b32 v213, 1.0
 v_mov_b32 v214, 1.0
 v_mov_b32 v215, 1.0
 v_mov_b32 v216, 1.0
 v_mov_b32 v217, 1.0
 v_mov_b32 v218, 1.0
 v_mov_b32 v219, 1.0
 v_mov_b32 v220, 1.0
 v_mov_b32 v221, 1.0
 v_mov_b32 v222, 1.0
 v_mov_b32 v223, 1.0
 v_mov_b32 v224, 1.0
 v_mov_b32 v225, 1.0
 v_mov_b32 v226, 1.0
 v_mov_b32 v227, 1.0
 v_mov_b32 v228, 1.0
 v_mov_b32 v229, 1.0
 v_mov_b32 v230, 1.0
 v_mov_b32 v231, 1.0
 v_mov_b32 v232, 1.0
 v_mov_b32 v233, 1.0
 v_mov_b32 v234, 1.0
 v_mov_b32 v235, 1.0
 v_mov_b32 v236, 1.0
 v_mov_b32 v237, 1.0
 v_mov_b32 v238, 1.0
 v_mov_b32 v239, 1.0
 v_mov_b32 v240, 1.0
 v_mov_b32 v241, 1.0
 v_mov_b32 v242, 1.0
 v_mov_b32 v243, 1.0
 v_mov_b32 v244, 1.0
 v_mov_b32 v245, 1.0
 v_mov_b32 v246, 1.0
 v_mov_b32 v247, 1.0
 v_mov_b32 v248, 1.0
 v_mov_b32 v249, 1.0
 v_mov_b32 v250, 1.0
 v_mov_b32 v251, 1.0
 v_mov_b32 v252, 1.0
 v_mov_b32 v253, 1.0
 v_mov_b32 v254, 1.0
 v_mov_b32 v255, 1.0
 v_accvgpr_write_b32 a248, 1.0
 v_accvgpr_write_b32 a249, 1.0
 v_accvgpr_write_b32 a250, 1.0
 v_accvgpr_write_b32 a251, 1.0
 v_accvgpr_write_b32 a252, 1.0
 v_accvgpr_write_b32 a253, 1.0
 v_accvgpr_write_b32 a254, 1.0
 v_accvgpr_write_b32 a255, 1.0
 v_and_b32 v5, 768, v1
 v_add3_u32 v5, v5, v1, s52
 s_waitcnt vmcnt(8)
 ds_read_b64_tr_b16 v[8:9], v5 offset:0
 ds_read_b64_tr_b16 v[10:11], v5 offset:256
 ds_read_b64_tr_b16 v[12:13], v5 offset:8
 ds_read_b64_tr_b16 v[14:15], v5 offset:264
 s_waitcnt lgkmcnt(2)
 buffer_store_dwordx4 v[8:11], v1, s[12:15], s49 offen sc1
 s_waitcnt lgkmcnt(0)
 buffer_store_dwordx4 v[12:15], v1, s[12:15], s49 offen offset:2048 sc1
 s_add_u32 s49, s49, 2097152
 s_waitcnt vmcnt(9)
 v_lshlrev_b32 v40, 16, v32
 v_and_b32 v41, s26, v32
 v_lshlrev_b32 v42, 16, v33
 v_and_b32 v43, s26, v33
 ds_write_b128 v31, v[40:43]
 s_waitcnt vmcnt(8)
 v_lshlrev_b32 v44, 16, v34
 v_and_b32 v45, s26, v34
 v_lshlrev_b32 v46, 16, v35
 v_and_b32 v47, s26, v35
 ds_write_b128 v31, v[44:47] offset:4096
 s_waitcnt vmcnt(7)
 v_lshlrev_b32 v48, 16, v36
 v_and_b32 v49, s26, v36
 v_lshlrev_b32 v50, 16, v37
 v_and_b32 v51, s26, v37
 ds_write_b128 v31, v[48:51] offset:8192
 s_waitcnt lgkmcnt(0)
 v_mov_b32 v32, 1.0
 v_mov_b32 v33, 1.0
 v_mov_b32 v34, 1.0
 v_mov_b32 v35, 1.0
 v_mov_b32 v36, 1.0
 v_mov_b32 v37, 1.0
 v_mov_b32 v38, 1.0
 v_mov_b32 v39, 1.0
 v_mov_b32 v40, 1.0
 v_mov_b32 v41, 1.0
 v_mov_b32 v42, 1.0
 v_mov_b32 v43, 1.0
 v_mov_b32 v44, 1.0
 v_mov_b32 v45, 1.0
 v_mov_b32 v46, 1.0
 v_mov_b32 v47, 1.0
 v_mov_b32 v48, 1.0
 v_mov_b32 v49, 1.0
 v_mov_b32 v50, 1.0
 v_mov_b32 v51, 1.0
 v_mov_b32 v52, 1.0
 v_mov_b32 v53, 1.0
 v_mov_b32 v54, 1.0
 v_mov_b32 v55, 1.0
 v_mov_b32 v56, 1.0
 v_mov_b32 v57, 1.0
 v_mov_b32 v58, 1.0
 v_mov_b32 v59, 1.0
 v_mov_b32 v60, 1.0
 v_mov_b32 v61, 1.0
 v_mov_b32 v62, 1.0
 v_mov_b32 v63, 1.0
 s_waitcnt vmcnt(0)
 s_barrier
 v_mov_b32 v7, 1
 buffer_atomic_add v7, v0, s[56:59], 0 offen sc1
 s_add_u32 m0, s50, 4096
 s_add_u32 s3, s28, 32768
 buffer_load_dwordx4 v20, s[8:11], s3 offen lds
 s_add_u32 m0, s50, 5120
 s_add_u32 s3, s28, 40960
 buffer_load_dwordx4 v21, s[8:11], s3 offen lds
 s_add_u32 m0, s50, 6144
 s_add_u32 s3, s28, 49152
 buffer_load_dwordx4 v22, s[8:11], s3 offen lds
 s_add_u32 m0, s50, 7168
 s_add_u32 s3, s28, 57344
 buffer_load_dwordx4 v23, s[8:11], s3 offen lds
 s_add_u32 m0, s50, 8192
 s_add_u32 s3, s28, 65536
 buffer_load_dwordx4 v20, s[8:11], s3 offen lds
 s_add_u32 m0, s50, 9216
 s_add_u32 s3, s28, 73728
 buffer_load_dwordx4 v21, s[8:11], s3 offen lds
 s_add_u32 m0, s50, 10240
 s_add_u32 s3, s28, 81920
 buffer_load_dwordx4 v22, s[8:11], s3 offen lds
 s_add_u32 m0, s50, 11264
 s_add_u32 s3, s28, 90112
 buffer_load_dwordx4 v23, s[8:11], s3 offen lds
 s_add_u32 m0, s50, 12288
 s_add_u32 s3, s28, 98304
 buffer_load_dwordx4 v20, s[8:11], s3 offen lds
 s_add_u32 m0, s50, 13312
 s_add_u32 s3, s28, 106496
 buffer_load_dwordx4 v21, s[8:11], s3 offen lds
 s_add_u32 m0, s50, 14336
 s_add_u32 s3, s28, 114688
 buffer_load_dwordx4 v22, s[8:11], s3 offen lds
 s_add_u32 m0, s50, 15360
 s_add_u32 s3, s28, 122880
 buffer_load_dwordx4 v23, s[8:11], s3 offen lds
 ds_read_b128 a[0:3], v24
 ds_read_b128 a[32:35], v25
 ds_read_b128 a[64:67], v26
 ds_read_b128 a[96:99], v27
 s_waitcnt lgkmcnt(0)
 ds_write_b128 v3, a[0:3]
 ds_write_b128 v3, a[32:35] offset:1024
 ds_write_b128 v3, a[64:67] offset:2048
 ds_write_b128 v3, a[96:99] offset:3072
 s_add_u32 m0, s50, 16384
 s_add_u32 s3, s28, 131072
 buffer_load_dwordx4 v20, s[8:11], s3 offen lds
 s_add_u32 m0, s50, 17408
 s_add_u32 s3, s28, 139264
 buffer_load_dwordx4 v21, s[8:11], s3 offen lds
 s_add_u32 m0, s50, 18432
 s_add_u32 s3, s28, 147456
 buffer_load_dwordx4 v22, s[8:11], s3 offen lds
 s_add_u32 m0, s50, 19456
 s_add_u32 s3, s28, 155648
 buffer_load_dwordx4 v23, s[8:11], s3 offen lds
 s_waitcnt vmcnt(12)
 ds_read_b128 a[4:7], v24 offset:4096
 ds_read_b128 a[36:39], v25 offset:4096
 ds_read_b128 a[68:71], v26 offset:4096
 ds_read_b128 a[100:103], v27 offset:4096
 s_waitcnt lgkmcnt(0)
 ds_write_b128 v3, a[4:7] offset:4096
 ds_write_b128 v3, a[36:39] offset:5120
 ds_write_b128 v3, a[68:71] offset:6144
 ds_write_b128 v3, a[100:103] offset:7168
 s_add_u32 m0, s50, 20480
 s_add_u32 s3, s28, 163840
 buffer_load_dwordx4 v20, s[8:11], s3 offen lds
 s_add_u32 m0, s50, 21504
 s_add_u32 s3, s28, 172032
 buffer_load_dwordx4 v21, s[8:11], s3 offen lds
 s_add_u32 m0, s50, 22528
 s_add_u32 s3, s28, 180224
 buffer_load_dwordx4 v22, s[8:11], s3 offen lds
 s_add_u32 m0, s50, 23552
 s_add_u32 s3, s28, 188416
 buffer_load_dwordx4 v23, s[8:11], s3 offen lds
 s_waitcnt vmcnt(12)
 ds_read_b128 a[8:11], v24 offset:8192
 ds_read_b128 a[40:43], v25 offset:8192
 ds_read_b128 a[72:75], v26 offset:8192
 ds_read_b128 a[104:107], v27 offset:8192
 s_waitcnt lgkmcnt(0)
 ds_write_b128 v3, a[8:11] offset:8192
 ds_write_b128 v3, a[40:43] offset:9216
 ds_write_b128 v3, a[72:75] offset:10240
 ds_write_b128 v3, a[104:107] offset:11264
 v_lshlrev_b32 v4, 2, v1
 v_and_b32 v4, 192, v4
 buffer_load_dword v4, v4, s[44:47], 0 offen sc1
 s_add_u32 m0, s50, 24576
 s_add_u32 s3, s28, 196608
 buffer_load_dwordx4 v20, s[8:11], s3 offen lds
 s_add_u32 m0, s50, 25600
 s_add_u32 s3, s28, 204800
 buffer_load_dwordx4 v21, s[8:11], s3 offen lds
 s_add_u32 m0, s50, 26624
 s_add_u32 s3, s28, 212992
 buffer_load_dwordx4 v22, s[8:11], s3 offen lds
 s_add_u32 m0, s50, 27648
 s_add_u32 s3, s28, 221184
 buffer_load_dwordx4 v23, s[8:11], s3 offen lds
 s_waitcnt vmcnt(13)
 ds_read_b128 a[12:15], v24 offset:12288
 ds_read_b128 a[44:47], v25 offset:12288
 ds_read_b128 a[76:79], v26 offset:12288
 ds_read_b128 a[108:111], v27 offset:12288
 s_waitcnt lgkmcnt(0)
 ds_write_b128 v3, a[12:15] offset:12288
 ds_write_b128 v3, a[44:47] offset:13312
 ds_write_b128 v3, a[76:79] offset:14336
 ds_write_b128 v3, a[108:111] offset:15360
 s_add_u32 m0, s50, 28672
 s_add_u32 s3, s28, 229376
 buffer_load_dwordx4 v20, s[8:11], s3 offen lds
 s_add_u32 m0, s50, 29696
 s_add_u32 s3, s28, 237568
 buffer_load_dwordx4 v21, s[8:11], s3 offen lds
 s_add_u32 m0, s50, 30720
 s_add_u32 s3, s28, 245760
 buffer_load_dwordx4 v22, s[8:11], s3 offen lds
 s_add_u32 m0, s50, 31744
 s_add_u32 s3, s28, 253952
 buffer_load_dwordx4 v23, s[8:11], s3 offen lds
 s_waitcnt vmcnt(13)
 ds_read_b128 a[16:19], v24 offset:16384
 ds_read_b128 a[48:51], v25 offset:16384
 ds_read_b128 a[80:83], v26 offset:16384
 ds_read_b128 a[112:115], v27 offset:16384
 s_waitcnt lgkmcnt(0)
 ds_write_b128 v3, a[16:19] offset:16384
 ds_write_b128 v3, a[48:51] offset:17408
 ds_write_b128 v3, a[80:83] offset:18432
 ds_write_b128 v3, a[112:115] offset:19456
 s_waitcnt vmcnt(9)
 ds_read_b128 a[20:23], v24 offset:20480
 ds_read_b128 a[52:55], v25 offset:20480
 ds_read_b128 a[84:87], v26 offset:20480
 ds_read_b128 a[116:119], v27 offset:20480
 s_waitcnt lgkmcnt(0)
 ds_write_b128 v3, a[20:23] offset:20480
 ds_write_b128 v3, a[52:55] offset:21504
 ds_write_b128 v3, a[84:87] offset:22528
 ds_write_b128 v3, a[116:119] offset:23552
 s_waitcnt vmcnt(8)
 v_cmp_gt_i32 vcc, s27, v4
 s_cbranch_vccnz Lspin_pro
Lok_pro:
 s_add_u32 s27, s27, 64
 global_load_dwordx4 a[196:199], v0, s[70:71] offset:-3072
 global_load_dwordx4 a[192:195], v0, s[70:71] offset:-4096
 global_load_dwordx4 a[204:207], v0, s[70:71] offset:-1024
 global_load_dwordx4 a[200:203], v0, s[70:71] offset:-2048
 global_load_dwordx4 a[212:215], v0, s[70:71] offset:1024
 global_load_dwordx4 a[208:211], v0, s[70:71] offset:0
 global_load_dwordx4 a[220:223], v0, s[70:71] offset:3072
 global_load_dwordx4 a[216:219], v0, s[70:71] offset:2048
 s_add_u32 s70, s70, 8192
 s_addc_u32 s71, s71, 0
 global_load_dwordx4 a[228:231], v0, s[70:71] offset:-3072
 global_load_dwordx4 a[224:227], v0, s[70:71] offset:-4096
 global_load_dwordx4 a[236:239], v0, s[70:71] offset:-1024
 global_load_dwordx4 a[232:235], v0, s[70:71] offset:-2048
 s_waitcnt vmcnt(16)
 ds_read_b128 a[24:27], v24 offset:24576
 ds_read_b128 a[56:59], v25 offset:24576
 ds_read_b128 a[88:91], v26 offset:24576
 ds_read_b128 a[120:123], v27 offset:24576
 s_waitcnt lgkmcnt(0)
 ds_write_b128 v3, a[24:27] offset:24576
 ds_write_b128 v3, a[56:59] offset:25600
 ds_write_b128 v3, a[88:91] offset:26624
 ds_write_b128 v3, a[120:123] offset:27648
 s_waitcnt vmcnt(12)
 ds_read_b128 a[28:31], v24 offset:28672
 ds_read_b128 a[60:63], v25 offset:28672
 ds_read_b128 a[92:95], v26 offset:28672
 ds_read_b128 a[124:127], v27 offset:28672
 s_waitcnt lgkmcnt(0)
 ds_write_b128 v3, a[28:31] offset:28672
 ds_write_b128 v3, a[60:63] offset:29696
 ds_write_b128 v3, a[92:95] offset:30720
 ds_write_b128 v3, a[124:127] offset:31744
 v_mov_b32 v16, 1.0
 v_mov_b32 v17, 1.0
 v_mov_b32 v18, 1.0
 v_mov_b32 v19, 1.0
 v_mov_b32 v20, 1.0
 v_mov_b32 v21, 1.0
 v_mov_b32 v22, 1.0
 v_mov_b32 v23, 1.0
 v_mov_b32 v24, 1.0
 v_mov_b32 v25, 1.0
 v_mov_b32 v26, 1.0
 v_mov_b32 v27, 1.0
 v_mov_b32 v28, 1.0
 v_mov_b32 v29, 1.0
 v_mov_b32 v30, 1.0
 v_mov_b32 v31, 1.0
 s_xor_b32 s30, s28, 1024
 s_mov_b32 s20, 64
 s_mov_b32 s21, 32704
 s_mov_b32 s22, 0xfffc8040
 s_waitcnt lgkmcnt(0)
 s_barrier
 ds_read_b128 a[128:131], v1
 ds_read_b128 a[132:135], v1 offset:1024
 ds_read_b128 a[140:143], v1 offset:5120
 ds_read_b128 a[136:139], v1 offset:4096
 ds_read_b128 a[144:147], v1 offset:8192
 ds_read_b128 a[148:151], v1 offset:9216
 ds_read_b128 a[156:159], v1 offset:13312
 ds_read_b128 a[152:155], v1 offset:12288
 ds_read_b128 a[160:163], v1 offset:16384
 ds_read_b128 a[164:167], v1 offset:17408
 ds_read_b128 a[172:175], v1 offset:21504
 ds_read_b128 a[168:171], v1 offset:20480
 ds_read_b128 a[176:179], v1 offset:24576
 ds_read_b128 a[180:183], v1 offset:25600
 ds_read_b128 a[188:191], v1 offset:29696
 ds_read_b128 a[184:187], v1 offset:28672
 s_waitcnt vmcnt(10) lgkmcnt(8)
 v_mfma_f32_16x16x32_bf16 v[16:19], a[192:195], a[128:131], v[16:19]
 v_mfma_f32_16x16x32_bf16 v[16:19], a[196:199], a[132:135], v[16:19]
 v_mfma_f32_16x16x32_bf16 v[20:23], a[196:199], a[140:143], v[20:23]
 v_mfma_f32_16x16x32_bf16 v[20:23], a[192:195], a[136:139], v[20:23]
 v_mfma_f32_16x16x32_bf16 v[24:27], a[192:195], a[144:147], v[24:27]
 v_mfma_f32_16x16x32_bf16 v[24:27], a[196:199], a[148:151], v[24:27]
 v_mfma_f32_16x16x32_bf16 v[28:31], a[196:199], a[156:159], v[28:31]
 v_mfma_f32_16x16x32_bf16 v[28:31], a[192:195], a[152:155], v[28:31]
 s_waitcnt lgkmcnt(0)
 v_mfma_f32_16x16x32_bf16 v[32:35], a[192:195], a[160:163], v[32:35]
 v_mfma_f32_16x16x32_bf16 v[32:35], a[196:199], a[164:167], v[32:35]
 v_mfma_f32_16x16x32_bf16 v[36:39], a[196:199], a[172:175], v[36:39]
 v_mfma_f32_16x16x32_bf16 v[36:39], a[192:195], a[168:171], v[36:39]
 v_mfma_f32_16x16x32_bf16 v[40:43], a[192:195], a[176:179], v[40:43]
 v_mfma_f32_16x16x32_bf16 v[40:43], a[196:199], a[180:183], v[40:43]
 v_mfma_f32_16x16x32_bf16 v[44:47], a[196:199], a[188:191], v[44:47]
 v_mfma_f32_16x16x32_bf16 v[44:47], a[192:195], a[184:187], v[44:47]
 s_waitcnt vmcnt(8)
 v_mfma_f32_16x16x32_bf16 v[76:79], a[200:203], a[184:187], v[76:79]
 v_mfma_f32_16x16x32_bf16 v[76:79], a[204:207], a[188:191], v[76:79]
 global_load_dwordx4 a[196:199], v0, s[70:71] offset:1024
 v_mfma_f32_16x16x32_bf16 v[72:75], a[204:207], a[180:183], v[72:75]
 v_mfma_f32_16x16x32_bf16 v[72:75], a[200:203], a[176:179], v[72:75]
 global_load_dwordx4 a[192:195], v0, s[70:71] offset:0
 v_mfma_f32_16x16x32_bf16 v[68:71], a[200:203], a[168:171], v[68:71]
 v_mfma_f32_16x16x32_bf16 v[68:71], a[204:207], a[172:175], v[68:71]
 v_mfma_f32_16x16x32_bf16 v[64:67], a[204:207], a[164:167], v[64:67]
 v_mfma_f32_16x16x32_bf16 v[64:67], a[200:203], a[160:163], v[64:67]
 v_mfma_f32_16x16x32_bf16 v[60:63], a[200:203], a[152:155], v[60:63]
 v_mfma_f32_16x16x32_bf16 v[60:63], a[204:207], a[156:159], v[60:63]
 v_mfma_f32_16x16x32_bf16 v[56:59], a[204:207], a[148:151], v[56:59]
 v_mfma_f32_16x16x32_bf16 v[56:59], a[200:203], a[144:147], v[56:59]
 v_mfma_f32_16x16x32_bf16 v[52:55], a[200:203], a[136:139], v[52:55]
 v_mfma_f32_16x16x32_bf16 v[52:55], a[204:207], a[140:143], v[52:55]
 v_mfma_f32_16x16x32_bf16 v[48:51], a[204:207], a[132:135], v[48:51]
 v_mfma_f32_16x16x32_bf16 v[48:51], a[200:203], a[128:131], v[48:51]
 s_waitcnt vmcnt(8)
 v_mfma_f32_16x16x32_bf16 v[80:83], a[208:211], a[128:131], v[80:83]
 v_mfma_f32_16x16x32_bf16 v[80:83], a[212:215], a[132:135], v[80:83]
 global_load_dwordx4 a[204:207], v0, s[70:71] offset:3072
 v_mfma_f32_16x16x32_bf16 v[84:87], a[212:215], a[140:143], v[84:87]
 v_mfma_f32_16x16x32_bf16 v[84:87], a[208:211], a[136:139], v[84:87]
 global_load_dwordx4 a[200:203], v0, s[70:71] offset:2048
 v_mfma_f32_16x16x32_bf16 v[88:91], a[208:211], a[144:147], v[88:91]
 s_add_u32 s70, s70, 8192
 s_addc_u32 s71, s71, 0
 v_mfma_f32_16x16x32_bf16 v[88:91], a[212:215], a[148:151], v[88:91]
 v_mfma_f32_16x16x32_bf16 v[92:95], a[212:215], a[156:159], v[92:95]
 v_mfma_f32_16x16x32_bf16 v[92:95], a[208:211], a[152:155], v[92:95]
 v_mfma_f32_16x16x32_bf16 v[96:99], a[208:211], a[160:163], v[96:99]
 v_mfma_f32_16x16x32_bf16 v[96:99], a[212:215], a[164:167], v[96:99]
 v_mfma_f32_16x16x32_bf16 v[100:103], a[212:215], a[172:175], v[100:103]
 v_mfma_f32_16x16x32_bf16 v[100:103], a[208:211], a[168:171], v[100:103]
 v_mfma_f32_16x16x32_bf16 v[104:107], a[208:211], a[176:179], v[104:107]
 v_mfma_f32_16x16x32_bf16 v[104:107], a[212:215], a[180:183], v[104:107]
 v_mfma_f32_16x16x32_bf16 v[108:111], a[212:215], a[188:191], v[108:111]
 v_mfma_f32_16x16x32_bf16 v[108:111], a[208:211], a[184:187], v[108:111]
 s_waitcnt vmcnt(8)
 v_mfma_f32_16x16x32_bf16 a[244:247], a[216:219], a[184:187], a[244:247]
 ds_read_b128 a[184:187], v1 offset:61440
 v_mfma_f32_16x16x32_bf16 a[244:247], a[220:223], a[188:191], a[244:247]
 global_load_dwordx4 a[212:215], v0, s[70:71] offset:-3072
 ds_read_b128 a[188:191], v1 offset:62464
 v_mfma_f32_16x16x32_bf16 a[240:243], a[220:223], a[180:183], a[240:243]
 ds_read_b128 a[180:183], v1 offset:58368
 v_mfma_f32_16x16x32_bf16 a[240:243], a[216:219], a[176:179], a[240:243]
 global_load_dwordx4 a[208:211], v0, s[70:71] offset:-4096
 ds_read_b128 a[176:179], v1 offset:57344
 v_mfma_f32_16x16x32_bf16 v[132:135], a[216:219], a[168:171], v[132:135]
 ds_read_b128 a[168:171], v1 offset:53248
 v_mfma_f32_16x16x32_bf16 v[132:135], a[220:223], a[172:175], v[132:135]
 ds_read_b128 a[172:175], v1 offset:54272
 v_mfma_f32_16x16x32_bf16 v[128:131], a[220:223], a[164:167], v[128:131]
 ds_read_b128 a[164:167], v1 offset:50176
 v_mfma_f32_16x16x32_bf16 v[128:131], a[216:219], a[160:163], v[128:131]
 ds_read_b128 a[160:163], v1 offset:49152
 v_mfma_f32_16x16x32_bf16 v[124:127], a[216:219], a[152:155], v[124:127]
 ds_read_b128 a[152:155], v1 offset:45056
 v_mfma_f32_16x16x32_bf16 v[124:127], a[220:223], a[156:159], v[124:127]
 ds_read_b128 a[156:159], v1 offset:46080
 v_mfma_f32_16x16x32_bf16 v[120:123], a[220:223], a[148:151], v[120:123]
 ds_read_b128 a[148:151], v1 offset:41984
 v_mfma_f32_16x16x32_bf16 v[120:123], a[216:219], a[144:147], v[120:123]
 ds_read_b128 a[144:147], v1 offset:40960
 v_mfma_f32_16x16x32_bf16 v[116:119], a[216:219], a[136:139], v[116:119]
 ds_read_b128 a[136:139], v1 offset:36864
 v_mfma_f32_16x16x32_bf16 v[116:119], a[220:223], a[140:143], v[116:119]
 ds_read_b128 a[140:143], v1 offset:37888
 v_mfma_f32_16x16x32_bf16 v[112:115], a[220:223], a[132:135], v[112:115]
 ds_read_b128 a[132:135], v1 offset:33792
 v_mfma_f32_16x16x32_bf16 v[112:115], a[216:219], a[128:131], v[112:115]
 ds_read_b128 a[128:131], v1 offset:32768
 s_waitcnt vmcnt(8) lgkmcnt(8)
 v_mfma_f32_16x16x32_bf16 v[44:47], a[224:227], a[184:187], v[44:47]
 v_mfma_f32_16x16x32_bf16 v[44:47], a[228:231], a[188:191], v[44:47]
 global_load_dwordx4 a[220:223], v0, s[70:71] offset:-1024
 v_mfma_f32_16x16x32_bf16 v[40:43], a[228:231], a[180:183], v[40:43]
 v_mfma_f32_16x16x32_bf16 v[40:43], a[224:227], a[176:179], v[40:43]
 global_load_dwordx4 a[216:219], v0, s[70:71] offset:-2048
 v_mfma_f32_16x16x32_bf16 v[36:39], a[224:227], a[168:171], v[36:39]
 v_mfma_f32_16x16x32_bf16 v[36:39], a[228:231], a[172:175], v[36:39]
 v_mfma_f32_16x16x32_bf16 v[32:35], a[228:231], a[164:167], v[32:35]
 v_mfma_f32_16x16x32_bf16 v[32:35], a[224:227], a[160:163], v[32:35]
 s_waitcnt lgkmcnt(0)
 v_mfma_f32_16x16x32_bf16 v[28:31], a[224:227], a[152:155], v[28:31]
 v_mfma_f32_16x16x32_bf16 v[28:31], a[228:231], a[156:159], v[28:31]
 v_mfma_f32_16x16x32_bf16 v[24:27], a[228:231], a[148:151], v[24:27]
 v_mfma_f32_16x16x32_bf16 v[24:27], a[224:227], a[144:147], v[24:27]
 v_mfma_f32_16x16x32_bf16 v[20:23], a[224:227], a[136:139], v[20:23]
 v_mfma_f32_16x16x32_bf16 v[20:23], a[228:231], a[140:143], v[20:23]
 v_mfma_f32_16x16x32_bf16 v[16:19], a[228:231], a[132:135], v[16:19]
 v_mfma_f32_16x16x32_bf16 v[16:19], a[224:227], a[128:131], v[16:19]
 s_waitcnt vmcnt(8)
 v_mfma_f32_16x16x32_bf16 v[48:51], a[232:235], a[128:131], v[48:51]
 v_mfma_f32_16x16x32_bf16 v[48:51], a[236:239], a[132:135], v[48:51]
 global_load_dwordx4 a[228:231], v0, s[70:71] offset:1024
 v_mfma_f32_16x16x32_bf16 v[52:55], a[236:239], a[140:143], v[52:55]
 v_mfma_f32_16x16x32_bf16 v[52:55], a[232:235], a[136:139], v[52:55]
 global_load_dwordx4 a[224:227], v0, s[70:71] offset:0
 v_mfma_f32_16x16x32_bf16 v[56:59], a[232:235], a[144:147], v[56:59]
 v_mfma_f32_16x16x32_bf16 v[56:59], a[236:239], a[148:151], v[56:59]
 v_mfma_f32_16x16x32_bf16 v[60:63], a[236:239], a[156:159], v[60:63]
 v_mfma_f32_16x16x32_bf16 v[60:63], a[232:235], a[152:155], v[60:63]
 v_mfma_f32_16x16x32_bf16 v[64:67], a[232:235], a[160:163], v[64:67]
 v_mfma_f32_16x16x32_bf16 v[64:67], a[236:239], a[164:167], v[64:67]
 v_mfma_f32_16x16x32_bf16 v[68:71], a[236:239], a[172:175], v[68:71]
 v_mfma_f32_16x16x32_bf16 v[68:71], a[232:235], a[168:171], v[68:71]
 v_mfma_f32_16x16x32_bf16 v[72:75], a[232:235], a[176:179], v[72:75]
 v_mfma_f32_16x16x32_bf16 v[72:75], a[236:239], a[180:183], v[72:75]
 v_mfma_f32_16x16x32_bf16 v[76:79], a[236:239], a[188:191], v[76:79]
 v_mfma_f32_16x16x32_bf16 v[76:79], a[232:235], a[184:187], v[76:79]
 s_waitcnt vmcnt(8)
 v_mfma_f32_16x16x32_bf16 v[108:111], a[192:195], a[184:187], v[108:111]
 v_mfma_f32_16x16x32_bf16 v[108:111], a[196:199], a[188:191], v[108:111]
 global_load_dwordx4 a[236:239], v0, s[70:71] offset:3072
 v_mfma_f32_16x16x32_bf16 v[104:107], a[196:199], a[180:183], v[104:107]
 v_mfma_f32_16x16x32_bf16 v[104:107], a[192:195], a[176:179], v[104:107]
 global_load_dwordx4 a[232:235], v0, s[70:71] offset:2048
 v_mfma_f32_16x16x32_bf16 v[100:103], a[192:195], a[168:171], v[100:103]
 s_add_u32 s70, s70, 8192
 s_addc_u32 s71, s71, 0
 v_mfma_f32_16x16x32_bf16 v[100:103], a[196:199], a[172:175], v[100:103]
 v_mfma_f32_16x16x32_bf16 v[96:99], a[196:199], a[164:167], v[96:99]
 v_mfma_f32_16x16x32_bf16 v[96:99], a[192:195], a[160:163], v[96:99]
 v_mfma_f32_16x16x32_bf16 v[92:95], a[192:195], a[152:155], v[92:95]
 v_mfma_f32_16x16x32_bf16 v[92:95], a[196:199], a[156:159], v[92:95]
 v_mfma_f32_16x16x32_bf16 v[88:91], a[196:199], a[148:151], v[88:91]
 v_mfma_f32_16x16x32_bf16 v[88:91], a[192:195], a[144:147], v[88:91]
 v_mfma_f32_16x16x32_bf16 v[84:87], a[192:195], a[136:139], v[84:87]
 v_mfma_f32_16x16x32_bf16 v[84:87], a[196:199], a[140:143], v[84:87]
 v_mfma_f32_16x16x32_bf16 v[80:83], a[196:199], a[132:135], v[80:83]
 v_mfma_f32_16x16x32_bf16 v[80:83], a[192:195], a[128:131], v[80:83]
 s_waitcnt vmcnt(8)
 v_mfma_f32_16x16x32_bf16 v[112:115], a[200:203], a[128:131], v[112:115]
 ds_read_b128 a[128:131], v2
 v_mfma_f32_16x16x32_bf16 v[112:115], a[204:207], a[132:135], v[112:115]
 global_load_dwordx4 a[196:199], v0, s[70:71] offset:-3072
 ds_read_b128 a[132:135], v2 offset:1024
 v_mfma_f32_16x16x32_bf16 v[116:119], a[204:207], a[140:143], v[116:119]
 ds_read_b128 a[140:143], v2 offset:5120
 v_mfma_f32_16x16x32_bf16 v[116:119], a[200:203], a[136:139], v[116:119]
 global_load_dwordx4 a[192:195], v0, s[70:71] offset:-4096
 ds_read_b128 a[136:139], v2 offset:4096
 v_mfma_f32_16x16x32_bf16 v[120:123], a[200:203], a[144:147], v[120:123]
 ds_read_b128 a[144:147], v2 offset:8192
 v_mfma_f32_16x16x32_bf16 v[120:123], a[204:207], a[148:151], v[120:123]
 ds_read_b128 a[148:151], v2 offset:9216
 v_mfma_f32_16x16x32_bf16 v[124:127], a[204:207], a[156:159], v[124:127]
 ds_read_b128 a[156:159], v2 offset:13312
 v_mfma_f32_16x16x32_bf16 v[124:127], a[200:203], a[152:155], v[124:127]
 ds_read_b128 a[152:155], v2 offset:12288
 v_mfma_f32_16x16x32_bf16 v[128:131], a[200:203], a[160:163], v[128:131]
 ds_read_b128 a[160:163], v2 offset:16384
 v_mfma_f32_16x16x32_bf16 v[128:131], a[204:207], a[164:167], v[128:131]
 ds_read_b128 a[164:167], v2 offset:17408
 v_mfma_f32_16x16x32_bf16 v[132:135], a[204:207], a[172:175], v[132:135]
 ds_read_b128 a[172:175], v2 offset:21504
 v_mfma_f32_16x16x32_bf16 v[132:135], a[200:203], a[168:171], v[132:135]
 ds_read_b128 a[168:171], v2 offset:20480
 v_mfma_f32_16x16x32_bf16 a[240:243], a[200:203], a[176:179], a[240:243]
 ds_read_b128 a[176:179], v2 offset:24576
 v_mfma_f32_16x16x32_bf16 a[240:243], a[204:207], a[180:183], a[240:243]
 ds_read_b128 a[180:183], v2 offset:25600
 v_mfma_f32_16x16x32_bf16 a[244:247], a[204:207], a[188:191], a[244:247]
 ds_read_b128 a[188:191], v2 offset:29696
 v_mfma_f32_16x16x32_bf16 a[244:247], a[200:203], a[184:187], a[244:247]
 ds_read_b128 a[184:187], v2 offset:28672
 s_waitcnt vmcnt(8) lgkmcnt(8)
 v_mfma_f32_16x16x32_bf16 v[16:19], a[208:211], a[128:131], v[16:19]
 v_mfma_f32_16x16x32_bf16 v[16:19], a[212:215], a[132:135], v[16:19]
 global_load_dwordx4 a[204:207], v0, s[70:71] offset:-1024
 v_mfma_f32_16x16x32_bf16 v[20:23], a[212:215], a[140:143], v[20:23]
 v_mfma_f32_16x16x32_bf16 v[20:23], a[208:211], a[136:139], v[20:23]
 global_load_dwordx4 a[200:203], v0, s[70:71] offset:-2048
 v_mfma_f32_16x16x32_bf16 v[24:27], a[208:211], a[144:147], v[24:27]
 v_mfma_f32_16x16x32_bf16 v[24:27], a[212:215], a[148:151], v[24:27]
 v_mfma_f32_16x16x32_bf16 v[28:31], a[212:215], a[156:159], v[28:31]
 v_mfma_f32_16x16x32_bf16 v[28:31], a[208:211], a[152:155], v[28:31]
 s_waitcnt lgkmcnt(0)
 v_mfma_f32_16x16x32_bf16 v[32:35], a[208:211], a[160:163], v[32:35]
 v_mfma_f32_16x16x32_bf16 v[32:35], a[212:215], a[164:167], v[32:35]
 v_mfma_f32_16x16x32_bf16 v[36:39], a[212:215], a[172:175], v[36:39]
 v_mfma_f32_16x16x32_bf16 v[36:39], a[208:211], a[168:171], v[36:39]
 v_mfma_f32_16x16x32_bf16 v[40:43], a[208:211], a[176:179], v[40:43]
 v_mfma_f32_16x16x32_bf16 v[40:43], a[212:215], a[180:183], v[40:43]
 v_mfma_f32_16x16x32_bf16 v[44:47], a[212:215], a[188:191], v[44:47]
 v_mfma_f32_16x16x32_bf16 v[44:47], a[208:211], a[184:187], v[44:47]
 s_waitcnt vmcnt(8)
 v_mfma_f32_16x16x32_bf16 v[76:79], a[216:219], a[184:187], v[76:79]
 v_mfma_f32_16x16x32_bf16 v[76:79], a[220:223], a[188:191], v[76:79]
 global_load_dwordx4 a[212:215], v0, s[70:71] offset:1024
 v_mfma_f32_16x16x32_bf16 v[72:75], a[220:223], a[180:183], v[72:75]
 v_mfma_f32_16x16x32_bf16 v[72:75], a[216:219], a[176:179], v[72:75]
 global_load_dwordx4 a[208:211], v0, s[70:71] offset:0
 v_mfma_f32_16x16x32_bf16 v[68:71], a[216:219], a[168:171], v[68:71]
 v_mfma_f32_16x16x32_bf16 v[68:71], a[220:223], a[172:175], v[68:71]
 v_mfma_f32_16x16x32_bf16 v[64:67], a[220:223], a[164:167], v[64:67]
 v_mfma_f32_16x16x32_bf16 v[64:67], a[216:219], a[160:163], v[64:67]
 v_mfma_f32_16x16x32_bf16 v[60:63], a[216:219], a[152:155], v[60:63]
 v_mfma_f32_16x16x32_bf16 v[60:63], a[220:223], a[156:159], v[60:63]
 v_mfma_f32_16x16x32_bf16 v[56:59], a[220:223], a[148:151], v[56:59]
 v_mfma_f32_16x16x32_bf16 v[56:59], a[216:219], a[144:147], v[56:59]
 v_mfma_f32_16x16x32_bf16 v[52:55], a[216:219], a[136:139], v[52:55]
 v_mfma_f32_16x16x32_bf16 v[52:55], a[220:223], a[140:143], v[52:55]
 v_mfma_f32_16x16x32_bf16 v[48:51], a[220:223], a[132:135], v[48:51]
 v_mfma_f32_16x16x32_bf16 v[48:51], a[216:219], a[128:131], v[48:51]
 s_waitcnt vmcnt(8)
 v_mfma_f32_16x16x32_bf16 v[80:83], a[224:227], a[128:131], v[80:83]
 v_mfma_f32_16x16x32_bf16 v[80:83], a[228:231], a[132:135], v[80:83]
 global_load_dwordx4 a[220:223], v0, s[70:71] offset:3072
 v_mfma_f32_16x16x32_bf16 v[84:87], a[228:231], a[140:143], v[84:87]
 v_mfma_f32_16x16x32_bf16 v[84:87], a[224:227], a[136:139], v[84:87]
 global_load_dwordx4 a[216:219], v0, s[70:71] offset:2048
 v_mfma_f32_16x16x32_bf16 v[88:91], a[224:227], a[144:147], v[88:91]
 s_add_u32 s70, s70, 8192
 s_addc_u32 s71, s71, 0
 v_mfma_f32_16x16x32_bf16 v[88:91], a[228:231], a[148:151], v[88:91]
 v_mfma_f32_16x16x32_bf16 v[92:95], a[228:231], a[156:159], v[92:95]
 v_mfma_f32_16x16x32_bf16 v[92:95], a[224:227], a[152:155], v[92:95]
 v_mfma_f32_16x16x32_bf16 v[96:99], a[224:227], a[160:163], v[96:99]
 v_mfma_f32_16x16x32_bf16 v[96:99], a[228:231], a[164:167], v[96:99]
 v_mfma_f32_16x16x32_bf16 v[100:103], a[228:231], a[172:175], v[100:103]
 v_mfma_f32_16x16x32_bf16 v[100:103], a[224:227], a[168:171], v[100:103]
 v_mfma_f32_16x16x32_bf16 v[104:107], a[224:227], a[176:179], v[104:107]
 v_mfma_f32_16x16x32_bf16 v[104:107], a[228:231], a[180:183], v[104:107]
 v_mfma_f32_16x16x32_bf16 v[108:111], a[228:231], a[188:191], v[108:111]
 v_mfma_f32_16x16x32_bf16 v[108:111], a[224:227], a[184:187], v[108:111]
 s_waitcnt vmcnt(8)
 v_mfma_f32_16x16x32_bf16 a[244:247], a[232:235], a[184:187], a[244:247]
 ds_read_b128 a[184:187], v2 offset:61440
 v_mfma_f32_16x16x32_bf16 a[244:247], a[236:239], a[188:191], a[244:247]
 global_load_dwordx4 a[228:231], v0, s[70:71] offset:-3072
 ds_read_b128 a[188:191], v2 offset:62464
 v_mfma_f32_16x16x32_bf16 a[240:243], a[236:239], a[180:183], a[240:243]
 ds_read_b128 a[180:183], v2 offset:58368
 v_mfma_f32_16x16x32_bf16 a[240:243], a[232:235], a[176:179], a[240:243]
 global_load_dwordx4 a[224:227], v0, s[70:71] offset:-4096
 ds_read_b128 a[176:179], v2 offset:57344
 v_mfma_f32_16x16x32_bf16 v[132:135], a[232:235], a[168:171], v[132:135]
 ds_read_b128 a[168:171], v2 offset:53248
 v_mfma_f32_16x16x32_bf16 v[132:135], a[236:239], a[172:175], v[132:135]
 ds_read_b128 a[172:175], v2 offset:54272
 v_mfma_f32_16x16x32_bf16 v[128:131], a[236:239], a[164:167], v[128:131]
 ds_read_b128 a[164:167], v2 offset:50176
 v_mfma_f32_16x16x32_bf16 v[128:131], a[232:235], a[160:163], v[128:131]
 ds_read_b128 a[160:163], v2 offset:49152
 v_mfma_f32_16x16x32_bf16 v[124:127], a[232:235], a[152:155], v[124:127]
 ds_read_b128 a[152:155], v2 offset:45056
 v_mfma_f32_16x16x32_bf16 v[124:127], a[236:239], a[156:159], v[124:127]
 ds_read_b128 a[156:159], v2 offset:46080
 v_mfma_f32_16x16x32_bf16 v[120:123], a[236:239], a[148:151], v[120:123]
 ds_read_b128 a[148:151], v2 offset:41984
 v_mfma_f32_16x16x32_bf16 v[120:123], a[232:235], a[144:147], v[120:123]
 ds_read_b128 a[144:147], v2 offset:40960
 v_mfma_f32_16x16x32_bf16 v[116:119], a[232:235], a[136:139], v[116:119]
 ds_read_b128 a[136:139], v2 offset:36864
 v_mfma_f32_16x16x32_bf16 v[116:119], a[236:239], a[140:143], v[116:119]
 ds_read_b128 a[140:143], v2 offset:37888
 v_mfma_f32_16x16x32_bf16 v[112:115], a[236:239], a[132:135], v[112:115]
 ds_read_b128 a[132:135], v2 offset:33792
 v_mfma_f32_16x16x32_bf16 v[112:115], a[232:235], a[128:131], v[112:115]
 ds_read_b128 a[128:131], v2 offset:32768
 s_waitcnt vmcnt(8) lgkmcnt(8)
 v_mfma_f32_16x16x32_bf16 v[44:47], a[192:195], a[184:187], v[44:47]
 v_mfma_f32_16x16x32_bf16 v[44:47], a[196:199], a[188:191], v[44:47]
 global_load_dwordx4 a[236:239], v0, s[70:71] offset:-1024
 v_mfma_f32_16x16x32_bf16 v[40:43], a[196:199], a[180:183], v[40:43]
 v_mfma_f32_16x16x32_bf16 v[40:43], a[192:195], a[176:179], v[40:43]
 global_load_dwordx4 a[232:235], v0, s[70:71] offset:-2048
 v_mfma_f32_16x16x32_bf16 v[36:39], a[192:195], a[168:171], v[36:39]
 v_mfma_f32_16x16x32_bf16 v[36:39], a[196:199], a[172:175], v[36:39]
 v_mfma_f32_16x16x32_bf16 v[32:35], a[196:199], a[164:167], v[32:35]
 v_mfma_f32_16x16x32_bf16 v[32:35], a[192:195], a[160:163], v[32:35]
 s_waitcnt lgkmcnt(0)
 v_mfma_f32_16x16x32_bf16 v[28:31], a[192:195], a[152:155], v[28:31]
 v_mfma_f32_16x16x32_bf16 v[28:31], a[196:199], a[156:159], v[28:31]
 v_mfma_f32_16x16x32_bf16 v[24:27], a[196:199], a[148:151], v[24:27]
 v_mfma_f32_16x16x32_bf16 v[24:27], a[192:195], a[144:147], v[24:27]
 v_mfma_f32_16x16x32_bf16 v[20:23], a[192:195], a[136:139], v[20:23]
 v_mfma_f32_16x16x32_bf16 v[20:23], a[196:199], a[140:143], v[20:23]
 v_mfma_f32_16x16x32_bf16 v[16:19], a[196:199], a[132:135], v[16:19]
 v_mfma_f32_16x16x32_bf16 v[16:19], a[192:195], a[128:131], v[16:19]
 s_waitcnt vmcnt(8)
 v_mfma_f32_16x16x32_bf16 v[48:51], a[200:203], a[128:131], v[48:51]
 v_mfma_f32_16x16x32_bf16 v[48:51], a[204:207], a[132:135], v[48:51]
 global_load_dwordx4 a[196:199], v0, s[70:71] offset:1024
 v_mfma_f32_16x16x32_bf16 v[52:55], a[204:207], a[140:143], v[52:55]
 v_mfma_f32_16x16x32_bf16 v[52:55], a[200:203], a[136:139], v[52:55]
 global_load_dwordx4 a[192:195], v0, s[70:71] offset:0
 v_mfma_f32_16x16x32_bf16 v[56:59], a[200:203], a[144:147], v[56:59]
 v_mfma_f32_16x16x32_bf16 v[56:59], a[204:207], a[148:151], v[56:59]
 v_mfma_f32_16x16x32_bf16 v[60:63], a[204:207], a[156:159], v[60:63]
 v_mfma_f32_16x16x32_bf16 v[60:63], a[200:203], a[152:155], v[60:63]
 v_mfma_f32_16x16x32_bf16 v[64:67], a[200:203], a[160:163], v[64:67]
 v_mfma_f32_16x16x32_bf16 v[64:67], a[204:207], a[164:167], v[64:67]
 v_mfma_f32_16x16x32_bf16 v[68:71], a[204:207], a[172:175], v[68:71]
 v_mfma_f32_16x16x32_bf16 v[68:71], a[200:203], a[168:171], v[68:71]
 v_mfma_f32_16x16x32_bf16 v[72:75], a[200:203], a[176:179], v[72:75]
 v_mfma_f32_16x16x32_bf16 v[72:75], a[204:207], a[180:183], v[72:75]
 v_mfma_f32_16x16x32_bf16 v[76:79], a[204:207], a[188:191], v[76:79]
 v_mfma_f32_16x16x32_bf16 v[76:79], a[200:203], a[184:187], v[76:79]
 s_waitcnt vmcnt(8)
 v_mfma_f32_16x16x32_bf16 v[108:111], a[208:211], a[184:187], v[108:111]
 v_mfma_f32_16x16x32_bf16 v[108:111], a[212:215], a[188:191], v[108:111]
 global_load_dwordx4 a[204:207], v0, s[70:71] offset:3072
 v_mfma_f32_16x16x32_bf16 v[104:107], a[212:215], a[180:183], v[104:107]
 v_mfma_f32_16x16x32_bf16 v[104:107], a[208:211], a[176:179], v[104:107]
 global_load_dwordx4 a[200:203], v0, s[70:71] offset:2048
 v_mfma_f32_16x16x32_bf16 v[100:103], a[208:211], a[168:171], v[100:103]
 s_add_u32 s70, s70, 8192
 s_addc_u32 s71, s71, 0
 v_mfma_f32_16x16x32_bf16 v[100:103], a[212:215], a[172:175], v[100:103]
 v_mfma_f32_16x16x32_bf16 v[96:99], a[212:215], a[164:167], v[96:99]
 v_mfma_f32_16x16x32_bf16 v[96:99], a[208:211], a[160:163], v[96:99]
 v_mfma_f32_16x16x32_bf16 v[92:95], a[208:211], a[152:155], v[92:95]
 v_mfma_f32_16x16x32_bf16 v[92:95], a[212:215], a[156:159], v[92:95]
 v_mfma_f32_16x16x32_bf16 v[88:91], a[212:215], a[148:151], v[88:91]
 v_mfma_f32_16x16x32_bf16 v[88:91], a[208:211], a[144:147], v[88:91]
 v_mfma_f32_16x16x32_bf16 v[84:87], a[208:211], a[136:139], v[84:87]
 v_mfma_f32_16x16x32_bf16 v[84:87], a[212:215], a[140:143], v[84:87]
 v_mfma_f32_16x16x32_bf16 v[80:83], a[212:215], a[132:135], v[80:83]
 v_mfma_f32_16x16x32_bf16 v[80:83], a[208:211], a[128:131], v[80:83]
 s_waitcnt vmcnt(8)
 v_mfma_f32_16x16x32_bf16 v[112:115], a[216:219], a[128:131], v[112:115]
 ds_read_b128 a[128:131], v1
 v_mfma_f32_16x16x32_bf16 v[112:115], a[220:223], a[132:135], v[112:115]
 global_load_dwordx4 a[212:215], v0, s[70:71] offset:-3072
 ds_read_b128 a[132:135], v1 offset:1024
 v_mfma_f32_16x16x32_bf16 v[116:119], a[220:223], a[140:143], v[116:119]
 ds_read_b128 a[140:143], v1 offset:5120
 v_mfma_f32_16x16x32_bf16 v[116:119], a[216:219], a[136:139], v[116:119]
 global_load_dwordx4 a[208:211], v0, s[70:71] offset:-4096
 ds_read_b128 a[136:139], v1 offset:4096
 v_mfma_f32_16x16x32_bf16 v[120:123], a[216:219], a[144:147], v[120:123]
 ds_read_b128 a[144:147], v1 offset:8192
 v_mfma_f32_16x16x32_bf16 v[120:123], a[220:223], a[148:151], v[120:123]
 ds_read_b128 a[148:151], v1 offset:9216
 v_mfma_f32_16x16x32_bf16 v[124:127], a[220:223], a[156:159], v[124:127]
 ds_read_b128 a[156:159], v1 offset:13312
 v_mfma_f32_16x16x32_bf16 v[124:127], a[216:219], a[152:155], v[124:127]
 ds_read_b128 a[152:155], v1 offset:12288
 v_mfma_f32_16x16x32_bf16 v[128:131], a[216:219], a[160:163], v[128:131]
 ds_read_b128 a[160:163], v1 offset:16384
 v_mfma_f32_16x16x32_bf16 v[128:131], a[220:223], a[164:167], v[128:131]
 ds_read_b128 a[164:167], v1 offset:17408
 v_mfma_f32_16x16x32_bf16 v[132:135], a[220:223], a[172:175], v[132:135]
 ds_read_b128 a[172:175], v1 offset:21504
 v_mfma_f32_16x16x32_bf16 v[132:135], a[216:219], a[168:171], v[132:135]
 ds_read_b128 a[168:171], v1 offset:20480
 v_mfma_f32_16x16x32_bf16 a[240:243], a[216:219], a[176:179], a[240:243]
 ds_read_b128 a[176:179], v1 offset:24576
 v_mfma_f32_16x16x32_bf16 a[240:243], a[220:223], a[180:183], a[240:243]
 ds_read_b128 a[180:183], v1 offset:25600
 v_mfma_f32_16x16x32_bf16 a[244:247], a[220:223], a[188:191], a[244:247]
 global_load_dwordx4 a[220:223], v0, s[70:71] offset:-1024
 ds_read_b128 a[188:191], v1 offset:29696
 v_mfma_f32_16x16x32_bf16 a[244:247], a[216:219], a[184:187], a[244:247]
 global_load_dwordx4 a[216:219], v0, s[70:71] offset:-2048
 ds_read_b128 a[184:187], v1 offset:28672
 s_waitcnt vmcnt(10) lgkmcnt(8)
Ls1b:
 v_mfma_f32_16x16x32_bf16 v[136:139], a[224:227], a[128:131], v[136:139]
 v_lshrrev_b32 v4, 8, v1
 v_mfma_f32_16x16x32_bf16 v[136:139], a[228:231], a[132:135], v[136:139]
 v_mfma_f32_16x16x32_bf16 v[140:143], a[228:231], a[140:143], v[140:143]
 v_lshl_add_u32 v4, v4, 5, s51
 v_mfma_f32_16x16x32_bf16 v[140:143], a[224:227], a[136:139], v[140:143]
 ds_read_b128 v[8:11], v4
 v_mfma_f32_16x16x32_bf16 v[144:147], a[224:227], a[144:147], v[144:147]
 v_mfma_f32_16x16x32_bf16 v[144:147], a[228:231], a[148:151], v[144:147]
 v_mfma_f32_16x16x32_bf16 v[148:151], a[228:231], a[156:159], v[148:151]
 v_mfma_f32_16x16x32_bf16 v[148:151], a[224:227], a[152:155], v[148:151]
 s_waitcnt lgkmcnt(1)
 v_mfma_f32_16x16x32_bf16 v[152:155], a[224:227], a[160:163], v[152:155]
 v_mfma_f32_16x16x32_bf16 v[152:155], a[228:231], a[164:167], v[152:155]
 v_mfma_f32_16x16x32_bf16 v[156:159], a[228:231], a[172:175], v[156:159]
 v_mfma_f32_16x16x32_bf16 v[156:159], a[224:227], a[168:171], v[156:159]
 v_mfma_f32_16x16x32_bf16 v[160:163], a[224:227], a[176:179], v[160:163]
 v_mfma_f32_16x16x32_bf16 v[160:163], a[228:231], a[180:183], v[160:163]
 v_mfma_f32_16x16x32_bf16 v[164:167], a[228:231], a[188:191], v[164:167]
 v_mfma_f32_16x16x32_bf16 v[164:167], a[224:227], a[184:187], v[164:167]
 s_waitcnt vmcnt(8)
 v_mfma_f32_16x16x32_bf16 v[196:199], a[232:235], a[184:187], v[196:199]
 s_waitcnt lgkmcnt(0)
 v_mfma_f32_16x16x32_bf16 v[196:199], a[236:239], a[188:191], v[196:199]
 global_load_dwordx4 a[228:231], v0, s[70:71] offset:1024
 v_add_f32 v16, v16, v8
 v_mfma_f32_16x16x32_bf16 v[192:195], a[236:239], a[180:183], v[192:195]
 ds_read_b128 v[12:15], v4 offset:16
 v_mfma_f32_16x16x32_bf16 v[192:195], a[232:235], a[176:179], v[192:195]
 global_load_dwordx4 a[224:227], v0, s[70:71] offset:0
 v_mfma_f32_16x16x32_bf16 v[188:191], a[232:235], a[168:171], v[188:191]
 v_add_f32 v17, v17, v9
 v_mfma_f32_16x16x32_bf16 v[188:191], a[236:239], a[172:175], v[188:191]
 v_add_f32 v18, v18, v10
 v_mfma_f32_16x16x32_bf16 v[184:187], a[236:239], a[164:167], v[184:187]
 v_mfma_f32_16x16x32_bf16 v[184:187], a[232:235], a[160:163], v[184:187]
 v_add_f32 v19, v19, v11
 v_mfma_f32_16x16x32_bf16 v[180:183], a[232:235], a[152:155], v[180:183]
 v_add_f32 v20, v20, v8
 v_mfma_f32_16x16x32_bf16 v[180:183], a[236:239], a[156:159], v[180:183]
 v_add_f32 v21, v21, v9
 v_mfma_f32_16x16x32_bf16 v[176:179], a[236:239], a[148:151], v[176:179]
 v_mfma_f32_16x16x32_bf16 v[176:179], a[232:235], a[144:147], v[176:179]
 v_add_f32 v22, v22, v10
 v_mfma_f32_16x16x32_bf16 v[172:175], a[232:235], a[136:139], v[172:175]
 v_add_f32 v23, v23, v11
 v_mfma_f32_16x16x32_bf16 v[172:175], a[236:239], a[140:143], v[172:175]
 v_mfma_f32_16x16x32_bf16 v[168:171], a[236:239], a[132:135], v[168:171]
 v_add_f32 v24, v24, v8
 v_mfma_f32_16x16x32_bf16 v[168:171], a[232:235], a[128:131], v[168:171]
 v_add_f32 v25, v25, v9
 s_waitcnt vmcnt(8)
 v_mfma_f32_16x16x32_bf16 v[200:203], a[192:195], a[128:131], v[200:203]
 v_add_f32 v26, v26, v10
 v_mfma_f32_16x16x32_bf16 v[200:203], a[196:199], a[132:135], v[200:203]
 global_load_dwordx4 a[236:239], v0, s[70:71] offset:3072
 v_mfma_f32_16x16x32_bf16 v[204:207], a[196:199], a[140:143], v[204:207]
 v_add_f32 v27, v27, v11
 v_mfma_f32_16x16x32_bf16 v[204:207], a[192:195], a[136:139], v[204:207]
 global_load_dwordx4 a[232:235], v0, s[70:71] offset:2048
 v_add_f32 v28, v28, v8
 v_mfma_f32_16x16x32_bf16 v[208:211], a[192:195], a[144:147], v[208:211]
 s_add_u32 s70, s70, 8192
 s_addc_u32 s71, s71, 0
 v_mfma_f32_16x16x32_bf16 v[208:211], a[196:199], a[148:151], v[208:211]
 v_add_f32 v29, v29, v9
 v_mfma_f32_16x16x32_bf16 v[212:215], a[196:199], a[156:159], v[212:215]
 v_add_f32 v30, v30, v10
 v_mfma_f32_16x16x32_bf16 v[212:215], a[192:195], a[152:155], v[212:215]
 v_add_f32 v31, v31, v11
 v_mfma_f32_16x16x32_bf16 v[216:219], a[192:195], a[160:163], v[216:219]
 v_mfma_f32_16x16x32_bf16 v[216:219], a[196:199], a[164:167], v[216:219]
 v_add_f32 v32, v32, v8
 v_mfma_f32_16x16x32_bf16 v[220:223], a[196:199], a[172:175], v[220:223]
 v_add_f32 v33, v33, v9
 v_mfma_f32_16x16x32_bf16 v[220:223], a[192:195], a[168:171], v[220:223]
 v_mfma_f32_16x16x32_bf16 v[224:227], a[192:195], a[176:179], v[224:227]
 v_add_f32 v34, v34, v10
 v_mfma_f32_16x16x32_bf16 v[224:227], a[196:199], a[180:183], v[224:227]
 v_add_f32 v35, v35, v11
 v_mfma_f32_16x16x32_bf16 v[228:231], a[196:199], a[188:191], v[228:231]
 v_add_f32 v36, v36, v8
 v_mfma_f32_16x16x32_bf16 v[228:231], a[192:195], a[184:187], v[228:231]
 v_add_f32 v37, v37, v9
 s_waitcnt vmcnt(8)
 v_mfma_f32_16x16x32_bf16 a[252:255], a[200:203], a[184:187], a[252:255]
 ds_read_b128 a[184:187], v1 offset:61440
 v_add_f32 v38, v38, v10
 v_mfma_f32_16x16x32_bf16 a[252:255], a[204:207], a[188:191], a[252:255]
 global_load_dwordx4 a[196:199], v0, s[70:71] offset:-3072
 ds_read_b128 a[188:191], v1 offset:62464
 v_mfma_f32_16x16x32_bf16 a[248:251], a[204:207], a[180:183], a[248:251]
 ds_read_b128 a[180:183], v1 offset:58368
 v_add_f32 v39, v39, v11
 v_mfma_f32_16x16x32_bf16 a[248:251], a[200:203], a[176:179], a[248:251]
 global_load_dwordx4 a[192:195], v0, s[70:71] offset:-4096
 ds_read_b128 a[176:179], v1 offset:57344
 v_mfma_f32_16x16x32_bf16 v[252:255], a[200:203], a[168:171], v[252:255]
 ds_read_b128 a[168:171], v1 offset:53248
 v_add_f32 v40, v40, v8
 v_mfma_f32_16x16x32_bf16 v[252:255], a[204:207], a[172:175], v[252:255]
 ds_read_b128 a[172:175], v1 offset:54272
 v_add_f32 v41, v41, v9
 v_mfma_f32_16x16x32_bf16 v[248:251], a[204:207], a[164:167], v[248:251]
 ds_read_b128 a[164:167], v1 offset:50176
 v_mfma_f32_16x16x32_bf16 v[248:251], a[200:203], a[160:163], v[248:251]
 ds_read_b128 a[160:163], v1 offset:49152
 v_add_f32 v42, v42, v10
 v_mfma_f32_16x16x32_bf16 v[244:247], a[200:203], a[152:155], v[244:247]
 ds_read_b128 a[152:155], v1 offset:45056
 v_add_f32 v43, v43, v11
 v_mfma_f32_16x16x32_bf16 v[244:247], a[204:207], a[156:159], v[244:247]
 ds_read_b128 a[156:159], v1 offset:46080
 v_mfma_f32_16x16x32_bf16 v[240:243], a[204:207], a[148:151], v[240:243]
 ds_read_b128 a[148:151], v1 offset:41984
 v_add_f32 v44, v44, v8
 v_mfma_f32_16x16x32_bf16 v[240:243], a[200:203], a[144:147], v[240:243]
 ds_read_b128 a[144:147], v1 offset:40960
 v_add_f32 v45, v45, v9
 v_mfma_f32_16x16x32_bf16 v[236:239], a[200:203], a[136:139], v[236:239]
 ds_read_b128 a[136:139], v1 offset:36864
 v_add_f32 v46, v46, v10
 v_mfma_f32_16x16x32_bf16 v[236:239], a[204:207], a[140:143], v[236:239]
 ds_read_b128 a[140:143], v1 offset:37888
 v_mfma_f32_16x16x32_bf16 v[232:235], a[204:207], a[132:135], v[232:235]
 ds_read_b128 a[132:135], v1 offset:33792
 v_add_f32 v47, v47, v11
 v_mfma_f32_16x16x32_bf16 v[232:235], a[200:203], a[128:131], v[232:235]
 ds_read_b128 a[128:131], v1 offset:32768
 s_waitcnt lgkmcnt(15)
 s_waitcnt vmcnt(8) lgkmcnt(8)
 v_mfma_f32_16x16x32_bf16 v[164:167], a[208:211], a[184:187], v[164:167]
 v_mfma_f32_16x16x32_bf16 v[164:167], a[212:215], a[188:191], v[164:167]
 global_load_dwordx4 a[204:207], v0, s[70:71] offset:-1024
 v_add_f32 v48, v48, v12
 v_mfma_f32_16x16x32_bf16 v[160:163], a[212:215], a[180:183], v[160:163]
 ds_read_b128 v[8:11], v4 offset:128
 v_mfma_f32_16x16x32_bf16 v[160:163], a[208:211], a[176:179], v[160:163]
 global_load_dwordx4 a[200:203], v0, s[70:71] offset:-2048
 v_add_f32 v49, v49, v13
 v_mfma_f32_16x16x32_bf16 v[156:159], a[208:211], a[168:171], v[156:159]
 v_mfma_f32_16x16x32_bf16 v[156:159], a[212:215], a[172:175], v[156:159]
 v_add_f32 v50, v50, v14
 v_mfma_f32_16x16x32_bf16 v[152:155], a[212:215], a[164:167], v[152:155]
 v_add_f32 v51, v51, v15
 v_mfma_f32_16x16x32_bf16 v[152:155], a[208:211], a[160:163], v[152:155]
 s_waitcnt lgkmcnt(1)
 v_mfma_f32_16x16x32_bf16 v[148:151], a[208:211], a[152:155], v[148:151]
 v_add_f32 v52, v52, v12
 v_mfma_f32_16x16x32_bf16 v[148:151], a[212:215], a[156:159], v[148:151]
 v_add_f32 v53, v53, v13
 v_mfma_f32_16x16x32_bf16 v[144:147], a[212:215], a[148:151], v[144:147]
 v_add_f32 v54, v54, v14
 v_mfma_f32_16x16x32_bf16 v[144:147], a[208:211], a[144:147], v[144:147]
 v_mfma_f32_16x16x32_bf16 v[140:143], a[208:211], a[136:139], v[140:143]
 v_add_f32 v55, v55, v15
 v_mfma_f32_16x16x32_bf16 v[140:143], a[212:215], a[140:143], v[140:143]
 v_add_f32 v56, v56, v12
 v_mfma_f32_16x16x32_bf16 v[136:139], a[212:215], a[132:135], v[136:139]
 v_mfma_f32_16x16x32_bf16 v[136:139], a[208:211], a[128:131], v[136:139]
 v_add_f32 v57, v57, v13
 s_waitcnt vmcnt(8)
 v_mfma_f32_16x16x32_bf16 v[168:171], a[216:219], a[128:131], v[168:171]
 v_add_f32 v58, v58, v14
 v_mfma_f32_16x16x32_bf16 v[168:171], a[220:223], a[132:135], v[168:171]
 global_load_dwordx4 a[212:215], v0, s[70:71] offset:1024
 v_add_f32 v59, v59, v15
 v_mfma_f32_16x16x32_bf16 v[172:175], a[220:223], a[140:143], v[172:175]
 v_mfma_f32_16x16x32_bf16 v[172:175], a[216:219], a[136:139], v[172:175]
 global_load_dwordx4 a[208:211], v0, s[70:71] offset:0
 v_add_f32 v60, v60, v12
 v_mfma_f32_16x16x32_bf16 v[176:179], a[216:219], a[144:147], v[176:179]
 v_add_f32 v61, v61, v13
 v_mfma_f32_16x16x32_bf16 v[176:179], a[220:223], a[148:151], v[176:179]
 v_mfma_f32_16x16x32_bf16 v[180:183], a[220:223], a[156:159], v[180:183]
 v_add_f32 v62, v62, v14
 v_mfma_f32_16x16x32_bf16 v[180:183], a[216:219], a[152:155], v[180:183]
 v_add_f32 v63, v63, v15
 v_mfma_f32_16x16x32_bf16 v[184:187], a[216:219], a[160:163], v[184:187]
 v_add_f32 v64, v64, v12
 v_mfma_f32_16x16x32_bf16 v[184:187], a[220:223], a[164:167], v[184:187]
 v_mfma_f32_16x16x32_bf16 v[188:191], a[220:223], a[172:175], v[188:191]
 v_add_f32 v65, v65, v13
 v_mfma_f32_16x16x32_bf16 v[188:191], a[216:219], a[168:171], v[188:191]
 v_add_f32 v66, v66, v14
 v_mfma_f32_16x16x32_bf16 v[192:195], a[216:219], a[176:179], v[192:195]
 v_mfma_f32_16x16x32_bf16 v[192:195], a[220:223], a[180:183], v[192:195]
 v_add_f32 v67, v67, v15
 v_mfma_f32_16x16x32_bf16 v[196:199], a[220:223], a[188:191], v[196:199]
 v_add_f32 v68, v68, v12
 v_mfma_f32_16x16x32_bf16 v[196:199], a[216:219], a[184:187], v[196:199]
 v_add_f32 v69, v69, v13
 s_waitcnt vmcnt(8)
 v_mfma_f32_16x16x32_bf16 v[228:231], a[224:227], a[184:187], v[228:231]
 v_mfma_f32_16x16x32_bf16 v[228:231], a[228:231], a[188:191], v[228:231]
 global_load_dwordx4 a[220:223], v0, s[70:71] offset:3072
 v_add_f32 v70, v70, v14
 v_mfma_f32_16x16x32_bf16 v[224:227], a[228:231], a[180:183], v[224:227]
 v_add_f32 v71, v71, v15
 v_mfma_f32_16x16x32_bf16 v[224:227], a[224:227], a[176:179], v[224:227]
 global_load_dwordx4 a[216:219], v0, s[70:71] offset:2048
 v_mfma_f32_16x16x32_bf16 v[220:223], a[224:227], a[168:171], v[220:223]
 v_add_f32 v72, v72, v12
 s_add_u32 s70, s70, 8192
 s_addc_u32 s71, s71, 0
 v_mfma_f32_16x16x32_bf16 v[220:223], a[228:231], a[172:175], v[220:223]
 s_add_u32 s31, s31, 1
 v_mfma_f32_16x16x32_bf16 v[216:219], a[228:231], a[164:167], v[216:219]
 v_mfma_f32_16x16x32_bf16 v[216:219], a[224:227], a[160:163], v[216:219]
 v_mfma_f32_16x16x32_bf16 v[212:215], a[224:227], a[152:155], v[212:215]
 v_mov_b32 v7, s31
 v_mfma_f32_16x16x32_bf16 v[212:215], a[228:231], a[156:159], v[212:215]
 buffer_store_dword v7, v1, s[60:63], 0 offen sc1
 v_mfma_f32_16x16x32_bf16 v[208:211], a[228:231], a[148:151], v[208:211]
 v_mfma_f32_16x16x32_bf16 v[208:211], a[224:227], a[144:147], v[208:211]
 v_add_f32 v73, v73, v13
 v_mfma_f32_16x16x32_bf16 v[204:207], a[224:227], a[136:139], v[204:207]
 v_add_f32 v74, v74, v14
 v_mfma_f32_16x16x32_bf16 v[204:207], a[228:231], a[140:143], v[204:207]
 v_add_f32 v75, v75, v15
 v_mfma_f32_16x16x32_bf16 v[200:203], a[228:231], a[132:135], v[200:203]
 v_mfma_f32_16x16x32_bf16 v[200:203], a[224:227], a[128:131], v[200:203]
 v_add_f32 v76, v76, v12
 s_waitcnt vmcnt(9)
 v_mfma_f32_16x16x32_bf16 v[232:235], a[232:235], a[128:131], v[232:235]
 ds_read_b128 a[128:131], v2
 v_add_f32 v77, v77, v13
 v_mfma_f32_16x16x32_bf16 v[232:235], a[236:239], a[132:135], v[232:235]
 global_load_dwordx4 a[228:231], v0, s[70:71] offset:-3072
 ds_read_b128 a[132:135], v2 offset:1024
 v_mfma_f32_16x16x32_bf16 v[236:239], a[236:239], a[140:143], v[236:239]
 ds_read_b128 a[140:143], v2 offset:5120
 v_add_f32 v78, v78, v14
 v_mfma_f32_16x16x32_bf16 v[236:239], a[232:235], a[136:139], v[236:239]
 global_load_dwordx4 a[224:227], v0, s[70:71] offset:-4096
 ds_read_b128 a[136:139], v2 offset:4096
 v_mfma_f32_16x16x32_bf16 v[240:243], a[232:235], a[144:147], v[240:243]
 ds_read_b128 a[144:147], v2 offset:8192
 v_add_f32 v79, v79, v15
 v_mfma_f32_16x16x32_bf16 v[240:243], a[236:239], a[148:151], v[240:243]
 ds_read_b128 a[148:151], v2 offset:9216
 s_waitcnt lgkmcnt(6)
 v_mfma_f32_16x16x32_bf16 v[244:247], a[236:239], a[156:159], v[244:247]
 ds_read_b128 a[156:159], v2 offset:13312
 v_add_f32 v80, v80, v8
 v_mfma_f32_16x16x32_bf16 v[244:247], a[232:235], a[152:155], v[244:247]
 ds_read_b128 a[152:155], v2 offset:12288
 ds_read_b128 v[12:15], v4 offset:144
 v_mfma_f32_16x16x32_bf16 v[248:251], a[232:235], a[160:163], v[248:251]
 ds_read_b128 a[160:163], v2 offset:16384
 v_mfma_f32_16x16x32_bf16 v[248:251], a[236:239], a[164:167], v[248:251]
 ds_read_b128 a[164:167], v2 offset:17408
 v_add_f32 v81, v81, v9
 v_mfma_f32_16x16x32_bf16 v[252:255], a[236:239], a[172:175], v[252:255]
 ds_read_b128 a[172:175], v2 offset:21504
 v_add_f32 v82, v82, v10
 v_mfma_f32_16x16x32_bf16 v[252:255], a[232:235], a[168:171], v[252:255]
 ds_read_b128 a[168:171], v2 offset:20480
 v_mfma_f32_16x16x32_bf16 a[248:251], a[232:235], a[176:179], a[248:251]
 ds_read_b128 a[176:179], v2 offset:24576
 v_add_f32 v83, v83, v11
 v_mfma_f32_16x16x32_bf16 a[248:251], a[236:239], a[180:183], a[248:251]
 ds_read_b128 a[180:183], v2 offset:25600
 v_add_f32 v84, v84, v8
 v_mfma_f32_16x16x32_bf16 a[252:255], a[236:239], a[188:191], a[252:255]
 ds_read_b128 a[188:191], v2 offset:29696
 v_add_f32 v85, v85, v9
 v_mfma_f32_16x16x32_bf16 a[252:255], a[232:235], a[184:187], a[252:255]
 ds_read_b128 a[184:187], v2 offset:28672
 s_waitcnt vmcnt(9) lgkmcnt(9)
 v_mfma_f32_16x16x32_bf16 v[136:139], a[192:195], a[128:131], v[136:139]
 v_add_f32 v86, v86, v10
 v_mfma_f32_16x16x32_bf16 v[136:139], a[196:199], a[132:135], v[136:139]
 global_load_dwordx4 a[236:239], v0, s[70:71] offset:-1024
 v_add_f32 v87, v87, v11
 v_mfma_f32_16x16x32_bf16 v[140:143], a[196:199], a[140:143], v[140:143]
 v_mfma_f32_16x16x32_bf16 v[140:143], a[192:195], a[136:139], v[140:143]
 global_load_dwordx4 a[232:235], v0, s[70:71] offset:-2048
 v_add_f32 v88, v88, v8
 v_mfma_f32_16x16x32_bf16 v[144:147], a[192:195], a[144:147], v[144:147]
 v_add_f32 v89, v89, v9
 v_mfma_f32_16x16x32_bf16 v[144:147], a[196:199], a[148:151], v[144:147]
 v_add_f32 v90, v90, v10
 v_mfma_f32_16x16x32_bf16 v[148:151], a[196:199], a[156:159], v[148:151]
 v_mfma_f32_16x16x32_bf16 v[148:151], a[192:195], a[152:155], v[148:151]
 v_add_f32 v91, v91, v11
 s_waitcnt lgkmcnt(0)
 v_mfma_f32_16x16x32_bf16 v[152:155], a[192:195], a[160:163], v[152:155]
 v_add_f32 v92, v92, v8
 v_mfma_f32_16x16x32_bf16 v[152:155], a[196:199], a[164:167], v[152:155]
 v_mfma_f32_16x16x32_bf16 v[156:159], a[196:199], a[172:175], v[156:159]
 v_add_f32 v93, v93, v9
 v_mfma_f32_16x16x32_bf16 v[156:159], a[192:195], a[168:171], v[156:159]
 buffer_load_dword v4, off, s[64:67], 0 sc1
 v_mfma_f32_16x16x32_bf16 v[160:163], a[192:195], a[176:179], v[160:163]
 v_add_f32 v94, v94, v10
 v_mfma_f32_16x16x32_bf16 v[160:163], a[196:199], a[180:183], v[160:163]
 v_mfma_f32_16x16x32_bf16 v[164:167], a[196:199], a[188:191], v[164:167]
 v_add_f32 v95, v95, v11
 v_mfma_f32_16x16x32_bf16 v[164:167], a[192:195], a[184:187], v[164:167]
 v_add_f32 v96, v96, v8
 s_waitcnt vmcnt(10)
 v_mfma_f32_16x16x32_bf16 v[196:199], a[200:203], a[184:187], v[196:199]
 v_mfma_f32_16x16x32_bf16 v[196:199], a[204:207], a[188:191], v[196:199]
 global_load_dwordx4 a[196:199], v0, s[70:71] offset:1024
 v_add_f32 v97, v97, v9
 v_mfma_f32_16x16x32_bf16 v[192:195], a[204:207], a[180:183], v[192:195]
 v_add_f32 v98, v98, v10
 v_mfma_f32_16x16x32_bf16 v[192:195], a[200:203], a[176:179], v[192:195]
 global_load_dwordx4 a[192:195], v0, s[70:71] offset:0
 v_add_f32 v99, v99, v11
 v_mfma_f32_16x16x32_bf16 v[188:191], a[200:203], a[168:171], v[188:191]
 v_mfma_f32_16x16x32_bf16 v[188:191], a[204:207], a[172:175], v[188:191]
 v_add_f32 v100, v100, v8
 v_mfma_f32_16x16x32_bf16 v[184:187], a[204:207], a[164:167], v[184:187]
 v_add_f32 v101, v101, v9
 v_mfma_f32_16x16x32_bf16 v[184:187], a[200:203], a[160:163], v[184:187]
 v_mfma_f32_16x16x32_bf16 v[180:183], a[200:203], a[152:155], v[180:183]
 v_add_f32 v102, v102, v10
 v_mfma_f32_16x16x32_bf16 v[180:183], a[204:207], a[156:159], v[180:183]
 v_add_f32 v103, v103, v11
 v_mfma_f32_16x16x32_bf16 v[176:179], a[204:207], a[148:151], v[176:179]
 v_add_f32 v104, v104, v8
 v_mfma_f32_16x16x32_bf16 v[176:179], a[200:203], a[144:147], v[176:179]
 v_mfma_f32_16x16x32_bf16 v[172:175], a[200:203], a[136:139], v[172:175]
 v_add_f32 v105, v105, v9
 v_mfma_f32_16x16x32_bf16 v[172:175], a[204:207], a[140:143], v[172:175]
 v_add_f32 v106, v106, v10
 v_mfma_f32_16x16x32_bf16 v[168:171], a[204:207], a[132:135], v[168:171]
 v_mfma_f32_16x16x32_bf16 v[168:171], a[200:203], a[128:131], v[168:171]
 v_add_f32 v107, v107, v11
 s_waitcnt vmcnt(10)
 v_mfma_f32_16x16x32_bf16 v[200:203], a[208:211], a[128:131], v[200:203]
 v_add_f32 v108, v108, v8
 v_mfma_f32_16x16x32_bf16 v[200:203], a[212:215], a[132:135], v[200:203]
 global_load_dwordx4 a[204:207], v0, s[70:71] offset:3072
 v_add_f32 v109, v109, v9
 v_mfma_f32_16x16x32_bf16 v[204:207], a[212:215], a[140:143], v[204:207]
 v_mfma_f32_16x16x32_bf16 v[204:207], a[208:211], a[136:139], v[204:207]
 global_load_dwordx4 a[200:203], v0, s[70:71] offset:2048
 v_add_f32 v110, v110, v10
 v_mfma_f32_16x16x32_bf16 v[208:211], a[208:211], a[144:147], v[208:211]
 v_add_f32 v111, v111, v11
 s_add_u32 s70, s70, 8192
 s_addc_u32 s71, s71, 0
 v_mfma_f32_16x16x32_bf16 v[208:211], a[212:215], a[148:151], v[208:211]
 v_mfma_f32_16x16x32_bf16 v[212:215], a[212:215], a[156:159], v[212:215]
 v_mfma_f32_16x16x32_bf16 v[212:215], a[208:211], a[152:155], v[212:215]
 v_add_f32 v112, v112, v12
 v_mfma_f32_16x16x32_bf16 v[216:219], a[208:211], a[160:163], v[216:219]
 v_add_f32 v113, v113, v13
 v_mfma_f32_16x16x32_bf16 v[216:219], a[212:215], a[164:167], v[216:219]
 v_mfma_f32_16x16x32_bf16 v[220:223], a[212:215], a[172:175], v[220:223]
 v_add_f32 v114, v114, v14
 v_mfma_f32_16x16x32_bf16 v[220:223], a[208:211], a[168:171], v[220:223]
 v_add_f32 v115, v115, v15
 v_mfma_f32_16x16x32_bf16 v[224:227], a[208:211], a[176:179], v[224:227]
 v_mfma_f32_16x16x32_bf16 v[224:227], a[212:215], a[180:183], v[224:227]
 v_add_f32 v116, v116, v12
 v_mfma_f32_16x16x32_bf16 v[228:231], a[212:215], a[188:191], v[228:231]
 v_add_f32 v117, v117, v13
 v_mfma_f32_16x16x32_bf16 v[228:231], a[208:211], a[184:187], v[228:231]
 v_add_f32 v118, v118, v14
 s_waitcnt vmcnt(10)
 v_mfma_f32_16x16x32_bf16 a[252:255], a[216:219], a[184:187], a[252:255]
 ds_read_b128 a[184:187], v2 offset:61440
 v_add_f32 v119, v119, v15
 v_mfma_f32_16x16x32_bf16 a[252:255], a[220:223], a[188:191], a[252:255]
 global_load_dwordx4 a[212:215], v0, s[70:71] offset:-3072
 ds_read_b128 a[188:191], v2 offset:62464
 v_mfma_f32_16x16x32_bf16 a[248:251], a[220:223], a[180:183], a[248:251]
 ds_read_b128 a[180:183], v2 offset:58368
 v_add_f32 v120, v120, v12
 v_mfma_f32_16x16x32_bf16 a[248:251], a[216:219], a[176:179], a[248:251]
 global_load_dwordx4 a[208:211], v0, s[70:71] offset:-4096
 ds_read_b128 a[176:179], v2 offset:57344
 v_mfma_f32_16x16x32_bf16 v[252:255], a[216:219], a[168:171], v[252:255]
 ds_read_b128 a[168:171], v2 offset:53248
 v_add_f32 v121, v121, v13
 v_mfma_f32_16x16x32_bf16 v[252:255], a[220:223], a[172:175], v[252:255]
 ds_read_b128 a[172:175], v2 offset:54272
 v_add_f32 v122, v122, v14
 v_mfma_f32_16x16x32_bf16 v[248:251], a[220:223], a[164:167], v[248:251]
 ds_read_b128 a[164:167], v2 offset:50176
 v_add_f32 v123, v123, v15
 v_mfma_f32_16x16x32_bf16 v[248:251], a[216:219], a[160:163], v[248:251]
 ds_read_b128 a[160:163], v2 offset:49152
 v_mfma_f32_16x16x32_bf16 v[244:247], a[216:219], a[152:155], v[244:247]
 ds_read_b128 a[152:155], v2 offset:45056
 v_add_f32 v124, v124, v12
 v_mfma_f32_16x16x32_bf16 v[244:247], a[220:223], a[156:159], v[244:247]
 ds_read_b128 a[156:159], v2 offset:46080
 v_add_f32 v125, v125, v13
 v_mfma_f32_16x16x32_bf16 v[240:243], a[220:223], a[148:151], v[240:243]
 ds_read_b128 a[148:151], v2 offset:41984
 v_mfma_f32_16x16x32_bf16 v[240:243], a[216:219], a[144:147], v[240:243]
 ds_read_b128 a[144:147], v2 offset:40960
 v_add_f32 v126, v126, v14
 v_mfma_f32_16x16x32_bf16 v[236:239], a[216:219], a[136:139], v[236:239]
 ds_read_b128 a[136:139], v2 offset:36864
 v_add_f32 v127, v127, v15
 v_mfma_f32_16x16x32_bf16 v[236:239], a[220:223], a[140:143], v[236:239]
 ds_read_b128 a[140:143], v2 offset:37888
 v_add_f32 v128, v128, v12
 v_mfma_f32_16x16x32_bf16 v[232:235], a[220:223], a[132:135], v[232:235]
 ds_read_b128 a[132:135], v2 offset:33792
 v_mfma_f32_16x16x32_bf16 v[232:235], a[216:219], a[128:131], v[232:235]
 ds_read_b128 a[128:131], v2 offset:32768
 v_add_f32 v129, v129, v13
 s_waitcnt vmcnt(9) lgkmcnt(8)
 v_mfma_f32_16x16x32_bf16 v[164:167], a[224:227], a[184:187], v[164:167]
 v_add_f32 v130, v130, v14
 v_mfma_f32_16x16x32_bf16 v[164:167], a[228:231], a[188:191], v[164:167]
 global_load_dwordx4 a[220:223], v0, s[70:71] offset:-1024
 v_mfma_f32_16x16x32_bf16 v[160:163], a[228:231], a[180:183], v[160:163]
 v_add_f32 v131, v131, v15
 v_mfma_f32_16x16x32_bf16 v[160:163], a[224:227], a[176:179], v[160:163]
 global_load_dwordx4 a[216:219], v0, s[70:71] offset:-2048
 v_add_f32 v132, v132, v12
 v_mfma_f32_16x16x32_bf16 v[156:159], a[224:227], a[168:171], v[156:159]
 v_add_f32 v133, v133, v13
 v_mfma_f32_16x16x32_bf16 v[156:159], a[228:231], a[172:175], v[156:159]
 v_mfma_f32_16x16x32_bf16 v[152:155], a[228:231], a[164:167], v[152:155]
 v_add_f32 v134, v134, v14
 v_mfma_f32_16x16x32_bf16 v[152:155], a[224:227], a[160:163], v[152:155]
 v_add_f32 v135, v135, v15
 s_waitcnt lgkmcnt(0)
 v_mfma_f32_16x16x32_bf16 v[148:151], a[224:227], a[152:155], v[148:151]
 v_mfma_f32_16x16x32_bf16 v[148:151], a[228:231], a[156:159], v[148:151]
 v_accvgpr_read_b32 v5, a240
 v_mfma_f32_16x16x32_bf16 v[144:147], a[228:231], a[148:151], v[144:147]
 v_add_f32 v5, v5, v12
 v_mfma_f32_16x16x32_bf16 v[144:147], a[224:227], a[144:147], v[144:147]
 v_accvgpr_write_b32 a240, v5
 v_mfma_f32_16x16x32_bf16 v[140:143], a[224:227], a[136:139], v[140:143]
 v_mfma_f32_16x16x32_bf16 v[140:143], a[228:231], a[140:143], v[140:143]
 v_accvgpr_read_b32 v6, a241
 v_mfma_f32_16x16x32_bf16 v[136:139], a[228:231], a[132:135], v[136:139]
 v_add_f32 v6, v6, v13
 v_mfma_f32_16x16x32_bf16 v[136:139], a[224:227], a[128:131], v[136:139]
 s_waitcnt vmcnt(9)
 v_mfma_f32_16x16x32_bf16 v[168:171], a[232:235], a[128:131], v[168:171]
 v_accvgpr_write_b32 a241, v6
 v_mfma_f32_16x16x32_bf16 v[168:171], a[236:239], a[132:135], v[168:171]
 global_load_dwordx4 a[228:231], v0, s[70:71] offset:1024
 v_accvgpr_read_b32 v5, a242
 v_mfma_f32_16x16x32_bf16 v[172:175], a[236:239], a[140:143], v[172:175]
 v_add_f32 v5, v5, v14
 v_mfma_f32_16x16x32_bf16 v[172:175], a[232:235], a[136:139], v[172:175]
 global_load_dwordx4 a[224:227], v0, s[70:71] offset:0
 v_mfma_f32_16x16x32_bf16 v[176:179], a[232:235], a[144:147], v[176:179]
 v_accvgpr_write_b32 a242, v5
 v_mfma_f32_16x16x32_bf16 v[176:179], a[236:239], a[148:151], v[176:179]
 v_accvgpr_read_b32 v6, a243
 v_mfma_f32_16x16x32_bf16 v[180:183], a[236:239], a[156:159], v[180:183]
 v_mfma_f32_16x16x32_bf16 v[180:183], a[232:235], a[152:155], v[180:183]
 v_add_f32 v6, v6, v15
 v_mfma_f32_16x16x32_bf16 v[184:187], a[232:235], a[160:163], v[184:187]
 v_accvgpr_write_b32 a243, v6
 v_mfma_f32_16x16x32_bf16 v[184:187], a[236:239], a[164:167], v[184:187]
 v_accvgpr_read_b32 v5, a244
 v_mfma_f32_16x16x32_bf16 v[188:191], a[236:239], a[172:175], v[188:191]
 v_mfma_f32_16x16x32_bf16 v[188:191], a[232:235], a[168:171], v[188:191]
 v_add_f32 v5, v5, v12
 v_mfma_f32_16x16x32_bf16 v[192:195], a[232:235], a[176:179], v[192:195]
 v_accvgpr_write_b32 a244, v5
 v_mfma_f32_16x16x32_bf16 v[192:195], a[236:239], a[180:183], v[192:195]
 v_mfma_f32_16x16x32_bf16 v[196:199], a[236:239], a[188:191], v[196:199]
 v_accvgpr_read_b32 v6, a245
 v_mfma_f32_16x16x32_bf16 v[196:199], a[232:235], a[184:187], v[196:199]
 v_add_f32 v6, v6, v13
 s_waitcnt vmcnt(8)
 v_mfma_f32_16x16x32_bf16 v[228:231], a[192:195], a[184:187], v[228:231]
 v_accvgpr_write_b32 a245, v6
 v_mfma_f32_16x16x32_bf16 v[228:231], a[196:199], a[188:191], v[228:231]
 global_load_dwordx4 a[236:239], v0, s[70:71] offset:3072
 v_mfma_f32_16x16x32_bf16 v[224:227], a[196:199], a[180:183], v[224:227]
 v_accvgpr_read_b32 v5, a246
 v_mfma_f32_16x16x32_bf16 v[224:227], a[192:195], a[176:179], v[224:227]
 global_load_dwordx4 a[232:235], v0, s[70:71] offset:2048
 v_add_f32 v5, v5, v14
 v_mfma_f32_16x16x32_bf16 v[220:223], a[192:195], a[168:171], v[220:223]
 s_add_u32 s70, s70, 8192
 s_addc_u32 s71, s71, 0
 v_mfma_f32_16x16x32_bf16 v[220:223], a[196:199], a[172:175], v[220:223]
 v_accvgpr_write_b32 a246, v5
 v_mfma_f32_16x16x32_bf16 v[216:219], a[196:199], a[164:167], v[216:219]
 v_accvgpr_read_b32 v6, a247
 v_mfma_f32_16x16x32_bf16 v[216:219], a[192:195], a[160:163], v[216:219]
 v_add_f32 v6, v6, v15
 v_mfma_f32_16x16x32_bf16 v[212:215], a[192:195], a[152:155], v[212:215]
 v_mfma_f32_16x16x32_bf16 v[212:215], a[196:199], a[156:159], v[212:215]
 v_accvgpr_write_b32 a247, v6
 v_mfma_f32_16x16x32_bf16 v[208:211], a[196:199], a[148:151], v[208:211]
 v_cmp_gt_i32 vcc, s55, v4
 s_cbranch_vccnz Lspin_pa
Lok_pa:
 s_add_u32 s55, s55, 1
 s_waitcnt lgkmcnt(0)
 s_barrier
 v_mfma_f32_16x16x32_bf16 v[208:211], a[192:195], a[144:147], v[208:211]
 v_mfma_f32_16x16x32_bf16 v[204:207], a[192:195], a[136:139], v[204:207]
 v_mfma_f32_16x16x32_bf16 v[204:207], a[196:199], a[140:143], v[204:207]
 v_mfma_f32_16x16x32_bf16 v[200:203], a[196:199], a[132:135], v[200:203]
 v_mfma_f32_16x16x32_bf16 v[200:203], a[192:195], a[128:131], v[200:203]
 s_waitcnt vmcnt(8)
 v_mfma_f32_16x16x32_bf16 v[232:235], a[200:203], a[128:131], v[232:235]
 ds_read_b128 a[128:131], v1 offset:2048
 v_mfma_f32_16x16x32_bf16 v[232:235], a[204:207], a[132:135], v[232:235]
 global_load_dwordx4 a[196:199], v0, s[70:71] offset:-3072
 ds_read_b128 a[132:135], v1 offset:3072
 v_mfma_f32_16x16x32_bf16 v[236:239], a[204:207], a[140:143], v[236:239]
 ds_read_b128 a[140:143], v1 offset:7168
 v_mfma_f32_16x16x32_bf16 v[236:239], a[200:203], a[136:139], v[236:239]
 global_load_dwordx4 a[192:195], v0, s[70:71] offset:-4096
 ds_read_b128 a[136:139], v1 offset:6144
 v_mfma_f32_16x16x32_bf16 v[240:243], a[200:203], a[144:147], v[240:243]
 ds_read_b128 a[144:147], v1 offset:10240
 v_mfma_f32_16x16x32_bf16 v[240:243], a[204:207], a[148:151], v[240:243]
 ds_read_b128 a[148:151], v1 offset:11264
 v_mfma_f32_16x16x32_bf16 v[244:247], a[204:207], a[156:159], v[244:247]
 ds_read_b128 a[156:159], v1 offset:15360
 v_mfma_f32_16x16x32_bf16 v[244:247], a[200:203], a[152:155], v[244:247]
 ds_read_b128 a[152:155], v1 offset:14336
 v_mfma_f32_16x16x32_bf16 v[248:251], a[200:203], a[160:163], v[248:251]
 ds_read_b128 a[160:163], v1 offset:18432
 v_mfma_f32_16x16x32_bf16 v[248:251], a[204:207], a[164:167], v[248:251]
 ds_read_b128 a[164:167], v1 offset:19456
 v_mfma_f32_16x16x32_bf16 v[252:255], a[204:207], a[172:175], v[252:255]
 ds_read_b128 a[172:175], v1 offset:23552
 v_mfma_f32_16x16x32_bf16 v[252:255], a[200:203], a[168:171], v[252:255]
 ds_read_b128 a[168:171], v1 offset:22528
 v_mfma_f32_16x16x32_bf16 a[248:251], a[200:203], a[176:179], a[248:251]
 ds_read_b128 a[176:179], v1 offset:26624
 v_mfma_f32_16x16x32_bf16 a[248:251], a[204:207], a[180:183], a[248:251]
 ds_read_b128 a[180:183], v1 offset:27648
 v_mfma_f32_16x16x32_bf16 a[252:255], a[204:207], a[188:191], a[252:255]
 global_load_dwordx4 a[204:207], v0, s[70:71] offset:-1024
 ds_read_b128 a[188:191], v1 offset:31744
 v_mfma_f32_16x16x32_bf16 a[252:255], a[200:203], a[184:187], a[252:255]
 global_load_dwordx4 a[200:203], v0, s[70:71] offset:-2048
 ds_read_b128 a[184:187], v1 offset:30720
 s_waitcnt vmcnt(10) lgkmcnt(8)
 v_mfma_f32_16x16x32_bf16 v[16:19], a[208:211], a[128:131], v[16:19]
 v_mfma_f32_16x16x32_bf16 v[16:19], a[212:215], a[132:135], v[16:19]
 s_add_u32 s29, s29, 0x2000000
 v_mfma_f32_16x16x32_bf16 v[20:23], a[212:215], a[140:143], v[20:23]
 v_mfma_f32_16x16x32_bf16 v[20:23], a[208:211], a[136:139], v[20:23]
 v_mov_b32 v6, v3
 s_cmp_eq_u32 s25, 0
 s_cbranch_scc1 Lgat0
Lgatr0:
 v_mfma_f32_16x16x32_bf16 v[24:27], a[208:211], a[144:147], v[24:27]
 v_mfma_f32_16x16x32_bf16 v[24:27], a[212:215], a[148:151], v[24:27]
 v_mfma_f32_16x16x32_bf16 v[28:31], a[212:215], a[156:159], v[28:31]
 v_mfma_f32_16x16x32_bf16 v[28:31], a[208:211], a[152:155], v[28:31]
 s_waitcnt lgkmcnt(0)
 v_mfma_f32_16x16x32_bf16 v[32:35], a[208:211], a[160:163], v[32:35]
 v_mfma_f32_16x16x32_bf16 v[32:35], a[212:215], a[164:167], v[32:35]
 s_add_u32 m0, s50, 0
 v_mfma_f32_16x16x32_bf16 v[36:39], a[212:215], a[172:175], v[36:39]
 v_mfma_f32_16x16x32_bf16 v[36:39], a[208:211], a[168:171], v[36:39]
 v_mfma_f32_16x16x32_bf16 v[40:43], a[208:211], a[176:179], v[40:43]
 v_mfma_f32_16x16x32_bf16 v[40:43], a[212:215], a[180:183], v[40:43]
 v_mfma_f32_16x16x32_bf16 v[44:47], a[212:215], a[188:191], v[44:47]
 v_mfma_f32_16x16x32_bf16 v[44:47], a[208:211], a[184:187], v[44:47]
 s_waitcnt vmcnt(8)
 v_mfma_f32_16x16x32_bf16 v[76:79], a[216:219], a[184:187], v[76:79]
 v_mfma_f32_16x16x32_bf16 v[76:79], a[220:223], a[188:191], v[76:79]
 global_load_dwordx4 a[212:215], v0, s[70:71] offset:1024
 v_mfma_f32_16x16x32_bf16 v[72:75], a[220:223], a[180:183], v[72:75]
 v_mfma_f32_16x16x32_bf16 v[72:75], a[216:219], a[176:179], v[72:75]
 global_load_dwordx4 a[208:211], v0, s[70:71] offset:0
 v_mfma_f32_16x16x32_bf16 v[68:71], a[216:219], a[168:171], v[68:71]
 v_mfma_f32_16x16x32_bf16 v[68:71], a[220:223], a[172:175], v[68:71]
 buffer_load_dwordx4 v6, s[8:11], s30 offen sc1 lds
 v_mfma_f32_16x16x32_bf16 v[64:67], a[220:223], a[164:167], v[64:67]
 v_mfma_f32_16x16x32_bf16 v[64:67], a[216:219], a[160:163], v[64:67]
 v_mfma_f32_16x16x32_bf16 v[60:63], a[216:219], a[152:155], v[60:63]
 v_mfma_f32_16x16x32_bf16 v[60:63], a[220:223], a[156:159], v[60:63]
 v_mfma_f32_16x16x32_bf16 v[56:59], a[220:223], a[148:151], v[56:59]
 v_mfma_f32_16x16x32_bf16 v[56:59], a[216:219], a[144:147], v[56:59]
 v_mfma_f32_16x16x32_bf16 v[52:55], a[216:219], a[136:139], v[52:55]
 s_add_u32 m0, m0, 1024
 v_mfma_f32_16x16x32_bf16 v[52:55], a[220:223], a[140:143], v[52:55]
 v_mfma_f32_16x16x32_bf16 v[48:51], a[220:223], a[132:135], v[48:51]
 v_mfma_f32_16x16x32_bf16 v[48:51], a[216:219], a[128:131], v[48:51]
 s_waitcnt vmcnt(9)
 v_mfma_f32_16x16x32_bf16 v[80:83], a[224:227], a[128:131], v[80:83]
 v_mfma_f32_16x16x32_bf16 v[80:83], a[228:231], a[132:135], v[80:83]
 global_load_dwordx4 a[220:223], v0, s[70:71] offset:3072
 v_mfma_f32_16x16x32_bf16 v[84:87], a[228:231], a[140:143], v[84:87]
 s_add_u32 s30, s30, s20
 v_mfma_f32_16x16x32_bf16 v[84:87], a[224:227], a[136:139], v[84:87]
 global_load_dwordx4 a[216:219], v0, s[70:71] offset:2048
 v_mfma_f32_16x16x32_bf16 v[88:91], a[224:227], a[144:147], v[88:91]
 s_add_u32 s70, s70, 8192
 s_addc_u32 s71, s71, 0
 v_mfma_f32_16x16x32_bf16 v[88:91], a[228:231], a[148:151], v[88:91]
 v_mfma_f32_16x16x32_bf16 v[92:95], a[228:231], a[156:159], v[92:95]
 v_mfma_f32_16x16x32_bf16 v[92:95], a[224:227], a[152:155], v[92:95]
 v_mfma_f32_16x16x32_bf16 v[96:99], a[224:227], a[160:163], v[96:99]
 buffer_load_dwordx4 v6, s[8:11], s30 offen sc1 lds
 v_mfma_f32_16x16x32_bf16 v[96:99], a[228:231], a[164:167], v[96:99]
 v_mfma_f32_16x16x32_bf16 v[100:103], a[228:231], a[172:175], v[100:103]
 v_mfma_f32_16x16x32_bf16 v[100:103], a[224:227], a[168:171], v[100:103]
 v_mfma_f32_16x16x32_bf16 v[104:107], a[224:227], a[176:179], v[104:107]
 v_mfma_f32_16x16x32_bf16 v[104:107], a[228:231], a[180:183], v[104:107]
 v_mfma_f32_16x16x32_bf16 v[108:111], a[228:231], a[188:191], v[108:111]
 v_mfma_f32_16x16x32_bf16 v[108:111], a[224:227], a[184:187], v[108:111]
 s_add_u32 m0, m0, 3072
 s_waitcnt vmcnt(10)
 v_mfma_f32_16x16x32_bf16 a[244:247], a[232:235], a[184:187], a[244:247]
 v_mfma_f32_16x16x32_bf16 a[244:247], a[236:239], a[188:191], a[244:247]
 global_load_dwordx4 a[228:231], v0, s[70:71] offset:-3072
 v_mfma_f32_16x16x32_bf16 a[240:243], a[236:239], a[180:183], a[240:243]
 v_mfma_f32_16x16x32_bf16 a[240:243], a[232:235], a[176:179], a[240:243]
 global_load_dwordx4 a[224:227], v0, s[70:71] offset:-4096
 v_mfma_f32_16x16x32_bf16 v[132:135], a[232:235], a[168:171], v[132:135]
 v_mfma_f32_16x16x32_bf16 v[132:135], a[236:239], a[172:175], v[132:135]
 s_add_u32 s30, s30, s21
 v_mfma_f32_16x16x32_bf16 v[128:131], a[236:239], a[164:167], v[128:131]
 v_mfma_f32_16x16x32_bf16 v[128:131], a[232:235], a[160:163], v[128:131]
 v_mfma_f32_16x16x32_bf16 v[124:127], a[232:235], a[152:155], v[124:127]
 v_mfma_f32_16x16x32_bf16 v[124:127], a[236:239], a[156:159], v[124:127]
 v_mfma_f32_16x16x32_bf16 v[120:123], a[236:239], a[148:151], v[120:123]
 v_mfma_f32_16x16x32_bf16 v[120:123], a[232:235], a[144:147], v[120:123]
 buffer_load_dwordx4 v6, s[8:11], s30 offen sc1 lds
 v_mfma_f32_16x16x32_bf16 v[116:119], a[232:235], a[136:139], v[116:119]
 v_mfma_f32_16x16x32_bf16 v[116:119], a[236:239], a[140:143], v[116:119]
 v_mfma_f32_16x16x32_bf16 v[112:115], a[236:239], a[132:135], v[112:115]
 v_mfma_f32_16x16x32_bf16 v[112:115], a[232:235], a[128:131], v[112:115]
 s_waitcnt vmcnt(11)
 v_mfma_f32_16x16x32_bf16 v[136:139], a[192:195], a[128:131], v[136:139]
 v_mfma_f32_16x16x32_bf16 v[136:139], a[196:199], a[132:135], v[136:139]
 global_load_dwordx4 a[236:239], v0, s[70:71] offset:-1024
 s_add_u32 m0, m0, 1024
 v_mfma_f32_16x16x32_bf16 v[140:143], a[196:199], a[140:143], v[140:143]
 v_mfma_f32_16x16x32_bf16 v[140:143], a[192:195], a[136:139], v[140:143]
 global_load_dwordx4 a[232:235], v0, s[70:71] offset:-2048
 v_mfma_f32_16x16x32_bf16 v[144:147], a[192:195], a[144:147], v[144:147]
 v_mfma_f32_16x16x32_bf16 v[144:147], a[196:199], a[148:151], v[144:147]
 v_mfma_f32_16x16x32_bf16 v[148:151], a[196:199], a[156:159], v[148:151]
 v_mfma_f32_16x16x32_bf16 v[148:151], a[192:195], a[152:155], v[148:151]
 v_mfma_f32_16x16x32_bf16 v[152:155], a[192:195], a[160:163], v[152:155]
 s_add_u32 s30, s30, s20
 v_mfma_f32_16x16x32_bf16 v[152:155], a[196:199], a[164:167], v[152:155]
 v_mfma_f32_16x16x32_bf16 v[156:159], a[196:199], a[172:175], v[156:159]
 v_mfma_f32_16x16x32_bf16 v[156:159], a[192:195], a[168:171], v[156:159]
 v_mfma_f32_16x16x32_bf16 v[160:163], a[192:195], a[176:179], v[160:163]
 v_mfma_f32_16x16x32_bf16 v[160:163], a[196:199], a[180:183], v[160:163]
 v_mfma_f32_16x16x32_bf16 v[164:167], a[196:199], a[188:191], v[164:167]
 buffer_load_dwordx4 v6, s[8:11], s30 offen sc1 lds
 v_mfma_f32_16x16x32_bf16 v[164:167], a[192:195], a[184:187], v[164:167]
 s_waitcnt vmcnt(12)
 v_mfma_f32_16x16x32_bf16 v[196:199], a[200:203], a[184:187], v[196:199]
 v_mfma_f32_16x16x32_bf16 v[196:199], a[204:207], a[188:191], v[196:199]
 global_load_dwordx4 a[196:199], v0, s[70:71] offset:1024
 v_mfma_f32_16x16x32_bf16 v[192:195], a[204:207], a[180:183], v[192:195]
 v_mfma_f32_16x16x32_bf16 v[192:195], a[200:203], a[176:179], v[192:195]
 global_load_dwordx4 a[192:195], v0, s[70:71] offset:0
 v_mfma_f32_16x16x32_bf16 v[188:191], a[200:203], a[168:171], v[188:191]
 s_add_u32 m0, m0, 3072
 v_mfma_f32_16x16x32_bf16 v[188:191], a[204:207], a[172:175], v[188:191]
 v_mfma_f32_16x16x32_bf16 v[184:187], a[204:207], a[164:167], v[184:187]
 v_mfma_f32_16x16x32_bf16 v[184:187], a[200:203], a[160:163], v[184:187]
 v_mfma_f32_16x16x32_bf16 v[180:183], a[200:203], a[152:155], v[180:183]
 v_mfma_f32_16x16x32_bf16 v[180:183], a[204:207], a[156:159], v[180:183]
 v_mfma_f32_16x16x32_bf16 v[176:179], a[204:207], a[148:151], v[176:179]
 s_add_u32 s30, s30, s21
 v_mfma_f32_16x16x32_bf16 v[176:179], a[200:203], a[144:147], v[176:179]
 v_mfma_f32_16x16x32_bf16 v[172:175], a[200:203], a[136:139], v[172:175]
 v_mfma_f32_16x16x32_bf16 v[172:175], a[204:207], a[140:143], v[172:175]
 v_mfma_f32_16x16x32_bf16 v[168:171], a[204:207], a[132:135], v[168:171]
 v_mfma_f32_16x16x32_bf16 v[168:171], a[200:203], a[128:131], v[168:171]
 s_waitcnt vmcnt(12)
 v_mfma_f32_16x16x32_bf16 v[200:203], a[208:211], a[128:131], v[200:203]
 buffer_load_dwordx4 v6, s[8:11], s30 offen sc1 lds
 v_mfma_f32_16x16x32_bf16 v[200:203], a[212:215], a[132:135], v[200:203]
 global_load_dwordx4 a[204:207], v0, s[70:71] offset:3072
 v_mfma_f32_16x16x32_bf16 v[204:207], a[212:215], a[140:143], v[204:207]
 v_mfma_f32_16x16x32_bf16 v[204:207], a[208:211], a[136:139], v[204:207]
 global_load_dwordx4 a[200:203], v0, s[70:71] offset:2048
 v_mfma_f32_16x16x32_bf16 v[208:211], a[208:211], a[144:147], v[208:211]
 s_add_u32 s70, s70, 8192
 s_addc_u32 s71, s71, 0
 v_mfma_f32_16x16x32_bf16 v[208:211], a[212:215], a[148:151], v[208:211]
 v_mfma_f32_16x16x32_bf16 v[212:215], a[212:215], a[156:159], v[212:215]
 v_mfma_f32_16x16x32_bf16 v[212:215], a[208:211], a[152:155], v[212:215]
 s_add_u32 m0, m0, 1024
 v_mfma_f32_16x16x32_bf16 v[216:219], a[208:211], a[160:163], v[216:219]
 v_mfma_f32_16x16x32_bf16 v[216:219], a[212:215], a[164:167], v[216:219]
 v_mfma_f32_16x16x32_bf16 v[220:223], a[212:215], a[172:175], v[220:223]
 v_mfma_f32_16x16x32_bf16 v[220:223], a[208:211], a[168:171], v[220:223]
 v_mfma_f32_16x16x32_bf16 v[224:227], a[208:211], a[176:179], v[224:227]
 v_mfma_f32_16x16x32_bf16 v[224:227], a[212:215], a[180:183], v[224:227]
 s_add_u32 s30, s30, s20
 v_mfma_f32_16x16x32_bf16 v[228:231], a[212:215], a[188:191], v[228:231]
 v_mfma_f32_16x16x32_bf16 v[228:231], a[208:211], a[184:187], v[228:231]
 buffer_load_dwordx4 v6, s[8:11], s30 offen sc1 lds
 s_waitcnt vmcnt(13)
 v_mfma_f32_16x16x32_bf16 a[252:255], a[216:219], a[184:187], a[252:255]
 ds_read_b128 a[184:187], v1 offset:63488
 v_mfma_f32_16x16x32_bf16 a[252:255], a[220:223], a[188:191], a[252:255]
 global_load_dwordx4 a[212:215], v0, s[70:71] offset:-3072
 ds_read_b128 a[188:191], v1 offset:64512
 v_mfma_f32_16x16x32_bf16 a[248:251], a[220:223], a[180:183], a[248:251]
 ds_read_b128 a[180:183], v1 offset:60416
 v_mfma_f32_16x16x32_bf16 a[248:251], a[216:219], a[176:179], a[248:251]
 global_load_dwordx4 a[208:211], v0, s[70:71] offset:-4096
 ds_read_b128 a[176:179], v1 offset:59392
 v_mfma_f32_16x16x32_bf16 v[252:255], a[216:219], a[168:171], v[252:255]
 ds_read_b128 a[168:171], v1 offset:55296
 v_mfma_f32_16x16x32_bf16 v[252:255], a[220:223], a[172:175], v[252:255]
 ds_read_b128 a[172:175], v1 offset:56320
 v_mfma_f32_16x16x32_bf16 v[248:251], a[220:223], a[164:167], v[248:251]
 ds_read_b128 a[164:167], v1 offset:52224
 v_mfma_f32_16x16x32_bf16 v[248:251], a[216:219], a[160:163], v[248:251]
 ds_read_b128 a[160:163], v1 offset:51200
 v_mfma_f32_16x16x32_bf16 v[244:247], a[216:219], a[152:155], v[244:247]
 ds_read_b128 a[152:155], v1 offset:47104
 v_mfma_f32_16x16x32_bf16 v[244:247], a[220:223], a[156:159], v[244:247]
 ds_read_b128 a[156:159], v1 offset:48128
 v_mfma_f32_16x16x32_bf16 v[240:243], a[220:223], a[148:151], v[240:243]
 ds_read_b128 a[148:151], v1 offset:44032
 s_add_u32 m0, m0, 3072
 v_mfma_f32_16x16x32_bf16 v[240:243], a[216:219], a[144:147], v[240:243]
 ds_read_b128 a[144:147], v1 offset:43008
 v_mfma_f32_16x16x32_bf16 v[236:239], a[216:219], a[136:139], v[236:239]
 ds_read_b128 a[136:139], v1 offset:38912
 v_mfma_f32_16x16x32_bf16 v[236:239], a[220:223], a[140:143], v[236:239]
 ds_read_b128 a[140:143], v1 offset:39936
 v_mfma_f32_16x16x32_bf16 v[232:235], a[220:223], a[132:135], v[232:235]
 ds_read_b128 a[132:135], v1 offset:35840
 v_mfma_f32_16x16x32_bf16 v[232:235], a[216:219], a[128:131], v[232:235]
 ds_read_b128 a[128:131], v1 offset:34816
 s_waitcnt vmcnt(12) lgkmcnt(8)
 v_mfma_f32_16x16x32_bf16 v[44:47], a[224:227], a[184:187], v[44:47]
 s_add_u32 s30, s30, s21
 v_mfma_f32_16x16x32_bf16 v[44:47], a[228:231], a[188:191], v[44:47]
 global_load_dwordx4 a[220:223], v0, s[70:71] offset:-1024
 v_mfma_f32_16x16x32_bf16 v[40:43], a[228:231], a[180:183], v[40:43]
 v_mfma_f32_16x16x32_bf16 v[40:43], a[224:227], a[176:179], v[40:43]
 global_load_dwordx4 a[216:219], v0, s[70:71] offset:-2048
 v_mfma_f32_16x16x32_bf16 v[36:39], a[224:227], a[168:171], v[36:39]
 v_mfma_f32_16x16x32_bf16 v[36:39], a[228:231], a[172:175], v[36:39]
 v_mfma_f32_16x16x32_bf16 v[32:35], a[228:231], a[164:167], v[32:35]
 buffer_load_dwordx4 v6, s[8:11], s30 offen sc1 lds
 v_mfma_f32_16x16x32_bf16 v[32:35], a[224:227], a[160:163], v[32:35]
 s_waitcnt lgkmcnt(0)
 v_mfma_f32_16x16x32_bf16 v[28:31], a[224:227], a[152:155], v[28:31]
 v_mfma_f32_16x16x32_bf16 v[28:31], a[228:231], a[156:159], v[28:31]
 v_mfma_f32_16x16x32_bf16 v[24:27], a[228:231], a[148:151], v[24:27]
 v_mfma_f32_16x16x32_bf16 v[24:27], a[224:227], a[144:147], v[24:27]
 v_mfma_f32_16x16x32_bf16 v[20:23], a[224:227], a[136:139], v[20:23]
 v_mfma_f32_16x16x32_bf16 v[20:23], a[228:231], a[140:143], v[20:23]
 s_add_u32 m0, m0, 1024
 v_mfma_f32_16x16x32_bf16 v[16:19], a[228:231], a[132:135], v[16:19]
 v_mfma_f32_16x16x32_bf16 v[16:19], a[224:227], a[128:131], v[16:19]
 s_waitcnt vmcnt(12)
 v_mfma_f32_16x16x32_bf16 v[48:51], a[232:235], a[128:131], v[48:51]
 v_mfma_f32_16x16x32_bf16 v[48:51], a[236:239], a[132:135], v[48:51]
 global_load_dwordx4 a[228:231], v0, s[70:71] offset:1024
 v_mfma_f32_16x16x32_bf16 v[52:55], a[236:239], a[140:143], v[52:55]
 v_mfma_f32_16x16x32_bf16 v[52:55], a[232:235], a[136:139], v[52:55]
 global_load_dwordx4 a[224:227], v0, s[70:71] offset:0
 s_add_u32 s30, s30, s20
 v_mfma_f32_16x16x32_bf16 v[56:59], a[232:235], a[144:147], v[56:59]
 v_mfma_f32_16x16x32_bf16 v[56:59], a[236:239], a[148:151], v[56:59]
 v_mfma_f32_16x16x32_bf16 v[60:63], a[236:239], a[156:159], v[60:63]
 v_mfma_f32_16x16x32_bf16 v[60:63], a[232:235], a[152:155], v[60:63]
 v_mfma_f32_16x16x32_bf16 v[64:67], a[232:235], a[160:163], v[64:67]
 v_mfma_f32_16x16x32_bf16 v[64:67], a[236:239], a[164:167], v[64:67]
 buffer_load_dwordx4 v6, s[8:11], s30 offen sc1 lds
 v_mfma_f32_16x16x32_bf16 v[68:71], a[236:239], a[172:175], v[68:71]
 v_mfma_f32_16x16x32_bf16 v[68:71], a[232:235], a[168:171], v[68:71]
 v_mfma_f32_16x16x32_bf16 v[72:75], a[232:235], a[176:179], v[72:75]
 v_mfma_f32_16x16x32_bf16 v[72:75], a[236:239], a[180:183], v[72:75]
 v_mfma_f32_16x16x32_bf16 v[76:79], a[236:239], a[188:191], v[76:79]
 v_mfma_f32_16x16x32_bf16 v[76:79], a[232:235], a[184:187], v[76:79]
 s_waitcnt vmcnt(12)
 v_mfma_f32_16x16x32_bf16 v[108:111], a[192:195], a[184:187], v[108:111]
 s_add_u32 m0, m0, 3072
 v_mfma_f32_16x16x32_bf16 v[108:111], a[196:199], a[188:191], v[108:111]
 global_load_dwordx4 a[236:239], v0, s[70:71] offset:3072
 v_mfma_f32_16x16x32_bf16 v[104:107], a[196:199], a[180:183], v[104:107]
 v_mfma_f32_16x16x32_bf16 v[104:107], a[192:195], a[176:179], v[104:107]
 global_load_dwordx4 a[232:235], v0, s[70:71] offset:2048
 v_mfma_f32_16x16x32_bf16 v[100:103], a[192:195], a[168:171], v[100:103]
 s_add_u32 s70, s70, 8192
 s_addc_u32 s71, s71, 0
 v_mfma_f32_16x16x32_bf16 v[100:103], a[196:199], a[172:175], v[100:103]
 v_mfma_f32_16x16x32_bf16 v[96:99], a[196:199], a[164:167], v[96:99]
 s_add_u32 s30, s30, s21
 v_mfma_f32_16x16x32_bf16 v[96:99], a[192:195], a[160:163], v[96:99]
 v_mfma_f32_16x16x32_bf16 v[92:95], a[192:195], a[152:155], v[92:95]
 v_mfma_f32_16x16x32_bf16 v[92:95], a[196:199], a[156:159], v[92:95]
 v_mfma_f32_16x16x32_bf16 v[88:91], a[196:199], a[148:151], v[88:91]
 v_mfma_f32_16x16x32_bf16 v[88:91], a[192:195], a[144:147], v[88:91]
 v_mfma_f32_16x16x32_bf16 v[84:87], a[192:195], a[136:139], v[84:87]
 buffer_load_dwordx4 v6, s[8:11], s30 offen sc1 lds
 v_mfma_f32_16x16x32_bf16 v[84:87], a[196:199], a[140:143], v[84:87]
 v_mfma_f32_16x16x32_bf16 v[80:83], a[196:199], a[132:135], v[80:83]
 v_mfma_f32_16x16x32_bf16 v[80:83], a[192:195], a[128:131], v[80:83]
 s_waitcnt vmcnt(12)
 v_mfma_f32_16x16x32_bf16 v[112:115], a[200:203], a[128:131], v[112:115]
 v_mfma_f32_16x16x32_bf16 v[112:115], a[204:207], a[132:135], v[112:115]
 global_load_dwordx4 a[196:199], v0, s[70:71] offset:-3072
 v_mfma_f32_16x16x32_bf16 v[116:119], a[204:207], a[140:143], v[116:119]
 s_add_u32 m0, m0, 1024
 v_mfma_f32_16x16x32_bf16 v[116:119], a[200:203], a[136:139], v[116:119]
 global_load_dwordx4 a[192:195], v0, s[70:71] offset:-4096
 v_mfma_f32_16x16x32_bf16 v[120:123], a[200:203], a[144:147], v[120:123]
 v_mfma_f32_16x16x32_bf16 v[120:123], a[204:207], a[148:151], v[120:123]
 v_mfma_f32_16x16x32_bf16 v[124:127], a[204:207], a[156:159], v[124:127]
 v_mfma_f32_16x16x32_bf16 v[124:127], a[200:203], a[152:155], v[124:127]
 v_mfma_f32_16x16x32_bf16 v[128:131], a[200:203], a[160:163], v[128:131]
 v_mfma_f32_16x16x32_bf16 v[128:131], a[204:207], a[164:167], v[128:131]
 s_add_u32 s30, s30, s20
 v_mfma_f32_16x16x32_bf16 v[132:135], a[204:207], a[172:175], v[132:135]
 v_mfma_f32_16x16x32_bf16 v[132:135], a[200:203], a[168:171], v[132:135]
 v_mfma_f32_16x16x32_bf16 a[240:243], a[200:203], a[176:179], a[240:243]
 v_mfma_f32_16x16x32_bf16 a[240:243], a[204:207], a[180:183], a[240:243]
 v_mfma_f32_16x16x32_bf16 a[244:247], a[204:207], a[188:191], a[244:247]
 v_mfma_f32_16x16x32_bf16 a[244:247], a[200:203], a[184:187], a[244:247]
 buffer_load_dwordx4 v6, s[8:11], s30 offen sc1 lds
 s_waitcnt vmcnt(12)
 v_mfma_f32_16x16x32_bf16 v[164:167], a[208:211], a[184:187], v[164:167]
 v_mfma_f32_16x16x32_bf16 v[164:167], a[212:215], a[188:191], v[164:167]
 global_load_dwordx4 a[204:207], v0, s[70:71] offset:-1024
 v_mfma_f32_16x16x32_bf16 v[160:163], a[212:215], a[180:183], v[160:163]
 v_mfma_f32_16x16x32_bf16 v[160:163], a[208:211], a[176:179], v[160:163]
 global_load_dwordx4 a[200:203], v0, s[70:71] offset:-2048
 v_mfma_f32_16x16x32_bf16 v[156:159], a[208:211], a[168:171], v[156:159]
 v_mfma_f32_16x16x32_bf16 v[156:159], a[212:215], a[172:175], v[156:159]
 s_add_u32 m0, m0, 3072
 v_mfma_f32_16x16x32_bf16 v[152:155], a[212:215], a[164:167], v[152:155]
 v_mfma_f32_16x16x32_bf16 v[152:155], a[208:211], a[160:163], v[152:155]
 v_mfma_f32_16x16x32_bf16 v[148:151], a[208:211], a[152:155], v[148:151]
 v_mfma_f32_16x16x32_bf16 v[148:151], a[212:215], a[156:159], v[148:151]
 v_mfma_f32_16x16x32_bf16 v[144:147], a[212:215], a[148:151], v[144:147]
 v_mfma_f32_16x16x32_bf16 v[144:147], a[208:211], a[144:147], v[144:147]
 s_add_u32 s30, s30, s21
 v_mfma_f32_16x16x32_bf16 v[140:143], a[208:211], a[136:139], v[140:143]
 v_mfma_f32_16x16x32_bf16 v[140:143], a[212:215], a[140:143], v[140:143]
 v_mfma_f32_16x16x32_bf16 v[136:139], a[212:215], a[132:135], v[136:139]
 v_mfma_f32_16x16x32_bf16 v[136:139], a[208:211], a[128:131], v[136:139]
 s_waitcnt vmcnt(12)
 v_mfma_f32_16x16x32_bf16 v[168:171], a[216:219], a[128:131], v[168:171]
 v_mfma_f32_16x16x32_bf16 v[168:171], a[220:223], a[132:135], v[168:171]
 global_load_dwordx4 a[212:215], v0, s[70:71] offset:1024
 v_mfma_f32_16x16x32_bf16 v[172:175], a[220:223], a[140:143], v[172:175]
 buffer_load_dwordx4 v6, s[8:11], s30 offen sc1 lds
 v_mfma_f32_16x16x32_bf16 v[172:175], a[216:219], a[136:139], v[172:175]
 global_load_dwordx4 a[208:211], v0, s[70:71] offset:0
 v_mfma_f32_16x16x32_bf16 v[176:179], a[216:219], a[144:147], v[176:179]
 v_mfma_f32_16x16x32_bf16 v[176:179], a[220:223], a[148:151], v[176:179]
 v_mfma_f32_16x16x32_bf16 v[180:183], a[220:223], a[156:159], v[180:183]
 v_mfma_f32_16x16x32_bf16 v[180:183], a[216:219], a[152:155], v[180:183]
 v_mfma_f32_16x16x32_bf16 v[184:187], a[216:219], a[160:163], v[184:187]
 s_add_u32 m0, m0, 1024
 v_mfma_f32_16x16x32_bf16 v[184:187], a[220:223], a[164:167], v[184:187]
 v_mfma_f32_16x16x32_bf16 v[188:191], a[220:223], a[172:175], v[188:191]
 v_mfma_f32_16x16x32_bf16 v[188:191], a[216:219], a[168:171], v[188:191]
 v_mfma_f32_16x16x32_bf16 v[192:195], a[216:219], a[176:179], v[192:195]
 v_mfma_f32_16x16x32_bf16 v[192:195], a[220:223], a[180:183], v[192:195]
 v_mfma_f32_16x16x32_bf16 v[196:199], a[220:223], a[188:191], v[196:199]
 s_add_u32 s30, s30, s20
 v_mfma_f32_16x16x32_bf16 v[196:199], a[216:219], a[184:187], v[196:199]
 s_waitcnt vmcnt(12)
 v_mfma_f32_16x16x32_bf16 v[228:231], a[224:227], a[184:187], v[228:231]
 v_mfma_f32_16x16x32_bf16 v[228:231], a[228:231], a[188:191], v[228:231]
 global_load_dwordx4 a[220:223], v0, s[70:71] offset:3072
 v_mfma_f32_16x16x32_bf16 v[224:227], a[228:231], a[180:183], v[224:227]
 v_mfma_f32_16x16x32_bf16 v[224:227], a[224:227], a[176:179], v[224:227]
 global_load_dwordx4 a[216:219], v0, s[70:71] offset:2048
 v_mfma_f32_16x16x32_bf16 v[220:223], a[224:227], a[168:171], v[220:223]
 s_add_u32 s70, s70, 8192
 s_addc_u32 s71, s71, 0
 v_mfma_f32_16x16x32_bf16 v[220:223], a[228:231], a[172:175], v[220:223]
 buffer_load_dwordx4 v6, s[8:11], s30 offen sc1 lds
 v_mfma_f32_16x16x32_bf16 v[216:219], a[228:231], a[164:167], v[216:219]
 v_mfma_f32_16x16x32_bf16 v[216:219], a[224:227], a[160:163], v[216:219]
 v_mfma_f32_16x16x32_bf16 v[212:215], a[224:227], a[152:155], v[212:215]
 v_mfma_f32_16x16x32_bf16 v[212:215], a[228:231], a[156:159], v[212:215]
 v_mfma_f32_16x16x32_bf16 v[208:211], a[228:231], a[148:151], v[208:211]
 v_mfma_f32_16x16x32_bf16 v[208:211], a[224:227], a[144:147], v[208:211]
 s_add_u32 m0, m0, 3072
 v_mfma_f32_16x16x32_bf16 v[204:207], a[224:227], a[136:139], v[204:207]
 v_mfma_f32_16x16x32_bf16 v[204:207], a[228:231], a[140:143], v[204:207]
 v_mfma_f32_16x16x32_bf16 v[200:203], a[228:231], a[132:135], v[200:203]
 v_mfma_f32_16x16x32_bf16 v[200:203], a[224:227], a[128:131], v[200:203]
 s_add_u32 s30, s30, s21
 buffer_load_dwordx4 v6, s[8:11], s30 offen sc1 lds
 s_waitcnt vmcnt(13)
 v_mfma_f32_16x16x32_bf16 v[232:235], a[232:235], a[128:131], v[232:235]
 ds_read_b128 a[128:131], v2 offset:2048
 v_mfma_f32_16x16x32_bf16 v[232:235], a[236:239], a[132:135], v[232:235]
 global_load_dwordx4 a[228:231], v0, s[70:71] offset:-3072
 ds_read_b128 a[132:135], v2 offset:3072
 v_mfma_f32_16x16x32_bf16 v[236:239], a[236:239], a[140:143], v[236:239]
 ds_read_b128 a[140:143], v2 offset:7168
 v_mfma_f32_16x16x32_bf16 v[236:239], a[232:235], a[136:139], v[236:239]
 global_load_dwordx4 a[224:227], v0, s[70:71] offset:-4096
 ds_read_b128 a[136:139], v2 offset:6144
 v_mfma_f32_16x16x32_bf16 v[240:243], a[232:235], a[144:147], v[240:243]
 ds_read_b128 a[144:147], v2 offset:10240
 v_mfma_f32_16x16x32_bf16 v[240:243], a[236:239], a[148:151], v[240:243]
 ds_read_b128 a[148:151], v2 offset:11264
 v_mfma_f32_16x16x32_bf16 v[244:247], a[236:239], a[156:159], v[244:247]
 ds_read_b128 a[156:159], v2 offset:15360
 v_mfma_f32_16x16x32_bf16 v[244:247], a[232:235], a[152:155], v[244:247]
 ds_read_b128 a[152:155], v2 offset:14336
 v_mfma_f32_16x16x32_bf16 v[248:251], a[232:235], a[160:163], v[248:251]
 ds_read_b128 a[160:163], v2 offset:18432
 v_mfma_f32_16x16x32_bf16 v[248:251], a[236:239], a[164:167], v[248:251]
 ds_read_b128 a[164:167], v2 offset:19456
 v_mfma_f32_16x16x32_bf16 v[252:255], a[236:239], a[172:175], v[252:255]
 ds_read_b128 a[172:175], v2 offset:23552
 v_mfma_f32_16x16x32_bf16 v[252:255], a[232:235], a[168:171], v[252:255]
 ds_read_b128 a[168:171], v2 offset:22528
 v_mfma_f32_16x16x32_bf16 a[248:251], a[232:235], a[176:179], a[248:251]
 ds_read_b128 a[176:179], v2 offset:26624
 v_mfma_f32_16x16x32_bf16 a[248:251], a[236:239], a[180:183], a[248:251]
 ds_read_b128 a[180:183], v2 offset:27648
 v_mfma_f32_16x16x32_bf16 a[252:255], a[236:239], a[188:191], a[252:255]
 ds_read_b128 a[188:191], v2 offset:31744
 s_add_u32 m0, m0, 1024
 v_mfma_f32_16x16x32_bf16 a[252:255], a[232:235], a[184:187], a[252:255]
 ds_read_b128 a[184:187], v2 offset:30720
 s_waitcnt vmcnt(12) lgkmcnt(8)
 v_mfma_f32_16x16x32_bf16 v[16:19], a[192:195], a[128:131], v[16:19]
 v_mfma_f32_16x16x32_bf16 v[16:19], a[196:199], a[132:135], v[16:19]
 global_load_dwordx4 a[236:239], v0, s[70:71] offset:-1024
 v_mfma_f32_16x16x32_bf16 v[20:23], a[196:199], a[140:143], v[20:23]
 v_mfma_f32_16x16x32_bf16 v[20:23], a[192:195], a[136:139], v[20:23]
 global_load_dwordx4 a[232:235], v0, s[70:71] offset:-2048
 v_mfma_f32_16x16x32_bf16 v[24:27], a[192:195], a[144:147], v[24:27]
 s_add_u32 s30, s30, s20
 v_mfma_f32_16x16x32_bf16 v[24:27], a[196:199], a[148:151], v[24:27]
 v_mfma_f32_16x16x32_bf16 v[28:31], a[196:199], a[156:159], v[28:31]
 v_mfma_f32_16x16x32_bf16 v[28:31], a[192:195], a[152:155], v[28:31]
 s_waitcnt lgkmcnt(0)
 v_mfma_f32_16x16x32_bf16 v[32:35], a[192:195], a[160:163], v[32:35]
 v_mfma_f32_16x16x32_bf16 v[32:35], a[196:199], a[164:167], v[32:35]
 v_mfma_f32_16x16x32_bf16 v[36:39], a[196:199], a[172:175], v[36:39]
 buffer_load_dwordx4 v6, s[8:11], s30 offen sc1 lds
 v_mfma_f32_16x16x32_bf16 v[36:39], a[192:195], a[168:171], v[36:39]
 v_mfma_f32_16x16x32_bf16 v[40:43], a[192:195], a[176:179], v[40:43]
 v_mfma_f32_16x16x32_bf16 v[40:43], a[196:199], a[180:183], v[40:43]
 v_mfma_f32_16x16x32_bf16 v[44:47], a[196:199], a[188:191], v[44:47]
 v_mfma_f32_16x16x32_bf16 v[44:47], a[192:195], a[184:187], v[44:47]
 s_waitcnt vmcnt(12)
 v_mfma_f32_16x16x32_bf16 v[76:79], a[200:203], a[184:187], v[76:79]
 s_add_u32 m0, m0, 3072
 v_mfma_f32_16x16x32_bf16 v[76:79], a[204:207], a[188:191], v[76:79]
 global_load_dwordx4 a[196:199], v0, s[70:71] offset:1024
 v_mfma_f32_16x16x32_bf16 v[72:75], a[204:207], a[180:183], v[72:75]
 v_mfma_f32_16x16x32_bf16 v[72:75], a[200:203], a[176:179], v[72:75]
 global_load_dwordx4 a[192:195], v0, s[70:71] offset:0
 v_mfma_f32_16x16x32_bf16 v[68:71], a[200:203], a[168:171], v[68:71]
 v_mfma_f32_16x16x32_bf16 v[68:71], a[204:207], a[172:175], v[68:71]
 v_mfma_f32_16x16x32_bf16 v[64:67], a[204:207], a[164:167], v[64:67]
 v_mfma_f32_16x16x32_bf16 v[64:67], a[200:203], a[160:163], v[64:67]
 s_add_u32 s30, s30, s21
 v_mfma_f32_16x16x32_bf16 v[60:63], a[200:203], a[152:155], v[60:63]
 v_mfma_f32_16x16x32_bf16 v[60:63], a[204:207], a[156:159], v[60:63]
 v_mfma_f32_16x16x32_bf16 v[56:59], a[204:207], a[148:151], v[56:59]
 v_mfma_f32_16x16x32_bf16 v[56:59], a[200:203], a[144:147], v[56:59]
 v_mfma_f32_16x16x32_bf16 v[52:55], a[200:203], a[136:139], v[52:55]
 v_mfma_f32_16x16x32_bf16 v[52:55], a[204:207], a[140:143], v[52:55]
 buffer_load_dwordx4 v6, s[8:11], s30 offen sc1 lds
 v_mfma_f32_16x16x32_bf16 v[48:51], a[204:207], a[132:135], v[48:51]
 v_mfma_f32_16x16x32_bf16 v[48:51], a[200:203], a[128:131], v[48:51]
 s_waitcnt vmcnt(12)
 v_mfma_f32_16x16x32_bf16 v[80:83], a[208:211], a[128:131], v[80:83]
 v_mfma_f32_16x16x32_bf16 v[80:83], a[212:215], a[132:135], v[80:83]
 global_load_dwordx4 a[204:207], v0, s[70:71] offset:3072
 v_mfma_f32_16x16x32_bf16 v[84:87], a[212:215], a[140:143], v[84:87]
 v_mfma_f32_16x16x32_bf16 v[84:87], a[208:211], a[136:139], v[84:87]
 global_load_dwordx4 a[200:203], v0, s[70:71] offset:2048
 s_add_u32 m0, m0, 1024
 v_mfma_f32_16x16x32_bf16 v[88:91], a[208:211], a[144:147], v[88:91]
 s_add_u32 s70, s70, 8192
 s_addc_u32 s71, s71, 0
 v_mfma_f32_16x16x32_bf16 v[88:91], a[212:215], a[148:151], v[88:91]
 v_mfma_f32_16x16x32_bf16 v[92:95], a[212:215], a[156:159], v[92:95]
 v_mfma_f32_16x16x32_bf16 v[92:95], a[208:211], a[152:155], v[92:95]
 v_mfma_f32_16x16x32_bf16 v[96:99], a[208:211], a[160:163], v[96:99]
 v_mfma_f32_16x16x32_bf16 v[96:99], a[212:215], a[164:167], v[96:99]
 v_mfma_f32_16x16x32_bf16 v[100:103], a[212:215], a[172:175], v[100:103]
 s_add_u32 s30, s30, s20
 v_mfma_f32_16x16x32_bf16 v[100:103], a[208:211], a[168:171], v[100:103]
 v_mfma_f32_16x16x32_bf16 v[104:107], a[208:211], a[176:179], v[104:107]
 v_mfma_f32_16x16x32_bf16 v[104:107], a[212:215], a[180:183], v[104:107]
 v_mfma_f32_16x16x32_bf16 v[108:111], a[212:215], a[188:191], v[108:111]
 v_mfma_f32_16x16x32_bf16 v[108:111], a[208:211], a[184:187], v[108:111]
 s_waitcnt vmcnt(12)
 v_mfma_f32_16x16x32_bf16 a[244:247], a[216:219], a[184:187], a[244:247]
 buffer_load_dwordx4 v6, s[8:11], s30 offen sc1 lds
 v_mfma_f32_16x16x32_bf16 a[244:247], a[220:223], a[188:191], a[244:247]
 global_load_dwordx4 a[212:215], v0, s[70:71] offset:-3072
 v_mfma_f32_16x16x32_bf16 a[240:243], a[220:223], a[180:183], a[240:243]
 v_mfma_f32_16x16x32_bf16 a[240:243], a[216:219], a[176:179], a[240:243]
 global_load_dwordx4 a[208:211], v0, s[70:71] offset:-4096
 v_mfma_f32_16x16x32_bf16 v[132:135], a[216:219], a[168:171], v[132:135]
 v_mfma_f32_16x16x32_bf16 v[132:135], a[220:223], a[172:175], v[132:135]
 v_mfma_f32_16x16x32_bf16 v[128:131], a[220:223], a[164:167], v[128:131]
 s_add_u32 m0, m0, 3072
 v_mfma_f32_16x16x32_bf16 v[128:131], a[216:219], a[160:163], v[128:131]
 v_mfma_f32_16x16x32_bf16 v[124:127], a[216:219], a[152:155], v[124:127]
 v_mfma_f32_16x16x32_bf16 v[124:127], a[220:223], a[156:159], v[124:127]
 v_mfma_f32_16x16x32_bf16 v[120:123], a[220:223], a[148:151], v[120:123]
 v_mfma_f32_16x16x32_bf16 v[120:123], a[216:219], a[144:147], v[120:123]
 v_mfma_f32_16x16x32_bf16 v[116:119], a[216:219], a[136:139], v[116:119]
 s_add_u32 s30, s30, s22
 v_mfma_f32_16x16x32_bf16 v[116:119], a[220:223], a[140:143], v[116:119]
 v_mfma_f32_16x16x32_bf16 v[112:115], a[220:223], a[132:135], v[112:115]
 v_mfma_f32_16x16x32_bf16 v[112:115], a[216:219], a[128:131], v[112:115]
 s_waitcnt vmcnt(11)
 v_mfma_f32_16x16x32_bf16 v[136:139], a[224:227], a[128:131], v[136:139]
 v_mfma_f32_16x16x32_bf16 v[136:139], a[228:231], a[132:135], v[136:139]
 global_load_dwordx4 a[220:223], v0, s[70:71] offset:-1024
 v_mfma_f32_16x16x32_bf16 v[140:143], a[228:231], a[140:143], v[140:143]
 v_mfma_f32_16x16x32_bf16 v[140:143], a[224:227], a[136:139], v[140:143]
 global_load_dwordx4 a[216:219], v0, s[70:71] offset:-2048
 v_mfma_f32_16x16x32_bf16 v[144:147], a[224:227], a[144:147], v[144:147]
 v_mfma_f32_16x16x32_bf16 v[144:147], a[228:231], a[148:151], v[144:147]
 v_mfma_f32_16x16x32_bf16 v[148:151], a[228:231], a[156:159], v[148:151]
 v_mfma_f32_16x16x32_bf16 v[148:151], a[224:227], a[152:155], v[148:151]
 v_mfma_f32_16x16x32_bf16 v[152:155], a[224:227], a[160:163], v[152:155]
 v_mfma_f32_16x16x32_bf16 v[152:155], a[228:231], a[164:167], v[152:155]
 v_mfma_f32_16x16x32_bf16 v[156:159], a[228:231], a[172:175], v[156:159]
 v_mfma_f32_16x16x32_bf16 v[156:159], a[224:227], a[168:171], v[156:159]
 v_mfma_f32_16x16x32_bf16 v[160:163], a[224:227], a[176:179], v[160:163]
 v_mfma_f32_16x16x32_bf16 v[160:163], a[228:231], a[180:183], v[160:163]
 v_mfma_f32_16x16x32_bf16 v[164:167], a[228:231], a[188:191], v[164:167]
 v_mfma_f32_16x16x32_bf16 v[164:167], a[224:227], a[184:187], v[164:167]
 s_waitcnt vmcnt(11)
 v_mfma_f32_16x16x32_bf16 v[196:199], a[232:235], a[184:187], v[196:199]
 v_mfma_f32_16x16x32_bf16 v[196:199], a[236:239], a[188:191], v[196:199]
 global_load_dwordx4 a[228:231], v0, s[70:71] offset:1024
 v_mfma_f32_16x16x32_bf16 v[192:195], a[236:239], a[180:183], v[192:195]
 v_mfma_f32_16x16x32_bf16 v[192:195], a[232:235], a[176:179], v[192:195]
 global_load_dwordx4 a[224:227], v0, s[70:71] offset:0
 v_mfma_f32_16x16x32_bf16 v[188:191], a[232:235], a[168:171], v[188:191]
 v_mfma_f32_16x16x32_bf16 v[188:191], a[236:239], a[172:175], v[188:191]
 v_mfma_f32_16x16x32_bf16 v[184:187], a[236:239], a[164:167], v[184:187]
 v_mfma_f32_16x16x32_bf16 v[184:187], a[232:235], a[160:163], v[184:187]
 v_mfma_f32_16x16x32_bf16 v[180:183], a[232:235], a[152:155], v[180:183]
 v_mfma_f32_16x16x32_bf16 v[180:183], a[236:239], a[156:159], v[180:183]
 v_mfma_f32_16x16x32_bf16 v[176:179], a[236:239], a[148:151], v[176:179]
 v_mfma_f32_16x16x32_bf16 v[176:179], a[232:235], a[144:147], v[176:179]
 v_mfma_f32_16x16x32_bf16 v[172:175], a[232:235], a[136:139], v[172:175]
 v_mfma_f32_16x16x32_bf16 v[172:175], a[236:239], a[140:143], v[172:175]
 v_mfma_f32_16x16x32_bf16 v[168:171], a[236:239], a[132:135], v[168:171]
 v_mfma_f32_16x16x32_bf16 v[168:171], a[232:235], a[128:131], v[168:171]
 s_waitcnt vmcnt(10)
 v_mfma_f32_16x16x32_bf16 v[200:203], a[192:195], a[128:131], v[200:203]
 v_mfma_f32_16x16x32_bf16 v[200:203], a[196:199], a[132:135], v[200:203]
 global_load_dwordx4 a[236:239], v0, s[70:71] offset:3072
 v_mfma_f32_16x16x32_bf16 v[204:207], a[196:199], a[140:143], v[204:207]
 v_mfma_f32_16x16x32_bf16 v[204:207], a[192:195], a[136:139], v[204:207]
 global_load_dwordx4 a[232:235], v0, s[70:71] offset:2048
 v_mfma_f32_16x16x32_bf16 v[208:211], a[192:195], a[144:147], v[208:211]
 s_add_u32 s70, s70, 8192
 s_addc_u32 s71, s71, 0
 v_mfma_f32_16x16x32_bf16 v[208:211], a[196:199], a[148:151], v[208:211]
 v_mfma_f32_16x16x32_bf16 v[212:215], a[196:199], a[156:159], v[212:215]
 v_mfma_f32_16x16x32_bf16 v[212:215], a[192:195], a[152:155], v[212:215]
 v_mfma_f32_16x16x32_bf16 v[216:219], a[192:195], a[160:163], v[216:219]
 v_mfma_f32_16x16x32_bf16 v[216:219], a[196:199], a[164:167], v[216:219]
 v_mfma_f32_16x16x32_bf16 v[220:223], a[196:199], a[172:175], v[220:223]
 v_mfma_f32_16x16x32_bf16 v[220:223], a[192:195], a[168:171], v[220:223]
 v_mfma_f32_16x16x32_bf16 v[224:227], a[192:195], a[176:179], v[224:227]
 v_mfma_f32_16x16x32_bf16 v[224:227], a[196:199], a[180:183], v[224:227]
 v_mfma_f32_16x16x32_bf16 v[228:231], a[196:199], a[188:191], v[228:231]
 v_mfma_f32_16x16x32_bf16 v[228:231], a[192:195], a[184:187], v[228:231]
 s_waitcnt vmcnt(9)
 v_mfma_f32_16x16x32_bf16 a[252:255], a[200:203], a[184:187], a[252:255]
 ds_read_b128 a[184:187], v2 offset:63488
 v_mfma_f32_16x16x32_bf16 a[252:255], a[204:207], a[188:191], a[252:255]
 global_load_dwordx4 a[196:199], v0, s[70:71] offset:-3072
 ds_read_b128 a[188:191], v2 offset:64512
 v_mfma_f32_16x16x32_bf16 a[248:251], a[204:207], a[180:183], a[248:251]
 ds_read_b128 a[180:183], v2 offset:60416
 v_mfma_f32_16x16x32_bf16 a[248:251], a[200:203], a[176:179], a[248:251]
 global_load_dwordx4 a[192:195], v0, s[70:71] offset:-4096
 ds_read_b128 a[176:179], v2 offset:59392
 v_mfma_f32_16x16x32_bf16 v[252:255], a[200:203], a[168:171], v[252:255]
 ds_read_b128 a[168:171], v2 offset:55296
 v_mfma_f32_16x16x32_bf16 v[252:255], a[204:207], a[172:175], v[252:255]
 ds_read_b128 a[172:175], v2 offset:56320
 v_mfma_f32_16x16x32_bf16 v[248:251], a[204:207], a[164:167], v[248:251]
 ds_read_b128 a[164:167], v2 offset:52224
 v_mfma_f32_16x16x32_bf16 v[248:251], a[200:203], a[160:163], v[248:251]
 ds_read_b128 a[160:163], v2 offset:51200
 v_mfma_f32_16x16x32_bf16 v[244:247], a[200:203], a[152:155], v[244:247]
 ds_read_b128 a[152:155], v2 offset:47104
 v_mfma_f32_16x16x32_bf16 v[244:247], a[204:207], a[156:159], v[244:247]
 ds_read_b128 a[156:159], v2 offset:48128
 v_mfma_f32_16x16x32_bf16 v[240:243], a[204:207], a[148:151], v[240:243]
 ds_read_b128 a[148:151], v2 offset:44032
 v_mfma_f32_16x16x32_bf16 v[240:243], a[200:203], a[144:147], v[240:243]
 ds_read_b128 a[144:147], v2 offset:43008
 v_mfma_f32_16x16x32_bf16 v[236:239], a[200:203], a[136:139], v[236:239]
 ds_read_b128 a[136:139], v2 offset:38912
 v_mfma_f32_16x16x32_bf16 v[236:239], a[204:207], a[140:143], v[236:239]
 ds_read_b128 a[140:143], v2 offset:39936
 v_mfma_f32_16x16x32_bf16 v[232:235], a[204:207], a[132:135], v[232:235]
 ds_read_b128 a[132:135], v2 offset:35840
 v_mfma_f32_16x16x32_bf16 v[232:235], a[200:203], a[128:131], v[232:235]
 ds_read_b128 a[128:131], v2 offset:34816
 s_waitcnt vmcnt(8) lgkmcnt(8)
 v_mfma_f32_16x16x32_bf16 v[44:47], a[208:211], a[184:187], v[44:47]
 v_mfma_f32_16x16x32_bf16 v[44:47], a[212:215], a[188:191], v[44:47]
 global_load_dwordx4 a[204:207], v0, s[70:71] offset:-1024
 v_mfma_f32_16x16x32_bf16 v[40:43], a[212:215], a[180:183], v[40:43]
 buffer_load_dword v4, off, s[64:67], 0 sc1
 v_mfma_f32_16x16x32_bf16 v[40:43], a[208:211], a[176:179], v[40:43]
 global_load_dwordx4 a[200:203], v0, s[70:71] offset:-2048
 v_mfma_f32_16x16x32_bf16 v[36:39], a[208:211], a[168:171], v[36:39]
 v_mfma_f32_16x16x32_bf16 v[36:39], a[212:215], a[172:175], v[36:39]
 v_mfma_f32_16x16x32_bf16 v[32:35], a[212:215], a[164:167], v[32:35]
 v_mfma_f32_16x16x32_bf16 v[32:35], a[208:211], a[160:163], v[32:35]
 s_waitcnt lgkmcnt(0)
 v_mfma_f32_16x16x32_bf16 v[28:31], a[208:211], a[152:155], v[28:31]
 v_mfma_f32_16x16x32_bf16 v[28:31], a[212:215], a[156:159], v[28:31]
 v_mfma_f32_16x16x32_bf16 v[24:27], a[212:215], a[148:151], v[24:27]
 v_mfma_f32_16x16x32_bf16 v[24:27], a[208:211], a[144:147], v[24:27]
 v_mfma_f32_16x16x32_bf16 v[20:23], a[208:211], a[136:139], v[20:23]
 v_mfma_f32_16x16x32_bf16 v[20:23], a[212:215], a[140:143], v[20:23]
 v_mfma_f32_16x16x32_bf16 v[16:19], a[212:215], a[132:135], v[16:19]
 v_mfma_f32_16x16x32_bf16 v[16:19], a[208:211], a[128:131], v[16:19]
 s_waitcnt vmcnt(9)
 v_mfma_f32_16x16x32_bf16 v[48:51], a[216:219], a[128:131], v[48:51]
 v_lshrrev_b32 v5, 6, v1
 v_mfma_f32_16x16x32_bf16 v[48:51], a[220:223], a[132:135], v[48:51]
 global_load_dwordx4 a[212:215], v0, s[70:71] offset:1024
 v_mfma_f32_16x16x32_bf16 v[52:55], a[220:223], a[140:143], v[52:55]
 v_and_b32 v6, 48, v1
 v_mfma_f32_16x16x32_bf16 v[52:55], a[216:219], a[136:139], v[52:55]
 global_load_dwordx4 a[208:211], v0, s[70:71] offset:0
 v_lshl_add_u32 v5, v5, 11, v6
 v_mfma_f32_16x16x32_bf16 v[56:59], a[216:219], a[144:147], v[56:59]
 v_mfma_f32_16x16x32_bf16 v[56:59], a[220:223], a[148:151], v[56:59]
 s_mov_b32 m0, s52
 v_mfma_f32_16x16x32_bf16 v[60:63], a[220:223], a[156:159], v[60:63]
 s_add_u32 s3, s48, 31744
 v_mfma_f32_16x16x32_bf16 v[60:63], a[216:219], a[152:155], v[60:63]
 v_mfma_f32_16x16x32_bf16 v[64:67], a[216:219], a[160:163], v[64:67]
 buffer_load_dwordx4 v5, s[40:43], s48 offen lds
 v_mfma_f32_16x16x32_bf16 v[64:67], a[220:223], a[164:167], v[64:67]
 buffer_load_dwordx4 v5, s[40:43], s3 offen offset:1024 lds
 v_mfma_f32_16x16x32_bf16 v[68:71], a[220:223], a[172:175], v[68:71]
 v_mfma_f32_16x16x32_bf16 v[68:71], a[216:219], a[168:171], v[68:71]
 s_add_u32 s48, s48, 2097152
 v_mfma_f32_16x16x32_bf16 v[72:75], a[216:219], a[176:179], v[72:75]
 v_mfma_f32_16x16x32_bf16 v[72:75], a[220:223], a[180:183], v[72:75]
 v_mfma_f32_16x16x32_bf16 v[76:79], a[220:223], a[188:191], v[76:79]
 v_mfma_f32_16x16x32_bf16 v[76:79], a[216:219], a[184:187], v[76:79]
 s_waitcnt vmcnt(11)
 v_mfma_f32_16x16x32_bf16 v[108:111], a[224:227], a[184:187], v[108:111]
 v_mfma_f32_16x16x32_bf16 v[108:111], a[228:231], a[188:191], v[108:111]
 global_load_dwordx4 a[220:223], v0, s[70:71] offset:3072
 v_mfma_f32_16x16x32_bf16 v[104:107], a[228:231], a[180:183], v[104:107]
 v_mfma_f32_16x16x32_bf16 v[104:107], a[224:227], a[176:179], v[104:107]
 global_load_dwordx4 a[216:219], v0, s[70:71] offset:2048
 v_mfma_f32_16x16x32_bf16 v[100:103], a[224:227], a[168:171], v[100:103]
 s_add_u32 s70, s70, 8192
 s_addc_u32 s71, s71, 0
 v_mfma_f32_16x16x32_bf16 v[100:103], a[228:231], a[172:175], v[100:103]
 v_mfma_f32_16x16x32_bf16 v[96:99], a[228:231], a[164:167], v[96:99]
 v_mfma_f32_16x16x32_bf16 v[96:99], a[224:227], a[160:163], v[96:99]
 v_mfma_f32_16x16x32_bf16 v[92:95], a[224:227], a[152:155], v[92:95]
 v_mfma_f32_16x16x32_bf16 v[92:95], a[228:231], a[156:159], v[92:95]
 v_mfma_f32_16x16x32_bf16 v[88:91], a[228:231], a[148:151], v[88:91]
 v_mfma_f32_16x16x32_bf16 v[88:91], a[224:227], a[144:147], v[88:91]
 v_mfma_f32_16x16x32_bf16 v[84:87], a[224:227], a[136:139], v[84:87]
 v_mfma_f32_16x16x32_bf16 v[84:87], a[228:231], a[140:143], v[84:87]
 v_mfma_f32_16x16x32_bf16 v[80:83], a[228:231], a[132:135], v[80:83]
 v_mfma_f32_16x16x32_bf16 v[80:83], a[224:227], a[128:131], v[80:83]
 s_waitcnt vmcnt(11)
 v_mfma_f32_16x16x32_bf16 v[112:115], a[232:235], a[128:131], v[112:115]
 v_mfma_f32_16x16x32_bf16 v[112:115], a[236:239], a[132:135], v[112:115]
 global_load_dwordx4 a[228:231], v0, s[70:71] offset:-3072
 v_mfma_f32_16x16x32_bf16 v[116:119], a[236:239], a[140:143], v[116:119]
 v_mfma_f32_16x16x32_bf16 v[116:119], a[232:235], a[136:139], v[116:119]
 global_load_dwordx4 a[224:227], v0, s[70:71] offset:-4096
 v_mfma_f32_16x16x32_bf16 v[120:123], a[232:235], a[144:147], v[120:123]
 v_mfma_f32_16x16x32_bf16 v[120:123], a[236:239], a[148:151], v[120:123]
 v_mfma_f32_16x16x32_bf16 v[124:127], a[236:239], a[156:159], v[124:127]
 v_mfma_f32_16x16x32_bf16 v[124:127], a[232:235], a[152:155], v[124:127]
 v_mfma_f32_16x16x32_bf16 v[128:131], a[232:235], a[160:163], v[128:131]
 v_mfma_f32_16x16x32_bf16 v[128:131], a[236:239], a[164:167], v[128:131]
 v_mfma_f32_16x16x32_bf16 v[132:135], a[236:239], a[172:175], v[132:135]
 v_mfma_f32_16x16x32_bf16 v[132:135], a[232:235], a[168:171], v[132:135]
 v_mfma_f32_16x16x32_bf16 a[240:243], a[232:235], a[176:179], a[240:243]
 v_mfma_f32_16x16x32_bf16 a[240:243], a[236:239], a[180:183], a[240:243]
 v_mfma_f32_16x16x32_bf16 a[244:247], a[236:239], a[188:191], a[244:247]
 v_mfma_f32_16x16x32_bf16 a[244:247], a[232:235], a[184:187], a[244:247]
 s_waitcnt vmcnt(11)
 v_mfma_f32_16x16x32_bf16 v[164:167], a[192:195], a[184:187], v[164:167]
 v_mfma_f32_16x16x32_bf16 v[164:167], a[196:199], a[188:191], v[164:167]
 global_load_dwordx4 a[236:239], v0, s[70:71] offset:-1024
 v_mfma_f32_16x16x32_bf16 v[160:163], a[196:199], a[180:183], v[160:163]
 v_mfma_f32_16x16x32_bf16 v[160:163], a[192:195], a[176:179], v[160:163]
 global_load_dwordx4 a[232:235], v0, s[70:71] offset:-2048
 v_mfma_f32_16x16x32_bf16 v[156:159], a[192:195], a[168:171], v[156:159]
 v_mfma_f32_16x16x32_bf16 v[156:159], a[196:199], a[172:175], v[156:159]
 v_mfma_f32_16x16x32_bf16 v[152:155], a[196:199], a[164:167], v[152:155]
 v_mfma_f32_16x16x32_bf16 v[152:155], a[192:195], a[160:163], v[152:155]
 v_mfma_f32_16x16x32_bf16 v[148:151], a[192:195], a[152:155], v[148:151]
 v_mfma_f32_16x16x32_bf16 v[148:151], a[196:199], a[156:159], v[148:151]
 v_mfma_f32_16x16x32_bf16 v[144:147], a[196:199], a[148:151], v[144:147]
 v_mfma_f32_16x16x32_bf16 v[144:147], a[192:195], a[144:147], v[144:147]
 v_mfma_f32_16x16x32_bf16 v[140:143], a[192:195], a[136:139], v[140:143]
 v_mfma_f32_16x16x32_bf16 v[140:143], a[196:199], a[140:143], v[140:143]
 v_mfma_f32_16x16x32_bf16 v[136:139], a[196:199], a[132:135], v[136:139]
 v_mfma_f32_16x16x32_bf16 v[136:139], a[192:195], a[128:131], v[136:139]
 s_waitcnt vmcnt(10)
 v_mfma_f32_16x16x32_bf16 v[168:171], a[200:203], a[128:131], v[168:171]
 v_mfma_f32_16x16x32_bf16 v[168:171], a[204:207], a[132:135], v[168:171]
 global_load_dwordx4 a[196:199], v0, s[70:71] offset:1024
 v_mfma_f32_16x16x32_bf16 v[172:175], a[204:207], a[140:143], v[172:175]
 v_mfma_f32_16x16x32_bf16 v[172:175], a[200:203], a[136:139], v[172:175]
 global_load_dwordx4 a[192:195], v0, s[70:71] offset:0
 v_mfma_f32_16x16x32_bf16 v[176:179], a[200:203], a[144:147], v[176:179]
 v_mfma_f32_16x16x32_bf16 v[176:179], a[204:207], a[148:151], v[176:179]
 v_mfma_f32_16x16x32_bf16 v[180:183], a[204:207], a[156:159], v[180:183]
 v_mfma_f32_16x16x32_bf16 v[180:183], a[200:203], a[152:155], v[180:183]
 v_mfma_f32_16x16x32_bf16 v[184:187], a[200:203], a[160:163], v[184:187]
 v_mfma_f32_16x16x32_bf16 v[184:187], a[204:207], a[164:167], v[184:187]
 v_mfma_f32_16x16x32_bf16 v[188:191], a[204:207], a[172:175], v[188:191]
 v_mfma_f32_16x16x32_bf16 v[188:191], a[200:203], a[168:171], v[188:191]
 v_mfma_f32_16x16x32_bf16 v[192:195], a[200:203], a[176:179], v[192:195]
 v_mfma_f32_16x16x32_bf16 v[192:195], a[204:207], a[180:183], v[192:195]
 v_mfma_f32_16x16x32_bf16 v[196:199], a[204:207], a[188:191], v[196:199]
 v_mfma_f32_16x16x32_bf16 v[196:199], a[200:203], a[184:187], v[196:199]
 s_waitcnt vmcnt(10)
 v_mfma_f32_16x16x32_bf16 v[228:231], a[208:211], a[184:187], v[228:231]
 v_mfma_f32_16x16x32_bf16 v[228:231], a[212:215], a[188:191], v[228:231]
 global_load_dwordx4 a[204:207], v0, s[70:71] offset:3072
 v_mfma_f32_16x16x32_bf16 v[224:227], a[212:215], a[180:183], v[224:227]
 v_mfma_f32_16x16x32_bf16 v[224:227], a[208:211], a[176:179], v[224:227]
 global_load_dwordx4 a[200:203], v0, s[70:71] offset:2048
 v_mfma_f32_16x16x32_bf16 v[220:223], a[208:211], a[168:171], v[220:223]
 s_add_u32 s70, s70, 8192
 s_addc_u32 s71, s71, 0
 v_mfma_f32_16x16x32_bf16 v[220:223], a[212:215], a[172:175], v[220:223]
 v_mfma_f32_16x16x32_bf16 v[216:219], a[212:215], a[164:167], v[216:219]
 v_mfma_f32_16x16x32_bf16 v[216:219], a[208:211], a[160:163], v[216:219]
 v_mfma_f32_16x16x32_bf16 v[212:215], a[208:211], a[152:155], v[212:215]
 v_mfma_f32_16x16x32_bf16 v[212:215], a[212:215], a[156:159], v[212:215]
 v_mfma_f32_16x16x32_bf16 v[208:211], a[212:215], a[148:151], v[208:211]
 v_cmp_gt_i32 vcc, s55, v4
 s_cbranch_vccnz Lspin_pb
Lok_pb:
 s_add_u32 s55, s55, 1
 s_waitcnt lgkmcnt(0)
 s_barrier
 v_mfma_f32_16x16x32_bf16 v[208:211], a[208:211], a[144:147], v[208:211]
 v_mfma_f32_16x16x32_bf16 v[204:207], a[208:211], a[136:139], v[204:207]
 v_mfma_f32_16x16x32_bf16 v[204:207], a[212:215], a[140:143], v[204:207]
 v_mfma_f32_16x16x32_bf16 v[200:203], a[212:215], a[132:135], v[200:203]
 v_mfma_f32_16x16x32_bf16 v[200:203], a[208:211], a[128:131], v[200:203]
 s_waitcnt vmcnt(8)
 v_mfma_f32_16x16x32_bf16 v[232:235], a[216:219], a[128:131], v[232:235]
 ds_read_b128 a[128:131], v1
 v_mfma_f32_16x16x32_bf16 v[232:235], a[220:223], a[132:135], v[232:235]
 global_load_dwordx4 a[212:215], v0, s[70:71] offset:-3072
 ds_read_b128 a[132:135], v1 offset:1024
 v_mfma_f32_16x16x32_bf16 v[236:239], a[220:223], a[140:143], v[236:239]
 ds_read_b128 a[140:143], v1 offset:5120
 v_mfma_f32_16x16x32_bf16 v[236:239], a[216:219], a[136:139], v[236:239]
 global_load_dwordx4 a[208:211], v0, s[70:71] offset:-4096
 ds_read_b128 a[136:139], v1 offset:4096
 v_mfma_f32_16x16x32_bf16 v[240:243], a[216:219], a[144:147], v[240:243]
 ds_read_b128 a[144:147], v1 offset:8192
 v_mfma_f32_16x16x32_bf16 v[240:243], a[220:223], a[148:151], v[240:243]
 ds_read_b128 a[148:151], v1 offset:9216
 v_mfma_f32_16x16x32_bf16 v[244:247], a[220:223], a[156:159], v[244:247]
 ds_read_b128 a[156:159], v1 offset:13312
 v_mfma_f32_16x16x32_bf16 v[244:247], a[216:219], a[152:155], v[244:247]
 ds_read_b128 a[152:155], v1 offset:12288
 v_mfma_f32_16x16x32_bf16 v[248:251], a[216:219], a[160:163], v[248:251]
 ds_read_b128 a[160:163], v1 offset:16384
 v_mfma_f32_16x16x32_bf16 v[248:251], a[220:223], a[164:167], v[248:251]
 ds_read_b128 a[164:167], v1 offset:17408
 v_mfma_f32_16x16x32_bf16 v[252:255], a[220:223], a[172:175], v[252:255]
 ds_read_b128 a[172:175], v1 offset:21504
 v_mfma_f32_16x16x32_bf16 v[252:255], a[216:219], a[168:171], v[252:255]
 ds_read_b128 a[168:171], v1 offset:20480
 v_mfma_f32_16x16x32_bf16 a[248:251], a[216:219], a[176:179], a[248:251]
 ds_read_b128 a[176:179], v1 offset:24576
 v_mfma_f32_16x16x32_bf16 a[248:251], a[220:223], a[180:183], a[248:251]
 ds_read_b128 a[180:183], v1 offset:25600
 v_mfma_f32_16x16x32_bf16 a[252:255], a[220:223], a[188:191], a[252:255]
 global_load_dwordx4 a[220:223], v0, s[70:71] offset:-1024
 ds_read_b128 a[188:191], v1 offset:29696
 v_mfma_f32_16x16x32_bf16 a[252:255], a[216:219], a[184:187], a[252:255]
 global_load_dwordx4 a[216:219], v0, s[70:71] offset:-2048
 ds_read_b128 a[184:187], v1 offset:28672
 s_waitcnt vmcnt(10) lgkmcnt(8)
 v_mfma_f32_16x16x32_bf16 v[16:19], a[224:227], a[128:131], v[16:19]
 v_mfma_f32_16x16x32_bf16 v[16:19], a[228:231], a[132:135], v[16:19]
 v_mfma_f32_16x16x32_bf16 v[20:23], a[228:231], a[140:143], v[20:23]
 v_mfma_f32_16x16x32_bf16 v[20:23], a[224:227], a[136:139], v[20:23]
 v_mov_b32 v6, v3
 s_cmp_eq_u32 s25, 0
 s_cbranch_scc1 Lgat1
Lgatr1:
 v_mfma_f32_16x16x32_bf16 v[24:27], a[224:227], a[144:147], v[24:27]
 v_mfma_f32_16x16x32_bf16 v[24:27], a[228:231], a[148:151], v[24:27]
 v_mfma_f32_16x16x32_bf16 v[28:31], a[228:231], a[156:159], v[28:31]
 v_mfma_f32_16x16x32_bf16 v[28:31], a[224:227], a[152:155], v[28:31]
 s_waitcnt lgkmcnt(0)
 v_mfma_f32_16x16x32_bf16 v[32:35], a[224:227], a[160:163], v[32:35]
 v_mfma_f32_16x16x32_bf16 v[32:35], a[228:231], a[164:167], v[32:35]
 s_add_u32 m0, s50, 2048
 v_mfma_f32_16x16x32_bf16 v[36:39], a[228:231], a[172:175], v[36:39]
 v_mfma_f32_16x16x32_bf16 v[36:39], a[224:227], a[168:171], v[36:39]
 v_mfma_f32_16x16x32_bf16 v[40:43], a[224:227], a[176:179], v[40:43]
 v_mfma_f32_16x16x32_bf16 v[40:43], a[228:231], a[180:183], v[40:43]
 v_mfma_f32_16x16x32_bf16 v[44:47], a[228:231], a[188:191], v[44:47]
 v_mfma_f32_16x16x32_bf16 v[44:47], a[224:227], a[184:187], v[44:47]
 s_waitcnt vmcnt(8)
 v_mfma_f32_16x16x32_bf16 v[76:79], a[232:235], a[184:187], v[76:79]
 v_mfma_f32_16x16x32_bf16 v[76:79], a[236:239], a[188:191], v[76:79]
 global_load_dwordx4 a[228:231], v0, s[70:71] offset:1024
 v_mfma_f32_16x16x32_bf16 v[72:75], a[236:239], a[180:183], v[72:75]
 v_mfma_f32_16x16x32_bf16 v[72:75], a[232:235], a[176:179], v[72:75]
 global_load_dwordx4 a[224:227], v0, s[70:71] offset:0
 v_mfma_f32_16x16x32_bf16 v[68:71], a[232:235], a[168:171], v[68:71]
 v_mfma_f32_16x16x32_bf16 v[68:71], a[236:239], a[172:175], v[68:71]
 buffer_load_dwordx4 v6, s[8:11], s30 offen sc1 lds
 v_mfma_f32_16x16x32_bf16 v[64:67], a[236:239], a[164:167], v[64:67]
 v_mfma_f32_16x16x32_bf16 v[64:67], a[232:235], a[160:163], v[64:67]
 v_mfma_f32_16x16x32_bf16 v[60:63], a[232:235], a[152:155], v[60:63]
 v_mfma_f32_16x16x32_bf16 v[60:63], a[236:239], a[156:159], v[60:63]
 v_mfma_f32_16x16x32_bf16 v[56:59], a[236:239], a[148:151], v[56:59]
 v_mfma_f32_16x16x32_bf16 v[56:59], a[232:235], a[144:147], v[56:59]
 v_mfma_f32_16x16x32_bf16 v[52:55], a[232:235], a[136:139], v[52:55]
 s_add_u32 m0, m0, 1024
 v_mfma_f32_16x16x32_bf16 v[52:55], a[236:239], a[140:143], v[52:55]
 v_mfma_f32_16x16x32_bf16 v[48:51], a[236:239], a[132:135], v[48:51]
 v_mfma_f32_16x16x32_bf16 v[48:51], a[232:235], a[128:131], v[48:51]
 s_waitcnt vmcnt(9)
 v_mfma_f32_16x16x32_bf16 v[80:83], a[192:195], a[128:131], v[80:83]
 v_mfma_f32_16x16x32_bf16 v[80:83], a[196:199], a[132:135], v[80:83]
 global_load_dwordx4 a[236:239], v0, s[70:71] offset:3072
 v_mfma_f32_16x16x32_bf16 v[84:87], a[196:199], a[140:143], v[84:87]
 s_add_u32 s30, s30, s20
 v_mfma_f32_16x16x32_bf16 v[84:87], a[192:195], a[136:139], v[84:87]
 global_load_dwordx4 a[232:235], v0, s[70:71] offset:2048
 v_mfma_f32_16x16x32_bf16 v[88:91], a[192:195], a[144:147], v[88:91]
 s_add_u32 s70, s70, 8192
 s_addc_u32 s71, s71, 0
 v_mfma_f32_16x16x32_bf16 v[88:91], a[196:199], a[148:151], v[88:91]
 v_mfma_f32_16x16x32_bf16 v[92:95], a[196:199], a[156:159], v[92:95]
 v_mfma_f32_16x16x32_bf16 v[92:95], a[192:195], a[152:155], v[92:95]
 v_mfma_f32_16x16x32_bf16 v[96:99], a[192:195], a[160:163], v[96:99]
 buffer_load_dwordx4 v6, s[8:11], s30 offen sc1 lds
 v_mfma_f32_16x16x32_bf16 v[96:99], a[196:199], a[164:167], v[96:99]
 v_mfma_f32_16x16x32_bf16 v[100:103], a[196:199], a[172:175], v[100:103]
 v_mfma_f32_16x16x32_bf16 v[100:103], a[192:195], a[168:171], v[100:103]
 v_mfma_f32_16x16x32_bf16 v[104:107], a[192:195], a[176:179], v[104:107]
 v_mfma_f32_16x16x32_bf16 v[104:107], a[196:199], a[180:183], v[104:107]
 v_mfma_f32_16x16x32_bf16 v[108:111], a[196:199], a[188:191], v[108:111]
 v_mfma_f32_16x16x32_bf16 v[108:111], a[192:195], a[184:187], v[108:111]
 s_add_u32 m0, m0, 3072
 s_waitcnt vmcnt(10)
 v_mfma_f32_16x16x32_bf16 a[244:247], a[200:203], a[184:187], a[244:247]
 v_mfma_f32_16x16x32_bf16 a[244:247], a[204:207], a[188:191], a[244:247]
 global_load_dwordx4 a[196:199], v0, s[70:71] offset:-3072
 v_mfma_f32_16x16x32_bf16 a[240:243], a[204:207], a[180:183], a[240:243]
 v_mfma_f32_16x16x32_bf16 a[240:243], a[200:203], a[176:179], a[240:243]
 global_load_dwordx4 a[192:195], v0, s[70:71] offset:-4096
 v_mfma_f32_16x16x32_bf16 v[132:135], a[200:203], a[168:171], v[132:135]
 v_mfma_f32_16x16x32_bf16 v[132:135], a[204:207], a[172:175], v[132:135]
 s_add_u32 s30, s30, s21
 v_mfma_f32_16x16x32_bf16 v[128:131], a[204:207], a[164:167], v[128:131]
 v_mfma_f32_16x16x32_bf16 v[128:131], a[200:203], a[160:163], v[128:131]
 v_mfma_f32_16x16x32_bf16 v[124:127], a[200:203], a[152:155], v[124:127]
 v_mfma_f32_16x16x32_bf16 v[124:127], a[204:207], a[156:159], v[124:127]
 v_mfma_f32_16x16x32_bf16 v[120:123], a[204:207], a[148:151], v[120:123]
 v_mfma_f32_16x16x32_bf16 v[120:123], a[200:203], a[144:147], v[120:123]
 buffer_load_dwordx4 v6, s[8:11], s30 offen sc1 lds
 v_mfma_f32_16x16x32_bf16 v[116:119], a[200:203], a[136:139], v[116:119]
 v_mfma_f32_16x16x32_bf16 v[116:119], a[204:207], a[140:143], v[116:119]
 v_mfma_f32_16x16x32_bf16 v[112:115], a[204:207], a[132:135], v[112:115]
 v_mfma_f32_16x16x32_bf16 v[112:115], a[200:203], a[128:131], v[112:115]
 s_waitcnt vmcnt(11)
 v_mfma_f32_16x16x32_bf16 v[136:139], a[208:211], a[128:131], v[136:139]
 v_mfma_f32_16x16x32_bf16 v[136:139], a[212:215], a[132:135], v[136:139]
 global_load_dwordx4 a[204:207], v0, s[70:71] offset:-1024
 s_add_u32 m0, m0, 1024
 v_mfma_f32_16x16x32_bf16 v[140:143], a[212:215], a[140:143], v[140:143]
 v_mfma_f32_16x16x32_bf16 v[140:143], a[208:211], a[136:139], v[140:143]
 global_load_dwordx4 a[200:203], v0, s[70:71] offset:-2048
 v_mfma_f32_16x16x32_bf16 v[144:147], a[208:211], a[144:147], v[144:147]
 v_mfma_f32_16x16x32_bf16 v[144:147], a[212:215], a[148:151], v[144:147]
 v_mfma_f32_16x16x32_bf16 v[148:151], a[212:215], a[156:159], v[148:151]
 v_mfma_f32_16x16x32_bf16 v[148:151], a[208:211], a[152:155], v[148:151]
 v_mfma_f32_16x16x32_bf16 v[152:155], a[208:211], a[160:163], v[152:155]
 s_add_u32 s30, s30, s20
 v_mfma_f32_16x16x32_bf16 v[152:155], a[212:215], a[164:167], v[152:155]
 v_mfma_f32_16x16x32_bf16 v[156:159], a[212:215], a[172:175], v[156:159]
 v_mfma_f32_16x16x32_bf16 v[156:159], a[208:211], a[168:171], v[156:159]
 v_mfma_f32_16x16x32_bf16 v[160:163], a[208:211], a[176:179], v[160:163]
 v_mfma_f32_16x16x32_bf16 v[160:163], a[212:215], a[180:183], v[160:163]
 v_mfma_f32_16x16x32_bf16 v[164:167], a[212:215], a[188:191], v[164:167]
 buffer_load_dwordx4 v6, s[8:11], s30 offen sc1 lds
 v_mfma_f32_16x16x32_bf16 v[164:167], a[208:211], a[184:187], v[164:167]
 s_waitcnt vmcnt(12)
 v_mfma_f32_16x16x32_bf16 v[196:199], a[216:219], a[184:187], v[196:199]
 v_mfma_f32_16x16x32_bf16 v[196:199], a[220:223], a[188:191], v[196:199]
 global_load_dwordx4 a[212:215], v0, s[70:71] offset:1024
 v_mfma_f32_16x16x32_bf16 v[192:195], a[220:223], a[180:183], v[192:195]
 v_mfma_f32_16x16x32_bf16 v[192:195], a[216:219], a[176:179], v[192:195]
 global_load_dwordx4 a[208:211], v0, s[70:71] offset:0
 v_mfma_f32_16x16x32_bf16 v[188:191], a[216:219], a[168:171], v[188:191]
 s_add_u32 m0, m0, 3072
 v_mfma_f32_16x16x32_bf16 v[188:191], a[220:223], a[172:175], v[188:191]
 v_mfma_f32_16x16x32_bf16 v[184:187], a[220:223], a[164:167], v[184:187]
 v_mfma_f32_16x16x32_bf16 v[184:187], a[216:219], a[160:163], v[184:187]
 v_mfma_f32_16x16x32_bf16 v[180:183], a[216:219], a[152:155], v[180:183]
 v_mfma_f32_16x16x32_bf16 v[180:183], a[220:223], a[156:159], v[180:183]
 v_mfma_f32_16x16x32_bf16 v[176:179], a[220:223], a[148:151], v[176:179]
 s_add_u32 s30, s30, s21
 v_mfma_f32_16x16x32_bf16 v[176:179], a[216:219], a[144:147], v[176:179]
 v_mfma_f32_16x16x32_bf16 v[172:175], a[216:219], a[136:139], v[172:175]
 v_mfma_f32_16x16x32_bf16 v[172:175], a[220:223], a[140:143], v[172:175]
 v_mfma_f32_16x16x32_bf16 v[168:171], a[220:223], a[132:135], v[168:171]
 v_mfma_f32_16x16x32_bf16 v[168:171], a[216:219], a[128:131], v[168:171]
 s_waitcnt vmcnt(12)
 v_mfma_f32_16x16x32_bf16 v[200:203], a[224:227], a[128:131], v[200:203]
 buffer_load_dwordx4 v6, s[8:11], s30 offen sc1 lds
 v_mfma_f32_16x16x32_bf16 v[200:203], a[228:231], a[132:135], v[200:203]
 global_load_dwordx4 a[220:223], v0, s[70:71] offset:3072
 v_mfma_f32_16x16x32_bf16 v[204:207], a[228:231], a[140:143], v[204:207]
 v_mfma_f32_16x16x32_bf16 v[204:207], a[224:227], a[136:139], v[204:207]
 global_load_dwordx4 a[216:219], v0, s[70:71] offset:2048
 v_mfma_f32_16x16x32_bf16 v[208:211], a[224:227], a[144:147], v[208:211]
 s_add_u32 s70, s70, 8192
 s_addc_u32 s71, s71, 0
 v_mfma_f32_16x16x32_bf16 v[208:211], a[228:231], a[148:151], v[208:211]
 v_mfma_f32_16x16x32_bf16 v[212:215], a[228:231], a[156:159], v[212:215]
 v_mfma_f32_16x16x32_bf16 v[212:215], a[224:227], a[152:155], v[212:215]
 s_add_u32 m0, m0, 1024
 v_mfma_f32_16x16x32_bf16 v[216:219], a[224:227], a[160:163], v[216:219]
 v_mfma_f32_16x16x32_bf16 v[216:219], a[228:231], a[164:167], v[216:219]
 v_mfma_f32_16x16x32_bf16 v[220:223], a[228:231], a[172:175], v[220:223]
 v_mfma_f32_16x16x32_bf16 v[220:223], a[224:227], a[168:171], v[220:223]
 v_mfma_f32_16x16x32_bf16 v[224:227], a[224:227], a[176:179], v[224:227]
 v_mfma_f32_16x16x32_bf16 v[224:227], a[228:231], a[180:183], v[224:227]
 s_add_u32 s30, s30, s20
 v_mfma_f32_16x16x32_bf16 v[228:231], a[228:231], a[188:191], v[228:231]
 v_mfma_f32_16x16x32_bf16 v[228:231], a[224:227], a[184:187], v[228:231]
 buffer_load_dwordx4 v6, s[8:11], s30 offen sc1 lds
 s_waitcnt vmcnt(13)
 v_mfma_f32_16x16x32_bf16 a[252:255], a[232:235], a[184:187], a[252:255]
 ds_read_b128 a[184:187], v1 offset:61440
 v_mfma_f32_16x16x32_bf16 a[252:255], a[236:239], a[188:191], a[252:255]
 global_load_dwordx4 a[228:231], v0, s[70:71] offset:-3072
 ds_read_b128 a[188:191], v1 offset:62464
 v_mfma_f32_16x16x32_bf16 a[248:251], a[236:239], a[180:183], a[248:251]
 ds_read_b128 a[180:183], v1 offset:58368
 v_mfma_f32_16x16x32_bf16 a[248:251], a[232:235], a[176:179], a[248:251]
 global_load_dwordx4 a[224:227], v0, s[70:71] offset:-4096
 ds_read_b128 a[176:179], v1 offset:57344
 v_mfma_f32_16x16x32_bf16 v[252:255], a[232:235], a[168:171], v[252:255]
 ds_read_b128 a[168:171], v1 offset:53248
 v_mfma_f32_16x16x32_bf16 v[252:255], a[236:239], a[172:175], v[252:255]
 ds_read_b128 a[172:175], v1 offset:54272
 v_mfma_f32_16x16x32_bf16 v[248:251], a[236:239], a[164:167], v[248:251]
 ds_read_b128 a[164:167], v1 offset:50176
 v_mfma_f32_16x16x32_bf16 v[248:251], a[232:235], a[160:163], v[248:251]
 ds_read_b128 a[160:163], v1 offset:49152
 v_mfma_f32_16x16x32_bf16 v[244:247], a[232:235], a[152:155], v[244:247]
 ds_read_b128 a[152:155], v1 offset:45056
 v_mfma_f32_16x16x32_bf16 v[244:247], a[236:239], a[156:159], v[244:247]
 ds_read_b128 a[156:159], v1 offset:46080
 v_mfma_f32_16x16x32_bf16 v[240:243], a[236:239], a[148:151], v[240:243]
 ds_read_b128 a[148:151], v1 offset:41984
 s_add_u32 m0, m0, 3072
 v_mfma_f32_16x16x32_bf16 v[240:243], a[232:235], a[144:147], v[240:243]
 ds_read_b128 a[144:147], v1 offset:40960
 v_mfma_f32_16x16x32_bf16 v[236:239], a[232:235], a[136:139], v[236:239]
 ds_read_b128 a[136:139], v1 offset:36864
 v_mfma_f32_16x16x32_bf16 v[236:239], a[236:239], a[140:143], v[236:239]
 ds_read_b128 a[140:143], v1 offset:37888
 v_mfma_f32_16x16x32_bf16 v[232:235], a[236:239], a[132:135], v[232:235]
 ds_read_b128 a[132:135], v1 offset:33792
 v_mfma_f32_16x16x32_bf16 v[232:235], a[232:235], a[128:131], v[232:235]
 ds_read_b128 a[128:131], v1 offset:32768
 s_waitcnt vmcnt(12) lgkmcnt(8)
 v_mfma_f32_16x16x32_bf16 v[44:47], a[192:195], a[184:187], v[44:47]
 s_add_u32 s30, s30, s21
 v_mfma_f32_16x16x32_bf16 v[44:47], a[196:199], a[188:191], v[44:47]
 v_mfma_f32_16x16x32_bf16 v[40:43], a[196:199], a[180:183], v[40:43]
 v_mfma_f32_16x16x32_bf16 v[40:43], a[192:195], a[176:179], v[40:43]
 v_mfma_f32_16x16x32_bf16 v[36:39], a[192:195], a[168:171], v[36:39]
 v_mfma_f32_16x16x32_bf16 v[36:39], a[196:199], a[172:175], v[36:39]
 v_mfma_f32_16x16x32_bf16 v[32:35], a[196:199], a[164:167], v[32:35]
 buffer_load_dwordx4 v6, s[8:11], s30 offen sc1 lds
 v_mfma_f32_16x16x32_bf16 v[32:35], a[192:195], a[160:163], v[32:35]
 s_waitcnt lgkmcnt(0)
 v_mfma_f32_16x16x32_bf16 v[28:31], a[192:195], a[152:155], v[28:31]
 v_mfma_f32_16x16x32_bf16 v[28:31], a[196:199], a[156:159], v[28:31]
 v_mfma_f32_16x16x32_bf16 v[24:27], a[196:199], a[148:151], v[24:27]
 v_mfma_f32_16x16x32_bf16 v[24:27], a[192:195], a[144:147], v[24:27]
 v_mfma_f32_16x16x32_bf16 v[20:23], a[192:195], a[136:139], v[20:23]
 v_mfma_f32_16x16x32_bf16 v[20:23], a[196:199], a[140:143], v[20:23]
 s_add_u32 m0, m0, 1024
 v_mfma_f32_16x16x32_bf16 v[16:19], a[196:199], a[132:135], v[16:19]
 v_mfma_f32_16x16x32_bf16 v[16:19], a[192:195], a[128:131], v[16:19]
 s_waitcnt vmcnt(10)
 v_mfma_f32_16x16x32_bf16 v[48:51], a[200:203], a[128:131], v[48:51]
 v_mfma_f32_16x16x32_bf16 v[48:51], a[204:207], a[132:135], v[48:51]
 global_load_dwordx4 a[196:199], v0, s[70:71] offset:-1024
 v_mfma_f32_16x16x32_bf16 v[52:55], a[204:207], a[140:143], v[52:55]
 v_mfma_f32_16x16x32_bf16 v[52:55], a[200:203], a[136:139], v[52:55]
 global_load_dwordx4 a[192:195], v0, s[70:71] offset:-2048
 s_add_u32 s30, s30, s20
 v_mfma_f32_16x16x32_bf16 v[56:59], a[200:203], a[144:147], v[56:59]
 v_mfma_f32_16x16x32_bf16 v[56:59], a[204:207], a[148:151], v[56:59]
 v_mfma_f32_16x16x32_bf16 v[60:63], a[204:207], a[156:159], v[60:63]
 v_mfma_f32_16x16x32_bf16 v[60:63], a[200:203], a[152:155], v[60:63]
 v_mfma_f32_16x16x32_bf16 v[64:67], a[200:203], a[160:163], v[64:67]
 v_mfma_f32_16x16x32_bf16 v[64:67], a[204:207], a[164:167], v[64:67]
 buffer_load_dwordx4 v6, s[8:11], s30 offen sc1 lds
 v_mfma_f32_16x16x32_bf16 v[68:71], a[204:207], a[172:175], v[68:71]
 v_mfma_f32_16x16x32_bf16 v[68:71], a[200:203], a[168:171], v[68:71]
 v_mfma_f32_16x16x32_bf16 v[72:75], a[200:203], a[176:179], v[72:75]
 v_mfma_f32_16x16x32_bf16 v[72:75], a[204:207], a[180:183], v[72:75]
 v_mfma_f32_16x16x32_bf16 v[76:79], a[204:207], a[188:191], v[76:79]
 v_mfma_f32_16x16x32_bf16 v[76:79], a[200:203], a[184:187], v[76:79]
 s_waitcnt vmcnt(10)
 v_mfma_f32_16x16x32_bf16 v[108:111], a[208:211], a[184:187], v[108:111]
 s_add_u32 m0, m0, 3072
 v_mfma_f32_16x16x32_bf16 v[108:111], a[212:215], a[188:191], v[108:111]
 global_load_dwordx4 a[204:207], v0, s[70:71] offset:1024
 v_mfma_f32_16x16x32_bf16 v[104:107], a[212:215], a[180:183], v[104:107]
 v_mfma_f32_16x16x32_bf16 v[104:107], a[208:211], a[176:179], v[104:107]
 global_load_dwordx4 a[200:203], v0, s[70:71] offset:0
 v_mfma_f32_16x16x32_bf16 v[100:103], a[208:211], a[168:171], v[100:103]
 v_mfma_f32_16x16x32_bf16 v[100:103], a[212:215], a[172:175], v[100:103]
 v_mfma_f32_16x16x32_bf16 v[96:99], a[212:215], a[164:167], v[96:99]
 s_add_u32 s30, s30, s21
 v_mfma_f32_16x16x32_bf16 v[96:99], a[208:211], a[160:163], v[96:99]
 v_mfma_f32_16x16x32_bf16 v[92:95], a[208:211], a[152:155], v[92:95]
 v_mfma_f32_16x16x32_bf16 v[92:95], a[212:215], a[156:159], v[92:95]
 v_mfma_f32_16x16x32_bf16 v[88:91], a[212:215], a[148:151], v[88:91]
 v_mfma_f32_16x16x32_bf16 v[88:91], a[208:211], a[144:147], v[88:91]
 v_mfma_f32_16x16x32_bf16 v[84:87], a[208:211], a[136:139], v[84:87]
 buffer_load_dwordx4 v6, s[8:11], s30 offen sc1 lds
 v_mfma_f32_16x16x32_bf16 v[84:87], a[212:215], a[140:143], v[84:87]
 v_mfma_f32_16x16x32_bf16 v[80:83], a[212:215], a[132:135], v[80:83]
 v_mfma_f32_16x16x32_bf16 v[80:83], a[208:211], a[128:131], v[80:83]
 s_waitcnt vmcnt(10)
 v_mfma_f32_16x16x32_bf16 v[112:115], a[216:219], a[128:131], v[112:115]
 v_mfma_f32_16x16x32_bf16 v[112:115], a[220:223], a[132:135], v[112:115]
 global_load_dwordx4 a[212:215], v0, s[70:71] offset:3072
 v_mfma_f32_16x16x32_bf16 v[116:119], a[220:223], a[140:143], v[116:119]
 s_add_u32 m0, m0, 1024
 v_mfma_f32_16x16x32_bf16 v[116:119], a[216:219], a[136:139], v[116:119]
 global_load_dwordx4 a[208:211], v0, s[70:71] offset:2048
 v_mfma_f32_16x16x32_bf16 v[120:123], a[216:219], a[144:147], v[120:123]
 s_add_u32 s70, s70, 8192
 s_addc_u32 s71, s71, 0
 v_mfma_f32_16x16x32_bf16 v[120:123], a[220:223], a[148:151], v[120:123]
 v_mfma_f32_16x16x32_bf16 v[124:127], a[220:223], a[156:159], v[124:127]
 v_mfma_f32_16x16x32_bf16 v[124:127], a[216:219], a[152:155], v[124:127]
 v_mfma_f32_16x16x32_bf16 v[128:131], a[216:219], a[160:163], v[128:131]
 v_mfma_f32_16x16x32_bf16 v[128:131], a[220:223], a[164:167], v[128:131]
 s_add_u32 s30, s30, s20
 v_mfma_f32_16x16x32_bf16 v[132:135], a[220:223], a[172:175], v[132:135]
 v_mfma_f32_16x16x32_bf16 v[132:135], a[216:219], a[168:171], v[132:135]
 v_mfma_f32_16x16x32_bf16 a[240:243], a[216:219], a[176:179], a[240:243]
 v_mfma_f32_16x16x32_bf16 a[240:243], a[220:223], a[180:183], a[240:243]
 v_mfma_f32_16x16x32_bf16 a[244:247], a[220:223], a[188:191], a[244:247]
 v_mfma_f32_16x16x32_bf16 a[244:247], a[216:219], a[184:187], a[244:247]
 buffer_load_dwordx4 v6, s[8:11], s30 offen sc1 lds
 s_waitcnt vmcnt(10)
 v_mfma_f32_16x16x32_bf16 v[164:167], a[224:227], a[184:187], v[164:167]
 v_mfma_f32_16x16x32_bf16 v[164:167], a[228:231], a[188:191], v[164:167]
 global_load_dwordx4 a[220:223], v0, s[70:71] offset:-3072
 v_mfma_f32_16x16x32_bf16 v[160:163], a[228:231], a[180:183], v[160:163]
 v_mfma_f32_16x16x32_bf16 v[160:163], a[224:227], a[176:179], v[160:163]
 global_load_dwordx4 a[216:219], v0, s[70:71] offset:-4096
 v_mfma_f32_16x16x32_bf16 v[156:159], a[224:227], a[168:171], v[156:159]
 v_mfma_f32_16x16x32_bf16 v[156:159], a[228:231], a[172:175], v[156:159]
 s_add_u32 m0, m0, 3072
 v_mfma_f32_16x16x32_bf16 v[152:155], a[228:231], a[164:167], v[152:155]
 v_mfma_f32_16x16x32_bf16 v[152:155], a[224:227], a[160:163], v[152:155]
 v_mfma_f32_16x16x32_bf16 v[148:151], a[224:227], a[152:155], v[148:151]
 v_mfma_f32_16x16x32_bf16 v[148:151], a[228:231], a[156:159], v[148:151]
 v_mfma_f32_16x16x32_bf16 v[144:147], a[228:231], a[148:151], v[144:147]
 v_mfma_f32_16x16x32_bf16 v[144:147], a[224:227], a[144:147], v[144:147]
 s_add_u32 s30, s30, s21
 v_mfma_f32_16x16x32_bf16 v[140:143], a[224:227], a[136:139], v[140:143]
 v_mfma_f32_16x16x32_bf16 v[140:143], a[228:231], a[140:143], v[140:143]
 v_mfma_f32_16x16x32_bf16 v[136:139], a[228:231], a[132:135], v[136:139]
 v_mfma_f32_16x16x32_bf16 v[136:139], a[224:227], a[128:131], v[136:139]
 s_waitcnt vmcnt(9)
 v_mfma_f32_16x16x32_bf16 v[168:171], a[192:195], a[128:131], v[168:171]
 v_mfma_f32_16x16x32_bf16 v[168:171], a[196:199], a[132:135], v[168:171]
 global_load_dwordx4 a[228:231], v0, s[70:71] offset:-1024
 v_mfma_f32_16x16x32_bf16 v[172:175], a[196:199], a[140:143], v[172:175]
 buffer_load_dwordx4 v6, s[8:11], s30 offen sc1 lds
 v_mfma_f32_16x16x32_bf16 v[172:175], a[192:195], a[136:139], v[172:175]
 global_load_dwordx4 a[224:227], v0, s[70:71] offset:-2048
 v_mfma_f32_16x16x32_bf16 v[176:179], a[192:195], a[144:147], v[176:179]
 v_mfma_f32_16x16x32_bf16 v[176:179], a[196:199], a[148:151], v[176:179]
 v_mfma_f32_16x16x32_bf16 v[180:183], a[196:199], a[156:159], v[180:183]
 v_mfma_f32_16x16x32_bf16 v[180:183], a[192:195], a[152:155], v[180:183]
 v_mfma_f32_16x16x32_bf16 v[184:187], a[192:195], a[160:163], v[184:187]
 s_add_u32 m0, m0, 1024
 v_mfma_f32_16x16x32_bf16 v[184:187], a[196:199], a[164:167], v[184:187]
 v_mfma_f32_16x16x32_bf16 v[188:191], a[196:199], a[172:175], v[188:191]
 v_mfma_f32_16x16x32_bf16 v[188:191], a[192:195], a[168:171], v[188:191]
 v_mfma_f32_16x16x32_bf16 v[192:195], a[192:195], a[176:179], v[192:195]
 v_mfma_f32_16x16x32_bf16 v[192:195], a[196:199], a[180:183], v[192:195]
 v_mfma_f32_16x16x32_bf16 v[196:199], a[196:199], a[188:191], v[196:199]
 s_add_u32 s30, s30, s20
 v_mfma_f32_16x16x32_bf16 v[196:199], a[192:195], a[184:187], v[196:199]
 s_waitcnt vmcnt(9)
 v_mfma_f32_16x16x32_bf16 v[228:231], a[200:203], a[184:187], v[228:231]
 v_mfma_f32_16x16x32_bf16 v[228:231], a[204:207], a[188:191], v[228:231]
 global_load_dwordx4 a[196:199], v0, s[70:71] offset:1024
 v_mfma_f32_16x16x32_bf16 v[224:227], a[204:207], a[180:183], v[224:227]
 v_mfma_f32_16x16x32_bf16 v[224:227], a[200:203], a[176:179], v[224:227]
 global_load_dwordx4 a[192:195], v0, s[70:71] offset:0
 v_mfma_f32_16x16x32_bf16 v[220:223], a[200:203], a[168:171], v[220:223]
 v_mfma_f32_16x16x32_bf16 v[220:223], a[204:207], a[172:175], v[220:223]
 buffer_load_dwordx4 v6, s[8:11], s30 offen sc1 lds
 v_mfma_f32_16x16x32_bf16 v[216:219], a[204:207], a[164:167], v[216:219]
 v_mfma_f32_16x16x32_bf16 v[216:219], a[200:203], a[160:163], v[216:219]
 v_mfma_f32_16x16x32_bf16 v[212:215], a[200:203], a[152:155], v[212:215]
 v_mfma_f32_16x16x32_bf16 v[212:215], a[204:207], a[156:159], v[212:215]
 v_mfma_f32_16x16x32_bf16 v[208:211], a[204:207], a[148:151], v[208:211]
 v_mfma_f32_16x16x32_bf16 v[208:211], a[200:203], a[144:147], v[208:211]
 s_add_u32 m0, m0, 3072
 v_mfma_f32_16x16x32_bf16 v[204:207], a[200:203], a[136:139], v[204:207]
 v_mfma_f32_16x16x32_bf16 v[204:207], a[204:207], a[140:143], v[204:207]
 v_mfma_f32_16x16x32_bf16 v[200:203], a[204:207], a[132:135], v[200:203]
 v_mfma_f32_16x16x32_bf16 v[200:203], a[200:203], a[128:131], v[200:203]
 s_add_u32 s30, s30, s21
 buffer_load_dwordx4 v6, s[8:11], s30 offen sc1 lds
 s_waitcnt vmcnt(10)
 v_mfma_f32_16x16x32_bf16 v[232:235], a[208:211], a[128:131], v[232:235]
 ds_read_b128 a[128:131], v2
 v_mfma_f32_16x16x32_bf16 v[232:235], a[212:215], a[132:135], v[232:235]
 global_load_dwordx4 a[204:207], v0, s[70:71] offset:3072
 ds_read_b128 a[132:135], v2 offset:1024
 v_mfma_f32_16x16x32_bf16 v[236:239], a[212:215], a[140:143], v[236:239]
 ds_read_b128 a[140:143], v2 offset:5120
 v_mfma_f32_16x16x32_bf16 v[236:239], a[208:211], a[136:139], v[236:239]
 global_load_dwordx4 a[200:203], v0, s[70:71] offset:2048
 ds_read_b128 a[136:139], v2 offset:4096
 v_mfma_f32_16x16x32_bf16 v[240:243], a[208:211], a[144:147], v[240:243]
 s_add_u32 s70, s70, 8192
 s_addc_u32 s71, s71, 0
 ds_read_b128 a[144:147], v2 offset:8192
 v_mfma_f32_16x16x32_bf16 v[240:243], a[212:215], a[148:151], v[240:243]
 ds_read_b128 a[148:151], v2 offset:9216
 v_mfma_f32_16x16x32_bf16 v[244:247], a[212:215], a[156:159], v[244:247]
 ds_read_b128 a[156:159], v2 offset:13312
 v_mfma_f32_16x16x32_bf16 v[244:247], a[208:211], a[152:155], v[244:247]
 ds_read_b128 a[152:155], v2 offset:12288
 v_mfma_f32_16x16x32_bf16 v[248:251], a[208:211], a[160:163], v[248:251]
 ds_read_b128 a[160:163], v2 offset:16384
 v_mfma_f32_16x16x32_bf16 v[248:251], a[212:215], a[164:167], v[248:251]
 ds_read_b128 a[164:167], v2 offset:17408
 v_mfma_f32_16x16x32_bf16 v[252:255], a[212:215], a[172:175], v[252:255]
 ds_read_b128 a[172:175], v2 offset:21504
 v_mfma_f32_16x16x32_bf16 v[252:255], a[208:211], a[168:171], v[252:255]
 ds_read_b128 a[168:171], v2 offset:20480
 v_mfma_f32_16x16x32_bf16 a[248:251], a[208:211], a[176:179], a[248:251]
 ds_read_b128 a[176:179], v2 offset:24576
 v_mfma_f32_16x16x32_bf16 a[248:251], a[212:215], a[180:183], a[248:251]
 ds_read_b128 a[180:183], v2 offset:25600
 v_mfma_f32_16x16x32_bf16 a[252:255], a[212:215], a[188:191], a[252:255]
 ds_read_b128 a[188:191], v2 offset:29696
 s_add_u32 m0, m0, 1024
 v_mfma_f32_16x16x32_bf16 a[252:255], a[208:211], a[184:187], a[252:255]
 ds_read_b128 a[184:187], v2 offset:28672
 s_waitcnt vmcnt(9) lgkmcnt(8)
 v_mfma_f32_16x16x32_bf16 v[16:19], a[216:219], a[128:131], v[16:19]
 v_mfma_f32_16x16x32_bf16 v[16:19], a[220:223], a[132:135], v[16:19]
 global_load_dwordx4 a[212:215], v0, s[70:71] offset:-3072
 v_mfma_f32_16x16x32_bf16 v[20:23], a[220:223], a[140:143], v[20:23]
 v_mfma_f32_16x16x32_bf16 v[20:23], a[216:219], a[136:139], v[20:23]
 global_load_dwordx4 a[208:211], v0, s[70:71] offset:-4096
 v_mfma_f32_16x16x32_bf16 v[24:27], a[216:219], a[144:147], v[24:27]
 s_add_u32 s30, s30, s20
 v_mfma_f32_16x16x32_bf16 v[24:27], a[220:223], a[148:151], v[24:27]
 v_mfma_f32_16x16x32_bf16 v[28:31], a[220:223], a[156:159], v[28:31]
 v_mfma_f32_16x16x32_bf16 v[28:31], a[216:219], a[152:155], v[28:31]
 s_waitcnt lgkmcnt(0)
 v_mfma_f32_16x16x32_bf16 v[32:35], a[216:219], a[160:163], v[32:35]
 v_mfma_f32_16x16x32_bf16 v[32:35], a[220:223], a[164:167], v[32:35]
 v_mfma_f32_16x16x32_bf16 v[36:39], a[220:223], a[172:175], v[36:39]
 buffer_load_dwordx4 v6, s[8:11], s30 offen sc1 lds
 v_mfma_f32_16x16x32_bf16 v[36:39], a[216:219], a[168:171], v[36:39]
 v_mfma_f32_16x16x32_bf16 v[40:43], a[216:219], a[176:179], v[40:43]
 v_mfma_f32_16x16x32_bf16 v[40:43], a[220:223], a[180:183], v[40:43]
 v_mfma_f32_16x16x32_bf16 v[44:47], a[220:223], a[188:191], v[44:47]
 v_mfma_f32_16x16x32_bf16 v[44:47], a[216:219], a[184:187], v[44:47]
 s_waitcnt vmcnt(9)
 v_mfma_f32_16x16x32_bf16 v[76:79], a[224:227], a[184:187], v[76:79]
 s_add_u32 m0, m0, 3072
 v_mfma_f32_16x16x32_bf16 v[76:79], a[228:231], a[188:191], v[76:79]
 global_load_dwordx4 a[220:223], v0, s[70:71] offset:-1024
 v_mfma_f32_16x16x32_bf16 v[72:75], a[228:231], a[180:183], v[72:75]
 v_mfma_f32_16x16x32_bf16 v[72:75], a[224:227], a[176:179], v[72:75]
 global_load_dwordx4 a[216:219], v0, s[70:71] offset:-2048
 v_mfma_f32_16x16x32_bf16 v[68:71], a[224:227], a[168:171], v[68:71]
 v_mfma_f32_16x16x32_bf16 v[68:71], a[228:231], a[172:175], v[68:71]
 v_mfma_f32_16x16x32_bf16 v[64:67], a[228:231], a[164:167], v[64:67]
 v_mfma_f32_16x16x32_bf16 v[64:67], a[224:227], a[160:163], v[64:67]
 s_add_u32 s30, s30, s21
 v_mfma_f32_16x16x32_bf16 v[60:63], a[224:227], a[152:155], v[60:63]
 v_mfma_f32_16x16x32_bf16 v[60:63], a[228:231], a[156:159], v[60:63]
 v_mfma_f32_16x16x32_bf16 v[56:59], a[228:231], a[148:151], v[56:59]
 v_mfma_f32_16x16x32_bf16 v[56:59], a[224:227], a[144:147], v[56:59]
 v_mfma_f32_16x16x32_bf16 v[52:55], a[224:227], a[136:139], v[52:55]
 v_mfma_f32_16x16x32_bf16 v[52:55], a[228:231], a[140:143], v[52:55]
 buffer_load_dwordx4 v6, s[8:11], s30 offen sc1 lds
 v_mfma_f32_16x16x32_bf16 v[48:51], a[228:231], a[132:135], v[48:51]
 v_mfma_f32_16x16x32_bf16 v[48:51], a[224:227], a[128:131], v[48:51]
 s_waitcnt vmcnt(10)
 v_mfma_f32_16x16x32_bf16 v[80:83], a[192:195], a[128:131], v[80:83]
 v_mfma_f32_16x16x32_bf16 v[80:83], a[196:199], a[132:135], v[80:83]
 global_load_dwordx4 a[228:231], v0, s[70:71] offset:1024
 v_mfma_f32_16x16x32_bf16 v[84:87], a[196:199], a[140:143], v[84:87]
 v_mfma_f32_16x16x32_bf16 v[84:87], a[192:195], a[136:139], v[84:87]
 global_load_dwordx4 a[224:227], v0, s[70:71] offset:0
 s_add_u32 m0, m0, 1024
 v_mfma_f32_16x16x32_bf16 v[88:91], a[192:195], a[144:147], v[88:91]
 v_mfma_f32_16x16x32_bf16 v[88:91], a[196:199], a[148:151], v[88:91]
 v_mfma_f32_16x16x32_bf16 v[92:95], a[196:199], a[156:159], v[92:95]
 v_mfma_f32_16x16x32_bf16 v[92:95], a[192:195], a[152:155], v[92:95]
 v_mfma_f32_16x16x32_bf16 v[96:99], a[192:195], a[160:163], v[96:99]
 v_mfma_f32_16x16x32_bf16 v[96:99], a[196:199], a[164:167], v[96:99]
 v_mfma_f32_16x16x32_bf16 v[100:103], a[196:199], a[172:175], v[100:103]
 s_add_u32 s30, s30, s20
 v_mfma_f32_16x16x32_bf16 v[100:103], a[192:195], a[168:171], v[100:103]
 v_mfma_f32_16x16x32_bf16 v[104:107], a[192:195], a[176:179], v[104:107]
 v_mfma_f32_16x16x32_bf16 v[104:107], a[196:199], a[180:183], v[104:107]
 v_mfma_f32_16x16x32_bf16 v[108:111], a[196:199], a[188:191], v[108:111]
 v_mfma_f32_16x16x32_bf16 v[108:111], a[192:195], a[184:187], v[108:111]
 s_waitcnt vmcnt(8)
 v_mfma_f32_16x16x32_bf16 a[244:247], a[200:203], a[184:187], a[244:247]
 buffer_load_dwordx4 v6, s[8:11], s30 offen sc1 lds
 v_mfma_f32_16x16x32_bf16 a[244:247], a[204:207], a[188:191], a[244:247]
 global_load_dwordx4 a[196:199], v0, s[70:71] offset:3072
 v_mfma_f32_16x16x32_bf16 a[240:243], a[204:207], a[180:183], a[240:243]
 v_mfma_f32_16x16x32_bf16 a[240:243], a[200:203], a[176:179], a[240:243]
 global_load_dwordx4 a[192:195], v0, s[70:71] offset:2048
 v_mfma_f32_16x16x32_bf16 v[132:135], a[200:203], a[168:171], v[132:135]
 s_add_u32 s70, s70, 8192
 s_addc_u32 s71, s71, 0
 v_mfma_f32_16x16x32_bf16 v[132:135], a[204:207], a[172:175], v[132:135]
 v_mfma_f32_16x16x32_bf16 v[128:131], a[204:207], a[164:167], v[128:131]
 s_add_u32 m0, m0, 3072
 v_mfma_f32_16x16x32_bf16 v[128:131], a[200:203], a[160:163], v[128:131]
 v_mfma_f32_16x16x32_bf16 v[124:127], a[200:203], a[152:155], v[124:127]
 v_mfma_f32_16x16x32_bf16 v[124:127], a[204:207], a[156:159], v[124:127]
 v_mfma_f32_16x16x32_bf16 v[120:123], a[204:207], a[148:151], v[120:123]
 v_mfma_f32_16x16x32_bf16 v[120:123], a[200:203], a[144:147], v[120:123]
 v_mfma_f32_16x16x32_bf16 v[116:119], a[200:203], a[136:139], v[116:119]
 s_add_u32 s30, s30, s22
 v_mfma_f32_16x16x32_bf16 v[116:119], a[204:207], a[140:143], v[116:119]
 v_mfma_f32_16x16x32_bf16 v[112:115], a[204:207], a[132:135], v[112:115]
 v_mfma_f32_16x16x32_bf16 v[112:115], a[200:203], a[128:131], v[112:115]
 s_waitcnt vmcnt(9)
 v_mfma_f32_16x16x32_bf16 v[136:139], a[208:211], a[128:131], v[136:139]
 v_mfma_f32_16x16x32_bf16 v[136:139], a[212:215], a[132:135], v[136:139]
 global_load_dwordx4 a[204:207], v0, s[70:71] offset:-3072
 v_mfma_f32_16x16x32_bf16 v[140:143], a[212:215], a[140:143], v[140:143]
 v_mfma_f32_16x16x32_bf16 v[140:143], a[208:211], a[136:139], v[140:143]
 global_load_dwordx4 a[200:203], v0, s[70:71] offset:-4096
 v_mfma_f32_16x16x32_bf16 v[144:147], a[208:211], a[144:147], v[144:147]
 v_mfma_f32_16x16x32_bf16 v[144:147], a[212:215], a[148:151], v[144:147]
 v_mfma_f32_16x16x32_bf16 v[148:151], a[212:215], a[156:159], v[148:151]
 v_mfma_f32_16x16x32_bf16 v[148:151], a[208:211], a[152:155], v[148:151]
 v_mfma_f32_16x16x32_bf16 v[152:155], a[208:211], a[160:163], v[152:155]
 v_mfma_f32_16x16x32_bf16 v[152:155], a[212:215], a[164:167], v[152:155]
 v_mfma_f32_16x16x32_bf16 v[156:159], a[212:215], a[172:175], v[156:159]
 v_and_b32 v5, 768, v1
 v_mfma_f32_16x16x32_bf16 v[156:159], a[208:211], a[168:171], v[156:159]
 v_mfma_f32_16x16x32_bf16 v[160:163], a[208:211], a[176:179], v[160:163]
 v_add3_u32 v5, v5, v1, s52
 v_mfma_f32_16x16x32_bf16 v[160:163], a[212:215], a[180:183], v[160:163]
 v_mfma_f32_16x16x32_bf16 v[164:167], a[212:215], a[188:191], v[164:167]
 ds_read_b64_tr_b16 v[8:9], v5 offset:0
 v_mfma_f32_16x16x32_bf16 v[164:167], a[208:211], a[184:187], v[164:167]
 s_waitcnt vmcnt(8)
 v_mfma_f32_16x16x32_bf16 v[196:199], a[216:219], a[184:187], v[196:199]
 ds_read_b64_tr_b16 v[10:11], v5 offset:256
 v_mfma_f32_16x16x32_bf16 v[196:199], a[220:223], a[188:191], v[196:199]
 global_load_dwordx4 a[212:215], v0, s[70:71] offset:-1024
 ds_read_b64_tr_b16 v[12:13], v5 offset:8
 v_mfma_f32_16x16x32_bf16 v[192:195], a[220:223], a[180:183], v[192:195]
 ds_read_b64_tr_b16 v[14:15], v5 offset:264
 v_mfma_f32_16x16x32_bf16 v[192:195], a[216:219], a[176:179], v[192:195]
 global_load_dwordx4 a[208:211], v0, s[70:71] offset:-2048
 v_mfma_f32_16x16x32_bf16 v[188:191], a[216:219], a[168:171], v[188:191]
 v_mfma_f32_16x16x32_bf16 v[188:191], a[220:223], a[172:175], v[188:191]
 v_mfma_f32_16x16x32_bf16 v[184:187], a[220:223], a[164:167], v[184:187]
 v_mfma_f32_16x16x32_bf16 v[184:187], a[216:219], a[160:163], v[184:187]
 v_mfma_f32_16x16x32_bf16 v[180:183], a[216:219], a[152:155], v[180:183]
 v_mfma_f32_16x16x32_bf16 v[180:183], a[220:223], a[156:159], v[180:183]
 v_mfma_f32_16x16x32_bf16 v[176:179], a[220:223], a[148:151], v[176:179]
 v_mfma_f32_16x16x32_bf16 v[176:179], a[216:219], a[144:147], v[176:179]
 v_mfma_f32_16x16x32_bf16 v[172:175], a[216:219], a[136:139], v[172:175]
 v_mfma_f32_16x16x32_bf16 v[172:175], a[220:223], a[140:143], v[172:175]
 v_mfma_f32_16x16x32_bf16 v[168:171], a[220:223], a[132:135], v[168:171]
 v_mfma_f32_16x16x32_bf16 v[168:171], a[216:219], a[128:131], v[168:171]
 s_waitcnt vmcnt(7)
 v_mfma_f32_16x16x32_bf16 v[200:203], a[224:227], a[128:131], v[200:203]
 v_mfma_f32_16x16x32_bf16 v[200:203], a[228:231], a[132:135], v[200:203]
 global_load_dwordx4 a[220:223], v0, s[70:71] offset:1024
 s_waitcnt lgkmcnt(2)
 v_mfma_f32_16x16x32_bf16 v[204:207], a[228:231], a[140:143], v[204:207]
 v_mfma_f32_16x16x32_bf16 v[204:207], a[224:227], a[136:139], v[204:207]
 global_load_dwordx4 a[216:219], v0, s[70:71] offset:0
 v_mfma_f32_16x16x32_bf16 v[208:211], a[224:227], a[144:147], v[208:211]
 buffer_store_dwordx4 v[8:11], v1, s[12:15], s49 offen sc1
 s_waitcnt lgkmcnt(0)
 v_mfma_f32_16x16x32_bf16 v[208:211], a[228:231], a[148:151], v[208:211]
 buffer_store_dwordx4 v[12:15], v1, s[12:15], s49 offen offset:2048 sc1
 v_mfma_f32_16x16x32_bf16 v[212:215], a[228:231], a[156:159], v[212:215]
 v_mfma_f32_16x16x32_bf16 v[212:215], a[224:227], a[152:155], v[212:215]
 s_add_u32 s49, s49, 2097152
 v_mfma_f32_16x16x32_bf16 v[216:219], a[224:227], a[160:163], v[216:219]
 v_mfma_f32_16x16x32_bf16 v[216:219], a[228:231], a[164:167], v[216:219]
 v_mfma_f32_16x16x32_bf16 v[220:223], a[228:231], a[172:175], v[220:223]
 v_mfma_f32_16x16x32_bf16 v[220:223], a[224:227], a[168:171], v[220:223]
 v_mfma_f32_16x16x32_bf16 v[224:227], a[224:227], a[176:179], v[224:227]
 v_mfma_f32_16x16x32_bf16 v[224:227], a[228:231], a[180:183], v[224:227]
 v_mfma_f32_16x16x32_bf16 v[228:231], a[228:231], a[188:191], v[228:231]
 v_mfma_f32_16x16x32_bf16 v[228:231], a[224:227], a[184:187], v[228:231]
 s_waitcnt vmcnt(8)
 v_mfma_f32_16x16x32_bf16 a[252:255], a[192:195], a[184:187], a[252:255]
 ds_read_b128 a[184:187], v2 offset:61440
 v_mfma_f32_16x16x32_bf16 a[252:255], a[196:199], a[188:191], a[252:255]
 global_load_dwordx4 a[228:231], v0, s[70:71] offset:3072
 ds_read_b128 a[188:191], v2 offset:62464
 v_mfma_f32_16x16x32_bf16 a[248:251], a[196:199], a[180:183], a[248:251]
 ds_read_b128 a[180:183], v2 offset:58368
 v_mfma_f32_16x16x32_bf16 a[248:251], a[192:195], a[176:179], a[248:251]
 global_load_dwordx4 a[224:227], v0, s[70:71] offset:2048
 ds_read_b128 a[176:179], v2 offset:57344
 v_mfma_f32_16x16x32_bf16 v[252:255], a[192:195], a[168:171], v[252:255]
 s_add_u32 s70, s70, 8192
 s_addc_u32 s71, s71, 0
 ds_read_b128 a[168:171], v2 offset:53248
 v_mfma_f32_16x16x32_bf16 v[252:255], a[196:199], a[172:175], v[252:255]
 ds_read_b128 a[172:175], v2 offset:54272
 v_mfma_f32_16x16x32_bf16 v[248:251], a[196:199], a[164:167], v[248:251]
 ds_read_b128 a[164:167], v2 offset:50176
 v_mfma_f32_16x16x32_bf16 v[248:251], a[192:195], a[160:163], v[248:251]
 ds_read_b128 a[160:163], v2 offset:49152
 v_mfma_f32_16x16x32_bf16 v[244:247], a[192:195], a[152:155], v[244:247]
 ds_read_b128 a[152:155], v2 offset:45056
 v_mfma_f32_16x16x32_bf16 v[244:247], a[196:199], a[156:159], v[244:247]
 ds_read_b128 a[156:159], v2 offset:46080
 v_mfma_f32_16x16x32_bf16 v[240:243], a[196:199], a[148:151], v[240:243]
 ds_read_b128 a[148:151], v2 offset:41984
 v_mfma_f32_16x16x32_bf16 v[240:243], a[192:195], a[144:147], v[240:243]
 ds_read_b128 a[144:147], v2 offset:40960
 v_mfma_f32_16x16x32_bf16 v[236:239], a[192:195], a[136:139], v[236:239]
 ds_read_b128 a[136:139], v2 offset:36864
 v_mfma_f32_16x16x32_bf16 v[236:239], a[196:199], a[140:143], v[236:239]
 ds_read_b128 a[140:143], v2 offset:37888
 v_mfma_f32_16x16x32_bf16 v[232:235], a[196:199], a[132:135], v[232:235]
 ds_read_b128 a[132:135], v2 offset:33792
 v_mfma_f32_16x16x32_bf16 v[232:235], a[192:195], a[128:131], v[232:235]
 ds_read_b128 a[128:131], v2 offset:32768
 s_waitcnt vmcnt(8) lgkmcnt(8)
 v_mfma_f32_16x16x32_bf16 v[44:47], a[200:203], a[184:187], v[44:47]
 v_mfma_f32_16x16x32_bf16 v[44:47], a[204:207], a[188:191], v[44:47]
 global_load_dwordx4 a[196:199], v0, s[70:71] offset:-3072
 v_mfma_f32_16x16x32_bf16 v[40:43], a[204:207], a[180:183], v[40:43]
 v_mfma_f32_16x16x32_bf16 v[40:43], a[200:203], a[176:179], v[40:43]
 global_load_dwordx4 a[192:195], v0, s[70:71] offset:-4096
 v_mfma_f32_16x16x32_bf16 v[36:39], a[200:203], a[168:171], v[36:39]
 v_mfma_f32_16x16x32_bf16 v[36:39], a[204:207], a[172:175], v[36:39]
 v_mfma_f32_16x16x32_bf16 v[32:35], a[204:207], a[164:167], v[32:35]
 v_mfma_f32_16x16x32_bf16 v[32:35], a[200:203], a[160:163], v[32:35]
 s_waitcnt lgkmcnt(0)
 v_mfma_f32_16x16x32_bf16 v[28:31], a[200:203], a[152:155], v[28:31]
 v_mfma_f32_16x16x32_bf16 v[28:31], a[204:207], a[156:159], v[28:31]
 v_mfma_f32_16x16x32_bf16 v[24:27], a[204:207], a[148:151], v[24:27]
 v_mfma_f32_16x16x32_bf16 v[24:27], a[200:203], a[144:147], v[24:27]
 v_mfma_f32_16x16x32_bf16 v[20:23], a[200:203], a[136:139], v[20:23]
 v_mfma_f32_16x16x32_bf16 v[20:23], a[204:207], a[140:143], v[20:23]
 v_mfma_f32_16x16x32_bf16 v[16:19], a[204:207], a[132:135], v[16:19]
 v_mfma_f32_16x16x32_bf16 v[16:19], a[200:203], a[128:131], v[16:19]
 s_waitcnt vmcnt(8)
 v_mfma_f32_16x16x32_bf16 v[48:51], a[208:211], a[128:131], v[48:51]
 v_mfma_f32_16x16x32_bf16 v[48:51], a[212:215], a[132:135], v[48:51]
 global_load_dwordx4 a[204:207], v0, s[70:71] offset:-1024
 v_mfma_f32_16x16x32_bf16 v[52:55], a[212:215], a[140:143], v[52:55]
 v_mfma_f32_16x16x32_bf16 v[52:55], a[208:211], a[136:139], v[52:55]
 global_load_dwordx4 a[200:203], v0, s[70:71] offset:-2048
 v_mfma_f32_16x16x32_bf16 v[56:59], a[208:211], a[144:147], v[56:59]
 v_mfma_f32_16x16x32_bf16 v[56:59], a[212:215], a[148:151], v[56:59]
 v_mfma_f32_16x16x32_bf16 v[60:63], a[212:215], a[156:159], v[60:63]
 v_mfma_f32_16x16x32_bf16 v[60:63], a[208:211], a[152:155], v[60:63]
 v_mfma_f32_16x16x32_bf16 v[64:67], a[208:211], a[160:163], v[64:67]
 v_mfma_f32_16x16x32_bf16 v[64:67], a[212:215], a[164:167], v[64:67]
 v_mfma_f32_16x16x32_bf16 v[68:71], a[212:215], a[172:175], v[68:71]
 v_mfma_f32_16x16x32_bf16 v[68:71], a[208:211], a[168:171], v[68:71]
 v_mfma_f32_16x16x32_bf16 v[72:75], a[208:211], a[176:179], v[72:75]
 v_mfma_f32_16x16x32_bf16 v[72:75], a[212:215], a[180:183], v[72:75]
 v_mfma_f32_16x16x32_bf16 v[76:79], a[212:215], a[188:191], v[76:79]
 v_mfma_f32_16x16x32_bf16 v[76:79], a[208:211], a[184:187], v[76:79]
 s_waitcnt vmcnt(8)
 v_mfma_f32_16x16x32_bf16 v[108:111], a[216:219], a[184:187], v[108:111]
 v_mfma_f32_16x16x32_bf16 v[108:111], a[220:223], a[188:191], v[108:111]
 global_load_dwordx4 a[212:215], v0, s[70:71] offset:1024
 v_mfma_f32_16x16x32_bf16 v[104:107], a[220:223], a[180:183], v[104:107]
 v_mfma_f32_16x16x32_bf16 v[104:107], a[216:219], a[176:179], v[104:107]
 global_load_dwordx4 a[208:211], v0, s[70:71] offset:0
 v_mfma_f32_16x16x32_bf16 v[100:103], a[216:219], a[168:171], v[100:103]
 v_mfma_f32_16x16x32_bf16 v[100:103], a[220:223], a[172:175], v[100:103]
 v_mfma_f32_16x16x32_bf16 v[96:99], a[220:223], a[164:167], v[96:99]
 v_mfma_f32_16x16x32_bf16 v[96:99], a[216:219], a[160:163], v[96:99]
 v_mfma_f32_16x16x32_bf16 v[92:95], a[216:219], a[152:155], v[92:95]
 v_mfma_f32_16x16x32_bf16 v[92:95], a[220:223], a[156:159], v[92:95]
 v_mfma_f32_16x16x32_bf16 v[88:91], a[220:223], a[148:151], v[88:91]
 v_mfma_f32_16x16x32_bf16 v[88:91], a[216:219], a[144:147], v[88:91]
 v_mfma_f32_16x16x32_bf16 v[84:87], a[216:219], a[136:139], v[84:87]
 v_mfma_f32_16x16x32_bf16 v[84:87], a[220:223], a[140:143], v[84:87]
 v_mfma_f32_16x16x32_bf16 v[80:83], a[220:223], a[132:135], v[80:83]
 v_mfma_f32_16x16x32_bf16 v[80:83], a[216:219], a[128:131], v[80:83]
 s_waitcnt vmcnt(6)
 v_mfma_f32_16x16x32_bf16 v[112:115], a[224:227], a[128:131], v[112:115]
 v_mfma_f32_16x16x32_bf16 v[112:115], a[228:231], a[132:135], v[112:115]
 global_load_dwordx4 a[220:223], v0, s[70:71] offset:3072
 v_mfma_f32_16x16x32_bf16 v[116:119], a[228:231], a[140:143], v[116:119]
 v_mfma_f32_16x16x32_bf16 v[116:119], a[224:227], a[136:139], v[116:119]
 global_load_dwordx4 a[216:219], v0, s[70:71] offset:2048
 v_mfma_f32_16x16x32_bf16 v[120:123], a[224:227], a[144:147], v[120:123]
 s_add_u32 s70, s70, 8192
 s_addc_u32 s71, s71, 0
 v_mfma_f32_16x16x32_bf16 v[120:123], a[228:231], a[148:151], v[120:123]
 v_mfma_f32_16x16x32_bf16 v[124:127], a[228:231], a[156:159], v[124:127]
 v_mfma_f32_16x16x32_bf16 v[124:127], a[224:227], a[152:155], v[124:127]
 v_mfma_f32_16x16x32_bf16 v[128:131], a[224:227], a[160:163], v[128:131]
 v_mfma_f32_16x16x32_bf16 v[128:131], a[228:231], a[164:167], v[128:131]
 v_mfma_f32_16x16x32_bf16 v[132:135], a[228:231], a[172:175], v[132:135]
 v_mfma_f32_16x16x32_bf16 v[132:135], a[224:227], a[168:171], v[132:135]
 v_mfma_f32_16x16x32_bf16 a[240:243], a[224:227], a[176:179], a[240:243]
 v_mfma_f32_16x16x32_bf16 a[240:243], a[228:231], a[180:183], a[240:243]
 v_mfma_f32_16x16x32_bf16 a[244:247], a[228:231], a[188:191], a[244:247]
 v_mfma_f32_16x16x32_bf16 a[244:247], a[224:227], a[184:187], a[244:247]
 s_waitcnt vmcnt(6)
 v_mfma_f32_16x16x32_bf16 v[164:167], a[192:195], a[184:187], v[164:167]
 v_mfma_f32_16x16x32_bf16 v[164:167], a[196:199], a[188:191], v[164:167]
 global_load_dwordx4 a[228:231], v0, s[70:71] offset:-3072
 v_mfma_f32_16x16x32_bf16 v[160:163], a[196:199], a[180:183], v[160:163]
 v_mfma_f32_16x16x32_bf16 v[160:163], a[192:195], a[176:179], v[160:163]
 global_load_dwordx4 a[224:227], v0, s[70:71] offset:-4096
 v_mfma_f32_16x16x32_bf16 v[156:159], a[192:195], a[168:171], v[156:159]
 v_mfma_f32_16x16x32_bf16 v[156:159], a[196:199], a[172:175], v[156:159]
 global_load_dwordx4 a[236:239], v0, s[70:71] offset:-1024
 v_mfma_f32_16x16x32_bf16 v[152:155], a[196:199], a[164:167], v[152:155]
 v_mfma_f32_16x16x32_bf16 v[152:155], a[192:195], a[160:163], v[152:155]
 global_load_dwordx4 a[232:235], v0, s[70:71] offset:-2048
 v_mfma_f32_16x16x32_bf16 v[148:151], a[192:195], a[152:155], v[148:151]
 v_mfma_f32_16x16x32_bf16 v[148:151], a[196:199], a[156:159], v[148:151]
 v_mfma_f32_16x16x32_bf16 v[144:147], a[196:199], a[148:151], v[144:147]
 v_mfma_f32_16x16x32_bf16 v[144:147], a[192:195], a[144:147], v[144:147]
 v_mfma_f32_16x16x32_bf16 v[140:143], a[192:195], a[136:139], v[140:143]
 v_mfma_f32_16x16x32_bf16 v[140:143], a[196:199], a[140:143], v[140:143]
 v_mfma_f32_16x16x32_bf16 v[136:139], a[196:199], a[132:135], v[136:139]
 v_mfma_f32_16x16x32_bf16 v[136:139], a[192:195], a[128:131], v[136:139]
 s_waitcnt vmcnt(8)
 v_mfma_f32_16x16x32_bf16 v[168:171], a[200:203], a[128:131], v[168:171]
 v_mfma_f32_16x16x32_bf16 v[168:171], a[204:207], a[132:135], v[168:171]
 global_load_dwordx4 a[196:199], v0, s[70:71] offset:1024
 v_mfma_f32_16x16x32_bf16 v[172:175], a[204:207], a[140:143], v[172:175]
 v_mfma_f32_16x16x32_bf16 v[172:175], a[200:203], a[136:139], v[172:175]
 global_load_dwordx4 a[192:195], v0, s[70:71] offset:0
 v_mfma_f32_16x16x32_bf16 v[176:179], a[200:203], a[144:147], v[176:179]
 v_mfma_f32_16x16x32_bf16 v[176:179], a[204:207], a[148:151], v[176:179]
 v_mfma_f32_16x16x32_bf16 v[180:183], a[204:207], a[156:159], v[180:183]
 v_mfma_f32_16x16x32_bf16 v[180:183], a[200:203], a[152:155], v[180:183]
 v_mfma_f32_16x16x32_bf16 v[184:187], a[200:203], a[160:163], v[184:187]
 v_mfma_f32_16x16x32_bf16 v[184:187], a[204:207], a[164:167], v[184:187]
 v_mfma_f32_16x16x32_bf16 v[188:191], a[204:207], a[172:175], v[188:191]
 v_mfma_f32_16x16x32_bf16 v[188:191], a[200:203], a[168:171], v[188:191]
 v_mfma_f32_16x16x32_bf16 v[192:195], a[200:203], a[176:179], v[192:195]
 v_mfma_f32_16x16x32_bf16 v[192:195], a[204:207], a[180:183], v[192:195]
 v_mfma_f32_16x16x32_bf16 v[196:199], a[204:207], a[188:191], v[196:199]
 v_mfma_f32_16x16x32_bf16 v[196:199], a[200:203], a[184:187], v[196:199]
 s_waitcnt vmcnt(8)
 v_mfma_f32_16x16x32_bf16 v[228:231], a[208:211], a[184:187], v[228:231]
 v_mfma_f32_16x16x32_bf16 v[228:231], a[212:215], a[188:191], v[228:231]
 global_load_dwordx4 a[204:207], v0, s[70:71] offset:3072
 v_mfma_f32_16x16x32_bf16 v[224:227], a[212:215], a[180:183], v[224:227]
 v_mfma_f32_16x16x32_bf16 v[224:227], a[208:211], a[176:179], v[224:227]
 global_load_dwordx4 a[200:203], v0, s[70:71] offset:2048
 v_mfma_f32_16x16x32_bf16 v[220:223], a[208:211], a[168:171], v[220:223]
 s_add_u32 s70, s70, 8192
 s_addc_u32 s71, s71, 0
 v_mfma_f32_16x16x32_bf16 v[220:223], a[212:215], a[172:175], v[220:223]
 v_mfma_f32_16x16x32_bf16 v[216:219], a[212:215], a[164:167], v[216:219]
 v_mfma_f32_16x16x32_bf16 v[216:219], a[208:211], a[160:163], v[216:219]
 v_mfma_f32_16x16x32_bf16 v[212:215], a[208:211], a[152:155], v[212:215]
 v_mfma_f32_16x16x32_bf16 v[212:215], a[212:215], a[156:159], v[212:215]
 v_mfma_f32_16x16x32_bf16 v[208:211], a[212:215], a[148:151], v[208:211]
 s_waitcnt lgkmcnt(0)
 s_barrier
 v_mfma_f32_16x16x32_bf16 v[208:211], a[208:211], a[144:147], v[208:211]
 v_mfma_f32_16x16x32_bf16 v[204:207], a[208:211], a[136:139], v[204:207]
 v_mfma_f32_16x16x32_bf16 v[204:207], a[212:215], a[140:143], v[204:207]
 v_mfma_f32_16x16x32_bf16 v[200:203], a[212:215], a[132:135], v[200:203]
 v_mfma_f32_16x16x32_bf16 v[200:203], a[208:211], a[128:131], v[200:203]
 s_waitcnt vmcnt(8)
 v_mfma_f32_16x16x32_bf16 v[232:235], a[216:219], a[128:131], v[232:235]
 ds_read_b128 a[128:131], v1 offset:2048
 v_mfma_f32_16x16x32_bf16 v[232:235], a[220:223], a[132:135], v[232:235]
 global_load_dwordx4 a[212:215], v0, s[70:71] offset:-3072
 ds_read_b128 a[132:135], v1 offset:3072
 v_mfma_f32_16x16x32_bf16 v[236:239], a[220:223], a[140:143], v[236:239]
 ds_read_b128 a[140:143], v1 offset:7168
 v_mfma_f32_16x16x32_bf16 v[236:239], a[216:219], a[136:139], v[236:239]
 global_load_dwordx4 a[208:211], v0, s[70:71] offset:-4096
 ds_read_b128 a[136:139], v1 offset:6144
 v_mfma_f32_16x16x32_bf16 v[240:243], a[216:219], a[144:147], v[240:243]
 ds_read_b128 a[144:147], v1 offset:10240
 v_mfma_f32_16x16x32_bf16 v[240:243], a[220:223], a[148:151], v[240:243]
 ds_read_b128 a[148:151], v1 offset:11264
 v_mfma_f32_16x16x32_bf16 v[244:247], a[220:223], a[156:159], v[244:247]
 ds_read_b128 a[156:159], v1 offset:15360
 v_mfma_f32_16x16x32_bf16 v[244:247], a[216:219], a[152:155], v[244:247]
 ds_read_b128 a[152:155], v1 offset:14336
 v_mfma_f32_16x16x32_bf16 v[248:251], a[216:219], a[160:163], v[248:251]
 ds_read_b128 a[160:163], v1 offset:18432
 v_mfma_f32_16x16x32_bf16 v[248:251], a[220:223], a[164:167], v[248:251]
 ds_read_b128 a[164:167], v1 offset:19456
 v_mfma_f32_16x16x32_bf16 v[252:255], a[220:223], a[172:175], v[252:255]
 ds_read_b128 a[172:175], v1 offset:23552
 v_mfma_f32_16x16x32_bf16 v[252:255], a[216:219], a[168:171], v[252:255]
 ds_read_b128 a[168:171], v1 offset:22528
 v_mfma_f32_16x16x32_bf16 a[248:251], a[216:219], a[176:179], a[248:251]
 ds_read_b128 a[176:179], v1 offset:26624
 v_mfma_f32_16x16x32_bf16 a[248:251], a[220:223], a[180:183], a[248:251]
 ds_read_b128 a[180:183], v1 offset:27648
 v_mfma_f32_16x16x32_bf16 a[252:255], a[220:223], a[188:191], a[252:255]
 global_load_dwordx4 a[220:223], v0, s[70:71] offset:-1024
 ds_read_b128 a[188:191], v1 offset:31744
 v_mfma_f32_16x16x32_bf16 a[252:255], a[216:219], a[184:187], a[252:255]
 global_load_dwordx4 a[216:219], v0, s[70:71] offset:-2048
 ds_read_b128 a[184:187], v1 offset:30720
 s_waitcnt vmcnt(10) lgkmcnt(8)
 v_mfma_f32_16x16x32_bf16 v[16:19], a[224:227], a[128:131], v[16:19]
 v_mov_b32 v7, 1
 v_mfma_f32_16x16x32_bf16 v[16:19], a[228:231], a[132:135], v[16:19]
 v_mfma_f32_16x16x32_bf16 v[20:23], a[228:231], a[140:143], v[20:23]
 buffer_atomic_add v7, v0, s[56:59], 0 offen sc1
 v_mfma_f32_16x16x32_bf16 v[20:23], a[224:227], a[136:139], v[20:23]
 v_lshrrev_b32 v4, 8, v1
 v_mfma_f32_16x16x32_bf16 v[24:27], a[224:227], a[144:147], v[24:27]
 v_mfma_f32_16x16x32_bf16 v[24:27], a[228:231], a[148:151], v[24:27]
 v_lshl_add_u32 v4, v4, 5, s51
 v_mfma_f32_16x16x32_bf16 v[28:31], a[228:231], a[156:159], v[28:31]
 ds_read_b128 v[8:11], v4 offset:256
 v_mfma_f32_16x16x32_bf16 v[28:31], a[224:227], a[152:155], v[28:31]
 s_waitcnt lgkmcnt(1)
 v_mfma_f32_16x16x32_bf16 v[32:35], a[224:227], a[160:163], v[32:35]
 v_mfma_f32_16x16x32_bf16 v[32:35], a[228:231], a[164:167], v[32:35]
 v_mfma_f32_16x16x32_bf16 v[36:39], a[228:231], a[172:175], v[36:39]
 v_mfma_f32_16x16x32_bf16 v[36:39], a[224:227], a[168:171], v[36:39]
 v_mfma_f32_16x16x32_bf16 v[40:43], a[224:227], a[176:179], v[40:43]
 v_mfma_f32_16x16x32_bf16 v[40:43], a[228:231], a[180:183], v[40:43]
 v_mfma_f32_16x16x32_bf16 v[44:47], a[228:231], a[188:191], v[44:47]
 v_mfma_f32_16x16x32_bf16 v[44:47], a[224:227], a[184:187], v[44:47]
 s_waitcnt vmcnt(9)
 v_mfma_f32_16x16x32_bf16 v[76:79], a[232:235], a[184:187], v[76:79]
 v_mfma_f32_16x16x32_bf16 v[76:79], a[236:239], a[188:191], v[76:79]
 global_load_dwordx4 a[228:231], v0, s[70:71] offset:1024
 v_mfma_f32_16x16x32_bf16 v[72:75], a[236:239], a[180:183], v[72:75]
 v_mfma_f32_16x16x32_bf16 v[72:75], a[232:235], a[176:179], v[72:75]
 global_load_dwordx4 a[224:227], v0, s[70:71] offset:0
 v_mfma_f32_16x16x32_bf16 v[68:71], a[232:235], a[168:171], v[68:71]
 s_waitcnt lgkmcnt(0)
 v_mfma_f32_16x16x32_bf16 v[68:71], a[236:239], a[172:175], v[68:71]
 v_mfma_f32_16x16x32_bf16 v[64:67], a[236:239], a[164:167], v[64:67]
 v_add_f32 v136, v136, v8
 v_mfma_f32_16x16x32_bf16 v[64:67], a[232:235], a[160:163], v[64:67]
 v_mfma_f32_16x16x32_bf16 v[60:63], a[232:235], a[152:155], v[60:63]
 ds_read_b128 v[12:15], v4 offset:272
 v_mfma_f32_16x16x32_bf16 v[60:63], a[236:239], a[156:159], v[60:63]
 v_add_f32 v137, v137, v9
 v_mfma_f32_16x16x32_bf16 v[56:59], a[236:239], a[148:151], v[56:59]
 v_mfma_f32_16x16x32_bf16 v[56:59], a[232:235], a[144:147], v[56:59]
 v_add_f32 v138, v138, v10
 v_mfma_f32_16x16x32_bf16 v[52:55], a[232:235], a[136:139], v[52:55]
 v_add_f32 v139, v139, v11
 v_mfma_f32_16x16x32_bf16 v[52:55], a[236:239], a[140:143], v[52:55]
 v_mfma_f32_16x16x32_bf16 v[48:51], a[236:239], a[132:135], v[48:51]
 v_add_f32 v140, v140, v8
 v_mfma_f32_16x16x32_bf16 v[48:51], a[232:235], a[128:131], v[48:51]
 v_add_f32 v141, v141, v9
 s_waitcnt vmcnt(9)
 v_mfma_f32_16x16x32_bf16 v[80:83], a[192:195], a[128:131], v[80:83]
 v_mfma_f32_16x16x32_bf16 v[80:83], a[196:199], a[132:135], v[80:83]
 global_load_dwordx4 a[236:239], v0, s[70:71] offset:3072
 v_add_f32 v142, v142, v10
 v_mfma_f32_16x16x32_bf16 v[84:87], a[196:199], a[140:143], v[84:87]
 v_add_f32 v143, v143, v11
 v_mfma_f32_16x16x32_bf16 v[84:87], a[192:195], a[136:139], v[84:87]
 global_load_dwordx4 a[232:235], v0, s[70:71] offset:2048
 v_mfma_f32_16x16x32_bf16 v[88:91], a[192:195], a[144:147], v[88:91]
 v_add_f32 v144, v144, v8
 s_add_u32 s70, s70, 8192
 s_addc_u32 s71, s71, 0
 v_mfma_f32_16x16x32_bf16 v[88:91], a[196:199], a[148:151], v[88:91]
 v_mfma_f32_16x16x32_bf16 v[92:95], a[196:199], a[156:159], v[92:95]
 v_add_f32 v145, v145, v9
 v_mfma_f32_16x16x32_bf16 v[92:95], a[192:195], a[152:155], v[92:95]
 v_add_f32 v146, v146, v10
 v_mfma_f32_16x16x32_bf16 v[96:99], a[192:195], a[160:163], v[96:99]
 v_mfma_f32_16x16x32_bf16 v[96:99], a[196:199], a[164:167], v[96:99]
 v_add_f32 v147, v147, v11
 v_mfma_f32_16x16x32_bf16 v[100:103], a[196:199], a[172:175], v[100:103]
 v_add_f32 v148, v148, v8
 v_mfma_f32_16x16x32_bf16 v[100:103], a[192:195], a[168:171], v[100:103]
 v_mfma_f32_16x16x32_bf16 v[104:107], a[192:195], a[176:179], v[104:107]
 v_add_f32 v149, v149, v9
 v_mfma_f32_16x16x32_bf16 v[104:107], a[196:199], a[180:183], v[104:107]
 v_add_f32 v150, v150, v10
 v_mfma_f32_16x16x32_bf16 v[108:111], a[196:199], a[188:191], v[108:111]
 v_mfma_f32_16x16x32_bf16 v[108:111], a[192:195], a[184:187], v[108:111]
 v_add_f32 v151, v151, v11
 s_waitcnt vmcnt(9)
 v_mfma_f32_16x16x32_bf16 a[244:247], a[200:203], a[184:187], a[244:247]
 ds_read_b128 a[184:187], v1 offset:63488
 v_add_f32 v152, v152, v8
 v_mfma_f32_16x16x32_bf16 a[244:247], a[204:207], a[188:191], a[244:247]
 global_load_dwordx4 a[196:199], v0, s[70:71] offset:-3072
 ds_read_b128 a[188:191], v1 offset:64512
 v_mfma_f32_16x16x32_bf16 a[240:243], a[204:207], a[180:183], a[240:243]
 ds_read_b128 a[180:183], v1 offset:60416
 v_add_f32 v153, v153, v9
 v_mfma_f32_16x16x32_bf16 a[240:243], a[200:203], a[176:179], a[240:243]
 global_load_dwordx4 a[192:195], v0, s[70:71] offset:-4096
 ds_read_b128 a[176:179], v1 offset:59392
 v_mfma_f32_16x16x32_bf16 v[132:135], a[200:203], a[168:171], v[132:135]
 ds_read_b128 a[168:171], v1 offset:55296
 v_add_f32 v154, v154, v10
 v_mfma_f32_16x16x32_bf16 v[132:135], a[204:207], a[172:175], v[132:135]
 ds_read_b128 a[172:175], v1 offset:56320
 v_add_f32 v155, v155, v11
 v_mfma_f32_16x16x32_bf16 v[128:131], a[204:207], a[164:167], v[128:131]
 ds_read_b128 a[164:167], v1 offset:52224
 v_mfma_f32_16x16x32_bf16 v[128:131], a[200:203], a[160:163], v[128:131]
 ds_read_b128 a[160:163], v1 offset:51200
 v_add_f32 v156, v156, v8
 v_mfma_f32_16x16x32_bf16 v[124:127], a[200:203], a[152:155], v[124:127]
 ds_read_b128 a[152:155], v1 offset:47104
 v_add_f32 v157, v157, v9
 v_mfma_f32_16x16x32_bf16 v[124:127], a[204:207], a[156:159], v[124:127]
 ds_read_b128 a[156:159], v1 offset:48128
 v_mfma_f32_16x16x32_bf16 v[120:123], a[204:207], a[148:151], v[120:123]
 ds_read_b128 a[148:151], v1 offset:44032
 v_add_f32 v158, v158, v10
 v_mfma_f32_16x16x32_bf16 v[120:123], a[200:203], a[144:147], v[120:123]
 ds_read_b128 a[144:147], v1 offset:43008
 v_add_f32 v159, v159, v11
 v_mfma_f32_16x16x32_bf16 v[116:119], a[200:203], a[136:139], v[116:119]
 ds_read_b128 a[136:139], v1 offset:38912
 v_mfma_f32_16x16x32_bf16 v[116:119], a[204:207], a[140:143], v[116:119]
 ds_read_b128 a[140:143], v1 offset:39936
 v_add_f32 v160, v160, v8
 v_mfma_f32_16x16x32_bf16 v[112:115], a[204:207], a[132:135], v[112:115]
 ds_read_b128 a[132:135], v1 offset:35840
 v_add_f32 v161, v161, v9
 v_mfma_f32_16x16x32_bf16 v[112:115], a[200:203], a[128:131], v[112:115]
 ds_read_b128 a[128:131], v1 offset:34816
 s_waitcnt vmcnt(9) lgkmcnt(8)
 v_mfma_f32_16x16x32_bf16 v[44:47], a[208:211], a[184:187], v[44:47]
 v_add_f32 v162, v162, v10
 v_mfma_f32_16x16x32_bf16 v[44:47], a[212:215], a[188:191], v[44:47]
 global_load_dwordx4 a[204:207], v0, s[70:71] offset:-1024
 v_mfma_f32_16x16x32_bf16 v[40:43], a[212:215], a[180:183], v[40:43]
 v_add_f32 v163, v163, v11
 v_mfma_f32_16x16x32_bf16 v[40:43], a[208:211], a[176:179], v[40:43]
 global_load_dwordx4 a[200:203], v0, s[70:71] offset:-2048
 v_add_f32 v164, v164, v8
 v_mfma_f32_16x16x32_bf16 v[36:39], a[208:211], a[168:171], v[36:39]
 v_mfma_f32_16x16x32_bf16 v[36:39], a[212:215], a[172:175], v[36:39]
 v_add_f32 v165, v165, v9
 v_mfma_f32_16x16x32_bf16 v[32:35], a[212:215], a[164:167], v[32:35]
 v_add_f32 v166, v166, v10
 v_mfma_f32_16x16x32_bf16 v[32:35], a[208:211], a[160:163], v[32:35]
 s_waitcnt lgkmcnt(0)
 v_mfma_f32_16x16x32_bf16 v[28:31], a[208:211], a[152:155], v[28:31]
 v_add_f32 v167, v167, v11
 v_mfma_f32_16x16x32_bf16 v[28:31], a[212:215], a[156:159], v[28:31]
 v_mfma_f32_16x16x32_bf16 v[24:27], a[212:215], a[148:151], v[24:27]
 v_mfma_f32_16x16x32_bf16 v[24:27], a[208:211], a[144:147], v[24:27]
 v_add_f32 v168, v168, v12
 v_mfma_f32_16x16x32_bf16 v[20:23], a[208:211], a[136:139], v[20:23]
 ds_read_b128 v[8:11], v4 offset:384
 v_mfma_f32_16x16x32_bf16 v[20:23], a[212:215], a[140:143], v[20:23]
 v_mfma_f32_16x16x32_bf16 v[16:19], a[212:215], a[132:135], v[16:19]
 v_add_f32 v169, v169, v13
 v_mfma_f32_16x16x32_bf16 v[16:19], a[208:211], a[128:131], v[16:19]
 s_waitcnt vmcnt(9)
 v_mfma_f32_16x16x32_bf16 v[48:51], a[216:219], a[128:131], v[48:51]
 v_add_f32 v170, v170, v14
 v_mfma_f32_16x16x32_bf16 v[48:51], a[220:223], a[132:135], v[48:51]
 global_load_dwordx4 a[212:215], v0, s[70:71] offset:1024
 v_add_f32 v171, v171, v15
 v_mfma_f32_16x16x32_bf16 v[52:55], a[220:223], a[140:143], v[52:55]
 v_mfma_f32_16x16x32_bf16 v[52:55], a[216:219], a[136:139], v[52:55]
 global_load_dwordx4 a[208:211], v0, s[70:71] offset:0
 v_add_f32 v172, v172, v12
 v_mfma_f32_16x16x32_bf16 v[56:59], a[216:219], a[144:147], v[56:59]
 v_add_f32 v173, v173, v13
 v_mfma_f32_16x16x32_bf16 v[56:59], a[220:223], a[148:151], v[56:59]
 v_mfma_f32_16x16x32_bf16 v[60:63], a[220:223], a[156:159], v[60:63]
 v_add_f32 v174, v174, v14
 v_mfma_f32_16x16x32_bf16 v[60:63], a[216:219], a[152:155], v[60:63]
 v_add_f32 v175, v175, v15
 v_mfma_f32_16x16x32_bf16 v[64:67], a[216:219], a[160:163], v[64:67]
 v_mfma_f32_16x16x32_bf16 v[64:67], a[220:223], a[164:167], v[64:67]
 v_add_f32 v176, v176, v12
 v_mfma_f32_16x16x32_bf16 v[68:71], a[220:223], a[172:175], v[68:71]
 v_add_f32 v177, v177, v13
 v_mfma_f32_16x16x32_bf16 v[68:71], a[216:219], a[168:171], v[68:71]
 v_mfma_f32_16x16x32_bf16 v[72:75], a[216:219], a[176:179], v[72:75]
 v_add_f32 v178, v178, v14
 v_mfma_f32_16x16x32_bf16 v[72:75], a[220:223], a[180:183], v[72:75]
 v_mfma_f32_16x16x32_bf16 v[76:79], a[220:223], a[188:191], v[76:79]
 v_add_f32 v179, v179, v15
 v_mfma_f32_16x16x32_bf16 v[76:79], a[216:219], a[184:187], v[76:79]
 v_add_f32 v180, v180, v12
 s_waitcnt vmcnt(8)
 v_mfma_f32_16x16x32_bf16 v[108:111], a[224:227], a[184:187], v[108:111]
 v_mfma_f32_16x16x32_bf16 v[108:111], a[228:231], a[188:191], v[108:111]
 global_load_dwordx4 a[220:223], v0, s[70:71] offset:3072
 v_add_f32 v181, v181, v13
 v_mfma_f32_16x16x32_bf16 v[104:107], a[228:231], a[180:183], v[104:107]
 v_add_f32 v182, v182, v14
 v_mfma_f32_16x16x32_bf16 v[104:107], a[224:227], a[176:179], v[104:107]
 global_load_dwordx4 a[216:219], v0, s[70:71] offset:2048
 v_mfma_f32_16x16x32_bf16 v[100:103], a[224:227], a[168:171], v[100:103]
 v_add_f32 v183, v183, v15
 s_add_u32 s70, s70, 8192
 s_addc_u32 s71, s71, 0
 v_mfma_f32_16x16x32_bf16 v[100:103], a[228:231], a[172:175], v[100:103]
 v_add_f32 v184, v184, v12
 v_mfma_f32_16x16x32_bf16 v[96:99], a[228:231], a[164:167], v[96:99]
 v_mfma_f32_16x16x32_bf16 v[96:99], a[224:227], a[160:163], v[96:99]
 v_add_f32 v185, v185, v13
 v_mfma_f32_16x16x32_bf16 v[92:95], a[224:227], a[152:155], v[92:95]
 v_add_f32 v186, v186, v14
 v_mfma_f32_16x16x32_bf16 v[92:95], a[228:231], a[156:159], v[92:95]
 v_mfma_f32_16x16x32_bf16 v[88:91], a[228:231], a[148:151], v[88:91]
 v_add_f32 v187, v187, v15
 v_mfma_f32_16x16x32_bf16 v[88:91], a[224:227], a[144:147], v[88:91]
 v_mfma_f32_16x16x32_bf16 v[84:87], a[224:227], a[136:139], v[84:87]
 v_add_f32 v188, v188, v12
 v_mfma_f32_16x16x32_bf16 v[84:87], a[228:231], a[140:143], v[84:87]
 v_add_f32 v189, v189, v13
 v_mfma_f32_16x16x32_bf16 v[80:83], a[228:231], a[132:135], v[80:83]
 v_mfma_f32_16x16x32_bf16 v[80:83], a[224:227], a[128:131], v[80:83]
 v_add_f32 v190, v190, v14
 s_waitcnt vmcnt(8)
 v_mfma_f32_16x16x32_bf16 v[112:115], a[232:235], a[128:131], v[112:115]
 ds_read_b128 a[128:131], v2 offset:2048
 v_add_f32 v191, v191, v15
 v_mfma_f32_16x16x32_bf16 v[112:115], a[236:239], a[132:135], v[112:115]
 global_load_dwordx4 a[228:231], v0, s[70:71] offset:-3072
 ds_read_b128 a[132:135], v2 offset:3072
 v_mfma_f32_16x16x32_bf16 v[116:119], a[236:239], a[140:143], v[116:119]
 ds_read_b128 a[140:143], v2 offset:7168
 v_add_f32 v192, v192, v12
 v_mfma_f32_16x16x32_bf16 v[116:119], a[232:235], a[136:139], v[116:119]
 global_load_dwordx4 a[224:227], v0, s[70:71] offset:-4096
 ds_read_b128 a[136:139], v2 offset:6144
 v_mfma_f32_16x16x32_bf16 v[120:123], a[232:235], a[144:147], v[120:123]
 ds_read_b128 a[144:147], v2 offset:10240
 v_add_f32 v193, v193, v13
 v_mfma_f32_16x16x32_bf16 v[120:123], a[236:239], a[148:151], v[120:123]
 ds_read_b128 a[148:151], v2 offset:11264
 v_add_f32 v194, v194, v14
 v_mfma_f32_16x16x32_bf16 v[124:127], a[236:239], a[156:159], v[124:127]
 ds_read_b128 a[156:159], v2 offset:15360
 v_add_f32 v195, v195, v15
 v_mfma_f32_16x16x32_bf16 v[124:127], a[232:235], a[152:155], v[124:127]
 ds_read_b128 a[152:155], v2 offset:14336
 v_mfma_f32_16x16x32_bf16 v[128:131], a[232:235], a[160:163], v[128:131]
 ds_read_b128 a[160:163], v2 offset:18432
 v_add_f32 v196, v196, v12
 v_mfma_f32_16x16x32_bf16 v[128:131], a[236:239], a[164:167], v[128:131]
 ds_read_b128 a[164:167], v2 offset:19456
 v_mfma_f32_16x16x32_bf16 v[132:135], a[236:239], a[172:175], v[132:135]
 ds_read_b128 a[172:175], v2 offset:23552
 v_add_f32 v197, v197, v13
 v_mfma_f32_16x16x32_bf16 v[132:135], a[232:235], a[168:171], v[132:135]
 ds_read_b128 a[168:171], v2 offset:22528
 v_add_f32 v198, v198, v14
 v_mfma_f32_16x16x32_bf16 a[240:243], a[232:235], a[176:179], a[240:243]
 ds_read_b128 a[176:179], v2 offset:26624
 v_mfma_f32_16x16x32_bf16 a[240:243], a[236:239], a[180:183], a[240:243]
 ds_read_b128 a[180:183], v2 offset:27648
 v_add_f32 v199, v199, v15
 v_mfma_f32_16x16x32_bf16 a[244:247], a[236:239], a[188:191], a[244:247]
 ds_read_b128 a[188:191], v2 offset:31744
 s_waitcnt lgkmcnt(15)
 v_mfma_f32_16x16x32_bf16 a[244:247], a[232:235], a[184:187], a[244:247]
 ds_read_b128 a[184:187], v2 offset:30720
 s_waitcnt vmcnt(8) lgkmcnt(8)
 v_mfma_f32_16x16x32_bf16 v[16:19], a[192:195], a[128:131], v[16:19]
 v_add_f32 v200, v200, v8
 v_mfma_f32_16x16x32_bf16 v[16:19], a[196:199], a[132:135], v[16:19]
 global_load_dwordx4 a[236:239], v0, s[70:71] offset:-1024
 ds_read_b128 v[12:15], v4 offset:400
 v_mfma_f32_16x16x32_bf16 v[20:23], a[196:199], a[140:143], v[20:23]
 v_mfma_f32_16x16x32_bf16 v[20:23], a[192:195], a[136:139], v[20:23]
 global_load_dwordx4 a[232:235], v0, s[70:71] offset:-2048
 v_add_f32 v201, v201, v9
 v_mfma_f32_16x16x32_bf16 v[24:27], a[192:195], a[144:147], v[24:27]
 v_add_f32 v202, v202, v10
 v_mfma_f32_16x16x32_bf16 v[24:27], a[196:199], a[148:151], v[24:27]
 v_mfma_f32_16x16x32_bf16 v[28:31], a[196:199], a[156:159], v[28:31]
 v_add_f32 v203, v203, v11
 v_mfma_f32_16x16x32_bf16 v[28:31], a[192:195], a[152:155], v[28:31]
 s_waitcnt lgkmcnt(1)
 v_mfma_f32_16x16x32_bf16 v[32:35], a[192:195], a[160:163], v[32:35]
 v_add_f32 v204, v204, v8
 v_mfma_f32_16x16x32_bf16 v[32:35], a[196:199], a[164:167], v[32:35]
 v_add_f32 v205, v205, v9
 v_mfma_f32_16x16x32_bf16 v[36:39], a[196:199], a[172:175], v[36:39]
 v_mfma_f32_16x16x32_bf16 v[36:39], a[192:195], a[168:171], v[36:39]
 v_add_f32 v206, v206, v10
 v_mfma_f32_16x16x32_bf16 v[40:43], a[192:195], a[176:179], v[40:43]
 v_add_f32 v207, v207, v11
 v_mfma_f32_16x16x32_bf16 v[40:43], a[196:199], a[180:183], v[40:43]
 v_mfma_f32_16x16x32_bf16 v[44:47], a[196:199], a[188:191], v[44:47]
 v_add_f32 v208, v208, v8
 v_mfma_f32_16x16x32_bf16 v[44:47], a[192:195], a[184:187], v[44:47]
 v_add_f32 v209, v209, v9
 s_waitcnt vmcnt(8)
 v_mfma_f32_16x16x32_bf16 v[76:79], a[200:203], a[184:187], v[76:79]
 v_mfma_f32_16x16x32_bf16 v[76:79], a[204:207], a[188:191], v[76:79]
 global_load_dwordx4 a[196:199], v0, s[70:71] offset:1024
 v_add_f32 v210, v210, v10
 v_mfma_f32_16x16x32_bf16 v[72:75], a[204:207], a[180:183], v[72:75]
 v_add_f32 v211, v211, v11
 v_mfma_f32_16x16x32_bf16 v[72:75], a[200:203], a[176:179], v[72:75]
 global_load_dwordx4 a[192:195], v0, s[70:71] offset:0
 v_mfma_f32_16x16x32_bf16 v[68:71], a[200:203], a[168:171], v[68:71]
 v_add_f32 v212, v212, v8
 v_mfma_f32_16x16x32_bf16 v[68:71], a[204:207], a[172:175], v[68:71]
 v_mfma_f32_16x16x32_bf16 v[64:67], a[204:207], a[164:167], v[64:67]
 v_add_f32 v213, v213, v9
 v_mfma_f32_16x16x32_bf16 v[64:67], a[200:203], a[160:163], v[64:67]
 v_add_f32 v214, v214, v10
 v_mfma_f32_16x16x32_bf16 v[60:63], a[200:203], a[152:155], v[60:63]
 v_mfma_f32_16x16x32_bf16 v[60:63], a[204:207], a[156:159], v[60:63]
 v_add_f32 v215, v215, v11
 v_mfma_f32_16x16x32_bf16 v[56:59], a[204:207], a[148:151], v[56:59]
 v_add_f32 v216, v216, v8
 v_mfma_f32_16x16x32_bf16 v[56:59], a[200:203], a[144:147], v[56:59]
 v_mfma_f32_16x16x32_bf16 v[52:55], a[200:203], a[136:139], v[52:55]
 v_add_f32 v217, v217, v9
 v_mfma_f32_16x16x32_bf16 v[52:55], a[204:207], a[140:143], v[52:55]
 v_add_f32 v218, v218, v10
 v_mfma_f32_16x16x32_bf16 v[48:51], a[204:207], a[132:135], v[48:51]
 v_mfma_f32_16x16x32_bf16 v[48:51], a[200:203], a[128:131], v[48:51]
 v_add_f32 v219, v219, v11
 s_waitcnt vmcnt(8)
 v_mfma_f32_16x16x32_bf16 v[80:83], a[208:211], a[128:131], v[80:83]
 v_add_f32 v220, v220, v8
 v_mfma_f32_16x16x32_bf16 v[80:83], a[212:215], a[132:135], v[80:83]
 global_load_dwordx4 a[204:207], v0, s[70:71] offset:3072
 v_mfma_f32_16x16x32_bf16 v[84:87], a[212:215], a[140:143], v[84:87]
 v_add_f32 v221, v221, v9
 v_mfma_f32_16x16x32_bf16 v[84:87], a[208:211], a[136:139], v[84:87]
 global_load_dwordx4 a[200:203], v0, s[70:71] offset:2048
 v_mfma_f32_16x16x32_bf16 v[88:91], a[208:211], a[144:147], v[88:91]
 v_add_f32 v222, v222, v10
 s_add_u32 s70, s70, 8192
 s_addc_u32 s71, s71, 0
 v_mfma_f32_16x16x32_bf16 v[88:91], a[212:215], a[148:151], v[88:91]
 v_add_f32 v223, v223, v11
 v_mfma_f32_16x16x32_bf16 v[92:95], a[212:215], a[156:159], v[92:95]
 v_mfma_f32_16x16x32_bf16 v[92:95], a[208:211], a[152:155], v[92:95]
 v_add_f32 v224, v224, v8
 v_mfma_f32_16x16x32_bf16 v[96:99], a[208:211], a[160:163], v[96:99]
 v_add_f32 v225, v225, v9
 v_mfma_f32_16x16x32_bf16 v[96:99], a[212:215], a[164:167], v[96:99]
 v_mfma_f32_16x16x32_bf16 v[100:103], a[212:215], a[172:175], v[100:103]
 v_add_f32 v226, v226, v10
 v_mfma_f32_16x16x32_bf16 v[100:103], a[208:211], a[168:171], v[100:103]
 v_add_f32 v227, v227, v11
 v_mfma_f32_16x16x32_bf16 v[104:107], a[208:211], a[176:179], v[104:107]
 v_mfma_f32_16x16x32_bf16 v[104:107], a[212:215], a[180:183], v[104:107]
 v_add_f32 v228, v228, v8
 v_mfma_f32_16x16x32_bf16 v[108:111], a[212:215], a[188:191], v[108:111]
 v_add_f32 v229, v229, v9
 v_mfma_f32_16x16x32_bf16 v[108:111], a[208:211], a[184:187], v[108:111]
 s_waitcnt vmcnt(8)
 v_mfma_f32_16x16x32_bf16 a[244:247], a[216:219], a[184:187], a[244:247]
 ds_read_b128 a[184:187], v2 offset:63488
 v_add_f32 v230, v230, v10
 v_mfma_f32_16x16x32_bf16 a[244:247], a[220:223], a[188:191], a[244:247]
 global_load_dwordx4 a[212:215], v0, s[70:71] offset:-3072
 ds_read_b128 a[188:191], v2 offset:64512
 v_mfma_f32_16x16x32_bf16 a[240:243], a[220:223], a[180:183], a[240:243]
 ds_read_b128 a[180:183], v2 offset:60416
 v_add_f32 v231, v231, v11
 v_mfma_f32_16x16x32_bf16 a[240:243], a[216:219], a[176:179], a[240:243]
 global_load_dwordx4 a[208:211], v0, s[70:71] offset:-4096
 ds_read_b128 a[176:179], v2 offset:59392
 s_waitcnt lgkmcnt(4)
 v_mfma_f32_16x16x32_bf16 v[132:135], a[216:219], a[168:171], v[132:135]
 ds_read_b128 a[168:171], v2 offset:55296
 v_mfma_f32_16x16x32_bf16 v[132:135], a[220:223], a[172:175], v[132:135]
 ds_read_b128 a[172:175], v2 offset:56320
 v_add_f32 v232, v232, v12
 v_mfma_f32_16x16x32_bf16 v[128:131], a[220:223], a[164:167], v[128:131]
 ds_read_b128 a[164:167], v2 offset:52224
 v_add_f32 v233, v233, v13
 v_mfma_f32_16x16x32_bf16 v[128:131], a[216:219], a[160:163], v[128:131]
 ds_read_b128 a[160:163], v2 offset:51200
 v_mfma_f32_16x16x32_bf16 v[124:127], a[216:219], a[152:155], v[124:127]
 ds_read_b128 a[152:155], v2 offset:47104
 v_add_f32 v234, v234, v14
 v_mfma_f32_16x16x32_bf16 v[124:127], a[220:223], a[156:159], v[124:127]
 ds_read_b128 a[156:159], v2 offset:48128
 v_add_f32 v235, v235, v15
 v_mfma_f32_16x16x32_bf16 v[120:123], a[220:223], a[148:151], v[120:123]
 ds_read_b128 a[148:151], v2 offset:44032
 v_mfma_f32_16x16x32_bf16 v[120:123], a[216:219], a[144:147], v[120:123]
 ds_read_b128 a[144:147], v2 offset:43008
 v_add_f32 v236, v236, v12
 v_mfma_f32_16x16x32_bf16 v[116:119], a[216:219], a[136:139], v[116:119]
 ds_read_b128 a[136:139], v2 offset:38912
 v_add_f32 v237, v237, v13
 v_mfma_f32_16x16x32_bf16 v[116:119], a[220:223], a[140:143], v[116:119]
 ds_read_b128 a[140:143], v2 offset:39936
 v_mfma_f32_16x16x32_bf16 v[112:115], a[220:223], a[132:135], v[112:115]
 ds_read_b128 a[132:135], v2 offset:35840
 v_add_f32 v238, v238, v14
 v_mfma_f32_16x16x32_bf16 v[112:115], a[216:219], a[128:131], v[112:115]
 ds_read_b128 a[128:131], v2 offset:34816
 s_waitcnt vmcnt(8) lgkmcnt(8)
 v_mfma_f32_16x16x32_bf16 v[44:47], a[224:227], a[184:187], v[44:47]
 v_add_f32 v239, v239, v15
 v_mfma_f32_16x16x32_bf16 v[44:47], a[228:231], a[188:191], v[44:47]
 global_load_dwordx4 a[220:223], v0, s[70:71] offset:-1024
 v_add_f32 v240, v240, v12
 v_mfma_f32_16x16x32_bf16 v[40:43], a[228:231], a[180:183], v[40:43]
 v_mfma_f32_16x16x32_bf16 v[40:43], a[224:227], a[176:179], v[40:43]
 global_load_dwordx4 a[216:219], v0, s[70:71] offset:-2048
 v_add_f32 v241, v241, v13
 v_mfma_f32_16x16x32_bf16 v[36:39], a[224:227], a[168:171], v[36:39]
 v_add_f32 v242, v242, v14
 v_mfma_f32_16x16x32_bf16 v[36:39], a[228:231], a[172:175], v[36:39]
 v_mfma_f32_16x16x32_bf16 v[32:35], a[228:231], a[164:167], v[32:35]
 v_add_f32 v243, v243, v15
 v_mfma_f32_16x16x32_bf16 v[32:35], a[224:227], a[160:163], v[32:35]
 v_add_f32 v244, v244, v12
 s_waitcnt lgkmcnt(0)
 v_mfma_f32_16x16x32_bf16 v[28:31], a[224:227], a[152:155], v[28:31]
 v_mfma_f32_16x16x32_bf16 v[28:31], a[228:231], a[156:159], v[28:31]
 v_add_f32 v245, v245, v13
 v_mfma_f32_16x16x32_bf16 v[24:27], a[228:231], a[148:151], v[24:27]
 v_add_f32 v246, v246, v14
 v_mfma_f32_16x16x32_bf16 v[24:27], a[224:227], a[144:147], v[24:27]
 v_mfma_f32_16x16x32_bf16 v[20:23], a[224:227], a[136:139], v[20:23]
 v_add_f32 v247, v247, v15
 v_mfma_f32_16x16x32_bf16 v[20:23], a[228:231], a[140:143], v[20:23]
 v_mfma_f32_16x16x32_bf16 v[16:19], a[228:231], a[132:135], v[16:19]
 v_add_f32 v248, v248, v12
 v_mfma_f32_16x16x32_bf16 v[16:19], a[224:227], a[128:131], v[16:19]
 v_add_f32 v249, v249, v13
 s_waitcnt vmcnt(8)
 v_mfma_f32_16x16x32_bf16 v[48:51], a[232:235], a[128:131], v[48:51]
 v_mfma_f32_16x16x32_bf16 v[48:51], a[236:239], a[132:135], v[48:51]
 global_load_dwordx4 a[228:231], v0, s[70:71] offset:1024
 v_add_f32 v250, v250, v14
 v_mfma_f32_16x16x32_bf16 v[52:55], a[236:239], a[140:143], v[52:55]
 v_add_f32 v251, v251, v15
 v_mfma_f32_16x16x32_bf16 v[52:55], a[232:235], a[136:139], v[52:55]
 global_load_dwordx4 a[224:227], v0, s[70:71] offset:0
 v_mfma_f32_16x16x32_bf16 v[56:59], a[232:235], a[144:147], v[56:59]
 v_add_f32 v252, v252, v12
 v_mfma_f32_16x16x32_bf16 v[56:59], a[236:239], a[148:151], v[56:59]
 v_add_f32 v253, v253, v13
 v_mfma_f32_16x16x32_bf16 v[60:63], a[236:239], a[156:159], v[60:63]
 v_mfma_f32_16x16x32_bf16 v[60:63], a[232:235], a[152:155], v[60:63]
 v_add_f32 v254, v254, v14
 v_mfma_f32_16x16x32_bf16 v[64:67], a[232:235], a[160:163], v[64:67]
 v_add_f32 v255, v255, v15
 v_mfma_f32_16x16x32_bf16 v[64:67], a[236:239], a[164:167], v[64:67]
 v_mfma_f32_16x16x32_bf16 v[68:71], a[236:239], a[172:175], v[68:71]
 v_accvgpr_read_b32 v5, a248
 v_mfma_f32_16x16x32_bf16 v[68:71], a[232:235], a[168:171], v[68:71]
 v_mfma_f32_16x16x32_bf16 v[72:75], a[232:235], a[176:179], v[72:75]
 v_add_f32 v5, v5, v12
 v_mfma_f32_16x16x32_bf16 v[72:75], a[236:239], a[180:183], v[72:75]
 v_accvgpr_write_b32 a248, v5
 v_mfma_f32_16x16x32_bf16 v[76:79], a[236:239], a[188:191], v[76:79]
 v_mfma_f32_16x16x32_bf16 v[76:79], a[232:235], a[184:187], v[76:79]
 v_accvgpr_read_b32 v6, a249
 s_waitcnt vmcnt(8)
 v_mfma_f32_16x16x32_bf16 v[108:111], a[192:195], a[184:187], v[108:111]
 v_add_f32 v6, v6, v13
 v_mfma_f32_16x16x32_bf16 v[108:111], a[196:199], a[188:191], v[108:111]
 global_load_dwordx4 a[236:239], v0, s[70:71] offset:3072
 v_mfma_f32_16x16x32_bf16 v[104:107], a[196:199], a[180:183], v[104:107]
 v_accvgpr_write_b32 a249, v6
 v_mfma_f32_16x16x32_bf16 v[104:107], a[192:195], a[176:179], v[104:107]
 global_load_dwordx4 a[232:235], v0, s[70:71] offset:2048
 v_accvgpr_read_b32 v5, a250
 v_mfma_f32_16x16x32_bf16 v[100:103], a[192:195], a[168:171], v[100:103]
 s_add_u32 s70, s70, 8192
 s_addc_u32 s71, s71, 0
 v_mfma_f32_16x16x32_bf16 v[100:103], a[196:199], a[172:175], v[100:103]
 v_add_f32 v5, v5, v14
 v_mfma_f32_16x16x32_bf16 v[96:99], a[196:199], a[164:167], v[96:99]
 v_accvgpr_write_b32 a250, v5
 v_mfma_f32_16x16x32_bf16 v[96:99], a[192:195], a[160:163], v[96:99]
 v_mfma_f32_16x16x32_bf16 v[92:95], a[192:195], a[152:155], v[92:95]
 v_accvgpr_read_b32 v6, a251
 v_mfma_f32_16x16x32_bf16 v[92:95], a[196:199], a[156:159], v[92:95]
 v_mfma_f32_16x16x32_bf16 v[88:91], a[196:199], a[148:151], v[88:91]
 v_add_f32 v6, v6, v15
 v_mfma_f32_16x16x32_bf16 v[88:91], a[192:195], a[144:147], v[88:91]
 v_accvgpr_write_b32 a251, v6
 v_mfma_f32_16x16x32_bf16 v[84:87], a[192:195], a[136:139], v[84:87]
 v_mfma_f32_16x16x32_bf16 v[84:87], a[196:199], a[140:143], v[84:87]
 v_accvgpr_read_b32 v5, a252
 v_mfma_f32_16x16x32_bf16 v[80:83], a[196:199], a[132:135], v[80:83]
 v_add_f32 v5, v5, v12
 v_mfma_f32_16x16x32_bf16 v[80:83], a[192:195], a[128:131], v[80:83]
 s_waitcnt vmcnt(8)
 v_mfma_f32_16x16x32_bf16 v[112:115], a[200:203], a[128:131], v[112:115]
 ds_read_b128 a[128:131], v1 offset:2048
 v_accvgpr_write_b32 a252, v5
 v_mfma_f32_16x16x32_bf16 v[112:115], a[204:207], a[132:135], v[112:115]
 global_load_dwordx4 a[196:199], v0, s[70:71] offset:-3072
 ds_read_b128 a[132:135], v1 offset:3072
 v_mfma_f32_16x16x32_bf16 v[116:119], a[204:207], a[140:143], v[116:119]
 ds_read_b128 a[140:143], v1 offset:7168
 v_accvgpr_read_b32 v6, a253
 v_mfma_f32_16x16x32_bf16 v[116:119], a[200:203], a[136:139], v[116:119]
 global_load_dwordx4 a[192:195], v0, s[70:71] offset:-4096
 ds_read_b128 a[136:139], v1 offset:6144
 v_mfma_f32_16x16x32_bf16 v[120:123], a[200:203], a[144:147], v[120:123]
 ds_read_b128 a[144:147], v1 offset:10240
 v_add_f32 v6, v6, v13
 v_mfma_f32_16x16x32_bf16 v[120:123], a[204:207], a[148:151], v[120:123]
 ds_read_b128 a[148:151], v1 offset:11264
 v_accvgpr_write_b32 a253, v6
 v_mfma_f32_16x16x32_bf16 v[124:127], a[204:207], a[156:159], v[124:127]
 ds_read_b128 a[156:159], v1 offset:15360
 v_accvgpr_read_b32 v5, a254
 v_mfma_f32_16x16x32_bf16 v[124:127], a[200:203], a[152:155], v[124:127]
 ds_read_b128 a[152:155], v1 offset:14336
 v_mfma_f32_16x16x32_bf16 v[128:131], a[200:203], a[160:163], v[128:131]
 ds_read_b128 a[160:163], v1 offset:18432
 v_add_f32 v5, v5, v14
 v_mfma_f32_16x16x32_bf16 v[128:131], a[204:207], a[164:167], v[128:131]
 ds_read_b128 a[164:167], v1 offset:19456
 v_accvgpr_write_b32 a254, v5
 v_mfma_f32_16x16x32_bf16 v[132:135], a[204:207], a[172:175], v[132:135]
 ds_read_b128 a[172:175], v1 offset:23552
 v_mfma_f32_16x16x32_bf16 v[132:135], a[200:203], a[168:171], v[132:135]
 ds_read_b128 a[168:171], v1 offset:22528
 v_accvgpr_read_b32 v6, a255
 v_mfma_f32_16x16x32_bf16 a[240:243], a[200:203], a[176:179], a[240:243]
 ds_read_b128 a[176:179], v1 offset:26624
 v_add_f32 v6, v6, v15
 v_mfma_f32_16x16x32_bf16 a[240:243], a[204:207], a[180:183], a[240:243]
 ds_read_b128 a[180:183], v1 offset:27648
 v_accvgpr_write_b32 a255, v6
 v_mfma_f32_16x16x32_bf16 a[244:247], a[204:207], a[188:191], a[244:247]
 global_load_dwordx4 a[204:207], v0, s[70:71] offset:-1024
 ds_read_b128 a[188:191], v1 offset:31744
 v_mfma_f32_16x16x32_bf16 a[244:247], a[200:203], a[184:187], a[244:247]
 global_load_dwordx4 a[200:203], v0, s[70:71] offset:-2048
 ds_read_b128 a[184:187], v1 offset:30720
 s_waitcnt vmcnt(10) lgkmcnt(8)
 s_mov_b32 s8, s32
 s_mov_b32 s9, s33
 s_mov_b32 s10, s34
 s_mov_b32 s20, 1024
 s_mov_b32 s21, 1024
 s_mov_b32 s22, 1024
 s_xor_b32 s30, s29, 131072
 s_add_u32 s51, s51, 2048
 s_add_u32 s25, s25, 1
 s_cmp_eq_u32 s25, 6
 s_cbranch_scc1 Llast
 v_mfma_f32_16x16x32_bf16 v[136:139], a[208:211], a[128:131], v[136:139]
 v_accvgpr_read_b32 v5, a0
 v_lshlrev_b32 v6, 16, v5
 v_mfma_f32_16x16x32_bf16 v[136:139], a[212:215], a[132:135], v[136:139]
 v_and_b32 v5, s26, v5
 v_mul_f32 v6, v6, v16
 v_mfma_f32_16x16x32_bf16 v[140:143], a[212:215], a[140:143], v[140:143]
 v_mul_f32 v5, v5, v17
 v_cvt_pk_bf16_f32 v8, v6, v5
 v_mfma_f32_16x16x32_bf16 v[140:143], a[208:211], a[136:139], v[140:143]
 v_accvgpr_read_b32 v5, a1
 v_mfma_f32_16x16x32_bf16 v[144:147], a[208:211], a[144:147], v[144:147]
 v_lshlrev_b32 v6, 16, v5
 v_and_b32 v5, s26, v5
 v_mfma_f32_16x16x32_bf16 v[144:147], a[212:215], a[148:151], v[144:147]
 v_mul_f32 v6, v6, v18
 v_mul_f32 v5, v5, v19
 v_mfma_f32_16x16x32_bf16 v[148:151], a[212:215], a[156:159], v[148:151]
 v_cvt_pk_bf16_f32 v9, v6, v5
 v_accvgpr_read_b32 v5, a2
 v_mfma_f32_16x16x32_bf16 v[148:151], a[208:211], a[152:155], v[148:151]
 v_lshlrev_b32 v6, 16, v5
 v_and_b32 v5, s26, v5
 s_waitcnt lgkmcnt(0)
 v_mfma_f32_16x16x32_bf16 v[152:155], a[208:211], a[160:163], v[152:155]
 v_mul_f32 v6, v6, v48
 v_mul_f32 v5, v5, v49
 v_mfma_f32_16x16x32_bf16 v[152:155], a[212:215], a[164:167], v[152:155]
 v_cvt_pk_bf16_f32 v10, v6, v5
 v_mfma_f32_16x16x32_bf16 v[156:159], a[212:215], a[172:175], v[156:159]
 v_accvgpr_read_b32 v5, a3
 v_lshlrev_b32 v6, 16, v5
 v_mfma_f32_16x16x32_bf16 v[156:159], a[208:211], a[168:171], v[156:159]
 v_and_b32 v5, s26, v5
 v_mul_f32 v6, v6, v50
 v_mfma_f32_16x16x32_bf16 v[160:163], a[208:211], a[176:179], v[160:163]
 v_mul_f32 v5, v5, v51
 v_cvt_pk_bf16_f32 v11, v6, v5
 v_mfma_f32_16x16x32_bf16 v[160:163], a[212:215], a[180:183], v[160:163]
 ds_write_b128 v3, v[8:11]
 s_add_u32 s68, s29, 0
 v_mfma_f32_16x16x32_bf16 v[164:167], a[212:215], a[188:191], v[164:167]
 buffer_store_dwordx4 v[8:11], v3, s[32:35], s68 offen sc1
 v_accvgpr_read_b32 v5, a32
 v_mfma_f32_16x16x32_bf16 v[164:167], a[208:211], a[184:187], v[164:167]
 v_lshlrev_b32 v6, 16, v5
 v_and_b32 v5, s26, v5
 s_waitcnt vmcnt(9)
 v_mfma_f32_16x16x32_bf16 v[196:199], a[216:219], a[184:187], v[196:199]
 v_mul_f32 v6, v6, v80
 v_mul_f32 v5, v5, v81
 v_mfma_f32_16x16x32_bf16 v[196:199], a[220:223], a[188:191], v[196:199]
 global_load_dwordx4 a[212:215], v0, s[70:71] offset:1024
 v_cvt_pk_bf16_f32 v12, v6, v5
 v_mfma_f32_16x16x32_bf16 v[192:195], a[220:223], a[180:183], v[192:195]
 v_accvgpr_read_b32 v5, a33
 v_lshlrev_b32 v6, 16, v5
 v_mfma_f32_16x16x32_bf16 v[192:195], a[216:219], a[176:179], v[192:195]
 global_load_dwordx4 a[208:211], v0, s[70:71] offset:0
 v_and_b32 v5, s26, v5
 v_mfma_f32_16x16x32_bf16 v[188:191], a[216:219], a[168:171], v[188:191]
 v_mul_f32 v6, v6, v82
 v_mul_f32 v5, v5, v83
 v_mfma_f32_16x16x32_bf16 v[188:191], a[220:223], a[172:175], v[188:191]
 v_cvt_pk_bf16_f32 v13, v6, v5
 v_accvgpr_read_b32 v5, a34
 v_mfma_f32_16x16x32_bf16 v[184:187], a[220:223], a[164:167], v[184:187]
 v_lshlrev_b32 v6, 16, v5
 v_and_b32 v5, s26, v5
 v_mfma_f32_16x16x32_bf16 v[184:187], a[216:219], a[160:163], v[184:187]
 v_mul_f32 v6, v6, v112
 v_mul_f32 v5, v5, v113
 v_mfma_f32_16x16x32_bf16 v[180:183], a[216:219], a[152:155], v[180:183]
 v_cvt_pk_bf16_f32 v14, v6, v5
 v_accvgpr_read_b32 v5, a35
 v_mfma_f32_16x16x32_bf16 v[180:183], a[220:223], a[156:159], v[180:183]
 v_lshlrev_b32 v6, 16, v5
 v_and_b32 v5, s26, v5
 v_mfma_f32_16x16x32_bf16 v[176:179], a[220:223], a[148:151], v[176:179]
 v_mul_f32 v6, v6, v114
 v_mul_f32 v5, v5, v115
 v_mfma_f32_16x16x32_bf16 v[176:179], a[216:219], a[144:147], v[176:179]
 v_cvt_pk_bf16_f32 v15, v6, v5
 v_mfma_f32_16x16x32_bf16 v[172:175], a[216:219], a[136:139], v[172:175]
 ds_write_b128 v3, v[12:15] offset:1024
 v_mfma_f32_16x16x32_bf16 v[172:175], a[220:223], a[140:143], v[172:175]
 buffer_store_dwordx4 v[12:15], v3, s[32:35], s68 offen offset:1024 sc1
 v_accvgpr_read_b32 v5, a4
 v_lshlrev_b32 v6, 16, v5
 v_and_b32 v5, s26, v5
 v_mul_f32 v6, v6, v20
 v_mfma_f32_16x16x32_bf16 v[168:171], a[220:223], a[132:135], v[168:171]
 v_mul_f32 v5, v5, v21
 v_cvt_pk_bf16_f32 v8, v6, v5
 v_mfma_f32_16x16x32_bf16 v[168:171], a[216:219], a[128:131], v[168:171]
 v_accvgpr_read_b32 v5, a5
 v_lshlrev_b32 v6, 16, v5
 s_waitcnt vmcnt(10)
 v_mfma_f32_16x16x32_bf16 v[200:203], a[224:227], a[128:131], v[200:203]
 v_and_b32 v5, s26, v5
 v_mul_f32 v6, v6, v22
 v_mfma_f32_16x16x32_bf16 v[200:203], a[228:231], a[132:135], v[200:203]
 global_load_dwordx4 a[220:223], v0, s[70:71] offset:3072
 v_mul_f32 v5, v5, v23
 v_mfma_f32_16x16x32_bf16 v[204:207], a[228:231], a[140:143], v[204:207]
 v_cvt_pk_bf16_f32 v9, v6, v5
 v_accvgpr_read_b32 v5, a6
 v_mfma_f32_16x16x32_bf16 v[204:207], a[224:227], a[136:139], v[204:207]
 global_load_dwordx4 a[216:219], v0, s[70:71] offset:2048
 v_lshlrev_b32 v6, 16, v5
 v_mfma_f32_16x16x32_bf16 v[208:211], a[224:227], a[144:147], v[208:211]
 v_and_b32 v5, s26, v5
 v_mul_f32 v6, v6, v52
 s_add_u32 s70, s70, 8192
 s_addc_u32 s71, s71, 0
 v_mfma_f32_16x16x32_bf16 v[208:211], a[228:231], a[148:151], v[208:211]
 v_mul_f32 v5, v5, v53
 v_cvt_pk_bf16_f32 v10, v6, v5
 v_mfma_f32_16x16x32_bf16 v[212:215], a[228:231], a[156:159], v[212:215]
 v_accvgpr_read_b32 v5, a7
 v_lshlrev_b32 v6, 16, v5
 v_mfma_f32_16x16x32_bf16 v[212:215], a[224:227], a[152:155], v[212:215]
 v_and_b32 v5, s26, v5
 v_mul_f32 v6, v6, v54
 v_mfma_f32_16x16x32_bf16 v[216:219], a[224:227], a[160:163], v[216:219]
 v_mul_f32 v5, v5, v55
 v_cvt_pk_bf16_f32 v11, v6, v5
 v_mfma_f32_16x16x32_bf16 v[216:219], a[228:231], a[164:167], v[216:219]
 ds_write_b128 v3, v[8:11] offset:4096
 v_mfma_f32_16x16x32_bf16 v[220:223], a[228:231], a[172:175], v[220:223]
 buffer_store_dwordx4 v[8:11], v3, s[32:35], s68 offen offset:2048 sc1
 v_accvgpr_read_b32 v5, a36
 v_lshlrev_b32 v6, 16, v5
 v_and_b32 v5, s26, v5
 v_mul_f32 v6, v6, v84
 v_mfma_f32_16x16x32_bf16 v[220:223], a[224:227], a[168:171], v[220:223]
 v_mul_f32 v5, v5, v85
 v_cvt_pk_bf16_f32 v12, v6, v5
 v_mfma_f32_16x16x32_bf16 v[224:227], a[224:227], a[176:179], v[224:227]
 v_accvgpr_read_b32 v5, a37
 v_lshlrev_b32 v6, 16, v5
 v_mfma_f32_16x16x32_bf16 v[224:227], a[228:231], a[180:183], v[224:227]
 v_and_b32 v5, s26, v5
 v_mul_f32 v6, v6, v86
 v_mfma_f32_16x16x32_bf16 v[228:231], a[228:231], a[188:191], v[228:231]
 v_mul_f32 v5, v5, v87
 v_cvt_pk_bf16_f32 v13, v6, v5
 v_mfma_f32_16x16x32_bf16 v[228:231], a[224:227], a[184:187], v[228:231]
 v_accvgpr_read_b32 v5, a38
 v_lshlrev_b32 v6, 16, v5
 s_waitcnt vmcnt(11)
 v_mfma_f32_16x16x32_bf16 a[252:255], a[232:235], a[184:187], a[252:255]
 ds_read_b128 a[184:187], v1 offset:63488
 v_and_b32 v5, s26, v5
 v_mfma_f32_16x16x32_bf16 a[252:255], a[236:239], a[188:191], a[252:255]
 global_load_dwordx4 a[228:231], v0, s[70:71] offset:-3072
 ds_read_b128 a[188:191], v1 offset:64512
 v_mfma_f32_16x16x32_bf16 a[248:251], a[236:239], a[180:183], a[248:251]
 ds_read_b128 a[180:183], v1 offset:60416
 v_mul_f32 v6, v6, v116
 v_mfma_f32_16x16x32_bf16 a[248:251], a[232:235], a[176:179], a[248:251]
 global_load_dwordx4 a[224:227], v0, s[70:71] offset:-4096
 ds_read_b128 a[176:179], v1 offset:59392
 v_mul_f32 v5, v5, v117
 v_mfma_f32_16x16x32_bf16 v[252:255], a[232:235], a[168:171], v[252:255]
 ds_read_b128 a[168:171], v1 offset:55296
 v_cvt_pk_bf16_f32 v14, v6, v5
 v_accvgpr_read_b32 v5, a39
 v_mfma_f32_16x16x32_bf16 v[252:255], a[236:239], a[172:175], v[252:255]
 ds_read_b128 a[172:175], v1 offset:56320
 v_lshlrev_b32 v6, 16, v5
 v_mfma_f32_16x16x32_bf16 v[248:251], a[236:239], a[164:167], v[248:251]
 ds_read_b128 a[164:167], v1 offset:52224
 v_and_b32 v5, s26, v5
 v_mul_f32 v6, v6, v118
 v_mfma_f32_16x16x32_bf16 v[248:251], a[232:235], a[160:163], v[248:251]
 ds_read_b128 a[160:163], v1 offset:51200
 v_mul_f32 v5, v5, v119
 v_cvt_pk_bf16_f32 v15, v6, v5
 v_mfma_f32_16x16x32_bf16 v[244:247], a[232:235], a[152:155], v[244:247]
 ds_read_b128 a[152:155], v1 offset:47104
 ds_write_b128 v3, v[12:15] offset:5120
 v_mfma_f32_16x16x32_bf16 v[244:247], a[236:239], a[156:159], v[244:247]
 buffer_store_dwordx4 v[12:15], v3, s[32:35], s68 offen offset:3072 sc1
 ds_read_b128 a[156:159], v1 offset:48128
 v_accvgpr_read_b32 v5, a8
 v_lshlrev_b32 v6, 16, v5
 v_and_b32 v5, s26, v5
 v_mfma_f32_16x16x32_bf16 v[240:243], a[236:239], a[148:151], v[240:243]
 ds_read_b128 a[148:151], v1 offset:44032
 v_mul_f32 v6, v6, v24
 v_mfma_f32_16x16x32_bf16 v[240:243], a[232:235], a[144:147], v[240:243]
 ds_read_b128 a[144:147], v1 offset:43008
 v_mul_f32 v5, v5, v25
 v_cvt_pk_bf16_f32 v8, v6, v5
 v_mfma_f32_16x16x32_bf16 v[236:239], a[232:235], a[136:139], v[236:239]
 ds_read_b128 a[136:139], v1 offset:38912
 v_accvgpr_read_b32 v5, a9
 v_mfma_f32_16x16x32_bf16 v[236:239], a[236:239], a[140:143], v[236:239]
 ds_read_b128 a[140:143], v1 offset:39936
 v_lshlrev_b32 v6, 16, v5
 v_mfma_f32_16x16x32_bf16 v[232:235], a[236:239], a[132:135], v[232:235]
 ds_read_b128 a[132:135], v1 offset:35840
 v_and_b32 v5, s26, v5
 v_mfma_f32_16x16x32_bf16 v[232:235], a[232:235], a[128:131], v[232:235]
 ds_read_b128 a[128:131], v1 offset:34816
 v_mul_f32 v6, v6, v26
 s_waitcnt vmcnt(12) lgkmcnt(9)
 v_mfma_f32_16x16x32_bf16 v[164:167], a[192:195], a[184:187], v[164:167]
 v_mul_f32 v5, v5, v27
 v_cvt_pk_bf16_f32 v9, v6, v5
 v_mfma_f32_16x16x32_bf16 v[164:167], a[196:199], a[188:191], v[164:167]
 global_load_dwordx4 a[236:239], v0, s[70:71] offset:-1024
 v_accvgpr_read_b32 v5, a10
 v_mfma_f32_16x16x32_bf16 v[160:163], a[196:199], a[180:183], v[160:163]
 v_lshlrev_b32 v6, 16, v5
 v_and_b32 v5, s26, v5
 v_mfma_f32_16x16x32_bf16 v[160:163], a[192:195], a[176:179], v[160:163]
 global_load_dwordx4 a[232:235], v0, s[70:71] offset:-2048
 v_mul_f32 v6, v6, v56
 v_mfma_f32_16x16x32_bf16 v[156:159], a[192:195], a[168:171], v[156:159]
 v_mul_f32 v5, v5, v57
 v_cvt_pk_bf16_f32 v10, v6, v5
 v_mfma_f32_16x16x32_bf16 v[156:159], a[196:199], a[172:175], v[156:159]
 v_accvgpr_read_b32 v5, a11
 v_lshlrev_b32 v6, 16, v5
 v_mfma_f32_16x16x32_bf16 v[152:155], a[196:199], a[164:167], v[152:155]
 v_and_b32 v5, s26, v5
 v_mul_f32 v6, v6, v58
 v_mfma_f32_16x16x32_bf16 v[152:155], a[192:195], a[160:163], v[152:155]
 v_mul_f32 v5, v5, v59
 v_cvt_pk_bf16_f32 v11, v6, v5
 s_waitcnt lgkmcnt(0)
 v_mfma_f32_16x16x32_bf16 v[148:151], a[192:195], a[152:155], v[148:151]
 ds_write_b128 v3, v[8:11] offset:8192
 s_add_u32 s68, s29, 4096
 v_mfma_f32_16x16x32_bf16 v[148:151], a[196:199], a[156:159], v[148:151]
 buffer_store_dwordx4 v[8:11], v3, s[32:35], s68 offen sc1
 v_accvgpr_read_b32 v5, a40
 v_lshlrev_b32 v6, 16, v5
 v_and_b32 v5, s26, v5
 v_mul_f32 v6, v6, v88
 v_mfma_f32_16x16x32_bf16 v[144:147], a[196:199], a[148:151], v[144:147]
 v_mul_f32 v5, v5, v89
 v_cvt_pk_bf16_f32 v12, v6, v5
 v_mfma_f32_16x16x32_bf16 v[144:147], a[192:195], a[144:147], v[144:147]
 v_accvgpr_read_b32 v5, a41
 v_lshlrev_b32 v6, 16, v5
 v_mfma_f32_16x16x32_bf16 v[140:143], a[192:195], a[136:139], v[140:143]
 v_and_b32 v5, s26, v5
 v_mul_f32 v6, v6, v90
 v_mfma_f32_16x16x32_bf16 v[140:143], a[196:199], a[140:143], v[140:143]
 v_mul_f32 v5, v5, v91
 v_cvt_pk_bf16_f32 v13, v6, v5
 v_mfma_f32_16x16x32_bf16 v[136:139], a[196:199], a[132:135], v[136:139]
 v_accvgpr_read_b32 v5, a42
 v_lshlrev_b32 v6, 16, v5
 v_mfma_f32_16x16x32_bf16 v[136:139], a[192:195], a[128:131], v[136:139]
 v_and_b32 v5, s26, v5
 v_mul_f32 v6, v6, v120
 s_waitcnt vmcnt(13)
 v_mfma_f32_16x16x32_bf16 v[168:171], a[200:203], a[128:131], v[168:171]
 v_mul_f32 v5, v5, v121
 v_cvt_pk_bf16_f32 v14, v6, v5
 v_mfma_f32_16x16x32_bf16 v[168:171], a[204:207], a[132:135], v[168:171]
 global_load_dwordx4 a[196:199], v0, s[70:71] offset:1024
 v_accvgpr_read_b32 v5, a43
 v_mfma_f32_16x16x32_bf16 v[172:175], a[204:207], a[140:143], v[172:175]
 v_lshlrev_b32 v6, 16, v5
 v_and_b32 v5, s26, v5
 v_mfma_f32_16x16x32_bf16 v[172:175], a[200:203], a[136:139], v[172:175]
 global_load_dwordx4 a[192:195], v0, s[70:71] offset:0
 v_mul_f32 v6, v6, v122
 v_mfma_f32_16x16x32_bf16 v[176:179], a[200:203], a[144:147], v[176:179]
 v_mul_f32 v5, v5, v123
 v_cvt_pk_bf16_f32 v15, v6, v5
 v_mfma_f32_16x16x32_bf16 v[176:179], a[204:207], a[148:151], v[176:179]
 ds_write_b128 v3, v[12:15] offset:9216
 v_mfma_f32_16x16x32_bf16 v[180:183], a[204:207], a[156:159], v[180:183]
 v_lshlrev_b32 v4, 2, v1
 v_and_b32 v4, 192, v4
 v_mfma_f32_16x16x32_bf16 v[180:183], a[200:203], a[152:155], v[180:183]
 buffer_load_dword v4, v4, s[44:47], 0 offen sc1
 v_mfma_f32_16x16x32_bf16 v[184:187], a[200:203], a[160:163], v[184:187]
 buffer_store_dwordx4 v[12:15], v3, s[32:35], s68 offen offset:1024 sc1
 v_accvgpr_read_b32 v5, a12
 v_lshlrev_b32 v6, 16, v5
 v_and_b32 v5, s26, v5
 v_mul_f32 v6, v6, v28
 v_mfma_f32_16x16x32_bf16 v[184:187], a[204:207], a[164:167], v[184:187]
 v_mul_f32 v5, v5, v29
 v_cvt_pk_bf16_f32 v8, v6, v5
 v_mfma_f32_16x16x32_bf16 v[188:191], a[204:207], a[172:175], v[188:191]
 v_accvgpr_read_b32 v5, a13
 v_lshlrev_b32 v6, 16, v5
 v_mfma_f32_16x16x32_bf16 v[188:191], a[200:203], a[168:171], v[188:191]
 v_and_b32 v5, s26, v5
 v_mul_f32 v6, v6, v30
 v_mfma_f32_16x16x32_bf16 v[192:195], a[200:203], a[176:179], v[192:195]
 v_mul_f32 v5, v5, v31
 v_cvt_pk_bf16_f32 v9, v6, v5
 v_mfma_f32_16x16x32_bf16 v[192:195], a[204:207], a[180:183], v[192:195]
 v_accvgpr_read_b32 v5, a14
 v_lshlrev_b32 v6, 16, v5
 v_mfma_f32_16x16x32_bf16 v[196:199], a[204:207], a[188:191], v[196:199]
 v_and_b32 v5, s26, v5
 v_mul_f32 v6, v6, v60
 v_mfma_f32_16x16x32_bf16 v[196:199], a[200:203], a[184:187], v[196:199]
 v_mul_f32 v5, v5, v61
 v_cvt_pk_bf16_f32 v10, v6, v5
 s_waitcnt vmcnt(14)
 v_mfma_f32_16x16x32_bf16 v[228:231], a[208:211], a[184:187], v[228:231]
 v_accvgpr_read_b32 v5, a15
 v_lshlrev_b32 v6, 16, v5
 v_mfma_f32_16x16x32_bf16 v[228:231], a[212:215], a[188:191], v[228:231]
 global_load_dwordx4 a[204:207], v0, s[70:71] offset:3072
 v_and_b32 v5, s26, v5
 v_mfma_f32_16x16x32_bf16 v[224:227], a[212:215], a[180:183], v[224:227]
 v_mul_f32 v6, v6, v62
 v_mul_f32 v5, v5, v63
 v_mfma_f32_16x16x32_bf16 v[224:227], a[208:211], a[176:179], v[224:227]
 global_load_dwordx4 a[200:203], v0, s[70:71] offset:2048
 v_cvt_pk_bf16_f32 v11, v6, v5
 v_mfma_f32_16x16x32_bf16 v[220:223], a[208:211], a[168:171], v[220:223]
 ds_write_b128 v3, v[8:11] offset:12288
 s_add_u32 s70, s70, 8192
 s_addc_u32 s71, s71, 0
 v_mfma_f32_16x16x32_bf16 v[220:223], a[212:215], a[172:175], v[220:223]
 buffer_store_dwordx4 v[8:11], v3, s[32:35], s68 offen offset:2048 sc1
 v_accvgpr_read_b32 v5, a44
 v_lshlrev_b32 v6, 16, v5
 v_and_b32 v5, s26, v5
 v_mfma_f32_16x16x32_bf16 v[216:219], a[212:215], a[164:167], v[216:219]
 v_mul_f32 v6, v6, v92
 v_mul_f32 v5, v5, v93
 v_mfma_f32_16x16x32_bf16 v[216:219], a[208:211], a[160:163], v[216:219]
 v_cvt_pk_bf16_f32 v12, v6, v5
 v_accvgpr_read_b32 v5, a45
 v_mfma_f32_16x16x32_bf16 v[212:215], a[208:211], a[152:155], v[212:215]
 v_lshlrev_b32 v6, 16, v5
 v_and_b32 v5, s26, v5
 v_mfma_f32_16x16x32_bf16 v[212:215], a[212:215], a[156:159], v[212:215]
 v_mul_f32 v6, v6, v94
 v_mul_f32 v5, v5, v95
 v_mfma_f32_16x16x32_bf16 v[208:211], a[212:215], a[148:151], v[208:211]
 v_cvt_pk_bf16_f32 v13, v6, v5
 v_accvgpr_read_b32 v5, a46
 v_mfma_f32_16x16x32_bf16 v[208:211], a[208:211], a[144:147], v[208:211]
 v_lshlrev_b32 v6, 16, v5
 v_and_b32 v5, s26, v5
 v_mfma_f32_16x16x32_bf16 v[204:207], a[208:211], a[136:139], v[204:207]
 v_mul_f32 v6, v6, v124
 v_mul_f32 v5, v5, v125
 v_mfma_f32_16x16x32_bf16 v[204:207], a[212:215], a[140:143], v[204:207]
 v_cvt_pk_bf16_f32 v14, v6, v5
 v_accvgpr_read_b32 v5, a47
 v_mfma_f32_16x16x32_bf16 v[200:203], a[212:215], a[132:135], v[200:203]
 v_lshlrev_b32 v6, 16, v5
 v_and_b32 v5, s26, v5
 v_mfma_f32_16x16x32_bf16 v[200:203], a[208:211], a[128:131], v[200:203]
 v_mul_f32 v6, v6, v126
 v_mul_f32 v5, v5, v127
 s_waitcnt vmcnt(14)
 v_mfma_f32_16x16x32_bf16 v[232:235], a[216:219], a[128:131], v[232:235]
 ds_read_b128 a[128:131], v2 offset:2048
 v_cvt_pk_bf16_f32 v15, v6, v5
 v_mfma_f32_16x16x32_bf16 v[232:235], a[220:223], a[132:135], v[232:235]
 global_load_dwordx4 a[212:215], v0, s[70:71] offset:-3072
 ds_read_b128 a[132:135], v2 offset:3072
 v_mfma_f32_16x16x32_bf16 v[236:239], a[220:223], a[140:143], v[236:239]
 ds_read_b128 a[140:143], v2 offset:7168
 ds_write_b128 v3, v[12:15] offset:13312
 v_mfma_f32_16x16x32_bf16 v[236:239], a[216:219], a[136:139], v[236:239]
 global_load_dwordx4 a[208:211], v0, s[70:71] offset:-4096
 ds_read_b128 a[136:139], v2 offset:6144
 v_mfma_f32_16x16x32_bf16 v[240:243], a[216:219], a[144:147], v[240:243]
 buffer_store_dwordx4 v[12:15], v3, s[32:35], s68 offen offset:3072 sc1
 ds_read_b128 a[144:147], v2 offset:10240
 v_accvgpr_read_b32 v5, a16
 v_lshlrev_b32 v6, 16, v5
 v_and_b32 v5, s26, v5
 v_mfma_f32_16x16x32_bf16 v[240:243], a[220:223], a[148:151], v[240:243]
 ds_read_b128 a[148:151], v2 offset:11264
 v_mul_f32 v6, v6, v32
 v_mfma_f32_16x16x32_bf16 v[244:247], a[220:223], a[156:159], v[244:247]
 ds_read_b128 a[156:159], v2 offset:15360
 v_mul_f32 v5, v5, v33
 v_cvt_pk_bf16_f32 v8, v6, v5
 v_mfma_f32_16x16x32_bf16 v[244:247], a[216:219], a[152:155], v[244:247]
 ds_read_b128 a[152:155], v2 offset:14336
 v_accvgpr_read_b32 v5, a17
 v_lshlrev_b32 v6, 16, v5
 v_mfma_f32_16x16x32_bf16 v[248:251], a[216:219], a[160:163], v[248:251]
 ds_read_b128 a[160:163], v2 offset:18432
 v_and_b32 v5, s26, v5
 v_mul_f32 v6, v6, v34
 v_mfma_f32_16x16x32_bf16 v[248:251], a[220:223], a[164:167], v[248:251]
 ds_read_b128 a[164:167], v2 offset:19456
 v_mul_f32 v5, v5, v35
 v_cvt_pk_bf16_f32 v9, v6, v5
 v_mfma_f32_16x16x32_bf16 v[252:255], a[220:223], a[172:175], v[252:255]
 ds_read_b128 a[172:175], v2 offset:23552
 v_accvgpr_read_b32 v5, a18
 v_mfma_f32_16x16x32_bf16 v[252:255], a[216:219], a[168:171], v[252:255]
 ds_read_b128 a[168:171], v2 offset:22528
 v_lshlrev_b32 v6, 16, v5
 v_mfma_f32_16x16x32_bf16 a[248:251], a[216:219], a[176:179], a[248:251]
 ds_read_b128 a[176:179], v2 offset:26624
 v_and_b32 v5, s26, v5
 v_mfma_f32_16x16x32_bf16 a[248:251], a[220:223], a[180:183], a[248:251]
 ds_read_b128 a[180:183], v2 offset:27648
 v_mul_f32 v6, v6, v64
 v_mfma_f32_16x16x32_bf16 a[252:255], a[220:223], a[188:191], a[252:255]
 ds_read_b128 a[188:191], v2 offset:31744
 v_mul_f32 v5, v5, v65
 v_mfma_f32_16x16x32_bf16 a[252:255], a[216:219], a[184:187], a[252:255]
 ds_read_b128 a[184:187], v2 offset:30720
 v_cvt_pk_bf16_f32 v10, v6, v5
 s_waitcnt vmcnt(14) lgkmcnt(8)
 v_mfma_f32_16x16x32_bf16 v[136:139], a[224:227], a[128:131], v[136:139]
 v_accvgpr_read_b32 v5, a19
 v_lshlrev_b32 v6, 16, v5
 v_mfma_f32_16x16x32_bf16 v[136:139], a[228:231], a[132:135], v[136:139]
 global_load_dwordx4 a[220:223], v0, s[70:71] offset:-1024
 v_and_b32 v5, s26, v5
 v_mfma_f32_16x16x32_bf16 v[140:143], a[228:231], a[140:143], v[140:143]
 v_mul_f32 v6, v6, v66
 v_mul_f32 v5, v5, v67
 v_mfma_f32_16x16x32_bf16 v[140:143], a[224:227], a[136:139], v[140:143]
 global_load_dwordx4 a[216:219], v0, s[70:71] offset:-2048
 v_cvt_pk_bf16_f32 v11, v6, v5
 v_mfma_f32_16x16x32_bf16 v[144:147], a[224:227], a[144:147], v[144:147]
 ds_write_b128 v3, v[8:11] offset:16384
 s_add_u32 s68, s29, 8192
 v_mfma_f32_16x16x32_bf16 v[144:147], a[228:231], a[148:151], v[144:147]
 buffer_store_dwordx4 v[8:11], v3, s[32:35], s68 offen sc1
 v_accvgpr_read_b32 v5, a48
 v_lshlrev_b32 v6, 16, v5
 v_and_b32 v5, s26, v5
 v_mul_f32 v6, v6, v96
 v_mfma_f32_16x16x32_bf16 v[148:151], a[228:231], a[156:159], v[148:151]
 v_mul_f32 v5, v5, v97
 v_cvt_pk_bf16_f32 v12, v6, v5
 v_mfma_f32_16x16x32_bf16 v[148:151], a[224:227], a[152:155], v[148:151]
 v_accvgpr_read_b32 v5, a49
 v_lshlrev_b32 v6, 16, v5
 s_waitcnt lgkmcnt(1)
 v_mfma_f32_16x16x32_bf16 v[152:155], a[224:227], a[160:163], v[152:155]
 v_and_b32 v5, s26, v5
 v_mul_f32 v6, v6, v98
 v_mfma_f32_16x16x32_bf16 v[152:155], a[228:231], a[164:167], v[152:155]
 v_mul_f32 v5, v5, v99
 v_cvt_pk_bf16_f32 v13, v6, v5
 v_mfma_f32_16x16x32_bf16 v[156:159], a[228:231], a[172:175], v[156:159]
 v_accvgpr_read_b32 v5, a50
 v_lshlrev_b32 v6, 16, v5
 v_mfma_f32_16x16x32_bf16 v[156:159], a[224:227], a[168:171], v[156:159]
 v_and_b32 v5, s26, v5
 v_mul_f32 v6, v6, v128
 v_mfma_f32_16x16x32_bf16 v[160:163], a[224:227], a[176:179], v[160:163]
 v_mul_f32 v5, v5, v129
 v_cvt_pk_bf16_f32 v14, v6, v5
 v_mfma_f32_16x16x32_bf16 v[160:163], a[228:231], a[180:183], v[160:163]
 v_accvgpr_read_b32 v5, a51
 v_lshlrev_b32 v6, 16, v5
 v_mfma_f32_16x16x32_bf16 v[164:167], a[228:231], a[188:191], v[164:167]
 v_and_b32 v5, s26, v5
 v_mul_f32 v6, v6, v130
 v_mfma_f32_16x16x32_bf16 v[164:167], a[224:227], a[184:187], v[164:167]
 v_mul_f32 v5, v5, v131
 v_cvt_pk_bf16_f32 v15, v6, v5
 s_waitcnt vmcnt(14)
 v_mfma_f32_16x16x32_bf16 v[196:199], a[232:235], a[184:187], v[196:199]
 ds_write_b128 v3, v[12:15] offset:17408
 v_mfma_f32_16x16x32_bf16 v[196:199], a[236:239], a[188:191], v[196:199]
 buffer_store_dwordx4 v[12:15], v3, s[32:35], s68 offen offset:1024 sc1
 global_load_dwordx4 a[228:231], v0, s[70:71] offset:1024
 v_accvgpr_read_b32 v5, a20
 v_lshlrev_b32 v6, 16, v5
 v_and_b32 v5, s26, v5
 v_mfma_f32_16x16x32_bf16 v[192:195], a[236:239], a[180:183], v[192:195]
 v_mul_f32 v6, v6, v36
 v_mul_f32 v5, v5, v37
 v_mfma_f32_16x16x32_bf16 v[192:195], a[232:235], a[176:179], v[192:195]
 global_load_dwordx4 a[224:227], v0, s[70:71] offset:0
 v_cvt_pk_bf16_f32 v8, v6, v5
 v_mfma_f32_16x16x32_bf16 v[188:191], a[232:235], a[168:171], v[188:191]
 v_accvgpr_read_b32 v5, a21
 v_lshlrev_b32 v6, 16, v5
 v_mfma_f32_16x16x32_bf16 v[188:191], a[236:239], a[172:175], v[188:191]
 v_and_b32 v5, s26, v5
 v_mul_f32 v6, v6, v38
 v_mfma_f32_16x16x32_bf16 v[184:187], a[236:239], a[164:167], v[184:187]
 v_mul_f32 v5, v5, v39
 v_cvt_pk_bf16_f32 v9, v6, v5
 v_mfma_f32_16x16x32_bf16 v[184:187], a[232:235], a[160:163], v[184:187]
 v_accvgpr_read_b32 v5, a22
 v_lshlrev_b32 v6, 16, v5
 v_mfma_f32_16x16x32_bf16 v[180:183], a[232:235], a[152:155], v[180:183]
 v_and_b32 v5, s26, v5
 v_mul_f32 v6, v6, v68
 v_mfma_f32_16x16x32_bf16 v[180:183], a[236:239], a[156:159], v[180:183]
 v_mul_f32 v5, v5, v69
 v_cvt_pk_bf16_f32 v10, v6, v5
 v_mfma_f32_16x16x32_bf16 v[176:179], a[236:239], a[148:151], v[176:179]
 v_accvgpr_read_b32 v5, a23
 v_lshlrev_b32 v6, 16, v5
 v_mfma_f32_16x16x32_bf16 v[176:179], a[232:235], a[144:147], v[176:179]
 v_and_b32 v5, s26, v5
 v_mul_f32 v6, v6, v70
 v_mfma_f32_16x16x32_bf16 v[172:175], a[232:235], a[136:139], v[172:175]
 v_mul_f32 v5, v5, v71
 v_cvt_pk_bf16_f32 v11, v6, v5
 v_mfma_f32_16x16x32_bf16 v[172:175], a[236:239], a[140:143], v[172:175]
 ds_write_b128 v3, v[8:11] offset:20480
 v_mfma_f32_16x16x32_bf16 v[168:171], a[236:239], a[132:135], v[168:171]
 buffer_store_dwordx4 v[8:11], v3, s[32:35], s68 offen offset:2048 sc1
 v_accvgpr_read_b32 v5, a52
 v_lshlrev_b32 v6, 16, v5
 v_and_b32 v5, s26, v5
 v_mfma_f32_16x16x32_bf16 v[168:171], a[232:235], a[128:131], v[168:171]
 v_mul_f32 v6, v6, v100
 v_mul_f32 v5, v5, v101
 s_waitcnt vmcnt(15)
 v_mfma_f32_16x16x32_bf16 v[200:203], a[192:195], a[128:131], v[200:203]
 v_cvt_pk_bf16_f32 v12, v6, v5
 v_accvgpr_read_b32 v5, a53
 v_mfma_f32_16x16x32_bf16 v[200:203], a[196:199], a[132:135], v[200:203]
 global_load_dwordx4 a[236:239], v0, s[70:71] offset:3072
 v_lshlrev_b32 v6, 16, v5
 v_mfma_f32_16x16x32_bf16 v[204:207], a[196:199], a[140:143], v[204:207]
 v_and_b32 v5, s26, v5
 s_waitcnt vmcnt(15)
 v_cmp_gt_i32 vcc, s27, v4
 s_cbranch_vccnz Lspin_w
Lok_w:
 s_add_u32 s27, s27, 64
 v_mfma_f32_16x16x32_bf16 v[204:207], a[192:195], a[136:139], v[204:207]
 global_load_dwordx4 a[232:235], v0, s[70:71] offset:2048
 v_mul_f32 v6, v6, v102
 v_mfma_f32_16x16x32_bf16 v[208:211], a[192:195], a[144:147], v[208:211]
 v_mul_f32 v5, v5, v103
 v_cvt_pk_bf16_f32 v13, v6, v5
 s_add_u32 s70, s70, 1843200
 s_addc_u32 s71, s71, 0
 v_mfma_f32_16x16x32_bf16 v[208:211], a[196:199], a[148:151], v[208:211]
 v_accvgpr_read_b32 v5, a54
 v_lshlrev_b32 v6, 16, v5
 v_mfma_f32_16x16x32_bf16 v[212:215], a[196:199], a[156:159], v[212:215]
 v_and_b32 v5, s26, v5
 v_mul_f32 v6, v6, v132
 v_mfma_f32_16x16x32_bf16 v[212:215], a[192:195], a[152:155], v[212:215]
 v_mul_f32 v5, v5, v133
 v_cvt_pk_bf16_f32 v14, v6, v5
 v_mfma_f32_16x16x32_bf16 v[216:219], a[192:195], a[160:163], v[216:219]
 v_accvgpr_read_b32 v5, a55
 v_lshlrev_b32 v6, 16, v5
 v_mfma_f32_16x16x32_bf16 v[216:219], a[196:199], a[164:167], v[216:219]
 v_and_b32 v5, s26, v5
 v_mul_f32 v6, v6, v134
 v_mfma_f32_16x16x32_bf16 v[220:223], a[196:199], a[172:175], v[220:223]
 v_mul_f32 v5, v5, v135
 v_cvt_pk_bf16_f32 v15, v6, v5
 v_mfma_f32_16x16x32_bf16 v[220:223], a[192:195], a[168:171], v[220:223]
 ds_write_b128 v3, v[12:15] offset:21504
 v_mfma_f32_16x16x32_bf16 v[224:227], a[192:195], a[176:179], v[224:227]
 buffer_store_dwordx4 v[12:15], v3, s[32:35], s68 offen offset:3072 sc1
 v_accvgpr_read_b32 v5, a24
 v_lshlrev_b32 v6, 16, v5
 v_and_b32 v5, s26, v5
 v_mul_f32 v6, v6, v40
 v_mfma_f32_16x16x32_bf16 v[224:227], a[196:199], a[180:183], v[224:227]
 v_mul_f32 v5, v5, v41
 v_cvt_pk_bf16_f32 v8, v6, v5
 v_mfma_f32_16x16x32_bf16 v[228:231], a[196:199], a[188:191], v[228:231]
 v_accvgpr_read_b32 v5, a25
 v_lshlrev_b32 v6, 16, v5
 v_mfma_f32_16x16x32_bf16 v[228:231], a[192:195], a[184:187], v[228:231]
 v_and_b32 v5, s26, v5
 v_mul_f32 v6, v6, v42
 s_waitcnt vmcnt(14)
 v_mfma_f32_16x16x32_bf16 a[252:255], a[200:203], a[184:187], a[252:255]
 ds_read_b128 a[184:187], v2 offset:63488
 v_mul_f32 v5, v5, v43
 v_mfma_f32_16x16x32_bf16 a[252:255], a[204:207], a[188:191], a[252:255]
 global_load_dwordx4 a[196:199], v0, s[70:71] offset:-3072
 ds_read_b128 a[188:191], v2 offset:64512
 v_mfma_f32_16x16x32_bf16 a[248:251], a[204:207], a[180:183], a[248:251]
 ds_read_b128 a[180:183], v2 offset:60416
 v_cvt_pk_bf16_f32 v9, v6, v5
 v_mfma_f32_16x16x32_bf16 a[248:251], a[200:203], a[176:179], a[248:251]
 global_load_dwordx4 a[192:195], v0, s[70:71] offset:-4096
 ds_read_b128 a[176:179], v2 offset:59392
 v_accvgpr_read_b32 v5, a26
 v_lshlrev_b32 v6, 16, v5
 v_mfma_f32_16x16x32_bf16 v[252:255], a[200:203], a[168:171], v[252:255]
 ds_read_b128 a[168:171], v2 offset:55296
 v_and_b32 v5, s26, v5
 v_mfma_f32_16x16x32_bf16 v[252:255], a[204:207], a[172:175], v[252:255]
 ds_read_b128 a[172:175], v2 offset:56320
 v_mul_f32 v6, v6, v72
 v_mfma_f32_16x16x32_bf16 v[248:251], a[204:207], a[164:167], v[248:251]
 ds_read_b128 a[164:167], v2 offset:52224
 v_mul_f32 v5, v5, v73
 v_mfma_f32_16x16x32_bf16 v[248:251], a[200:203], a[160:163], v[248:251]
 ds_read_b128 a[160:163], v2 offset:51200
 v_cvt_pk_bf16_f32 v10, v6, v5
 v_mfma_f32_16x16x32_bf16 v[244:247], a[200:203], a[152:155], v[244:247]
 ds_read_b128 a[152:155], v2 offset:47104
 v_accvgpr_read_b32 v5, a27
 v_mfma_f32_16x16x32_bf16 v[244:247], a[204:207], a[156:159], v[244:247]
 ds_read_b128 a[156:159], v2 offset:48128
 v_lshlrev_b32 v6, 16, v5
 v_mfma_f32_16x16x32_bf16 v[240:243], a[204:207], a[148:151], v[240:243]
 ds_read_b128 a[148:151], v2 offset:44032
 v_and_b32 v5, s26, v5
 v_mfma_f32_16x16x32_bf16 v[240:243], a[200:203], a[144:147], v[240:243]
 ds_read_b128 a[144:147], v2 offset:43008
 v_mul_f32 v6, v6, v74
 v_mfma_f32_16x16x32_bf16 v[236:239], a[200:203], a[136:139], v[236:239]
 ds_read_b128 a[136:139], v2 offset:38912
 v_mul_f32 v5, v5, v75
 v_mfma_f32_16x16x32_bf16 v[236:239], a[204:207], a[140:143], v[236:239]
 ds_read_b128 a[140:143], v2 offset:39936
 v_cvt_pk_bf16_f32 v11, v6, v5
 v_mfma_f32_16x16x32_bf16 v[232:235], a[204:207], a[132:135], v[232:235]
 ds_read_b128 a[132:135], v2 offset:35840
 ds_write_b128 v3, v[8:11] offset:24576
 s_add_u32 s68, s29, 12288
 buffer_store_dwordx4 v[8:11], v3, s[32:35], s68 offen sc1
 v_accvgpr_read_b32 v5, a56
 v_lshlrev_b32 v6, 16, v5
 v_and_b32 v5, s26, v5
 v_mul_f32 v6, v6, v104
 v_mfma_f32_16x16x32_bf16 v[232:235], a[200:203], a[128:131], v[232:235]
 ds_read_b128 a[128:131], v2 offset:34816
 v_mul_f32 v5, v5, v105
 v_cvt_pk_bf16_f32 v12, v6, v5
 s_waitcnt vmcnt(14) lgkmcnt(9)
 v_mfma_f32_16x16x32_bf16 v[164:167], a[208:211], a[184:187], v[164:167]
 v_accvgpr_read_b32 v5, a57
 v_lshlrev_b32 v6, 16, v5
 v_mfma_f32_16x16x32_bf16 v[164:167], a[212:215], a[188:191], v[164:167]
 global_load_dwordx4 a[204:207], v0, s[70:71] offset:-1024
 v_and_b32 v5, s26, v5
 v_mfma_f32_16x16x32_bf16 v[160:163], a[212:215], a[180:183], v[160:163]
 v_mul_f32 v6, v6, v106
 v_mul_f32 v5, v5, v107
 v_mfma_f32_16x16x32_bf16 v[160:163], a[208:211], a[176:179], v[160:163]
 global_load_dwordx4 a[200:203], v0, s[70:71] offset:-2048
 v_cvt_pk_bf16_f32 v13, v6, v5
 v_mfma_f32_16x16x32_bf16 v[156:159], a[208:211], a[168:171], v[156:159]
 v_accvgpr_read_b32 v5, a58
 v_accvgpr_read_b32 v7, a240
 v_mfma_f32_16x16x32_bf16 v[156:159], a[212:215], a[172:175], v[156:159]
 v_lshlrev_b32 v6, 16, v5
 v_and_b32 v5, s26, v5
 v_mfma_f32_16x16x32_bf16 v[152:155], a[212:215], a[164:167], v[152:155]
 v_mul_f32 v6, v6, v7
 v_accvgpr_read_b32 v7, a241
 v_mfma_f32_16x16x32_bf16 v[152:155], a[208:211], a[160:163], v[152:155]
 v_mul_f32 v5, v5, v7
 v_cvt_pk_bf16_f32 v14, v6, v5
 s_waitcnt lgkmcnt(0)
 v_mfma_f32_16x16x32_bf16 v[148:151], a[208:211], a[152:155], v[148:151]
 v_accvgpr_read_b32 v5, a59
 v_accvgpr_read_b32 v7, a242
 v_mfma_f32_16x16x32_bf16 v[148:151], a[212:215], a[156:159], v[148:151]
 v_lshlrev_b32 v6, 16, v5
 v_and_b32 v5, s26, v5
 v_mfma_f32_16x16x32_bf16 v[144:147], a[212:215], a[148:151], v[144:147]
 v_mul_f32 v6, v6, v7
 v_accvgpr_read_b32 v7, a243
 v_mfma_f32_16x16x32_bf16 v[144:147], a[208:211], a[144:147], v[144:147]
 v_mul_f32 v5, v5, v7
 v_cvt_pk_bf16_f32 v15, v6, v5
 v_mfma_f32_16x16x32_bf16 v[140:143], a[208:211], a[136:139], v[140:143]
 ds_write_b128 v3, v[12:15] offset:25600
 v_mfma_f32_16x16x32_bf16 v[140:143], a[212:215], a[140:143], v[140:143]
 buffer_store_dwordx4 v[12:15], v3, s[32:35], s68 offen offset:1024 sc1
 v_accvgpr_read_b32 v5, a28
 v_lshlrev_b32 v6, 16, v5
 v_and_b32 v5, s26, v5
 v_mul_f32 v6, v6, v44
 v_mfma_f32_16x16x32_bf16 v[136:139], a[212:215], a[132:135], v[136:139]
 v_mul_f32 v5, v5, v45
 v_cvt_pk_bf16_f32 v8, v6, v5
 v_mfma_f32_16x16x32_bf16 v[136:139], a[208:211], a[128:131], v[136:139]
 v_accvgpr_read_b32 v5, a29
 v_lshlrev_b32 v6, 16, v5
 s_waitcnt vmcnt(14)
 v_mfma_f32_16x16x32_bf16 v[168:171], a[216:219], a[128:131], v[168:171]
 v_and_b32 v5, s26, v5
 v_mul_f32 v6, v6, v46
 v_mfma_f32_16x16x32_bf16 v[168:171], a[220:223], a[132:135], v[168:171]
 global_load_dwordx4 a[212:215], v0, s[70:71] offset:1024
 v_mul_f32 v5, v5, v47
 v_mfma_f32_16x16x32_bf16 v[172:175], a[220:223], a[140:143], v[172:175]
 v_cvt_pk_bf16_f32 v9, v6, v5
 v_accvgpr_read_b32 v5, a30
 v_mfma_f32_16x16x32_bf16 v[172:175], a[216:219], a[136:139], v[172:175]
 global_load_dwordx4 a[208:211], v0, s[70:71] offset:0
 v_lshlrev_b32 v6, 16, v5
 v_mfma_f32_16x16x32_bf16 v[176:179], a[216:219], a[144:147], v[176:179]
 v_and_b32 v5, s26, v5
 v_mul_f32 v6, v6, v76
 v_mfma_f32_16x16x32_bf16 v[176:179], a[220:223], a[148:151], v[176:179]
 v_mul_f32 v5, v5, v77
 v_cvt_pk_bf16_f32 v10, v6, v5
 v_mfma_f32_16x16x32_bf16 v[180:183], a[220:223], a[156:159], v[180:183]
 v_accvgpr_read_b32 v5, a31
 v_lshlrev_b32 v6, 16, v5
 v_mfma_f32_16x16x32_bf16 v[180:183], a[216:219], a[152:155], v[180:183]
 v_and_b32 v5, s26, v5
 v_mul_f32 v6, v6, v78
 v_mfma_f32_16x16x32_bf16 v[184:187], a[216:219], a[160:163], v[184:187]
 v_mul_f32 v5, v5, v79
 v_cvt_pk_bf16_f32 v11, v6, v5
 v_mfma_f32_16x16x32_bf16 v[184:187], a[220:223], a[164:167], v[184:187]
 ds_write_b128 v3, v[8:11] offset:28672
 v_mfma_f32_16x16x32_bf16 v[188:191], a[220:223], a[172:175], v[188:191]
 buffer_store_dwordx4 v[8:11], v3, s[32:35], s68 offen offset:2048 sc1
 v_accvgpr_read_b32 v5, a60
 v_lshlrev_b32 v6, 16, v5
 v_and_b32 v5, s26, v5
 v_mul_f32 v6, v6, v108
 v_mfma_f32_16x16x32_bf16 v[188:191], a[216:219], a[168:171], v[188:191]
 v_mul_f32 v5, v5, v109
 v_cvt_pk_bf16_f32 v12, v6, v5
 v_mfma_f32_16x16x32_bf16 v[192:195], a[216:219], a[176:179], v[192:195]
 v_accvgpr_read_b32 v5, a61
 v_lshlrev_b32 v6, 16, v5
 v_mfma_f32_16x16x32_bf16 v[192:195], a[220:223], a[180:183], v[192:195]
 v_and_b32 v5, s26, v5
 v_mul_f32 v6, v6, v110
 v_mfma_f32_16x16x32_bf16 v[196:199], a[220:223], a[188:191], v[196:199]
 v_mul_f32 v5, v5, v111
 v_cvt_pk_bf16_f32 v13, v6, v5
 v_mfma_f32_16x16x32_bf16 v[196:199], a[216:219], a[184:187], v[196:199]
 v_accvgpr_read_b32 v5, a62
 v_accvgpr_read_b32 v7, a244
 s_waitcnt vmcnt(13)
 v_mfma_f32_16x16x32_bf16 v[228:231], a[224:227], a[184:187], v[228:231]
 v_lshlrev_b32 v6, 16, v5
 v_and_b32 v5, s26, v5
 v_mfma_f32_16x16x32_bf16 v[228:231], a[228:231], a[188:191], v[228:231]
 global_load_dwordx4 a[220:223], v0, s[70:71] offset:3072
 v_mul_f32 v6, v6, v7
 v_mfma_f32_16x16x32_bf16 v[224:227], a[228:231], a[180:183], v[224:227]
 v_accvgpr_read_b32 v7, a245
 v_mul_f32 v5, v5, v7
 v_mfma_f32_16x16x32_bf16 v[224:227], a[224:227], a[176:179], v[224:227]
 global_load_dwordx4 a[216:219], v0, s[70:71] offset:2048
 v_cvt_pk_bf16_f32 v14, v6, v5
 v_mfma_f32_16x16x32_bf16 v[220:223], a[224:227], a[168:171], v[220:223]
 v_accvgpr_read_b32 v5, a63
 v_accvgpr_read_b32 v7, a246
 s_add_u32 s70, s70, 8192
 s_addc_u32 s71, s71, 0
 v_mfma_f32_16x16x32_bf16 v[220:223], a[228:231], a[172:175], v[220:223]
 v_lshlrev_b32 v6, 16, v5
 v_and_b32 v5, s26, v5
 v_mfma_f32_16x16x32_bf16 v[216:219], a[228:231], a[164:167], v[216:219]
 v_mul_f32 v6, v6, v7
 v_accvgpr_read_b32 v7, a247
 v_mfma_f32_16x16x32_bf16 v[216:219], a[224:227], a[160:163], v[216:219]
 v_mul_f32 v5, v5, v7
 v_cvt_pk_bf16_f32 v15, v6, v5
 v_mfma_f32_16x16x32_bf16 v[212:215], a[224:227], a[152:155], v[212:215]
 ds_write_b128 v3, v[12:15] offset:29696
 v_mfma_f32_16x16x32_bf16 v[212:215], a[228:231], a[156:159], v[212:215]
 buffer_store_dwordx4 v[12:15], v3, s[32:35], s68 offen offset:3072 sc1
 v_mfma_f32_16x16x32_bf16 v[208:211], a[228:231], a[148:151], v[208:211]
 s_waitcnt lgkmcnt(0)
 s_barrier
 v_mfma_f32_16x16x32_bf16 v[208:211], a[224:227], a[144:147], v[208:211]
 v_mfma_f32_16x16x32_bf16 v[204:207], a[224:227], a[136:139], v[204:207]
 v_mfma_f32_16x16x32_bf16 v[204:207], a[228:231], a[140:143], v[204:207]
 v_mfma_f32_16x16x32_bf16 v[200:203], a[228:231], a[132:135], v[200:203]
 v_mfma_f32_16x16x32_bf16 v[200:203], a[224:227], a[128:131], v[200:203]
 s_waitcnt vmcnt(13)
 v_mfma_f32_16x16x32_bf16 v[232:235], a[232:235], a[128:131], v[232:235]
 ds_read_b128 a[128:131], v1
 v_mfma_f32_16x16x32_bf16 v[232:235], a[236:239], a[132:135], v[232:235]
 global_load_dwordx4 a[228:231], v0, s[70:71] offset:-3072
 ds_read_b128 a[132:135], v1 offset:1024
 v_mfma_f32_16x16x32_bf16 v[236:239], a[236:239], a[140:143], v[236:239]
 ds_read_b128 a[140:143], v1 offset:5120
 v_mfma_f32_16x16x32_bf16 v[236:239], a[232:235], a[136:139], v[236:239]
 global_load_dwordx4 a[224:227], v0, s[70:71] offset:-4096
 ds_read_b128 a[136:139], v1 offset:4096
 v_mfma_f32_16x16x32_bf16 v[240:243], a[232:235], a[144:147], v[240:243]
 ds_read_b128 a[144:147], v1 offset:8192
 v_mfma_f32_16x16x32_bf16 v[240:243], a[236:239], a[148:151], v[240:243]
 ds_read_b128 a[148:151], v1 offset:9216
 v_mfma_f32_16x16x32_bf16 v[244:247], a[236:239], a[156:159], v[244:247]
 ds_read_b128 a[156:159], v1 offset:13312
 v_mfma_f32_16x16x32_bf16 v[244:247], a[232:235], a[152:155], v[244:247]
 ds_read_b128 a[152:155], v1 offset:12288
 v_mfma_f32_16x16x32_bf16 v[248:251], a[232:235], a[160:163], v[248:251]
 ds_read_b128 a[160:163], v1 offset:16384
 v_mfma_f32_16x16x32_bf16 v[248:251], a[236:239], a[164:167], v[248:251]
 ds_read_b128 a[164:167], v1 offset:17408
 v_mfma_f32_16x16x32_bf16 v[252:255], a[236:239], a[172:175], v[252:255]
 ds_read_b128 a[172:175], v1 offset:21504
 v_mfma_f32_16x16x32_bf16 v[252:255], a[232:235], a[168:171], v[252:255]
 ds_read_b128 a[168:171], v1 offset:20480
 v_mfma_f32_16x16x32_bf16 a[248:251], a[232:235], a[176:179], a[248:251]
 ds_read_b128 a[176:179], v1 offset:24576
 v_mfma_f32_16x16x32_bf16 a[248:251], a[236:239], a[180:183], a[248:251]
 ds_read_b128 a[180:183], v1 offset:25600
 v_mfma_f32_16x16x32_bf16 a[252:255], a[236:239], a[188:191], a[252:255]
 global_load_dwordx4 a[236:239], v0, s[70:71] offset:-1024
 ds_read_b128 a[188:191], v1 offset:29696
 v_mfma_f32_16x16x32_bf16 a[252:255], a[232:235], a[184:187], a[252:255]
 global_load_dwordx4 a[232:235], v0, s[70:71] offset:-2048
 ds_read_b128 a[184:187], v1 offset:28672
 s_waitcnt vmcnt(14) lgkmcnt(8)
 v_mfma_f32_16x16x32_bf16 v[16:19], a[192:195], a[128:131], v[16:19]
 v_accvgpr_read_b32 v5, a64
 v_lshlrev_b32 v6, 16, v5
 v_mfma_f32_16x16x32_bf16 v[16:19], a[196:199], a[132:135], v[16:19]
 v_and_b32 v5, s26, v5
 v_mfma_f32_16x16x32_bf16 v[20:23], a[196:199], a[140:143], v[20:23]
 v_mul_f32 v6, v6, v136
 v_mul_f32 v5, v5, v137
 v_mfma_f32_16x16x32_bf16 v[20:23], a[192:195], a[136:139], v[20:23]
 v_cvt_pk_bf16_f32 v8, v6, v5
 v_accvgpr_read_b32 v5, a65
 v_mfma_f32_16x16x32_bf16 v[24:27], a[192:195], a[144:147], v[24:27]
 v_lshlrev_b32 v6, 16, v5
 v_mfma_f32_16x16x32_bf16 v[24:27], a[196:199], a[148:151], v[24:27]
 v_and_b32 v5, s26, v5
 v_mul_f32 v6, v6, v138
 v_mfma_f32_16x16x32_bf16 v[28:31], a[196:199], a[156:159], v[28:31]
 v_mul_f32 v5, v5, v139
 v_cvt_pk_bf16_f32 v9, v6, v5
 v_mfma_f32_16x16x32_bf16 v[28:31], a[192:195], a[152:155], v[28:31]
 v_accvgpr_read_b32 v5, a66
 v_lshlrev_b32 v6, 16, v5
 s_waitcnt lgkmcnt(0)
 v_mfma_f32_16x16x32_bf16 v[32:35], a[192:195], a[160:163], v[32:35]
 v_and_b32 v5, s26, v5
 v_mul_f32 v6, v6, v168
 v_mfma_f32_16x16x32_bf16 v[32:35], a[196:199], a[164:167], v[32:35]
 v_mul_f32 v5, v5, v169
 v_cvt_pk_bf16_f32 v10, v6, v5
 v_mfma_f32_16x16x32_bf16 v[36:39], a[196:199], a[172:175], v[36:39]
 v_accvgpr_read_b32 v5, a67
 v_lshlrev_b32 v6, 16, v5
 v_mfma_f32_16x16x32_bf16 v[36:39], a[192:195], a[168:171], v[36:39]
 v_and_b32 v5, s26, v5
 v_mul_f32 v6, v6, v170
 v_mfma_f32_16x16x32_bf16 v[40:43], a[192:195], a[176:179], v[40:43]
 v_mul_f32 v5, v5, v171
 v_cvt_pk_bf16_f32 v11, v6, v5
 v_mfma_f32_16x16x32_bf16 v[40:43], a[196:199], a[180:183], v[40:43]
 ds_write_b128 v3, v[8:11] offset:2048
 v_mfma_f32_16x16x32_bf16 v[44:47], a[196:199], a[188:191], v[44:47]
 s_add_u32 s68, s29, 16384
 buffer_store_dwordx4 v[8:11], v3, s[32:35], s68 offen sc1
 v_mfma_f32_16x16x32_bf16 v[44:47], a[192:195], a[184:187], v[44:47]
 v_accvgpr_read_b32 v5, a96
 s_waitcnt vmcnt(12)
 v_mfma_f32_16x16x32_bf16 v[76:79], a[200:203], a[184:187], v[76:79]
 v_lshlrev_b32 v6, 16, v5
 v_mfma_f32_16x16x32_bf16 v[76:79], a[204:207], a[188:191], v[76:79]
 global_load_dwordx4 a[196:199], v0, s[70:71] offset:1024
 v_and_b32 v5, s26, v5
 v_mfma_f32_16x16x32_bf16 v[72:75], a[204:207], a[180:183], v[72:75]
 v_mul_f32 v6, v6, v200
 v_mul_f32 v5, v5, v201
 v_mfma_f32_16x16x32_bf16 v[72:75], a[200:203], a[176:179], v[72:75]
 global_load_dwordx4 a[192:195], v0, s[70:71] offset:0
 v_cvt_pk_bf16_f32 v12, v6, v5
 v_mfma_f32_16x16x32_bf16 v[68:71], a[200:203], a[168:171], v[68:71]
 v_accvgpr_read_b32 v5, a97
 v_lshlrev_b32 v6, 16, v5
 v_mfma_f32_16x16x32_bf16 v[68:71], a[204:207], a[172:175], v[68:71]
 v_and_b32 v5, s26, v5
 v_mul_f32 v6, v6, v202
 v_mfma_f32_16x16x32_bf16 v[64:67], a[204:207], a[164:167], v[64:67]
 v_mul_f32 v5, v5, v203
 v_cvt_pk_bf16_f32 v13, v6, v5
 v_mfma_f32_16x16x32_bf16 v[64:67], a[200:203], a[160:163], v[64:67]
 v_accvgpr_read_b32 v5, a98
 v_lshlrev_b32 v6, 16, v5
 v_mfma_f32_16x16x32_bf16 v[60:63], a[200:203], a[152:155], v[60:63]
 v_and_b32 v5, s26, v5
 v_mul_f32 v6, v6, v232
 v_mfma_f32_16x16x32_bf16 v[60:63], a[204:207], a[156:159], v[60:63]
 v_mul_f32 v5, v5, v233
 v_cvt_pk_bf16_f32 v14, v6, v5
 v_mfma_f32_16x16x32_bf16 v[56:59], a[204:207], a[148:151], v[56:59]
 v_accvgpr_read_b32 v5, a99
 v_lshlrev_b32 v6, 16, v5
 v_mfma_f32_16x16x32_bf16 v[56:59], a[200:203], a[144:147], v[56:59]
 v_and_b32 v5, s26, v5
 v_mul_f32 v6, v6, v234
 v_mfma_f32_16x16x32_bf16 v[52:55], a[200:203], a[136:139], v[52:55]
 v_mul_f32 v5, v5, v235
 v_cvt_pk_bf16_f32 v15, v6, v5
 v_mfma_f32_16x16x32_bf16 v[52:55], a[204:207], a[140:143], v[52:55]
 ds_write_b128 v3, v[12:15] offset:3072
 v_mfma_f32_16x16x32_bf16 v[48:51], a[204:207], a[132:135], v[48:51]
 buffer_store_dwordx4 v[12:15], v3, s[32:35], s68 offen offset:1024 sc1
 v_mfma_f32_16x16x32_bf16 v[48:51], a[200:203], a[128:131], v[48:51]
 v_accvgpr_read_b32 v5, a68
 v_lshlrev_b32 v6, 16, v5
 s_waitcnt vmcnt(12)
 v_mfma_f32_16x16x32_bf16 v[80:83], a[208:211], a[128:131], v[80:83]
 v_and_b32 v5, s26, v5
 v_mul_f32 v6, v6, v140
 v_mfma_f32_16x16x32_bf16 v[80:83], a[212:215], a[132:135], v[80:83]
 global_load_dwordx4 a[204:207], v0, s[70:71] offset:3072
 v_mul_f32 v5, v5, v141
 v_mfma_f32_16x16x32_bf16 v[84:87], a[212:215], a[140:143], v[84:87]
 v_cvt_pk_bf16_f32 v8, v6, v5
 v_accvgpr_read_b32 v5, a69
 v_mfma_f32_16x16x32_bf16 v[84:87], a[208:211], a[136:139], v[84:87]
 global_load_dwordx4 a[200:203], v0, s[70:71] offset:2048
 v_lshlrev_b32 v6, 16, v5
 v_mfma_f32_16x16x32_bf16 v[88:91], a[208:211], a[144:147], v[88:91]
 v_and_b32 v5, s26, v5
 v_mul_f32 v6, v6, v142
 s_add_u32 s70, s70, 8192
 s_addc_u32 s71, s71, 0
 v_mfma_f32_16x16x32_bf16 v[88:91], a[212:215], a[148:151], v[88:91]
 v_mul_f32 v5, v5, v143
 v_cvt_pk_bf16_f32 v9, v6, v5
 v_mfma_f32_16x16x32_bf16 v[92:95], a[212:215], a[156:159], v[92:95]
 v_accvgpr_read_b32 v5, a70
 v_lshlrev_b32 v6, 16, v5
 v_mfma_f32_16x16x32_bf16 v[92:95], a[208:211], a[152:155], v[92:95]
 v_and_b32 v5, s26, v5
 v_mul_f32 v6, v6, v172
 v_mfma_f32_16x16x32_bf16 v[96:99], a[208:211], a[160:163], v[96:99]
 v_mul_f32 v5, v5, v173
 v_cvt_pk_bf16_f32 v10, v6, v5
 v_mfma_f32_16x16x32_bf16 v[96:99], a[212:215], a[164:167], v[96:99]
 v_accvgpr_read_b32 v5, a71
 v_lshlrev_b32 v6, 16, v5
 v_mfma_f32_16x16x32_bf16 v[100:103], a[212:215], a[172:175], v[100:103]
 v_and_b32 v5, s26, v5
 v_mul_f32 v6, v6, v174
 v_mfma_f32_16x16x32_bf16 v[100:103], a[208:211], a[168:171], v[100:103]
 v_mul_f32 v5, v5, v175
 v_cvt_pk_bf16_f32 v11, v6, v5
 v_mfma_f32_16x16x32_bf16 v[104:107], a[208:211], a[176:179], v[104:107]
 ds_write_b128 v3, v[8:11] offset:6144
 v_mfma_f32_16x16x32_bf16 v[104:107], a[212:215], a[180:183], v[104:107]
 buffer_store_dwordx4 v[8:11], v3, s[32:35], s68 offen offset:2048 sc1
 v_accvgpr_read_b32 v5, a100
 v_lshlrev_b32 v6, 16, v5
 v_and_b32 v5, s26, v5
 v_mul_f32 v6, v6, v204
 v_mfma_f32_16x16x32_bf16 v[108:111], a[212:215], a[188:191], v[108:111]
 v_mul_f32 v5, v5, v205
 v_cvt_pk_bf16_f32 v12, v6, v5
 v_mfma_f32_16x16x32_bf16 v[108:111], a[208:211], a[184:187], v[108:111]
 v_accvgpr_read_b32 v5, a101
 v_lshlrev_b32 v6, 16, v5
 s_waitcnt vmcnt(12)
 v_mfma_f32_16x16x32_bf16 a[244:247], a[216:219], a[184:187], a[244:247]
 ds_read_b128 a[184:187], v1 offset:61440
 v_and_b32 v5, s26, v5
 v_mfma_f32_16x16x32_bf16 a[244:247], a[220:223], a[188:191], a[244:247]
 global_load_dwordx4 a[212:215], v0, s[70:71] offset:-3072
 ds_read_b128 a[188:191], v1 offset:62464
 v_mfma_f32_16x16x32_bf16 a[240:243], a[220:223], a[180:183], a[240:243]
 ds_read_b128 a[180:183], v1 offset:58368
 v_mul_f32 v6, v6, v206
 v_mfma_f32_16x16x32_bf16 a[240:243], a[216:219], a[176:179], a[240:243]
 global_load_dwordx4 a[208:211], v0, s[70:71] offset:-4096
 ds_read_b128 a[176:179], v1 offset:57344
 v_mfma_f32_16x16x32_bf16 v[132:135], a[216:219], a[168:171], v[132:135]
 ds_read_b128 a[168:171], v1 offset:53248
 v_mul_f32 v5, v5, v207
 v_mfma_f32_16x16x32_bf16 v[132:135], a[220:223], a[172:175], v[132:135]
 ds_read_b128 a[172:175], v1 offset:54272
 v_cvt_pk_bf16_f32 v13, v6, v5
 v_mfma_f32_16x16x32_bf16 v[128:131], a[220:223], a[164:167], v[128:131]
 ds_read_b128 a[164:167], v1 offset:50176
 v_accvgpr_read_b32 v5, a102
 v_lshlrev_b32 v6, 16, v5
 v_mfma_f32_16x16x32_bf16 v[128:131], a[216:219], a[160:163], v[128:131]
 ds_read_b128 a[160:163], v1 offset:49152
 v_and_b32 v5, s26, v5
 v_mul_f32 v6, v6, v236
 v_mfma_f32_16x16x32_bf16 v[124:127], a[216:219], a[152:155], v[124:127]
 ds_read_b128 a[152:155], v1 offset:45056
 v_mul_f32 v5, v5, v237
 v_mfma_f32_16x16x32_bf16 v[124:127], a[220:223], a[156:159], v[124:127]
 ds_read_b128 a[156:159], v1 offset:46080
 v_cvt_pk_bf16_f32 v14, v6, v5
 v_mfma_f32_16x16x32_bf16 v[120:123], a[220:223], a[148:151], v[120:123]
 ds_read_b128 a[148:151], v1 offset:41984
 v_accvgpr_read_b32 v5, a103
 v_mfma_f32_16x16x32_bf16 v[120:123], a[216:219], a[144:147], v[120:123]
 ds_read_b128 a[144:147], v1 offset:40960
 v_lshlrev_b32 v6, 16, v5
 v_mfma_f32_16x16x32_bf16 v[116:119], a[216:219], a[136:139], v[116:119]
 ds_read_b128 a[136:139], v1 offset:36864
 v_and_b32 v5, s26, v5
 v_mfma_f32_16x16x32_bf16 v[116:119], a[220:223], a[140:143], v[116:119]
 ds_read_b128 a[140:143], v1 offset:37888
 v_mul_f32 v6, v6, v238
 v_mfma_f32_16x16x32_bf16 v[112:115], a[220:223], a[132:135], v[112:115]
 ds_read_b128 a[132:135], v1 offset:33792
 v_mul_f32 v5, v5, v239
 v_mfma_f32_16x16x32_bf16 v[112:115], a[216:219], a[128:131], v[112:115]
 ds_read_b128 a[128:131], v1 offset:32768
 v_cvt_pk_bf16_f32 v15, v6, v5
 s_waitcnt vmcnt(11) lgkmcnt(8)
 v_mfma_f32_16x16x32_bf16 v[44:47], a[224:227], a[184:187], v[44:47]
 ds_write_b128 v3, v[12:15] offset:7168
 v_mfma_f32_16x16x32_bf16 v[44:47], a[228:231], a[188:191], v[44:47]
 buffer_store_dwordx4 v[12:15], v3, s[32:35], s68 offen offset:3072 sc1
 global_load_dwordx4 a[220:223], v0, s[70:71] offset:-1024
 v_accvgpr_read_b32 v5, a72
 v_lshlrev_b32 v6, 16, v5
 v_and_b32 v5, s26, v5
 v_mfma_f32_16x16x32_bf16 v[40:43], a[228:231], a[180:183], v[40:43]
 v_mul_f32 v6, v6, v144
 v_mul_f32 v5, v5, v145
 v_mfma_f32_16x16x32_bf16 v[40:43], a[224:227], a[176:179], v[40:43]
 global_load_dwordx4 a[216:219], v0, s[70:71] offset:-2048
 v_cvt_pk_bf16_f32 v8, v6, v5
 v_mfma_f32_16x16x32_bf16 v[36:39], a[224:227], a[168:171], v[36:39]
 v_accvgpr_read_b32 v5, a73
 v_lshlrev_b32 v6, 16, v5
 v_mfma_f32_16x16x32_bf16 v[36:39], a[228:231], a[172:175], v[36:39]
 v_and_b32 v5, s26, v5
 v_mul_f32 v6, v6, v146
 v_mfma_f32_16x16x32_bf16 v[32:35], a[228:231], a[164:167], v[32:35]
 v_mul_f32 v5, v5, v147
 v_cvt_pk_bf16_f32 v9, v6, v5
 v_mfma_f32_16x16x32_bf16 v[32:35], a[224:227], a[160:163], v[32:35]
 v_accvgpr_read_b32 v5, a74
 v_lshlrev_b32 v6, 16, v5
 s_waitcnt lgkmcnt(1)
 v_mfma_f32_16x16x32_bf16 v[28:31], a[224:227], a[152:155], v[28:31]
 v_and_b32 v5, s26, v5
 v_mul_f32 v6, v6, v176
 v_mfma_f32_16x16x32_bf16 v[28:31], a[228:231], a[156:159], v[28:31]
 v_mul_f32 v5, v5, v177
 v_cvt_pk_bf16_f32 v10, v6, v5
 v_mfma_f32_16x16x32_bf16 v[24:27], a[228:231], a[148:151], v[24:27]
 v_accvgpr_read_b32 v5, a75
 v_lshlrev_b32 v6, 16, v5
 v_mfma_f32_16x16x32_bf16 v[24:27], a[224:227], a[144:147], v[24:27]
 v_and_b32 v5, s26, v5
 v_mul_f32 v6, v6, v178
 v_mfma_f32_16x16x32_bf16 v[20:23], a[224:227], a[136:139], v[20:23]
 v_mul_f32 v5, v5, v179
 v_cvt_pk_bf16_f32 v11, v6, v5
 v_mfma_f32_16x16x32_bf16 v[20:23], a[228:231], a[140:143], v[20:23]
 ds_write_b128 v3, v[8:11] offset:10240
 s_add_u32 s68, s29, 20480
 v_mfma_f32_16x16x32_bf16 v[16:19], a[228:231], a[132:135], v[16:19]
 buffer_store_dwordx4 v[8:11], v3, s[32:35], s68 offen sc1
 v_accvgpr_read_b32 v5, a104
 v_lshlrev_b32 v6, 16, v5
 v_mfma_f32_16x16x32_bf16 v[16:19], a[224:227], a[128:131], v[16:19]
 v_and_b32 v5, s26, v5
 v_mul_f32 v6, v6, v208
 s_waitcnt vmcnt(13)
 v_mfma_f32_16x16x32_bf16 v[48:51], a[232:235], a[128:131], v[48:51]
 v_mul_f32 v5, v5, v209
 v_cvt_pk_bf16_f32 v12, v6, v5
 v_mfma_f32_16x16x32_bf16 v[48:51], a[236:239], a[132:135], v[48:51]
 global_load_dwordx4 a[228:231], v0, s[70:71] offset:1024
 v_accvgpr_read_b32 v5, a105
 v_mfma_f32_16x16x32_bf16 v[52:55], a[236:239], a[140:143], v[52:55]
 v_lshlrev_b32 v6, 16, v5
 v_and_b32 v5, s26, v5
 v_mfma_f32_16x16x32_bf16 v[52:55], a[232:235], a[136:139], v[52:55]
 global_load_dwordx4 a[224:227], v0, s[70:71] offset:0
 v_mul_f32 v6, v6, v210
 v_mfma_f32_16x16x32_bf16 v[56:59], a[232:235], a[144:147], v[56:59]
 v_mul_f32 v5, v5, v211
 v_cvt_pk_bf16_f32 v13, v6, v5
 v_mfma_f32_16x16x32_bf16 v[56:59], a[236:239], a[148:151], v[56:59]
 v_accvgpr_read_b32 v5, a106
 v_lshlrev_b32 v6, 16, v5
 v_mfma_f32_16x16x32_bf16 v[60:63], a[236:239], a[156:159], v[60:63]
 v_and_b32 v5, s26, v5
 v_mfma_f32_16x16x32_bf16 v[60:63], a[232:235], a[152:155], v[60:63]
 v_mul_f32 v6, v6, v240
 v_mul_f32 v5, v5, v241
 v_mfma_f32_16x16x32_bf16 v[64:67], a[232:235], a[160:163], v[64:67]
 v_cvt_pk_bf16_f32 v14, v6, v5
 v_accvgpr_read_b32 v5, a107
 v_mfma_f32_16x16x32_bf16 v[64:67], a[236:239], a[164:167], v[64:67]
 v_lshlrev_b32 v6, 16, v5
 v_mfma_f32_16x16x32_bf16 v[68:71], a[236:239], a[172:175], v[68:71]
 v_and_b32 v5, s26, v5
 v_mul_f32 v6, v6, v242
 v_mfma_f32_16x16x32_bf16 v[68:71], a[232:235], a[168:171], v[68:71]
 v_mul_f32 v5, v5, v243
 v_cvt_pk_bf16_f32 v15, v6, v5
 v_mfma_f32_16x16x32_bf16 v[72:75], a[232:235], a[176:179], v[72:75]
 ds_write_b128 v3, v[12:15] offset:11264
 v_mfma_f32_16x16x32_bf16 v[72:75], a[236:239], a[180:183], v[72:75]
 buffer_store_dwordx4 v[12:15], v3, s[32:35], s68 offen offset:1024 sc1
 v_accvgpr_read_b32 v5, a76
 v_lshlrev_b32 v6, 16, v5
 v_mfma_f32_16x16x32_bf16 v[76:79], a[236:239], a[188:191], v[76:79]
 v_and_b32 v5, s26, v5
 v_mul_f32 v6, v6, v148
 v_mfma_f32_16x16x32_bf16 v[76:79], a[232:235], a[184:187], v[76:79]
 v_mul_f32 v5, v5, v149
 v_cvt_pk_bf16_f32 v8, v6, v5
 s_waitcnt vmcnt(13)
 v_mfma_f32_16x16x32_bf16 v[108:111], a[192:195], a[184:187], v[108:111]
 v_accvgpr_read_b32 v5, a77
 v_lshlrev_b32 v6, 16, v5
 v_mfma_f32_16x16x32_bf16 v[108:111], a[196:199], a[188:191], v[108:111]
 global_load_dwordx4 a[236:239], v0, s[70:71] offset:3072
 v_and_b32 v5, s26, v5
 v_mfma_f32_16x16x32_bf16 v[104:107], a[196:199], a[180:183], v[104:107]
 v_mul_f32 v6, v6, v150
 v_mul_f32 v5, v5, v151
 v_mfma_f32_16x16x32_bf16 v[104:107], a[192:195], a[176:179], v[104:107]
 global_load_dwordx4 a[232:235], v0, s[70:71] offset:2048
 v_cvt_pk_bf16_f32 v9, v6, v5
 v_mfma_f32_16x16x32_bf16 v[100:103], a[192:195], a[168:171], v[100:103]
 v_accvgpr_read_b32 v5, a78
 v_lshlrev_b32 v6, 16, v5
 s_add_u32 s70, s70, 8192
 s_addc_u32 s71, s71, 0
 v_mfma_f32_16x16x32_bf16 v[100:103], a[196:199], a[172:175], v[100:103]
 v_and_b32 v5, s26, v5
 v_mul_f32 v6, v6, v180
 v_mfma_f32_16x16x32_bf16 v[96:99], a[196:199], a[164:167], v[96:99]
 v_mul_f32 v5, v5, v181
 v_cvt_pk_bf16_f32 v10, v6, v5
 v_mfma_f32_16x16x32_bf16 v[96:99], a[192:195], a[160:163], v[96:99]
 v_accvgpr_read_b32 v5, a79
 v_lshlrev_b32 v6, 16, v5
 v_mfma_f32_16x16x32_bf16 v[92:95], a[192:195], a[152:155], v[92:95]
 v_and_b32 v5, s26, v5
 v_mul_f32 v6, v6, v182
 v_mfma_f32_16x16x32_bf16 v[92:95], a[196:199], a[156:159], v[92:95]
 v_mul_f32 v5, v5, v183
 v_cvt_pk_bf16_f32 v11, v6, v5
 v_mfma_f32_16x16x32_bf16 v[88:91], a[196:199], a[148:151], v[88:91]
 ds_write_b128 v3, v[8:11] offset:14336
 v_mfma_f32_16x16x32_bf16 v[88:91], a[192:195], a[144:147], v[88:91]
 buffer_store_dwordx4 v[8:11], v3, s[32:35], s68 offen offset:2048 sc1
 v_accvgpr_read_b32 v5, a108
 v_lshlrev_b32 v6, 16, v5
 v_and_b32 v5, s26, v5
 v_mul_f32 v6, v6, v212
 v_mfma_f32_16x16x32_bf16 v[84:87], a[192:195], a[136:139], v[84:87]
 v_mul_f32 v5, v5, v213
 v_cvt_pk_bf16_f32 v12, v6, v5
 v_mfma_f32_16x16x32_bf16 v[84:87], a[196:199], a[140:143], v[84:87]
 v_accvgpr_read_b32 v5, a109
 v_lshlrev_b32 v6, 16, v5
 v_mfma_f32_16x16x32_bf16 v[80:83], a[196:199], a[132:135], v[80:83]
 v_and_b32 v5, s26, v5
 v_mul_f32 v6, v6, v214
 v_mfma_f32_16x16x32_bf16 v[80:83], a[192:195], a[128:131], v[80:83]
 v_mul_f32 v5, v5, v215
 v_cvt_pk_bf16_f32 v13, v6, v5
 s_waitcnt vmcnt(13)
 v_mfma_f32_16x16x32_bf16 v[112:115], a[200:203], a[128:131], v[112:115]
 ds_read_b128 a[128:131], v2
 v_accvgpr_read_b32 v5, a110
 v_mfma_f32_16x16x32_bf16 v[112:115], a[204:207], a[132:135], v[112:115]
 global_load_dwordx4 a[196:199], v0, s[70:71] offset:-3072
 ds_read_b128 a[132:135], v2 offset:1024
 v_mfma_f32_16x16x32_bf16 v[116:119], a[204:207], a[140:143], v[116:119]
 ds_read_b128 a[140:143], v2 offset:5120
 v_lshlrev_b32 v6, 16, v5
 v_mfma_f32_16x16x32_bf16 v[116:119], a[200:203], a[136:139], v[116:119]
 global_load_dwordx4 a[192:195], v0, s[70:71] offset:-4096
 ds_read_b128 a[136:139], v2 offset:4096
 v_mfma_f32_16x16x32_bf16 v[120:123], a[200:203], a[144:147], v[120:123]
 ds_read_b128 a[144:147], v2 offset:8192
 v_and_b32 v5, s26, v5
 v_mfma_f32_16x16x32_bf16 v[120:123], a[204:207], a[148:151], v[120:123]
 ds_read_b128 a[148:151], v2 offset:9216
 v_mul_f32 v6, v6, v244
 v_mfma_f32_16x16x32_bf16 v[124:127], a[204:207], a[156:159], v[124:127]
 ds_read_b128 a[156:159], v2 offset:13312
 v_mul_f32 v5, v5, v245
 v_cvt_pk_bf16_f32 v14, v6, v5
 v_mfma_f32_16x16x32_bf16 v[124:127], a[200:203], a[152:155], v[124:127]
 ds_read_b128 a[152:155], v2 offset:12288
 v_accvgpr_read_b32 v5, a111
 v_mfma_f32_16x16x32_bf16 v[128:131], a[200:203], a[160:163], v[128:131]
 ds_read_b128 a[160:163], v2 offset:16384
 v_lshlrev_b32 v6, 16, v5
 v_mfma_f32_16x16x32_bf16 v[128:131], a[204:207], a[164:167], v[128:131]
 ds_read_b128 a[164:167], v2 offset:17408
 v_and_b32 v5, s26, v5
 v_mfma_f32_16x16x32_bf16 v[132:135], a[204:207], a[172:175], v[132:135]
 ds_read_b128 a[172:175], v2 offset:21504
 v_mul_f32 v6, v6, v246
 v_mfma_f32_16x16x32_bf16 v[132:135], a[200:203], a[168:171], v[132:135]
 ds_read_b128 a[168:171], v2 offset:20480
 v_mul_f32 v5, v5, v247
 v_mfma_f32_16x16x32_bf16 a[240:243], a[200:203], a[176:179], a[240:243]
 ds_read_b128 a[176:179], v2 offset:24576
 v_cvt_pk_bf16_f32 v15, v6, v5
 v_mfma_f32_16x16x32_bf16 a[240:243], a[204:207], a[180:183], a[240:243]
 ds_read_b128 a[180:183], v2 offset:25600
 ds_write_b128 v3, v[12:15] offset:15360
 s_add_u32 s31, s31, 1
 v_mov_b32 v7, s31
 v_mfma_f32_16x16x32_bf16 a[244:247], a[204:207], a[188:191], a[244:247]
 buffer_store_dword v7, v1, s[60:63], 0 offen sc1
 ds_read_b128 a[188:191], v2 offset:29696
 v_mfma_f32_16x16x32_bf16 a[244:247], a[200:203], a[184:187], a[244:247]
 buffer_store_dwordx4 v[12:15], v3, s[32:35], s68 offen offset:3072 sc1
 ds_read_b128 a[184:187], v2 offset:28672
 v_accvgpr_read_b32 v5, a80
 v_lshlrev_b32 v6, 16, v5
 v_and_b32 v5, s26, v5
 s_waitcnt vmcnt(14) lgkmcnt(9)
 v_mfma_f32_16x16x32_bf16 v[16:19], a[208:211], a[128:131], v[16:19]
 v_mul_f32 v6, v6, v152
 v_mul_f32 v5, v5, v153
 v_mfma_f32_16x16x32_bf16 v[16:19], a[212:215], a[132:135], v[16:19]
 global_load_dwordx4 a[204:207], v0, s[70:71] offset:-1024
 v_cvt_pk_bf16_f32 v8, v6, v5
 v_mfma_f32_16x16x32_bf16 v[20:23], a[212:215], a[140:143], v[20:23]
 v_accvgpr_read_b32 v5, a81
 v_lshlrev_b32 v6, 16, v5
 v_mfma_f32_16x16x32_bf16 v[20:23], a[208:211], a[136:139], v[20:23]
 global_load_dwordx4 a[200:203], v0, s[70:71] offset:-2048
 v_and_b32 v5, s26, v5
 v_mfma_f32_16x16x32_bf16 v[24:27], a[208:211], a[144:147], v[24:27]
 v_mul_f32 v6, v6, v154
 v_mul_f32 v5, v5, v155
 v_mfma_f32_16x16x32_bf16 v[24:27], a[212:215], a[148:151], v[24:27]
 v_cvt_pk_bf16_f32 v9, v6, v5
 v_accvgpr_read_b32 v5, a82
 v_mfma_f32_16x16x32_bf16 v[28:31], a[212:215], a[156:159], v[28:31]
 v_lshlrev_b32 v6, 16, v5
 v_and_b32 v5, s26, v5
 v_mfma_f32_16x16x32_bf16 v[28:31], a[208:211], a[152:155], v[28:31]
 v_mul_f32 v6, v6, v184
 s_waitcnt lgkmcnt(0)
 v_mfma_f32_16x16x32_bf16 v[32:35], a[208:211], a[160:163], v[32:35]
 v_mul_f32 v5, v5, v185
 v_cvt_pk_bf16_f32 v10, v6, v5
 v_mfma_f32_16x16x32_bf16 v[32:35], a[212:215], a[164:167], v[32:35]
 v_accvgpr_read_b32 v5, a83
 v_lshlrev_b32 v6, 16, v5
 v_mfma_f32_16x16x32_bf16 v[36:39], a[212:215], a[172:175], v[36:39]
 v_and_b32 v5, s26, v5
 v_mul_f32 v6, v6, v186
 v_mfma_f32_16x16x32_bf16 v[36:39], a[208:211], a[168:171], v[36:39]
 v_mul_f32 v5, v5, v187
 v_cvt_pk_bf16_f32 v11, v6, v5
 v_mfma_f32_16x16x32_bf16 v[40:43], a[208:211], a[176:179], v[40:43]
 ds_write_b128 v3, v[8:11] offset:18432
 v_mfma_f32_16x16x32_bf16 v[40:43], a[212:215], a[180:183], v[40:43]
 s_add_u32 s68, s29, 24576
 buffer_store_dwordx4 v[8:11], v3, s[32:35], s68 offen sc1
 v_mfma_f32_16x16x32_bf16 v[44:47], a[212:215], a[188:191], v[44:47]
 v_accvgpr_read_b32 v5, a112
 v_mfma_f32_16x16x32_bf16 v[44:47], a[208:211], a[184:187], v[44:47]
 v_lshlrev_b32 v6, 16, v5
 v_and_b32 v5, s26, v5
 s_waitcnt vmcnt(14)
 v_mfma_f32_16x16x32_bf16 v[76:79], a[216:219], a[184:187], v[76:79]
 v_mul_f32 v6, v6, v216
 v_mul_f32 v5, v5, v217
 v_mfma_f32_16x16x32_bf16 v[76:79], a[220:223], a[188:191], v[76:79]
 global_load_dwordx4 a[212:215], v0, s[70:71] offset:1024
 v_cvt_pk_bf16_f32 v12, v6, v5
 v_mfma_f32_16x16x32_bf16 v[72:75], a[220:223], a[180:183], v[72:75]
 v_accvgpr_read_b32 v5, a113
 v_lshlrev_b32 v6, 16, v5
 v_mfma_f32_16x16x32_bf16 v[72:75], a[216:219], a[176:179], v[72:75]
 global_load_dwordx4 a[208:211], v0, s[70:71] offset:0
 v_and_b32 v5, s26, v5
 v_mfma_f32_16x16x32_bf16 v[68:71], a[216:219], a[168:171], v[68:71]
 v_mul_f32 v6, v6, v218
 v_mul_f32 v5, v5, v219
 v_mfma_f32_16x16x32_bf16 v[68:71], a[220:223], a[172:175], v[68:71]
 v_cvt_pk_bf16_f32 v13, v6, v5
 v_accvgpr_read_b32 v5, a114
 v_mfma_f32_16x16x32_bf16 v[64:67], a[220:223], a[164:167], v[64:67]
 v_lshlrev_b32 v6, 16, v5
 v_and_b32 v5, s26, v5
 v_mfma_f32_16x16x32_bf16 v[64:67], a[216:219], a[160:163], v[64:67]
 v_mul_f32 v6, v6, v248
 v_mul_f32 v5, v5, v249
 v_mfma_f32_16x16x32_bf16 v[60:63], a[216:219], a[152:155], v[60:63]
 v_cvt_pk_bf16_f32 v14, v6, v5
 v_mfma_f32_16x16x32_bf16 v[60:63], a[220:223], a[156:159], v[60:63]
 v_accvgpr_read_b32 v5, a115
 v_lshlrev_b32 v6, 16, v5
 v_mfma_f32_16x16x32_bf16 v[56:59], a[220:223], a[148:151], v[56:59]
 v_and_b32 v5, s26, v5
 v_mul_f32 v6, v6, v250
 v_mfma_f32_16x16x32_bf16 v[56:59], a[216:219], a[144:147], v[56:59]
 v_mul_f32 v5, v5, v251
 v_cvt_pk_bf16_f32 v15, v6, v5
 v_mfma_f32_16x16x32_bf16 v[52:55], a[216:219], a[136:139], v[52:55]
 ds_write_b128 v3, v[12:15] offset:19456
 v_mfma_f32_16x16x32_bf16 v[52:55], a[220:223], a[140:143], v[52:55]
 buffer_store_dwordx4 v[12:15], v3, s[32:35], s68 offen offset:1024 sc1
 v_accvgpr_read_b32 v5, a84
 v_mfma_f32_16x16x32_bf16 v[48:51], a[220:223], a[132:135], v[48:51]
 v_lshlrev_b32 v6, 16, v5
 v_mfma_f32_16x16x32_bf16 v[48:51], a[216:219], a[128:131], v[48:51]
 v_and_b32 v5, s26, v5
 v_mul_f32 v6, v6, v156
 s_waitcnt vmcnt(14)
 v_mfma_f32_16x16x32_bf16 v[80:83], a[224:227], a[128:131], v[80:83]
 v_mul_f32 v5, v5, v157
 v_cvt_pk_bf16_f32 v8, v6, v5
 v_mfma_f32_16x16x32_bf16 v[80:83], a[228:231], a[132:135], v[80:83]
 global_load_dwordx4 a[220:223], v0, s[70:71] offset:3072
 v_accvgpr_read_b32 v5, a85
 v_mfma_f32_16x16x32_bf16 v[84:87], a[228:231], a[140:143], v[84:87]
 v_lshlrev_b32 v6, 16, v5
 v_and_b32 v5, s26, v5
 v_mfma_f32_16x16x32_bf16 v[84:87], a[224:227], a[136:139], v[84:87]
 global_load_dwordx4 a[216:219], v0, s[70:71] offset:2048
 v_mul_f32 v6, v6, v158
 v_mfma_f32_16x16x32_bf16 v[88:91], a[224:227], a[144:147], v[88:91]
 v_mul_f32 v5, v5, v159
 v_cvt_pk_bf16_f32 v9, v6, v5
 s_add_u32 s70, s70, 8192
 s_addc_u32 s71, s71, 0
 v_mfma_f32_16x16x32_bf16 v[88:91], a[228:231], a[148:151], v[88:91]
 v_accvgpr_read_b32 v5, a86
 v_lshlrev_b32 v6, 16, v5
 v_mfma_f32_16x16x32_bf16 v[92:95], a[228:231], a[156:159], v[92:95]
 v_and_b32 v5, s26, v5
 v_mul_f32 v6, v6, v188
 v_mfma_f32_16x16x32_bf16 v[92:95], a[224:227], a[152:155], v[92:95]
 v_mul_f32 v5, v5, v189
 v_cvt_pk_bf16_f32 v10, v6, v5
 v_mfma_f32_16x16x32_bf16 v[96:99], a[224:227], a[160:163], v[96:99]
 v_accvgpr_read_b32 v5, a87
 v_lshlrev_b32 v6, 16, v5
 v_mfma_f32_16x16x32_bf16 v[96:99], a[228:231], a[164:167], v[96:99]
 v_and_b32 v5, s26, v5
 v_mul_f32 v6, v6, v190
 v_mfma_f32_16x16x32_bf16 v[100:103], a[228:231], a[172:175], v[100:103]
 v_mul_f32 v5, v5, v191
 v_cvt_pk_bf16_f32 v11, v6, v5
 v_mfma_f32_16x16x32_bf16 v[100:103], a[224:227], a[168:171], v[100:103]
 ds_write_b128 v3, v[8:11] offset:22528
 v_mfma_f32_16x16x32_bf16 v[104:107], a[224:227], a[176:179], v[104:107]
 buffer_store_dwordx4 v[8:11], v3, s[32:35], s68 offen offset:2048 sc1
 v_accvgpr_read_b32 v5, a116
 v_lshlrev_b32 v6, 16, v5
 v_and_b32 v5, s26, v5
 v_mul_f32 v6, v6, v220
 v_mfma_f32_16x16x32_bf16 v[104:107], a[228:231], a[180:183], v[104:107]
 v_mul_f32 v5, v5, v221
 v_cvt_pk_bf16_f32 v12, v6, v5
 v_mfma_f32_16x16x32_bf16 v[108:111], a[228:231], a[188:191], v[108:111]
 v_accvgpr_read_b32 v5, a117
 v_lshlrev_b32 v6, 16, v5
 v_mfma_f32_16x16x32_bf16 v[108:111], a[224:227], a[184:187], v[108:111]
 v_and_b32 v5, s26, v5
 v_mul_f32 v6, v6, v222
 s_waitcnt vmcnt(14)
 v_mfma_f32_16x16x32_bf16 a[244:247], a[232:235], a[184:187], a[244:247]
 ds_read_b128 a[184:187], v2 offset:61440
 v_mul_f32 v5, v5, v223
 v_mfma_f32_16x16x32_bf16 a[244:247], a[236:239], a[188:191], a[244:247]
 global_load_dwordx4 a[228:231], v0, s[70:71] offset:-3072
 ds_read_b128 a[188:191], v2 offset:62464
 v_mfma_f32_16x16x32_bf16 a[240:243], a[236:239], a[180:183], a[240:243]
 ds_read_b128 a[180:183], v2 offset:58368
 v_cvt_pk_bf16_f32 v13, v6, v5
 v_mfma_f32_16x16x32_bf16 a[240:243], a[232:235], a[176:179], a[240:243]
 global_load_dwordx4 a[224:227], v0, s[70:71] offset:-4096
 ds_read_b128 a[176:179], v2 offset:57344
 v_accvgpr_read_b32 v5, a118
 v_mfma_f32_16x16x32_bf16 v[132:135], a[232:235], a[168:171], v[132:135]
 ds_read_b128 a[168:171], v2 offset:53248
 v_lshlrev_b32 v6, 16, v5
 v_mfma_f32_16x16x32_bf16 v[132:135], a[236:239], a[172:175], v[132:135]
 ds_read_b128 a[172:175], v2 offset:54272
 v_and_b32 v5, s26, v5
 v_mfma_f32_16x16x32_bf16 v[128:131], a[236:239], a[164:167], v[128:131]
 ds_read_b128 a[164:167], v2 offset:50176
 v_mul_f32 v6, v6, v252
 v_mfma_f32_16x16x32_bf16 v[128:131], a[232:235], a[160:163], v[128:131]
 ds_read_b128 a[160:163], v2 offset:49152
 v_mul_f32 v5, v5, v253
 v_mfma_f32_16x16x32_bf16 v[124:127], a[232:235], a[152:155], v[124:127]
 ds_read_b128 a[152:155], v2 offset:45056
 v_cvt_pk_bf16_f32 v14, v6, v5
 v_mfma_f32_16x16x32_bf16 v[124:127], a[236:239], a[156:159], v[124:127]
 ds_read_b128 a[156:159], v2 offset:46080
 v_accvgpr_read_b32 v5, a119
 v_mfma_f32_16x16x32_bf16 v[120:123], a[236:239], a[148:151], v[120:123]
 ds_read_b128 a[148:151], v2 offset:41984
 v_lshlrev_b32 v6, 16, v5
 v_mfma_f32_16x16x32_bf16 v[120:123], a[232:235], a[144:147], v[120:123]
 ds_read_b128 a[144:147], v2 offset:40960
 v_and_b32 v5, s26, v5
 v_mfma_f32_16x16x32_bf16 v[116:119], a[232:235], a[136:139], v[116:119]
 ds_read_b128 a[136:139], v2 offset:36864
 v_mul_f32 v6, v6, v254
 v_mfma_f32_16x16x32_bf16 v[116:119], a[236:239], a[140:143], v[116:119]
 ds_read_b128 a[140:143], v2 offset:37888
 v_mul_f32 v5, v5, v255
 v_mfma_f32_16x16x32_bf16 v[112:115], a[236:239], a[132:135], v[112:115]
 ds_read_b128 a[132:135], v2 offset:33792
 v_cvt_pk_bf16_f32 v15, v6, v5
 v_mfma_f32_16x16x32_bf16 v[112:115], a[232:235], a[128:131], v[112:115]
 ds_read_b128 a[128:131], v2 offset:32768
 ds_write_b128 v3, v[12:15] offset:23552
 buffer_store_dwordx4 v[12:15], v3, s[32:35], s68 offen offset:3072 sc1
 v_accvgpr_read_b32 v5, a88
 v_lshlrev_b32 v6, 16, v5
 v_and_b32 v5, s26, v5
 s_waitcnt vmcnt(14) lgkmcnt(9)
 v_mfma_f32_16x16x32_bf16 v[44:47], a[192:195], a[184:187], v[44:47]
 v_mul_f32 v6, v6, v160
 v_mul_f32 v5, v5, v161
 v_mfma_f32_16x16x32_bf16 v[44:47], a[196:199], a[188:191], v[44:47]
 global_load_dwordx4 a[236:239], v0, s[70:71] offset:-1024
 v_cvt_pk_bf16_f32 v8, v6, v5
 v_mfma_f32_16x16x32_bf16 v[40:43], a[196:199], a[180:183], v[40:43]
 v_accvgpr_read_b32 v5, a89
 v_lshlrev_b32 v6, 16, v5
 v_mfma_f32_16x16x32_bf16 v[40:43], a[192:195], a[176:179], v[40:43]
 global_load_dwordx4 a[232:235], v0, s[70:71] offset:-2048
 v_and_b32 v5, s26, v5
 v_mfma_f32_16x16x32_bf16 v[36:39], a[192:195], a[168:171], v[36:39]
 v_mul_f32 v6, v6, v162
 v_mul_f32 v5, v5, v163
 v_mfma_f32_16x16x32_bf16 v[36:39], a[196:199], a[172:175], v[36:39]
 v_cvt_pk_bf16_f32 v9, v6, v5
 v_accvgpr_read_b32 v5, a90
 v_mfma_f32_16x16x32_bf16 v[32:35], a[196:199], a[164:167], v[32:35]
 v_lshlrev_b32 v6, 16, v5
 v_and_b32 v5, s26, v5
 v_mfma_f32_16x16x32_bf16 v[32:35], a[192:195], a[160:163], v[32:35]
 v_mul_f32 v6, v6, v192
 v_mul_f32 v5, v5, v193
 s_waitcnt lgkmcnt(1)
 v_mfma_f32_16x16x32_bf16 v[28:31], a[192:195], a[152:155], v[28:31]
 v_cvt_pk_bf16_f32 v10, v6, v5
 v_accvgpr_read_b32 v5, a91
 v_mfma_f32_16x16x32_bf16 v[28:31], a[196:199], a[156:159], v[28:31]
 v_lshlrev_b32 v6, 16, v5
 v_and_b32 v5, s26, v5
 v_mfma_f32_16x16x32_bf16 v[24:27], a[196:199], a[148:151], v[24:27]
 v_mul_f32 v6, v6, v194
 v_mul_f32 v5, v5, v195
 v_mfma_f32_16x16x32_bf16 v[24:27], a[192:195], a[144:147], v[24:27]
 v_cvt_pk_bf16_f32 v11, v6, v5
 v_mfma_f32_16x16x32_bf16 v[20:23], a[192:195], a[136:139], v[20:23]
 ds_write_b128 v3, v[8:11] offset:26624
 s_add_u32 s68, s29, 28672
 v_mfma_f32_16x16x32_bf16 v[20:23], a[196:199], a[140:143], v[20:23]
 buffer_store_dwordx4 v[8:11], v3, s[32:35], s68 offen sc1
 v_accvgpr_read_b32 v5, a120
 v_lshlrev_b32 v6, 16, v5
 v_and_b32 v5, s26, v5
 v_mfma_f32_16x16x32_bf16 v[16:19], a[196:199], a[132:135], v[16:19]
 v_mul_f32 v6, v6, v224
 v_mul_f32 v5, v5, v225
 v_mfma_f32_16x16x32_bf16 v[16:19], a[192:195], a[128:131], v[16:19]
 v_cvt_pk_bf16_f32 v12, v6, v5
 v_accvgpr_read_b32 v5, a121
 s_waitcnt vmcnt(13)
 v_mfma_f32_16x16x32_bf16 v[48:51], a[200:203], a[128:131], v[48:51]
 v_lshlrev_b32 v6, 16, v5
 v_and_b32 v5, s26, v5
 v_mfma_f32_16x16x32_bf16 v[48:51], a[204:207], a[132:135], v[48:51]
 global_load_dwordx4 a[196:199], v0, s[70:71] offset:1024
 v_mul_f32 v6, v6, v226
 v_mfma_f32_16x16x32_bf16 v[52:55], a[204:207], a[140:143], v[52:55]
 v_mul_f32 v5, v5, v227
 v_cvt_pk_bf16_f32 v13, v6, v5
 v_mfma_f32_16x16x32_bf16 v[52:55], a[200:203], a[136:139], v[52:55]
 global_load_dwordx4 a[192:195], v0, s[70:71] offset:0
 v_accvgpr_read_b32 v5, a122
 v_mfma_f32_16x16x32_bf16 v[56:59], a[200:203], a[144:147], v[56:59]
 v_accvgpr_read_b32 v7, a248
 v_lshlrev_b32 v6, 16, v5
 v_mfma_f32_16x16x32_bf16 v[56:59], a[204:207], a[148:151], v[56:59]
 v_and_b32 v5, s26, v5
 v_mul_f32 v6, v6, v7
 v_mfma_f32_16x16x32_bf16 v[60:63], a[204:207], a[156:159], v[60:63]
 v_accvgpr_read_b32 v7, a249
 v_mfma_f32_16x16x32_bf16 v[60:63], a[200:203], a[152:155], v[60:63]
 v_mul_f32 v5, v5, v7
 v_cvt_pk_bf16_f32 v14, v6, v5
 v_mfma_f32_16x16x32_bf16 v[64:67], a[200:203], a[160:163], v[64:67]
 v_accvgpr_read_b32 v5, a123
 v_accvgpr_read_b32 v7, a250
 v_mfma_f32_16x16x32_bf16 v[64:67], a[204:207], a[164:167], v[64:67]
 v_lshlrev_b32 v6, 16, v5
 v_mfma_f32_16x16x32_bf16 v[68:71], a[204:207], a[172:175], v[68:71]
 v_and_b32 v5, s26, v5
 v_mul_f32 v6, v6, v7
 v_mfma_f32_16x16x32_bf16 v[68:71], a[200:203], a[168:171], v[68:71]
 v_accvgpr_read_b32 v7, a251
 v_mul_f32 v5, v5, v7
 v_mfma_f32_16x16x32_bf16 v[72:75], a[200:203], a[176:179], v[72:75]
 v_cvt_pk_bf16_f32 v15, v6, v5
 v_mfma_f32_16x16x32_bf16 v[72:75], a[204:207], a[180:183], v[72:75]
 ds_write_b128 v3, v[12:15] offset:27648
 v_mfma_f32_16x16x32_bf16 v[76:79], a[204:207], a[188:191], v[76:79]
 buffer_store_dwordx4 v[12:15], v3, s[32:35], s68 offen offset:1024 sc1
 v_accvgpr_read_b32 v5, a92
 v_lshlrev_b32 v6, 16, v5
 v_mfma_f32_16x16x32_bf16 v[76:79], a[200:203], a[184:187], v[76:79]
 v_and_b32 v5, s26, v5
 v_mul_f32 v6, v6, v164
 s_waitcnt vmcnt(13)
 v_mfma_f32_16x16x32_bf16 v[108:111], a[208:211], a[184:187], v[108:111]
 v_mul_f32 v5, v5, v165
 v_cvt_pk_bf16_f32 v8, v6, v5
 v_mfma_f32_16x16x32_bf16 v[108:111], a[212:215], a[188:191], v[108:111]
 global_load_dwordx4 a[204:207], v0, s[70:71] offset:3072
 v_accvgpr_read_b32 v5, a93
 v_mfma_f32_16x16x32_bf16 v[104:107], a[212:215], a[180:183], v[104:107]
 v_lshlrev_b32 v6, 16, v5
 v_and_b32 v5, s26, v5
 v_mfma_f32_16x16x32_bf16 v[104:107], a[208:211], a[176:179], v[104:107]
 global_load_dwordx4 a[200:203], v0, s[70:71] offset:2048
 v_mul_f32 v6, v6, v166
 v_mfma_f32_16x16x32_bf16 v[100:103], a[208:211], a[168:171], v[100:103]
 v_mul_f32 v5, v5, v167
 v_cvt_pk_bf16_f32 v9, v6, v5
 s_add_u32 s70, s70, 8192
 s_addc_u32 s71, s71, 0
 v_mfma_f32_16x16x32_bf16 v[100:103], a[212:215], a[172:175], v[100:103]
 v_accvgpr_read_b32 v5, a94
 v_lshlrev_b32 v6, 16, v5
 v_mfma_f32_16x16x32_bf16 v[96:99], a[212:215], a[164:167], v[96:99]
 v_and_b32 v5, s26, v5
 v_mul_f32 v6, v6, v196
 v_mfma_f32_16x16x32_bf16 v[96:99], a[208:211], a[160:163], v[96:99]
 v_mul_f32 v5, v5, v197
 v_cvt_pk_bf16_f32 v10, v6, v5
 v_mfma_f32_16x16x32_bf16 v[92:95], a[208:211], a[152:155], v[92:95]
 v_accvgpr_read_b32 v5, a95
 v_lshlrev_b32 v6, 16, v5
 v_mfma_f32_16x16x32_bf16 v[92:95], a[212:215], a[156:159], v[92:95]
 v_and_b32 v5, s26, v5
 v_mul_f32 v6, v6, v198
 v_mfma_f32_16x16x32_bf16 v[88:91], a[212:215], a[148:151], v[88:91]
 v_mul_f32 v5, v5, v199
 v_cvt_pk_bf16_f32 v11, v6, v5
 v_mfma_f32_16x16x32_bf16 v[88:91], a[208:211], a[144:147], v[88:91]
 ds_write_b128 v3, v[8:11] offset:30720
 v_mfma_f32_16x16x32_bf16 v[84:87], a[208:211], a[136:139], v[84:87]
 buffer_store_dwordx4 v[8:11], v3, s[32:35], s68 offen offset:2048 sc1
 v_accvgpr_read_b32 v5, a124
 v_lshlrev_b32 v6, 16, v5
 v_and_b32 v5, s26, v5
 v_mul_f32 v6, v6, v228
 v_mfma_f32_16x16x32_bf16 v[84:87], a[212:215], a[140:143], v[84:87]
 v_mul_f32 v5, v5, v229
 v_cvt_pk_bf16_f32 v12, v6, v5
 v_mfma_f32_16x16x32_bf16 v[80:83], a[212:215], a[132:135], v[80:83]
 v_accvgpr_read_b32 v5, a125
 v_lshlrev_b32 v6, 16, v5
 v_mfma_f32_16x16x32_bf16 v[80:83], a[208:211], a[128:131], v[80:83]
 v_and_b32 v5, s26, v5
 v_mul_f32 v6, v6, v230
 s_waitcnt vmcnt(13)
 v_mfma_f32_16x16x32_bf16 v[112:115], a[216:219], a[128:131], v[112:115]
 ds_read_b128 a[128:131], v1
 v_mul_f32 v5, v5, v231
 v_mfma_f32_16x16x32_bf16 v[112:115], a[220:223], a[132:135], v[112:115]
 global_load_dwordx4 a[212:215], v0, s[70:71] offset:-3072
 ds_read_b128 a[132:135], v1 offset:1024
 v_mfma_f32_16x16x32_bf16 v[116:119], a[220:223], a[140:143], v[116:119]
 ds_read_b128 a[140:143], v1 offset:5120
 v_cvt_pk_bf16_f32 v13, v6, v5
 v_mfma_f32_16x16x32_bf16 v[116:119], a[216:219], a[136:139], v[116:119]
 global_load_dwordx4 a[208:211], v0, s[70:71] offset:-4096
 ds_read_b128 a[136:139], v1 offset:4096
 v_mfma_f32_16x16x32_bf16 v[120:123], a[216:219], a[144:147], v[120:123]
 ds_read_b128 a[144:147], v1 offset:8192
 v_accvgpr_read_b32 v5, a126
 v_mfma_f32_16x16x32_bf16 v[120:123], a[220:223], a[148:151], v[120:123]
 ds_read_b128 a[148:151], v1 offset:9216
 v_accvgpr_read_b32 v7, a252
 v_lshlrev_b32 v6, 16, v5
 v_mfma_f32_16x16x32_bf16 v[124:127], a[220:223], a[156:159], v[124:127]
 ds_read_b128 a[156:159], v1 offset:13312
 v_and_b32 v5, s26, v5
 v_mfma_f32_16x16x32_bf16 v[124:127], a[216:219], a[152:155], v[124:127]
 ds_read_b128 a[152:155], v1 offset:12288
 v_mul_f32 v6, v6, v7
 v_accvgpr_read_b32 v7, a253
 v_mfma_f32_16x16x32_bf16 v[128:131], a[216:219], a[160:163], v[128:131]
 ds_read_b128 a[160:163], v1 offset:16384
 v_mul_f32 v5, v5, v7
 v_cvt_pk_bf16_f32 v14, v6, v5
 v_mfma_f32_16x16x32_bf16 v[128:131], a[220:223], a[164:167], v[128:131]
 ds_read_b128 a[164:167], v1 offset:17408
 v_accvgpr_read_b32 v5, a127
 v_accvgpr_read_b32 v7, a254
 v_mfma_f32_16x16x32_bf16 v[132:135], a[220:223], a[172:175], v[132:135]
 ds_read_b128 a[172:175], v1 offset:21504
 v_lshlrev_b32 v6, 16, v5
 v_mfma_f32_16x16x32_bf16 v[132:135], a[216:219], a[168:171], v[132:135]
 ds_read_b128 a[168:171], v1 offset:20480
 v_and_b32 v5, s26, v5
 v_mul_f32 v6, v6, v7
 v_mfma_f32_16x16x32_bf16 a[240:243], a[216:219], a[176:179], a[240:243]
 ds_read_b128 a[176:179], v1 offset:24576
 v_accvgpr_read_b32 v7, a255
 v_mul_f32 v5, v5, v7
 v_cvt_pk_bf16_f32 v15, v6, v5
 v_mfma_f32_16x16x32_bf16 a[240:243], a[220:223], a[180:183], a[240:243]
 ds_read_b128 a[180:183], v1 offset:25600
 ds_write_b128 v3, v[12:15] offset:31744
 v_mfma_f32_16x16x32_bf16 a[244:247], a[220:223], a[188:191], a[244:247]
 buffer_store_dwordx4 v[12:15], v3, s[32:35], s68 offen offset:3072 sc1
 global_load_dwordx4 a[220:223], v0, s[70:71] offset:-1024
 ds_read_b128 a[188:191], v1 offset:29696
 v_mfma_f32_16x16x32_bf16 a[244:247], a[216:219], a[184:187], a[244:247]
 global_load_dwordx4 a[216:219], v0, s[70:71] offset:-2048
 ds_read_b128 a[184:187], v1 offset:28672
 s_waitcnt vmcnt(15) lgkmcnt(9)
 s_branch Ls1b
Llast:
 v_mfma_f32_16x16x32_bf16 v[136:139], a[208:211], a[128:131], v[136:139]
 v_accvgpr_read_b32 v5, a0
 v_lshlrev_b32 v6, 16, v5
 v_mfma_f32_16x16x32_bf16 v[136:139], a[212:215], a[132:135], v[136:139]
 v_and_b32 v5, s26, v5
 v_mul_f32 v6, v6, v16
 v_mfma_f32_16x16x32_bf16 v[140:143], a[212:215], a[140:143], v[140:143]
 v_mul_f32 v5, v5, v17
 v_cvt_pk_bf16_f32 v8, v6, v5
 v_mfma_f32_16x16x32_bf16 v[140:143], a[208:211], a[136:139], v[140:143]
 v_accvgpr_read_b32 v5, a1
 v_lshlrev_b32 v6, 16, v5
 v_mfma_f32_16x16x32_bf16 v[144:147], a[208:211], a[144:147], v[144:147]
 v_and_b32 v5, s26, v5
 v_mul_f32 v6, v6, v18
 v_mfma_f32_16x16x32_bf16 v[144:147], a[212:215], a[148:151], v[144:147]
 v_mul_f32 v5, v5, v19
 v_cvt_pk_bf16_f32 v9, v6, v5
 v_mfma_f32_16x16x32_bf16 v[148:151], a[212:215], a[156:159], v[148:151]
 v_accvgpr_read_b32 v5, a2
 v_lshlrev_b32 v6, 16, v5
 v_mfma_f32_16x16x32_bf16 v[148:151], a[208:211], a[152:155], v[148:151]
 v_and_b32 v5, s26, v5
 v_mul_f32 v6, v6, v48
 s_waitcnt lgkmcnt(0)
 v_mfma_f32_16x16x32_bf16 v[152:155], a[208:211], a[160:163], v[152:155]
 v_mul_f32 v5, v5, v49
 v_cvt_pk_bf16_f32 v10, v6, v5
 v_mfma_f32_16x16x32_bf16 v[152:155], a[212:215], a[164:167], v[152:155]
 v_accvgpr_read_b32 v5, a3
 v_lshlrev_b32 v6, 16, v5
 v_mfma_f32_16x16x32_bf16 v[156:159], a[212:215], a[172:175], v[156:159]
 v_and_b32 v5, s26, v5
 v_mul_f32 v6, v6, v50
 v_mfma_f32_16x16x32_bf16 v[156:159], a[208:211], a[168:171], v[156:159]
 v_mul_f32 v5, v5, v51
 v_cvt_pk_bf16_f32 v11, v6, v5
 v_mfma_f32_16x16x32_bf16 v[160:163], a[208:211], a[176:179], v[160:163]
 v_lshrrev_b32 v5, 7, v1
 v_lshlrev_b32 v6, 4, v5
 v_mfma_f32_16x16x32_bf16 v[160:163], a[212:215], a[180:183], v[160:163]
 v_xor_b32 v6, v6, v1
 v_and_b32 v6, 112, v6
 v_mfma_f32_16x16x32_bf16 v[164:167], a[212:215], a[188:191], v[164:167]
 v_lshl_add_u32 v16, v5, 11, v6
 v_lshrrev_b32 v5, 4, v1
 v_mfma_f32_16x16x32_bf16 v[164:167], a[208:211], a[184:187], v[164:167]
 v_and_b32 v5, 48, v5
 v_xor_b32 v5, v5, v1
 s_waitcnt vmcnt(8)
 v_mfma_f32_16x16x32_bf16 v[196:199], a[216:219], a[184:187], v[196:199]
 v_and_b32 v5, 112, v5
 v_and_b32 v6, 240, v1
 v_mfma_f32_16x16x32_bf16 v[196:199], a[220:223], a[188:191], v[196:199]
 global_load_dwordx4 a[212:215], v0, s[70:71] offset:1024
 v_lshl_add_u32 v5, v6, 3, v5
 v_mfma_f32_16x16x32_bf16 v[192:195], a[220:223], a[180:183], v[192:195]
 v_add_u32 v17, s50, v5
 v_xor_b32 v18, 64, v17
 v_mfma_f32_16x16x32_bf16 v[192:195], a[216:219], a[176:179], v[192:195]
 global_load_dwordx4 a[208:211], v0, s[70:71] offset:0
 ds_write_b128 v17, v[8:11]
 v_mfma_f32_16x16x32_bf16 v[188:191], a[216:219], a[168:171], v[188:191]
 v_accvgpr_read_b32 v5, a32
 v_lshlrev_b32 v6, 16, v5
 v_mfma_f32_16x16x32_bf16 v[188:191], a[220:223], a[172:175], v[188:191]
 v_and_b32 v5, s26, v5
 v_mul_f32 v6, v6, v80
 v_mfma_f32_16x16x32_bf16 v[184:187], a[220:223], a[164:167], v[184:187]
 v_mul_f32 v5, v5, v81
 v_cvt_pk_bf16_f32 v12, v6, v5
 v_mfma_f32_16x16x32_bf16 v[184:187], a[216:219], a[160:163], v[184:187]
 v_accvgpr_read_b32 v5, a33
 v_lshlrev_b32 v6, 16, v5
 v_mfma_f32_16x16x32_bf16 v[180:183], a[216:219], a[152:155], v[180:183]
 v_and_b32 v5, s26, v5
 v_mul_f32 v6, v6, v82
 v_mfma_f32_16x16x32_bf16 v[180:183], a[220:223], a[156:159], v[180:183]
 v_mul_f32 v5, v5, v83
 v_cvt_pk_bf16_f32 v13, v6, v5
 v_mfma_f32_16x16x32_bf16 v[176:179], a[220:223], a[148:151], v[176:179]
 v_accvgpr_read_b32 v5, a34
 v_lshlrev_b32 v6, 16, v5
 v_mfma_f32_16x16x32_bf16 v[176:179], a[216:219], a[144:147], v[176:179]
 v_and_b32 v5, s26, v5
 v_mul_f32 v6, v6, v112
 v_mfma_f32_16x16x32_bf16 v[172:175], a[216:219], a[136:139], v[172:175]
 v_mul_f32 v5, v5, v113
 v_cvt_pk_bf16_f32 v14, v6, v5
 v_mfma_f32_16x16x32_bf16 v[172:175], a[220:223], a[140:143], v[172:175]
 v_accvgpr_read_b32 v5, a35
 v_lshlrev_b32 v6, 16, v5
 v_mfma_f32_16x16x32_bf16 v[168:171], a[220:223], a[132:135], v[168:171]
 v_and_b32 v5, s26, v5
 v_mul_f32 v6, v6, v114
 v_mfma_f32_16x16x32_bf16 v[168:171], a[216:219], a[128:131], v[168:171]
 v_mul_f32 v5, v5, v115
 v_cvt_pk_bf16_f32 v15, v6, v5
 s_waitcnt vmcnt(8)
 v_mfma_f32_16x16x32_bf16 v[200:203], a[224:227], a[128:131], v[200:203]
 ds_write_b128 v18, v[12:15]
 v_mfma_f32_16x16x32_bf16 v[200:203], a[228:231], a[132:135], v[200:203]
 global_load_dwordx4 a[220:223], v0, s[70:71] offset:3072
 ds_read_b128 v[48:51], v3
 v_mfma_f32_16x16x32_bf16 v[204:207], a[228:231], a[140:143], v[204:207]
 ds_read_b128 v[80:83], v3 offset:1024
 v_accvgpr_read_b32 v5, a4
 v_mfma_f32_16x16x32_bf16 v[204:207], a[224:227], a[136:139], v[204:207]
 global_load_dwordx4 a[216:219], v0, s[70:71] offset:2048
 v_lshlrev_b32 v6, 16, v5
 v_mfma_f32_16x16x32_bf16 v[208:211], a[224:227], a[144:147], v[208:211]
 v_and_b32 v5, s26, v5
 v_mul_f32 v6, v6, v20
 s_add_u32 s70, s70, 8192
 s_addc_u32 s71, s71, 0
 v_mfma_f32_16x16x32_bf16 v[208:211], a[228:231], a[148:151], v[208:211]
 v_mul_f32 v5, v5, v21
 v_cvt_pk_bf16_f32 v8, v6, v5
 v_mfma_f32_16x16x32_bf16 v[212:215], a[228:231], a[156:159], v[212:215]
 v_accvgpr_read_b32 v5, a5
 v_lshlrev_b32 v6, 16, v5
 v_mfma_f32_16x16x32_bf16 v[212:215], a[224:227], a[152:155], v[212:215]
 v_and_b32 v5, s26, v5
 v_mul_f32 v6, v6, v22
 v_mfma_f32_16x16x32_bf16 v[216:219], a[224:227], a[160:163], v[216:219]
 v_mul_f32 v5, v5, v23
 v_cvt_pk_bf16_f32 v9, v6, v5
 s_waitcnt lgkmcnt(1)
 s_add_u32 s3, s28, 0
 v_mfma_f32_16x16x32_bf16 v[216:219], a[228:231], a[164:167], v[216:219]
 buffer_store_dwordx4 v[48:51], v16, s[16:19], s3 offen nt
 s_waitcnt lgkmcnt(0)
 s_add_u32 s3, s28, 16384
 buffer_store_dwordx4 v[80:83], v16, s[16:19], s3 offen nt
 v_accvgpr_read_b32 v5, a6
 v_lshlrev_b32 v6, 16, v5
 v_and_b32 v5, s26, v5
 v_mul_f32 v6, v6, v52
 v_mfma_f32_16x16x32_bf16 v[220:223], a[228:231], a[172:175], v[220:223]
 v_mul_f32 v5, v5, v53
 v_cvt_pk_bf16_f32 v10, v6, v5
 v_mfma_f32_16x16x32_bf16 v[220:223], a[224:227], a[168:171], v[220:223]
 v_accvgpr_read_b32 v5, a7
 v_lshlrev_b32 v6, 16, v5
 v_mfma_f32_16x16x32_bf16 v[224:227], a[224:227], a[176:179], v[224:227]
 v_and_b32 v5, s26, v5
 v_mul_f32 v6, v6, v54
 v_mul_f32 v5, v5, v55
 v_cvt_pk_bf16_f32 v11, v6, v5
 v_mfma_f32_16x16x32_bf16 v[224:227], a[228:231], a[180:183], v[224:227]
 ds_write_b128 v17, v[8:11] offset:4096
 v_mfma_f32_16x16x32_bf16 v[228:231], a[228:231], a[188:191], v[228:231]
 v_accvgpr_read_b32 v5, a36
 v_lshlrev_b32 v6, 16, v5
 v_mfma_f32_16x16x32_bf16 v[228:231], a[224:227], a[184:187], v[228:231]
 v_and_b32 v5, s26, v5
 v_mul_f32 v6, v6, v84
 s_waitcnt vmcnt(10)
 v_mfma_f32_16x16x32_bf16 a[252:255], a[232:235], a[184:187], a[252:255]
 ds_read_b128 a[184:187], v1 offset:63488
 v_mul_f32 v5, v5, v85
 v_mfma_f32_16x16x32_bf16 a[252:255], a[236:239], a[188:191], a[252:255]
 global_load_dwordx4 a[228:231], v0, s[70:71] offset:-3072
 ds_read_b128 a[188:191], v1 offset:64512
 v_mfma_f32_16x16x32_bf16 a[248:251], a[236:239], a[180:183], a[248:251]
 ds_read_b128 a[180:183], v1 offset:60416
 v_cvt_pk_bf16_f32 v12, v6, v5
 v_mfma_f32_16x16x32_bf16 a[248:251], a[232:235], a[176:179], a[248:251]
 global_load_dwordx4 a[224:227], v0, s[70:71] offset:-4096
 ds_read_b128 a[176:179], v1 offset:59392
 v_mfma_f32_16x16x32_bf16 v[252:255], a[232:235], a[168:171], v[252:255]
 ds_read_b128 a[168:171], v1 offset:55296
 v_accvgpr_read_b32 v5, a37
 v_mfma_f32_16x16x32_bf16 v[252:255], a[236:239], a[172:175], v[252:255]
 ds_read_b128 a[172:175], v1 offset:56320
 v_lshlrev_b32 v6, 16, v5
 v_mfma_f32_16x16x32_bf16 v[248:251], a[236:239], a[164:167], v[248:251]
 ds_read_b128 a[164:167], v1 offset:52224
 v_and_b32 v5, s26, v5
 v_mfma_f32_16x16x32_bf16 v[248:251], a[232:235], a[160:163], v[248:251]
 ds_read_b128 a[160:163], v1 offset:51200
 v_mul_f32 v6, v6, v86
 v_mul_f32 v5, v5, v87
 v_mfma_f32_16x16x32_bf16 v[244:247], a[232:235], a[152:155], v[244:247]
 ds_read_b128 a[152:155], v1 offset:47104
 v_cvt_pk_bf16_f32 v13, v6, v5
 v_mfma_f32_16x16x32_bf16 v[244:247], a[236:239], a[156:159], v[244:247]
 ds_read_b128 a[156:159], v1 offset:48128
 v_accvgpr_read_b32 v5, a38
 v_lshlrev_b32 v6, 16, v5
 v_mfma_f32_16x16x32_bf16 v[240:243], a[236:239], a[148:151], v[240:243]
 ds_read_b128 a[148:151], v1 offset:44032
 v_and_b32 v5, s26, v5
 v_mul_f32 v6, v6, v116
 v_mfma_f32_16x16x32_bf16 v[240:243], a[232:235], a[144:147], v[240:243]
 ds_read_b128 a[144:147], v1 offset:43008
 v_mul_f32 v5, v5, v117
 v_mfma_f32_16x16x32_bf16 v[236:239], a[232:235], a[136:139], v[236:239]
 ds_read_b128 a[136:139], v1 offset:38912
 v_cvt_pk_bf16_f32 v14, v6, v5
 v_mfma_f32_16x16x32_bf16 v[236:239], a[236:239], a[140:143], v[236:239]
 ds_read_b128 a[140:143], v1 offset:39936
 v_accvgpr_read_b32 v5, a39
 v_mfma_f32_16x16x32_bf16 v[232:235], a[236:239], a[132:135], v[232:235]
 ds_read_b128 a[132:135], v1 offset:35840
 v_lshlrev_b32 v6, 16, v5
 v_mfma_f32_16x16x32_bf16 v[232:235], a[232:235], a[128:131], v[232:235]
 ds_read_b128 a[128:131], v1 offset:34816
 v_and_b32 v5, s26, v5
 s_waitcnt vmcnt(10) lgkmcnt(8)
 v_mfma_f32_16x16x32_bf16 v[164:167], a[192:195], a[184:187], v[164:167]
 v_mul_f32 v6, v6, v118
 v_mul_f32 v5, v5, v119
 v_mfma_f32_16x16x32_bf16 v[164:167], a[196:199], a[188:191], v[164:167]
 global_load_dwordx4 a[236:239], v0, s[70:71] offset:-1024
 v_cvt_pk_bf16_f32 v15, v6, v5
 v_mfma_f32_16x16x32_bf16 v[160:163], a[196:199], a[180:183], v[160:163]
 ds_write_b128 v18, v[12:15] offset:4096
 ds_read_b128 v[48:51], v3 offset:4096
 v_mfma_f32_16x16x32_bf16 v[160:163], a[192:195], a[176:179], v[160:163]
 global_load_dwordx4 a[232:235], v0, s[70:71] offset:-2048
 ds_read_b128 v[80:83], v3 offset:5120
 v_mfma_f32_16x16x32_bf16 v[156:159], a[192:195], a[168:171], v[156:159]
 v_accvgpr_read_b32 v5, a8
 v_lshlrev_b32 v6, 16, v5
 v_mfma_f32_16x16x32_bf16 v[156:159], a[196:199], a[172:175], v[156:159]
 v_and_b32 v5, s26, v5
 v_mul_f32 v6, v6, v24
 v_mfma_f32_16x16x32_bf16 v[152:155], a[196:199], a[164:167], v[152:155]
 v_mul_f32 v5, v5, v25
 v_cvt_pk_bf16_f32 v8, v6, v5
 v_mfma_f32_16x16x32_bf16 v[152:155], a[192:195], a[160:163], v[152:155]
 v_accvgpr_read_b32 v5, a9
 v_lshlrev_b32 v6, 16, v5
 s_waitcnt lgkmcnt(3)
 v_mfma_f32_16x16x32_bf16 v[148:151], a[192:195], a[152:155], v[148:151]
 v_and_b32 v5, s26, v5
 v_mul_f32 v6, v6, v26
 v_mfma_f32_16x16x32_bf16 v[148:151], a[196:199], a[156:159], v[148:151]
 v_mul_f32 v5, v5, v27
 v_cvt_pk_bf16_f32 v9, v6, v5
 s_waitcnt lgkmcnt(1)
 s_add_u32 s3, s28, 32768
 v_mfma_f32_16x16x32_bf16 v[144:147], a[196:199], a[148:151], v[144:147]
 buffer_store_dwordx4 v[48:51], v16, s[16:19], s3 offen nt
 s_waitcnt lgkmcnt(0)
 s_add_u32 s3, s28, 49152
 buffer_store_dwordx4 v[80:83], v16, s[16:19], s3 offen nt
 v_accvgpr_read_b32 v5, a10
 v_lshlrev_b32 v6, 16, v5
 v_and_b32 v5, s26, v5
 v_mul_f32 v6, v6, v56
 v_mfma_f32_16x16x32_bf16 v[144:147], a[192:195], a[144:147], v[144:147]
 v_mul_f32 v5, v5, v57
 v_cvt_pk_bf16_f32 v10, v6, v5
 v_mfma_f32_16x16x32_bf16 v[140:143], a[192:195], a[136:139], v[140:143]
 v_accvgpr_read_b32 v5, a11
 v_lshlrev_b32 v6, 16, v5
 v_mfma_f32_16x16x32_bf16 v[140:143], a[196:199], a[140:143], v[140:143]
 v_and_b32 v5, s26, v5
 v_mul_f32 v6, v6, v58
 v_mfma_f32_16x16x32_bf16 v[136:139], a[196:199], a[132:135], v[136:139]
 v_mul_f32 v5, v5, v59
 v_cvt_pk_bf16_f32 v11, v6, v5
 v_mfma_f32_16x16x32_bf16 v[136:139], a[192:195], a[128:131], v[136:139]
 ds_write_b128 v17, v[8:11] offset:8192
 s_waitcnt vmcnt(12)
 v_mfma_f32_16x16x32_bf16 v[168:171], a[200:203], a[128:131], v[168:171]
 v_accvgpr_read_b32 v5, a40
 v_lshlrev_b32 v6, 16, v5
 v_mfma_f32_16x16x32_bf16 v[168:171], a[204:207], a[132:135], v[168:171]
 global_load_dwordx4 a[196:199], v0, s[70:71] offset:1024
 v_and_b32 v5, s26, v5
 v_mfma_f32_16x16x32_bf16 v[172:175], a[204:207], a[140:143], v[172:175]
 v_mul_f32 v6, v6, v88
 v_mul_f32 v5, v5, v89
 v_mfma_f32_16x16x32_bf16 v[172:175], a[200:203], a[136:139], v[172:175]
 global_load_dwordx4 a[192:195], v0, s[70:71] offset:0
 v_cvt_pk_bf16_f32 v12, v6, v5
 v_mfma_f32_16x16x32_bf16 v[176:179], a[200:203], a[144:147], v[176:179]
 v_accvgpr_read_b32 v5, a41
 v_lshlrev_b32 v6, 16, v5
 v_mfma_f32_16x16x32_bf16 v[176:179], a[204:207], a[148:151], v[176:179]
 v_and_b32 v5, s26, v5
 v_mul_f32 v6, v6, v90
 v_mfma_f32_16x16x32_bf16 v[180:183], a[204:207], a[156:159], v[180:183]
 v_mul_f32 v5, v5, v91
 v_cvt_pk_bf16_f32 v13, v6, v5
 v_mfma_f32_16x16x32_bf16 v[180:183], a[200:203], a[152:155], v[180:183]
 v_accvgpr_read_b32 v5, a42
 v_lshlrev_b32 v6, 16, v5
 v_mfma_f32_16x16x32_bf16 v[184:187], a[200:203], a[160:163], v[184:187]
 v_and_b32 v5, s26, v5
 v_mul_f32 v6, v6, v120
 v_mfma_f32_16x16x32_bf16 v[184:187], a[204:207], a[164:167], v[184:187]
 v_mul_f32 v5, v5, v121
 v_cvt_pk_bf16_f32 v14, v6, v5
 v_mfma_f32_16x16x32_bf16 v[188:191], a[204:207], a[172:175], v[188:191]
 v_accvgpr_read_b32 v5, a43
 v_lshlrev_b32 v6, 16, v5
 v_mfma_f32_16x16x32_bf16 v[188:191], a[200:203], a[168:171], v[188:191]
 v_and_b32 v5, s26, v5
 v_mul_f32 v6, v6, v122
 v_mfma_f32_16x16x32_bf16 v[192:195], a[200:203], a[176:179], v[192:195]
 v_mul_f32 v5, v5, v123
 v_cvt_pk_bf16_f32 v15, v6, v5
 v_mfma_f32_16x16x32_bf16 v[192:195], a[204:207], a[180:183], v[192:195]
 ds_write_b128 v18, v[12:15] offset:8192
 v_mfma_f32_16x16x32_bf16 v[196:199], a[204:207], a[188:191], v[196:199]
 ds_read_b128 v[48:51], v3 offset:8192
 ds_read_b128 v[80:83], v3 offset:9216
 v_mfma_f32_16x16x32_bf16 v[196:199], a[200:203], a[184:187], v[196:199]
 v_accvgpr_read_b32 v5, a12
 v_lshlrev_b32 v6, 16, v5
 s_waitcnt vmcnt(12)
 v_mfma_f32_16x16x32_bf16 v[228:231], a[208:211], a[184:187], v[228:231]
 v_and_b32 v5, s26, v5
 v_mul_f32 v6, v6, v28
 v_mfma_f32_16x16x32_bf16 v[228:231], a[212:215], a[188:191], v[228:231]
 global_load_dwordx4 a[204:207], v0, s[70:71] offset:3072
 v_mul_f32 v5, v5, v29
 v_mfma_f32_16x16x32_bf16 v[224:227], a[212:215], a[180:183], v[224:227]
 v_cvt_pk_bf16_f32 v8, v6, v5
 v_accvgpr_read_b32 v5, a13
 v_mfma_f32_16x16x32_bf16 v[224:227], a[208:211], a[176:179], v[224:227]
 global_load_dwordx4 a[200:203], v0, s[70:71] offset:2048
 v_lshlrev_b32 v6, 16, v5
 v_mfma_f32_16x16x32_bf16 v[220:223], a[208:211], a[168:171], v[220:223]
 v_and_b32 v5, s26, v5
 v_mul_f32 v6, v6, v30
 s_add_u32 s70, s70, 8192
 s_addc_u32 s71, s71, 0
 v_mfma_f32_16x16x32_bf16 v[220:223], a[212:215], a[172:175], v[220:223]
 v_mul_f32 v5, v5, v31
 v_cvt_pk_bf16_f32 v9, v6, v5
 s_waitcnt lgkmcnt(1)
 v_mfma_f32_16x16x32_bf16 v[216:219], a[212:215], a[164:167], v[216:219]
 s_add_u32 s3, s28, 65536
 buffer_store_dwordx4 v[48:51], v16, s[16:19], s3 offen nt
 s_waitcnt lgkmcnt(0)
 v_mfma_f32_16x16x32_bf16 v[216:219], a[208:211], a[160:163], v[216:219]
 s_add_u32 s3, s28, 81920
 buffer_store_dwordx4 v[80:83], v16, s[16:19], s3 offen nt
 v_accvgpr_read_b32 v5, a14
 v_lshlrev_b32 v6, 16, v5
 v_and_b32 v5, s26, v5
 v_mul_f32 v6, v6, v60
 v_mfma_f32_16x16x32_bf16 v[212:215], a[208:211], a[152:155], v[212:215]
 v_mul_f32 v5, v5, v61
 v_cvt_pk_bf16_f32 v10, v6, v5
 v_mfma_f32_16x16x32_bf16 v[212:215], a[212:215], a[156:159], v[212:215]
 v_accvgpr_read_b32 v5, a15
 v_lshlrev_b32 v6, 16, v5
 v_mfma_f32_16x16x32_bf16 v[208:211], a[212:215], a[148:151], v[208:211]
 v_and_b32 v5, s26, v5
 v_mul_f32 v6, v6, v62
 v_mfma_f32_16x16x32_bf16 v[208:211], a[208:211], a[144:147], v[208:211]
 v_mul_f32 v5, v5, v63
 v_cvt_pk_bf16_f32 v11, v6, v5
 v_mfma_f32_16x16x32_bf16 v[204:207], a[208:211], a[136:139], v[204:207]
 ds_write_b128 v17, v[8:11] offset:12288
 v_mfma_f32_16x16x32_bf16 v[204:207], a[212:215], a[140:143], v[204:207]
 v_accvgpr_read_b32 v5, a44
 v_lshlrev_b32 v6, 16, v5
 v_mfma_f32_16x16x32_bf16 v[200:203], a[212:215], a[132:135], v[200:203]
 v_and_b32 v5, s26, v5
 v_mul_f32 v6, v6, v92
 v_mfma_f32_16x16x32_bf16 v[200:203], a[208:211], a[128:131], v[200:203]
 v_mul_f32 v5, v5, v93
 v_cvt_pk_bf16_f32 v12, v6, v5
 s_waitcnt vmcnt(14)
 v_mfma_f32_16x16x32_bf16 v[232:235], a[216:219], a[128:131], v[232:235]
 ds_read_b128 a[128:131], v2 offset:2048
 v_accvgpr_read_b32 v5, a45
 v_mfma_f32_16x16x32_bf16 v[232:235], a[220:223], a[132:135], v[232:235]
 global_load_dwordx4 a[212:215], v0, s[70:71] offset:-3072
 ds_read_b128 a[132:135], v2 offset:3072
 v_mfma_f32_16x16x32_bf16 v[236:239], a[220:223], a[140:143], v[236:239]
 ds_read_b128 a[140:143], v2 offset:7168
 v_lshlrev_b32 v6, 16, v5
 v_mfma_f32_16x16x32_bf16 v[236:239], a[216:219], a[136:139], v[236:239]
 global_load_dwordx4 a[208:211], v0, s[70:71] offset:-4096
 ds_read_b128 a[136:139], v2 offset:6144
 v_and_b32 v5, s26, v5
 v_mfma_f32_16x16x32_bf16 v[240:243], a[216:219], a[144:147], v[240:243]
 ds_read_b128 a[144:147], v2 offset:10240
 v_mul_f32 v6, v6, v94
 v_mul_f32 v5, v5, v95
 v_mfma_f32_16x16x32_bf16 v[240:243], a[220:223], a[148:151], v[240:243]
 ds_read_b128 a[148:151], v2 offset:11264
 v_cvt_pk_bf16_f32 v13, v6, v5
 v_mfma_f32_16x16x32_bf16 v[244:247], a[220:223], a[156:159], v[244:247]
 ds_read_b128 a[156:159], v2 offset:15360
 v_accvgpr_read_b32 v5, a46
 v_lshlrev_b32 v6, 16, v5
 v_mfma_f32_16x16x32_bf16 v[244:247], a[216:219], a[152:155], v[244:247]
 ds_read_b128 a[152:155], v2 offset:14336
 v_and_b32 v5, s26, v5
 v_mul_f32 v6, v6, v124
 v_mfma_f32_16x16x32_bf16 v[248:251], a[216:219], a[160:163], v[248:251]
 ds_read_b128 a[160:163], v2 offset:18432
 v_mul_f32 v5, v5, v125
 v_mfma_f32_16x16x32_bf16 v[248:251], a[220:223], a[164:167], v[248:251]
 ds_read_b128 a[164:167], v2 offset:19456
 v_cvt_pk_bf16_f32 v14, v6, v5
 v_mfma_f32_16x16x32_bf16 v[252:255], a[220:223], a[172:175], v[252:255]
 ds_read_b128 a[172:175], v2 offset:23552
 v_accvgpr_read_b32 v5, a47
 v_mfma_f32_16x16x32_bf16 v[252:255], a[216:219], a[168:171], v[252:255]
 ds_read_b128 a[168:171], v2 offset:22528
 v_lshlrev_b32 v6, 16, v5
 v_mfma_f32_16x16x32_bf16 a[248:251], a[216:219], a[176:179], a[248:251]
 ds_read_b128 a[176:179], v2 offset:26624
 v_and_b32 v5, s26, v5
 v_mfma_f32_16x16x32_bf16 a[248:251], a[220:223], a[180:183], a[248:251]
 ds_read_b128 a[180:183], v2 offset:27648
 v_mul_f32 v6, v6, v126
 v_mfma_f32_16x16x32_bf16 a[252:255], a[220:223], a[188:191], a[252:255]
 ds_read_b128 a[188:191], v2 offset:31744
 v_mul_f32 v5, v5, v127
 v_mfma_f32_16x16x32_bf16 a[252:255], a[216:219], a[184:187], a[252:255]
 ds_read_b128 a[184:187], v2 offset:30720
 v_cvt_pk_bf16_f32 v15, v6, v5
 s_waitcnt vmcnt(12) lgkmcnt(8)
 v_mfma_f32_16x16x32_bf16 v[136:139], a[224:227], a[128:131], v[136:139]
 ds_write_b128 v18, v[12:15] offset:12288
 ds_read_b128 v[48:51], v3 offset:12288
 ds_read_b128 v[80:83], v3 offset:13312
 v_mfma_f32_16x16x32_bf16 v[136:139], a[228:231], a[132:135], v[136:139]
 global_load_dwordx4 a[220:223], v0, s[70:71] offset:-1024
 v_accvgpr_read_b32 v5, a16
 v_mfma_f32_16x16x32_bf16 v[140:143], a[228:231], a[140:143], v[140:143]
 v_lshlrev_b32 v6, 16, v5
 v_and_b32 v5, s26, v5
 v_mfma_f32_16x16x32_bf16 v[140:143], a[224:227], a[136:139], v[140:143]
 global_load_dwordx4 a[216:219], v0, s[70:71] offset:-2048
 v_mul_f32 v6, v6, v32
 v_mfma_f32_16x16x32_bf16 v[144:147], a[224:227], a[144:147], v[144:147]
 v_mul_f32 v5, v5, v33
 v_cvt_pk_bf16_f32 v8, v6, v5
 v_mfma_f32_16x16x32_bf16 v[144:147], a[228:231], a[148:151], v[144:147]
 v_accvgpr_read_b32 v5, a17
 v_lshlrev_b32 v6, 16, v5
 v_mfma_f32_16x16x32_bf16 v[148:151], a[228:231], a[156:159], v[148:151]
 v_and_b32 v5, s26, v5
 v_mul_f32 v6, v6, v34
 v_mfma_f32_16x16x32_bf16 v[148:151], a[224:227], a[152:155], v[148:151]
 v_mul_f32 v5, v5, v35
 v_cvt_pk_bf16_f32 v9, v6, v5
 s_waitcnt lgkmcnt(1)
 s_add_u32 s3, s28, 98304
 v_mfma_f32_16x16x32_bf16 v[152:155], a[224:227], a[160:163], v[152:155]
 buffer_store_dwordx4 v[48:51], v16, s[16:19], s3 offen nt
 s_waitcnt lgkmcnt(0)
 s_add_u32 s3, s28, 114688
 buffer_store_dwordx4 v[80:83], v16, s[16:19], s3 offen nt
 v_accvgpr_read_b32 v5, a18
 v_lshlrev_b32 v6, 16, v5
 v_and_b32 v5, s26, v5
 v_mul_f32 v6, v6, v64
 v_mfma_f32_16x16x32_bf16 v[152:155], a[228:231], a[164:167], v[152:155]
 v_mul_f32 v5, v5, v65
 v_cvt_pk_bf16_f32 v10, v6, v5
 v_mfma_f32_16x16x32_bf16 v[156:159], a[228:231], a[172:175], v[156:159]
 v_accvgpr_read_b32 v5, a19
 v_lshlrev_b32 v6, 16, v5
 v_mfma_f32_16x16x32_bf16 v[156:159], a[224:227], a[168:171], v[156:159]
 v_and_b32 v5, s26, v5
 v_mul_f32 v6, v6, v66
 v_mfma_f32_16x16x32_bf16 v[160:163], a[224:227], a[176:179], v[160:163]
 v_mul_f32 v5, v5, v67
 v_cvt_pk_bf16_f32 v11, v6, v5
 v_mfma_f32_16x16x32_bf16 v[160:163], a[228:231], a[180:183], v[160:163]
 ds_write_b128 v17, v[8:11] offset:16384
 v_mfma_f32_16x16x32_bf16 v[164:167], a[228:231], a[188:191], v[164:167]
 v_accvgpr_read_b32 v5, a48
 v_lshlrev_b32 v6, 16, v5
 v_mfma_f32_16x16x32_bf16 v[164:167], a[224:227], a[184:187], v[164:167]
 v_and_b32 v5, s26, v5
 v_mul_f32 v6, v6, v96
 s_waitcnt vmcnt(14)
 v_mfma_f32_16x16x32_bf16 v[196:199], a[232:235], a[184:187], v[196:199]
 v_mul_f32 v5, v5, v97
 v_cvt_pk_bf16_f32 v12, v6, v5
 v_mfma_f32_16x16x32_bf16 v[196:199], a[236:239], a[188:191], v[196:199]
 global_load_dwordx4 a[228:231], v0, s[70:71] offset:1024
 v_accvgpr_read_b32 v5, a49
 v_mfma_f32_16x16x32_bf16 v[192:195], a[236:239], a[180:183], v[192:195]
 v_lshlrev_b32 v6, 16, v5
 v_and_b32 v5, s26, v5
 v_mfma_f32_16x16x32_bf16 v[192:195], a[232:235], a[176:179], v[192:195]
 global_load_dwordx4 a[224:227], v0, s[70:71] offset:0
 v_mul_f32 v6, v6, v98
 v_mfma_f32_16x16x32_bf16 v[188:191], a[232:235], a[168:171], v[188:191]
 v_mul_f32 v5, v5, v99
 v_cvt_pk_bf16_f32 v13, v6, v5
 v_mfma_f32_16x16x32_bf16 v[188:191], a[236:239], a[172:175], v[188:191]
 v_accvgpr_read_b32 v5, a50
 v_lshlrev_b32 v6, 16, v5
 v_mfma_f32_16x16x32_bf16 v[184:187], a[236:239], a[164:167], v[184:187]
 v_and_b32 v5, s26, v5
 v_mul_f32 v6, v6, v128
 v_mfma_f32_16x16x32_bf16 v[184:187], a[232:235], a[160:163], v[184:187]
 v_mul_f32 v5, v5, v129
 v_cvt_pk_bf16_f32 v14, v6, v5
 v_mfma_f32_16x16x32_bf16 v[180:183], a[232:235], a[152:155], v[180:183]
 v_accvgpr_read_b32 v5, a51
 v_lshlrev_b32 v6, 16, v5
 v_mfma_f32_16x16x32_bf16 v[180:183], a[236:239], a[156:159], v[180:183]
 v_and_b32 v5, s26, v5
 v_mul_f32 v6, v6, v130
 v_mfma_f32_16x16x32_bf16 v[176:179], a[236:239], a[148:151], v[176:179]
 v_mul_f32 v5, v5, v131
 v_cvt_pk_bf16_f32 v15, v6, v5
 v_mfma_f32_16x16x32_bf16 v[176:179], a[232:235], a[144:147], v[176:179]
 ds_write_b128 v18, v[12:15] offset:16384
 v_mfma_f32_16x16x32_bf16 v[172:175], a[232:235], a[136:139], v[172:175]
 ds_read_b128 v[48:51], v3 offset:16384
 ds_read_b128 v[80:83], v3 offset:17408
 v_mfma_f32_16x16x32_bf16 v[172:175], a[236:239], a[140:143], v[172:175]
 v_accvgpr_read_b32 v5, a20
 v_lshlrev_b32 v6, 16, v5
 v_mfma_f32_16x16x32_bf16 v[168:171], a[236:239], a[132:135], v[168:171]
 v_and_b32 v5, s26, v5
 v_mul_f32 v6, v6, v36
 v_mfma_f32_16x16x32_bf16 v[168:171], a[232:235], a[128:131], v[168:171]
 v_mul_f32 v5, v5, v37
 v_cvt_pk_bf16_f32 v8, v6, v5
 s_waitcnt vmcnt(12)
 v_mfma_f32_16x16x32_bf16 v[200:203], a[192:195], a[128:131], v[200:203]
 v_accvgpr_read_b32 v5, a21
 v_lshlrev_b32 v6, 16, v5
 v_mfma_f32_16x16x32_bf16 v[200:203], a[196:199], a[132:135], v[200:203]
 global_load_dwordx4 a[236:239], v0, s[70:71] offset:3072
 v_and_b32 v5, s26, v5
 v_mfma_f32_16x16x32_bf16 v[204:207], a[196:199], a[140:143], v[204:207]
 v_mul_f32 v6, v6, v38
 v_mul_f32 v5, v5, v39
 v_mfma_f32_16x16x32_bf16 v[204:207], a[192:195], a[136:139], v[204:207]
 global_load_dwordx4 a[232:235], v0, s[70:71] offset:2048
 v_cvt_pk_bf16_f32 v9, v6, v5
 s_waitcnt lgkmcnt(1)
 s_add_u32 s3, s28, 131072
 v_mfma_f32_16x16x32_bf16 v[208:211], a[192:195], a[144:147], v[208:211]
 buffer_store_dwordx4 v[48:51], v16, s[16:19], s3 offen nt
 s_waitcnt lgkmcnt(0)
 s_add_u32 s3, s28, 147456
 s_add_u32 s70, s70, 1843200
 s_addc_u32 s71, s71, 0
 v_mfma_f32_16x16x32_bf16 v[208:211], a[196:199], a[148:151], v[208:211]
 buffer_store_dwordx4 v[80:83], v16, s[16:19], s3 offen nt
 v_accvgpr_read_b32 v5, a22
 v_lshlrev_b32 v6, 16, v5
 v_and_b32 v5, s26, v5
 v_mul_f32 v6, v6, v68
 v_mfma_f32_16x16x32_bf16 v[212:215], a[196:199], a[156:159], v[212:215]
 v_mul_f32 v5, v5, v69
 v_cvt_pk_bf16_f32 v10, v6, v5
 v_mfma_f32_16x16x32_bf16 v[212:215], a[192:195], a[152:155], v[212:215]
 v_accvgpr_read_b32 v5, a23
 v_lshlrev_b32 v6, 16, v5
 v_mfma_f32_16x16x32_bf16 v[216:219], a[192:195], a[160:163], v[216:219]
 v_and_b32 v5, s26, v5
 v_mul_f32 v6, v6, v70
 v_mfma_f32_16x16x32_bf16 v[216:219], a[196:199], a[164:167], v[216:219]
 v_mul_f32 v5, v5, v71
 v_cvt_pk_bf16_f32 v11, v6, v5
 v_mfma_f32_16x16x32_bf16 v[220:223], a[196:199], a[172:175], v[220:223]
 ds_write_b128 v17, v[8:11] offset:20480
 v_mfma_f32_16x16x32_bf16 v[220:223], a[192:195], a[168:171], v[220:223]
 v_accvgpr_read_b32 v5, a52
 v_lshlrev_b32 v6, 16, v5
 v_mfma_f32_16x16x32_bf16 v[224:227], a[192:195], a[176:179], v[224:227]
 v_and_b32 v5, s26, v5
 v_mul_f32 v6, v6, v100
 v_mfma_f32_16x16x32_bf16 v[224:227], a[196:199], a[180:183], v[224:227]
 v_mul_f32 v5, v5, v101
 v_cvt_pk_bf16_f32 v12, v6, v5
 v_mfma_f32_16x16x32_bf16 v[228:231], a[196:199], a[188:191], v[228:231]
 v_accvgpr_read_b32 v5, a53
 v_lshlrev_b32 v6, 16, v5
 v_mfma_f32_16x16x32_bf16 v[228:231], a[192:195], a[184:187], v[228:231]
 v_and_b32 v5, s26, v5
 v_mul_f32 v6, v6, v102
 s_waitcnt vmcnt(14)
 v_mfma_f32_16x16x32_bf16 a[252:255], a[200:203], a[184:187], a[252:255]
 ds_read_b128 a[184:187], v2 offset:63488
 v_mul_f32 v5, v5, v103
 v_mfma_f32_16x16x32_bf16 a[252:255], a[204:207], a[188:191], a[252:255]
 ds_read_b128 a[188:191], v2 offset:64512
 v_cvt_pk_bf16_f32 v13, v6, v5
 v_mfma_f32_16x16x32_bf16 a[248:251], a[204:207], a[180:183], a[248:251]
 ds_read_b128 a[180:183], v2 offset:60416
 v_accvgpr_read_b32 v5, a54
 v_mfma_f32_16x16x32_bf16 a[248:251], a[200:203], a[176:179], a[248:251]
 ds_read_b128 a[176:179], v2 offset:59392
 v_lshlrev_b32 v6, 16, v5
 v_mfma_f32_16x16x32_bf16 v[252:255], a[200:203], a[168:171], v[252:255]
 ds_read_b128 a[168:171], v2 offset:55296
 v_and_b32 v5, s26, v5
 v_mfma_f32_16x16x32_bf16 v[252:255], a[204:207], a[172:175], v[252:255]
 ds_read_b128 a[172:175], v2 offset:56320
 v_mul_f32 v6, v6, v132
 v_mfma_f32_16x16x32_bf16 v[248:251], a[204:207], a[164:167], v[248:251]
 ds_read_b128 a[164:167], v2 offset:52224
 v_mul_f32 v5, v5, v133
 v_mfma_f32_16x16x32_bf16 v[248:251], a[200:203], a[160:163], v[248:251]
 ds_read_b128 a[160:163], v2 offset:51200
 v_cvt_pk_bf16_f32 v14, v6, v5
 v_mfma_f32_16x16x32_bf16 v[244:247], a[200:203], a[152:155], v[244:247]
 ds_read_b128 a[152:155], v2 offset:47104
 v_accvgpr_read_b32 v5, a55
 v_mfma_f32_16x16x32_bf16 v[244:247], a[204:207], a[156:159], v[244:247]
 ds_read_b128 a[156:159], v2 offset:48128
 v_lshlrev_b32 v6, 16, v5
 v_mfma_f32_16x16x32_bf16 v[240:243], a[204:207], a[148:151], v[240:243]
 ds_read_b128 a[148:151], v2 offset:44032
 v_and_b32 v5, s26, v5
 v_mfma_f32_16x16x32_bf16 v[240:243], a[200:203], a[144:147], v[240:243]
 ds_read_b128 a[144:147], v2 offset:43008
 v_mul_f32 v6, v6, v134
 v_mfma_f32_16x16x32_bf16 v[236:239], a[200:203], a[136:139], v[236:239]
 ds_read_b128 a[136:139], v2 offset:38912
 v_mul_f32 v5, v5, v135
 v_mfma_f32_16x16x32_bf16 v[236:239], a[204:207], a[140:143], v[236:239]
 ds_read_b128 a[140:143], v2 offset:39936
 v_cvt_pk_bf16_f32 v15, v6, v5
 v_mfma_f32_16x16x32_bf16 v[232:235], a[204:207], a[132:135], v[232:235]
 ds_read_b128 a[132:135], v2 offset:35840
 v_mfma_f32_16x16x32_bf16 v[232:235], a[200:203], a[128:131], v[232:235]
 ds_read_b128 a[128:131], v2 offset:34816
 ds_write_b128 v18, v[12:15] offset:20480
 ds_read_b128 v[48:51], v3 offset:20480
 ds_read_b128 v[80:83], v3 offset:21504
 v_accvgpr_read_b32 v5, a24
 v_lshlrev_b32 v6, 16, v5
 s_waitcnt vmcnt(10) lgkmcnt(11)
 v_mfma_f32_16x16x32_bf16 v[164:167], a[208:211], a[184:187], v[164:167]
 v_and_b32 v5, s26, v5
 v_mul_f32 v6, v6, v40
 v_mfma_f32_16x16x32_bf16 v[164:167], a[212:215], a[188:191], v[164:167]
 v_mul_f32 v5, v5, v41
 v_cvt_pk_bf16_f32 v8, v6, v5
 v_mfma_f32_16x16x32_bf16 v[160:163], a[212:215], a[180:183], v[160:163]
 v_accvgpr_read_b32 v5, a25
 v_lshlrev_b32 v6, 16, v5
 v_mfma_f32_16x16x32_bf16 v[160:163], a[208:211], a[176:179], v[160:163]
 v_and_b32 v5, s26, v5
 v_mul_f32 v6, v6, v42
 v_mfma_f32_16x16x32_bf16 v[156:159], a[208:211], a[168:171], v[156:159]
 v_mul_f32 v5, v5, v43
 v_cvt_pk_bf16_f32 v9, v6, v5
 s_waitcnt lgkmcnt(1)
 s_add_u32 s3, s28, 163840
 v_mfma_f32_16x16x32_bf16 v[156:159], a[212:215], a[172:175], v[156:159]
 buffer_store_dwordx4 v[48:51], v16, s[16:19], s3 offen nt
 s_waitcnt lgkmcnt(0)
 s_add_u32 s3, s28, 180224
 buffer_store_dwordx4 v[80:83], v16, s[16:19], s3 offen nt
 v_accvgpr_read_b32 v5, a26
 v_lshlrev_b32 v6, 16, v5
 v_and_b32 v5, s26, v5
 v_mul_f32 v6, v6, v72
 v_mfma_f32_16x16x32_bf16 v[152:155], a[212:215], a[164:167], v[152:155]
 v_mul_f32 v5, v5, v73
 v_cvt_pk_bf16_f32 v10, v6, v5
 v_mfma_f32_16x16x32_bf16 v[152:155], a[208:211], a[160:163], v[152:155]
 v_accvgpr_read_b32 v5, a27
 v_lshlrev_b32 v6, 16, v5
 v_mfma_f32_16x16x32_bf16 v[148:151], a[208:211], a[152:155], v[148:151]
 v_and_b32 v5, s26, v5
 v_mul_f32 v6, v6, v74
 v_mfma_f32_16x16x32_bf16 v[148:151], a[212:215], a[156:159], v[148:151]
 v_mul_f32 v5, v5, v75
 v_cvt_pk_bf16_f32 v11, v6, v5
 v_mfma_f32_16x16x32_bf16 v[144:147], a[212:215], a[148:151], v[144:147]
 ds_write_b128 v17, v[8:11] offset:24576
 v_mfma_f32_16x16x32_bf16 v[144:147], a[208:211], a[144:147], v[144:147]
 v_accvgpr_read_b32 v5, a56
 v_lshlrev_b32 v6, 16, v5
 v_mfma_f32_16x16x32_bf16 v[140:143], a[208:211], a[136:139], v[140:143]
 v_and_b32 v5, s26, v5
 v_mul_f32 v6, v6, v104
 v_mfma_f32_16x16x32_bf16 v[140:143], a[212:215], a[140:143], v[140:143]
 v_mul_f32 v5, v5, v105
 v_cvt_pk_bf16_f32 v12, v6, v5
 v_mfma_f32_16x16x32_bf16 v[136:139], a[212:215], a[132:135], v[136:139]
 v_accvgpr_read_b32 v5, a57
 v_lshlrev_b32 v6, 16, v5
 v_mfma_f32_16x16x32_bf16 v[136:139], a[208:211], a[128:131], v[136:139]
 v_and_b32 v5, s26, v5
 v_mul_f32 v6, v6, v106
 s_waitcnt vmcnt(10)
 v_mfma_f32_16x16x32_bf16 v[168:171], a[216:219], a[128:131], v[168:171]
 v_mul_f32 v5, v5, v107
 v_cvt_pk_bf16_f32 v13, v6, v5
 v_mfma_f32_16x16x32_bf16 v[168:171], a[220:223], a[132:135], v[168:171]
 v_accvgpr_read_b32 v5, a58
 v_accvgpr_read_b32 v7, a240
 v_mfma_f32_16x16x32_bf16 v[172:175], a[220:223], a[140:143], v[172:175]
 v_lshlrev_b32 v6, 16, v5
 v_and_b32 v5, s26, v5
 v_mfma_f32_16x16x32_bf16 v[172:175], a[216:219], a[136:139], v[172:175]
 v_mul_f32 v6, v6, v7
 v_accvgpr_read_b32 v7, a241
 v_mfma_f32_16x16x32_bf16 v[176:179], a[216:219], a[144:147], v[176:179]
 v_mul_f32 v5, v5, v7
 v_cvt_pk_bf16_f32 v14, v6, v5
 v_mfma_f32_16x16x32_bf16 v[176:179], a[220:223], a[148:151], v[176:179]
 v_accvgpr_read_b32 v5, a59
 v_accvgpr_read_b32 v7, a242
 v_mfma_f32_16x16x32_bf16 v[180:183], a[220:223], a[156:159], v[180:183]
 v_lshlrev_b32 v6, 16, v5
 v_and_b32 v5, s26, v5
 v_mfma_f32_16x16x32_bf16 v[180:183], a[216:219], a[152:155], v[180:183]
 v_mul_f32 v6, v6, v7
 v_accvgpr_read_b32 v7, a243
 v_mfma_f32_16x16x32_bf16 v[184:187], a[216:219], a[160:163], v[184:187]
 v_mul_f32 v5, v5, v7
 v_cvt_pk_bf16_f32 v15, v6, v5
 v_mfma_f32_16x16x32_bf16 v[184:187], a[220:223], a[164:167], v[184:187]
 ds_write_b128 v18, v[12:15] offset:24576
 v_mfma_f32_16x16x32_bf16 v[188:191], a[220:223], a[172:175], v[188:191]
 ds_read_b128 v[48:51], v3 offset:24576
 ds_read_b128 v[80:83], v3 offset:25600
 v_mfma_f32_16x16x32_bf16 v[188:191], a[216:219], a[168:171], v[188:191]
 v_accvgpr_read_b32 v5, a28
 v_mfma_f32_16x16x32_bf16 v[192:195], a[216:219], a[176:179], v[192:195]
 v_lshlrev_b32 v6, 16, v5
 v_and_b32 v5, s26, v5
 v_mfma_f32_16x16x32_bf16 v[192:195], a[220:223], a[180:183], v[192:195]
 v_mul_f32 v6, v6, v44
 v_mul_f32 v5, v5, v45
 v_mfma_f32_16x16x32_bf16 v[196:199], a[220:223], a[188:191], v[196:199]
 v_cvt_pk_bf16_f32 v8, v6, v5
 v_accvgpr_read_b32 v5, a29
 v_mfma_f32_16x16x32_bf16 v[196:199], a[216:219], a[184:187], v[196:199]
 v_lshlrev_b32 v6, 16, v5
 v_and_b32 v5, s26, v5
 s_waitcnt vmcnt(6)
 v_mfma_f32_16x16x32_bf16 v[228:231], a[224:227], a[184:187], v[228:231]
 v_mul_f32 v6, v6, v46
 v_mul_f32 v5, v5, v47
 v_mfma_f32_16x16x32_bf16 v[228:231], a[228:231], a[188:191], v[228:231]
 v_cvt_pk_bf16_f32 v9, v6, v5
 s_waitcnt lgkmcnt(1)
 v_mfma_f32_16x16x32_bf16 v[224:227], a[228:231], a[180:183], v[224:227]
 s_add_u32 s3, s28, 196608
 buffer_store_dwordx4 v[48:51], v16, s[16:19], s3 offen nt
 v_mfma_f32_16x16x32_bf16 v[224:227], a[224:227], a[176:179], v[224:227]
 s_waitcnt lgkmcnt(0)
 s_add_u32 s3, s28, 212992
 v_mfma_f32_16x16x32_bf16 v[220:223], a[224:227], a[168:171], v[220:223]
 buffer_store_dwordx4 v[80:83], v16, s[16:19], s3 offen nt
 v_accvgpr_read_b32 v5, a30
 v_mfma_f32_16x16x32_bf16 v[220:223], a[228:231], a[172:175], v[220:223]
 v_lshlrev_b32 v6, 16, v5
 v_mfma_f32_16x16x32_bf16 v[216:219], a[228:231], a[164:167], v[216:219]
 v_and_b32 v5, s26, v5
 v_mul_f32 v6, v6, v76
 v_mfma_f32_16x16x32_bf16 v[216:219], a[224:227], a[160:163], v[216:219]
 v_mul_f32 v5, v5, v77
 v_cvt_pk_bf16_f32 v10, v6, v5
 v_mfma_f32_16x16x32_bf16 v[212:215], a[224:227], a[152:155], v[212:215]
 v_accvgpr_read_b32 v5, a31
 v_lshlrev_b32 v6, 16, v5
 v_mfma_f32_16x16x32_bf16 v[212:215], a[228:231], a[156:159], v[212:215]
 v_and_b32 v5, s26, v5
 v_mul_f32 v6, v6, v78
 v_mfma_f32_16x16x32_bf16 v[208:211], a[228:231], a[148:151], v[208:211]
 v_mul_f32 v5, v5, v79
 v_cvt_pk_bf16_f32 v11, v6, v5
 v_mfma_f32_16x16x32_bf16 v[208:211], a[224:227], a[144:147], v[208:211]
 ds_write_b128 v17, v[8:11] offset:28672
 v_mfma_f32_16x16x32_bf16 v[204:207], a[224:227], a[136:139], v[204:207]
 v_accvgpr_read_b32 v5, a60
 v_lshlrev_b32 v6, 16, v5
 v_mfma_f32_16x16x32_bf16 v[204:207], a[228:231], a[140:143], v[204:207]
 v_and_b32 v5, s26, v5
 v_mul_f32 v6, v6, v108
 v_mfma_f32_16x16x32_bf16 v[200:203], a[228:231], a[132:135], v[200:203]
 v_mul_f32 v5, v5, v109
 v_cvt_pk_bf16_f32 v12, v6, v5
 v_mfma_f32_16x16x32_bf16 v[200:203], a[224:227], a[128:131], v[200:203]
 v_accvgpr_read_b32 v5, a61
 v_lshlrev_b32 v6, 16, v5
 s_waitcnt vmcnt(6)
 v_mfma_f32_16x16x32_bf16 v[232:235], a[232:235], a[128:131], v[232:235]
 v_and_b32 v5, s26, v5
 v_mul_f32 v6, v6, v110
 v_mfma_f32_16x16x32_bf16 v[232:235], a[236:239], a[132:135], v[232:235]
 v_mul_f32 v5, v5, v111
 v_cvt_pk_bf16_f32 v13, v6, v5
 v_mfma_f32_16x16x32_bf16 v[236:239], a[236:239], a[140:143], v[236:239]
 v_accvgpr_read_b32 v5, a62
 v_accvgpr_read_b32 v7, a244
 v_mfma_f32_16x16x32_bf16 v[236:239], a[232:235], a[136:139], v[236:239]
 v_lshlrev_b32 v6, 16, v5
 v_and_b32 v5, s26, v5
 v_mfma_f32_16x16x32_bf16 v[240:243], a[232:235], a[144:147], v[240:243]
 v_mul_f32 v6, v6, v7
 v_accvgpr_read_b32 v7, a245
 v_mfma_f32_16x16x32_bf16 v[240:243], a[236:239], a[148:151], v[240:243]
 v_mul_f32 v5, v5, v7
 v_cvt_pk_bf16_f32 v14, v6, v5
 v_mfma_f32_16x16x32_bf16 v[244:247], a[236:239], a[156:159], v[244:247]
 v_accvgpr_read_b32 v5, a63
 v_accvgpr_read_b32 v7, a246
 v_mfma_f32_16x16x32_bf16 v[244:247], a[232:235], a[152:155], v[244:247]
 v_lshlrev_b32 v6, 16, v5
 v_and_b32 v5, s26, v5
 v_mfma_f32_16x16x32_bf16 v[248:251], a[232:235], a[160:163], v[248:251]
 v_mul_f32 v6, v6, v7
 v_accvgpr_read_b32 v7, a247
 v_mfma_f32_16x16x32_bf16 v[248:251], a[236:239], a[164:167], v[248:251]
 v_mul_f32 v5, v5, v7
 v_cvt_pk_bf16_f32 v15, v6, v5
 v_mfma_f32_16x16x32_bf16 v[252:255], a[236:239], a[172:175], v[252:255]
 ds_write_b128 v18, v[12:15] offset:28672
 v_mfma_f32_16x16x32_bf16 v[252:255], a[232:235], a[168:171], v[252:255]
 ds_read_b128 v[48:51], v3 offset:28672
 ds_read_b128 v[80:83], v3 offset:29696
 v_mfma_f32_16x16x32_bf16 a[248:251], a[232:235], a[176:179], a[248:251]
 s_waitcnt lgkmcnt(1)
 s_add_u32 s3, s28, 229376
 v_mfma_f32_16x16x32_bf16 a[248:251], a[236:239], a[180:183], a[248:251]
 buffer_store_dwordx4 v[48:51], v16, s[16:19], s3 offen nt
 s_waitcnt lgkmcnt(0)
 v_mfma_f32_16x16x32_bf16 a[252:255], a[236:239], a[188:191], a[252:255]
 s_add_u32 s3, s28, 245760
 buffer_store_dwordx4 v[80:83], v16, s[16:19], s3 offen nt
 v_mfma_f32_16x16x32_bf16 a[252:255], a[232:235], a[184:187], a[252:255]
 s_nop 7
 v_accvgpr_read_b32 v7, a64
 v_lshlrev_b32 v6, 16, v7
 v_and_b32 v7, s26, v7
 v_pk_mul_f32 v[6:7], v[6:7], v[136:137]
 v_cvt_pk_bf16_f32 v8, v6, v7
 v_accvgpr_read_b32 v7, a65
 v_lshlrev_b32 v6, 16, v7
 v_and_b32 v7, s26, v7
 v_pk_mul_f32 v[6:7], v[6:7], v[138:139]
 v_cvt_pk_bf16_f32 v9, v6, v7
 v_accvgpr_read_b32 v7, a66
 v_lshlrev_b32 v6, 16, v7
 v_and_b32 v7, s26, v7
 v_pk_mul_f32 v[6:7], v[6:7], v[168:169]
 v_cvt_pk_bf16_f32 v10, v6, v7
 v_accvgpr_read_b32 v7, a67
 v_lshlrev_b32 v6, 16, v7
 v_and_b32 v7, s26, v7
 v_pk_mul_f32 v[6:7], v[6:7], v[170:171]
 v_cvt_pk_bf16_f32 v11, v6, v7
 ds_write_b128 v17, v[8:11]
 v_accvgpr_read_b32 v7, a96
 v_lshlrev_b32 v6, 16, v7
 v_and_b32 v7, s26, v7
 v_pk_mul_f32 v[6:7], v[6:7], v[200:201]
 v_cvt_pk_bf16_f32 v12, v6, v7
 v_accvgpr_read_b32 v7, a97
 v_lshlrev_b32 v6, 16, v7
 v_and_b32 v7, s26, v7
 v_pk_mul_f32 v[6:7], v[6:7], v[202:203]
 v_cvt_pk_bf16_f32 v13, v6, v7
 v_accvgpr_read_b32 v7, a98
 v_lshlrev_b32 v6, 16, v7
 v_and_b32 v7, s26, v7
 v_pk_mul_f32 v[6:7], v[6:7], v[232:233]
 v_cvt_pk_bf16_f32 v14, v6, v7
 v_accvgpr_read_b32 v7, a99
 v_lshlrev_b32 v6, 16, v7
 v_and_b32 v7, s26, v7
 v_pk_mul_f32 v[6:7], v[6:7], v[234:235]
 v_cvt_pk_bf16_f32 v15, v6, v7
 ds_write_b128 v18, v[12:15]
 ds_read_b128 v[48:51], v3
 ds_read_b128 v[80:83], v3 offset:1024
 v_accvgpr_read_b32 v7, a68
 v_lshlrev_b32 v6, 16, v7
 v_and_b32 v7, s26, v7
 v_pk_mul_f32 v[6:7], v[6:7], v[140:141]
 v_cvt_pk_bf16_f32 v8, v6, v7
 v_accvgpr_read_b32 v7, a69
 v_lshlrev_b32 v6, 16, v7
 v_and_b32 v7, s26, v7
 v_pk_mul_f32 v[6:7], v[6:7], v[142:143]
 v_cvt_pk_bf16_f32 v9, v6, v7
 v_accvgpr_read_b32 v7, a70
 v_lshlrev_b32 v6, 16, v7
 s_waitcnt lgkmcnt(1)
 s_add_u32 s3, s28, 0
 buffer_store_dwordx4 v[48:51], v16, s[16:19], s3 offen offset:128 nt
 s_waitcnt lgkmcnt(0)
 s_add_u32 s3, s28, 16384
 buffer_store_dwordx4 v[80:83], v16, s[16:19], s3 offen offset:128 nt
 v_and_b32 v7, s26, v7
 v_pk_mul_f32 v[6:7], v[6:7], v[172:173]
 v_cvt_pk_bf16_f32 v10, v6, v7
 v_accvgpr_read_b32 v7, a71
 v_lshlrev_b32 v6, 16, v7
 v_and_b32 v7, s26, v7
 v_pk_mul_f32 v[6:7], v[6:7], v[174:175]
 v_cvt_pk_bf16_f32 v11, v6, v7
 ds_write_b128 v17, v[8:11] offset:4096
 v_accvgpr_read_b32 v7, a100
 v_lshlrev_b32 v6, 16, v7
 v_and_b32 v7, s26, v7
 v_pk_mul_f32 v[6:7], v[6:7], v[204:205]
 v_cvt_pk_bf16_f32 v12, v6, v7
 v_accvgpr_read_b32 v7, a101
 v_lshlrev_b32 v6, 16, v7
 v_and_b32 v7, s26, v7
 v_pk_mul_f32 v[6:7], v[6:7], v[206:207]
 v_cvt_pk_bf16_f32 v13, v6, v7
 v_accvgpr_read_b32 v7, a102
 v_lshlrev_b32 v6, 16, v7
 v_and_b32 v7, s26, v7
 v_pk_mul_f32 v[6:7], v[6:7], v[236:237]
 v_cvt_pk_bf16_f32 v14, v6, v7
 v_accvgpr_read_b32 v7, a103
 v_lshlrev_b32 v6, 16, v7
 v_and_b32 v7, s26, v7
 v_pk_mul_f32 v[6:7], v[6:7], v[238:239]
 v_cvt_pk_bf16_f32 v15, v6, v7
 ds_write_b128 v18, v[12:15] offset:4096
 ds_read_b128 v[48:51], v3 offset:4096
 ds_read_b128 v[80:83], v3 offset:5120
 v_accvgpr_read_b32 v7, a72
 v_lshlrev_b32 v6, 16, v7
 v_and_b32 v7, s26, v7
 v_pk_mul_f32 v[6:7], v[6:7], v[144:145]
 v_cvt_pk_bf16_f32 v8, v6, v7
 v_accvgpr_read_b32 v7, a73
 v_lshlrev_b32 v6, 16, v7
 v_and_b32 v7, s26, v7
 v_pk_mul_f32 v[6:7], v[6:7], v[146:147]
 v_cvt_pk_bf16_f32 v9, v6, v7
 v_accvgpr_read_b32 v7, a74
 v_lshlrev_b32 v6, 16, v7
 s_waitcnt lgkmcnt(1)
 s_add_u32 s3, s28, 32768
 buffer_store_dwordx4 v[48:51], v16, s[16:19], s3 offen offset:128 nt
 s_waitcnt lgkmcnt(0)
 s_add_u32 s3, s28, 49152
 buffer_store_dwordx4 v[80:83], v16, s[16:19], s3 offen offset:128 nt
 v_and_b32 v7, s26, v7
 v_pk_mul_f32 v[6:7], v[6:7], v[176:177]
 v_cvt_pk_bf16_f32 v10, v6, v7
 v_accvgpr_read_b32 v7, a75
 v_lshlrev_b32 v6, 16, v7
 v_and_b32 v7, s26, v7
 v_pk_mul_f32 v[6:7], v[6:7], v[178:179]
 v_cvt_pk_bf16_f32 v11, v6, v7
 ds_write_b128 v17, v[8:11] offset:8192
 v_accvgpr_read_b32 v7, a104
 v_lshlrev_b32 v6, 16, v7
 v_and_b32 v7, s26, v7
 v_pk_mul_f32 v[6:7], v[6:7], v[208:209]
 v_cvt_pk_bf16_f32 v12, v6, v7
 v_accvgpr_read_b32 v7, a105
 v_lshlrev_b32 v6, 16, v7
 v_and_b32 v7, s26, v7
 v_pk_mul_f32 v[6:7], v[6:7], v[210:211]
 v_cvt_pk_bf16_f32 v13, v6, v7
 v_accvgpr_read_b32 v7, a106
 v_lshlrev_b32 v6, 16, v7
 v_and_b32 v7, s26, v7
 v_pk_mul_f32 v[6:7], v[6:7], v[240:241]
 v_cvt_pk_bf16_f32 v14, v6, v7
 v_accvgpr_read_b32 v7, a107
 v_lshlrev_b32 v6, 16, v7
 v_and_b32 v7, s26, v7
 v_pk_mul_f32 v[6:7], v[6:7], v[242:243]
 v_cvt_pk_bf16_f32 v15, v6, v7
 ds_write_b128 v18, v[12:15] offset:8192
 ds_read_b128 v[48:51], v3 offset:8192
 ds_read_b128 v[80:83], v3 offset:9216
 v_accvgpr_read_b32 v7, a76
 v_lshlrev_b32 v6, 16, v7
 v_and_b32 v7, s26, v7
 v_pk_mul_f32 v[6:7], v[6:7], v[148:149]
 v_cvt_pk_bf16_f32 v8, v6, v7
 v_accvgpr_read_b32 v7, a77
 v_lshlrev_b32 v6, 16, v7
 v_and_b32 v7, s26, v7
 v_pk_mul_f32 v[6:7], v[6:7], v[150:151]
 v_cvt_pk_bf16_f32 v9, v6, v7
 v_accvgpr_read_b32 v7, a78
 v_lshlrev_b32 v6, 16, v7
 s_waitcnt lgkmcnt(1)
 s_add_u32 s3, s28, 65536
 buffer_store_dwordx4 v[48:51], v16, s[16:19], s3 offen offset:128 nt
 s_waitcnt lgkmcnt(0)
 s_add_u32 s3, s28, 81920
 buffer_store_dwordx4 v[80:83], v16, s[16:19], s3 offen offset:128 nt
 v_and_b32 v7, s26, v7
 v_pk_mul_f32 v[6:7], v[6:7], v[180:181]
 v_cvt_pk_bf16_f32 v10, v6, v7
 v_accvgpr_read_b32 v7, a79
 v_lshlrev_b32 v6, 16, v7
 v_and_b32 v7, s26, v7
 v_pk_mul_f32 v[6:7], v[6:7], v[182:183]
 v_cvt_pk_bf16_f32 v11, v6, v7
 ds_write_b128 v17, v[8:11] offset:12288
 v_accvgpr_read_b32 v7, a108
 v_lshlrev_b32 v6, 16, v7
 v_and_b32 v7, s26, v7
 v_pk_mul_f32 v[6:7], v[6:7], v[212:213]
 v_cvt_pk_bf16_f32 v12, v6, v7
 v_accvgpr_read_b32 v7, a109
 v_lshlrev_b32 v6, 16, v7
 v_and_b32 v7, s26, v7
 v_pk_mul_f32 v[6:7], v[6:7], v[214:215]
 v_cvt_pk_bf16_f32 v13, v6, v7
 v_accvgpr_read_b32 v7, a110
 v_lshlrev_b32 v6, 16, v7
 v_and_b32 v7, s26, v7
 v_pk_mul_f32 v[6:7], v[6:7], v[244:245]
 v_cvt_pk_bf16_f32 v14, v6, v7
 v_accvgpr_read_b32 v7, a111
 v_lshlrev_b32 v6, 16, v7
 v_and_b32 v7, s26, v7
 v_pk_mul_f32 v[6:7], v[6:7], v[246:247]
 v_cvt_pk_bf16_f32 v15, v6, v7
 ds_write_b128 v18, v[12:15] offset:12288
 ds_read_b128 v[48:51], v3 offset:12288
 ds_read_b128 v[80:83], v3 offset:13312
 v_accvgpr_read_b32 v7, a80
 v_lshlrev_b32 v6, 16, v7
 v_and_b32 v7, s26, v7
 v_pk_mul_f32 v[6:7], v[6:7], v[152:153]
 v_cvt_pk_bf16_f32 v8, v6, v7
 v_accvgpr_read_b32 v7, a81
 v_lshlrev_b32 v6, 16, v7
 v_and_b32 v7, s26, v7
 v_pk_mul_f32 v[6:7], v[6:7], v[154:155]
 v_cvt_pk_bf16_f32 v9, v6, v7
 v_accvgpr_read_b32 v7, a82
 v_lshlrev_b32 v6, 16, v7
 s_waitcnt lgkmcnt(1)
 s_add_u32 s3, s28, 98304
 buffer_store_dwordx4 v[48:51], v16, s[16:19], s3 offen offset:128 nt
 s_waitcnt lgkmcnt(0)
 s_add_u32 s3, s28, 114688
 buffer_store_dwordx4 v[80:83], v16, s[16:19], s3 offen offset:128 nt
 v_and_b32 v7, s26, v7
 v_pk_mul_f32 v[6:7], v[6:7], v[184:185]
 v_cvt_pk_bf16_f32 v10, v6, v7
 v_accvgpr_read_b32 v7, a83
 v_lshlrev_b32 v6, 16, v7
 v_and_b32 v7, s26, v7
 v_pk_mul_f32 v[6:7], v[6:7], v[186:187]
 v_cvt_pk_bf16_f32 v11, v6, v7
 ds_write_b128 v17, v[8:11] offset:16384
 v_accvgpr_read_b32 v7, a112
 v_lshlrev_b32 v6, 16, v7
 v_and_b32 v7, s26, v7
 v_pk_mul_f32 v[6:7], v[6:7], v[216:217]
 v_cvt_pk_bf16_f32 v12, v6, v7
 v_accvgpr_read_b32 v7, a113
 v_lshlrev_b32 v6, 16, v7
 v_and_b32 v7, s26, v7
 v_pk_mul_f32 v[6:7], v[6:7], v[218:219]
 v_cvt_pk_bf16_f32 v13, v6, v7
 v_accvgpr_read_b32 v7, a114
 v_lshlrev_b32 v6, 16, v7
 v_and_b32 v7, s26, v7
 v_pk_mul_f32 v[6:7], v[6:7], v[248:249]
 v_cvt_pk_bf16_f32 v14, v6, v7
 v_accvgpr_read_b32 v7, a115
 v_lshlrev_b32 v6, 16, v7
 v_and_b32 v7, s26, v7
 v_pk_mul_f32 v[6:7], v[6:7], v[250:251]
 v_cvt_pk_bf16_f32 v15, v6, v7
 ds_write_b128 v18, v[12:15] offset:16384
 ds_read_b128 v[48:51], v3 offset:16384
 ds_read_b128 v[80:83], v3 offset:17408
 v_accvgpr_read_b32 v7, a84
 v_lshlrev_b32 v6, 16, v7
 v_and_b32 v7, s26, v7
 v_pk_mul_f32 v[6:7], v[6:7], v[156:157]
 v_cvt_pk_bf16_f32 v8, v6, v7
 v_accvgpr_read_b32 v7, a85
 v_lshlrev_b32 v6, 16, v7
 v_and_b32 v7, s26, v7
 v_pk_mul_f32 v[6:7], v[6:7], v[158:159]
 v_cvt_pk_bf16_f32 v9, v6, v7
 v_accvgpr_read_b32 v7, a86
 v_lshlrev_b32 v6, 16, v7
 s_waitcnt lgkmcnt(1)
 s_add_u32 s3, s28, 131072
 buffer_store_dwordx4 v[48:51], v16, s[16:19], s3 offen offset:128 nt
 s_waitcnt lgkmcnt(0)
 s_add_u32 s3, s28, 147456
 buffer_store_dwordx4 v[80:83], v16, s[16:19], s3 offen offset:128 nt
 v_and_b32 v7, s26, v7
 v_pk_mul_f32 v[6:7], v[6:7], v[188:189]
 v_cvt_pk_bf16_f32 v10, v6, v7
 v_accvgpr_read_b32 v7, a87
 v_lshlrev_b32 v6, 16, v7
 v_and_b32 v7, s26, v7
 v_pk_mul_f32 v[6:7], v[6:7], v[190:191]
 v_cvt_pk_bf16_f32 v11, v6, v7
 ds_write_b128 v17, v[8:11] offset:20480
 v_accvgpr_read_b32 v7, a116
 v_lshlrev_b32 v6, 16, v7
 v_and_b32 v7, s26, v7
 v_pk_mul_f32 v[6:7], v[6:7], v[220:221]
 v_cvt_pk_bf16_f32 v12, v6, v7
 v_accvgpr_read_b32 v7, a117
 v_lshlrev_b32 v6, 16, v7
 v_and_b32 v7, s26, v7
 v_pk_mul_f32 v[6:7], v[6:7], v[222:223]
 v_cvt_pk_bf16_f32 v13, v6, v7
 v_accvgpr_read_b32 v7, a118
 v_lshlrev_b32 v6, 16, v7
 v_and_b32 v7, s26, v7
 v_pk_mul_f32 v[6:7], v[6:7], v[252:253]
 v_cvt_pk_bf16_f32 v14, v6, v7
 v_accvgpr_read_b32 v7, a119
 v_lshlrev_b32 v6, 16, v7
 v_and_b32 v7, s26, v7
 v_pk_mul_f32 v[6:7], v[6:7], v[254:255]
 v_cvt_pk_bf16_f32 v15, v6, v7
 ds_write_b128 v18, v[12:15] offset:20480
 ds_read_b128 v[48:51], v3 offset:20480
 ds_read_b128 v[80:83], v3 offset:21504
 v_accvgpr_read_b32 v7, a88
 v_lshlrev_b32 v6, 16, v7
 v_and_b32 v7, s26, v7
 v_pk_mul_f32 v[6:7], v[6:7], v[160:161]
 v_cvt_pk_bf16_f32 v8, v6, v7
 v_accvgpr_read_b32 v7, a89
 v_lshlrev_b32 v6, 16, v7
 v_and_b32 v7, s26, v7
 v_pk_mul_f32 v[6:7], v[6:7], v[162:163]
 v_cvt_pk_bf16_f32 v9, v6, v7
 v_accvgpr_read_b32 v7, a90
 v_lshlrev_b32 v6, 16, v7
 s_waitcnt lgkmcnt(1)
 s_add_u32 s3, s28, 163840
 buffer_store_dwordx4 v[48:51], v16, s[16:19], s3 offen offset:128 nt
 s_waitcnt lgkmcnt(0)
 s_add_u32 s3, s28, 180224
 buffer_store_dwordx4 v[80:83], v16, s[16:19], s3 offen offset:128 nt
 v_and_b32 v7, s26, v7
 v_pk_mul_f32 v[6:7], v[6:7], v[192:193]
 v_cvt_pk_bf16_f32 v10, v6, v7
 v_accvgpr_read_b32 v7, a91
 v_lshlrev_b32 v6, 16, v7
 v_and_b32 v7, s26, v7
 v_pk_mul_f32 v[6:7], v[6:7], v[194:195]
 v_cvt_pk_bf16_f32 v11, v6, v7
 ds_write_b128 v17, v[8:11] offset:24576
 v_accvgpr_read_b32 v7, a120
 v_lshlrev_b32 v6, 16, v7
 v_and_b32 v7, s26, v7
 v_pk_mul_f32 v[6:7], v[6:7], v[224:225]
 v_cvt_pk_bf16_f32 v12, v6, v7
 v_accvgpr_read_b32 v7, a121
 v_lshlrev_b32 v6, 16, v7
 v_and_b32 v7, s26, v7
 v_pk_mul_f32 v[6:7], v[6:7], v[226:227]
 v_cvt_pk_bf16_f32 v13, v6, v7
 v_accvgpr_read_b32 v7, a122
 v_accvgpr_read_b32 v112, a248
 v_accvgpr_read_b32 v113, a249
 v_lshlrev_b32 v6, 16, v7
 v_and_b32 v7, s26, v7
 v_pk_mul_f32 v[6:7], v[6:7], v[112:113]
 v_cvt_pk_bf16_f32 v14, v6, v7
 v_accvgpr_read_b32 v7, a123
 v_accvgpr_read_b32 v112, a250
 v_accvgpr_read_b32 v113, a251
 v_lshlrev_b32 v6, 16, v7
 v_and_b32 v7, s26, v7
 v_pk_mul_f32 v[6:7], v[6:7], v[112:113]
 v_cvt_pk_bf16_f32 v15, v6, v7
 ds_write_b128 v18, v[12:15] offset:24576
 ds_read_b128 v[48:51], v3 offset:24576
 ds_read_b128 v[80:83], v3 offset:25600
 v_accvgpr_read_b32 v7, a92
 v_lshlrev_b32 v6, 16, v7
 v_and_b32 v7, s26, v7
 v_pk_mul_f32 v[6:7], v[6:7], v[164:165]
 v_cvt_pk_bf16_f32 v8, v6, v7
 v_accvgpr_read_b32 v7, a93
 v_lshlrev_b32 v6, 16, v7
 v_and_b32 v7, s26, v7
 v_pk_mul_f32 v[6:7], v[6:7], v[166:167]
 v_cvt_pk_bf16_f32 v9, v6, v7
 v_accvgpr_read_b32 v7, a94
 v_lshlrev_b32 v6, 16, v7
 s_waitcnt lgkmcnt(1)
 s_add_u32 s3, s28, 196608
 buffer_store_dwordx4 v[48:51], v16, s[16:19], s3 offen offset:128 nt
 s_waitcnt lgkmcnt(0)
 s_add_u32 s3, s28, 212992
 buffer_store_dwordx4 v[80:83], v16, s[16:19], s3 offen offset:128 nt
 v_and_b32 v7, s26, v7
 v_pk_mul_f32 v[6:7], v[6:7], v[196:197]
 v_cvt_pk_bf16_f32 v10, v6, v7
 v_accvgpr_read_b32 v7, a95
 v_lshlrev_b32 v6, 16, v7
 v_and_b32 v7, s26, v7
 v_pk_mul_f32 v[6:7], v[6:7], v[198:199]
 v_cvt_pk_bf16_f32 v11, v6, v7
 ds_write_b128 v17, v[8:11] offset:28672
 v_accvgpr_read_b32 v7, a124
 v_lshlrev_b32 v6, 16, v7
 v_and_b32 v7, s26, v7
 v_pk_mul_f32 v[6:7], v[6:7], v[228:229]
 v_cvt_pk_bf16_f32 v12, v6, v7
 v_accvgpr_read_b32 v7, a125
 v_lshlrev_b32 v6, 16, v7
 v_and_b32 v7, s26, v7
 v_pk_mul_f32 v[6:7], v[6:7], v[230:231]
 v_cvt_pk_bf16_f32 v13, v6, v7
 v_accvgpr_read_b32 v7, a126
 v_accvgpr_read_b32 v112, a252
 v_accvgpr_read_b32 v113, a253
 v_lshlrev_b32 v6, 16, v7
 v_and_b32 v7, s26, v7
 v_pk_mul_f32 v[6:7], v[6:7], v[112:113]
 v_cvt_pk_bf16_f32 v14, v6, v7
 v_accvgpr_read_b32 v7, a127
 v_accvgpr_read_b32 v112, a254
 v_accvgpr_read_b32 v113, a255
 v_lshlrev_b32 v6, 16, v7
 v_and_b32 v7, s26, v7
 v_pk_mul_f32 v[6:7], v[6:7], v[112:113]
 v_cvt_pk_bf16_f32 v15, v6, v7
 ds_write_b128 v18, v[12:15] offset:28672
 ds_read_b128 v[48:51], v3 offset:28672
 ds_read_b128 v[80:83], v3 offset:29696
 s_waitcnt lgkmcnt(1)
 s_add_u32 s3, s28, 229376
 buffer_store_dwordx4 v[48:51], v16, s[16:19], s3 offen offset:128 nt
 s_waitcnt lgkmcnt(0)
 s_add_u32 s3, s28, 245760
 buffer_store_dwordx4 v[80:83], v16, s[16:19], s3 offen offset:128 nt
Lend:
 s_endpgm
Lspin_pro:
 s_add_u32 s53, s53, 1
 v_lshlrev_b32 v4, 2, v1
 v_and_b32 v4, 192, v4
 buffer_load_dword v4, v4, s[44:47], 0 offen sc1
 s_cmp_ge_u32 s53, 0x400000
 s_cbranch_scc1 Lgiveup_pro
 s_waitcnt vmcnt(0)
 v_cmp_gt_i32 vcc, s27, v4
 s_cbranch_vccnz Lspin_pro
Lgiveup_pro:
 s_waitcnt vmcnt(0)
 s_branch Lok_pro
Lspin_pa:
 s_add_u32 s53, s53, 1
 buffer_load_dword v4, off, s[64:67], 0 sc1
 s_cmp_ge_u32 s53, 0x400000
 s_cbranch_scc1 Lgiveup_pa
 s_waitcnt vmcnt(0)
 v_cmp_gt_i32 vcc, s55, v4
 s_cbranch_vccnz Lspin_pa
Lgiveup_pa:
 s_waitcnt vmcnt(0)
 s_branch Lok_pa
Lgat0:
 v_and_b32 v5, 0xf0, v1
 v_lshrrev_b32 v6, 4, v1
 v_and_b32 v6, 0x30, v6
 v_lshl_add_u32 v6, v5, 7, v6
 s_branch Lgatr0
Lspin_pb:
 s_add_u32 s53, s53, 1
 buffer_load_dword v4, off, s[64:67], 0 sc1
 s_cmp_ge_u32 s53, 0x400000
 s_cbranch_scc1 Lgiveup_pb
 s_waitcnt vmcnt(0)
 v_cmp_gt_i32 vcc, s55, v4
 s_cbranch_vccnz Lspin_pb
Lgiveup_pb:
 s_waitcnt vmcnt(0)
 s_branch Lok_pb
Lgat1:
 v_and_b32 v5, 0xf0, v1
 v_lshrrev_b32 v6, 4, v1
 v_and_b32 v6, 0x30, v6
 v_lshl_add_u32 v6, v5, 7, v6
 s_branch Lgatr1
Lspin_w:
 s_add_u32 s53, s53, 1
 v_lshlrev_b32 v4, 2, v1
 v_and_b32 v4, 192, v4
 buffer_load_dword v4, v4, s[44:47], 0 offen sc1
 s_cmp_ge_u32 s53, 0x400000
 s_cbranch_scc1 Lgiveup_w
 s_waitcnt vmcnt(0)
 v_cmp_gt_i32 vcc, s27, v4
 s_cbranch_vccnz Lspin_w
Lgiveup_w:
 s_waitcnt vmcnt(0)
 s_branch Lok_w
.section .rodata,"a"
.p2align 6
.amdhsa_kernel standalone__cross_network_dcn__recsys_kernel
  .amdhsa_next_free_vgpr 512
  .amdhsa_next_free_sgpr 102
  .amdhsa_accum_offset 256
  .amdhsa_group_segment_fixed_size 0
  .amdhsa_kernarg_size 48
  .amdhsa_user_sgpr_count 2
  .amdhsa_user_sgpr_kernarg_segment_ptr 1
  .amdhsa_system_sgpr_workgroup_id_x 1
  .amdhsa_float_denorm_mode_32 3
.end_amdhsa_kernel
```

```asm
; @launch grid=(256,1,1) block=(256,1,1) lds=151552
.amdgcn_target "amdgcn-amd-amdhsa--gfx950"
.text
.globl standalone__cross_network_dcn__recsys_kernel
.p2align 8
.type standalone__cross_network_dcn__recsys_kernel,@function
standalone__cross_network_dcn__recsys_kernel:
 s_cmp_ge_u32 s2, 256
 s_cbranch_scc1 Lend
 s_load_dwordx4 s[56:59], s[0:1], 0
 s_load_dwordx4 s[60:63], s[0:1], 16
 s_load_dwordx4 s[64:67], s[0:1], 32
 v_lshrrev_b32 v9, 6, v0
 v_and_b32 v10, 63, v0
 v_readfirstlane_b32 s54, v9
 v_lshlrev_b32 v1, 4, v10
 s_getpc_b64 s[4:5]
Lpc:
 v_lshlrev_b32 v11, 6, v0
 v_min_u32 v12, Lend-Lpc, v11
 global_load_dword v60, v12, s[4:5]
 v_add_u32 v11, 16384, v11
 v_min_u32 v12, Lend-Lpc, v11
 global_load_dword v61, v12, s[4:5]
 v_add_u32 v11, 16384, v11
 v_min_u32 v12, Lend-Lpc, v11
 global_load_dword v62, v12, s[4:5]
 v_add_u32 v11, 16384, v11
 v_min_u32 v12, Lend-Lpc, v11
 global_load_dword v63, v12, s[4:5]
 v_add_u32 v11, 16384, v11
 v_lshrrev_b32 v11, 7, v0
 v_and_b32 v12, 127, v0
 v_lshlrev_b32 v12, 3, v12
 v_lshl_add_u32 v30, v11, 11, v12
 v_lshlrev_b32 v31, 4, v0
 v_add_u32 v31, 131072, v31
 v_add_u32 v2, 65536, v1
 v_lshl_add_u32 v3, v9, 15, v1
 v_lshl_add_u32 v0, v9, 18, v1
 v_lshrrev_b32 v11, 4, v10
 v_and_b32 v12, 15, v10
 v_xor_b32 v13, v11, v12
 v_lshlrev_b32 v13, 4, v13
 v_lshl_add_u32 v20, v11, 11, v13
 v_xor_b32 v21, 64, v20
 v_xor_b32 v22, 128, v20
 v_xor_b32 v23, 192, v20
 v_lshl_add_u32 v24, v12, 8, v13
 v_lshl_add_u32 v24, v9, 15, v24
 v_xor_b32 v25, 64, v24
 v_xor_b32 v26, 128, v24
 v_xor_b32 v27, 192, v24
 s_and_b32 s7, s2, 1
 s_lshr_b32 s28, s2, 1
 s_lshl_b32 s28, s28, 18
 s_lshl_b32 s6, s7, 10
 s_add_u32 s28, s28, s6
 s_lshl_b32 s6, s54, 8
 s_add_u32 s28, s28, s6
 s_mov_b32 s26, 0xffff0000
 s_lshl_b32 s24, s7, 20
 s_mov_b32 s25, 0
 s_mov_b32 s53, 0
 s_mov_b32 s31, -1
 s_mov_b32 s27, 64
 s_mov_b32 s55, -1
 s_lshl_b32 s50, s54, 15
 s_lshl_b32 s29, s2, 17
 s_add_u32 s29, s29, 33554432
 s_xor_b32 s30, s29, 131072
 s_lshr_b32 s4, s2, 3
 s_and_b32 s5, s2, 7
 s_lshl_b32 s48, s4, 16
 s_lshl_b32 s6, s5, 8
 s_add_u32 s48, s48, s6
 s_lshl_b32 s6, s54, 6
 s_add_u32 s48, s48, s6
 s_lshl_b32 s49, s5, 18
 s_and_b32 s6, s4, 1
 s_lshl_b32 s6, s6, 10
 s_add_u32 s49, s49, s6
 s_lshr_b32 s6, s4, 4
 s_lshr_b32 s5, s5, 2
 s_xor_b32 s5, s5, s6
 s_bfe_u32 s6, s4, 0x10001
 s_lshl_b32 s3, s5, 1
 s_add_u32 s3, s3, s6
 s_lshl_b32 s3, s3, 16
 s_add_u32 s49, s49, s3
 s_bfe_u32 s4, s4, 0x20002
 s_xor_b32 s5, s5, s6
 s_lshr_b32 s3, s54, 1
 s_lshl_b32 s3, s3, 4
 s_lshl_b32 s6, s4, 2
 s_add_u32 s3, s3, s6
 s_and_b32 s6, s54, 1
 s_lshl_b32 s6, s6, 1
 s_add_u32 s3, s3, s6
 s_lshl_b32 s4, s4, 3
 s_lshl_b32 s6, s54, 1
 s_add_u32 s4, s4, s6
 s_cmp_eq_u32 s5, 0
 s_cselect_b32 s3, s3, s4
 s_lshl_b32 s3, s3, 11
 s_add_u32 s49, s49, s3
 s_lshl_b32 s52, s54, 11
 s_add_u32 s52, s52, 143360
 s_lshl_b32 s51, s54, 9
 s_add_u32 s51, s51, 131072
 s_waitcnt lgkmcnt(0)
 s_mov_b32 s40, s58
 s_mov_b32 s41, s59
 s_mov_b32 s42, 0xc00000
 s_mov_b32 s43, 0x20000
 v_lshrrev_b32 v5, 6, v1
 v_and_b32 v6, 48, v1
 v_lshl_add_u32 v5, v5, 11, v6
 s_mov_b32 m0, s52
 s_add_u32 s3, s48, 31744
 buffer_load_dwordx4 v5, s[40:43], s48 offen lds
 buffer_load_dwordx4 v5, s[40:43], s3 offen offset:1024 lds
 s_add_u32 s48, s48, 2097152
 s_mov_b32 s20, s60
 s_mov_b32 s21, s61
 s_mov_b32 s22, 0x3000
 s_mov_b32 s23, 0x20000
 s_lshl_b32 s3, s7, 10
 buffer_load_dwordx2 v[32:33], v30, s[20:23], s3 offen
 s_add_u32 s3, s3, 4096
 buffer_load_dwordx2 v[34:35], v30, s[20:23], s3 offen
 s_add_u32 s3, s3, 4096
 buffer_load_dwordx2 v[36:37], v30, s[20:23], s3 offen
 s_add_u32 s3, s3, 4096
 s_mov_b32 s8, s56
 s_mov_b32 s9, s57
 s_mov_b32 s10, 0x2000000
 s_mov_b32 s11, 0x20000
 s_mov_b32 s16, s62
 s_mov_b32 s17, s63
 s_mov_b32 s18, 0x2000000
 s_mov_b32 s19, 0x20000
 s_mov_b32 s12, s66
 s_mov_b32 s13, s67
 s_mov_b32 s14, 0xc00000
 s_mov_b32 s15, 0x20000
 s_mov_b32 s32, s66
 s_mov_b32 s33, s67
 s_mov_b32 s34, 0x10000000
 s_mov_b32 s35, 0x20000
 s_mov_b32 s44, s64
 s_mov_b32 s45, s65
 s_mov_b32 s46, 0x100
 s_mov_b32 s47, 0x20000
 s_add_u32 s24, s24, 4096
 s_add_u32 s70, s66, s24
 s_addc_u32 s71, s67, 0
 s_sub_u32 s24, s24, 4096
 s_and_b32 s3, s2, 3
 s_lshl_b32 s3, s3, 6
 s_add_u32 s56, s44, s3
 s_addc_u32 s57, s45, 0
 s_mov_b32 s58, 0x4
 s_mov_b32 s59, 0x20000
 s_lshl_b32 s3, s2, 2
 s_add_u32 s3, s3, s54
 s_lshl_b32 s3, s3, 7
 s_add_u32 s3, s3, 15728640
 s_add_u32 s60, s32, s3
 s_addc_u32 s61, s33, 0
 s_mov_b32 s62, 0x4
 s_mov_b32 s63, 0x20000
 s_xor_b32 s3, s3, 512
 s_add_u32 s64, s32, s3
 s_addc_u32 s65, s33, 0
 s_mov_b32 s66, 0x4
 s_mov_b32 s67, 0x20000
 v_mov_b32 v7, 0
 buffer_store_dword v7, v1, s[60:63], 0 offen sc1
 s_add_u32 m0, s50, 0
 s_add_u32 s3, s28, 0
 buffer_load_dwordx4 v20, s[8:11], s3 offen lds
 s_add_u32 m0, s50, 1024
 s_add_u32 s3, s28, 8192
 buffer_load_dwordx4 v21, s[8:11], s3 offen lds
 s_add_u32 m0, s50, 2048
 s_add_u32 s3, s28, 16384
 buffer_load_dwordx4 v22, s[8:11], s3 offen lds
 s_add_u32 m0, s50, 3072
 s_add_u32 s3, s28, 24576
 buffer_load_dwordx4 v23, s[8:11], s3 offen lds
 v_mov_b32 v72, 1.0
 v_mov_b32 v73, 1.0
 v_mov_b32 v74, 1.0
 v_mov_b32 v75, 1.0
 v_mov_b32 v76, 1.0
 v_mov_b32 v77, 1.0
 v_mov_b32 v78, 1.0
 v_mov_b32 v79, 1.0
 v_mov_b32 v80, 1.0
 v_mov_b32 v81, 1.0
 v_mov_b32 v82, 1.0
 v_mov_b32 v83, 1.0
 v_mov_b32 v84, 1.0
 v_mov_b32 v85, 1.0
 v_mov_b32 v86, 1.0
 v_mov_b32 v87, 1.0
 v_mov_b32 v88, 1.0
 v_mov_b32 v89, 1.0
 v_mov_b32 v90, 1.0
 v_mov_b32 v91, 1.0
 v_mov_b32 v92, 1.0
 v_mov_b32 v93, 1.0
 v_mov_b32 v94, 1.0
 v_mov_b32 v95, 1.0
 v_mov_b32 v96, 1.0
 v_mov_b32 v97, 1.0
 v_mov_b32 v98, 1.0
 v_mov_b32 v99, 1.0
 v_mov_b32 v100, 1.0
 v_mov_b32 v101, 1.0
 v_mov_b32 v102, 1.0
 v_mov_b32 v103, 1.0
 v_mov_b32 v104, 1.0
 v_mov_b32 v105, 1.0
 v_mov_b32 v106, 1.0
 v_mov_b32 v107, 1.0
 v_mov_b32 v108, 1.0
 v_mov_b32 v109, 1.0
 v_mov_b32 v110, 1.0
 v_mov_b32 v111, 1.0
 v_mov_b32 v112, 1.0
 v_mov_b32 v113, 1.0
 v_mov_b32 v114, 1.0
 v_mov_b32 v115, 1.0
 v_mov_b32 v116, 1.0
 v_mov_b32 v117, 1.0
 v_mov_b32 v118, 1.0
 v_mov_b32 v119, 1.0
 v_mov_b32 v120, 1.0
 v_mov_b32 v121, 1.0
 v_mov_b32 v122, 1.0
 v_mov_b32 v123, 1.0
 v_mov_b32 v124, 1.0
 v_mov_b32 v125, 1.0
 v_mov_b32 v126, 1.0
 v_mov_b32 v127, 1.0
 v_mov_b32 v128, 1.0
 v_mov_b32 v129, 1.0
 v_mov_b32 v130, 1.0
 v_mov_b32 v131, 1.0
 v_mov_b32 v132, 1.0
 v_mov_b32 v133, 1.0
 v_mov_b32 v134, 1.0
 v_mov_b32 v135, 1.0
 v_accvgpr_write_b32 a240, 1.0
 v_accvgpr_write_b32 a241, 1.0
 v_accvgpr_write_b32 a242, 1.0
 v_accvgpr_write_b32 a243, 1.0
 v_accvgpr_write_b32 a244, 1.0
 v_accvgpr_write_b32 a245, 1.0
 v_accvgpr_write_b32 a246, 1.0
 v_accvgpr_write_b32 a247, 1.0
 v_mov_b32 v136, 1.0
 v_mov_b32 v137, 1.0
 v_mov_b32 v138, 1.0
 v_mov_b32 v139, 1.0
 v_mov_b32 v140, 1.0
 v_mov_b32 v141, 1.0
 v_mov_b32 v142, 1.0
 v_mov_b32 v143, 1.0
 v_mov_b32 v144, 1.0
 v_mov_b32 v145, 1.0
 v_mov_b32 v146, 1.0
 v_mov_b32 v147, 1.0
 v_mov_b32 v148, 1.0
 v_mov_b32 v149, 1.0
 v_mov_b32 v150, 1.0
 v_mov_b32 v151, 1.0
 v_mov_b32 v152, 1.0
 v_mov_b32 v153, 1.0
 v_mov_b32 v154, 1.0
 v_mov_b32 v155, 1.0
 v_mov_b32 v156, 1.0
 v_mov_b32 v157, 1.0
 v_mov_b32 v158, 1.0
 v_mov_b32 v159, 1.0
 v_mov_b32 v160, 1.0
 v_mov_b32 v161, 1.0
 v_mov_b32 v162, 1.0
 v_mov_b32 v163, 1.0
 v_mov_b32 v164, 1.0
 v_mov_b32 v165, 1.0
 v_mov_b32 v166, 1.0
 v_mov_b32 v167, 1.0
 v_mov_b32 v168, 1.0
 v_mov_b32 v169, 1.0
 v_mov_b32 v170, 1.0
 v_mov_b32 v171, 1.0
 v_mov_b32 v172, 1.0
 v_mov_b32 v173, 1.0
 v_mov_b32 v174, 1.0
 v_mov_b32 v175, 1.0
 v_mov_b32 v176, 1.0
 v_mov_b32 v177, 1.0
 v_mov_b32 v178, 1.0
 v_mov_b32 v179, 1.0
 v_mov_b32 v180, 1.0
 v_mov_b32 v181, 1.0
 v_mov_b32 v182, 1.0
 v_mov_b32 v183, 1.0
 v_mov_b32 v184, 1.0
 v_mov_b32 v185, 1.0
 v_mov_b32 v186, 1.0
 v_mov_b32 v187, 1.0
 v_mov_b32 v188, 1.0
 v_mov_b32 v189, 1.0
 v_mov_b32 v190, 1.0
 v_mov_b32 v191, 1.0
 v_mov_b32 v192, 1.0
 v_mov_b32 v193, 1.0
 v_mov_b32 v194, 1.0
 v_mov_b32 v195, 1.0
 v_mov_b32 v196, 1.0
 v_mov_b32 v197, 1.0
 v_mov_b32 v198, 1.0
 v_mov_b32 v199, 1.0
 v_mov_b32 v200, 1.0
 v_mov_b32 v201, 1.0
 v_mov_b32 v202, 1.0
 v_mov_b32 v203, 1.0
 v_mov_b32 v204, 1.0
 v_mov_b32 v205, 1.0
 v_mov_b32 v206, 1.0
 v_mov_b32 v207, 1.0
 v_mov_b32 v208, 1.0
 v_mov_b32 v209, 1.0
 v_mov_b32 v210, 1.0
 v_mov_b32 v211, 1.0
 v_mov_b32 v212, 1.0
 v_mov_b32 v213, 1.0
 v_mov_b32 v214, 1.0
 v_mov_b32 v215, 1.0
 v_mov_b32 v216, 1.0
 v_mov_b32 v217, 1.0
 v_mov_b32 v218, 1.0
 v_mov_b32 v219, 1.0
 v_mov_b32 v220, 1.0
 v_mov_b32 v221, 1.0
 v_mov_b32 v222, 1.0
 v_mov_b32 v223, 1.0
 v_mov_b32 v224, 1.0
 v_mov_b32 v225, 1.0
 v_mov_b32 v226, 1.0
 v_mov_b32 v227, 1.0
 v_mov_b32 v228, 1.0
 v_mov_b32 v229, 1.0
 v_mov_b32 v230, 1.0
 v_mov_b32 v231, 1.0
 v_mov_b32 v232, 1.0
 v_mov_b32 v233, 1.0
 v_mov_b32 v234, 1.0
 v_mov_b32 v235, 1.0
 v_mov_b32 v236, 1.0
 v_mov_b32 v237, 1.0
 v_mov_b32 v238, 1.0
 v_mov_b32 v239, 1.0
 v_mov_b32 v240, 1.0
 v_mov_b32 v241, 1.0
 v_mov_b32 v242, 1.0
 v_mov_b32 v243, 1.0
 v_mov_b32 v244, 1.0
 v_mov_b32 v245, 1.0
 v_mov_b32 v246, 1.0
 v_mov_b32 v247, 1.0
 v_mov_b32 v248, 1.0
 v_mov_b32 v249, 1.0
 v_mov_b32 v250, 1.0
 v_mov_b32 v251, 1.0
 v_mov_b32 v252, 1.0
 v_mov_b32 v253, 1.0
 v_mov_b32 v254, 1.0
 v_mov_b32 v255, 1.0
 v_accvgpr_write_b32 a248, 1.0
 v_accvgpr_write_b32 a249, 1.0
 v_accvgpr_write_b32 a250, 1.0
 v_accvgpr_write_b32 a251, 1.0
 v_accvgpr_write_b32 a252, 1.0
 v_accvgpr_write_b32 a253, 1.0
 v_accvgpr_write_b32 a254, 1.0
 v_accvgpr_write_b32 a255, 1.0
 v_and_b32 v5, 768, v1
 v_add3_u32 v5, v5, v1, s52
 s_waitcnt vmcnt(8)
 ds_read_b64_tr_b16 v[8:9], v5 offset:0
 ds_read_b64_tr_b16 v[10:11], v5 offset:256
 ds_read_b64_tr_b16 v[12:13], v5 offset:8
 ds_read_b64_tr_b16 v[14:15], v5 offset:264
 s_waitcnt lgkmcnt(2)
 buffer_store_dwordx4 v[8:11], v1, s[12:15], s49 offen sc1
 s_waitcnt lgkmcnt(0)
 buffer_store_dwordx4 v[12:15], v1, s[12:15], s49 offen offset:2048 sc1
 s_add_u32 s49, s49, 2097152
 s_add_u32 m0, s50, 4096
 s_add_u32 s3, s28, 32768
 buffer_load_dwordx4 v20, s[8:11], s3 offen lds
 s_add_u32 m0, s50, 5120
 s_add_u32 s3, s28, 40960
 buffer_load_dwordx4 v21, s[8:11], s3 offen lds
 s_add_u32 m0, s50, 6144
 s_add_u32 s3, s28, 49152
 buffer_load_dwordx4 v22, s[8:11], s3 offen lds
 s_add_u32 m0, s50, 7168
 s_add_u32 s3, s28, 57344
 buffer_load_dwordx4 v23, s[8:11], s3 offen lds
 s_waitcnt vmcnt(13)
 v_lshlrev_b32 v40, 16, v32
 v_and_b32 v41, s26, v32
 v_lshlrev_b32 v42, 16, v33
 v_and_b32 v43, s26, v33
 ds_write_b128 v31, v[40:43]
 s_waitcnt vmcnt(12)
 v_lshlrev_b32 v44, 16, v34
 v_and_b32 v45, s26, v34
 v_lshlrev_b32 v46, 16, v35
 v_and_b32 v47, s26, v35
 ds_write_b128 v31, v[44:47] offset:4096
 s_waitcnt vmcnt(11)
 v_lshlrev_b32 v48, 16, v36
 v_and_b32 v49, s26, v36
 v_lshlrev_b32 v50, 16, v37
 v_and_b32 v51, s26, v37
 ds_write_b128 v31, v[48:51] offset:8192
 s_waitcnt lgkmcnt(0)
 v_mov_b32 v32, 1.0
 v_mov_b32 v33, 1.0
 v_mov_b32 v34, 1.0
 v_mov_b32 v35, 1.0
 v_mov_b32 v36, 1.0
 v_mov_b32 v37, 1.0
 v_mov_b32 v38, 1.0
 v_mov_b32 v39, 1.0
 v_mov_b32 v40, 1.0
 v_mov_b32 v41, 1.0
 v_mov_b32 v42, 1.0
 v_mov_b32 v43, 1.0
 v_mov_b32 v44, 1.0
 v_mov_b32 v45, 1.0
 v_mov_b32 v46, 1.0
 v_mov_b32 v47, 1.0
 v_mov_b32 v48, 1.0
 v_mov_b32 v49, 1.0
 v_mov_b32 v50, 1.0
 v_mov_b32 v51, 1.0
 v_mov_b32 v52, 1.0
 v_mov_b32 v53, 1.0
 v_mov_b32 v54, 1.0
 v_mov_b32 v55, 1.0
 v_mov_b32 v56, 1.0
 v_mov_b32 v57, 1.0
 v_mov_b32 v58, 1.0
 v_mov_b32 v59, 1.0
 v_mov_b32 v60, 1.0
 v_mov_b32 v61, 1.0
 v_mov_b32 v62, 1.0
 v_mov_b32 v63, 1.0
 v_mov_b32 v64, 1.0
 v_mov_b32 v65, 1.0
 v_mov_b32 v66, 1.0
 v_mov_b32 v67, 1.0
 v_mov_b32 v68, 1.0
 v_mov_b32 v69, 1.0
 v_mov_b32 v70, 1.0
 v_mov_b32 v71, 1.0
 s_waitcnt vmcnt(4)
 s_barrier
 v_mov_b32 v7, 1
 buffer_atomic_add v7, v0, s[56:59], 0 offen sc1
 s_add_u32 m0, s50, 8192
 s_add_u32 s3, s28, 65536
 buffer_load_dwordx4 v20, s[8:11], s3 offen lds
 s_add_u32 m0, s50, 9216
 s_add_u32 s3, s28, 73728
 buffer_load_dwordx4 v21, s[8:11], s3 offen lds
 s_add_u32 m0, s50, 10240
 s_add_u32 s3, s28, 81920
 buffer_load_dwordx4 v22, s[8:11], s3 offen lds
 s_add_u32 m0, s50, 11264
 s_add_u32 s3, s28, 90112
 buffer_load_dwordx4 v23, s[8:11], s3 offen lds
 s_add_u32 m0, s50, 12288
 s_add_u32 s3, s28, 98304
 buffer_load_dwordx4 v20, s[8:11], s3 offen lds
 s_add_u32 m0, s50, 13312
 s_add_u32 s3, s28, 106496
 buffer_load_dwordx4 v21, s[8:11], s3 offen lds
 s_add_u32 m0, s50, 14336
 s_add_u32 s3, s28, 114688
 buffer_load_dwordx4 v22, s[8:11], s3 offen lds
 s_add_u32 m0, s50, 15360
 s_add_u32 s3, s28, 122880
 buffer_load_dwordx4 v23, s[8:11], s3 offen lds
 ds_read_b128 a[0:3], v24
 ds_read_b128 a[32:35], v25
 ds_read_b128 a[64:67], v26
 ds_read_b128 a[96:99], v27
 s_waitcnt lgkmcnt(0)
 ds_write_b128 v3, a[0:3]
 ds_write_b128 v3, a[32:35] offset:1024
 ds_write_b128 v3, a[64:67] offset:2048
 ds_write_b128 v3, a[96:99] offset:3072
 s_add_u32 m0, s50, 16384
 s_add_u32 s3, s28, 131072
 buffer_load_dwordx4 v20, s[8:11], s3 offen lds
 s_add_u32 m0, s50, 17408
 s_add_u32 s3, s28, 139264
 buffer_load_dwordx4 v21, s[8:11], s3 offen lds
 s_add_u32 m0, s50, 18432
 s_add_u32 s3, s28, 147456
 buffer_load_dwordx4 v22, s[8:11], s3 offen lds
 s_add_u32 m0, s50, 19456
 s_add_u32 s3, s28, 155648
 buffer_load_dwordx4 v23, s[8:11], s3 offen lds
 s_waitcnt vmcnt(13)
 ds_read_b128 a[4:7], v24 offset:4096
 ds_read_b128 a[36:39], v25 offset:4096
 ds_read_b128 a[68:71], v26 offset:4096
 ds_read_b128 a[100:103], v27 offset:4096
 s_waitcnt lgkmcnt(0)
 ds_write_b128 v3, a[4:7] offset:4096
 ds_write_b128 v3, a[36:39] offset:5120
 ds_write_b128 v3, a[68:71] offset:6144
 ds_write_b128 v3, a[100:103] offset:7168
 s_add_u32 m0, s50, 20480
 s_add_u32 s3, s28, 163840
 buffer_load_dwordx4 v20, s[8:11], s3 offen lds
 s_add_u32 m0, s50, 21504
 s_add_u32 s3, s28, 172032
 buffer_load_dwordx4 v21, s[8:11], s3 offen lds
 s_add_u32 m0, s50, 22528
 s_add_u32 s3, s28, 180224
 buffer_load_dwordx4 v22, s[8:11], s3 offen lds
 s_add_u32 m0, s50, 23552
 s_add_u32 s3, s28, 188416
 buffer_load_dwordx4 v23, s[8:11], s3 offen lds
 s_waitcnt vmcnt(12)
 ds_read_b128 a[8:11], v24 offset:8192
 ds_read_b128 a[40:43], v25 offset:8192
 ds_read_b128 a[72:75], v26 offset:8192
 ds_read_b128 a[104:107], v27 offset:8192
 s_waitcnt lgkmcnt(0)
 ds_write_b128 v3, a[8:11] offset:8192
 ds_write_b128 v3, a[40:43] offset:9216
 ds_write_b128 v3, a[72:75] offset:10240
 ds_write_b128 v3, a[104:107] offset:11264
 v_lshlrev_b32 v4, 2, v1
 v_and_b32 v4, 192, v4
 buffer_load_dword v4, v4, s[44:47], 0 offen sc1
 s_add_u32 m0, s50, 24576
 s_add_u32 s3, s28, 196608
 buffer_load_dwordx4 v20, s[8:11], s3 offen lds
 s_add_u32 m0, s50, 25600
 s_add_u32 s3, s28, 204800
 buffer_load_dwordx4 v21, s[8:11], s3 offen lds
 s_add_u32 m0, s50, 26624
 s_add_u32 s3, s28, 212992
 buffer_load_dwordx4 v22, s[8:11], s3 offen lds
 s_add_u32 m0, s50, 27648
 s_add_u32 s3, s28, 221184
 buffer_load_dwordx4 v23, s[8:11], s3 offen lds
 s_waitcnt vmcnt(13)
 ds_read_b128 a[12:15], v24 offset:12288
 ds_read_b128 a[44:47], v25 offset:12288
 ds_read_b128 a[76:79], v26 offset:12288
 ds_read_b128 a[108:111], v27 offset:12288
 s_waitcnt lgkmcnt(0)
 ds_write_b128 v3, a[12:15] offset:12288
 ds_write_b128 v3, a[44:47] offset:13312
 ds_write_b128 v3, a[76:79] offset:14336
 ds_write_b128 v3, a[108:111] offset:15360
 s_add_u32 m0, s50, 28672
 s_add_u32 s3, s28, 229376
 buffer_load_dwordx4 v20, s[8:11], s3 offen lds
 s_add_u32 m0, s50, 29696
 s_add_u32 s3, s28, 237568
 buffer_load_dwordx4 v21, s[8:11], s3 offen lds
 s_add_u32 m0, s50, 30720
 s_add_u32 s3, s28, 245760
 buffer_load_dwordx4 v22, s[8:11], s3 offen lds
 s_add_u32 m0, s50, 31744
 s_add_u32 s3, s28, 253952
 buffer_load_dwordx4 v23, s[8:11], s3 offen lds
 s_waitcnt vmcnt(13)
 ds_read_b128 a[16:19], v24 offset:16384
 ds_read_b128 a[48:51], v25 offset:16384
 ds_read_b128 a[80:83], v26 offset:16384
 ds_read_b128 a[112:115], v27 offset:16384
 s_waitcnt lgkmcnt(0)
 ds_write_b128 v3, a[16:19] offset:16384
 ds_write_b128 v3, a[48:51] offset:17408
 ds_write_b128 v3, a[80:83] offset:18432
 ds_write_b128 v3, a[112:115] offset:19456
 s_waitcnt vmcnt(9)
 ds_read_b128 a[20:23], v24 offset:20480
 ds_read_b128 a[52:55], v25 offset:20480
 ds_read_b128 a[84:87], v26 offset:20480
 ds_read_b128 a[116:119], v27 offset:20480
 s_waitcnt lgkmcnt(0)
 ds_write_b128 v3, a[20:23] offset:20480
 ds_write_b128 v3, a[52:55] offset:21504
 ds_write_b128 v3, a[84:87] offset:22528
 ds_write_b128 v3, a[116:119] offset:23552
 s_waitcnt vmcnt(8)
 v_cmp_gt_i32 vcc, s27, v4
 s_cbranch_vccnz Lspin_pro
Lok_pro:
 s_add_u32 s27, s27, 64
 global_load_dwordx4 a[196:199], v0, s[70:71] offset:-3072 sc1
 global_load_dwordx4 a[192:195], v0, s[70:71] offset:-4096 sc1
 global_load_dwordx4 a[204:207], v0, s[70:71] offset:-1024 sc1
 global_load_dwordx4 a[200:203], v0, s[70:71] offset:-2048 sc1
 global_load_dwordx4 a[212:215], v0, s[70:71] offset:1024 sc1
 global_load_dwordx4 a[208:211], v0, s[70:71] offset:0 sc1
 global_load_dwordx4 a[220:223], v0, s[70:71] offset:3072 sc1
 global_load_dwordx4 a[216:219], v0, s[70:71] offset:2048 sc1
 s_add_u32 s70, s70, 8192
 s_addc_u32 s71, s71, 0
 global_load_dwordx4 a[228:231], v0, s[70:71] offset:-3072 sc1
 global_load_dwordx4 a[224:227], v0, s[70:71] offset:-4096 sc1
 global_load_dwordx4 a[236:239], v0, s[70:71] offset:-1024 sc1
 global_load_dwordx4 a[232:235], v0, s[70:71] offset:-2048 sc1
 s_waitcnt vmcnt(16)
 ds_read_b128 a[24:27], v24 offset:24576
 ds_read_b128 a[56:59], v25 offset:24576
 ds_read_b128 a[88:91], v26 offset:24576
 ds_read_b128 a[120:123], v27 offset:24576
 s_waitcnt lgkmcnt(0)
 ds_write_b128 v3, a[24:27] offset:24576
 ds_write_b128 v3, a[56:59] offset:25600
 ds_write_b128 v3, a[88:91] offset:26624
 ds_write_b128 v3, a[120:123] offset:27648
 s_waitcnt vmcnt(12)
 ds_read_b128 a[28:31], v24 offset:28672
 ds_read_b128 a[60:63], v25 offset:28672
 ds_read_b128 a[92:95], v26 offset:28672
 ds_read_b128 a[124:127], v27 offset:28672
 s_waitcnt lgkmcnt(0)
 ds_write_b128 v3, a[28:31] offset:28672
 ds_write_b128 v3, a[60:63] offset:29696
 ds_write_b128 v3, a[92:95] offset:30720
 ds_write_b128 v3, a[124:127] offset:31744
 v_mov_b32 v16, 1.0
 v_mov_b32 v17, 1.0
 v_mov_b32 v18, 1.0
 v_mov_b32 v19, 1.0
 v_mov_b32 v20, 1.0
 v_mov_b32 v21, 1.0
 v_mov_b32 v22, 1.0
 v_mov_b32 v23, 1.0
 v_mov_b32 v24, 1.0
 v_mov_b32 v25, 1.0
 v_mov_b32 v26, 1.0
 v_mov_b32 v27, 1.0
 v_mov_b32 v28, 1.0
 v_mov_b32 v29, 1.0
 v_mov_b32 v30, 1.0
 v_mov_b32 v31, 1.0
 s_xor_b32 s30, s28, 1024
 s_mov_b32 s20, 64
 s_mov_b32 s21, 32704
 s_mov_b32 s22, 0xfffc8040
 s_waitcnt lgkmcnt(0)
 s_barrier
 ds_read_b128 a[128:131], v1
 ds_read_b128 a[132:135], v1 offset:1024
 ds_read_b128 a[140:143], v1 offset:5120
 ds_read_b128 a[136:139], v1 offset:4096
 ds_read_b128 a[144:147], v1 offset:8192
 ds_read_b128 a[148:151], v1 offset:9216
 ds_read_b128 a[156:159], v1 offset:13312
 ds_read_b128 a[152:155], v1 offset:12288
 ds_read_b128 a[160:163], v1 offset:16384
 ds_read_b128 a[164:167], v1 offset:17408
 ds_read_b128 a[172:175], v1 offset:21504
 ds_read_b128 a[168:171], v1 offset:20480
 ds_read_b128 a[176:179], v1 offset:24576
 ds_read_b128 a[180:183], v1 offset:25600
 ds_read_b128 a[188:191], v1 offset:29696
 ds_read_b128 a[184:187], v1 offset:28672
 s_waitcnt vmcnt(10) lgkmcnt(8)
 v_mfma_f32_16x16x32_bf16 v[16:19], a[192:195], a[128:131], v[16:19]
 v_mfma_f32_16x16x32_bf16 v[16:19], a[196:199], a[132:135], v[16:19]
 v_mfma_f32_16x16x32_bf16 v[20:23], a[196:199], a[140:143], v[20:23]
 v_mfma_f32_16x16x32_bf16 v[20:23], a[192:195], a[136:139], v[20:23]
 v_mfma_f32_16x16x32_bf16 v[24:27], a[192:195], a[144:147], v[24:27]
 v_mfma_f32_16x16x32_bf16 v[24:27], a[196:199], a[148:151], v[24:27]
 v_mfma_f32_16x16x32_bf16 v[28:31], a[196:199], a[156:159], v[28:31]
 v_mfma_f32_16x16x32_bf16 v[28:31], a[192:195], a[152:155], v[28:31]
 s_waitcnt lgkmcnt(0)
 v_mfma_f32_16x16x32_bf16 v[32:35], a[192:195], a[160:163], v[32:35]
 v_mfma_f32_16x16x32_bf16 v[32:35], a[196:199], a[164:167], v[32:35]
 v_mfma_f32_16x16x32_bf16 v[36:39], a[196:199], a[172:175], v[36:39]
 v_mfma_f32_16x16x32_bf16 v[36:39], a[192:195], a[168:171], v[36:39]
 v_mfma_f32_16x16x32_bf16 v[40:43], a[192:195], a[176:179], v[40:43]
 v_mfma_f32_16x16x32_bf16 v[40:43], a[196:199], a[180:183], v[40:43]
 v_mfma_f32_16x16x32_bf16 v[44:47], a[196:199], a[188:191], v[44:47]
 v_mfma_f32_16x16x32_bf16 v[44:47], a[192:195], a[184:187], v[44:47]
 s_waitcnt vmcnt(8)
 v_mfma_f32_16x16x32_bf16 v[76:79], a[200:203], a[184:187], v[76:79]
 v_mfma_f32_16x16x32_bf16 v[76:79], a[204:207], a[188:191], v[76:79]
 global_load_dwordx4 a[196:199], v0, s[70:71] offset:1024 sc1
 v_mfma_f32_16x16x32_bf16 v[72:75], a[204:207], a[180:183], v[72:75]
 v_mfma_f32_16x16x32_bf16 v[72:75], a[200:203], a[176:179], v[72:75]
 global_load_dwordx4 a[192:195], v0, s[70:71] offset:0 sc1
 v_mfma_f32_16x16x32_bf16 v[68:71], a[200:203], a[168:171], v[68:71]
 v_mfma_f32_16x16x32_bf16 v[68:71], a[204:207], a[172:175], v[68:71]
 v_mfma_f32_16x16x32_bf16 v[64:67], a[204:207], a[164:167], v[64:67]
 v_mfma_f32_16x16x32_bf16 v[64:67], a[200:203], a[160:163], v[64:67]
 v_mfma_f32_16x16x32_bf16 v[60:63], a[200:203], a[152:155], v[60:63]
 v_mfma_f32_16x16x32_bf16 v[60:63], a[204:207], a[156:159], v[60:63]
 v_mfma_f32_16x16x32_bf16 v[56:59], a[204:207], a[148:151], v[56:59]
 v_mfma_f32_16x16x32_bf16 v[56:59], a[200:203], a[144:147], v[56:59]
 v_mfma_f32_16x16x32_bf16 v[52:55], a[200:203], a[136:139], v[52:55]
 v_mfma_f32_16x16x32_bf16 v[52:55], a[204:207], a[140:143], v[52:55]
 v_mfma_f32_16x16x32_bf16 v[48:51], a[204:207], a[132:135], v[48:51]
 v_mfma_f32_16x16x32_bf16 v[48:51], a[200:203], a[128:131], v[48:51]
 s_waitcnt vmcnt(8)
 v_mfma_f32_16x16x32_bf16 v[80:83], a[208:211], a[128:131], v[80:83]
 v_mfma_f32_16x16x32_bf16 v[80:83], a[212:215], a[132:135], v[80:83]
 global_load_dwordx4 a[204:207], v0, s[70:71] offset:3072 sc1
 v_mfma_f32_16x16x32_bf16 v[84:87], a[212:215], a[140:143], v[84:87]
 v_mfma_f32_16x16x32_bf16 v[84:87], a[208:211], a[136:139], v[84:87]
 global_load_dwordx4 a[200:203], v0, s[70:71] offset:2048 sc1
 v_mfma_f32_16x16x32_bf16 v[88:91], a[208:211], a[144:147], v[88:91]
 s_add_u32 s70, s70, 8192
 s_addc_u32 s71, s71, 0
 v_mfma_f32_16x16x32_bf16 v[88:91], a[212:215], a[148:151], v[88:91]
 v_mfma_f32_16x16x32_bf16 v[92:95], a[212:215], a[156:159], v[92:95]
 v_mfma_f32_16x16x32_bf16 v[92:95], a[208:211], a[152:155], v[92:95]
 v_mfma_f32_16x16x32_bf16 v[96:99], a[208:211], a[160:163], v[96:99]
 v_mfma_f32_16x16x32_bf16 v[96:99], a[212:215], a[164:167], v[96:99]
 v_mfma_f32_16x16x32_bf16 v[100:103], a[212:215], a[172:175], v[100:103]
 v_mfma_f32_16x16x32_bf16 v[100:103], a[208:211], a[168:171], v[100:103]
 v_mfma_f32_16x16x32_bf16 v[104:107], a[208:211], a[176:179], v[104:107]
 v_mfma_f32_16x16x32_bf16 v[104:107], a[212:215], a[180:183], v[104:107]
 v_mfma_f32_16x16x32_bf16 v[108:111], a[212:215], a[188:191], v[108:111]
 v_mfma_f32_16x16x32_bf16 v[108:111], a[208:211], a[184:187], v[108:111]
 s_waitcnt vmcnt(8)
 v_mfma_f32_16x16x32_bf16 a[244:247], a[216:219], a[184:187], a[244:247]
 ds_read_b128 a[184:187], v1 offset:61440
 v_mfma_f32_16x16x32_bf16 a[244:247], a[220:223], a[188:191], a[244:247]
 global_load_dwordx4 a[212:215], v0, s[70:71] offset:-3072 sc1
 ds_read_b128 a[188:191], v1 offset:62464
 v_mfma_f32_16x16x32_bf16 a[240:243], a[220:223], a[180:183], a[240:243]
 ds_read_b128 a[180:183], v1 offset:58368
 v_mfma_f32_16x16x32_bf16 a[240:243], a[216:219], a[176:179], a[240:243]
 global_load_dwordx4 a[208:211], v0, s[70:71] offset:-4096 sc1
 ds_read_b128 a[176:179], v1 offset:57344
 v_mfma_f32_16x16x32_bf16 v[132:135], a[216:219], a[168:171], v[132:135]
 ds_read_b128 a[168:171], v1 offset:53248
 v_mfma_f32_16x16x32_bf16 v[132:135], a[220:223], a[172:175], v[132:135]
 ds_read_b128 a[172:175], v1 offset:54272
 v_mfma_f32_16x16x32_bf16 v[128:131], a[220:223], a[164:167], v[128:131]
 ds_read_b128 a[164:167], v1 offset:50176
 v_mfma_f32_16x16x32_bf16 v[128:131], a[216:219], a[160:163], v[128:131]
 ds_read_b128 a[160:163], v1 offset:49152
 v_mfma_f32_16x16x32_bf16 v[124:127], a[216:219], a[152:155], v[124:127]
 ds_read_b128 a[152:155], v1 offset:45056
 v_mfma_f32_16x16x32_bf16 v[124:127], a[220:223], a[156:159], v[124:127]
 ds_read_b128 a[156:159], v1 offset:46080
 v_mfma_f32_16x16x32_bf16 v[120:123], a[220:223], a[148:151], v[120:123]
 ds_read_b128 a[148:151], v1 offset:41984
 v_mfma_f32_16x16x32_bf16 v[120:123], a[216:219], a[144:147], v[120:123]
 ds_read_b128 a[144:147], v1 offset:40960
 v_mfma_f32_16x16x32_bf16 v[116:119], a[216:219], a[136:139], v[116:119]
 ds_read_b128 a[136:139], v1 offset:36864
 v_mfma_f32_16x16x32_bf16 v[116:119], a[220:223], a[140:143], v[116:119]
 ds_read_b128 a[140:143], v1 offset:37888
 v_mfma_f32_16x16x32_bf16 v[112:115], a[220:223], a[132:135], v[112:115]
 ds_read_b128 a[132:135], v1 offset:33792
 v_mfma_f32_16x16x32_bf16 v[112:115], a[216:219], a[128:131], v[112:115]
 ds_read_b128 a[128:131], v1 offset:32768
 s_waitcnt vmcnt(8) lgkmcnt(8)
 v_mfma_f32_16x16x32_bf16 v[44:47], a[224:227], a[184:187], v[44:47]
 v_mfma_f32_16x16x32_bf16 v[44:47], a[228:231], a[188:191], v[44:47]
 global_load_dwordx4 a[220:223], v0, s[70:71] offset:-1024 sc1
 v_mfma_f32_16x16x32_bf16 v[40:43], a[228:231], a[180:183], v[40:43]
 v_mfma_f32_16x16x32_bf16 v[40:43], a[224:227], a[176:179], v[40:43]
 global_load_dwordx4 a[216:219], v0, s[70:71] offset:-2048 sc1
 v_mfma_f32_16x16x32_bf16 v[36:39], a[224:227], a[168:171], v[36:39]
 v_mfma_f32_16x16x32_bf16 v[36:39], a[228:231], a[172:175], v[36:39]
 v_mfma_f32_16x16x32_bf16 v[32:35], a[228:231], a[164:167], v[32:35]
 v_mfma_f32_16x16x32_bf16 v[32:35], a[224:227], a[160:163], v[32:35]
 s_waitcnt lgkmcnt(0)
 v_mfma_f32_16x16x32_bf16 v[28:31], a[224:227], a[152:155], v[28:31]
 v_mfma_f32_16x16x32_bf16 v[28:31], a[228:231], a[156:159], v[28:31]
 v_mfma_f32_16x16x32_bf16 v[24:27], a[228:231], a[148:151], v[24:27]
 v_mfma_f32_16x16x32_bf16 v[24:27], a[224:227], a[144:147], v[24:27]
 v_mfma_f32_16x16x32_bf16 v[20:23], a[224:227], a[136:139], v[20:23]
 v_mfma_f32_16x16x32_bf16 v[20:23], a[228:231], a[140:143], v[20:23]
 v_mfma_f32_16x16x32_bf16 v[16:19], a[228:231], a[132:135], v[16:19]
 v_mfma_f32_16x16x32_bf16 v[16:19], a[224:227], a[128:131], v[16:19]
 s_waitcnt vmcnt(8)
 v_mfma_f32_16x16x32_bf16 v[48:51], a[232:235], a[128:131], v[48:51]
 v_mfma_f32_16x16x32_bf16 v[48:51], a[236:239], a[132:135], v[48:51]
 global_load_dwordx4 a[228:231], v0, s[70:71] offset:1024 sc1
 v_mfma_f32_16x16x32_bf16 v[52:55], a[236:239], a[140:143], v[52:55]
 v_mfma_f32_16x16x32_bf16 v[52:55], a[232:235], a[136:139], v[52:55]
 global_load_dwordx4 a[224:227], v0, s[70:71] offset:0 sc1
 v_mfma_f32_16x16x32_bf16 v[56:59], a[232:235], a[144:147], v[56:59]
 v_mfma_f32_16x16x32_bf16 v[56:59], a[236:239], a[148:151], v[56:59]
 v_mfma_f32_16x16x32_bf16 v[60:63], a[236:239], a[156:159], v[60:63]
 v_mfma_f32_16x16x32_bf16 v[60:63], a[232:235], a[152:155], v[60:63]
 v_mfma_f32_16x16x32_bf16 v[64:67], a[232:235], a[160:163], v[64:67]
 v_mfma_f32_16x16x32_bf16 v[64:67], a[236:239], a[164:167], v[64:67]
 v_mfma_f32_16x16x32_bf16 v[68:71], a[236:239], a[172:175], v[68:71]
 v_mfma_f32_16x16x32_bf16 v[68:71], a[232:235], a[168:171], v[68:71]
 v_mfma_f32_16x16x32_bf16 v[72:75], a[232:235], a[176:179], v[72:75]
 v_mfma_f32_16x16x32_bf16 v[72:75], a[236:239], a[180:183], v[72:75]
 v_mfma_f32_16x16x32_bf16 v[76:79], a[236:239], a[188:191], v[76:79]
 v_mfma_f32_16x16x32_bf16 v[76:79], a[232:235], a[184:187], v[76:79]
 s_waitcnt vmcnt(8)
 v_mfma_f32_16x16x32_bf16 v[108:111], a[192:195], a[184:187], v[108:111]
 v_mfma_f32_16x16x32_bf16 v[108:111], a[196:199], a[188:191], v[108:111]
 global_load_dwordx4 a[236:239], v0, s[70:71] offset:3072 sc1
 v_mfma_f32_16x16x32_bf16 v[104:107], a[196:199], a[180:183], v[104:107]
 v_mfma_f32_16x16x32_bf16 v[104:107], a[192:195], a[176:179], v[104:107]
 global_load_dwordx4 a[232:235], v0, s[70:71] offset:2048 sc1
 v_mfma_f32_16x16x32_bf16 v[100:103], a[192:195], a[168:171], v[100:103]
 s_add_u32 s70, s70, 8192
 s_addc_u32 s71, s71, 0
 v_mfma_f32_16x16x32_bf16 v[100:103], a[196:199], a[172:175], v[100:103]
 v_mfma_f32_16x16x32_bf16 v[96:99], a[196:199], a[164:167], v[96:99]
 v_mfma_f32_16x16x32_bf16 v[96:99], a[192:195], a[160:163], v[96:99]
 v_mfma_f32_16x16x32_bf16 v[92:95], a[192:195], a[152:155], v[92:95]
 v_mfma_f32_16x16x32_bf16 v[92:95], a[196:199], a[156:159], v[92:95]
 v_mfma_f32_16x16x32_bf16 v[88:91], a[196:199], a[148:151], v[88:91]
 v_mfma_f32_16x16x32_bf16 v[88:91], a[192:195], a[144:147], v[88:91]
 v_mfma_f32_16x16x32_bf16 v[84:87], a[192:195], a[136:139], v[84:87]
 v_mfma_f32_16x16x32_bf16 v[84:87], a[196:199], a[140:143], v[84:87]
 v_mfma_f32_16x16x32_bf16 v[80:83], a[196:199], a[132:135], v[80:83]
 v_mfma_f32_16x16x32_bf16 v[80:83], a[192:195], a[128:131], v[80:83]
 s_waitcnt vmcnt(8)
 v_mfma_f32_16x16x32_bf16 v[112:115], a[200:203], a[128:131], v[112:115]
 ds_read_b128 a[128:131], v2
 v_mfma_f32_16x16x32_bf16 v[112:115], a[204:207], a[132:135], v[112:115]
 global_load_dwordx4 a[196:199], v0, s[70:71] offset:-3072 sc1
 ds_read_b128 a[132:135], v2 offset:1024
 v_mfma_f32_16x16x32_bf16 v[116:119], a[204:207], a[140:143], v[116:119]
 ds_read_b128 a[140:143], v2 offset:5120
 v_mfma_f32_16x16x32_bf16 v[116:119], a[200:203], a[136:139], v[116:119]
 global_load_dwordx4 a[192:195], v0, s[70:71] offset:-4096 sc1
 ds_read_b128 a[136:139], v2 offset:4096
 v_mfma_f32_16x16x32_bf16 v[120:123], a[200:203], a[144:147], v[120:123]
 ds_read_b128 a[144:147], v2 offset:8192
 v_mfma_f32_16x16x32_bf16 v[120:123], a[204:207], a[148:151], v[120:123]
 ds_read_b128 a[148:151], v2 offset:9216
 v_mfma_f32_16x16x32_bf16 v[124:127], a[204:207], a[156:159], v[124:127]
 ds_read_b128 a[156:159], v2 offset:13312
 v_mfma_f32_16x16x32_bf16 v[124:127], a[200:203], a[152:155], v[124:127]
 ds_read_b128 a[152:155], v2 offset:12288
 v_mfma_f32_16x16x32_bf16 v[128:131], a[200:203], a[160:163], v[128:131]
 ds_read_b128 a[160:163], v2 offset:16384
 v_mfma_f32_16x16x32_bf16 v[128:131], a[204:207], a[164:167], v[128:131]
 ds_read_b128 a[164:167], v2 offset:17408
 v_mfma_f32_16x16x32_bf16 v[132:135], a[204:207], a[172:175], v[132:135]
 ds_read_b128 a[172:175], v2 offset:21504
 v_mfma_f32_16x16x32_bf16 v[132:135], a[200:203], a[168:171], v[132:135]
 ds_read_b128 a[168:171], v2 offset:20480
 v_mfma_f32_16x16x32_bf16 a[240:243], a[200:203], a[176:179], a[240:243]
 ds_read_b128 a[176:179], v2 offset:24576
 v_mfma_f32_16x16x32_bf16 a[240:243], a[204:207], a[180:183], a[240:243]
 ds_read_b128 a[180:183], v2 offset:25600
 v_mfma_f32_16x16x32_bf16 a[244:247], a[204:207], a[188:191], a[244:247]
 ds_read_b128 a[188:191], v2 offset:29696
 v_mfma_f32_16x16x32_bf16 a[244:247], a[200:203], a[184:187], a[244:247]
 ds_read_b128 a[184:187], v2 offset:28672
 s_waitcnt vmcnt(8) lgkmcnt(8)
 v_mfma_f32_16x16x32_bf16 v[16:19], a[208:211], a[128:131], v[16:19]
 v_mfma_f32_16x16x32_bf16 v[16:19], a[212:215], a[132:135], v[16:19]
 global_load_dwordx4 a[204:207], v0, s[70:71] offset:-1024 sc1
 v_mfma_f32_16x16x32_bf16 v[20:23], a[212:215], a[140:143], v[20:23]
 v_mfma_f32_16x16x32_bf16 v[20:23], a[208:211], a[136:139], v[20:23]
 global_load_dwordx4 a[200:203], v0, s[70:71] offset:-2048 sc1
 v_mfma_f32_16x16x32_bf16 v[24:27], a[208:211], a[144:147], v[24:27]
 v_mfma_f32_16x16x32_bf16 v[24:27], a[212:215], a[148:151], v[24:27]
 v_mfma_f32_16x16x32_bf16 v[28:31], a[212:215], a[156:159], v[28:31]
 v_mfma_f32_16x16x32_bf16 v[28:31], a[208:211], a[152:155], v[28:31]
 s_waitcnt lgkmcnt(0)
 v_mfma_f32_16x16x32_bf16 v[32:35], a[208:211], a[160:163], v[32:35]
 v_mfma_f32_16x16x32_bf16 v[32:35], a[212:215], a[164:167], v[32:35]
 v_mfma_f32_16x16x32_bf16 v[36:39], a[212:215], a[172:175], v[36:39]
 v_mfma_f32_16x16x32_bf16 v[36:39], a[208:211], a[168:171], v[36:39]
 v_mfma_f32_16x16x32_bf16 v[40:43], a[208:211], a[176:179], v[40:43]
 v_mfma_f32_16x16x32_bf16 v[40:43], a[212:215], a[180:183], v[40:43]
 v_mfma_f32_16x16x32_bf16 v[44:47], a[212:215], a[188:191], v[44:47]
 v_mfma_f32_16x16x32_bf16 v[44:47], a[208:211], a[184:187], v[44:47]
 s_waitcnt vmcnt(8)
 v_mfma_f32_16x16x32_bf16 v[76:79], a[216:219], a[184:187], v[76:79]
 v_mfma_f32_16x16x32_bf16 v[76:79], a[220:223], a[188:191], v[76:79]
 global_load_dwordx4 a[212:215], v0, s[70:71] offset:1024 sc1
 v_mfma_f32_16x16x32_bf16 v[72:75], a[220:223], a[180:183], v[72:75]
 v_mfma_f32_16x16x32_bf16 v[72:75], a[216:219], a[176:179], v[72:75]
 global_load_dwordx4 a[208:211], v0, s[70:71] offset:0 sc1
 v_mfma_f32_16x16x32_bf16 v[68:71], a[216:219], a[168:171], v[68:71]
 v_mfma_f32_16x16x32_bf16 v[68:71], a[220:223], a[172:175], v[68:71]
 v_mfma_f32_16x16x32_bf16 v[64:67], a[220:223], a[164:167], v[64:67]
 v_mfma_f32_16x16x32_bf16 v[64:67], a[216:219], a[160:163], v[64:67]
 v_mfma_f32_16x16x32_bf16 v[60:63], a[216:219], a[152:155], v[60:63]
 v_mfma_f32_16x16x32_bf16 v[60:63], a[220:223], a[156:159], v[60:63]
 v_mfma_f32_16x16x32_bf16 v[56:59], a[220:223], a[148:151], v[56:59]
 v_mfma_f32_16x16x32_bf16 v[56:59], a[216:219], a[144:147], v[56:59]
 v_mfma_f32_16x16x32_bf16 v[52:55], a[216:219], a[136:139], v[52:55]
 v_mfma_f32_16x16x32_bf16 v[52:55], a[220:223], a[140:143], v[52:55]
 v_mfma_f32_16x16x32_bf16 v[48:51], a[220:223], a[132:135], v[48:51]
 v_mfma_f32_16x16x32_bf16 v[48:51], a[216:219], a[128:131], v[48:51]
 s_waitcnt vmcnt(8)
 v_mfma_f32_16x16x32_bf16 v[80:83], a[224:227], a[128:131], v[80:83]
 v_mfma_f32_16x16x32_bf16 v[80:83], a[228:231], a[132:135], v[80:83]
 global_load_dwordx4 a[220:223], v0, s[70:71] offset:3072 sc1
 v_mfma_f32_16x16x32_bf16 v[84:87], a[228:231], a[140:143], v[84:87]
 v_mfma_f32_16x16x32_bf16 v[84:87], a[224:227], a[136:139], v[84:87]
 global_load_dwordx4 a[216:219], v0, s[70:71] offset:2048 sc1
 v_mfma_f32_16x16x32_bf16 v[88:91], a[224:227], a[144:147], v[88:91]
 s_add_u32 s70, s70, 8192
 s_addc_u32 s71, s71, 0
 v_mfma_f32_16x16x32_bf16 v[88:91], a[228:231], a[148:151], v[88:91]
 v_mfma_f32_16x16x32_bf16 v[92:95], a[228:231], a[156:159], v[92:95]
 v_mfma_f32_16x16x32_bf16 v[92:95], a[224:227], a[152:155], v[92:95]
 v_mfma_f32_16x16x32_bf16 v[96:99], a[224:227], a[160:163], v[96:99]
 v_mfma_f32_16x16x32_bf16 v[96:99], a[228:231], a[164:167], v[96:99]
 v_mfma_f32_16x16x32_bf16 v[100:103], a[228:231], a[172:175], v[100:103]
 v_mfma_f32_16x16x32_bf16 v[100:103], a[224:227], a[168:171], v[100:103]
 v_mfma_f32_16x16x32_bf16 v[104:107], a[224:227], a[176:179], v[104:107]
 v_mfma_f32_16x16x32_bf16 v[104:107], a[228:231], a[180:183], v[104:107]
 v_mfma_f32_16x16x32_bf16 v[108:111], a[228:231], a[188:191], v[108:111]
 v_mfma_f32_16x16x32_bf16 v[108:111], a[224:227], a[184:187], v[108:111]
 s_waitcnt vmcnt(8)
 v_mfma_f32_16x16x32_bf16 a[244:247], a[232:235], a[184:187], a[244:247]
 ds_read_b128 a[184:187], v2 offset:61440
 v_mfma_f32_16x16x32_bf16 a[244:247], a[236:239], a[188:191], a[244:247]
 global_load_dwordx4 a[228:231], v0, s[70:71] offset:-3072 sc1
 ds_read_b128 a[188:191], v2 offset:62464
 v_mfma_f32_16x16x32_bf16 a[240:243], a[236:239], a[180:183], a[240:243]
 ds_read_b128 a[180:183], v2 offset:58368
 v_mfma_f32_16x16x32_bf16 a[240:243], a[232:235], a[176:179], a[240:243]
 global_load_dwordx4 a[224:227], v0, s[70:71] offset:-4096 sc1
 ds_read_b128 a[176:179], v2 offset:57344
 v_mfma_f32_16x16x32_bf16 v[132:135], a[232:235], a[168:171], v[132:135]
 ds_read_b128 a[168:171], v2 offset:53248
 v_mfma_f32_16x16x32_bf16 v[132:135], a[236:239], a[172:175], v[132:135]
 ds_read_b128 a[172:175], v2 offset:54272
 v_mfma_f32_16x16x32_bf16 v[128:131], a[236:239], a[164:167], v[128:131]
 ds_read_b128 a[164:167], v2 offset:50176
 v_mfma_f32_16x16x32_bf16 v[128:131], a[232:235], a[160:163], v[128:131]
 ds_read_b128 a[160:163], v2 offset:49152
 v_mfma_f32_16x16x32_bf16 v[124:127], a[232:235], a[152:155], v[124:127]
 ds_read_b128 a[152:155], v2 offset:45056
 v_mfma_f32_16x16x32_bf16 v[124:127], a[236:239], a[156:159], v[124:127]
 ds_read_b128 a[156:159], v2 offset:46080
 v_mfma_f32_16x16x32_bf16 v[120:123], a[236:239], a[148:151], v[120:123]
 ds_read_b128 a[148:151], v2 offset:41984
 v_mfma_f32_16x16x32_bf16 v[120:123], a[232:235], a[144:147], v[120:123]
 ds_read_b128 a[144:147], v2 offset:40960
 v_mfma_f32_16x16x32_bf16 v[116:119], a[232:235], a[136:139], v[116:119]
 ds_read_b128 a[136:139], v2 offset:36864
 v_mfma_f32_16x16x32_bf16 v[116:119], a[236:239], a[140:143], v[116:119]
 ds_read_b128 a[140:143], v2 offset:37888
 v_mfma_f32_16x16x32_bf16 v[112:115], a[236:239], a[132:135], v[112:115]
 ds_read_b128 a[132:135], v2 offset:33792
 v_mfma_f32_16x16x32_bf16 v[112:115], a[232:235], a[128:131], v[112:115]
 ds_read_b128 a[128:131], v2 offset:32768
 s_waitcnt vmcnt(8) lgkmcnt(8)
 v_mfma_f32_16x16x32_bf16 v[44:47], a[192:195], a[184:187], v[44:47]
 v_mfma_f32_16x16x32_bf16 v[44:47], a[196:199], a[188:191], v[44:47]
 global_load_dwordx4 a[236:239], v0, s[70:71] offset:-1024 sc1
 v_mfma_f32_16x16x32_bf16 v[40:43], a[196:199], a[180:183], v[40:43]
 v_mfma_f32_16x16x32_bf16 v[40:43], a[192:195], a[176:179], v[40:43]
 global_load_dwordx4 a[232:235], v0, s[70:71] offset:-2048 sc1
 v_mfma_f32_16x16x32_bf16 v[36:39], a[192:195], a[168:171], v[36:39]
 v_mfma_f32_16x16x32_bf16 v[36:39], a[196:199], a[172:175], v[36:39]
 v_mfma_f32_16x16x32_bf16 v[32:35], a[196:199], a[164:167], v[32:35]
 v_mfma_f32_16x16x32_bf16 v[32:35], a[192:195], a[160:163], v[32:35]
 s_waitcnt lgkmcnt(0)
 v_mfma_f32_16x16x32_bf16 v[28:31], a[192:195], a[152:155], v[28:31]
 v_mfma_f32_16x16x32_bf16 v[28:31], a[196:199], a[156:159], v[28:31]
 v_mfma_f32_16x16x32_bf16 v[24:27], a[196:199], a[148:151], v[24:27]
 v_mfma_f32_16x16x32_bf16 v[24:27], a[192:195], a[144:147], v[24:27]
 v_mfma_f32_16x16x32_bf16 v[20:23], a[192:195], a[136:139], v[20:23]
 v_mfma_f32_16x16x32_bf16 v[20:23], a[196:199], a[140:143], v[20:23]
 v_mfma_f32_16x16x32_bf16 v[16:19], a[196:199], a[132:135], v[16:19]
 v_mfma_f32_16x16x32_bf16 v[16:19], a[192:195], a[128:131], v[16:19]
 s_waitcnt vmcnt(8)
 v_mfma_f32_16x16x32_bf16 v[48:51], a[200:203], a[128:131], v[48:51]
 v_mfma_f32_16x16x32_bf16 v[48:51], a[204:207], a[132:135], v[48:51]
 global_load_dwordx4 a[196:199], v0, s[70:71] offset:1024 sc1
 v_mfma_f32_16x16x32_bf16 v[52:55], a[204:207], a[140:143], v[52:55]
 v_mfma_f32_16x16x32_bf16 v[52:55], a[200:203], a[136:139], v[52:55]
 global_load_dwordx4 a[192:195], v0, s[70:71] offset:0 sc1
 v_mfma_f32_16x16x32_bf16 v[56:59], a[200:203], a[144:147], v[56:59]
 v_mfma_f32_16x16x32_bf16 v[56:59], a[204:207], a[148:151], v[56:59]
 v_mfma_f32_16x16x32_bf16 v[60:63], a[204:207], a[156:159], v[60:63]
 v_mfma_f32_16x16x32_bf16 v[60:63], a[200:203], a[152:155], v[60:63]
 v_mfma_f32_16x16x32_bf16 v[64:67], a[200:203], a[160:163], v[64:67]
 v_mfma_f32_16x16x32_bf16 v[64:67], a[204:207], a[164:167], v[64:67]
 v_mfma_f32_16x16x32_bf16 v[68:71], a[204:207], a[172:175], v[68:71]
 v_mfma_f32_16x16x32_bf16 v[68:71], a[200:203], a[168:171], v[68:71]
 v_mfma_f32_16x16x32_bf16 v[72:75], a[200:203], a[176:179], v[72:75]
 v_mfma_f32_16x16x32_bf16 v[72:75], a[204:207], a[180:183], v[72:75]
 v_mfma_f32_16x16x32_bf16 v[76:79], a[204:207], a[188:191], v[76:79]
 v_mfma_f32_16x16x32_bf16 v[76:79], a[200:203], a[184:187], v[76:79]
 s_waitcnt vmcnt(8)
 v_mfma_f32_16x16x32_bf16 v[108:111], a[208:211], a[184:187], v[108:111]
 v_mfma_f32_16x16x32_bf16 v[108:111], a[212:215], a[188:191], v[108:111]
 global_load_dwordx4 a[204:207], v0, s[70:71] offset:3072 sc1
 v_mfma_f32_16x16x32_bf16 v[104:107], a[212:215], a[180:183], v[104:107]
 v_mfma_f32_16x16x32_bf16 v[104:107], a[208:211], a[176:179], v[104:107]
 global_load_dwordx4 a[200:203], v0, s[70:71] offset:2048 sc1
 v_mfma_f32_16x16x32_bf16 v[100:103], a[208:211], a[168:171], v[100:103]
 s_add_u32 s70, s70, 8192
 s_addc_u32 s71, s71, 0
 v_mfma_f32_16x16x32_bf16 v[100:103], a[212:215], a[172:175], v[100:103]
 v_mfma_f32_16x16x32_bf16 v[96:99], a[212:215], a[164:167], v[96:99]
 v_mfma_f32_16x16x32_bf16 v[96:99], a[208:211], a[160:163], v[96:99]
 v_mfma_f32_16x16x32_bf16 v[92:95], a[208:211], a[152:155], v[92:95]
 v_mfma_f32_16x16x32_bf16 v[92:95], a[212:215], a[156:159], v[92:95]
 v_mfma_f32_16x16x32_bf16 v[88:91], a[212:215], a[148:151], v[88:91]
 v_mfma_f32_16x16x32_bf16 v[88:91], a[208:211], a[144:147], v[88:91]
 v_mfma_f32_16x16x32_bf16 v[84:87], a[208:211], a[136:139], v[84:87]
 v_mfma_f32_16x16x32_bf16 v[84:87], a[212:215], a[140:143], v[84:87]
 v_mfma_f32_16x16x32_bf16 v[80:83], a[212:215], a[132:135], v[80:83]
 v_mfma_f32_16x16x32_bf16 v[80:83], a[208:211], a[128:131], v[80:83]
 s_waitcnt vmcnt(8)
 v_mfma_f32_16x16x32_bf16 v[112:115], a[216:219], a[128:131], v[112:115]
 ds_read_b128 a[128:131], v1
 v_mfma_f32_16x16x32_bf16 v[112:115], a[220:223], a[132:135], v[112:115]
 global_load_dwordx4 a[212:215], v0, s[70:71] offset:-3072 sc1
 ds_read_b128 a[132:135], v1 offset:1024
 v_mfma_f32_16x16x32_bf16 v[116:119], a[220:223], a[140:143], v[116:119]
 ds_read_b128 a[140:143], v1 offset:5120
 v_mfma_f32_16x16x32_bf16 v[116:119], a[216:219], a[136:139], v[116:119]
 global_load_dwordx4 a[208:211], v0, s[70:71] offset:-4096 sc1
 ds_read_b128 a[136:139], v1 offset:4096
 v_mfma_f32_16x16x32_bf16 v[120:123], a[216:219], a[144:147], v[120:123]
 ds_read_b128 a[144:147], v1 offset:8192
 v_mfma_f32_16x16x32_bf16 v[120:123], a[220:223], a[148:151], v[120:123]
 ds_read_b128 a[148:151], v1 offset:9216
 v_mfma_f32_16x16x32_bf16 v[124:127], a[220:223], a[156:159], v[124:127]
 ds_read_b128 a[156:159], v1 offset:13312
 v_mfma_f32_16x16x32_bf16 v[124:127], a[216:219], a[152:155], v[124:127]
 ds_read_b128 a[152:155], v1 offset:12288
 v_mfma_f32_16x16x32_bf16 v[128:131], a[216:219], a[160:163], v[128:131]
 ds_read_b128 a[160:163], v1 offset:16384
 v_mfma_f32_16x16x32_bf16 v[128:131], a[220:223], a[164:167], v[128:131]
 ds_read_b128 a[164:167], v1 offset:17408
 v_mfma_f32_16x16x32_bf16 v[132:135], a[220:223], a[172:175], v[132:135]
 ds_read_b128 a[172:175], v1 offset:21504
 v_mfma_f32_16x16x32_bf16 v[132:135], a[216:219], a[168:171], v[132:135]
 ds_read_b128 a[168:171], v1 offset:20480
 v_mfma_f32_16x16x32_bf16 a[240:243], a[216:219], a[176:179], a[240:243]
 ds_read_b128 a[176:179], v1 offset:24576
 v_mfma_f32_16x16x32_bf16 a[240:243], a[220:223], a[180:183], a[240:243]
 ds_read_b128 a[180:183], v1 offset:25600
 v_mfma_f32_16x16x32_bf16 a[244:247], a[220:223], a[188:191], a[244:247]
 global_load_dwordx4 a[220:223], v0, s[70:71] offset:-1024 sc1
 ds_read_b128 a[188:191], v1 offset:29696
 v_mfma_f32_16x16x32_bf16 a[244:247], a[216:219], a[184:187], a[244:247]
 global_load_dwordx4 a[216:219], v0, s[70:71] offset:-2048 sc1
 ds_read_b128 a[184:187], v1 offset:28672
 s_waitcnt vmcnt(10) lgkmcnt(8)
Ls1b:
 v_mfma_f32_16x16x32_bf16 v[136:139], a[224:227], a[128:131], v[136:139]
 v_lshrrev_b32 v4, 8, v1
 v_mfma_f32_16x16x32_bf16 v[136:139], a[228:231], a[132:135], v[136:139]
 v_mfma_f32_16x16x32_bf16 v[140:143], a[228:231], a[140:143], v[140:143]
 v_lshl_add_u32 v4, v4, 5, s51
 v_mfma_f32_16x16x32_bf16 v[140:143], a[224:227], a[136:139], v[140:143]
 ds_read_b128 v[8:11], v4
 v_mfma_f32_16x16x32_bf16 v[144:147], a[224:227], a[144:147], v[144:147]
 v_mfma_f32_16x16x32_bf16 v[144:147], a[228:231], a[148:151], v[144:147]
 v_mfma_f32_16x16x32_bf16 v[148:151], a[228:231], a[156:159], v[148:151]
 v_mfma_f32_16x16x32_bf16 v[148:151], a[224:227], a[152:155], v[148:151]
 s_waitcnt lgkmcnt(1)
 v_mfma_f32_16x16x32_bf16 v[152:155], a[224:227], a[160:163], v[152:155]
 v_mfma_f32_16x16x32_bf16 v[152:155], a[228:231], a[164:167], v[152:155]
 v_mfma_f32_16x16x32_bf16 v[156:159], a[228:231], a[172:175], v[156:159]
 v_mfma_f32_16x16x32_bf16 v[156:159], a[224:227], a[168:171], v[156:159]
 v_mfma_f32_16x16x32_bf16 v[160:163], a[224:227], a[176:179], v[160:163]
 v_mfma_f32_16x16x32_bf16 v[160:163], a[228:231], a[180:183], v[160:163]
 v_mfma_f32_16x16x32_bf16 v[164:167], a[228:231], a[188:191], v[164:167]
 v_mfma_f32_16x16x32_bf16 v[164:167], a[224:227], a[184:187], v[164:167]
 s_waitcnt vmcnt(8)
 v_mfma_f32_16x16x32_bf16 v[196:199], a[232:235], a[184:187], v[196:199]
 s_waitcnt lgkmcnt(0)
 v_mfma_f32_16x16x32_bf16 v[196:199], a[236:239], a[188:191], v[196:199]
 global_load_dwordx4 a[228:231], v0, s[70:71] offset:1024 sc1
 v_add_f32 v16, v16, v8
 v_mfma_f32_16x16x32_bf16 v[192:195], a[236:239], a[180:183], v[192:195]
 ds_read_b128 v[12:15], v4 offset:16
 v_mfma_f32_16x16x32_bf16 v[192:195], a[232:235], a[176:179], v[192:195]
 global_load_dwordx4 a[224:227], v0, s[70:71] offset:0 sc1
 v_mfma_f32_16x16x32_bf16 v[188:191], a[232:235], a[168:171], v[188:191]
 v_add_f32 v17, v17, v9
 v_mfma_f32_16x16x32_bf16 v[188:191], a[236:239], a[172:175], v[188:191]
 v_add_f32 v18, v18, v10
 v_mfma_f32_16x16x32_bf16 v[184:187], a[236:239], a[164:167], v[184:187]
 v_mfma_f32_16x16x32_bf16 v[184:187], a[232:235], a[160:163], v[184:187]
 v_add_f32 v19, v19, v11
 v_mfma_f32_16x16x32_bf16 v[180:183], a[232:235], a[152:155], v[180:183]
 v_add_f32 v20, v20, v8
 v_mfma_f32_16x16x32_bf16 v[180:183], a[236:239], a[156:159], v[180:183]
 v_add_f32 v21, v21, v9
 v_mfma_f32_16x16x32_bf16 v[176:179], a[236:239], a[148:151], v[176:179]
 v_mfma_f32_16x16x32_bf16 v[176:179], a[232:235], a[144:147], v[176:179]
 v_add_f32 v22, v22, v10
 v_mfma_f32_16x16x32_bf16 v[172:175], a[232:235], a[136:139], v[172:175]
 v_add_f32 v23, v23, v11
 v_mfma_f32_16x16x32_bf16 v[172:175], a[236:239], a[140:143], v[172:175]
 v_mfma_f32_16x16x32_bf16 v[168:171], a[236:239], a[132:135], v[168:171]
 v_add_f32 v24, v24, v8
 v_mfma_f32_16x16x32_bf16 v[168:171], a[232:235], a[128:131], v[168:171]
 v_add_f32 v25, v25, v9
 s_waitcnt vmcnt(8)
 v_mfma_f32_16x16x32_bf16 v[200:203], a[192:195], a[128:131], v[200:203]
 v_add_f32 v26, v26, v10
 v_mfma_f32_16x16x32_bf16 v[200:203], a[196:199], a[132:135], v[200:203]
 global_load_dwordx4 a[236:239], v0, s[70:71] offset:3072 sc1
 v_mfma_f32_16x16x32_bf16 v[204:207], a[196:199], a[140:143], v[204:207]
 v_add_f32 v27, v27, v11
 v_mfma_f32_16x16x32_bf16 v[204:207], a[192:195], a[136:139], v[204:207]
 global_load_dwordx4 a[232:235], v0, s[70:71] offset:2048 sc1
 v_add_f32 v28, v28, v8
 v_mfma_f32_16x16x32_bf16 v[208:211], a[192:195], a[144:147], v[208:211]
 s_add_u32 s70, s70, 8192
 s_addc_u32 s71, s71, 0
 v_mfma_f32_16x16x32_bf16 v[208:211], a[196:199], a[148:151], v[208:211]
 v_add_f32 v29, v29, v9
 v_mfma_f32_16x16x32_bf16 v[212:215], a[196:199], a[156:159], v[212:215]
 v_add_f32 v30, v30, v10
 v_mfma_f32_16x16x32_bf16 v[212:215], a[192:195], a[152:155], v[212:215]
 v_add_f32 v31, v31, v11
 v_mfma_f32_16x16x32_bf16 v[216:219], a[192:195], a[160:163], v[216:219]
 v_mfma_f32_16x16x32_bf16 v[216:219], a[196:199], a[164:167], v[216:219]
 v_add_f32 v32, v32, v8
 v_mfma_f32_16x16x32_bf16 v[220:223], a[196:199], a[172:175], v[220:223]
 v_add_f32 v33, v33, v9
 v_mfma_f32_16x16x32_bf16 v[220:223], a[192:195], a[168:171], v[220:223]
 v_mfma_f32_16x16x32_bf16 v[224:227], a[192:195], a[176:179], v[224:227]
 v_add_f32 v34, v34, v10
 v_mfma_f32_16x16x32_bf16 v[224:227], a[196:199], a[180:183], v[224:227]
 v_add_f32 v35, v35, v11
 v_mfma_f32_16x16x32_bf16 v[228:231], a[196:199], a[188:191], v[228:231]
 v_add_f32 v36, v36, v8
 v_mfma_f32_16x16x32_bf16 v[228:231], a[192:195], a[184:187], v[228:231]
 v_add_f32 v37, v37, v9
 s_waitcnt vmcnt(8)
 v_mfma_f32_16x16x32_bf16 a[252:255], a[200:203], a[184:187], a[252:255]
 ds_read_b128 a[184:187], v1 offset:61440
 v_add_f32 v38, v38, v10
 v_mfma_f32_16x16x32_bf16 a[252:255], a[204:207], a[188:191], a[252:255]
 global_load_dwordx4 a[196:199], v0, s[70:71] offset:-3072 sc1
 ds_read_b128 a[188:191], v1 offset:62464
 v_mfma_f32_16x16x32_bf16 a[248:251], a[204:207], a[180:183], a[248:251]
 ds_read_b128 a[180:183], v1 offset:58368
 v_add_f32 v39, v39, v11
 v_mfma_f32_16x16x32_bf16 a[248:251], a[200:203], a[176:179], a[248:251]
 global_load_dwordx4 a[192:195], v0, s[70:71] offset:-4096 sc1
 ds_read_b128 a[176:179], v1 offset:57344
 v_mfma_f32_16x16x32_bf16 v[252:255], a[200:203], a[168:171], v[252:255]
 ds_read_b128 a[168:171], v1 offset:53248
 v_add_f32 v40, v40, v8
 v_mfma_f32_16x16x32_bf16 v[252:255], a[204:207], a[172:175], v[252:255]
 ds_read_b128 a[172:175], v1 offset:54272
 v_add_f32 v41, v41, v9
 v_mfma_f32_16x16x32_bf16 v[248:251], a[204:207], a[164:167], v[248:251]
 ds_read_b128 a[164:167], v1 offset:50176
 v_mfma_f32_16x16x32_bf16 v[248:251], a[200:203], a[160:163], v[248:251]
 ds_read_b128 a[160:163], v1 offset:49152
 v_add_f32 v42, v42, v10
 v_mfma_f32_16x16x32_bf16 v[244:247], a[200:203], a[152:155], v[244:247]
 ds_read_b128 a[152:155], v1 offset:45056
 v_add_f32 v43, v43, v11
 v_mfma_f32_16x16x32_bf16 v[244:247], a[204:207], a[156:159], v[244:247]
 ds_read_b128 a[156:159], v1 offset:46080
 v_mfma_f32_16x16x32_bf16 v[240:243], a[204:207], a[148:151], v[240:243]
 ds_read_b128 a[148:151], v1 offset:41984
 v_add_f32 v44, v44, v8
 v_mfma_f32_16x16x32_bf16 v[240:243], a[200:203], a[144:147], v[240:243]
 ds_read_b128 a[144:147], v1 offset:40960
 v_add_f32 v45, v45, v9
 v_mfma_f32_16x16x32_bf16 v[236:239], a[200:203], a[136:139], v[236:239]
 ds_read_b128 a[136:139], v1 offset:36864
 v_add_f32 v46, v46, v10
 v_mfma_f32_16x16x32_bf16 v[236:239], a[204:207], a[140:143], v[236:239]
 ds_read_b128 a[140:143], v1 offset:37888
 v_mfma_f32_16x16x32_bf16 v[232:235], a[204:207], a[132:135], v[232:235]
 ds_read_b128 a[132:135], v1 offset:33792
 v_add_f32 v47, v47, v11
 v_mfma_f32_16x16x32_bf16 v[232:235], a[200:203], a[128:131], v[232:235]
 ds_read_b128 a[128:131], v1 offset:32768
 s_waitcnt lgkmcnt(15)
 s_waitcnt vmcnt(8) lgkmcnt(8)
 v_mfma_f32_16x16x32_bf16 v[164:167], a[208:211], a[184:187], v[164:167]
 v_mfma_f32_16x16x32_bf16 v[164:167], a[212:215], a[188:191], v[164:167]
 global_load_dwordx4 a[204:207], v0, s[70:71] offset:-1024 sc1
 v_add_f32 v48, v48, v12
 v_mfma_f32_16x16x32_bf16 v[160:163], a[212:215], a[180:183], v[160:163]
 ds_read_b128 v[8:11], v4 offset:128
 v_mfma_f32_16x16x32_bf16 v[160:163], a[208:211], a[176:179], v[160:163]
 global_load_dwordx4 a[200:203], v0, s[70:71] offset:-2048 sc1
 v_add_f32 v49, v49, v13
 v_mfma_f32_16x16x32_bf16 v[156:159], a[208:211], a[168:171], v[156:159]
 v_mfma_f32_16x16x32_bf16 v[156:159], a[212:215], a[172:175], v[156:159]
 v_add_f32 v50, v50, v14
 v_mfma_f32_16x16x32_bf16 v[152:155], a[212:215], a[164:167], v[152:155]
 v_add_f32 v51, v51, v15
 v_mfma_f32_16x16x32_bf16 v[152:155], a[208:211], a[160:163], v[152:155]
 s_waitcnt lgkmcnt(1)
 v_mfma_f32_16x16x32_bf16 v[148:151], a[208:211], a[152:155], v[148:151]
 v_add_f32 v52, v52, v12
 v_mfma_f32_16x16x32_bf16 v[148:151], a[212:215], a[156:159], v[148:151]
 v_add_f32 v53, v53, v13
 v_mfma_f32_16x16x32_bf16 v[144:147], a[212:215], a[148:151], v[144:147]
 v_add_f32 v54, v54, v14
 v_mfma_f32_16x16x32_bf16 v[144:147], a[208:211], a[144:147], v[144:147]
 v_mfma_f32_16x16x32_bf16 v[140:143], a[208:211], a[136:139], v[140:143]
 v_add_f32 v55, v55, v15
 v_mfma_f32_16x16x32_bf16 v[140:143], a[212:215], a[140:143], v[140:143]
 v_add_f32 v56, v56, v12
 v_mfma_f32_16x16x32_bf16 v[136:139], a[212:215], a[132:135], v[136:139]
 v_mfma_f32_16x16x32_bf16 v[136:139], a[208:211], a[128:131], v[136:139]
 v_add_f32 v57, v57, v13
 s_waitcnt vmcnt(8)
 v_mfma_f32_16x16x32_bf16 v[168:171], a[216:219], a[128:131], v[168:171]
 v_add_f32 v58, v58, v14
 v_mfma_f32_16x16x32_bf16 v[168:171], a[220:223], a[132:135], v[168:171]
 global_load_dwordx4 a[212:215], v0, s[70:71] offset:1024 sc1
 v_add_f32 v59, v59, v15
 v_mfma_f32_16x16x32_bf16 v[172:175], a[220:223], a[140:143], v[172:175]
 v_mfma_f32_16x16x32_bf16 v[172:175], a[216:219], a[136:139], v[172:175]
 global_load_dwordx4 a[208:211], v0, s[70:71] offset:0 sc1
 v_add_f32 v60, v60, v12
 v_mfma_f32_16x16x32_bf16 v[176:179], a[216:219], a[144:147], v[176:179]
 v_add_f32 v61, v61, v13
 v_mfma_f32_16x16x32_bf16 v[176:179], a[220:223], a[148:151], v[176:179]
 v_mfma_f32_16x16x32_bf16 v[180:183], a[220:223], a[156:159], v[180:183]
 v_add_f32 v62, v62, v14
 v_mfma_f32_16x16x32_bf16 v[180:183], a[216:219], a[152:155], v[180:183]
 v_add_f32 v63, v63, v15
 v_mfma_f32_16x16x32_bf16 v[184:187], a[216:219], a[160:163], v[184:187]
 v_add_f32 v64, v64, v12
 v_mfma_f32_16x16x32_bf16 v[184:187], a[220:223], a[164:167], v[184:187]
 v_mfma_f32_16x16x32_bf16 v[188:191], a[220:223], a[172:175], v[188:191]
 v_add_f32 v65, v65, v13
 v_mfma_f32_16x16x32_bf16 v[188:191], a[216:219], a[168:171], v[188:191]
 v_add_f32 v66, v66, v14
 v_mfma_f32_16x16x32_bf16 v[192:195], a[216:219], a[176:179], v[192:195]
 v_mfma_f32_16x16x32_bf16 v[192:195], a[220:223], a[180:183], v[192:195]
 v_add_f32 v67, v67, v15
 v_mfma_f32_16x16x32_bf16 v[196:199], a[220:223], a[188:191], v[196:199]
 v_add_f32 v68, v68, v12
 v_mfma_f32_16x16x32_bf16 v[196:199], a[216:219], a[184:187], v[196:199]
 v_add_f32 v69, v69, v13
 s_waitcnt vmcnt(8)
 v_mfma_f32_16x16x32_bf16 v[228:231], a[224:227], a[184:187], v[228:231]
 v_mfma_f32_16x16x32_bf16 v[228:231], a[228:231], a[188:191], v[228:231]
 global_load_dwordx4 a[220:223], v0, s[70:71] offset:3072 sc1
 v_add_f32 v70, v70, v14
 v_mfma_f32_16x16x32_bf16 v[224:227], a[228:231], a[180:183], v[224:227]
 v_add_f32 v71, v71, v15
 v_mfma_f32_16x16x32_bf16 v[224:227], a[224:227], a[176:179], v[224:227]
 global_load_dwordx4 a[216:219], v0, s[70:71] offset:2048 sc1
 v_mfma_f32_16x16x32_bf16 v[220:223], a[224:227], a[168:171], v[220:223]
 v_add_f32 v72, v72, v12
 s_add_u32 s70, s70, 8192
 s_addc_u32 s71, s71, 0
 v_mfma_f32_16x16x32_bf16 v[220:223], a[228:231], a[172:175], v[220:223]
 s_add_u32 s31, s31, 1
 v_mfma_f32_16x16x32_bf16 v[216:219], a[228:231], a[164:167], v[216:219]
 v_mfma_f32_16x16x32_bf16 v[216:219], a[224:227], a[160:163], v[216:219]
 v_mfma_f32_16x16x32_bf16 v[212:215], a[224:227], a[152:155], v[212:215]
 v_mov_b32 v7, s31
 v_mfma_f32_16x16x32_bf16 v[212:215], a[228:231], a[156:159], v[212:215]
 buffer_store_dword v7, v1, s[60:63], 0 offen sc1
 v_mfma_f32_16x16x32_bf16 v[208:211], a[228:231], a[148:151], v[208:211]
 v_mfma_f32_16x16x32_bf16 v[208:211], a[224:227], a[144:147], v[208:211]
 v_add_f32 v73, v73, v13
 v_mfma_f32_16x16x32_bf16 v[204:207], a[224:227], a[136:139], v[204:207]
 v_add_f32 v74, v74, v14
 v_mfma_f32_16x16x32_bf16 v[204:207], a[228:231], a[140:143], v[204:207]
 v_add_f32 v75, v75, v15
 v_mfma_f32_16x16x32_bf16 v[200:203], a[228:231], a[132:135], v[200:203]
 v_mfma_f32_16x16x32_bf16 v[200:203], a[224:227], a[128:131], v[200:203]
 v_add_f32 v76, v76, v12
 s_waitcnt vmcnt(9)
 v_mfma_f32_16x16x32_bf16 v[232:235], a[232:235], a[128:131], v[232:235]
 ds_read_b128 a[128:131], v2
 v_add_f32 v77, v77, v13
 v_mfma_f32_16x16x32_bf16 v[232:235], a[236:239], a[132:135], v[232:235]
 global_load_dwordx4 a[228:231], v0, s[70:71] offset:-3072 sc1
 ds_read_b128 a[132:135], v2 offset:1024
 v_mfma_f32_16x16x32_bf16 v[236:239], a[236:239], a[140:143], v[236:239]
 ds_read_b128 a[140:143], v2 offset:5120
 v_add_f32 v78, v78, v14
 v_mfma_f32_16x16x32_bf16 v[236:239], a[232:235], a[136:139], v[236:239]
 global_load_dwordx4 a[224:227], v0, s[70:71] offset:-4096 sc1
 ds_read_b128 a[136:139], v2 offset:4096
 v_mfma_f32_16x16x32_bf16 v[240:243], a[232:235], a[144:147], v[240:243]
 ds_read_b128 a[144:147], v2 offset:8192
 v_add_f32 v79, v79, v15
 v_mfma_f32_16x16x32_bf16 v[240:243], a[236:239], a[148:151], v[240:243]
 ds_read_b128 a[148:151], v2 offset:9216
 s_waitcnt lgkmcnt(6)
 v_mfma_f32_16x16x32_bf16 v[244:247], a[236:239], a[156:159], v[244:247]
 ds_read_b128 a[156:159], v2 offset:13312
 v_add_f32 v80, v80, v8
 v_mfma_f32_16x16x32_bf16 v[244:247], a[232:235], a[152:155], v[244:247]
 ds_read_b128 a[152:155], v2 offset:12288
 ds_read_b128 v[12:15], v4 offset:144
 v_mfma_f32_16x16x32_bf16 v[248:251], a[232:235], a[160:163], v[248:251]
 ds_read_b128 a[160:163], v2 offset:16384
 v_mfma_f32_16x16x32_bf16 v[248:251], a[236:239], a[164:167], v[248:251]
 ds_read_b128 a[164:167], v2 offset:17408
 v_add_f32 v81, v81, v9
 v_mfma_f32_16x16x32_bf16 v[252:255], a[236:239], a[172:175], v[252:255]
 ds_read_b128 a[172:175], v2 offset:21504
 v_add_f32 v82, v82, v10
 v_mfma_f32_16x16x32_bf16 v[252:255], a[232:235], a[168:171], v[252:255]
 ds_read_b128 a[168:171], v2 offset:20480
 v_mfma_f32_16x16x32_bf16 a[248:251], a[232:235], a[176:179], a[248:251]
 ds_read_b128 a[176:179], v2 offset:24576
 v_add_f32 v83, v83, v11
 v_mfma_f32_16x16x32_bf16 a[248:251], a[236:239], a[180:183], a[248:251]
 ds_read_b128 a[180:183], v2 offset:25600
 v_add_f32 v84, v84, v8
 v_mfma_f32_16x16x32_bf16 a[252:255], a[236:239], a[188:191], a[252:255]
 ds_read_b128 a[188:191], v2 offset:29696
 v_add_f32 v85, v85, v9
 v_mfma_f32_16x16x32_bf16 a[252:255], a[232:235], a[184:187], a[252:255]
 ds_read_b128 a[184:187], v2 offset:28672
 s_waitcnt vmcnt(9) lgkmcnt(9)
 v_mfma_f32_16x16x32_bf16 v[136:139], a[192:195], a[128:131], v[136:139]
 v_add_f32 v86, v86, v10
 v_mfma_f32_16x16x32_bf16 v[136:139], a[196:199], a[132:135], v[136:139]
 global_load_dwordx4 a[236:239], v0, s[70:71] offset:-1024 sc1
 v_add_f32 v87, v87, v11
 v_mfma_f32_16x16x32_bf16 v[140:143], a[196:199], a[140:143], v[140:143]
 v_mfma_f32_16x16x32_bf16 v[140:143], a[192:195], a[136:139], v[140:143]
 global_load_dwordx4 a[232:235], v0, s[70:71] offset:-2048 sc1
 v_add_f32 v88, v88, v8
 v_mfma_f32_16x16x32_bf16 v[144:147], a[192:195], a[144:147], v[144:147]
 v_add_f32 v89, v89, v9
 v_mfma_f32_16x16x32_bf16 v[144:147], a[196:199], a[148:151], v[144:147]
 v_add_f32 v90, v90, v10
 v_mfma_f32_16x16x32_bf16 v[148:151], a[196:199], a[156:159], v[148:151]
 v_mfma_f32_16x16x32_bf16 v[148:151], a[192:195], a[152:155], v[148:151]
 v_add_f32 v91, v91, v11
 s_waitcnt lgkmcnt(0)
 v_mfma_f32_16x16x32_bf16 v[152:155], a[192:195], a[160:163], v[152:155]
 v_add_f32 v92, v92, v8
 v_mfma_f32_16x16x32_bf16 v[152:155], a[196:199], a[164:167], v[152:155]
 v_mfma_f32_16x16x32_bf16 v[156:159], a[196:199], a[172:175], v[156:159]
 v_add_f32 v93, v93, v9
 v_mfma_f32_16x16x32_bf16 v[156:159], a[192:195], a[168:171], v[156:159]
 buffer_load_dword v4, off, s[64:67], 0 sc1
 v_mfma_f32_16x16x32_bf16 v[160:163], a[192:195], a[176:179], v[160:163]
 v_add_f32 v94, v94, v10
 v_mfma_f32_16x16x32_bf16 v[160:163], a[196:199], a[180:183], v[160:163]
 v_mfma_f32_16x16x32_bf16 v[164:167], a[196:199], a[188:191], v[164:167]
 v_add_f32 v95, v95, v11
 v_mfma_f32_16x16x32_bf16 v[164:167], a[192:195], a[184:187], v[164:167]
 v_add_f32 v96, v96, v8
 s_waitcnt vmcnt(10)
 v_mfma_f32_16x16x32_bf16 v[196:199], a[200:203], a[184:187], v[196:199]
 v_mfma_f32_16x16x32_bf16 v[196:199], a[204:207], a[188:191], v[196:199]
 global_load_dwordx4 a[196:199], v0, s[70:71] offset:1024 sc1
 v_add_f32 v97, v97, v9
 v_mfma_f32_16x16x32_bf16 v[192:195], a[204:207], a[180:183], v[192:195]
 v_add_f32 v98, v98, v10
 v_mfma_f32_16x16x32_bf16 v[192:195], a[200:203], a[176:179], v[192:195]
 global_load_dwordx4 a[192:195], v0, s[70:71] offset:0 sc1
 v_add_f32 v99, v99, v11
 v_mfma_f32_16x16x32_bf16 v[188:191], a[200:203], a[168:171], v[188:191]
 v_mfma_f32_16x16x32_bf16 v[188:191], a[204:207], a[172:175], v[188:191]
 v_add_f32 v100, v100, v8
 v_mfma_f32_16x16x32_bf16 v[184:187], a[204:207], a[164:167], v[184:187]
 v_add_f32 v101, v101, v9
 v_mfma_f32_16x16x32_bf16 v[184:187], a[200:203], a[160:163], v[184:187]
 v_mfma_f32_16x16x32_bf16 v[180:183], a[200:203], a[152:155], v[180:183]
 v_add_f32 v102, v102, v10
 v_mfma_f32_16x16x32_bf16 v[180:183], a[204:207], a[156:159], v[180:183]
 v_add_f32 v103, v103, v11
 v_mfma_f32_16x16x32_bf16 v[176:179], a[204:207], a[148:151], v[176:179]
 v_add_f32 v104, v104, v8
 v_mfma_f32_16x16x32_bf16 v[176:179], a[200:203], a[144:147], v[176:179]
 v_mfma_f32_16x16x32_bf16 v[172:175], a[200:203], a[136:139], v[172:175]
 v_add_f32 v105, v105, v9
 v_mfma_f32_16x16x32_bf16 v[172:175], a[204:207], a[140:143], v[172:175]
 v_add_f32 v106, v106, v10
 v_mfma_f32_16x16x32_bf16 v[168:171], a[204:207], a[132:135], v[168:171]
 v_mfma_f32_16x16x32_bf16 v[168:171], a[200:203], a[128:131], v[168:171]
 v_add_f32 v107, v107, v11
 s_waitcnt vmcnt(10)
 v_mfma_f32_16x16x32_bf16 v[200:203], a[208:211], a[128:131], v[200:203]
 v_add_f32 v108, v108, v8
 v_mfma_f32_16x16x32_bf16 v[200:203], a[212:215], a[132:135], v[200:203]
 global_load_dwordx4 a[204:207], v0, s[70:71] offset:3072 sc1
 v_add_f32 v109, v109, v9
 v_mfma_f32_16x16x32_bf16 v[204:207], a[212:215], a[140:143], v[204:207]
 v_mfma_f32_16x16x32_bf16 v[204:207], a[208:211], a[136:139], v[204:207]
 global_load_dwordx4 a[200:203], v0, s[70:71] offset:2048 sc1
 v_add_f32 v110, v110, v10
 v_mfma_f32_16x16x32_bf16 v[208:211], a[208:211], a[144:147], v[208:211]
 v_add_f32 v111, v111, v11
 s_add_u32 s70, s70, 8192
 s_addc_u32 s71, s71, 0
 v_mfma_f32_16x16x32_bf16 v[208:211], a[212:215], a[148:151], v[208:211]
 v_mfma_f32_16x16x32_bf16 v[212:215], a[212:215], a[156:159], v[212:215]
 v_mfma_f32_16x16x32_bf16 v[212:215], a[208:211], a[152:155], v[212:215]
 v_add_f32 v112, v112, v12
 v_mfma_f32_16x16x32_bf16 v[216:219], a[208:211], a[160:163], v[216:219]
 v_add_f32 v113, v113, v13
 v_mfma_f32_16x16x32_bf16 v[216:219], a[212:215], a[164:167], v[216:219]
 v_mfma_f32_16x16x32_bf16 v[220:223], a[212:215], a[172:175], v[220:223]
 v_add_f32 v114, v114, v14
 v_mfma_f32_16x16x32_bf16 v[220:223], a[208:211], a[168:171], v[220:223]
 v_add_f32 v115, v115, v15
 v_mfma_f32_16x16x32_bf16 v[224:227], a[208:211], a[176:179], v[224:227]
 v_mfma_f32_16x16x32_bf16 v[224:227], a[212:215], a[180:183], v[224:227]
 v_add_f32 v116, v116, v12
 v_mfma_f32_16x16x32_bf16 v[228:231], a[212:215], a[188:191], v[228:231]
 v_add_f32 v117, v117, v13
 v_mfma_f32_16x16x32_bf16 v[228:231], a[208:211], a[184:187], v[228:231]
 v_add_f32 v118, v118, v14
 s_waitcnt vmcnt(10)
 v_mfma_f32_16x16x32_bf16 a[252:255], a[216:219], a[184:187], a[252:255]
 ds_read_b128 a[184:187], v2 offset:61440
 v_add_f32 v119, v119, v15
 v_mfma_f32_16x16x32_bf16 a[252:255], a[220:223], a[188:191], a[252:255]
 global_load_dwordx4 a[212:215], v0, s[70:71] offset:-3072 sc1
 ds_read_b128 a[188:191], v2 offset:62464
 v_mfma_f32_16x16x32_bf16 a[248:251], a[220:223], a[180:183], a[248:251]
 ds_read_b128 a[180:183], v2 offset:58368
 v_add_f32 v120, v120, v12
 v_mfma_f32_16x16x32_bf16 a[248:251], a[216:219], a[176:179], a[248:251]
 global_load_dwordx4 a[208:211], v0, s[70:71] offset:-4096 sc1
 ds_read_b128 a[176:179], v2 offset:57344
 v_mfma_f32_16x16x32_bf16 v[252:255], a[216:219], a[168:171], v[252:255]
 ds_read_b128 a[168:171], v2 offset:53248
 v_add_f32 v121, v121, v13
 v_mfma_f32_16x16x32_bf16 v[252:255], a[220:223], a[172:175], v[252:255]
 ds_read_b128 a[172:175], v2 offset:54272
 v_add_f32 v122, v122, v14
 v_mfma_f32_16x16x32_bf16 v[248:251], a[220:223], a[164:167], v[248:251]
 ds_read_b128 a[164:167], v2 offset:50176
 v_add_f32 v123, v123, v15
 v_mfma_f32_16x16x32_bf16 v[248:251], a[216:219], a[160:163], v[248:251]
 ds_read_b128 a[160:163], v2 offset:49152
 v_mfma_f32_16x16x32_bf16 v[244:247], a[216:219], a[152:155], v[244:247]
 ds_read_b128 a[152:155], v2 offset:45056
 v_add_f32 v124, v124, v12
 v_mfma_f32_16x16x32_bf16 v[244:247], a[220:223], a[156:159], v[244:247]
 ds_read_b128 a[156:159], v2 offset:46080
 v_add_f32 v125, v125, v13
 v_mfma_f32_16x16x32_bf16 v[240:243], a[220:223], a[148:151], v[240:243]
 ds_read_b128 a[148:151], v2 offset:41984
 v_mfma_f32_16x16x32_bf16 v[240:243], a[216:219], a[144:147], v[240:243]
 ds_read_b128 a[144:147], v2 offset:40960
 v_add_f32 v126, v126, v14
 v_mfma_f32_16x16x32_bf16 v[236:239], a[216:219], a[136:139], v[236:239]
 ds_read_b128 a[136:139], v2 offset:36864
 v_add_f32 v127, v127, v15
 v_mfma_f32_16x16x32_bf16 v[236:239], a[220:223], a[140:143], v[236:239]
 ds_read_b128 a[140:143], v2 offset:37888
 v_add_f32 v128, v128, v12
 v_mfma_f32_16x16x32_bf16 v[232:235], a[220:223], a[132:135], v[232:235]
 ds_read_b128 a[132:135], v2 offset:33792
 v_mfma_f32_16x16x32_bf16 v[232:235], a[216:219], a[128:131], v[232:235]
 ds_read_b128 a[128:131], v2 offset:32768
 v_add_f32 v129, v129, v13
 s_waitcnt vmcnt(9) lgkmcnt(8)
 v_mfma_f32_16x16x32_bf16 v[164:167], a[224:227], a[184:187], v[164:167]
 v_add_f32 v130, v130, v14
 v_mfma_f32_16x16x32_bf16 v[164:167], a[228:231], a[188:191], v[164:167]
 global_load_dwordx4 a[220:223], v0, s[70:71] offset:-1024 sc1
 v_mfma_f32_16x16x32_bf16 v[160:163], a[228:231], a[180:183], v[160:163]
 v_add_f32 v131, v131, v15
 v_mfma_f32_16x16x32_bf16 v[160:163], a[224:227], a[176:179], v[160:163]
 global_load_dwordx4 a[216:219], v0, s[70:71] offset:-2048 sc1
 v_add_f32 v132, v132, v12
 v_mfma_f32_16x16x32_bf16 v[156:159], a[224:227], a[168:171], v[156:159]
 v_add_f32 v133, v133, v13
 v_mfma_f32_16x16x32_bf16 v[156:159], a[228:231], a[172:175], v[156:159]
 v_mfma_f32_16x16x32_bf16 v[152:155], a[228:231], a[164:167], v[152:155]
 v_add_f32 v134, v134, v14
 v_mfma_f32_16x16x32_bf16 v[152:155], a[224:227], a[160:163], v[152:155]
 v_add_f32 v135, v135, v15
 s_waitcnt lgkmcnt(0)
 v_mfma_f32_16x16x32_bf16 v[148:151], a[224:227], a[152:155], v[148:151]
 v_mfma_f32_16x16x32_bf16 v[148:151], a[228:231], a[156:159], v[148:151]
 v_accvgpr_read_b32 v5, a240
 v_mfma_f32_16x16x32_bf16 v[144:147], a[228:231], a[148:151], v[144:147]
 v_add_f32 v5, v5, v12
 v_mfma_f32_16x16x32_bf16 v[144:147], a[224:227], a[144:147], v[144:147]
 v_accvgpr_write_b32 a240, v5
 v_mfma_f32_16x16x32_bf16 v[140:143], a[224:227], a[136:139], v[140:143]
 v_mfma_f32_16x16x32_bf16 v[140:143], a[228:231], a[140:143], v[140:143]
 v_accvgpr_read_b32 v6, a241
 v_mfma_f32_16x16x32_bf16 v[136:139], a[228:231], a[132:135], v[136:139]
 v_add_f32 v6, v6, v13
 v_mfma_f32_16x16x32_bf16 v[136:139], a[224:227], a[128:131], v[136:139]
 s_waitcnt vmcnt(9)
 v_mfma_f32_16x16x32_bf16 v[168:171], a[232:235], a[128:131], v[168:171]
 v_accvgpr_write_b32 a241, v6
 v_mfma_f32_16x16x32_bf16 v[168:171], a[236:239], a[132:135], v[168:171]
 global_load_dwordx4 a[228:231], v0, s[70:71] offset:1024 sc1
 v_accvgpr_read_b32 v5, a242
 v_mfma_f32_16x16x32_bf16 v[172:175], a[236:239], a[140:143], v[172:175]
 v_add_f32 v5, v5, v14
 v_mfma_f32_16x16x32_bf16 v[172:175], a[232:235], a[136:139], v[172:175]
 global_load_dwordx4 a[224:227], v0, s[70:71] offset:0 sc1
 v_mfma_f32_16x16x32_bf16 v[176:179], a[232:235], a[144:147], v[176:179]
 v_accvgpr_write_b32 a242, v5
 v_mfma_f32_16x16x32_bf16 v[176:179], a[236:239], a[148:151], v[176:179]
 v_accvgpr_read_b32 v6, a243
 v_mfma_f32_16x16x32_bf16 v[180:183], a[236:239], a[156:159], v[180:183]
 v_mfma_f32_16x16x32_bf16 v[180:183], a[232:235], a[152:155], v[180:183]
 v_add_f32 v6, v6, v15
 v_mfma_f32_16x16x32_bf16 v[184:187], a[232:235], a[160:163], v[184:187]
 v_accvgpr_write_b32 a243, v6
 v_mfma_f32_16x16x32_bf16 v[184:187], a[236:239], a[164:167], v[184:187]
 v_accvgpr_read_b32 v5, a244
 v_mfma_f32_16x16x32_bf16 v[188:191], a[236:239], a[172:175], v[188:191]
 v_mfma_f32_16x16x32_bf16 v[188:191], a[232:235], a[168:171], v[188:191]
 v_add_f32 v5, v5, v12
 v_mfma_f32_16x16x32_bf16 v[192:195], a[232:235], a[176:179], v[192:195]
 v_accvgpr_write_b32 a244, v5
 v_mfma_f32_16x16x32_bf16 v[192:195], a[236:239], a[180:183], v[192:195]
 v_mfma_f32_16x16x32_bf16 v[196:199], a[236:239], a[188:191], v[196:199]
 v_accvgpr_read_b32 v6, a245
 v_mfma_f32_16x16x32_bf16 v[196:199], a[232:235], a[184:187], v[196:199]
 v_add_f32 v6, v6, v13
 s_waitcnt vmcnt(8)
 v_mfma_f32_16x16x32_bf16 v[228:231], a[192:195], a[184:187], v[228:231]
 v_accvgpr_write_b32 a245, v6
 v_mfma_f32_16x16x32_bf16 v[228:231], a[196:199], a[188:191], v[228:231]
 global_load_dwordx4 a[236:239], v0, s[70:71] offset:3072 sc1
 v_mfma_f32_16x16x32_bf16 v[224:227], a[196:199], a[180:183], v[224:227]
 v_accvgpr_read_b32 v5, a246
 v_mfma_f32_16x16x32_bf16 v[224:227], a[192:195], a[176:179], v[224:227]
 global_load_dwordx4 a[232:235], v0, s[70:71] offset:2048 sc1
 v_add_f32 v5, v5, v14
 v_mfma_f32_16x16x32_bf16 v[220:223], a[192:195], a[168:171], v[220:223]
 s_add_u32 s70, s70, 8192
 s_addc_u32 s71, s71, 0
 v_mfma_f32_16x16x32_bf16 v[220:223], a[196:199], a[172:175], v[220:223]
 v_accvgpr_write_b32 a246, v5
 v_mfma_f32_16x16x32_bf16 v[216:219], a[196:199], a[164:167], v[216:219]
 v_accvgpr_read_b32 v6, a247
 v_mfma_f32_16x16x32_bf16 v[216:219], a[192:195], a[160:163], v[216:219]
 v_add_f32 v6, v6, v15
 v_mfma_f32_16x16x32_bf16 v[212:215], a[192:195], a[152:155], v[212:215]
 v_mfma_f32_16x16x32_bf16 v[212:215], a[196:199], a[156:159], v[212:215]
 v_accvgpr_write_b32 a247, v6
 v_mfma_f32_16x16x32_bf16 v[208:211], a[196:199], a[148:151], v[208:211]
 v_cmp_gt_i32 vcc, s55, v4
 s_cbranch_vccnz Lspin_pa
Lok_pa:
 s_add_u32 s55, s55, 1
 s_waitcnt lgkmcnt(0)
 s_barrier
 v_mfma_f32_16x16x32_bf16 v[208:211], a[192:195], a[144:147], v[208:211]
 v_mfma_f32_16x16x32_bf16 v[204:207], a[192:195], a[136:139], v[204:207]
 v_mfma_f32_16x16x32_bf16 v[204:207], a[196:199], a[140:143], v[204:207]
 v_mfma_f32_16x16x32_bf16 v[200:203], a[196:199], a[132:135], v[200:203]
 v_mfma_f32_16x16x32_bf16 v[200:203], a[192:195], a[128:131], v[200:203]
 s_waitcnt vmcnt(8)
 v_mfma_f32_16x16x32_bf16 v[232:235], a[200:203], a[128:131], v[232:235]
 ds_read_b128 a[128:131], v1 offset:2048
 v_mfma_f32_16x16x32_bf16 v[232:235], a[204:207], a[132:135], v[232:235]
 global_load_dwordx4 a[196:199], v0, s[70:71] offset:-3072 sc1
 ds_read_b128 a[132:135], v1 offset:3072
 v_mfma_f32_16x16x32_bf16 v[236:239], a[204:207], a[140:143], v[236:239]
 ds_read_b128 a[140:143], v1 offset:7168
 v_mfma_f32_16x16x32_bf16 v[236:239], a[200:203], a[136:139], v[236:239]
 global_load_dwordx4 a[192:195], v0, s[70:71] offset:-4096 sc1
 ds_read_b128 a[136:139], v1 offset:6144
 v_mfma_f32_16x16x32_bf16 v[240:243], a[200:203], a[144:147], v[240:243]
 ds_read_b128 a[144:147], v1 offset:10240
 v_mfma_f32_16x16x32_bf16 v[240:243], a[204:207], a[148:151], v[240:243]
 ds_read_b128 a[148:151], v1 offset:11264
 v_mfma_f32_16x16x32_bf16 v[244:247], a[204:207], a[156:159], v[244:247]
 ds_read_b128 a[156:159], v1 offset:15360
 v_mfma_f32_16x16x32_bf16 v[244:247], a[200:203], a[152:155], v[244:247]
 ds_read_b128 a[152:155], v1 offset:14336
 v_mfma_f32_16x16x32_bf16 v[248:251], a[200:203], a[160:163], v[248:251]
 ds_read_b128 a[160:163], v1 offset:18432
 v_mfma_f32_16x16x32_bf16 v[248:251], a[204:207], a[164:167], v[248:251]
 ds_read_b128 a[164:167], v1 offset:19456
 v_mfma_f32_16x16x32_bf16 v[252:255], a[204:207], a[172:175], v[252:255]
 ds_read_b128 a[172:175], v1 offset:23552
 v_mfma_f32_16x16x32_bf16 v[252:255], a[200:203], a[168:171], v[252:255]
 ds_read_b128 a[168:171], v1 offset:22528
 v_mfma_f32_16x16x32_bf16 a[248:251], a[200:203], a[176:179], a[248:251]
 ds_read_b128 a[176:179], v1 offset:26624
 v_mfma_f32_16x16x32_bf16 a[248:251], a[204:207], a[180:183], a[248:251]
 ds_read_b128 a[180:183], v1 offset:27648
 v_mfma_f32_16x16x32_bf16 a[252:255], a[204:207], a[188:191], a[252:255]
 global_load_dwordx4 a[204:207], v0, s[70:71] offset:-1024 sc1
 ds_read_b128 a[188:191], v1 offset:31744
 v_mfma_f32_16x16x32_bf16 a[252:255], a[200:203], a[184:187], a[252:255]
 global_load_dwordx4 a[200:203], v0, s[70:71] offset:-2048 sc1
 ds_read_b128 a[184:187], v1 offset:30720
 s_waitcnt vmcnt(10) lgkmcnt(8)
 v_mfma_f32_16x16x32_bf16 v[16:19], a[208:211], a[128:131], v[16:19]
 v_mov_b32 v6, v3
 s_cmp_eq_u32 s25, 0
 s_cbranch_scc1 Lgat0
Lgatr0:
 v_mfma_f32_16x16x32_bf16 v[16:19], a[212:215], a[132:135], v[16:19]
 s_add_u32 s29, s29, 0x2000000
 v_mfma_f32_16x16x32_bf16 v[20:23], a[212:215], a[140:143], v[20:23]
 s_add_u32 m0, s50, 0
 v_mfma_f32_16x16x32_bf16 v[20:23], a[208:211], a[136:139], v[20:23]
 v_mfma_f32_16x16x32_bf16 v[24:27], a[208:211], a[144:147], v[24:27]
 v_mfma_f32_16x16x32_bf16 v[24:27], a[212:215], a[148:151], v[24:27]
 buffer_load_dwordx4 v6, s[8:11], s30 offen lds
 v_mfma_f32_16x16x32_bf16 v[28:31], a[212:215], a[156:159], v[28:31]
 s_add_u32 m0, m0, 1024
 v_mfma_f32_16x16x32_bf16 v[28:31], a[208:211], a[152:155], v[28:31]
 s_waitcnt lgkmcnt(0)
 v_mfma_f32_16x16x32_bf16 v[32:35], a[208:211], a[160:163], v[32:35]
 s_add_u32 s30, s30, s20
 v_mfma_f32_16x16x32_bf16 v[32:35], a[212:215], a[164:167], v[32:35]
 buffer_load_dwordx4 v6, s[8:11], s30 offen lds
 v_mfma_f32_16x16x32_bf16 v[36:39], a[212:215], a[172:175], v[36:39]
 v_mfma_f32_16x16x32_bf16 v[36:39], a[208:211], a[168:171], v[36:39]
 s_add_u32 m0, m0, 3072
 v_mfma_f32_16x16x32_bf16 v[40:43], a[208:211], a[176:179], v[40:43]
 s_add_u32 s30, s30, s21
 v_mfma_f32_16x16x32_bf16 v[40:43], a[212:215], a[180:183], v[40:43]
 v_mfma_f32_16x16x32_bf16 v[44:47], a[212:215], a[188:191], v[44:47]
 v_mfma_f32_16x16x32_bf16 v[44:47], a[208:211], a[184:187], v[44:47]
 s_waitcnt vmcnt(10)
 v_mfma_f32_16x16x32_bf16 v[76:79], a[216:219], a[184:187], v[76:79]
 v_mfma_f32_16x16x32_bf16 v[76:79], a[220:223], a[188:191], v[76:79]
 global_load_dwordx4 a[212:215], v0, s[70:71] offset:1024 sc1
 v_mfma_f32_16x16x32_bf16 v[72:75], a[220:223], a[180:183], v[72:75]
 v_mfma_f32_16x16x32_bf16 v[72:75], a[216:219], a[176:179], v[72:75]
 global_load_dwordx4 a[208:211], v0, s[70:71] offset:0 sc1
 v_mfma_f32_16x16x32_bf16 v[68:71], a[216:219], a[168:171], v[68:71]
 v_mfma_f32_16x16x32_bf16 v[68:71], a[220:223], a[172:175], v[68:71]
 v_mfma_f32_16x16x32_bf16 v[64:67], a[220:223], a[164:167], v[64:67]
 v_mfma_f32_16x16x32_bf16 v[64:67], a[216:219], a[160:163], v[64:67]
 v_mfma_f32_16x16x32_bf16 v[60:63], a[216:219], a[152:155], v[60:63]
 v_mfma_f32_16x16x32_bf16 v[60:63], a[220:223], a[156:159], v[60:63]
 v_mfma_f32_16x16x32_bf16 v[56:59], a[220:223], a[148:151], v[56:59]
 v_mfma_f32_16x16x32_bf16 v[56:59], a[216:219], a[144:147], v[56:59]
 v_mfma_f32_16x16x32_bf16 v[52:55], a[216:219], a[136:139], v[52:55]
 v_mfma_f32_16x16x32_bf16 v[52:55], a[220:223], a[140:143], v[52:55]
 v_mfma_f32_16x16x32_bf16 v[48:51], a[220:223], a[132:135], v[48:51]
 v_mfma_f32_16x16x32_bf16 v[48:51], a[216:219], a[128:131], v[48:51]
 s_waitcnt vmcnt(10)
 v_mfma_f32_16x16x32_bf16 v[80:83], a[224:227], a[128:131], v[80:83]
 v_mfma_f32_16x16x32_bf16 v[80:83], a[228:231], a[132:135], v[80:83]
 global_load_dwordx4 a[220:223], v0, s[70:71] offset:3072 sc1
 v_mfma_f32_16x16x32_bf16 v[84:87], a[228:231], a[140:143], v[84:87]
 v_mfma_f32_16x16x32_bf16 v[84:87], a[224:227], a[136:139], v[84:87]
 global_load_dwordx4 a[216:219], v0, s[70:71] offset:2048 sc1
 v_mfma_f32_16x16x32_bf16 v[88:91], a[224:227], a[144:147], v[88:91]
 s_add_u32 s70, s70, 8192
 s_addc_u32 s71, s71, 0
 v_mfma_f32_16x16x32_bf16 v[88:91], a[228:231], a[148:151], v[88:91]
 v_mfma_f32_16x16x32_bf16 v[92:95], a[228:231], a[156:159], v[92:95]
 v_mfma_f32_16x16x32_bf16 v[92:95], a[224:227], a[152:155], v[92:95]
 v_mfma_f32_16x16x32_bf16 v[96:99], a[224:227], a[160:163], v[96:99]
 v_mfma_f32_16x16x32_bf16 v[96:99], a[228:231], a[164:167], v[96:99]
 v_mfma_f32_16x16x32_bf16 v[100:103], a[228:231], a[172:175], v[100:103]
 v_mfma_f32_16x16x32_bf16 v[100:103], a[224:227], a[168:171], v[100:103]
 v_mfma_f32_16x16x32_bf16 v[104:107], a[224:227], a[176:179], v[104:107]
 v_mfma_f32_16x16x32_bf16 v[104:107], a[228:231], a[180:183], v[104:107]
 v_mfma_f32_16x16x32_bf16 v[108:111], a[228:231], a[188:191], v[108:111]
 v_mfma_f32_16x16x32_bf16 v[108:111], a[224:227], a[184:187], v[108:111]
 s_waitcnt vmcnt(10)
 v_mfma_f32_16x16x32_bf16 a[244:247], a[232:235], a[184:187], a[244:247]
 v_mfma_f32_16x16x32_bf16 a[244:247], a[236:239], a[188:191], a[244:247]
 global_load_dwordx4 a[228:231], v0, s[70:71] offset:-3072 sc1
 v_mfma_f32_16x16x32_bf16 a[240:243], a[236:239], a[180:183], a[240:243]
 v_mfma_f32_16x16x32_bf16 a[240:243], a[232:235], a[176:179], a[240:243]
 global_load_dwordx4 a[224:227], v0, s[70:71] offset:-4096 sc1
 v_mfma_f32_16x16x32_bf16 v[132:135], a[232:235], a[168:171], v[132:135]
 v_mfma_f32_16x16x32_bf16 v[132:135], a[236:239], a[172:175], v[132:135]
 v_mfma_f32_16x16x32_bf16 v[128:131], a[236:239], a[164:167], v[128:131]
 v_mfma_f32_16x16x32_bf16 v[128:131], a[232:235], a[160:163], v[128:131]
 v_mfma_f32_16x16x32_bf16 v[124:127], a[232:235], a[152:155], v[124:127]
 v_mfma_f32_16x16x32_bf16 v[124:127], a[236:239], a[156:159], v[124:127]
 v_mfma_f32_16x16x32_bf16 v[120:123], a[236:239], a[148:151], v[120:123]
 v_mfma_f32_16x16x32_bf16 v[120:123], a[232:235], a[144:147], v[120:123]
 buffer_load_dwordx4 v6, s[8:11], s30 offen lds
 v_mfma_f32_16x16x32_bf16 v[116:119], a[232:235], a[136:139], v[116:119]
 s_add_u32 m0, m0, 1024
 v_mfma_f32_16x16x32_bf16 v[116:119], a[236:239], a[140:143], v[116:119]
 v_mfma_f32_16x16x32_bf16 v[112:115], a[236:239], a[132:135], v[112:115]
 s_add_u32 s30, s30, s20
 v_mfma_f32_16x16x32_bf16 v[112:115], a[232:235], a[128:131], v[112:115]
 buffer_load_dwordx4 v6, s[8:11], s30 offen lds
 s_waitcnt vmcnt(12)
 v_mfma_f32_16x16x32_bf16 v[136:139], a[192:195], a[128:131], v[136:139]
 v_mfma_f32_16x16x32_bf16 v[136:139], a[196:199], a[132:135], v[136:139]
 global_load_dwordx4 a[236:239], v0, s[70:71] offset:-1024 sc1
 s_add_u32 m0, m0, 3072
 v_mfma_f32_16x16x32_bf16 v[140:143], a[196:199], a[140:143], v[140:143]
 s_add_u32 s30, s30, s21
 v_mfma_f32_16x16x32_bf16 v[140:143], a[192:195], a[136:139], v[140:143]
 global_load_dwordx4 a[232:235], v0, s[70:71] offset:-2048 sc1
 v_mfma_f32_16x16x32_bf16 v[144:147], a[192:195], a[144:147], v[144:147]
 v_mfma_f32_16x16x32_bf16 v[144:147], a[196:199], a[148:151], v[144:147]
 v_mfma_f32_16x16x32_bf16 v[148:151], a[196:199], a[156:159], v[148:151]
 v_mfma_f32_16x16x32_bf16 v[148:151], a[192:195], a[152:155], v[148:151]
 v_mfma_f32_16x16x32_bf16 v[152:155], a[192:195], a[160:163], v[152:155]
 v_mfma_f32_16x16x32_bf16 v[152:155], a[196:199], a[164:167], v[152:155]
 v_mfma_f32_16x16x32_bf16 v[156:159], a[196:199], a[172:175], v[156:159]
 v_mfma_f32_16x16x32_bf16 v[156:159], a[192:195], a[168:171], v[156:159]
 v_mfma_f32_16x16x32_bf16 v[160:163], a[192:195], a[176:179], v[160:163]
 v_mfma_f32_16x16x32_bf16 v[160:163], a[196:199], a[180:183], v[160:163]
 v_mfma_f32_16x16x32_bf16 v[164:167], a[196:199], a[188:191], v[164:167]
 v_mfma_f32_16x16x32_bf16 v[164:167], a[192:195], a[184:187], v[164:167]
 s_waitcnt vmcnt(12)
 v_mfma_f32_16x16x32_bf16 v[196:199], a[200:203], a[184:187], v[196:199]
 v_mfma_f32_16x16x32_bf16 v[196:199], a[204:207], a[188:191], v[196:199]
 global_load_dwordx4 a[196:199], v0, s[70:71] offset:1024 sc1
 v_mfma_f32_16x16x32_bf16 v[192:195], a[204:207], a[180:183], v[192:195]
 v_mfma_f32_16x16x32_bf16 v[192:195], a[200:203], a[176:179], v[192:195]
 global_load_dwordx4 a[192:195], v0, s[70:71] offset:0 sc1
 v_mfma_f32_16x16x32_bf16 v[188:191], a[200:203], a[168:171], v[188:191]
 v_mfma_f32_16x16x32_bf16 v[188:191], a[204:207], a[172:175], v[188:191]
 v_mfma_f32_16x16x32_bf16 v[184:187], a[204:207], a[164:167], v[184:187]
 v_mfma_f32_16x16x32_bf16 v[184:187], a[200:203], a[160:163], v[184:187]
 v_mfma_f32_16x16x32_bf16 v[180:183], a[200:203], a[152:155], v[180:183]
 v_mfma_f32_16x16x32_bf16 v[180:183], a[204:207], a[156:159], v[180:183]
 v_mfma_f32_16x16x32_bf16 v[176:179], a[204:207], a[148:151], v[176:179]
 v_mfma_f32_16x16x32_bf16 v[176:179], a[200:203], a[144:147], v[176:179]
 v_mfma_f32_16x16x32_bf16 v[172:175], a[200:203], a[136:139], v[172:175]
 v_mfma_f32_16x16x32_bf16 v[172:175], a[204:207], a[140:143], v[172:175]
 v_mfma_f32_16x16x32_bf16 v[168:171], a[204:207], a[132:135], v[168:171]
 v_mfma_f32_16x16x32_bf16 v[168:171], a[200:203], a[128:131], v[168:171]
 s_waitcnt vmcnt(10)
 v_mfma_f32_16x16x32_bf16 v[200:203], a[208:211], a[128:131], v[200:203]
 v_mfma_f32_16x16x32_bf16 v[200:203], a[212:215], a[132:135], v[200:203]
 global_load_dwordx4 a[204:207], v0, s[70:71] offset:3072 sc1
 v_mfma_f32_16x16x32_bf16 v[204:207], a[212:215], a[140:143], v[204:207]
 v_mfma_f32_16x16x32_bf16 v[204:207], a[208:211], a[136:139], v[204:207]
 global_load_dwordx4 a[200:203], v0, s[70:71] offset:2048 sc1
 v_mfma_f32_16x16x32_bf16 v[208:211], a[208:211], a[144:147], v[208:211]
 s_add_u32 s70, s70, 8192
 s_addc_u32 s71, s71, 0
 v_mfma_f32_16x16x32_bf16 v[208:211], a[212:215], a[148:151], v[208:211]
 v_mfma_f32_16x16x32_bf16 v[212:215], a[212:215], a[156:159], v[212:215]
 v_mfma_f32_16x16x32_bf16 v[212:215], a[208:211], a[152:155], v[212:215]
 v_mfma_f32_16x16x32_bf16 v[216:219], a[208:211], a[160:163], v[216:219]
 v_mfma_f32_16x16x32_bf16 v[216:219], a[212:215], a[164:167], v[216:219]
 v_mfma_f32_16x16x32_bf16 v[220:223], a[212:215], a[172:175], v[220:223]
 v_mfma_f32_16x16x32_bf16 v[220:223], a[208:211], a[168:171], v[220:223]
 v_mfma_f32_16x16x32_bf16 v[224:227], a[208:211], a[176:179], v[224:227]
 v_mfma_f32_16x16x32_bf16 v[224:227], a[212:215], a[180:183], v[224:227]
 v_mfma_f32_16x16x32_bf16 v[228:231], a[212:215], a[188:191], v[228:231]
 v_mfma_f32_16x16x32_bf16 v[228:231], a[208:211], a[184:187], v[228:231]
 buffer_load_dwordx4 v6, s[8:11], s30 offen lds
 s_waitcnt vmcnt(11)
 v_mfma_f32_16x16x32_bf16 a[252:255], a[216:219], a[184:187], a[252:255]
 ds_read_b128 a[184:187], v1 offset:63488
 v_mfma_f32_16x16x32_bf16 a[252:255], a[220:223], a[188:191], a[252:255]
 global_load_dwordx4 a[212:215], v0, s[70:71] offset:-3072 sc1
 ds_read_b128 a[188:191], v1 offset:64512
 v_mfma_f32_16x16x32_bf16 a[248:251], a[220:223], a[180:183], a[248:251]
 ds_read_b128 a[180:183], v1 offset:60416
 s_add_u32 m0, m0, 1024
 v_mfma_f32_16x16x32_bf16 a[248:251], a[216:219], a[176:179], a[248:251]
 global_load_dwordx4 a[208:211], v0, s[70:71] offset:-4096 sc1
 ds_read_b128 a[176:179], v1 offset:59392
 s_add_u32 s30, s30, s20
 v_mfma_f32_16x16x32_bf16 v[252:255], a[216:219], a[168:171], v[252:255]
 ds_read_b128 a[168:171], v1 offset:55296
 v_mfma_f32_16x16x32_bf16 v[252:255], a[220:223], a[172:175], v[252:255]
 ds_read_b128 a[172:175], v1 offset:56320
 buffer_load_dwordx4 v6, s[8:11], s30 offen lds
 v_mfma_f32_16x16x32_bf16 v[248:251], a[220:223], a[164:167], v[248:251]
 ds_read_b128 a[164:167], v1 offset:52224
 s_add_u32 m0, m0, 3072
 v_mfma_f32_16x16x32_bf16 v[248:251], a[216:219], a[160:163], v[248:251]
 ds_read_b128 a[160:163], v1 offset:51200
 v_mfma_f32_16x16x32_bf16 v[244:247], a[216:219], a[152:155], v[244:247]
 ds_read_b128 a[152:155], v1 offset:47104
 s_add_u32 s30, s30, s21
 v_mfma_f32_16x16x32_bf16 v[244:247], a[220:223], a[156:159], v[244:247]
 ds_read_b128 a[156:159], v1 offset:48128
 v_mfma_f32_16x16x32_bf16 v[240:243], a[220:223], a[148:151], v[240:243]
 ds_read_b128 a[148:151], v1 offset:44032
 v_mfma_f32_16x16x32_bf16 v[240:243], a[216:219], a[144:147], v[240:243]
 ds_read_b128 a[144:147], v1 offset:43008
 v_mfma_f32_16x16x32_bf16 v[236:239], a[216:219], a[136:139], v[236:239]
 ds_read_b128 a[136:139], v1 offset:38912
 v_mfma_f32_16x16x32_bf16 v[236:239], a[220:223], a[140:143], v[236:239]
 ds_read_b128 a[140:143], v1 offset:39936
 v_mfma_f32_16x16x32_bf16 v[232:235], a[220:223], a[132:135], v[232:235]
 ds_read_b128 a[132:135], v1 offset:35840
 v_mfma_f32_16x16x32_bf16 v[232:235], a[216:219], a[128:131], v[232:235]
 ds_read_b128 a[128:131], v1 offset:34816
 s_waitcnt vmcnt(12) lgkmcnt(8)
 v_mfma_f32_16x16x32_bf16 v[44:47], a[224:227], a[184:187], v[44:47]
 v_mfma_f32_16x16x32_bf16 v[44:47], a[228:231], a[188:191], v[44:47]
 global_load_dwordx4 a[220:223], v0, s[70:71] offset:-1024 sc1
 v_mfma_f32_16x16x32_bf16 v[40:43], a[228:231], a[180:183], v[40:43]
 v_mfma_f32_16x16x32_bf16 v[40:43], a[224:227], a[176:179], v[40:43]
 global_load_dwordx4 a[216:219], v0, s[70:71] offset:-2048 sc1
 v_mfma_f32_16x16x32_bf16 v[36:39], a[224:227], a[168:171], v[36:39]
 v_mfma_f32_16x16x32_bf16 v[36:39], a[228:231], a[172:175], v[36:39]
 v_mfma_f32_16x16x32_bf16 v[32:35], a[228:231], a[164:167], v[32:35]
 v_mfma_f32_16x16x32_bf16 v[32:35], a[224:227], a[160:163], v[32:35]
 s_waitcnt lgkmcnt(0)
 v_mfma_f32_16x16x32_bf16 v[28:31], a[224:227], a[152:155], v[28:31]
 v_mfma_f32_16x16x32_bf16 v[28:31], a[228:231], a[156:159], v[28:31]
 v_mfma_f32_16x16x32_bf16 v[24:27], a[228:231], a[148:151], v[24:27]
 v_mfma_f32_16x16x32_bf16 v[24:27], a[224:227], a[144:147], v[24:27]
 v_mfma_f32_16x16x32_bf16 v[20:23], a[224:227], a[136:139], v[20:23]
 v_mfma_f32_16x16x32_bf16 v[20:23], a[228:231], a[140:143], v[20:23]
 v_mfma_f32_16x16x32_bf16 v[16:19], a[228:231], a[132:135], v[16:19]
 v_mfma_f32_16x16x32_bf16 v[16:19], a[224:227], a[128:131], v[16:19]
 s_waitcnt vmcnt(10)
 v_mfma_f32_16x16x32_bf16 v[48:51], a[232:235], a[128:131], v[48:51]
 v_mfma_f32_16x16x32_bf16 v[48:51], a[236:239], a[132:135], v[48:51]
 global_load_dwordx4 a[228:231], v0, s[70:71] offset:1024 sc1
 v_mfma_f32_16x16x32_bf16 v[52:55], a[236:239], a[140:143], v[52:55]
 v_mfma_f32_16x16x32_bf16 v[52:55], a[232:235], a[136:139], v[52:55]
 global_load_dwordx4 a[224:227], v0, s[70:71] offset:0 sc1
 v_mfma_f32_16x16x32_bf16 v[56:59], a[232:235], a[144:147], v[56:59]
 v_mfma_f32_16x16x32_bf16 v[56:59], a[236:239], a[148:151], v[56:59]
 v_mfma_f32_16x16x32_bf16 v[60:63], a[236:239], a[156:159], v[60:63]
 v_mfma_f32_16x16x32_bf16 v[60:63], a[232:235], a[152:155], v[60:63]
 v_mfma_f32_16x16x32_bf16 v[64:67], a[232:235], a[160:163], v[64:67]
 v_mfma_f32_16x16x32_bf16 v[64:67], a[236:239], a[164:167], v[64:67]
 v_mfma_f32_16x16x32_bf16 v[68:71], a[236:239], a[172:175], v[68:71]
 v_mfma_f32_16x16x32_bf16 v[68:71], a[232:235], a[168:171], v[68:71]
 v_mfma_f32_16x16x32_bf16 v[72:75], a[232:235], a[176:179], v[72:75]
 v_mfma_f32_16x16x32_bf16 v[72:75], a[236:239], a[180:183], v[72:75]
 v_mfma_f32_16x16x32_bf16 v[76:79], a[236:239], a[188:191], v[76:79]
 v_mfma_f32_16x16x32_bf16 v[76:79], a[232:235], a[184:187], v[76:79]
 s_waitcnt vmcnt(10)
 v_mfma_f32_16x16x32_bf16 v[108:111], a[192:195], a[184:187], v[108:111]
 v_mfma_f32_16x16x32_bf16 v[108:111], a[196:199], a[188:191], v[108:111]
 global_load_dwordx4 a[236:239], v0, s[70:71] offset:3072 sc1
 v_mfma_f32_16x16x32_bf16 v[104:107], a[196:199], a[180:183], v[104:107]
 v_mfma_f32_16x16x32_bf16 v[104:107], a[192:195], a[176:179], v[104:107]
 global_load_dwordx4 a[232:235], v0, s[70:71] offset:2048 sc1
 v_mfma_f32_16x16x32_bf16 v[100:103], a[192:195], a[168:171], v[100:103]
 s_add_u32 s70, s70, 8192
 s_addc_u32 s71, s71, 0
 v_mfma_f32_16x16x32_bf16 v[100:103], a[196:199], a[172:175], v[100:103]
 v_mfma_f32_16x16x32_bf16 v[96:99], a[196:199], a[164:167], v[96:99]
 buffer_load_dwordx4 v6, s[8:11], s30 offen lds
 v_mfma_f32_16x16x32_bf16 v[96:99], a[192:195], a[160:163], v[96:99]
 v_mfma_f32_16x16x32_bf16 v[92:95], a[192:195], a[152:155], v[92:95]
 s_add_u32 m0, m0, 1024
 v_mfma_f32_16x16x32_bf16 v[92:95], a[196:199], a[156:159], v[92:95]
 s_add_u32 s30, s30, s20
 v_mfma_f32_16x16x32_bf16 v[88:91], a[196:199], a[148:151], v[88:91]
 v_mfma_f32_16x16x32_bf16 v[88:91], a[192:195], a[144:147], v[88:91]
 buffer_load_dwordx4 v6, s[8:11], s30 offen lds
 v_mfma_f32_16x16x32_bf16 v[84:87], a[192:195], a[136:139], v[84:87]
 s_add_u32 m0, m0, 3072
 v_mfma_f32_16x16x32_bf16 v[84:87], a[196:199], a[140:143], v[84:87]
 v_mfma_f32_16x16x32_bf16 v[80:83], a[196:199], a[132:135], v[80:83]
 s_add_u32 s30, s30, s21
 v_mfma_f32_16x16x32_bf16 v[80:83], a[192:195], a[128:131], v[80:83]
 s_waitcnt vmcnt(12)
 v_mfma_f32_16x16x32_bf16 v[112:115], a[200:203], a[128:131], v[112:115]
 v_mfma_f32_16x16x32_bf16 v[112:115], a[204:207], a[132:135], v[112:115]
 global_load_dwordx4 a[196:199], v0, s[70:71] offset:-3072 sc1
 v_mfma_f32_16x16x32_bf16 v[116:119], a[204:207], a[140:143], v[116:119]
 v_mfma_f32_16x16x32_bf16 v[116:119], a[200:203], a[136:139], v[116:119]
 global_load_dwordx4 a[192:195], v0, s[70:71] offset:-4096 sc1
 v_mfma_f32_16x16x32_bf16 v[120:123], a[200:203], a[144:147], v[120:123]
 v_mfma_f32_16x16x32_bf16 v[120:123], a[204:207], a[148:151], v[120:123]
 v_mfma_f32_16x16x32_bf16 v[124:127], a[204:207], a[156:159], v[124:127]
 v_mfma_f32_16x16x32_bf16 v[124:127], a[200:203], a[152:155], v[124:127]
 v_mfma_f32_16x16x32_bf16 v[128:131], a[200:203], a[160:163], v[128:131]
 v_mfma_f32_16x16x32_bf16 v[128:131], a[204:207], a[164:167], v[128:131]
 v_mfma_f32_16x16x32_bf16 v[132:135], a[204:207], a[172:175], v[132:135]
 v_mfma_f32_16x16x32_bf16 v[132:135], a[200:203], a[168:171], v[132:135]
 v_mfma_f32_16x16x32_bf16 a[240:243], a[200:203], a[176:179], a[240:243]
 v_mfma_f32_16x16x32_bf16 a[240:243], a[204:207], a[180:183], a[240:243]
 v_mfma_f32_16x16x32_bf16 a[244:247], a[204:207], a[188:191], a[244:247]
 v_mfma_f32_16x16x32_bf16 a[244:247], a[200:203], a[184:187], a[244:247]
 s_waitcnt vmcnt(11)
 v_mfma_f32_16x16x32_bf16 v[164:167], a[208:211], a[184:187], v[164:167]
 v_mfma_f32_16x16x32_bf16 v[164:167], a[212:215], a[188:191], v[164:167]
 global_load_dwordx4 a[204:207], v0, s[70:71] offset:-1024 sc1
 v_mfma_f32_16x16x32_bf16 v[160:163], a[212:215], a[180:183], v[160:163]
 v_mfma_f32_16x16x32_bf16 v[160:163], a[208:211], a[176:179], v[160:163]
 global_load_dwordx4 a[200:203], v0, s[70:71] offset:-2048 sc1
 v_mfma_f32_16x16x32_bf16 v[156:159], a[208:211], a[168:171], v[156:159]
 v_mfma_f32_16x16x32_bf16 v[156:159], a[212:215], a[172:175], v[156:159]
 v_mfma_f32_16x16x32_bf16 v[152:155], a[212:215], a[164:167], v[152:155]
 v_mfma_f32_16x16x32_bf16 v[152:155], a[208:211], a[160:163], v[152:155]
 v_mfma_f32_16x16x32_bf16 v[148:151], a[208:211], a[152:155], v[148:151]
 v_mfma_f32_16x16x32_bf16 v[148:151], a[212:215], a[156:159], v[148:151]
 v_mfma_f32_16x16x32_bf16 v[144:147], a[212:215], a[148:151], v[144:147]
 v_mfma_f32_16x16x32_bf16 v[144:147], a[208:211], a[144:147], v[144:147]
 v_mfma_f32_16x16x32_bf16 v[140:143], a[208:211], a[136:139], v[140:143]
 v_mfma_f32_16x16x32_bf16 v[140:143], a[212:215], a[140:143], v[140:143]
 v_mfma_f32_16x16x32_bf16 v[136:139], a[212:215], a[132:135], v[136:139]
 v_mfma_f32_16x16x32_bf16 v[136:139], a[208:211], a[128:131], v[136:139]
 s_waitcnt vmcnt(10)
 v_mfma_f32_16x16x32_bf16 v[168:171], a[216:219], a[128:131], v[168:171]
 v_mfma_f32_16x16x32_bf16 v[168:171], a[220:223], a[132:135], v[168:171]
 global_load_dwordx4 a[212:215], v0, s[70:71] offset:1024 sc1
 v_mfma_f32_16x16x32_bf16 v[172:175], a[220:223], a[140:143], v[172:175]
 v_mfma_f32_16x16x32_bf16 v[172:175], a[216:219], a[136:139], v[172:175]
 global_load_dwordx4 a[208:211], v0, s[70:71] offset:0 sc1
 v_mfma_f32_16x16x32_bf16 v[176:179], a[216:219], a[144:147], v[176:179]
 v_mfma_f32_16x16x32_bf16 v[176:179], a[220:223], a[148:151], v[176:179]
 v_mfma_f32_16x16x32_bf16 v[180:183], a[220:223], a[156:159], v[180:183]
 v_mfma_f32_16x16x32_bf16 v[180:183], a[216:219], a[152:155], v[180:183]
 v_mfma_f32_16x16x32_bf16 v[184:187], a[216:219], a[160:163], v[184:187]
 v_mfma_f32_16x16x32_bf16 v[184:187], a[220:223], a[164:167], v[184:187]
 v_mfma_f32_16x16x32_bf16 v[188:191], a[220:223], a[172:175], v[188:191]
 v_mfma_f32_16x16x32_bf16 v[188:191], a[216:219], a[168:171], v[188:191]
 v_mfma_f32_16x16x32_bf16 v[192:195], a[216:219], a[176:179], v[192:195]
 buffer_load_dwordx4 v6, s[8:11], s30 offen lds
 v_mfma_f32_16x16x32_bf16 v[192:195], a[220:223], a[180:183], v[192:195]
 s_add_u32 m0, m0, 1024
 v_mfma_f32_16x16x32_bf16 v[196:199], a[220:223], a[188:191], v[196:199]
 v_mfma_f32_16x16x32_bf16 v[196:199], a[216:219], a[184:187], v[196:199]
 s_add_u32 s30, s30, s20
 s_waitcnt vmcnt(11)
 v_mfma_f32_16x16x32_bf16 v[228:231], a[224:227], a[184:187], v[228:231]
 buffer_load_dwordx4 v6, s[8:11], s30 offen lds
 v_mfma_f32_16x16x32_bf16 v[228:231], a[228:231], a[188:191], v[228:231]
 global_load_dwordx4 a[220:223], v0, s[70:71] offset:3072 sc1
 v_mfma_f32_16x16x32_bf16 v[224:227], a[228:231], a[180:183], v[224:227]
 s_add_u32 m0, m0, 3072
 v_mfma_f32_16x16x32_bf16 v[224:227], a[224:227], a[176:179], v[224:227]
 global_load_dwordx4 a[216:219], v0, s[70:71] offset:2048 sc1
 s_add_u32 s30, s30, s21
 v_mfma_f32_16x16x32_bf16 v[220:223], a[224:227], a[168:171], v[220:223]
 s_add_u32 s70, s70, 8192
 s_addc_u32 s71, s71, 0
 v_mfma_f32_16x16x32_bf16 v[220:223], a[228:231], a[172:175], v[220:223]
 v_mfma_f32_16x16x32_bf16 v[216:219], a[228:231], a[164:167], v[216:219]
 v_mfma_f32_16x16x32_bf16 v[216:219], a[224:227], a[160:163], v[216:219]
 v_mfma_f32_16x16x32_bf16 v[212:215], a[224:227], a[152:155], v[212:215]
 v_mfma_f32_16x16x32_bf16 v[212:215], a[228:231], a[156:159], v[212:215]
 v_mfma_f32_16x16x32_bf16 v[208:211], a[228:231], a[148:151], v[208:211]
 v_mfma_f32_16x16x32_bf16 v[208:211], a[224:227], a[144:147], v[208:211]
 v_mfma_f32_16x16x32_bf16 v[204:207], a[224:227], a[136:139], v[204:207]
 v_mfma_f32_16x16x32_bf16 v[204:207], a[228:231], a[140:143], v[204:207]
 v_mfma_f32_16x16x32_bf16 v[200:203], a[228:231], a[132:135], v[200:203]
 v_mfma_f32_16x16x32_bf16 v[200:203], a[224:227], a[128:131], v[200:203]
 s_waitcnt vmcnt(12)
 v_mfma_f32_16x16x32_bf16 v[232:235], a[232:235], a[128:131], v[232:235]
 ds_read_b128 a[128:131], v2 offset:2048
 v_mfma_f32_16x16x32_bf16 v[232:235], a[236:239], a[132:135], v[232:235]
 global_load_dwordx4 a[228:231], v0, s[70:71] offset:-3072 sc1
 ds_read_b128 a[132:135], v2 offset:3072
 v_mfma_f32_16x16x32_bf16 v[236:239], a[236:239], a[140:143], v[236:239]
 ds_read_b128 a[140:143], v2 offset:7168
 v_mfma_f32_16x16x32_bf16 v[236:239], a[232:235], a[136:139], v[236:239]
 global_load_dwordx4 a[224:227], v0, s[70:71] offset:-4096 sc1
 ds_read_b128 a[136:139], v2 offset:6144
 v_mfma_f32_16x16x32_bf16 v[240:243], a[232:235], a[144:147], v[240:243]
 ds_read_b128 a[144:147], v2 offset:10240
 v_mfma_f32_16x16x32_bf16 v[240:243], a[236:239], a[148:151], v[240:243]
 ds_read_b128 a[148:151], v2 offset:11264
 v_mfma_f32_16x16x32_bf16 v[244:247], a[236:239], a[156:159], v[244:247]
 ds_read_b128 a[156:159], v2 offset:15360
 v_mfma_f32_16x16x32_bf16 v[244:247], a[232:235], a[152:155], v[244:247]
 ds_read_b128 a[152:155], v2 offset:14336
 v_mfma_f32_16x16x32_bf16 v[248:251], a[232:235], a[160:163], v[248:251]
 ds_read_b128 a[160:163], v2 offset:18432
 v_mfma_f32_16x16x32_bf16 v[248:251], a[236:239], a[164:167], v[248:251]
 ds_read_b128 a[164:167], v2 offset:19456
 v_mfma_f32_16x16x32_bf16 v[252:255], a[236:239], a[172:175], v[252:255]
 ds_read_b128 a[172:175], v2 offset:23552
 v_mfma_f32_16x16x32_bf16 v[252:255], a[232:235], a[168:171], v[252:255]
 ds_read_b128 a[168:171], v2 offset:22528
 v_mfma_f32_16x16x32_bf16 a[248:251], a[232:235], a[176:179], a[248:251]
 ds_read_b128 a[176:179], v2 offset:26624
 v_mfma_f32_16x16x32_bf16 a[248:251], a[236:239], a[180:183], a[248:251]
 ds_read_b128 a[180:183], v2 offset:27648
 v_mfma_f32_16x16x32_bf16 a[252:255], a[236:239], a[188:191], a[252:255]
 ds_read_b128 a[188:191], v2 offset:31744
 v_mfma_f32_16x16x32_bf16 a[252:255], a[232:235], a[184:187], a[252:255]
 ds_read_b128 a[184:187], v2 offset:30720
 s_waitcnt vmcnt(10) lgkmcnt(8)
 v_mfma_f32_16x16x32_bf16 v[16:19], a[192:195], a[128:131], v[16:19]
 v_mfma_f32_16x16x32_bf16 v[16:19], a[196:199], a[132:135], v[16:19]
 global_load_dwordx4 a[236:239], v0, s[70:71] offset:-1024 sc1
 v_mfma_f32_16x16x32_bf16 v[20:23], a[196:199], a[140:143], v[20:23]
 v_mfma_f32_16x16x32_bf16 v[20:23], a[192:195], a[136:139], v[20:23]
 global_load_dwordx4 a[232:235], v0, s[70:71] offset:-2048 sc1
 v_mfma_f32_16x16x32_bf16 v[24:27], a[192:195], a[144:147], v[24:27]
 v_mfma_f32_16x16x32_bf16 v[24:27], a[196:199], a[148:151], v[24:27]
 v_mfma_f32_16x16x32_bf16 v[28:31], a[196:199], a[156:159], v[28:31]
 v_mfma_f32_16x16x32_bf16 v[28:31], a[192:195], a[152:155], v[28:31]
 s_waitcnt lgkmcnt(0)
 v_mfma_f32_16x16x32_bf16 v[32:35], a[192:195], a[160:163], v[32:35]
 v_mfma_f32_16x16x32_bf16 v[32:35], a[196:199], a[164:167], v[32:35]
 v_mfma_f32_16x16x32_bf16 v[36:39], a[196:199], a[172:175], v[36:39]
 v_mfma_f32_16x16x32_bf16 v[36:39], a[192:195], a[168:171], v[36:39]
 v_mfma_f32_16x16x32_bf16 v[40:43], a[192:195], a[176:179], v[40:43]
 v_mfma_f32_16x16x32_bf16 v[40:43], a[196:199], a[180:183], v[40:43]
 v_mfma_f32_16x16x32_bf16 v[44:47], a[196:199], a[188:191], v[44:47]
 v_mfma_f32_16x16x32_bf16 v[44:47], a[192:195], a[184:187], v[44:47]
 s_waitcnt vmcnt(10)
 v_mfma_f32_16x16x32_bf16 v[76:79], a[200:203], a[184:187], v[76:79]
 v_mfma_f32_16x16x32_bf16 v[76:79], a[204:207], a[188:191], v[76:79]
 global_load_dwordx4 a[196:199], v0, s[70:71] offset:1024 sc1
 v_mfma_f32_16x16x32_bf16 v[72:75], a[204:207], a[180:183], v[72:75]
 buffer_load_dwordx4 v6, s[8:11], s30 offen lds
 v_mfma_f32_16x16x32_bf16 v[72:75], a[200:203], a[176:179], v[72:75]
 global_load_dwordx4 a[192:195], v0, s[70:71] offset:0 sc1
 s_add_u32 m0, m0, 1024
 v_mfma_f32_16x16x32_bf16 v[68:71], a[200:203], a[168:171], v[68:71]
 v_mfma_f32_16x16x32_bf16 v[68:71], a[204:207], a[172:175], v[68:71]
 s_add_u32 s30, s30, s20
 v_mfma_f32_16x16x32_bf16 v[64:67], a[204:207], a[164:167], v[64:67]
 buffer_load_dwordx4 v6, s[8:11], s30 offen lds
 v_mfma_f32_16x16x32_bf16 v[64:67], a[200:203], a[160:163], v[64:67]
 v_mfma_f32_16x16x32_bf16 v[60:63], a[200:203], a[152:155], v[60:63]
 s_add_u32 m0, m0, 3072
 v_mfma_f32_16x16x32_bf16 v[60:63], a[204:207], a[156:159], v[60:63]
 s_add_u32 s30, s30, s21
 v_mfma_f32_16x16x32_bf16 v[56:59], a[204:207], a[148:151], v[56:59]
 v_mfma_f32_16x16x32_bf16 v[56:59], a[200:203], a[144:147], v[56:59]
 v_mfma_f32_16x16x32_bf16 v[52:55], a[200:203], a[136:139], v[52:55]
 v_mfma_f32_16x16x32_bf16 v[52:55], a[204:207], a[140:143], v[52:55]
 v_mfma_f32_16x16x32_bf16 v[48:51], a[204:207], a[132:135], v[48:51]
 v_mfma_f32_16x16x32_bf16 v[48:51], a[200:203], a[128:131], v[48:51]
 s_waitcnt vmcnt(12)
 v_mfma_f32_16x16x32_bf16 v[80:83], a[208:211], a[128:131], v[80:83]
 v_mfma_f32_16x16x32_bf16 v[80:83], a[212:215], a[132:135], v[80:83]
 global_load_dwordx4 a[204:207], v0, s[70:71] offset:3072 sc1
 v_mfma_f32_16x16x32_bf16 v[84:87], a[212:215], a[140:143], v[84:87]
 v_mfma_f32_16x16x32_bf16 v[84:87], a[208:211], a[136:139], v[84:87]
 global_load_dwordx4 a[200:203], v0, s[70:71] offset:2048 sc1
 v_mfma_f32_16x16x32_bf16 v[88:91], a[208:211], a[144:147], v[88:91]
 s_add_u32 s70, s70, 8192
 s_addc_u32 s71, s71, 0
 v_mfma_f32_16x16x32_bf16 v[88:91], a[212:215], a[148:151], v[88:91]
 v_mfma_f32_16x16x32_bf16 v[92:95], a[212:215], a[156:159], v[92:95]
 v_mfma_f32_16x16x32_bf16 v[92:95], a[208:211], a[152:155], v[92:95]
 v_mfma_f32_16x16x32_bf16 v[96:99], a[208:211], a[160:163], v[96:99]
 v_mfma_f32_16x16x32_bf16 v[96:99], a[212:215], a[164:167], v[96:99]
 v_mfma_f32_16x16x32_bf16 v[100:103], a[212:215], a[172:175], v[100:103]
 v_mfma_f32_16x16x32_bf16 v[100:103], a[208:211], a[168:171], v[100:103]
 v_mfma_f32_16x16x32_bf16 v[104:107], a[208:211], a[176:179], v[104:107]
 v_mfma_f32_16x16x32_bf16 v[104:107], a[212:215], a[180:183], v[104:107]
 v_mfma_f32_16x16x32_bf16 v[108:111], a[212:215], a[188:191], v[108:111]
 v_mfma_f32_16x16x32_bf16 v[108:111], a[208:211], a[184:187], v[108:111]
 s_waitcnt vmcnt(10)
 v_mfma_f32_16x16x32_bf16 a[244:247], a[216:219], a[184:187], a[244:247]
 v_mfma_f32_16x16x32_bf16 a[244:247], a[220:223], a[188:191], a[244:247]
 global_load_dwordx4 a[212:215], v0, s[70:71] offset:-3072 sc1
 v_mfma_f32_16x16x32_bf16 a[240:243], a[220:223], a[180:183], a[240:243]
 v_mfma_f32_16x16x32_bf16 a[240:243], a[216:219], a[176:179], a[240:243]
 global_load_dwordx4 a[208:211], v0, s[70:71] offset:-4096 sc1
 v_mfma_f32_16x16x32_bf16 v[132:135], a[216:219], a[168:171], v[132:135]
 v_mfma_f32_16x16x32_bf16 v[132:135], a[220:223], a[172:175], v[132:135]
 v_mfma_f32_16x16x32_bf16 v[128:131], a[220:223], a[164:167], v[128:131]
 v_mfma_f32_16x16x32_bf16 v[128:131], a[216:219], a[160:163], v[128:131]
 v_mfma_f32_16x16x32_bf16 v[124:127], a[216:219], a[152:155], v[124:127]
 v_mfma_f32_16x16x32_bf16 v[124:127], a[220:223], a[156:159], v[124:127]
 v_mfma_f32_16x16x32_bf16 v[120:123], a[220:223], a[148:151], v[120:123]
 v_mfma_f32_16x16x32_bf16 v[120:123], a[216:219], a[144:147], v[120:123]
 v_mfma_f32_16x16x32_bf16 v[116:119], a[216:219], a[136:139], v[116:119]
 v_mfma_f32_16x16x32_bf16 v[116:119], a[220:223], a[140:143], v[116:119]
 v_mfma_f32_16x16x32_bf16 v[112:115], a[220:223], a[132:135], v[112:115]
 v_mfma_f32_16x16x32_bf16 v[112:115], a[216:219], a[128:131], v[112:115]
 s_waitcnt vmcnt(10)
 v_mfma_f32_16x16x32_bf16 v[136:139], a[224:227], a[128:131], v[136:139]
 v_mfma_f32_16x16x32_bf16 v[136:139], a[228:231], a[132:135], v[136:139]
 global_load_dwordx4 a[220:223], v0, s[70:71] offset:-1024 sc1
 v_mfma_f32_16x16x32_bf16 v[140:143], a[228:231], a[140:143], v[140:143]
 v_mfma_f32_16x16x32_bf16 v[140:143], a[224:227], a[136:139], v[140:143]
 global_load_dwordx4 a[216:219], v0, s[70:71] offset:-2048 sc1
 v_mfma_f32_16x16x32_bf16 v[144:147], a[224:227], a[144:147], v[144:147]
 v_mfma_f32_16x16x32_bf16 v[144:147], a[228:231], a[148:151], v[144:147]
 v_mfma_f32_16x16x32_bf16 v[148:151], a[228:231], a[156:159], v[148:151]
 v_mfma_f32_16x16x32_bf16 v[148:151], a[224:227], a[152:155], v[148:151]
 buffer_load_dwordx4 v6, s[8:11], s30 offen lds
 v_mfma_f32_16x16x32_bf16 v[152:155], a[224:227], a[160:163], v[152:155]
 v_mfma_f32_16x16x32_bf16 v[152:155], a[228:231], a[164:167], v[152:155]
 s_add_u32 m0, m0, 1024
 v_mfma_f32_16x16x32_bf16 v[156:159], a[228:231], a[172:175], v[156:159]
 s_add_u32 s30, s30, s20
 v_mfma_f32_16x16x32_bf16 v[156:159], a[224:227], a[168:171], v[156:159]
 v_mfma_f32_16x16x32_bf16 v[160:163], a[224:227], a[176:179], v[160:163]
 buffer_load_dwordx4 v6, s[8:11], s30 offen lds
 v_mfma_f32_16x16x32_bf16 v[160:163], a[228:231], a[180:183], v[160:163]
 s_add_u32 m0, m0, 3072
 v_mfma_f32_16x16x32_bf16 v[164:167], a[228:231], a[188:191], v[164:167]
 v_mfma_f32_16x16x32_bf16 v[164:167], a[224:227], a[184:187], v[164:167]
 s_add_u32 s30, s30, s21
 s_waitcnt vmcnt(12)
 v_mfma_f32_16x16x32_bf16 v[196:199], a[232:235], a[184:187], v[196:199]
 v_mfma_f32_16x16x32_bf16 v[196:199], a[236:239], a[188:191], v[196:199]
 global_load_dwordx4 a[228:231], v0, s[70:71] offset:1024 sc1
 v_mfma_f32_16x16x32_bf16 v[192:195], a[236:239], a[180:183], v[192:195]
 v_mfma_f32_16x16x32_bf16 v[192:195], a[232:235], a[176:179], v[192:195]
 global_load_dwordx4 a[224:227], v0, s[70:71] offset:0 sc1
 v_mfma_f32_16x16x32_bf16 v[188:191], a[232:235], a[168:171], v[188:191]
 v_mfma_f32_16x16x32_bf16 v[188:191], a[236:239], a[172:175], v[188:191]
 v_mfma_f32_16x16x32_bf16 v[184:187], a[236:239], a[164:167], v[184:187]
 v_mfma_f32_16x16x32_bf16 v[184:187], a[232:235], a[160:163], v[184:187]
 v_mfma_f32_16x16x32_bf16 v[180:183], a[232:235], a[152:155], v[180:183]
 v_mfma_f32_16x16x32_bf16 v[180:183], a[236:239], a[156:159], v[180:183]
 v_mfma_f32_16x16x32_bf16 v[176:179], a[236:239], a[148:151], v[176:179]
 v_mfma_f32_16x16x32_bf16 v[176:179], a[232:235], a[144:147], v[176:179]
 v_mfma_f32_16x16x32_bf16 v[172:175], a[232:235], a[136:139], v[172:175]
 v_mfma_f32_16x16x32_bf16 v[172:175], a[236:239], a[140:143], v[172:175]
 v_mfma_f32_16x16x32_bf16 v[168:171], a[236:239], a[132:135], v[168:171]
 v_mfma_f32_16x16x32_bf16 v[168:171], a[232:235], a[128:131], v[168:171]
 s_waitcnt vmcnt(11)
 v_mfma_f32_16x16x32_bf16 v[200:203], a[192:195], a[128:131], v[200:203]
 v_mfma_f32_16x16x32_bf16 v[200:203], a[196:199], a[132:135], v[200:203]
 global_load_dwordx4 a[236:239], v0, s[70:71] offset:3072 sc1
 v_mfma_f32_16x16x32_bf16 v[204:207], a[196:199], a[140:143], v[204:207]
 v_mfma_f32_16x16x32_bf16 v[204:207], a[192:195], a[136:139], v[204:207]
 global_load_dwordx4 a[232:235], v0, s[70:71] offset:2048 sc1
 v_mfma_f32_16x16x32_bf16 v[208:211], a[192:195], a[144:147], v[208:211]
 s_add_u32 s70, s70, 8192
 s_addc_u32 s71, s71, 0
 v_mfma_f32_16x16x32_bf16 v[208:211], a[196:199], a[148:151], v[208:211]
 v_mfma_f32_16x16x32_bf16 v[212:215], a[196:199], a[156:159], v[212:215]
 v_mfma_f32_16x16x32_bf16 v[212:215], a[192:195], a[152:155], v[212:215]
 v_mfma_f32_16x16x32_bf16 v[216:219], a[192:195], a[160:163], v[216:219]
 v_mfma_f32_16x16x32_bf16 v[216:219], a[196:199], a[164:167], v[216:219]
 v_mfma_f32_16x16x32_bf16 v[220:223], a[196:199], a[172:175], v[220:223]
 v_mfma_f32_16x16x32_bf16 v[220:223], a[192:195], a[168:171], v[220:223]
 v_mfma_f32_16x16x32_bf16 v[224:227], a[192:195], a[176:179], v[224:227]
 v_mfma_f32_16x16x32_bf16 v[224:227], a[196:199], a[180:183], v[224:227]
 v_mfma_f32_16x16x32_bf16 v[228:231], a[196:199], a[188:191], v[228:231]
 v_mfma_f32_16x16x32_bf16 v[228:231], a[192:195], a[184:187], v[228:231]
 s_waitcnt vmcnt(10)
 v_mfma_f32_16x16x32_bf16 a[252:255], a[200:203], a[184:187], a[252:255]
 ds_read_b128 a[184:187], v2 offset:63488
 v_mfma_f32_16x16x32_bf16 a[252:255], a[204:207], a[188:191], a[252:255]
 global_load_dwordx4 a[196:199], v0, s[70:71] offset:-3072 sc1
 ds_read_b128 a[188:191], v2 offset:64512
 v_mfma_f32_16x16x32_bf16 a[248:251], a[204:207], a[180:183], a[248:251]
 ds_read_b128 a[180:183], v2 offset:60416
 v_mfma_f32_16x16x32_bf16 a[248:251], a[200:203], a[176:179], a[248:251]
 global_load_dwordx4 a[192:195], v0, s[70:71] offset:-4096 sc1
 ds_read_b128 a[176:179], v2 offset:59392
 v_mfma_f32_16x16x32_bf16 v[252:255], a[200:203], a[168:171], v[252:255]
 ds_read_b128 a[168:171], v2 offset:55296
 v_mfma_f32_16x16x32_bf16 v[252:255], a[204:207], a[172:175], v[252:255]
 ds_read_b128 a[172:175], v2 offset:56320
 v_mfma_f32_16x16x32_bf16 v[248:251], a[204:207], a[164:167], v[248:251]
 ds_read_b128 a[164:167], v2 offset:52224
 v_mfma_f32_16x16x32_bf16 v[248:251], a[200:203], a[160:163], v[248:251]
 ds_read_b128 a[160:163], v2 offset:51200
 v_mfma_f32_16x16x32_bf16 v[244:247], a[200:203], a[152:155], v[244:247]
 ds_read_b128 a[152:155], v2 offset:47104
 v_mfma_f32_16x16x32_bf16 v[244:247], a[204:207], a[156:159], v[244:247]
 ds_read_b128 a[156:159], v2 offset:48128
 v_mfma_f32_16x16x32_bf16 v[240:243], a[204:207], a[148:151], v[240:243]
 ds_read_b128 a[148:151], v2 offset:44032
 v_mfma_f32_16x16x32_bf16 v[240:243], a[200:203], a[144:147], v[240:243]
 ds_read_b128 a[144:147], v2 offset:43008
 v_mfma_f32_16x16x32_bf16 v[236:239], a[200:203], a[136:139], v[236:239]
 ds_read_b128 a[136:139], v2 offset:38912
 v_mfma_f32_16x16x32_bf16 v[236:239], a[204:207], a[140:143], v[236:239]
 ds_read_b128 a[140:143], v2 offset:39936
 v_mfma_f32_16x16x32_bf16 v[232:235], a[204:207], a[132:135], v[232:235]
 ds_read_b128 a[132:135], v2 offset:35840
 v_mfma_f32_16x16x32_bf16 v[232:235], a[200:203], a[128:131], v[232:235]
 ds_read_b128 a[128:131], v2 offset:34816
 s_waitcnt vmcnt(10) lgkmcnt(8)
 v_mfma_f32_16x16x32_bf16 v[44:47], a[208:211], a[184:187], v[44:47]
 buffer_load_dwordx4 v6, s[8:11], s30 offen lds
 s_add_u32 m0, m0, 1024
 v_mfma_f32_16x16x32_bf16 v[44:47], a[212:215], a[188:191], v[44:47]
 global_load_dwordx4 a[204:207], v0, s[70:71] offset:-1024 sc1
 s_add_u32 s30, s30, s20
 v_mfma_f32_16x16x32_bf16 v[40:43], a[212:215], a[180:183], v[40:43]
 buffer_load_dword v4, off, s[64:67], 0 sc1
 v_mfma_f32_16x16x32_bf16 v[40:43], a[208:211], a[176:179], v[40:43]
 global_load_dwordx4 a[200:203], v0, s[70:71] offset:-2048 sc1
 v_mfma_f32_16x16x32_bf16 v[36:39], a[208:211], a[168:171], v[36:39]
 buffer_load_dwordx4 v6, s[8:11], s30 offen lds
 s_add_u32 m0, m0, 3072
 v_mfma_f32_16x16x32_bf16 v[36:39], a[212:215], a[172:175], v[36:39]
 s_add_u32 s30, s30, s22
 v_mfma_f32_16x16x32_bf16 v[32:35], a[212:215], a[164:167], v[32:35]
 v_mfma_f32_16x16x32_bf16 v[32:35], a[208:211], a[160:163], v[32:35]
 s_waitcnt lgkmcnt(0)
 v_mfma_f32_16x16x32_bf16 v[28:31], a[208:211], a[152:155], v[28:31]
 v_mfma_f32_16x16x32_bf16 v[28:31], a[212:215], a[156:159], v[28:31]
 v_mfma_f32_16x16x32_bf16 v[24:27], a[212:215], a[148:151], v[24:27]
 v_mfma_f32_16x16x32_bf16 v[24:27], a[208:211], a[144:147], v[24:27]
 v_mfma_f32_16x16x32_bf16 v[20:23], a[208:211], a[136:139], v[20:23]
 v_mfma_f32_16x16x32_bf16 v[20:23], a[212:215], a[140:143], v[20:23]
 v_mfma_f32_16x16x32_bf16 v[16:19], a[212:215], a[132:135], v[16:19]
 v_mfma_f32_16x16x32_bf16 v[16:19], a[208:211], a[128:131], v[16:19]
 s_waitcnt vmcnt(13)
 v_mfma_f32_16x16x32_bf16 v[48:51], a[216:219], a[128:131], v[48:51]
 v_lshrrev_b32 v5, 6, v1
 v_mfma_f32_16x16x32_bf16 v[48:51], a[220:223], a[132:135], v[48:51]
 global_load_dwordx4 a[212:215], v0, s[70:71] offset:1024 sc1
 v_mfma_f32_16x16x32_bf16 v[52:55], a[220:223], a[140:143], v[52:55]
 v_and_b32 v6, 48, v1
 v_mfma_f32_16x16x32_bf16 v[52:55], a[216:219], a[136:139], v[52:55]
 global_load_dwordx4 a[208:211], v0, s[70:71] offset:0 sc1
 v_lshl_add_u32 v5, v5, 11, v6
 v_mfma_f32_16x16x32_bf16 v[56:59], a[216:219], a[144:147], v[56:59]
 v_mfma_f32_16x16x32_bf16 v[56:59], a[220:223], a[148:151], v[56:59]
 s_mov_b32 m0, s52
 v_mfma_f32_16x16x32_bf16 v[60:63], a[220:223], a[156:159], v[60:63]
 s_add_u32 s3, s48, 31744
 v_mfma_f32_16x16x32_bf16 v[60:63], a[216:219], a[152:155], v[60:63]
 v_mfma_f32_16x16x32_bf16 v[64:67], a[216:219], a[160:163], v[64:67]
 buffer_load_dwordx4 v5, s[40:43], s48 offen lds
 v_mfma_f32_16x16x32_bf16 v[64:67], a[220:223], a[164:167], v[64:67]
 buffer_load_dwordx4 v5, s[40:43], s3 offen offset:1024 lds
 v_mfma_f32_16x16x32_bf16 v[68:71], a[220:223], a[172:175], v[68:71]
 v_mfma_f32_16x16x32_bf16 v[68:71], a[216:219], a[168:171], v[68:71]
 s_add_u32 s48, s48, 2097152
 v_mfma_f32_16x16x32_bf16 v[72:75], a[216:219], a[176:179], v[72:75]
 v_mfma_f32_16x16x32_bf16 v[72:75], a[220:223], a[180:183], v[72:75]
 v_mfma_f32_16x16x32_bf16 v[76:79], a[220:223], a[188:191], v[76:79]
 v_mfma_f32_16x16x32_bf16 v[76:79], a[216:219], a[184:187], v[76:79]
 s_waitcnt vmcnt(13)
 v_mfma_f32_16x16x32_bf16 v[108:111], a[224:227], a[184:187], v[108:111]
 v_mfma_f32_16x16x32_bf16 v[108:111], a[228:231], a[188:191], v[108:111]
 global_load_dwordx4 a[220:223], v0, s[70:71] offset:3072 sc1
 v_mfma_f32_16x16x32_bf16 v[104:107], a[228:231], a[180:183], v[104:107]
 v_mfma_f32_16x16x32_bf16 v[104:107], a[224:227], a[176:179], v[104:107]
 global_load_dwordx4 a[216:219], v0, s[70:71] offset:2048 sc1
 v_mfma_f32_16x16x32_bf16 v[100:103], a[224:227], a[168:171], v[100:103]
 s_add_u32 s70, s70, 8192
 s_addc_u32 s71, s71, 0
 v_mfma_f32_16x16x32_bf16 v[100:103], a[228:231], a[172:175], v[100:103]
 v_mfma_f32_16x16x32_bf16 v[96:99], a[228:231], a[164:167], v[96:99]
 v_mfma_f32_16x16x32_bf16 v[96:99], a[224:227], a[160:163], v[96:99]
 v_mfma_f32_16x16x32_bf16 v[92:95], a[224:227], a[152:155], v[92:95]
 v_mfma_f32_16x16x32_bf16 v[92:95], a[228:231], a[156:159], v[92:95]
 v_mfma_f32_16x16x32_bf16 v[88:91], a[228:231], a[148:151], v[88:91]
 v_mfma_f32_16x16x32_bf16 v[88:91], a[224:227], a[144:147], v[88:91]
 v_mfma_f32_16x16x32_bf16 v[84:87], a[224:227], a[136:139], v[84:87]
 v_mfma_f32_16x16x32_bf16 v[84:87], a[228:231], a[140:143], v[84:87]
 v_mfma_f32_16x16x32_bf16 v[80:83], a[228:231], a[132:135], v[80:83]
 v_mfma_f32_16x16x32_bf16 v[80:83], a[224:227], a[128:131], v[80:83]
 s_waitcnt vmcnt(13)
 v_mfma_f32_16x16x32_bf16 v[112:115], a[232:235], a[128:131], v[112:115]
 v_mfma_f32_16x16x32_bf16 v[112:115], a[236:239], a[132:135], v[112:115]
 global_load_dwordx4 a[228:231], v0, s[70:71] offset:-3072 sc1
 v_mfma_f32_16x16x32_bf16 v[116:119], a[236:239], a[140:143], v[116:119]
 v_mfma_f32_16x16x32_bf16 v[116:119], a[232:235], a[136:139], v[116:119]
 global_load_dwordx4 a[224:227], v0, s[70:71] offset:-4096 sc1
 v_mfma_f32_16x16x32_bf16 v[120:123], a[232:235], a[144:147], v[120:123]
 v_mfma_f32_16x16x32_bf16 v[120:123], a[236:239], a[148:151], v[120:123]
 v_mfma_f32_16x16x32_bf16 v[124:127], a[236:239], a[156:159], v[124:127]
 v_mfma_f32_16x16x32_bf16 v[124:127], a[232:235], a[152:155], v[124:127]
 v_mfma_f32_16x16x32_bf16 v[128:131], a[232:235], a[160:163], v[128:131]
 v_mfma_f32_16x16x32_bf16 v[128:131], a[236:239], a[164:167], v[128:131]
 v_mfma_f32_16x16x32_bf16 v[132:135], a[236:239], a[172:175], v[132:135]
 v_mfma_f32_16x16x32_bf16 v[132:135], a[232:235], a[168:171], v[132:135]
 v_mfma_f32_16x16x32_bf16 a[240:243], a[232:235], a[176:179], a[240:243]
 v_mfma_f32_16x16x32_bf16 a[240:243], a[236:239], a[180:183], a[240:243]
 v_mfma_f32_16x16x32_bf16 a[244:247], a[236:239], a[188:191], a[244:247]
 v_mfma_f32_16x16x32_bf16 a[244:247], a[232:235], a[184:187], a[244:247]
 s_waitcnt vmcnt(13)
 v_mfma_f32_16x16x32_bf16 v[164:167], a[192:195], a[184:187], v[164:167]
 v_mfma_f32_16x16x32_bf16 v[164:167], a[196:199], a[188:191], v[164:167]
 global_load_dwordx4 a[236:239], v0, s[70:71] offset:-1024 sc1
 v_mfma_f32_16x16x32_bf16 v[160:163], a[196:199], a[180:183], v[160:163]
 v_mfma_f32_16x16x32_bf16 v[160:163], a[192:195], a[176:179], v[160:163]
 global_load_dwordx4 a[232:235], v0, s[70:71] offset:-2048 sc1
 v_mfma_f32_16x16x32_bf16 v[156:159], a[192:195], a[168:171], v[156:159]
 v_mfma_f32_16x16x32_bf16 v[156:159], a[196:199], a[172:175], v[156:159]
 v_mfma_f32_16x16x32_bf16 v[152:155], a[196:199], a[164:167], v[152:155]
 v_mfma_f32_16x16x32_bf16 v[152:155], a[192:195], a[160:163], v[152:155]
 v_mfma_f32_16x16x32_bf16 v[148:151], a[192:195], a[152:155], v[148:151]
 v_mfma_f32_16x16x32_bf16 v[148:151], a[196:199], a[156:159], v[148:151]
 v_mfma_f32_16x16x32_bf16 v[144:147], a[196:199], a[148:151], v[144:147]
 v_mfma_f32_16x16x32_bf16 v[144:147], a[192:195], a[144:147], v[144:147]
 v_mfma_f32_16x16x32_bf16 v[140:143], a[192:195], a[136:139], v[140:143]
 v_mfma_f32_16x16x32_bf16 v[140:143], a[196:199], a[140:143], v[140:143]
 v_mfma_f32_16x16x32_bf16 v[136:139], a[196:199], a[132:135], v[136:139]
 v_mfma_f32_16x16x32_bf16 v[136:139], a[192:195], a[128:131], v[136:139]
 s_waitcnt vmcnt(11)
 v_mfma_f32_16x16x32_bf16 v[168:171], a[200:203], a[128:131], v[168:171]
 v_mfma_f32_16x16x32_bf16 v[168:171], a[204:207], a[132:135], v[168:171]
 global_load_dwordx4 a[196:199], v0, s[70:71] offset:1024 sc1
 v_mfma_f32_16x16x32_bf16 v[172:175], a[204:207], a[140:143], v[172:175]
 v_mfma_f32_16x16x32_bf16 v[172:175], a[200:203], a[136:139], v[172:175]
 global_load_dwordx4 a[192:195], v0, s[70:71] offset:0 sc1
 v_mfma_f32_16x16x32_bf16 v[176:179], a[200:203], a[144:147], v[176:179]
 v_mfma_f32_16x16x32_bf16 v[176:179], a[204:207], a[148:151], v[176:179]
 v_mfma_f32_16x16x32_bf16 v[180:183], a[204:207], a[156:159], v[180:183]
 v_mfma_f32_16x16x32_bf16 v[180:183], a[200:203], a[152:155], v[180:183]
 v_mfma_f32_16x16x32_bf16 v[184:187], a[200:203], a[160:163], v[184:187]
 v_mfma_f32_16x16x32_bf16 v[184:187], a[204:207], a[164:167], v[184:187]
 v_mfma_f32_16x16x32_bf16 v[188:191], a[204:207], a[172:175], v[188:191]
 v_mfma_f32_16x16x32_bf16 v[188:191], a[200:203], a[168:171], v[188:191]
 v_mfma_f32_16x16x32_bf16 v[192:195], a[200:203], a[176:179], v[192:195]
 v_mfma_f32_16x16x32_bf16 v[192:195], a[204:207], a[180:183], v[192:195]
 v_mfma_f32_16x16x32_bf16 v[196:199], a[204:207], a[188:191], v[196:199]
 v_mfma_f32_16x16x32_bf16 v[196:199], a[200:203], a[184:187], v[196:199]
 s_waitcnt vmcnt(10)
 v_mfma_f32_16x16x32_bf16 v[228:231], a[208:211], a[184:187], v[228:231]
 v_mfma_f32_16x16x32_bf16 v[228:231], a[212:215], a[188:191], v[228:231]
 global_load_dwordx4 a[204:207], v0, s[70:71] offset:3072 sc1
 v_mfma_f32_16x16x32_bf16 v[224:227], a[212:215], a[180:183], v[224:227]
 v_mfma_f32_16x16x32_bf16 v[224:227], a[208:211], a[176:179], v[224:227]
 global_load_dwordx4 a[200:203], v0, s[70:71] offset:2048 sc1
 v_mfma_f32_16x16x32_bf16 v[220:223], a[208:211], a[168:171], v[220:223]
 s_add_u32 s70, s70, 8192
 s_addc_u32 s71, s71, 0
 v_mfma_f32_16x16x32_bf16 v[220:223], a[212:215], a[172:175], v[220:223]
 v_mfma_f32_16x16x32_bf16 v[216:219], a[212:215], a[164:167], v[216:219]
 v_mfma_f32_16x16x32_bf16 v[216:219], a[208:211], a[160:163], v[216:219]
 v_mfma_f32_16x16x32_bf16 v[212:215], a[208:211], a[152:155], v[212:215]
 v_mfma_f32_16x16x32_bf16 v[212:215], a[212:215], a[156:159], v[212:215]
 v_mfma_f32_16x16x32_bf16 v[208:211], a[212:215], a[148:151], v[208:211]
 v_cmp_gt_i32 vcc, s55, v4
 s_cbranch_vccnz Lspin_pb
Lok_pb:
 s_add_u32 s55, s55, 1
 s_waitcnt lgkmcnt(0)
 s_barrier
 v_mfma_f32_16x16x32_bf16 v[208:211], a[208:211], a[144:147], v[208:211]
 v_mfma_f32_16x16x32_bf16 v[204:207], a[208:211], a[136:139], v[204:207]
 v_mfma_f32_16x16x32_bf16 v[204:207], a[212:215], a[140:143], v[204:207]
 v_mfma_f32_16x16x32_bf16 v[200:203], a[212:215], a[132:135], v[200:203]
 v_mfma_f32_16x16x32_bf16 v[200:203], a[208:211], a[128:131], v[200:203]
 s_waitcnt vmcnt(8)
 v_mfma_f32_16x16x32_bf16 v[232:235], a[216:219], a[128:131], v[232:235]
 ds_read_b128 a[128:131], v1
 v_mfma_f32_16x16x32_bf16 v[232:235], a[220:223], a[132:135], v[232:235]
 global_load_dwordx4 a[212:215], v0, s[70:71] offset:-3072 sc1
 ds_read_b128 a[132:135], v1 offset:1024
 v_mfma_f32_16x16x32_bf16 v[236:239], a[220:223], a[140:143], v[236:239]
 ds_read_b128 a[140:143], v1 offset:5120
 v_mfma_f32_16x16x32_bf16 v[236:239], a[216:219], a[136:139], v[236:239]
 global_load_dwordx4 a[208:211], v0, s[70:71] offset:-4096 sc1
 ds_read_b128 a[136:139], v1 offset:4096
 v_mfma_f32_16x16x32_bf16 v[240:243], a[216:219], a[144:147], v[240:243]
 ds_read_b128 a[144:147], v1 offset:8192
 v_mfma_f32_16x16x32_bf16 v[240:243], a[220:223], a[148:151], v[240:243]
 ds_read_b128 a[148:151], v1 offset:9216
 v_mfma_f32_16x16x32_bf16 v[244:247], a[220:223], a[156:159], v[244:247]
 ds_read_b128 a[156:159], v1 offset:13312
 v_mfma_f32_16x16x32_bf16 v[244:247], a[216:219], a[152:155], v[244:247]
 ds_read_b128 a[152:155], v1 offset:12288
 v_mfma_f32_16x16x32_bf16 v[248:251], a[216:219], a[160:163], v[248:251]
 ds_read_b128 a[160:163], v1 offset:16384
 v_mfma_f32_16x16x32_bf16 v[248:251], a[220:223], a[164:167], v[248:251]
 ds_read_b128 a[164:167], v1 offset:17408
 v_mfma_f32_16x16x32_bf16 v[252:255], a[220:223], a[172:175], v[252:255]
 ds_read_b128 a[172:175], v1 offset:21504
 v_mfma_f32_16x16x32_bf16 v[252:255], a[216:219], a[168:171], v[252:255]
 ds_read_b128 a[168:171], v1 offset:20480
 v_mfma_f32_16x16x32_bf16 a[248:251], a[216:219], a[176:179], a[248:251]
 ds_read_b128 a[176:179], v1 offset:24576
 v_mfma_f32_16x16x32_bf16 a[248:251], a[220:223], a[180:183], a[248:251]
 ds_read_b128 a[180:183], v1 offset:25600
 v_mfma_f32_16x16x32_bf16 a[252:255], a[220:223], a[188:191], a[252:255]
 global_load_dwordx4 a[220:223], v0, s[70:71] offset:-1024 sc1
 ds_read_b128 a[188:191], v1 offset:29696
 v_mfma_f32_16x16x32_bf16 a[252:255], a[216:219], a[184:187], a[252:255]
 global_load_dwordx4 a[216:219], v0, s[70:71] offset:-2048 sc1
 ds_read_b128 a[184:187], v1 offset:28672
 s_waitcnt vmcnt(10) lgkmcnt(8)
 v_mfma_f32_16x16x32_bf16 v[16:19], a[224:227], a[128:131], v[16:19]
 v_mov_b32 v6, v3
 s_cmp_eq_u32 s25, 0
 s_cbranch_scc1 Lgat1
Lgatr1:
 v_mfma_f32_16x16x32_bf16 v[16:19], a[228:231], a[132:135], v[16:19]
 v_mfma_f32_16x16x32_bf16 v[20:23], a[228:231], a[140:143], v[20:23]
 s_add_u32 m0, s50, 2048
 v_mfma_f32_16x16x32_bf16 v[20:23], a[224:227], a[136:139], v[20:23]
 v_mfma_f32_16x16x32_bf16 v[24:27], a[224:227], a[144:147], v[24:27]
 v_mfma_f32_16x16x32_bf16 v[24:27], a[228:231], a[148:151], v[24:27]
 buffer_load_dwordx4 v6, s[8:11], s30 offen lds
 v_mfma_f32_16x16x32_bf16 v[28:31], a[228:231], a[156:159], v[28:31]
 s_add_u32 m0, m0, 1024
 v_mfma_f32_16x16x32_bf16 v[28:31], a[224:227], a[152:155], v[28:31]
 s_waitcnt lgkmcnt(0)
 v_mfma_f32_16x16x32_bf16 v[32:35], a[224:227], a[160:163], v[32:35]
 s_add_u32 s30, s30, s20
 v_mfma_f32_16x16x32_bf16 v[32:35], a[228:231], a[164:167], v[32:35]
 buffer_load_dwordx4 v6, s[8:11], s30 offen lds
 v_mfma_f32_16x16x32_bf16 v[36:39], a[228:231], a[172:175], v[36:39]
 v_mfma_f32_16x16x32_bf16 v[36:39], a[224:227], a[168:171], v[36:39]
 s_add_u32 m0, m0, 3072
 v_mfma_f32_16x16x32_bf16 v[40:43], a[224:227], a[176:179], v[40:43]
 v_mfma_f32_16x16x32_bf16 v[40:43], a[228:231], a[180:183], v[40:43]
 s_add_u32 s30, s30, s21
 v_mfma_f32_16x16x32_bf16 v[44:47], a[228:231], a[188:191], v[44:47]
 v_mfma_f32_16x16x32_bf16 v[44:47], a[224:227], a[184:187], v[44:47]
 s_waitcnt vmcnt(10)
 v_mfma_f32_16x16x32_bf16 v[76:79], a[232:235], a[184:187], v[76:79]
 v_mfma_f32_16x16x32_bf16 v[76:79], a[236:239], a[188:191], v[76:79]
 global_load_dwordx4 a[228:231], v0, s[70:71] offset:1024 sc1
 v_mfma_f32_16x16x32_bf16 v[72:75], a[236:239], a[180:183], v[72:75]
 v_mfma_f32_16x16x32_bf16 v[72:75], a[232:235], a[176:179], v[72:75]
 global_load_dwordx4 a[224:227], v0, s[70:71] offset:0 sc1
 v_mfma_f32_16x16x32_bf16 v[68:71], a[232:235], a[168:171], v[68:71]
 v_mfma_f32_16x16x32_bf16 v[68:71], a[236:239], a[172:175], v[68:71]
 v_mfma_f32_16x16x32_bf16 v[64:67], a[236:239], a[164:167], v[64:67]
 v_mfma_f32_16x16x32_bf16 v[64:67], a[232:235], a[160:163], v[64:67]
 v_mfma_f32_16x16x32_bf16 v[60:63], a[232:235], a[152:155], v[60:63]
 v_mfma_f32_16x16x32_bf16 v[60:63], a[236:239], a[156:159], v[60:63]
 v_mfma_f32_16x16x32_bf16 v[56:59], a[236:239], a[148:151], v[56:59]
 v_mfma_f32_16x16x32_bf16 v[56:59], a[232:235], a[144:147], v[56:59]
 v_mfma_f32_16x16x32_bf16 v[52:55], a[232:235], a[136:139], v[52:55]
 v_mfma_f32_16x16x32_bf16 v[52:55], a[236:239], a[140:143], v[52:55]
 v_mfma_f32_16x16x32_bf16 v[48:51], a[236:239], a[132:135], v[48:51]
 v_mfma_f32_16x16x32_bf16 v[48:51], a[232:235], a[128:131], v[48:51]
 s_waitcnt vmcnt(10)
 v_mfma_f32_16x16x32_bf16 v[80:83], a[192:195], a[128:131], v[80:83]
 v_mfma_f32_16x16x32_bf16 v[80:83], a[196:199], a[132:135], v[80:83]
 global_load_dwordx4 a[236:239], v0, s[70:71] offset:3072 sc1
 v_mfma_f32_16x16x32_bf16 v[84:87], a[196:199], a[140:143], v[84:87]
 v_mfma_f32_16x16x32_bf16 v[84:87], a[192:195], a[136:139], v[84:87]
 global_load_dwordx4 a[232:235], v0, s[70:71] offset:2048 sc1
 v_mfma_f32_16x16x32_bf16 v[88:91], a[192:195], a[144:147], v[88:91]
 s_add_u32 s70, s70, 8192
 s_addc_u32 s71, s71, 0
 v_mfma_f32_16x16x32_bf16 v[88:91], a[196:199], a[148:151], v[88:91]
 v_mfma_f32_16x16x32_bf16 v[92:95], a[196:199], a[156:159], v[92:95]
 v_mfma_f32_16x16x32_bf16 v[92:95], a[192:195], a[152:155], v[92:95]
 v_mfma_f32_16x16x32_bf16 v[96:99], a[192:195], a[160:163], v[96:99]
 v_mfma_f32_16x16x32_bf16 v[96:99], a[196:199], a[164:167], v[96:99]
 v_mfma_f32_16x16x32_bf16 v[100:103], a[196:199], a[172:175], v[100:103]
 v_mfma_f32_16x16x32_bf16 v[100:103], a[192:195], a[168:171], v[100:103]
 v_mfma_f32_16x16x32_bf16 v[104:107], a[192:195], a[176:179], v[104:107]
 v_mfma_f32_16x16x32_bf16 v[104:107], a[196:199], a[180:183], v[104:107]
 v_mfma_f32_16x16x32_bf16 v[108:111], a[196:199], a[188:191], v[108:111]
 v_mfma_f32_16x16x32_bf16 v[108:111], a[192:195], a[184:187], v[108:111]
 s_waitcnt vmcnt(10)
 v_mfma_f32_16x16x32_bf16 a[244:247], a[200:203], a[184:187], a[244:247]
 v_mfma_f32_16x16x32_bf16 a[244:247], a[204:207], a[188:191], a[244:247]
 global_load_dwordx4 a[196:199], v0, s[70:71] offset:-3072 sc1
 v_mfma_f32_16x16x32_bf16 a[240:243], a[204:207], a[180:183], a[240:243]
 v_mfma_f32_16x16x32_bf16 a[240:243], a[200:203], a[176:179], a[240:243]
 global_load_dwordx4 a[192:195], v0, s[70:71] offset:-4096 sc1
 v_mfma_f32_16x16x32_bf16 v[132:135], a[200:203], a[168:171], v[132:135]
 v_mfma_f32_16x16x32_bf16 v[132:135], a[204:207], a[172:175], v[132:135]
 v_mfma_f32_16x16x32_bf16 v[128:131], a[204:207], a[164:167], v[128:131]
 v_mfma_f32_16x16x32_bf16 v[128:131], a[200:203], a[160:163], v[128:131]
 v_mfma_f32_16x16x32_bf16 v[124:127], a[200:203], a[152:155], v[124:127]
 v_mfma_f32_16x16x32_bf16 v[124:127], a[204:207], a[156:159], v[124:127]
 v_mfma_f32_16x16x32_bf16 v[120:123], a[204:207], a[148:151], v[120:123]
 v_mfma_f32_16x16x32_bf16 v[120:123], a[200:203], a[144:147], v[120:123]
 v_mfma_f32_16x16x32_bf16 v[116:119], a[200:203], a[136:139], v[116:119]
 buffer_load_dwordx4 v6, s[8:11], s30 offen lds
 v_mfma_f32_16x16x32_bf16 v[116:119], a[204:207], a[140:143], v[116:119]
 v_mfma_f32_16x16x32_bf16 v[112:115], a[204:207], a[132:135], v[112:115]
 s_add_u32 m0, m0, 1024
 v_mfma_f32_16x16x32_bf16 v[112:115], a[200:203], a[128:131], v[112:115]
 s_add_u32 s30, s30, s20
 s_waitcnt vmcnt(11)
 v_mfma_f32_16x16x32_bf16 v[136:139], a[208:211], a[128:131], v[136:139]
 buffer_load_dwordx4 v6, s[8:11], s30 offen lds
 v_mfma_f32_16x16x32_bf16 v[136:139], a[212:215], a[132:135], v[136:139]
 global_load_dwordx4 a[204:207], v0, s[70:71] offset:-1024 sc1
 v_mfma_f32_16x16x32_bf16 v[140:143], a[212:215], a[140:143], v[140:143]
 s_add_u32 m0, m0, 3072
 v_mfma_f32_16x16x32_bf16 v[140:143], a[208:211], a[136:139], v[140:143]
 global_load_dwordx4 a[200:203], v0, s[70:71] offset:-2048 sc1
 v_mfma_f32_16x16x32_bf16 v[144:147], a[208:211], a[144:147], v[144:147]
 s_add_u32 s30, s30, s21
 v_mfma_f32_16x16x32_bf16 v[144:147], a[212:215], a[148:151], v[144:147]
 v_mfma_f32_16x16x32_bf16 v[148:151], a[212:215], a[156:159], v[148:151]
 v_mfma_f32_16x16x32_bf16 v[148:151], a[208:211], a[152:155], v[148:151]
 v_mfma_f32_16x16x32_bf16 v[152:155], a[208:211], a[160:163], v[152:155]
 v_mfma_f32_16x16x32_bf16 v[152:155], a[212:215], a[164:167], v[152:155]
 v_mfma_f32_16x16x32_bf16 v[156:159], a[212:215], a[172:175], v[156:159]
 v_mfma_f32_16x16x32_bf16 v[156:159], a[208:211], a[168:171], v[156:159]
 v_mfma_f32_16x16x32_bf16 v[160:163], a[208:211], a[176:179], v[160:163]
 v_mfma_f32_16x16x32_bf16 v[160:163], a[212:215], a[180:183], v[160:163]
 v_mfma_f32_16x16x32_bf16 v[164:167], a[212:215], a[188:191], v[164:167]
 v_mfma_f32_16x16x32_bf16 v[164:167], a[208:211], a[184:187], v[164:167]
 s_waitcnt vmcnt(12)
 v_mfma_f32_16x16x32_bf16 v[196:199], a[216:219], a[184:187], v[196:199]
 v_mfma_f32_16x16x32_bf16 v[196:199], a[220:223], a[188:191], v[196:199]
 global_load_dwordx4 a[212:215], v0, s[70:71] offset:1024 sc1
 v_mfma_f32_16x16x32_bf16 v[192:195], a[220:223], a[180:183], v[192:195]
 v_mfma_f32_16x16x32_bf16 v[192:195], a[216:219], a[176:179], v[192:195]
 global_load_dwordx4 a[208:211], v0, s[70:71] offset:0 sc1
 v_mfma_f32_16x16x32_bf16 v[188:191], a[216:219], a[168:171], v[188:191]
 v_mfma_f32_16x16x32_bf16 v[188:191], a[220:223], a[172:175], v[188:191]
 v_mfma_f32_16x16x32_bf16 v[184:187], a[220:223], a[164:167], v[184:187]
 v_mfma_f32_16x16x32_bf16 v[184:187], a[216:219], a[160:163], v[184:187]
 v_mfma_f32_16x16x32_bf16 v[180:183], a[216:219], a[152:155], v[180:183]
 v_mfma_f32_16x16x32_bf16 v[180:183], a[220:223], a[156:159], v[180:183]
 v_mfma_f32_16x16x32_bf16 v[176:179], a[220:223], a[148:151], v[176:179]
 v_mfma_f32_16x16x32_bf16 v[176:179], a[216:219], a[144:147], v[176:179]
 v_mfma_f32_16x16x32_bf16 v[172:175], a[216:219], a[136:139], v[172:175]
 v_mfma_f32_16x16x32_bf16 v[172:175], a[220:223], a[140:143], v[172:175]
 v_mfma_f32_16x16x32_bf16 v[168:171], a[220:223], a[132:135], v[168:171]
 v_mfma_f32_16x16x32_bf16 v[168:171], a[216:219], a[128:131], v[168:171]
 s_waitcnt vmcnt(10)
 v_mfma_f32_16x16x32_bf16 v[200:203], a[224:227], a[128:131], v[200:203]
 v_mfma_f32_16x16x32_bf16 v[200:203], a[228:231], a[132:135], v[200:203]
 global_load_dwordx4 a[220:223], v0, s[70:71] offset:3072 sc1
 v_mfma_f32_16x16x32_bf16 v[204:207], a[228:231], a[140:143], v[204:207]
 v_mfma_f32_16x16x32_bf16 v[204:207], a[224:227], a[136:139], v[204:207]
 global_load_dwordx4 a[216:219], v0, s[70:71] offset:2048 sc1
 v_mfma_f32_16x16x32_bf16 v[208:211], a[224:227], a[144:147], v[208:211]
 s_add_u32 s70, s70, 8192
 s_addc_u32 s71, s71, 0
 v_mfma_f32_16x16x32_bf16 v[208:211], a[228:231], a[148:151], v[208:211]
 v_mfma_f32_16x16x32_bf16 v[212:215], a[228:231], a[156:159], v[212:215]
 v_mfma_f32_16x16x32_bf16 v[212:215], a[224:227], a[152:155], v[212:215]
 v_mfma_f32_16x16x32_bf16 v[216:219], a[224:227], a[160:163], v[216:219]
 v_mfma_f32_16x16x32_bf16 v[216:219], a[228:231], a[164:167], v[216:219]
 v_mfma_f32_16x16x32_bf16 v[220:223], a[228:231], a[172:175], v[220:223]
 v_mfma_f32_16x16x32_bf16 v[220:223], a[224:227], a[168:171], v[220:223]
 v_mfma_f32_16x16x32_bf16 v[224:227], a[224:227], a[176:179], v[224:227]
 v_mfma_f32_16x16x32_bf16 v[224:227], a[228:231], a[180:183], v[224:227]
 v_mfma_f32_16x16x32_bf16 v[228:231], a[228:231], a[188:191], v[228:231]
 v_mfma_f32_16x16x32_bf16 v[228:231], a[224:227], a[184:187], v[228:231]
 buffer_load_dwordx4 v6, s[8:11], s30 offen lds
 s_waitcnt vmcnt(11)
 v_mfma_f32_16x16x32_bf16 a[252:255], a[232:235], a[184:187], a[252:255]
 ds_read_b128 a[184:187], v1 offset:61440
 v_mfma_f32_16x16x32_bf16 a[252:255], a[236:239], a[188:191], a[252:255]
 global_load_dwordx4 a[228:231], v0, s[70:71] offset:-3072 sc1
 ds_read_b128 a[188:191], v1 offset:62464
 v_mfma_f32_16x16x32_bf16 a[248:251], a[236:239], a[180:183], a[248:251]
 ds_read_b128 a[180:183], v1 offset:58368
 v_mfma_f32_16x16x32_bf16 a[248:251], a[232:235], a[176:179], a[248:251]
 global_load_dwordx4 a[224:227], v0, s[70:71] offset:-4096 sc1
 ds_read_b128 a[176:179], v1 offset:57344
 v_mfma_f32_16x16x32_bf16 v[252:255], a[232:235], a[168:171], v[252:255]
 ds_read_b128 a[168:171], v1 offset:53248
 v_mfma_f32_16x16x32_bf16 v[252:255], a[236:239], a[172:175], v[252:255]
 ds_read_b128 a[172:175], v1 offset:54272
 s_add_u32 m0, m0, 1024
 v_mfma_f32_16x16x32_bf16 v[248:251], a[236:239], a[164:167], v[248:251]
 ds_read_b128 a[164:167], v1 offset:50176
 s_add_u32 s30, s30, s20
 v_mfma_f32_16x16x32_bf16 v[248:251], a[232:235], a[160:163], v[248:251]
 ds_read_b128 a[160:163], v1 offset:49152
 v_mfma_f32_16x16x32_bf16 v[244:247], a[232:235], a[152:155], v[244:247]
 ds_read_b128 a[152:155], v1 offset:45056
 buffer_load_dwordx4 v6, s[8:11], s30 offen lds
 v_mfma_f32_16x16x32_bf16 v[244:247], a[236:239], a[156:159], v[244:247]
 ds_read_b128 a[156:159], v1 offset:46080
 s_add_u32 m0, m0, 3072
 v_mfma_f32_16x16x32_bf16 v[240:243], a[236:239], a[148:151], v[240:243]
 ds_read_b128 a[148:151], v1 offset:41984
 v_mfma_f32_16x16x32_bf16 v[240:243], a[232:235], a[144:147], v[240:243]
 ds_read_b128 a[144:147], v1 offset:40960
 s_add_u32 s30, s30, s21
 v_mfma_f32_16x16x32_bf16 v[236:239], a[232:235], a[136:139], v[236:239]
 ds_read_b128 a[136:139], v1 offset:36864
 v_mfma_f32_16x16x32_bf16 v[236:239], a[236:239], a[140:143], v[236:239]
 ds_read_b128 a[140:143], v1 offset:37888
 v_mfma_f32_16x16x32_bf16 v[232:235], a[236:239], a[132:135], v[232:235]
 ds_read_b128 a[132:135], v1 offset:33792
 v_mfma_f32_16x16x32_bf16 v[232:235], a[232:235], a[128:131], v[232:235]
 ds_read_b128 a[128:131], v1 offset:32768
 s_waitcnt vmcnt(12) lgkmcnt(8)
 v_mfma_f32_16x16x32_bf16 v[44:47], a[192:195], a[184:187], v[44:47]
 v_mfma_f32_16x16x32_bf16 v[44:47], a[196:199], a[188:191], v[44:47]
 v_mfma_f32_16x16x32_bf16 v[40:43], a[196:199], a[180:183], v[40:43]
 v_mfma_f32_16x16x32_bf16 v[40:43], a[192:195], a[176:179], v[40:43]
 v_mfma_f32_16x16x32_bf16 v[36:39], a[192:195], a[168:171], v[36:39]
 v_mfma_f32_16x16x32_bf16 v[36:39], a[196:199], a[172:175], v[36:39]
 v_mfma_f32_16x16x32_bf16 v[32:35], a[196:199], a[164:167], v[32:35]
 v_mfma_f32_16x16x32_bf16 v[32:35], a[192:195], a[160:163], v[32:35]
 s_waitcnt lgkmcnt(0)
 v_mfma_f32_16x16x32_bf16 v[28:31], a[192:195], a[152:155], v[28:31]
 v_mfma_f32_16x16x32_bf16 v[28:31], a[196:199], a[156:159], v[28:31]
 v_mfma_f32_16x16x32_bf16 v[24:27], a[196:199], a[148:151], v[24:27]
 v_mfma_f32_16x16x32_bf16 v[24:27], a[192:195], a[144:147], v[24:27]
 v_mfma_f32_16x16x32_bf16 v[20:23], a[192:195], a[136:139], v[20:23]
 v_mfma_f32_16x16x32_bf16 v[20:23], a[196:199], a[140:143], v[20:23]
 v_mfma_f32_16x16x32_bf16 v[16:19], a[196:199], a[132:135], v[16:19]
 v_mfma_f32_16x16x32_bf16 v[16:19], a[192:195], a[128:131], v[16:19]
 s_waitcnt vmcnt(8)
 v_mfma_f32_16x16x32_bf16 v[48:51], a[200:203], a[128:131], v[48:51]
 v_mfma_f32_16x16x32_bf16 v[48:51], a[204:207], a[132:135], v[48:51]
 global_load_dwordx4 a[196:199], v0, s[70:71] offset:-1024 sc1
 v_mfma_f32_16x16x32_bf16 v[52:55], a[204:207], a[140:143], v[52:55]
 v_mfma_f32_16x16x32_bf16 v[52:55], a[200:203], a[136:139], v[52:55]
 global_load_dwordx4 a[192:195], v0, s[70:71] offset:-2048 sc1
 v_mfma_f32_16x16x32_bf16 v[56:59], a[200:203], a[144:147], v[56:59]
 v_mfma_f32_16x16x32_bf16 v[56:59], a[204:207], a[148:151], v[56:59]
 v_mfma_f32_16x16x32_bf16 v[60:63], a[204:207], a[156:159], v[60:63]
 v_mfma_f32_16x16x32_bf16 v[60:63], a[200:203], a[152:155], v[60:63]
 v_mfma_f32_16x16x32_bf16 v[64:67], a[200:203], a[160:163], v[64:67]
 v_mfma_f32_16x16x32_bf16 v[64:67], a[204:207], a[164:167], v[64:67]
 v_mfma_f32_16x16x32_bf16 v[68:71], a[204:207], a[172:175], v[68:71]
 v_mfma_f32_16x16x32_bf16 v[68:71], a[200:203], a[168:171], v[68:71]
 v_mfma_f32_16x16x32_bf16 v[72:75], a[200:203], a[176:179], v[72:75]
 v_mfma_f32_16x16x32_bf16 v[72:75], a[204:207], a[180:183], v[72:75]
 v_mfma_f32_16x16x32_bf16 v[76:79], a[204:207], a[188:191], v[76:79]
 v_mfma_f32_16x16x32_bf16 v[76:79], a[200:203], a[184:187], v[76:79]
 s_waitcnt vmcnt(8)
 v_mfma_f32_16x16x32_bf16 v[108:111], a[208:211], a[184:187], v[108:111]
 v_mfma_f32_16x16x32_bf16 v[108:111], a[212:215], a[188:191], v[108:111]
 global_load_dwordx4 a[204:207], v0, s[70:71] offset:1024 sc1
 v_mfma_f32_16x16x32_bf16 v[104:107], a[212:215], a[180:183], v[104:107]
 v_mfma_f32_16x16x32_bf16 v[104:107], a[208:211], a[176:179], v[104:107]
 global_load_dwordx4 a[200:203], v0, s[70:71] offset:0 sc1
 v_mfma_f32_16x16x32_bf16 v[100:103], a[208:211], a[168:171], v[100:103]
 v_mfma_f32_16x16x32_bf16 v[100:103], a[212:215], a[172:175], v[100:103]
 v_mfma_f32_16x16x32_bf16 v[96:99], a[212:215], a[164:167], v[96:99]
 v_mfma_f32_16x16x32_bf16 v[96:99], a[208:211], a[160:163], v[96:99]
 v_mfma_f32_16x16x32_bf16 v[92:95], a[208:211], a[152:155], v[92:95]
 v_mfma_f32_16x16x32_bf16 v[92:95], a[212:215], a[156:159], v[92:95]
 v_mfma_f32_16x16x32_bf16 v[88:91], a[212:215], a[148:151], v[88:91]
 buffer_load_dwordx4 v6, s[8:11], s30 offen lds
 v_mfma_f32_16x16x32_bf16 v[88:91], a[208:211], a[144:147], v[88:91]
 v_mfma_f32_16x16x32_bf16 v[84:87], a[208:211], a[136:139], v[84:87]
 s_add_u32 m0, m0, 1024
 v_mfma_f32_16x16x32_bf16 v[84:87], a[212:215], a[140:143], v[84:87]
 s_add_u32 s30, s30, s20
 v_mfma_f32_16x16x32_bf16 v[80:83], a[212:215], a[132:135], v[80:83]
 v_mfma_f32_16x16x32_bf16 v[80:83], a[208:211], a[128:131], v[80:83]
 buffer_load_dwordx4 v6, s[8:11], s30 offen lds
 s_waitcnt vmcnt(10)
 v_mfma_f32_16x16x32_bf16 v[112:115], a[216:219], a[128:131], v[112:115]
 v_mfma_f32_16x16x32_bf16 v[112:115], a[220:223], a[132:135], v[112:115]
 global_load_dwordx4 a[212:215], v0, s[70:71] offset:3072 sc1
 s_add_u32 m0, m0, 3072
 v_mfma_f32_16x16x32_bf16 v[116:119], a[220:223], a[140:143], v[116:119]
 s_add_u32 s30, s30, s21
 v_mfma_f32_16x16x32_bf16 v[116:119], a[216:219], a[136:139], v[116:119]
 global_load_dwordx4 a[208:211], v0, s[70:71] offset:2048 sc1
 v_mfma_f32_16x16x32_bf16 v[120:123], a[216:219], a[144:147], v[120:123]
 s_add_u32 s70, s70, 8192
 s_addc_u32 s71, s71, 0
 v_mfma_f32_16x16x32_bf16 v[120:123], a[220:223], a[148:151], v[120:123]
 v_mfma_f32_16x16x32_bf16 v[124:127], a[220:223], a[156:159], v[124:127]
 v_mfma_f32_16x16x32_bf16 v[124:127], a[216:219], a[152:155], v[124:127]
 v_mfma_f32_16x16x32_bf16 v[128:131], a[216:219], a[160:163], v[128:131]
 v_mfma_f32_16x16x32_bf16 v[128:131], a[220:223], a[164:167], v[128:131]
 v_mfma_f32_16x16x32_bf16 v[132:135], a[220:223], a[172:175], v[132:135]
 v_mfma_f32_16x16x32_bf16 v[132:135], a[216:219], a[168:171], v[132:135]
 v_mfma_f32_16x16x32_bf16 a[240:243], a[216:219], a[176:179], a[240:243]
 v_mfma_f32_16x16x32_bf16 a[240:243], a[220:223], a[180:183], a[240:243]
 v_mfma_f32_16x16x32_bf16 a[244:247], a[220:223], a[188:191], a[244:247]
 v_mfma_f32_16x16x32_bf16 a[244:247], a[216:219], a[184:187], a[244:247]
 s_waitcnt vmcnt(9)
 v_mfma_f32_16x16x32_bf16 v[164:167], a[224:227], a[184:187], v[164:167]
 v_mfma_f32_16x16x32_bf16 v[164:167], a[228:231], a[188:191], v[164:167]
 global_load_dwordx4 a[220:223], v0, s[70:71] offset:-3072 sc1
 v_mfma_f32_16x16x32_bf16 v[160:163], a[228:231], a[180:183], v[160:163]
 v_mfma_f32_16x16x32_bf16 v[160:163], a[224:227], a[176:179], v[160:163]
 global_load_dwordx4 a[216:219], v0, s[70:71] offset:-4096 sc1
 v_mfma_f32_16x16x32_bf16 v[156:159], a[224:227], a[168:171], v[156:159]
 v_mfma_f32_16x16x32_bf16 v[156:159], a[228:231], a[172:175], v[156:159]
 v_mfma_f32_16x16x32_bf16 v[152:155], a[228:231], a[164:167], v[152:155]
 v_mfma_f32_16x16x32_bf16 v[152:155], a[224:227], a[160:163], v[152:155]
 v_mfma_f32_16x16x32_bf16 v[148:151], a[224:227], a[152:155], v[148:151]
 v_mfma_f32_16x16x32_bf16 v[148:151], a[228:231], a[156:159], v[148:151]
 v_mfma_f32_16x16x32_bf16 v[144:147], a[228:231], a[148:151], v[144:147]
 v_mfma_f32_16x16x32_bf16 v[144:147], a[224:227], a[144:147], v[144:147]
 v_mfma_f32_16x16x32_bf16 v[140:143], a[224:227], a[136:139], v[140:143]
 v_mfma_f32_16x16x32_bf16 v[140:143], a[228:231], a[140:143], v[140:143]
 v_mfma_f32_16x16x32_bf16 v[136:139], a[228:231], a[132:135], v[136:139]
 v_mfma_f32_16x16x32_bf16 v[136:139], a[224:227], a[128:131], v[136:139]
 s_waitcnt vmcnt(8)
 v_mfma_f32_16x16x32_bf16 v[168:171], a[192:195], a[128:131], v[168:171]
 v_mfma_f32_16x16x32_bf16 v[168:171], a[196:199], a[132:135], v[168:171]
 global_load_dwordx4 a[228:231], v0, s[70:71] offset:-1024 sc1
 v_mfma_f32_16x16x32_bf16 v[172:175], a[196:199], a[140:143], v[172:175]
 v_mfma_f32_16x16x32_bf16 v[172:175], a[192:195], a[136:139], v[172:175]
 global_load_dwordx4 a[224:227], v0, s[70:71] offset:-2048 sc1
 v_mfma_f32_16x16x32_bf16 v[176:179], a[192:195], a[144:147], v[176:179]
 v_mfma_f32_16x16x32_bf16 v[176:179], a[196:199], a[148:151], v[176:179]
 v_mfma_f32_16x16x32_bf16 v[180:183], a[196:199], a[156:159], v[180:183]
 v_mfma_f32_16x16x32_bf16 v[180:183], a[192:195], a[152:155], v[180:183]
 v_mfma_f32_16x16x32_bf16 v[184:187], a[192:195], a[160:163], v[184:187]
 v_mfma_f32_16x16x32_bf16 v[184:187], a[196:199], a[164:167], v[184:187]
 v_mfma_f32_16x16x32_bf16 v[188:191], a[196:199], a[172:175], v[188:191]
 v_mfma_f32_16x16x32_bf16 v[188:191], a[192:195], a[168:171], v[188:191]
 v_mfma_f32_16x16x32_bf16 v[192:195], a[192:195], a[176:179], v[192:195]
 v_mfma_f32_16x16x32_bf16 v[192:195], a[196:199], a[180:183], v[192:195]
 v_mfma_f32_16x16x32_bf16 v[196:199], a[196:199], a[188:191], v[196:199]
 v_mfma_f32_16x16x32_bf16 v[196:199], a[192:195], a[184:187], v[196:199]
 s_waitcnt vmcnt(8)
 v_mfma_f32_16x16x32_bf16 v[228:231], a[200:203], a[184:187], v[228:231]
 v_mfma_f32_16x16x32_bf16 v[228:231], a[204:207], a[188:191], v[228:231]
 global_load_dwordx4 a[196:199], v0, s[70:71] offset:1024 sc1
 v_mfma_f32_16x16x32_bf16 v[224:227], a[204:207], a[180:183], v[224:227]
 buffer_load_dwordx4 v6, s[8:11], s30 offen lds
 v_mfma_f32_16x16x32_bf16 v[224:227], a[200:203], a[176:179], v[224:227]
 global_load_dwordx4 a[192:195], v0, s[70:71] offset:0 sc1
 s_add_u32 m0, m0, 1024
 v_mfma_f32_16x16x32_bf16 v[220:223], a[200:203], a[168:171], v[220:223]
 v_mfma_f32_16x16x32_bf16 v[220:223], a[204:207], a[172:175], v[220:223]
 s_add_u32 s30, s30, s20
 v_mfma_f32_16x16x32_bf16 v[216:219], a[204:207], a[164:167], v[216:219]
 buffer_load_dwordx4 v6, s[8:11], s30 offen lds
 v_mfma_f32_16x16x32_bf16 v[216:219], a[200:203], a[160:163], v[216:219]
 v_mfma_f32_16x16x32_bf16 v[212:215], a[200:203], a[152:155], v[212:215]
 s_add_u32 m0, m0, 3072
 v_mfma_f32_16x16x32_bf16 v[212:215], a[204:207], a[156:159], v[212:215]
 s_add_u32 s30, s30, s21
 v_mfma_f32_16x16x32_bf16 v[208:211], a[204:207], a[148:151], v[208:211]
 v_mfma_f32_16x16x32_bf16 v[208:211], a[200:203], a[144:147], v[208:211]
 v_mfma_f32_16x16x32_bf16 v[204:207], a[200:203], a[136:139], v[204:207]
 v_mfma_f32_16x16x32_bf16 v[204:207], a[204:207], a[140:143], v[204:207]
 v_mfma_f32_16x16x32_bf16 v[200:203], a[204:207], a[132:135], v[200:203]
 v_mfma_f32_16x16x32_bf16 v[200:203], a[200:203], a[128:131], v[200:203]
 s_waitcnt vmcnt(8)
 v_mfma_f32_16x16x32_bf16 v[232:235], a[208:211], a[128:131], v[232:235]
 ds_read_b128 a[128:131], v2
 v_mfma_f32_16x16x32_bf16 v[232:235], a[212:215], a[132:135], v[232:235]
 global_load_dwordx4 a[204:207], v0, s[70:71] offset:3072 sc1
 ds_read_b128 a[132:135], v2 offset:1024
 v_mfma_f32_16x16x32_bf16 v[236:239], a[212:215], a[140:143], v[236:239]
 ds_read_b128 a[140:143], v2 offset:5120
 v_mfma_f32_16x16x32_bf16 v[236:239], a[208:211], a[136:139], v[236:239]
 global_load_dwordx4 a[200:203], v0, s[70:71] offset:2048 sc1
 ds_read_b128 a[136:139], v2 offset:4096
 v_mfma_f32_16x16x32_bf16 v[240:243], a[208:211], a[144:147], v[240:243]
 s_add_u32 s70, s70, 8192
 s_addc_u32 s71, s71, 0
 ds_read_b128 a[144:147], v2 offset:8192
 v_mfma_f32_16x16x32_bf16 v[240:243], a[212:215], a[148:151], v[240:243]
 ds_read_b128 a[148:151], v2 offset:9216
 v_mfma_f32_16x16x32_bf16 v[244:247], a[212:215], a[156:159], v[244:247]
 ds_read_b128 a[156:159], v2 offset:13312
 v_mfma_f32_16x16x32_bf16 v[244:247], a[208:211], a[152:155], v[244:247]
 ds_read_b128 a[152:155], v2 offset:12288
 v_mfma_f32_16x16x32_bf16 v[248:251], a[208:211], a[160:163], v[248:251]
 ds_read_b128 a[160:163], v2 offset:16384
 v_mfma_f32_16x16x32_bf16 v[248:251], a[212:215], a[164:167], v[248:251]
 ds_read_b128 a[164:167], v2 offset:17408
 v_mfma_f32_16x16x32_bf16 v[252:255], a[212:215], a[172:175], v[252:255]
 ds_read_b128 a[172:175], v2 offset:21504
 v_mfma_f32_16x16x32_bf16 v[252:255], a[208:211], a[168:171], v[252:255]
 ds_read_b128 a[168:171], v2 offset:20480
 v_mfma_f32_16x16x32_bf16 a[248:251], a[208:211], a[176:179], a[248:251]
 ds_read_b128 a[176:179], v2 offset:24576
 v_mfma_f32_16x16x32_bf16 a[248:251], a[212:215], a[180:183], a[248:251]
 ds_read_b128 a[180:183], v2 offset:25600
 v_mfma_f32_16x16x32_bf16 a[252:255], a[212:215], a[188:191], a[252:255]
 ds_read_b128 a[188:191], v2 offset:29696
 v_mfma_f32_16x16x32_bf16 a[252:255], a[208:211], a[184:187], a[252:255]
 ds_read_b128 a[184:187], v2 offset:28672
 s_waitcnt vmcnt(8) lgkmcnt(8)
 v_mfma_f32_16x16x32_bf16 v[16:19], a[216:219], a[128:131], v[16:19]
 v_mfma_f32_16x16x32_bf16 v[16:19], a[220:223], a[132:135], v[16:19]
 global_load_dwordx4 a[212:215], v0, s[70:71] offset:-3072 sc1
 v_mfma_f32_16x16x32_bf16 v[20:23], a[220:223], a[140:143], v[20:23]
 v_mfma_f32_16x16x32_bf16 v[20:23], a[216:219], a[136:139], v[20:23]
 global_load_dwordx4 a[208:211], v0, s[70:71] offset:-4096 sc1
 v_mfma_f32_16x16x32_bf16 v[24:27], a[216:219], a[144:147], v[24:27]
 v_mfma_f32_16x16x32_bf16 v[24:27], a[220:223], a[148:151], v[24:27]
 v_mfma_f32_16x16x32_bf16 v[28:31], a[220:223], a[156:159], v[28:31]
 v_mfma_f32_16x16x32_bf16 v[28:31], a[216:219], a[152:155], v[28:31]
 s_waitcnt lgkmcnt(0)
 v_mfma_f32_16x16x32_bf16 v[32:35], a[216:219], a[160:163], v[32:35]
 v_mfma_f32_16x16x32_bf16 v[32:35], a[220:223], a[164:167], v[32:35]
 v_mfma_f32_16x16x32_bf16 v[36:39], a[220:223], a[172:175], v[36:39]
 v_mfma_f32_16x16x32_bf16 v[36:39], a[216:219], a[168:171], v[36:39]
 v_mfma_f32_16x16x32_bf16 v[40:43], a[216:219], a[176:179], v[40:43]
 v_mfma_f32_16x16x32_bf16 v[40:43], a[220:223], a[180:183], v[40:43]
 v_mfma_f32_16x16x32_bf16 v[44:47], a[220:223], a[188:191], v[44:47]
 v_mfma_f32_16x16x32_bf16 v[44:47], a[216:219], a[184:187], v[44:47]
 s_waitcnt vmcnt(8)
 v_mfma_f32_16x16x32_bf16 v[76:79], a[224:227], a[184:187], v[76:79]
 v_mfma_f32_16x16x32_bf16 v[76:79], a[228:231], a[188:191], v[76:79]
 global_load_dwordx4 a[220:223], v0, s[70:71] offset:-1024 sc1
 v_mfma_f32_16x16x32_bf16 v[72:75], a[228:231], a[180:183], v[72:75]
 v_mfma_f32_16x16x32_bf16 v[72:75], a[224:227], a[176:179], v[72:75]
 global_load_dwordx4 a[216:219], v0, s[70:71] offset:-2048 sc1
 v_mfma_f32_16x16x32_bf16 v[68:71], a[224:227], a[168:171], v[68:71]
 v_mfma_f32_16x16x32_bf16 v[68:71], a[228:231], a[172:175], v[68:71]
 v_mfma_f32_16x16x32_bf16 v[64:67], a[228:231], a[164:167], v[64:67]
 v_mfma_f32_16x16x32_bf16 v[64:67], a[224:227], a[160:163], v[64:67]
 v_mfma_f32_16x16x32_bf16 v[60:63], a[224:227], a[152:155], v[60:63]
 v_mfma_f32_16x16x32_bf16 v[60:63], a[228:231], a[156:159], v[60:63]
 buffer_load_dwordx4 v6, s[8:11], s30 offen lds
 v_mfma_f32_16x16x32_bf16 v[56:59], a[228:231], a[148:151], v[56:59]
 s_add_u32 m0, m0, 1024
 v_mfma_f32_16x16x32_bf16 v[56:59], a[224:227], a[144:147], v[56:59]
 v_mfma_f32_16x16x32_bf16 v[52:55], a[224:227], a[136:139], v[52:55]
 s_add_u32 s30, s30, s20
 v_mfma_f32_16x16x32_bf16 v[52:55], a[228:231], a[140:143], v[52:55]
 buffer_load_dwordx4 v6, s[8:11], s30 offen lds
 v_mfma_f32_16x16x32_bf16 v[48:51], a[228:231], a[132:135], v[48:51]
 v_mfma_f32_16x16x32_bf16 v[48:51], a[224:227], a[128:131], v[48:51]
 s_add_u32 m0, m0, 3072
 s_waitcnt vmcnt(9)
 v_mfma_f32_16x16x32_bf16 v[80:83], a[192:195], a[128:131], v[80:83]
 s_add_u32 s30, s30, s21
 v_mfma_f32_16x16x32_bf16 v[80:83], a[196:199], a[132:135], v[80:83]
 global_load_dwordx4 a[228:231], v0, s[70:71] offset:1024 sc1
 v_mfma_f32_16x16x32_bf16 v[84:87], a[196:199], a[140:143], v[84:87]
 v_mfma_f32_16x16x32_bf16 v[84:87], a[192:195], a[136:139], v[84:87]
 global_load_dwordx4 a[224:227], v0, s[70:71] offset:0 sc1
 v_mfma_f32_16x16x32_bf16 v[88:91], a[192:195], a[144:147], v[88:91]
 v_mfma_f32_16x16x32_bf16 v[88:91], a[196:199], a[148:151], v[88:91]
 v_mfma_f32_16x16x32_bf16 v[92:95], a[196:199], a[156:159], v[92:95]
 v_mfma_f32_16x16x32_bf16 v[92:95], a[192:195], a[152:155], v[92:95]
 v_mfma_f32_16x16x32_bf16 v[96:99], a[192:195], a[160:163], v[96:99]
 v_mfma_f32_16x16x32_bf16 v[96:99], a[196:199], a[164:167], v[96:99]
 v_mfma_f32_16x16x32_bf16 v[100:103], a[196:199], a[172:175], v[100:103]
 v_mfma_f32_16x16x32_bf16 v[100:103], a[192:195], a[168:171], v[100:103]
 v_mfma_f32_16x16x32_bf16 v[104:107], a[192:195], a[176:179], v[104:107]
 v_mfma_f32_16x16x32_bf16 v[104:107], a[196:199], a[180:183], v[104:107]
 v_mfma_f32_16x16x32_bf16 v[108:111], a[196:199], a[188:191], v[108:111]
 v_mfma_f32_16x16x32_bf16 v[108:111], a[192:195], a[184:187], v[108:111]
 s_waitcnt vmcnt(8)
 v_mfma_f32_16x16x32_bf16 a[244:247], a[200:203], a[184:187], a[244:247]
 v_mfma_f32_16x16x32_bf16 a[244:247], a[204:207], a[188:191], a[244:247]
 global_load_dwordx4 a[196:199], v0, s[70:71] offset:3072 sc1
 v_mfma_f32_16x16x32_bf16 a[240:243], a[204:207], a[180:183], a[240:243]
 v_mfma_f32_16x16x32_bf16 a[240:243], a[200:203], a[176:179], a[240:243]
 global_load_dwordx4 a[192:195], v0, s[70:71] offset:2048 sc1
 v_mfma_f32_16x16x32_bf16 v[132:135], a[200:203], a[168:171], v[132:135]
 s_add_u32 s70, s70, 8192
 s_addc_u32 s71, s71, 0
 v_mfma_f32_16x16x32_bf16 v[132:135], a[204:207], a[172:175], v[132:135]
 v_mfma_f32_16x16x32_bf16 v[128:131], a[204:207], a[164:167], v[128:131]
 v_mfma_f32_16x16x32_bf16 v[128:131], a[200:203], a[160:163], v[128:131]
 v_mfma_f32_16x16x32_bf16 v[124:127], a[200:203], a[152:155], v[124:127]
 v_mfma_f32_16x16x32_bf16 v[124:127], a[204:207], a[156:159], v[124:127]
 v_mfma_f32_16x16x32_bf16 v[120:123], a[204:207], a[148:151], v[120:123]
 v_mfma_f32_16x16x32_bf16 v[120:123], a[200:203], a[144:147], v[120:123]
 v_mfma_f32_16x16x32_bf16 v[116:119], a[200:203], a[136:139], v[116:119]
 v_mfma_f32_16x16x32_bf16 v[116:119], a[204:207], a[140:143], v[116:119]
 v_mfma_f32_16x16x32_bf16 v[112:115], a[204:207], a[132:135], v[112:115]
 v_mfma_f32_16x16x32_bf16 v[112:115], a[200:203], a[128:131], v[112:115]
 s_waitcnt vmcnt(8)
 v_mfma_f32_16x16x32_bf16 v[136:139], a[208:211], a[128:131], v[136:139]
 v_mfma_f32_16x16x32_bf16 v[136:139], a[212:215], a[132:135], v[136:139]
 global_load_dwordx4 a[204:207], v0, s[70:71] offset:-3072 sc1
 v_mfma_f32_16x16x32_bf16 v[140:143], a[212:215], a[140:143], v[140:143]
 v_mfma_f32_16x16x32_bf16 v[140:143], a[208:211], a[136:139], v[140:143]
 global_load_dwordx4 a[200:203], v0, s[70:71] offset:-4096 sc1
 v_mfma_f32_16x16x32_bf16 v[144:147], a[208:211], a[144:147], v[144:147]
 v_mfma_f32_16x16x32_bf16 v[144:147], a[212:215], a[148:151], v[144:147]
 v_mfma_f32_16x16x32_bf16 v[148:151], a[212:215], a[156:159], v[148:151]
 v_mfma_f32_16x16x32_bf16 v[148:151], a[208:211], a[152:155], v[148:151]
 v_mfma_f32_16x16x32_bf16 v[152:155], a[208:211], a[160:163], v[152:155]
 v_mfma_f32_16x16x32_bf16 v[152:155], a[212:215], a[164:167], v[152:155]
 v_mfma_f32_16x16x32_bf16 v[156:159], a[212:215], a[172:175], v[156:159]
 v_and_b32 v5, 768, v1
 v_mfma_f32_16x16x32_bf16 v[156:159], a[208:211], a[168:171], v[156:159]
 v_mfma_f32_16x16x32_bf16 v[160:163], a[208:211], a[176:179], v[160:163]
 v_add3_u32 v5, v5, v1, s52
 v_mfma_f32_16x16x32_bf16 v[160:163], a[212:215], a[180:183], v[160:163]
 v_mfma_f32_16x16x32_bf16 v[164:167], a[212:215], a[188:191], v[164:167]
 ds_read_b64_tr_b16 v[8:9], v5 offset:0
 v_mfma_f32_16x16x32_bf16 v[164:167], a[208:211], a[184:187], v[164:167]
 buffer_load_dwordx4 v6, s[8:11], s30 offen lds
 s_waitcnt vmcnt(9)
 v_mfma_f32_16x16x32_bf16 v[196:199], a[216:219], a[184:187], v[196:199]
 ds_read_b64_tr_b16 v[10:11], v5 offset:256
 v_mfma_f32_16x16x32_bf16 v[196:199], a[220:223], a[188:191], v[196:199]
 global_load_dwordx4 a[212:215], v0, s[70:71] offset:-1024 sc1
 s_add_u32 m0, m0, 1024
 ds_read_b64_tr_b16 v[12:13], v5 offset:8
 v_mfma_f32_16x16x32_bf16 v[192:195], a[220:223], a[180:183], v[192:195]
 ds_read_b64_tr_b16 v[14:15], v5 offset:264
 v_mfma_f32_16x16x32_bf16 v[192:195], a[216:219], a[176:179], v[192:195]
 global_load_dwordx4 a[208:211], v0, s[70:71] offset:-2048 sc1
 s_add_u32 s30, s30, s20
 v_mfma_f32_16x16x32_bf16 v[188:191], a[216:219], a[168:171], v[188:191]
 buffer_load_dwordx4 v6, s[8:11], s30 offen lds
 v_mfma_f32_16x16x32_bf16 v[188:191], a[220:223], a[172:175], v[188:191]
 v_mfma_f32_16x16x32_bf16 v[184:187], a[220:223], a[164:167], v[184:187]
 s_add_u32 m0, m0, 3072
 v_mfma_f32_16x16x32_bf16 v[184:187], a[216:219], a[160:163], v[184:187]
 v_mfma_f32_16x16x32_bf16 v[180:183], a[216:219], a[152:155], v[180:183]
 s_add_u32 s30, s30, s21
 v_mfma_f32_16x16x32_bf16 v[180:183], a[220:223], a[156:159], v[180:183]
 v_mfma_f32_16x16x32_bf16 v[176:179], a[220:223], a[148:151], v[176:179]
 v_mfma_f32_16x16x32_bf16 v[176:179], a[216:219], a[144:147], v[176:179]
 v_mfma_f32_16x16x32_bf16 v[172:175], a[216:219], a[136:139], v[172:175]
 v_mfma_f32_16x16x32_bf16 v[172:175], a[220:223], a[140:143], v[172:175]
 v_mfma_f32_16x16x32_bf16 v[168:171], a[220:223], a[132:135], v[168:171]
 v_mfma_f32_16x16x32_bf16 v[168:171], a[216:219], a[128:131], v[168:171]
 s_waitcnt vmcnt(8)
 v_mfma_f32_16x16x32_bf16 v[200:203], a[224:227], a[128:131], v[200:203]
 v_mfma_f32_16x16x32_bf16 v[200:203], a[228:231], a[132:135], v[200:203]
 global_load_dwordx4 a[220:223], v0, s[70:71] offset:1024 sc1
 s_waitcnt lgkmcnt(2)
 v_mfma_f32_16x16x32_bf16 v[204:207], a[228:231], a[140:143], v[204:207]
 v_mfma_f32_16x16x32_bf16 v[204:207], a[224:227], a[136:139], v[204:207]
 global_load_dwordx4 a[216:219], v0, s[70:71] offset:0 sc1
 v_mfma_f32_16x16x32_bf16 v[208:211], a[224:227], a[144:147], v[208:211]
 buffer_store_dwordx4 v[8:11], v1, s[12:15], s49 offen sc1
 s_waitcnt lgkmcnt(0)
 v_mfma_f32_16x16x32_bf16 v[208:211], a[228:231], a[148:151], v[208:211]
 buffer_store_dwordx4 v[12:15], v1, s[12:15], s49 offen offset:2048 sc1
 v_mfma_f32_16x16x32_bf16 v[212:215], a[228:231], a[156:159], v[212:215]
 v_mfma_f32_16x16x32_bf16 v[212:215], a[224:227], a[152:155], v[212:215]
 s_add_u32 s49, s49, 2097152
 v_mfma_f32_16x16x32_bf16 v[216:219], a[224:227], a[160:163], v[216:219]
 v_mfma_f32_16x16x32_bf16 v[216:219], a[228:231], a[164:167], v[216:219]
 v_mfma_f32_16x16x32_bf16 v[220:223], a[228:231], a[172:175], v[220:223]
 v_mfma_f32_16x16x32_bf16 v[220:223], a[224:227], a[168:171], v[220:223]
 v_mfma_f32_16x16x32_bf16 v[224:227], a[224:227], a[176:179], v[224:227]
 v_mfma_f32_16x16x32_bf16 v[224:227], a[228:231], a[180:183], v[224:227]
 v_mfma_f32_16x16x32_bf16 v[228:231], a[228:231], a[188:191], v[228:231]
 v_mfma_f32_16x16x32_bf16 v[228:231], a[224:227], a[184:187], v[228:231]
 s_waitcnt vmcnt(10)
 v_mfma_f32_16x16x32_bf16 a[252:255], a[192:195], a[184:187], a[252:255]
 ds_read_b128 a[184:187], v2 offset:61440
 v_mfma_f32_16x16x32_bf16 a[252:255], a[196:199], a[188:191], a[252:255]
 global_load_dwordx4 a[228:231], v0, s[70:71] offset:3072 sc1
 ds_read_b128 a[188:191], v2 offset:62464
 v_mfma_f32_16x16x32_bf16 a[248:251], a[196:199], a[180:183], a[248:251]
 ds_read_b128 a[180:183], v2 offset:58368
 v_mfma_f32_16x16x32_bf16 a[248:251], a[192:195], a[176:179], a[248:251]
 global_load_dwordx4 a[224:227], v0, s[70:71] offset:2048 sc1
 ds_read_b128 a[176:179], v2 offset:57344
 v_mfma_f32_16x16x32_bf16 v[252:255], a[192:195], a[168:171], v[252:255]
 s_add_u32 s70, s70, 8192
 s_addc_u32 s71, s71, 0
 ds_read_b128 a[168:171], v2 offset:53248
 v_mfma_f32_16x16x32_bf16 v[252:255], a[196:199], a[172:175], v[252:255]
 ds_read_b128 a[172:175], v2 offset:54272
 v_mfma_f32_16x16x32_bf16 v[248:251], a[196:199], a[164:167], v[248:251]
 ds_read_b128 a[164:167], v2 offset:50176
 v_mfma_f32_16x16x32_bf16 v[248:251], a[192:195], a[160:163], v[248:251]
 ds_read_b128 a[160:163], v2 offset:49152
 v_mfma_f32_16x16x32_bf16 v[244:247], a[192:195], a[152:155], v[244:247]
 ds_read_b128 a[152:155], v2 offset:45056
 v_mfma_f32_16x16x32_bf16 v[244:247], a[196:199], a[156:159], v[244:247]
 ds_read_b128 a[156:159], v2 offset:46080
 v_mfma_f32_16x16x32_bf16 v[240:243], a[196:199], a[148:151], v[240:243]
 ds_read_b128 a[148:151], v2 offset:41984
 v_mfma_f32_16x16x32_bf16 v[240:243], a[192:195], a[144:147], v[240:243]
 ds_read_b128 a[144:147], v2 offset:40960
 v_mfma_f32_16x16x32_bf16 v[236:239], a[192:195], a[136:139], v[236:239]
 ds_read_b128 a[136:139], v2 offset:36864
 v_mfma_f32_16x16x32_bf16 v[236:239], a[196:199], a[140:143], v[236:239]
 ds_read_b128 a[140:143], v2 offset:37888
 v_mfma_f32_16x16x32_bf16 v[232:235], a[196:199], a[132:135], v[232:235]
 ds_read_b128 a[132:135], v2 offset:33792
 v_mfma_f32_16x16x32_bf16 v[232:235], a[192:195], a[128:131], v[232:235]
 ds_read_b128 a[128:131], v2 offset:32768
 s_waitcnt vmcnt(10) lgkmcnt(8)
 v_mfma_f32_16x16x32_bf16 v[44:47], a[200:203], a[184:187], v[44:47]
 v_mfma_f32_16x16x32_bf16 v[44:47], a[204:207], a[188:191], v[44:47]
 global_load_dwordx4 a[196:199], v0, s[70:71] offset:-3072 sc1
 v_mfma_f32_16x16x32_bf16 v[40:43], a[204:207], a[180:183], v[40:43]
 v_mfma_f32_16x16x32_bf16 v[40:43], a[200:203], a[176:179], v[40:43]
 global_load_dwordx4 a[192:195], v0, s[70:71] offset:-4096 sc1
 v_mfma_f32_16x16x32_bf16 v[36:39], a[200:203], a[168:171], v[36:39]
 v_mfma_f32_16x16x32_bf16 v[36:39], a[204:207], a[172:175], v[36:39]
 v_mfma_f32_16x16x32_bf16 v[32:35], a[204:207], a[164:167], v[32:35]
 v_mfma_f32_16x16x32_bf16 v[32:35], a[200:203], a[160:163], v[32:35]
 buffer_load_dwordx4 v6, s[8:11], s30 offen lds
 s_waitcnt lgkmcnt(0)
 v_mfma_f32_16x16x32_bf16 v[28:31], a[200:203], a[152:155], v[28:31]
 v_mfma_f32_16x16x32_bf16 v[28:31], a[204:207], a[156:159], v[28:31]
 s_add_u32 m0, m0, 1024
 v_mfma_f32_16x16x32_bf16 v[24:27], a[204:207], a[148:151], v[24:27]
 s_add_u32 s30, s30, s20
 v_mfma_f32_16x16x32_bf16 v[24:27], a[200:203], a[144:147], v[24:27]
 v_mfma_f32_16x16x32_bf16 v[20:23], a[200:203], a[136:139], v[20:23]
 buffer_load_dwordx4 v6, s[8:11], s30 offen lds
 v_mfma_f32_16x16x32_bf16 v[20:23], a[204:207], a[140:143], v[20:23]
 s_add_u32 m0, m0, 3072
 v_mfma_f32_16x16x32_bf16 v[16:19], a[204:207], a[132:135], v[16:19]
 v_mfma_f32_16x16x32_bf16 v[16:19], a[200:203], a[128:131], v[16:19]
 s_add_u32 s30, s30, s22
 s_waitcnt vmcnt(11)
 v_mfma_f32_16x16x32_bf16 v[48:51], a[208:211], a[128:131], v[48:51]
 v_mfma_f32_16x16x32_bf16 v[48:51], a[212:215], a[132:135], v[48:51]
 global_load_dwordx4 a[204:207], v0, s[70:71] offset:-1024 sc1
 v_mfma_f32_16x16x32_bf16 v[52:55], a[212:215], a[140:143], v[52:55]
 v_mfma_f32_16x16x32_bf16 v[52:55], a[208:211], a[136:139], v[52:55]
 global_load_dwordx4 a[200:203], v0, s[70:71] offset:-2048 sc1
 v_mfma_f32_16x16x32_bf16 v[56:59], a[208:211], a[144:147], v[56:59]
 v_mfma_f32_16x16x32_bf16 v[56:59], a[212:215], a[148:151], v[56:59]
 v_mfma_f32_16x16x32_bf16 v[60:63], a[212:215], a[156:159], v[60:63]
 v_mfma_f32_16x16x32_bf16 v[60:63], a[208:211], a[152:155], v[60:63]
 v_mfma_f32_16x16x32_bf16 v[64:67], a[208:211], a[160:163], v[64:67]
 v_mfma_f32_16x16x32_bf16 v[64:67], a[212:215], a[164:167], v[64:67]
 v_mfma_f32_16x16x32_bf16 v[68:71], a[212:215], a[172:175], v[68:71]
 v_mfma_f32_16x16x32_bf16 v[68:71], a[208:211], a[168:171], v[68:71]
 v_mfma_f32_16x16x32_bf16 v[72:75], a[208:211], a[176:179], v[72:75]
 v_mfma_f32_16x16x32_bf16 v[72:75], a[212:215], a[180:183], v[72:75]
 v_mfma_f32_16x16x32_bf16 v[76:79], a[212:215], a[188:191], v[76:79]
 v_mfma_f32_16x16x32_bf16 v[76:79], a[208:211], a[184:187], v[76:79]
 s_waitcnt vmcnt(10)
 v_mfma_f32_16x16x32_bf16 v[108:111], a[216:219], a[184:187], v[108:111]
 v_mfma_f32_16x16x32_bf16 v[108:111], a[220:223], a[188:191], v[108:111]
 global_load_dwordx4 a[212:215], v0, s[70:71] offset:1024 sc1
 v_mfma_f32_16x16x32_bf16 v[104:107], a[220:223], a[180:183], v[104:107]
 v_mfma_f32_16x16x32_bf16 v[104:107], a[216:219], a[176:179], v[104:107]
 global_load_dwordx4 a[208:211], v0, s[70:71] offset:0 sc1
 v_mfma_f32_16x16x32_bf16 v[100:103], a[216:219], a[168:171], v[100:103]
 v_mfma_f32_16x16x32_bf16 v[100:103], a[220:223], a[172:175], v[100:103]
 v_mfma_f32_16x16x32_bf16 v[96:99], a[220:223], a[164:167], v[96:99]
 v_mfma_f32_16x16x32_bf16 v[96:99], a[216:219], a[160:163], v[96:99]
 v_mfma_f32_16x16x32_bf16 v[92:95], a[216:219], a[152:155], v[92:95]
 v_mfma_f32_16x16x32_bf16 v[92:95], a[220:223], a[156:159], v[92:95]
 v_mfma_f32_16x16x32_bf16 v[88:91], a[220:223], a[148:151], v[88:91]
 v_mfma_f32_16x16x32_bf16 v[88:91], a[216:219], a[144:147], v[88:91]
 v_mfma_f32_16x16x32_bf16 v[84:87], a[216:219], a[136:139], v[84:87]
 v_mfma_f32_16x16x32_bf16 v[84:87], a[220:223], a[140:143], v[84:87]
 v_mfma_f32_16x16x32_bf16 v[80:83], a[220:223], a[132:135], v[80:83]
 v_mfma_f32_16x16x32_bf16 v[80:83], a[216:219], a[128:131], v[80:83]
 s_waitcnt vmcnt(8)
 v_mfma_f32_16x16x32_bf16 v[112:115], a[224:227], a[128:131], v[112:115]
 v_mfma_f32_16x16x32_bf16 v[112:115], a[228:231], a[132:135], v[112:115]
 global_load_dwordx4 a[220:223], v0, s[70:71] offset:3072 sc1
 v_mfma_f32_16x16x32_bf16 v[116:119], a[228:231], a[140:143], v[116:119]
 v_mfma_f32_16x16x32_bf16 v[116:119], a[224:227], a[136:139], v[116:119]
 global_load_dwordx4 a[216:219], v0, s[70:71] offset:2048 sc1
 v_mfma_f32_16x16x32_bf16 v[120:123], a[224:227], a[144:147], v[120:123]
 s_add_u32 s70, s70, 8192
 s_addc_u32 s71, s71, 0
 v_mfma_f32_16x16x32_bf16 v[120:123], a[228:231], a[148:151], v[120:123]
 v_mfma_f32_16x16x32_bf16 v[124:127], a[228:231], a[156:159], v[124:127]
 v_mfma_f32_16x16x32_bf16 v[124:127], a[224:227], a[152:155], v[124:127]
 v_mfma_f32_16x16x32_bf16 v[128:131], a[224:227], a[160:163], v[128:131]
 v_mfma_f32_16x16x32_bf16 v[128:131], a[228:231], a[164:167], v[128:131]
 v_mfma_f32_16x16x32_bf16 v[132:135], a[228:231], a[172:175], v[132:135]
 v_mfma_f32_16x16x32_bf16 v[132:135], a[224:227], a[168:171], v[132:135]
 v_mfma_f32_16x16x32_bf16 a[240:243], a[224:227], a[176:179], a[240:243]
 v_mfma_f32_16x16x32_bf16 a[240:243], a[228:231], a[180:183], a[240:243]
 v_mfma_f32_16x16x32_bf16 a[244:247], a[228:231], a[188:191], a[244:247]
 v_mfma_f32_16x16x32_bf16 a[244:247], a[224:227], a[184:187], a[244:247]
 s_waitcnt vmcnt(8)
 v_mfma_f32_16x16x32_bf16 v[164:167], a[192:195], a[184:187], v[164:167]
 v_mfma_f32_16x16x32_bf16 v[164:167], a[196:199], a[188:191], v[164:167]
 global_load_dwordx4 a[228:231], v0, s[70:71] offset:-3072 sc1
 v_mfma_f32_16x16x32_bf16 v[160:163], a[196:199], a[180:183], v[160:163]
 v_mfma_f32_16x16x32_bf16 v[160:163], a[192:195], a[176:179], v[160:163]
 global_load_dwordx4 a[224:227], v0, s[70:71] offset:-4096 sc1
 v_mfma_f32_16x16x32_bf16 v[156:159], a[192:195], a[168:171], v[156:159]
 v_mfma_f32_16x16x32_bf16 v[156:159], a[196:199], a[172:175], v[156:159]
 global_load_dwordx4 a[236:239], v0, s[70:71] offset:-1024 sc1
 v_mfma_f32_16x16x32_bf16 v[152:155], a[196:199], a[164:167], v[152:155]
 v_mfma_f32_16x16x32_bf16 v[152:155], a[192:195], a[160:163], v[152:155]
 global_load_dwordx4 a[232:235], v0, s[70:71] offset:-2048 sc1
 v_mfma_f32_16x16x32_bf16 v[148:151], a[192:195], a[152:155], v[148:151]
 v_mfma_f32_16x16x32_bf16 v[148:151], a[196:199], a[156:159], v[148:151]
 v_mfma_f32_16x16x32_bf16 v[144:147], a[196:199], a[148:151], v[144:147]
 v_mfma_f32_16x16x32_bf16 v[144:147], a[192:195], a[144:147], v[144:147]
 v_mfma_f32_16x16x32_bf16 v[140:143], a[192:195], a[136:139], v[140:143]
 v_mfma_f32_16x16x32_bf16 v[140:143], a[196:199], a[140:143], v[140:143]
 v_mfma_f32_16x16x32_bf16 v[136:139], a[196:199], a[132:135], v[136:139]
 v_mfma_f32_16x16x32_bf16 v[136:139], a[192:195], a[128:131], v[136:139]
 s_waitcnt vmcnt(8)
 v_mfma_f32_16x16x32_bf16 v[168:171], a[200:203], a[128:131], v[168:171]
 v_mfma_f32_16x16x32_bf16 v[168:171], a[204:207], a[132:135], v[168:171]
 global_load_dwordx4 a[196:199], v0, s[70:71] offset:1024 sc1
 v_mfma_f32_16x16x32_bf16 v[172:175], a[204:207], a[140:143], v[172:175]
 v_mfma_f32_16x16x32_bf16 v[172:175], a[200:203], a[136:139], v[172:175]
 global_load_dwordx4 a[192:195], v0, s[70:71] offset:0 sc1
 v_mfma_f32_16x16x32_bf16 v[176:179], a[200:203], a[144:147], v[176:179]
 v_mfma_f32_16x16x32_bf16 v[176:179], a[204:207], a[148:151], v[176:179]
 v_mfma_f32_16x16x32_bf16 v[180:183], a[204:207], a[156:159], v[180:183]
 v_mfma_f32_16x16x32_bf16 v[180:183], a[200:203], a[152:155], v[180:183]
 v_mfma_f32_16x16x32_bf16 v[184:187], a[200:203], a[160:163], v[184:187]
 v_mfma_f32_16x16x32_bf16 v[184:187], a[204:207], a[164:167], v[184:187]
 v_mfma_f32_16x16x32_bf16 v[188:191], a[204:207], a[172:175], v[188:191]
 v_mfma_f32_16x16x32_bf16 v[188:191], a[200:203], a[168:171], v[188:191]
 v_mfma_f32_16x16x32_bf16 v[192:195], a[200:203], a[176:179], v[192:195]
 v_mfma_f32_16x16x32_bf16 v[192:195], a[204:207], a[180:183], v[192:195]
 v_mfma_f32_16x16x32_bf16 v[196:199], a[204:207], a[188:191], v[196:199]
 v_mfma_f32_16x16x32_bf16 v[196:199], a[200:203], a[184:187], v[196:199]
 s_waitcnt vmcnt(8)
 v_mfma_f32_16x16x32_bf16 v[228:231], a[208:211], a[184:187], v[228:231]
 v_mfma_f32_16x16x32_bf16 v[228:231], a[212:215], a[188:191], v[228:231]
 global_load_dwordx4 a[204:207], v0, s[70:71] offset:3072 sc1
 v_mfma_f32_16x16x32_bf16 v[224:227], a[212:215], a[180:183], v[224:227]
 v_mfma_f32_16x16x32_bf16 v[224:227], a[208:211], a[176:179], v[224:227]
 global_load_dwordx4 a[200:203], v0, s[70:71] offset:2048 sc1
 v_mfma_f32_16x16x32_bf16 v[220:223], a[208:211], a[168:171], v[220:223]
 s_add_u32 s70, s70, 8192
 s_addc_u32 s71, s71, 0
 v_mfma_f32_16x16x32_bf16 v[220:223], a[212:215], a[172:175], v[220:223]
 v_mfma_f32_16x16x32_bf16 v[216:219], a[212:215], a[164:167], v[216:219]
 v_mfma_f32_16x16x32_bf16 v[216:219], a[208:211], a[160:163], v[216:219]
 v_mfma_f32_16x16x32_bf16 v[212:215], a[208:211], a[152:155], v[212:215]
 v_mfma_f32_16x16x32_bf16 v[212:215], a[212:215], a[156:159], v[212:215]
 v_mfma_f32_16x16x32_bf16 v[208:211], a[212:215], a[148:151], v[208:211]
 s_waitcnt lgkmcnt(0)
 s_barrier
 v_mfma_f32_16x16x32_bf16 v[208:211], a[208:211], a[144:147], v[208:211]
 v_mfma_f32_16x16x32_bf16 v[204:207], a[208:211], a[136:139], v[204:207]
 v_mfma_f32_16x16x32_bf16 v[204:207], a[212:215], a[140:143], v[204:207]
 v_mfma_f32_16x16x32_bf16 v[200:203], a[212:215], a[132:135], v[200:203]
 v_mfma_f32_16x16x32_bf16 v[200:203], a[208:211], a[128:131], v[200:203]
 s_waitcnt vmcnt(8)
 v_mfma_f32_16x16x32_bf16 v[232:235], a[216:219], a[128:131], v[232:235]
 ds_read_b128 a[128:131], v1 offset:2048
 v_mfma_f32_16x16x32_bf16 v[232:235], a[220:223], a[132:135], v[232:235]
 global_load_dwordx4 a[212:215], v0, s[70:71] offset:-3072 sc1
 ds_read_b128 a[132:135], v1 offset:3072
 v_mfma_f32_16x16x32_bf16 v[236:239], a[220:223], a[140:143], v[236:239]
 ds_read_b128 a[140:143], v1 offset:7168
 v_mfma_f32_16x16x32_bf16 v[236:239], a[216:219], a[136:139], v[236:239]
 global_load_dwordx4 a[208:211], v0, s[70:71] offset:-4096 sc1
 ds_read_b128 a[136:139], v1 offset:6144
 v_mfma_f32_16x16x32_bf16 v[240:243], a[216:219], a[144:147], v[240:243]
 ds_read_b128 a[144:147], v1 offset:10240
 v_mfma_f32_16x16x32_bf16 v[240:243], a[220:223], a[148:151], v[240:243]
 ds_read_b128 a[148:151], v1 offset:11264
 v_mfma_f32_16x16x32_bf16 v[244:247], a[220:223], a[156:159], v[244:247]
 ds_read_b128 a[156:159], v1 offset:15360
 v_mfma_f32_16x16x32_bf16 v[244:247], a[216:219], a[152:155], v[244:247]
 ds_read_b128 a[152:155], v1 offset:14336
 v_mfma_f32_16x16x32_bf16 v[248:251], a[216:219], a[160:163], v[248:251]
 ds_read_b128 a[160:163], v1 offset:18432
 v_mfma_f32_16x16x32_bf16 v[248:251], a[220:223], a[164:167], v[248:251]
 ds_read_b128 a[164:167], v1 offset:19456
 v_mfma_f32_16x16x32_bf16 v[252:255], a[220:223], a[172:175], v[252:255]
 ds_read_b128 a[172:175], v1 offset:23552
 v_mfma_f32_16x16x32_bf16 v[252:255], a[216:219], a[168:171], v[252:255]
 ds_read_b128 a[168:171], v1 offset:22528
 v_mfma_f32_16x16x32_bf16 a[248:251], a[216:219], a[176:179], a[248:251]
 ds_read_b128 a[176:179], v1 offset:26624
 v_mfma_f32_16x16x32_bf16 a[248:251], a[220:223], a[180:183], a[248:251]
 ds_read_b128 a[180:183], v1 offset:27648
 v_mfma_f32_16x16x32_bf16 a[252:255], a[220:223], a[188:191], a[252:255]
 global_load_dwordx4 a[220:223], v0, s[70:71] offset:-1024 sc1
 ds_read_b128 a[188:191], v1 offset:31744
 v_mfma_f32_16x16x32_bf16 a[252:255], a[216:219], a[184:187], a[252:255]
 global_load_dwordx4 a[216:219], v0, s[70:71] offset:-2048 sc1
 ds_read_b128 a[184:187], v1 offset:30720
 s_waitcnt vmcnt(10) lgkmcnt(8)
 v_mfma_f32_16x16x32_bf16 v[16:19], a[224:227], a[128:131], v[16:19]
 v_mov_b32 v7, 1
 v_mfma_f32_16x16x32_bf16 v[16:19], a[228:231], a[132:135], v[16:19]
 v_mfma_f32_16x16x32_bf16 v[20:23], a[228:231], a[140:143], v[20:23]
 buffer_atomic_add v7, v0, s[56:59], 0 offen sc1
 v_mfma_f32_16x16x32_bf16 v[20:23], a[224:227], a[136:139], v[20:23]
 v_lshrrev_b32 v4, 8, v1
 v_mfma_f32_16x16x32_bf16 v[24:27], a[224:227], a[144:147], v[24:27]
 v_mfma_f32_16x16x32_bf16 v[24:27], a[228:231], a[148:151], v[24:27]
 v_lshl_add_u32 v4, v4, 5, s51
 v_mfma_f32_16x16x32_bf16 v[28:31], a[228:231], a[156:159], v[28:31]
 ds_read_b128 v[8:11], v4 offset:256
 v_mfma_f32_16x16x32_bf16 v[28:31], a[224:227], a[152:155], v[28:31]
 s_waitcnt lgkmcnt(1)
 v_mfma_f32_16x16x32_bf16 v[32:35], a[224:227], a[160:163], v[32:35]
 v_mfma_f32_16x16x32_bf16 v[32:35], a[228:231], a[164:167], v[32:35]
 v_mfma_f32_16x16x32_bf16 v[36:39], a[228:231], a[172:175], v[36:39]
 v_mfma_f32_16x16x32_bf16 v[36:39], a[224:227], a[168:171], v[36:39]
 v_mfma_f32_16x16x32_bf16 v[40:43], a[224:227], a[176:179], v[40:43]
 v_mfma_f32_16x16x32_bf16 v[40:43], a[228:231], a[180:183], v[40:43]
 v_mfma_f32_16x16x32_bf16 v[44:47], a[228:231], a[188:191], v[44:47]
 v_mfma_f32_16x16x32_bf16 v[44:47], a[224:227], a[184:187], v[44:47]
 s_waitcnt vmcnt(9)
 v_mfma_f32_16x16x32_bf16 v[76:79], a[232:235], a[184:187], v[76:79]
 v_mfma_f32_16x16x32_bf16 v[76:79], a[236:239], a[188:191], v[76:79]
 global_load_dwordx4 a[228:231], v0, s[70:71] offset:1024 sc1
 v_mfma_f32_16x16x32_bf16 v[72:75], a[236:239], a[180:183], v[72:75]
 v_mfma_f32_16x16x32_bf16 v[72:75], a[232:235], a[176:179], v[72:75]
 global_load_dwordx4 a[224:227], v0, s[70:71] offset:0 sc1
 v_mfma_f32_16x16x32_bf16 v[68:71], a[232:235], a[168:171], v[68:71]
 s_waitcnt lgkmcnt(0)
 v_mfma_f32_16x16x32_bf16 v[68:71], a[236:239], a[172:175], v[68:71]
 v_mfma_f32_16x16x32_bf16 v[64:67], a[236:239], a[164:167], v[64:67]
 v_add_f32 v136, v136, v8
 v_mfma_f32_16x16x32_bf16 v[64:67], a[232:235], a[160:163], v[64:67]
 v_mfma_f32_16x16x32_bf16 v[60:63], a[232:235], a[152:155], v[60:63]
 ds_read_b128 v[12:15], v4 offset:272
 v_mfma_f32_16x16x32_bf16 v[60:63], a[236:239], a[156:159], v[60:63]
 v_add_f32 v137, v137, v9
 v_mfma_f32_16x16x32_bf16 v[56:59], a[236:239], a[148:151], v[56:59]
 v_mfma_f32_16x16x32_bf16 v[56:59], a[232:235], a[144:147], v[56:59]
 v_add_f32 v138, v138, v10
 v_mfma_f32_16x16x32_bf16 v[52:55], a[232:235], a[136:139], v[52:55]
 v_add_f32 v139, v139, v11
 v_mfma_f32_16x16x32_bf16 v[52:55], a[236:239], a[140:143], v[52:55]
 v_mfma_f32_16x16x32_bf16 v[48:51], a[236:239], a[132:135], v[48:51]
 v_add_f32 v140, v140, v8
 v_mfma_f32_16x16x32_bf16 v[48:51], a[232:235], a[128:131], v[48:51]
 v_add_f32 v141, v141, v9
 s_waitcnt vmcnt(9)
 v_mfma_f32_16x16x32_bf16 v[80:83], a[192:195], a[128:131], v[80:83]
 v_mfma_f32_16x16x32_bf16 v[80:83], a[196:199], a[132:135], v[80:83]
 global_load_dwordx4 a[236:239], v0, s[70:71] offset:3072 sc1
 v_add_f32 v142, v142, v10
 v_mfma_f32_16x16x32_bf16 v[84:87], a[196:199], a[140:143], v[84:87]
 v_add_f32 v143, v143, v11
 v_mfma_f32_16x16x32_bf16 v[84:87], a[192:195], a[136:139], v[84:87]
 global_load_dwordx4 a[232:235], v0, s[70:71] offset:2048 sc1
 v_mfma_f32_16x16x32_bf16 v[88:91], a[192:195], a[144:147], v[88:91]
 v_add_f32 v144, v144, v8
 s_add_u32 s70, s70, 8192
 s_addc_u32 s71, s71, 0
 v_mfma_f32_16x16x32_bf16 v[88:91], a[196:199], a[148:151], v[88:91]
 v_mfma_f32_16x16x32_bf16 v[92:95], a[196:199], a[156:159], v[92:95]
 v_add_f32 v145, v145, v9
 v_mfma_f32_16x16x32_bf16 v[92:95], a[192:195], a[152:155], v[92:95]
 v_add_f32 v146, v146, v10
 v_mfma_f32_16x16x32_bf16 v[96:99], a[192:195], a[160:163], v[96:99]
 v_mfma_f32_16x16x32_bf16 v[96:99], a[196:199], a[164:167], v[96:99]
 v_add_f32 v147, v147, v11
 v_mfma_f32_16x16x32_bf16 v[100:103], a[196:199], a[172:175], v[100:103]
 v_add_f32 v148, v148, v8
 v_mfma_f32_16x16x32_bf16 v[100:103], a[192:195], a[168:171], v[100:103]
 v_mfma_f32_16x16x32_bf16 v[104:107], a[192:195], a[176:179], v[104:107]
 v_add_f32 v149, v149, v9
 v_mfma_f32_16x16x32_bf16 v[104:107], a[196:199], a[180:183], v[104:107]
 v_add_f32 v150, v150, v10
 v_mfma_f32_16x16x32_bf16 v[108:111], a[196:199], a[188:191], v[108:111]
 v_mfma_f32_16x16x32_bf16 v[108:111], a[192:195], a[184:187], v[108:111]
 v_add_f32 v151, v151, v11
 s_waitcnt vmcnt(9)
 v_mfma_f32_16x16x32_bf16 a[244:247], a[200:203], a[184:187], a[244:247]
 ds_read_b128 a[184:187], v1 offset:63488
 v_add_f32 v152, v152, v8
 v_mfma_f32_16x16x32_bf16 a[244:247], a[204:207], a[188:191], a[244:247]
 global_load_dwordx4 a[196:199], v0, s[70:71] offset:-3072 sc1
 ds_read_b128 a[188:191], v1 offset:64512
 v_mfma_f32_16x16x32_bf16 a[240:243], a[204:207], a[180:183], a[240:243]
 ds_read_b128 a[180:183], v1 offset:60416
 v_add_f32 v153, v153, v9
 v_mfma_f32_16x16x32_bf16 a[240:243], a[200:203], a[176:179], a[240:243]
 global_load_dwordx4 a[192:195], v0, s[70:71] offset:-4096 sc1
 ds_read_b128 a[176:179], v1 offset:59392
 v_mfma_f32_16x16x32_bf16 v[132:135], a[200:203], a[168:171], v[132:135]
 ds_read_b128 a[168:171], v1 offset:55296
 v_add_f32 v154, v154, v10
 v_mfma_f32_16x16x32_bf16 v[132:135], a[204:207], a[172:175], v[132:135]
 ds_read_b128 a[172:175], v1 offset:56320
 v_add_f32 v155, v155, v11
 v_mfma_f32_16x16x32_bf16 v[128:131], a[204:207], a[164:167], v[128:131]
 ds_read_b128 a[164:167], v1 offset:52224
 v_mfma_f32_16x16x32_bf16 v[128:131], a[200:203], a[160:163], v[128:131]
 ds_read_b128 a[160:163], v1 offset:51200
 v_add_f32 v156, v156, v8
 v_mfma_f32_16x16x32_bf16 v[124:127], a[200:203], a[152:155], v[124:127]
 ds_read_b128 a[152:155], v1 offset:47104
 v_add_f32 v157, v157, v9
 v_mfma_f32_16x16x32_bf16 v[124:127], a[204:207], a[156:159], v[124:127]
 ds_read_b128 a[156:159], v1 offset:48128
 v_mfma_f32_16x16x32_bf16 v[120:123], a[204:207], a[148:151], v[120:123]
 ds_read_b128 a[148:151], v1 offset:44032
 v_add_f32 v158, v158, v10
 v_mfma_f32_16x16x32_bf16 v[120:123], a[200:203], a[144:147], v[120:123]
 ds_read_b128 a[144:147], v1 offset:43008
 v_add_f32 v159, v159, v11
 v_mfma_f32_16x16x32_bf16 v[116:119], a[200:203], a[136:139], v[116:119]
 ds_read_b128 a[136:139], v1 offset:38912
 v_mfma_f32_16x16x32_bf16 v[116:119], a[204:207], a[140:143], v[116:119]
 ds_read_b128 a[140:143], v1 offset:39936
 v_add_f32 v160, v160, v8
 v_mfma_f32_16x16x32_bf16 v[112:115], a[204:207], a[132:135], v[112:115]
 ds_read_b128 a[132:135], v1 offset:35840
 v_add_f32 v161, v161, v9
 v_mfma_f32_16x16x32_bf16 v[112:115], a[200:203], a[128:131], v[112:115]
 ds_read_b128 a[128:131], v1 offset:34816
 s_waitcnt vmcnt(9) lgkmcnt(8)
 v_mfma_f32_16x16x32_bf16 v[44:47], a[208:211], a[184:187], v[44:47]
 v_add_f32 v162, v162, v10
 v_mfma_f32_16x16x32_bf16 v[44:47], a[212:215], a[188:191], v[44:47]
 global_load_dwordx4 a[204:207], v0, s[70:71] offset:-1024 sc1
 v_mfma_f32_16x16x32_bf16 v[40:43], a[212:215], a[180:183], v[40:43]
 v_add_f32 v163, v163, v11
 v_mfma_f32_16x16x32_bf16 v[40:43], a[208:211], a[176:179], v[40:43]
 global_load_dwordx4 a[200:203], v0, s[70:71] offset:-2048 sc1
 v_add_f32 v164, v164, v8
 v_mfma_f32_16x16x32_bf16 v[36:39], a[208:211], a[168:171], v[36:39]
 v_mfma_f32_16x16x32_bf16 v[36:39], a[212:215], a[172:175], v[36:39]
 v_add_f32 v165, v165, v9
 v_mfma_f32_16x16x32_bf16 v[32:35], a[212:215], a[164:167], v[32:35]
 v_add_f32 v166, v166, v10
 v_mfma_f32_16x16x32_bf16 v[32:35], a[208:211], a[160:163], v[32:35]
 s_waitcnt lgkmcnt(0)
 v_mfma_f32_16x16x32_bf16 v[28:31], a[208:211], a[152:155], v[28:31]
 v_add_f32 v167, v167, v11
 v_mfma_f32_16x16x32_bf16 v[28:31], a[212:215], a[156:159], v[28:31]
 v_mfma_f32_16x16x32_bf16 v[24:27], a[212:215], a[148:151], v[24:27]
 v_mfma_f32_16x16x32_bf16 v[24:27], a[208:211], a[144:147], v[24:27]
 v_add_f32 v168, v168, v12
 v_mfma_f32_16x16x32_bf16 v[20:23], a[208:211], a[136:139], v[20:23]
 ds_read_b128 v[8:11], v4 offset:384
 v_mfma_f32_16x16x32_bf16 v[20:23], a[212:215], a[140:143], v[20:23]
 v_mfma_f32_16x16x32_bf16 v[16:19], a[212:215], a[132:135], v[16:19]
 v_add_f32 v169, v169, v13
 v_mfma_f32_16x16x32_bf16 v[16:19], a[208:211], a[128:131], v[16:19]
 s_waitcnt vmcnt(9)
 v_mfma_f32_16x16x32_bf16 v[48:51], a[216:219], a[128:131], v[48:51]
 v_add_f32 v170, v170, v14
 v_mfma_f32_16x16x32_bf16 v[48:51], a[220:223], a[132:135], v[48:51]
 global_load_dwordx4 a[212:215], v0, s[70:71] offset:1024 sc1
 v_add_f32 v171, v171, v15
 v_mfma_f32_16x16x32_bf16 v[52:55], a[220:223], a[140:143], v[52:55]
 v_mfma_f32_16x16x32_bf16 v[52:55], a[216:219], a[136:139], v[52:55]
 global_load_dwordx4 a[208:211], v0, s[70:71] offset:0 sc1
 v_add_f32 v172, v172, v12
 v_mfma_f32_16x16x32_bf16 v[56:59], a[216:219], a[144:147], v[56:59]
 v_add_f32 v173, v173, v13
 v_mfma_f32_16x16x32_bf16 v[56:59], a[220:223], a[148:151], v[56:59]
 v_mfma_f32_16x16x32_bf16 v[60:63], a[220:223], a[156:159], v[60:63]
 v_add_f32 v174, v174, v14
 v_mfma_f32_16x16x32_bf16 v[60:63], a[216:219], a[152:155], v[60:63]
 v_add_f32 v175, v175, v15
 v_mfma_f32_16x16x32_bf16 v[64:67], a[216:219], a[160:163], v[64:67]
 v_mfma_f32_16x16x32_bf16 v[64:67], a[220:223], a[164:167], v[64:67]
 v_add_f32 v176, v176, v12
 v_mfma_f32_16x16x32_bf16 v[68:71], a[220:223], a[172:175], v[68:71]
 v_add_f32 v177, v177, v13
 v_mfma_f32_16x16x32_bf16 v[68:71], a[216:219], a[168:171], v[68:71]
 v_mfma_f32_16x16x32_bf16 v[72:75], a[216:219], a[176:179], v[72:75]
 v_add_f32 v178, v178, v14
 v_mfma_f32_16x16x32_bf16 v[72:75], a[220:223], a[180:183], v[72:75]
 v_mfma_f32_16x16x32_bf16 v[76:79], a[220:223], a[188:191], v[76:79]
 v_add_f32 v179, v179, v15
 v_mfma_f32_16x16x32_bf16 v[76:79], a[216:219], a[184:187], v[76:79]
 v_add_f32 v180, v180, v12
 s_waitcnt vmcnt(8)
 v_mfma_f32_16x16x32_bf16 v[108:111], a[224:227], a[184:187], v[108:111]
 v_mfma_f32_16x16x32_bf16 v[108:111], a[228:231], a[188:191], v[108:111]
 global_load_dwordx4 a[220:223], v0, s[70:71] offset:3072 sc1
 v_add_f32 v181, v181, v13
 v_mfma_f32_16x16x32_bf16 v[104:107], a[228:231], a[180:183], v[104:107]
 v_add_f32 v182, v182, v14
 v_mfma_f32_16x16x32_bf16 v[104:107], a[224:227], a[176:179], v[104:107]
 global_load_dwordx4 a[216:219], v0, s[70:71] offset:2048 sc1
 v_mfma_f32_16x16x32_bf16 v[100:103], a[224:227], a[168:171], v[100:103]
 v_add_f32 v183, v183, v15
 s_add_u32 s70, s70, 8192
 s_addc_u32 s71, s71, 0
 v_mfma_f32_16x16x32_bf16 v[100:103], a[228:231], a[172:175], v[100:103]
 v_add_f32 v184, v184, v12
 v_mfma_f32_16x16x32_bf16 v[96:99], a[228:231], a[164:167], v[96:99]
 v_mfma_f32_16x16x32_bf16 v[96:99], a[224:227], a[160:163], v[96:99]
 v_add_f32 v185, v185, v13
 v_mfma_f32_16x16x32_bf16 v[92:95], a[224:227], a[152:155], v[92:95]
 v_add_f32 v186, v186, v14
 v_mfma_f32_16x16x32_bf16 v[92:95], a[228:231], a[156:159], v[92:95]
 v_mfma_f32_16x16x32_bf16 v[88:91], a[228:231], a[148:151], v[88:91]
 v_add_f32 v187, v187, v15
 v_mfma_f32_16x16x32_bf16 v[88:91], a[224:227], a[144:147], v[88:91]
 v_mfma_f32_16x16x32_bf16 v[84:87], a[224:227], a[136:139], v[84:87]
 v_add_f32 v188, v188, v12
 v_mfma_f32_16x16x32_bf16 v[84:87], a[228:231], a[140:143], v[84:87]
 v_add_f32 v189, v189, v13
 v_mfma_f32_16x16x32_bf16 v[80:83], a[228:231], a[132:135], v[80:83]
 v_mfma_f32_16x16x32_bf16 v[80:83], a[224:227], a[128:131], v[80:83]
 v_add_f32 v190, v190, v14
 s_waitcnt vmcnt(8)
 v_mfma_f32_16x16x32_bf16 v[112:115], a[232:235], a[128:131], v[112:115]
 ds_read_b128 a[128:131], v2 offset:2048
 v_add_f32 v191, v191, v15
 v_mfma_f32_16x16x32_bf16 v[112:115], a[236:239], a[132:135], v[112:115]
 global_load_dwordx4 a[228:231], v0, s[70:71] offset:-3072 sc1
 ds_read_b128 a[132:135], v2 offset:3072
 v_mfma_f32_16x16x32_bf16 v[116:119], a[236:239], a[140:143], v[116:119]
 ds_read_b128 a[140:143], v2 offset:7168
 v_add_f32 v192, v192, v12
 v_mfma_f32_16x16x32_bf16 v[116:119], a[232:235], a[136:139], v[116:119]
 global_load_dwordx4 a[224:227], v0, s[70:71] offset:-4096 sc1
 ds_read_b128 a[136:139], v2 offset:6144
 v_mfma_f32_16x16x32_bf16 v[120:123], a[232:235], a[144:147], v[120:123]
 ds_read_b128 a[144:147], v2 offset:10240
 v_add_f32 v193, v193, v13
 v_mfma_f32_16x16x32_bf16 v[120:123], a[236:239], a[148:151], v[120:123]
 ds_read_b128 a[148:151], v2 offset:11264
 v_add_f32 v194, v194, v14
 v_mfma_f32_16x16x32_bf16 v[124:127], a[236:239], a[156:159], v[124:127]
 ds_read_b128 a[156:159], v2 offset:15360
 v_add_f32 v195, v195, v15
 v_mfma_f32_16x16x32_bf16 v[124:127], a[232:235], a[152:155], v[124:127]
 ds_read_b128 a[152:155], v2 offset:14336
 v_mfma_f32_16x16x32_bf16 v[128:131], a[232:235], a[160:163], v[128:131]
 ds_read_b128 a[160:163], v2 offset:18432
 v_add_f32 v196, v196, v12
 v_mfma_f32_16x16x32_bf16 v[128:131], a[236:239], a[164:167], v[128:131]
 ds_read_b128 a[164:167], v2 offset:19456
 v_mfma_f32_16x16x32_bf16 v[132:135], a[236:239], a[172:175], v[132:135]
 ds_read_b128 a[172:175], v2 offset:23552
 v_add_f32 v197, v197, v13
 v_mfma_f32_16x16x32_bf16 v[132:135], a[232:235], a[168:171], v[132:135]
 ds_read_b128 a[168:171], v2 offset:22528
 v_add_f32 v198, v198, v14
 v_mfma_f32_16x16x32_bf16 a[240:243], a[232:235], a[176:179], a[240:243]
 ds_read_b128 a[176:179], v2 offset:26624
 v_mfma_f32_16x16x32_bf16 a[240:243], a[236:239], a[180:183], a[240:243]
 ds_read_b128 a[180:183], v2 offset:27648
 v_add_f32 v199, v199, v15
 v_mfma_f32_16x16x32_bf16 a[244:247], a[236:239], a[188:191], a[244:247]
 ds_read_b128 a[188:191], v2 offset:31744
 s_waitcnt lgkmcnt(15)
 v_mfma_f32_16x16x32_bf16 a[244:247], a[232:235], a[184:187], a[244:247]
 ds_read_b128 a[184:187], v2 offset:30720
 s_waitcnt vmcnt(8) lgkmcnt(8)
 v_mfma_f32_16x16x32_bf16 v[16:19], a[192:195], a[128:131], v[16:19]
 v_add_f32 v200, v200, v8
 v_mfma_f32_16x16x32_bf16 v[16:19], a[196:199], a[132:135], v[16:19]
 global_load_dwordx4 a[236:239], v0, s[70:71] offset:-1024 sc1
 ds_read_b128 v[12:15], v4 offset:400
 v_mfma_f32_16x16x32_bf16 v[20:23], a[196:199], a[140:143], v[20:23]
 v_mfma_f32_16x16x32_bf16 v[20:23], a[192:195], a[136:139], v[20:23]
 global_load_dwordx4 a[232:235], v0, s[70:71] offset:-2048 sc1
 v_add_f32 v201, v201, v9
 v_mfma_f32_16x16x32_bf16 v[24:27], a[192:195], a[144:147], v[24:27]
 v_add_f32 v202, v202, v10
 v_mfma_f32_16x16x32_bf16 v[24:27], a[196:199], a[148:151], v[24:27]
 v_mfma_f32_16x16x32_bf16 v[28:31], a[196:199], a[156:159], v[28:31]
 v_add_f32 v203, v203, v11
 v_mfma_f32_16x16x32_bf16 v[28:31], a[192:195], a[152:155], v[28:31]
 s_waitcnt lgkmcnt(1)
 v_mfma_f32_16x16x32_bf16 v[32:35], a[192:195], a[160:163], v[32:35]
 v_add_f32 v204, v204, v8
 v_mfma_f32_16x16x32_bf16 v[32:35], a[196:199], a[164:167], v[32:35]
 v_add_f32 v205, v205, v9
 v_mfma_f32_16x16x32_bf16 v[36:39], a[196:199], a[172:175], v[36:39]
 v_mfma_f32_16x16x32_bf16 v[36:39], a[192:195], a[168:171], v[36:39]
 v_add_f32 v206, v206, v10
 v_mfma_f32_16x16x32_bf16 v[40:43], a[192:195], a[176:179], v[40:43]
 v_add_f32 v207, v207, v11
 v_mfma_f32_16x16x32_bf16 v[40:43], a[196:199], a[180:183], v[40:43]
 v_mfma_f32_16x16x32_bf16 v[44:47], a[196:199], a[188:191], v[44:47]
 v_add_f32 v208, v208, v8
 v_mfma_f32_16x16x32_bf16 v[44:47], a[192:195], a[184:187], v[44:47]
 v_add_f32 v209, v209, v9
 s_waitcnt vmcnt(8)
 v_mfma_f32_16x16x32_bf16 v[76:79], a[200:203], a[184:187], v[76:79]
 v_mfma_f32_16x16x32_bf16 v[76:79], a[204:207], a[188:191], v[76:79]
 global_load_dwordx4 a[196:199], v0, s[70:71] offset:1024 sc1
 v_add_f32 v210, v210, v10
 v_mfma_f32_16x16x32_bf16 v[72:75], a[204:207], a[180:183], v[72:75]
 v_add_f32 v211, v211, v11
 v_mfma_f32_16x16x32_bf16 v[72:75], a[200:203], a[176:179], v[72:75]
 global_load_dwordx4 a[192:195], v0, s[70:71] offset:0 sc1
 v_mfma_f32_16x16x32_bf16 v[68:71], a[200:203], a[168:171], v[68:71]
 v_add_f32 v212, v212, v8
 v_mfma_f32_16x16x32_bf16 v[68:71], a[204:207], a[172:175], v[68:71]
 v_mfma_f32_16x16x32_bf16 v[64:67], a[204:207], a[164:167], v[64:67]
 v_add_f32 v213, v213, v9
 v_mfma_f32_16x16x32_bf16 v[64:67], a[200:203], a[160:163], v[64:67]
 v_add_f32 v214, v214, v10
 v_mfma_f32_16x16x32_bf16 v[60:63], a[200:203], a[152:155], v[60:63]
 v_mfma_f32_16x16x32_bf16 v[60:63], a[204:207], a[156:159], v[60:63]
 v_add_f32 v215, v215, v11
 v_mfma_f32_16x16x32_bf16 v[56:59], a[204:207], a[148:151], v[56:59]
 v_add_f32 v216, v216, v8
 v_mfma_f32_16x16x32_bf16 v[56:59], a[200:203], a[144:147], v[56:59]
 v_mfma_f32_16x16x32_bf16 v[52:55], a[200:203], a[136:139], v[52:55]
 v_add_f32 v217, v217, v9
 v_mfma_f32_16x16x32_bf16 v[52:55], a[204:207], a[140:143], v[52:55]
 v_add_f32 v218, v218, v10
 v_mfma_f32_16x16x32_bf16 v[48:51], a[204:207], a[132:135], v[48:51]
 v_mfma_f32_16x16x32_bf16 v[48:51], a[200:203], a[128:131], v[48:51]
 v_add_f32 v219, v219, v11
 s_waitcnt vmcnt(8)
 v_mfma_f32_16x16x32_bf16 v[80:83], a[208:211], a[128:131], v[80:83]
 v_add_f32 v220, v220, v8
 v_mfma_f32_16x16x32_bf16 v[80:83], a[212:215], a[132:135], v[80:83]
 global_load_dwordx4 a[204:207], v0, s[70:71] offset:3072 sc1
 v_mfma_f32_16x16x32_bf16 v[84:87], a[212:215], a[140:143], v[84:87]
 v_add_f32 v221, v221, v9
 v_mfma_f32_16x16x32_bf16 v[84:87], a[208:211], a[136:139], v[84:87]
 global_load_dwordx4 a[200:203], v0, s[70:71] offset:2048 sc1
 v_mfma_f32_16x16x32_bf16 v[88:91], a[208:211], a[144:147], v[88:91]
 v_add_f32 v222, v222, v10
 s_add_u32 s70, s70, 8192
 s_addc_u32 s71, s71, 0
 v_mfma_f32_16x16x32_bf16 v[88:91], a[212:215], a[148:151], v[88:91]
 v_add_f32 v223, v223, v11
 v_mfma_f32_16x16x32_bf16 v[92:95], a[212:215], a[156:159], v[92:95]
 v_mfma_f32_16x16x32_bf16 v[92:95], a[208:211], a[152:155], v[92:95]
 v_add_f32 v224, v224, v8
 v_mfma_f32_16x16x32_bf16 v[96:99], a[208:211], a[160:163], v[96:99]
 v_add_f32 v225, v225, v9
 v_mfma_f32_16x16x32_bf16 v[96:99], a[212:215], a[164:167], v[96:99]
 v_mfma_f32_16x16x32_bf16 v[100:103], a[212:215], a[172:175], v[100:103]
 v_add_f32 v226, v226, v10
 v_mfma_f32_16x16x32_bf16 v[100:103], a[208:211], a[168:171], v[100:103]
 v_add_f32 v227, v227, v11
 v_mfma_f32_16x16x32_bf16 v[104:107], a[208:211], a[176:179], v[104:107]
 v_mfma_f32_16x16x32_bf16 v[104:107], a[212:215], a[180:183], v[104:107]
 v_add_f32 v228, v228, v8
 v_mfma_f32_16x16x32_bf16 v[108:111], a[212:215], a[188:191], v[108:111]
 v_add_f32 v229, v229, v9
 v_mfma_f32_16x16x32_bf16 v[108:111], a[208:211], a[184:187], v[108:111]
 s_waitcnt vmcnt(8)
 v_mfma_f32_16x16x32_bf16 a[244:247], a[216:219], a[184:187], a[244:247]
 ds_read_b128 a[184:187], v2 offset:63488
 v_add_f32 v230, v230, v10
 v_mfma_f32_16x16x32_bf16 a[244:247], a[220:223], a[188:191], a[244:247]
 global_load_dwordx4 a[212:215], v0, s[70:71] offset:-3072 sc1
 ds_read_b128 a[188:191], v2 offset:64512
 v_mfma_f32_16x16x32_bf16 a[240:243], a[220:223], a[180:183], a[240:243]
 ds_read_b128 a[180:183], v2 offset:60416
 v_add_f32 v231, v231, v11
 v_mfma_f32_16x16x32_bf16 a[240:243], a[216:219], a[176:179], a[240:243]
 global_load_dwordx4 a[208:211], v0, s[70:71] offset:-4096 sc1
 ds_read_b128 a[176:179], v2 offset:59392
 s_waitcnt lgkmcnt(4)
 v_mfma_f32_16x16x32_bf16 v[132:135], a[216:219], a[168:171], v[132:135]
 ds_read_b128 a[168:171], v2 offset:55296
 v_mfma_f32_16x16x32_bf16 v[132:135], a[220:223], a[172:175], v[132:135]
 ds_read_b128 a[172:175], v2 offset:56320
 v_add_f32 v232, v232, v12
 v_mfma_f32_16x16x32_bf16 v[128:131], a[220:223], a[164:167], v[128:131]
 ds_read_b128 a[164:167], v2 offset:52224
 v_add_f32 v233, v233, v13
 v_mfma_f32_16x16x32_bf16 v[128:131], a[216:219], a[160:163], v[128:131]
 ds_read_b128 a[160:163], v2 offset:51200
 v_mfma_f32_16x16x32_bf16 v[124:127], a[216:219], a[152:155], v[124:127]
 ds_read_b128 a[152:155], v2 offset:47104
 v_add_f32 v234, v234, v14
 v_mfma_f32_16x16x32_bf16 v[124:127], a[220:223], a[156:159], v[124:127]
 ds_read_b128 a[156:159], v2 offset:48128
 v_add_f32 v235, v235, v15
 v_mfma_f32_16x16x32_bf16 v[120:123], a[220:223], a[148:151], v[120:123]
 ds_read_b128 a[148:151], v2 offset:44032
 v_mfma_f32_16x16x32_bf16 v[120:123], a[216:219], a[144:147], v[120:123]
 ds_read_b128 a[144:147], v2 offset:43008
 v_add_f32 v236, v236, v12
 v_mfma_f32_16x16x32_bf16 v[116:119], a[216:219], a[136:139], v[116:119]
 ds_read_b128 a[136:139], v2 offset:38912
 v_add_f32 v237, v237, v13
 v_mfma_f32_16x16x32_bf16 v[116:119], a[220:223], a[140:143], v[116:119]
 ds_read_b128 a[140:143], v2 offset:39936
 v_mfma_f32_16x16x32_bf16 v[112:115], a[220:223], a[132:135], v[112:115]
 ds_read_b128 a[132:135], v2 offset:35840
 v_add_f32 v238, v238, v14
 v_mfma_f32_16x16x32_bf16 v[112:115], a[216:219], a[128:131], v[112:115]
 ds_read_b128 a[128:131], v2 offset:34816
 s_waitcnt vmcnt(8) lgkmcnt(8)
 v_mfma_f32_16x16x32_bf16 v[44:47], a[224:227], a[184:187], v[44:47]
 v_add_f32 v239, v239, v15
 v_mfma_f32_16x16x32_bf16 v[44:47], a[228:231], a[188:191], v[44:47]
 global_load_dwordx4 a[220:223], v0, s[70:71] offset:-1024 sc1
 v_add_f32 v240, v240, v12
 v_mfma_f32_16x16x32_bf16 v[40:43], a[228:231], a[180:183], v[40:43]
 v_mfma_f32_16x16x32_bf16 v[40:43], a[224:227], a[176:179], v[40:43]
 global_load_dwordx4 a[216:219], v0, s[70:71] offset:-2048 sc1
 v_add_f32 v241, v241, v13
 v_mfma_f32_16x16x32_bf16 v[36:39], a[224:227], a[168:171], v[36:39]
 v_add_f32 v242, v242, v14
 v_mfma_f32_16x16x32_bf16 v[36:39], a[228:231], a[172:175], v[36:39]
 v_mfma_f32_16x16x32_bf16 v[32:35], a[228:231], a[164:167], v[32:35]
 v_add_f32 v243, v243, v15
 v_mfma_f32_16x16x32_bf16 v[32:35], a[224:227], a[160:163], v[32:35]
 v_add_f32 v244, v244, v12
 s_waitcnt lgkmcnt(0)
 v_mfma_f32_16x16x32_bf16 v[28:31], a[224:227], a[152:155], v[28:31]
 v_mfma_f32_16x16x32_bf16 v[28:31], a[228:231], a[156:159], v[28:31]
 v_add_f32 v245, v245, v13
 v_mfma_f32_16x16x32_bf16 v[24:27], a[228:231], a[148:151], v[24:27]
 v_add_f32 v246, v246, v14
 v_mfma_f32_16x16x32_bf16 v[24:27], a[224:227], a[144:147], v[24:27]
 v_mfma_f32_16x16x32_bf16 v[20:23], a[224:227], a[136:139], v[20:23]
 v_add_f32 v247, v247, v15
 v_mfma_f32_16x16x32_bf16 v[20:23], a[228:231], a[140:143], v[20:23]
 v_mfma_f32_16x16x32_bf16 v[16:19], a[228:231], a[132:135], v[16:19]
 v_add_f32 v248, v248, v12
 v_mfma_f32_16x16x32_bf16 v[16:19], a[224:227], a[128:131], v[16:19]
 v_add_f32 v249, v249, v13
 s_waitcnt vmcnt(8)
 v_mfma_f32_16x16x32_bf16 v[48:51], a[232:235], a[128:131], v[48:51]
 v_mfma_f32_16x16x32_bf16 v[48:51], a[236:239], a[132:135], v[48:51]
 global_load_dwordx4 a[228:231], v0, s[70:71] offset:1024 sc1
 v_add_f32 v250, v250, v14
 v_mfma_f32_16x16x32_bf16 v[52:55], a[236:239], a[140:143], v[52:55]
 v_add_f32 v251, v251, v15
 v_mfma_f32_16x16x32_bf16 v[52:55], a[232:235], a[136:139], v[52:55]
 global_load_dwordx4 a[224:227], v0, s[70:71] offset:0 sc1
 v_mfma_f32_16x16x32_bf16 v[56:59], a[232:235], a[144:147], v[56:59]
 v_add_f32 v252, v252, v12
 v_mfma_f32_16x16x32_bf16 v[56:59], a[236:239], a[148:151], v[56:59]
 v_add_f32 v253, v253, v13
 v_mfma_f32_16x16x32_bf16 v[60:63], a[236:239], a[156:159], v[60:63]
 v_mfma_f32_16x16x32_bf16 v[60:63], a[232:235], a[152:155], v[60:63]
 v_add_f32 v254, v254, v14
 v_mfma_f32_16x16x32_bf16 v[64:67], a[232:235], a[160:163], v[64:67]
 v_add_f32 v255, v255, v15
 v_mfma_f32_16x16x32_bf16 v[64:67], a[236:239], a[164:167], v[64:67]
 v_mfma_f32_16x16x32_bf16 v[68:71], a[236:239], a[172:175], v[68:71]
 v_accvgpr_read_b32 v5, a248
 v_mfma_f32_16x16x32_bf16 v[68:71], a[232:235], a[168:171], v[68:71]
 v_mfma_f32_16x16x32_bf16 v[72:75], a[232:235], a[176:179], v[72:75]
 v_add_f32 v5, v5, v12
 v_mfma_f32_16x16x32_bf16 v[72:75], a[236:239], a[180:183], v[72:75]
 v_accvgpr_write_b32 a248, v5
 v_mfma_f32_16x16x32_bf16 v[76:79], a[236:239], a[188:191], v[76:79]
 v_mfma_f32_16x16x32_bf16 v[76:79], a[232:235], a[184:187], v[76:79]
 v_accvgpr_read_b32 v6, a249
 s_waitcnt vmcnt(8)
 v_mfma_f32_16x16x32_bf16 v[108:111], a[192:195], a[184:187], v[108:111]
 v_add_f32 v6, v6, v13
 v_mfma_f32_16x16x32_bf16 v[108:111], a[196:199], a[188:191], v[108:111]
 global_load_dwordx4 a[236:239], v0, s[70:71] offset:3072 sc1
 v_mfma_f32_16x16x32_bf16 v[104:107], a[196:199], a[180:183], v[104:107]
 v_accvgpr_write_b32 a249, v6
 v_mfma_f32_16x16x32_bf16 v[104:107], a[192:195], a[176:179], v[104:107]
 global_load_dwordx4 a[232:235], v0, s[70:71] offset:2048 sc1
 v_accvgpr_read_b32 v5, a250
 v_mfma_f32_16x16x32_bf16 v[100:103], a[192:195], a[168:171], v[100:103]
 s_add_u32 s70, s70, 8192
 s_addc_u32 s71, s71, 0
 v_mfma_f32_16x16x32_bf16 v[100:103], a[196:199], a[172:175], v[100:103]
 v_add_f32 v5, v5, v14
 v_mfma_f32_16x16x32_bf16 v[96:99], a[196:199], a[164:167], v[96:99]
 v_accvgpr_write_b32 a250, v5
 v_mfma_f32_16x16x32_bf16 v[96:99], a[192:195], a[160:163], v[96:99]
 v_mfma_f32_16x16x32_bf16 v[92:95], a[192:195], a[152:155], v[92:95]
 v_accvgpr_read_b32 v6, a251
 v_mfma_f32_16x16x32_bf16 v[92:95], a[196:199], a[156:159], v[92:95]
 v_mfma_f32_16x16x32_bf16 v[88:91], a[196:199], a[148:151], v[88:91]
 v_add_f32 v6, v6, v15
 v_mfma_f32_16x16x32_bf16 v[88:91], a[192:195], a[144:147], v[88:91]
 v_accvgpr_write_b32 a251, v6
 v_mfma_f32_16x16x32_bf16 v[84:87], a[192:195], a[136:139], v[84:87]
 v_mfma_f32_16x16x32_bf16 v[84:87], a[196:199], a[140:143], v[84:87]
 v_accvgpr_read_b32 v5, a252
 v_mfma_f32_16x16x32_bf16 v[80:83], a[196:199], a[132:135], v[80:83]
 v_add_f32 v5, v5, v12
 v_mfma_f32_16x16x32_bf16 v[80:83], a[192:195], a[128:131], v[80:83]
 s_waitcnt vmcnt(8)
 v_mfma_f32_16x16x32_bf16 v[112:115], a[200:203], a[128:131], v[112:115]
 ds_read_b128 a[128:131], v1 offset:2048
 v_accvgpr_write_b32 a252, v5
 v_mfma_f32_16x16x32_bf16 v[112:115], a[204:207], a[132:135], v[112:115]
 global_load_dwordx4 a[196:199], v0, s[70:71] offset:-3072 sc1
 ds_read_b128 a[132:135], v1 offset:3072
 v_mfma_f32_16x16x32_bf16 v[116:119], a[204:207], a[140:143], v[116:119]
 ds_read_b128 a[140:143], v1 offset:7168
 v_accvgpr_read_b32 v6, a253
 v_mfma_f32_16x16x32_bf16 v[116:119], a[200:203], a[136:139], v[116:119]
 global_load_dwordx4 a[192:195], v0, s[70:71] offset:-4096 sc1
 ds_read_b128 a[136:139], v1 offset:6144
 v_mfma_f32_16x16x32_bf16 v[120:123], a[200:203], a[144:147], v[120:123]
 ds_read_b128 a[144:147], v1 offset:10240
 v_add_f32 v6, v6, v13
 v_mfma_f32_16x16x32_bf16 v[120:123], a[204:207], a[148:151], v[120:123]
 ds_read_b128 a[148:151], v1 offset:11264
 v_accvgpr_write_b32 a253, v6
 v_mfma_f32_16x16x32_bf16 v[124:127], a[204:207], a[156:159], v[124:127]
 ds_read_b128 a[156:159], v1 offset:15360
 v_accvgpr_read_b32 v5, a254
 v_mfma_f32_16x16x32_bf16 v[124:127], a[200:203], a[152:155], v[124:127]
 ds_read_b128 a[152:155], v1 offset:14336
 v_mfma_f32_16x16x32_bf16 v[128:131], a[200:203], a[160:163], v[128:131]
 ds_read_b128 a[160:163], v1 offset:18432
 v_add_f32 v5, v5, v14
 v_mfma_f32_16x16x32_bf16 v[128:131], a[204:207], a[164:167], v[128:131]
 ds_read_b128 a[164:167], v1 offset:19456
 v_accvgpr_write_b32 a254, v5
 v_mfma_f32_16x16x32_bf16 v[132:135], a[204:207], a[172:175], v[132:135]
 ds_read_b128 a[172:175], v1 offset:23552
 v_mfma_f32_16x16x32_bf16 v[132:135], a[200:203], a[168:171], v[132:135]
 ds_read_b128 a[168:171], v1 offset:22528
 v_accvgpr_read_b32 v6, a255
 v_mfma_f32_16x16x32_bf16 a[240:243], a[200:203], a[176:179], a[240:243]
 ds_read_b128 a[176:179], v1 offset:26624
 v_add_f32 v6, v6, v15
 v_mfma_f32_16x16x32_bf16 a[240:243], a[204:207], a[180:183], a[240:243]
 ds_read_b128 a[180:183], v1 offset:27648
 v_accvgpr_write_b32 a255, v6
 v_mfma_f32_16x16x32_bf16 a[244:247], a[204:207], a[188:191], a[244:247]
 global_load_dwordx4 a[204:207], v0, s[70:71] offset:-1024 sc1
 ds_read_b128 a[188:191], v1 offset:31744
 v_mfma_f32_16x16x32_bf16 a[244:247], a[200:203], a[184:187], a[244:247]
 global_load_dwordx4 a[200:203], v0, s[70:71] offset:-2048 sc1
 ds_read_b128 a[184:187], v1 offset:30720
 s_waitcnt vmcnt(10) lgkmcnt(8)
 s_mov_b32 s8, s32
 s_mov_b32 s9, s33
 s_mov_b32 s10, s34
 s_mov_b32 s20, 1024
 s_mov_b32 s21, 1024
 s_mov_b32 s22, 1024
 s_xor_b32 s30, s29, 131072
 s_add_u32 s51, s51, 2048
 s_add_u32 s25, s25, 1
 s_cmp_eq_u32 s25, 6
 s_cbranch_scc1 Llast
 v_mfma_f32_16x16x32_bf16 v[136:139], a[208:211], a[128:131], v[136:139]
 v_accvgpr_read_b32 v5, a0
 v_lshlrev_b32 v6, 16, v5
 v_mfma_f32_16x16x32_bf16 v[136:139], a[212:215], a[132:135], v[136:139]
 v_and_b32 v5, s26, v5
 v_mul_f32 v6, v6, v16
 v_mfma_f32_16x16x32_bf16 v[140:143], a[212:215], a[140:143], v[140:143]
 v_mul_f32 v5, v5, v17
 v_cvt_pk_bf16_f32 v8, v6, v5
 v_mfma_f32_16x16x32_bf16 v[140:143], a[208:211], a[136:139], v[140:143]
 v_accvgpr_read_b32 v5, a1
 v_mfma_f32_16x16x32_bf16 v[144:147], a[208:211], a[144:147], v[144:147]
 v_lshlrev_b32 v6, 16, v5
 v_and_b32 v5, s26, v5
 v_mfma_f32_16x16x32_bf16 v[144:147], a[212:215], a[148:151], v[144:147]
 v_mul_f32 v6, v6, v18
 v_mul_f32 v5, v5, v19
 v_mfma_f32_16x16x32_bf16 v[148:151], a[212:215], a[156:159], v[148:151]
 v_cvt_pk_bf16_f32 v9, v6, v5
 v_accvgpr_read_b32 v5, a2
 v_mfma_f32_16x16x32_bf16 v[148:151], a[208:211], a[152:155], v[148:151]
 v_lshlrev_b32 v6, 16, v5
 v_and_b32 v5, s26, v5
 s_waitcnt lgkmcnt(0)
 v_mfma_f32_16x16x32_bf16 v[152:155], a[208:211], a[160:163], v[152:155]
 v_mul_f32 v6, v6, v48
 v_mul_f32 v5, v5, v49
 v_mfma_f32_16x16x32_bf16 v[152:155], a[212:215], a[164:167], v[152:155]
 v_cvt_pk_bf16_f32 v10, v6, v5
 v_mfma_f32_16x16x32_bf16 v[156:159], a[212:215], a[172:175], v[156:159]
 v_accvgpr_read_b32 v5, a3
 v_lshlrev_b32 v6, 16, v5
 v_mfma_f32_16x16x32_bf16 v[156:159], a[208:211], a[168:171], v[156:159]
 v_and_b32 v5, s26, v5
 v_mul_f32 v6, v6, v50
 v_mfma_f32_16x16x32_bf16 v[160:163], a[208:211], a[176:179], v[160:163]
 v_mul_f32 v5, v5, v51
 v_cvt_pk_bf16_f32 v11, v6, v5
 v_mfma_f32_16x16x32_bf16 v[160:163], a[212:215], a[180:183], v[160:163]
 ds_write_b128 v3, v[8:11]
 s_add_u32 s68, s29, 0
 v_mfma_f32_16x16x32_bf16 v[164:167], a[212:215], a[188:191], v[164:167]
 buffer_store_dwordx4 v[8:11], v3, s[32:35], s68 offen sc1
 v_accvgpr_read_b32 v5, a32
 v_mfma_f32_16x16x32_bf16 v[164:167], a[208:211], a[184:187], v[164:167]
 v_lshlrev_b32 v6, 16, v5
 v_and_b32 v5, s26, v5
 s_waitcnt vmcnt(9)
 v_mfma_f32_16x16x32_bf16 v[196:199], a[216:219], a[184:187], v[196:199]
 v_mul_f32 v6, v6, v80
 v_mul_f32 v5, v5, v81
 v_mfma_f32_16x16x32_bf16 v[196:199], a[220:223], a[188:191], v[196:199]
 global_load_dwordx4 a[212:215], v0, s[70:71] offset:1024 sc1
 v_cvt_pk_bf16_f32 v12, v6, v5
 v_mfma_f32_16x16x32_bf16 v[192:195], a[220:223], a[180:183], v[192:195]
 v_accvgpr_read_b32 v5, a33
 v_lshlrev_b32 v6, 16, v5
 v_mfma_f32_16x16x32_bf16 v[192:195], a[216:219], a[176:179], v[192:195]
 global_load_dwordx4 a[208:211], v0, s[70:71] offset:0 sc1
 v_and_b32 v5, s26, v5
 v_mfma_f32_16x16x32_bf16 v[188:191], a[216:219], a[168:171], v[188:191]
 v_mul_f32 v6, v6, v82
 v_mul_f32 v5, v5, v83
 v_mfma_f32_16x16x32_bf16 v[188:191], a[220:223], a[172:175], v[188:191]
 v_cvt_pk_bf16_f32 v13, v6, v5
 v_accvgpr_read_b32 v5, a34
 v_mfma_f32_16x16x32_bf16 v[184:187], a[220:223], a[164:167], v[184:187]
 v_lshlrev_b32 v6, 16, v5
 v_and_b32 v5, s26, v5
 v_mfma_f32_16x16x32_bf16 v[184:187], a[216:219], a[160:163], v[184:187]
 v_mul_f32 v6, v6, v112
 v_mul_f32 v5, v5, v113
 v_mfma_f32_16x16x32_bf16 v[180:183], a[216:219], a[152:155], v[180:183]
 v_cvt_pk_bf16_f32 v14, v6, v5
 v_accvgpr_read_b32 v5, a35
 v_mfma_f32_16x16x32_bf16 v[180:183], a[220:223], a[156:159], v[180:183]
 v_lshlrev_b32 v6, 16, v5
 v_and_b32 v5, s26, v5
 v_mfma_f32_16x16x32_bf16 v[176:179], a[220:223], a[148:151], v[176:179]
 v_mul_f32 v6, v6, v114
 v_mul_f32 v5, v5, v115
 v_mfma_f32_16x16x32_bf16 v[176:179], a[216:219], a[144:147], v[176:179]
 v_cvt_pk_bf16_f32 v15, v6, v5
 v_mfma_f32_16x16x32_bf16 v[172:175], a[216:219], a[136:139], v[172:175]
 ds_write_b128 v3, v[12:15] offset:1024
 v_mfma_f32_16x16x32_bf16 v[172:175], a[220:223], a[140:143], v[172:175]
 buffer_store_dwordx4 v[12:15], v3, s[32:35], s68 offen offset:1024 sc1
 v_accvgpr_read_b32 v5, a4
 v_lshlrev_b32 v6, 16, v5
 v_and_b32 v5, s26, v5
 v_mul_f32 v6, v6, v20
 v_mfma_f32_16x16x32_bf16 v[168:171], a[220:223], a[132:135], v[168:171]
 v_mul_f32 v5, v5, v21
 v_cvt_pk_bf16_f32 v8, v6, v5
 v_mfma_f32_16x16x32_bf16 v[168:171], a[216:219], a[128:131], v[168:171]
 v_accvgpr_read_b32 v5, a5
 v_lshlrev_b32 v6, 16, v5
 s_waitcnt vmcnt(10)
 v_mfma_f32_16x16x32_bf16 v[200:203], a[224:227], a[128:131], v[200:203]
 v_and_b32 v5, s26, v5
 v_mul_f32 v6, v6, v22
 v_mfma_f32_16x16x32_bf16 v[200:203], a[228:231], a[132:135], v[200:203]
 global_load_dwordx4 a[220:223], v0, s[70:71] offset:3072 sc1
 v_mul_f32 v5, v5, v23
 v_mfma_f32_16x16x32_bf16 v[204:207], a[228:231], a[140:143], v[204:207]
 v_cvt_pk_bf16_f32 v9, v6, v5
 v_accvgpr_read_b32 v5, a6
 v_mfma_f32_16x16x32_bf16 v[204:207], a[224:227], a[136:139], v[204:207]
 global_load_dwordx4 a[216:219], v0, s[70:71] offset:2048 sc1
 v_lshlrev_b32 v6, 16, v5
 v_mfma_f32_16x16x32_bf16 v[208:211], a[224:227], a[144:147], v[208:211]
 v_and_b32 v5, s26, v5
 v_mul_f32 v6, v6, v52
 s_add_u32 s70, s70, 8192
 s_addc_u32 s71, s71, 0
 v_mfma_f32_16x16x32_bf16 v[208:211], a[228:231], a[148:151], v[208:211]
 v_mul_f32 v5, v5, v53
 v_cvt_pk_bf16_f32 v10, v6, v5
 v_mfma_f32_16x16x32_bf16 v[212:215], a[228:231], a[156:159], v[212:215]
 v_accvgpr_read_b32 v5, a7
 v_lshlrev_b32 v6, 16, v5
 v_mfma_f32_16x16x32_bf16 v[212:215], a[224:227], a[152:155], v[212:215]
 v_and_b32 v5, s26, v5
 v_mul_f32 v6, v6, v54
 v_mfma_f32_16x16x32_bf16 v[216:219], a[224:227], a[160:163], v[216:219]
 v_mul_f32 v5, v5, v55
 v_cvt_pk_bf16_f32 v11, v6, v5
 v_mfma_f32_16x16x32_bf16 v[216:219], a[228:231], a[164:167], v[216:219]
 ds_write_b128 v3, v[8:11] offset:4096
 v_mfma_f32_16x16x32_bf16 v[220:223], a[228:231], a[172:175], v[220:223]
 buffer_store_dwordx4 v[8:11], v3, s[32:35], s68 offen offset:2048 sc1
 v_accvgpr_read_b32 v5, a36
 v_lshlrev_b32 v6, 16, v5
 v_and_b32 v5, s26, v5
 v_mul_f32 v6, v6, v84
 v_mfma_f32_16x16x32_bf16 v[220:223], a[224:227], a[168:171], v[220:223]
 v_mul_f32 v5, v5, v85
 v_cvt_pk_bf16_f32 v12, v6, v5
 v_mfma_f32_16x16x32_bf16 v[224:227], a[224:227], a[176:179], v[224:227]
 v_accvgpr_read_b32 v5, a37
 v_lshlrev_b32 v6, 16, v5
 v_mfma_f32_16x16x32_bf16 v[224:227], a[228:231], a[180:183], v[224:227]
 v_and_b32 v5, s26, v5
 v_mul_f32 v6, v6, v86
 v_mfma_f32_16x16x32_bf16 v[228:231], a[228:231], a[188:191], v[228:231]
 v_mul_f32 v5, v5, v87
 v_cvt_pk_bf16_f32 v13, v6, v5
 v_mfma_f32_16x16x32_bf16 v[228:231], a[224:227], a[184:187], v[228:231]
 v_accvgpr_read_b32 v5, a38
 v_lshlrev_b32 v6, 16, v5
 s_waitcnt vmcnt(11)
 v_mfma_f32_16x16x32_bf16 a[252:255], a[232:235], a[184:187], a[252:255]
 ds_read_b128 a[184:187], v1 offset:63488
 v_and_b32 v5, s26, v5
 v_mfma_f32_16x16x32_bf16 a[252:255], a[236:239], a[188:191], a[252:255]
 global_load_dwordx4 a[228:231], v0, s[70:71] offset:-3072 sc1
 ds_read_b128 a[188:191], v1 offset:64512
 v_mfma_f32_16x16x32_bf16 a[248:251], a[236:239], a[180:183], a[248:251]
 ds_read_b128 a[180:183], v1 offset:60416
 v_mul_f32 v6, v6, v116
 v_mfma_f32_16x16x32_bf16 a[248:251], a[232:235], a[176:179], a[248:251]
 global_load_dwordx4 a[224:227], v0, s[70:71] offset:-4096 sc1
 ds_read_b128 a[176:179], v1 offset:59392
 v_mul_f32 v5, v5, v117
 v_mfma_f32_16x16x32_bf16 v[252:255], a[232:235], a[168:171], v[252:255]
 ds_read_b128 a[168:171], v1 offset:55296
 v_cvt_pk_bf16_f32 v14, v6, v5
 v_accvgpr_read_b32 v5, a39
 v_mfma_f32_16x16x32_bf16 v[252:255], a[236:239], a[172:175], v[252:255]
 ds_read_b128 a[172:175], v1 offset:56320
 v_lshlrev_b32 v6, 16, v5
 v_mfma_f32_16x16x32_bf16 v[248:251], a[236:239], a[164:167], v[248:251]
 ds_read_b128 a[164:167], v1 offset:52224
 v_and_b32 v5, s26, v5
 v_mul_f32 v6, v6, v118
 v_mfma_f32_16x16x32_bf16 v[248:251], a[232:235], a[160:163], v[248:251]
 ds_read_b128 a[160:163], v1 offset:51200
 v_mul_f32 v5, v5, v119
 v_cvt_pk_bf16_f32 v15, v6, v5
 v_mfma_f32_16x16x32_bf16 v[244:247], a[232:235], a[152:155], v[244:247]
 ds_read_b128 a[152:155], v1 offset:47104
 ds_write_b128 v3, v[12:15] offset:5120
 v_mfma_f32_16x16x32_bf16 v[244:247], a[236:239], a[156:159], v[244:247]
 buffer_store_dwordx4 v[12:15], v3, s[32:35], s68 offen offset:3072 sc1
 ds_read_b128 a[156:159], v1 offset:48128
 v_accvgpr_read_b32 v5, a8
 v_lshlrev_b32 v6, 16, v5
 v_and_b32 v5, s26, v5
 v_mfma_f32_16x16x32_bf16 v[240:243], a[236:239], a[148:151], v[240:243]
 ds_read_b128 a[148:151], v1 offset:44032
 v_mul_f32 v6, v6, v24
 v_mfma_f32_16x16x32_bf16 v[240:243], a[232:235], a[144:147], v[240:243]
 ds_read_b128 a[144:147], v1 offset:43008
 v_mul_f32 v5, v5, v25
 v_cvt_pk_bf16_f32 v8, v6, v5
 v_mfma_f32_16x16x32_bf16 v[236:239], a[232:235], a[136:139], v[236:239]
 ds_read_b128 a[136:139], v1 offset:38912
 v_accvgpr_read_b32 v5, a9
 v_mfma_f32_16x16x32_bf16 v[236:239], a[236:239], a[140:143], v[236:239]
 ds_read_b128 a[140:143], v1 offset:39936
 v_lshlrev_b32 v6, 16, v5
 v_mfma_f32_16x16x32_bf16 v[232:235], a[236:239], a[132:135], v[232:235]
 ds_read_b128 a[132:135], v1 offset:35840
 v_and_b32 v5, s26, v5
 v_mfma_f32_16x16x32_bf16 v[232:235], a[232:235], a[128:131], v[232:235]
 ds_read_b128 a[128:131], v1 offset:34816
 v_mul_f32 v6, v6, v26
 s_waitcnt vmcnt(12) lgkmcnt(9)
 v_mfma_f32_16x16x32_bf16 v[164:167], a[192:195], a[184:187], v[164:167]
 v_mul_f32 v5, v5, v27
 v_cvt_pk_bf16_f32 v9, v6, v5
 v_mfma_f32_16x16x32_bf16 v[164:167], a[196:199], a[188:191], v[164:167]
 global_load_dwordx4 a[236:239], v0, s[70:71] offset:-1024 sc1
 v_accvgpr_read_b32 v5, a10
 v_mfma_f32_16x16x32_bf16 v[160:163], a[196:199], a[180:183], v[160:163]
 v_lshlrev_b32 v6, 16, v5
 v_and_b32 v5, s26, v5
 v_mfma_f32_16x16x32_bf16 v[160:163], a[192:195], a[176:179], v[160:163]
 global_load_dwordx4 a[232:235], v0, s[70:71] offset:-2048 sc1
 v_mul_f32 v6, v6, v56
 v_mfma_f32_16x16x32_bf16 v[156:159], a[192:195], a[168:171], v[156:159]
 v_mul_f32 v5, v5, v57
 v_cvt_pk_bf16_f32 v10, v6, v5
 v_mfma_f32_16x16x32_bf16 v[156:159], a[196:199], a[172:175], v[156:159]
 v_accvgpr_read_b32 v5, a11
 v_lshlrev_b32 v6, 16, v5
 v_mfma_f32_16x16x32_bf16 v[152:155], a[196:199], a[164:167], v[152:155]
 v_and_b32 v5, s26, v5
 v_mul_f32 v6, v6, v58
 v_mfma_f32_16x16x32_bf16 v[152:155], a[192:195], a[160:163], v[152:155]
 v_mul_f32 v5, v5, v59
 v_cvt_pk_bf16_f32 v11, v6, v5
 s_waitcnt lgkmcnt(0)
 v_mfma_f32_16x16x32_bf16 v[148:151], a[192:195], a[152:155], v[148:151]
 ds_write_b128 v3, v[8:11] offset:8192
 s_add_u32 s68, s29, 4096
 v_mfma_f32_16x16x32_bf16 v[148:151], a[196:199], a[156:159], v[148:151]
 buffer_store_dwordx4 v[8:11], v3, s[32:35], s68 offen sc1
 v_accvgpr_read_b32 v5, a40
 v_lshlrev_b32 v6, 16, v5
 v_and_b32 v5, s26, v5
 v_mul_f32 v6, v6, v88
 v_mfma_f32_16x16x32_bf16 v[144:147], a[196:199], a[148:151], v[144:147]
 v_mul_f32 v5, v5, v89
 v_cvt_pk_bf16_f32 v12, v6, v5
 v_mfma_f32_16x16x32_bf16 v[144:147], a[192:195], a[144:147], v[144:147]
 v_accvgpr_read_b32 v5, a41
 v_lshlrev_b32 v6, 16, v5
 v_mfma_f32_16x16x32_bf16 v[140:143], a[192:195], a[136:139], v[140:143]
 v_and_b32 v5, s26, v5
 v_mul_f32 v6, v6, v90
 v_mfma_f32_16x16x32_bf16 v[140:143], a[196:199], a[140:143], v[140:143]
 v_mul_f32 v5, v5, v91
 v_cvt_pk_bf16_f32 v13, v6, v5
 v_mfma_f32_16x16x32_bf16 v[136:139], a[196:199], a[132:135], v[136:139]
 v_accvgpr_read_b32 v5, a42
 v_lshlrev_b32 v6, 16, v5
 v_mfma_f32_16x16x32_bf16 v[136:139], a[192:195], a[128:131], v[136:139]
 v_and_b32 v5, s26, v5
 v_mul_f32 v6, v6, v120
 s_waitcnt vmcnt(13)
 v_mfma_f32_16x16x32_bf16 v[168:171], a[200:203], a[128:131], v[168:171]
 v_mul_f32 v5, v5, v121
 v_cvt_pk_bf16_f32 v14, v6, v5
 v_mfma_f32_16x16x32_bf16 v[168:171], a[204:207], a[132:135], v[168:171]
 global_load_dwordx4 a[196:199], v0, s[70:71] offset:1024 sc1
 v_accvgpr_read_b32 v5, a43
 v_mfma_f32_16x16x32_bf16 v[172:175], a[204:207], a[140:143], v[172:175]
 v_lshlrev_b32 v6, 16, v5
 v_and_b32 v5, s26, v5
 v_mfma_f32_16x16x32_bf16 v[172:175], a[200:203], a[136:139], v[172:175]
 global_load_dwordx4 a[192:195], v0, s[70:71] offset:0 sc1
 v_mul_f32 v6, v6, v122
 v_mfma_f32_16x16x32_bf16 v[176:179], a[200:203], a[144:147], v[176:179]
 v_mul_f32 v5, v5, v123
 v_cvt_pk_bf16_f32 v15, v6, v5
 v_mfma_f32_16x16x32_bf16 v[176:179], a[204:207], a[148:151], v[176:179]
 ds_write_b128 v3, v[12:15] offset:9216
 v_mfma_f32_16x16x32_bf16 v[180:183], a[204:207], a[156:159], v[180:183]
 v_lshlrev_b32 v4, 2, v1
 v_and_b32 v4, 192, v4
 v_mfma_f32_16x16x32_bf16 v[180:183], a[200:203], a[152:155], v[180:183]
 buffer_load_dword v4, v4, s[44:47], 0 offen sc1
 v_mfma_f32_16x16x32_bf16 v[184:187], a[200:203], a[160:163], v[184:187]
 buffer_store_dwordx4 v[12:15], v3, s[32:35], s68 offen offset:1024 sc1
 v_accvgpr_read_b32 v5, a12
 v_lshlrev_b32 v6, 16, v5
 v_and_b32 v5, s26, v5
 v_mul_f32 v6, v6, v28
 v_mfma_f32_16x16x32_bf16 v[184:187], a[204:207], a[164:167], v[184:187]
 v_mul_f32 v5, v5, v29
 v_cvt_pk_bf16_f32 v8, v6, v5
 v_mfma_f32_16x16x32_bf16 v[188:191], a[204:207], a[172:175], v[188:191]
 v_accvgpr_read_b32 v5, a13
 v_lshlrev_b32 v6, 16, v5
 v_mfma_f32_16x16x32_bf16 v[188:191], a[200:203], a[168:171], v[188:191]
 v_and_b32 v5, s26, v5
 v_mul_f32 v6, v6, v30
 v_mfma_f32_16x16x32_bf16 v[192:195], a[200:203], a[176:179], v[192:195]
 v_mul_f32 v5, v5, v31
 v_cvt_pk_bf16_f32 v9, v6, v5
 v_mfma_f32_16x16x32_bf16 v[192:195], a[204:207], a[180:183], v[192:195]
 v_accvgpr_read_b32 v5, a14
 v_lshlrev_b32 v6, 16, v5
 v_mfma_f32_16x16x32_bf16 v[196:199], a[204:207], a[188:191], v[196:199]
 v_and_b32 v5, s26, v5
 v_mul_f32 v6, v6, v60
 v_mfma_f32_16x16x32_bf16 v[196:199], a[200:203], a[184:187], v[196:199]
 v_mul_f32 v5, v5, v61
 v_cvt_pk_bf16_f32 v10, v6, v5
 s_waitcnt vmcnt(14)
 v_mfma_f32_16x16x32_bf16 v[228:231], a[208:211], a[184:187], v[228:231]
 v_accvgpr_read_b32 v5, a15
 v_lshlrev_b32 v6, 16, v5
 v_mfma_f32_16x16x32_bf16 v[228:231], a[212:215], a[188:191], v[228:231]
 global_load_dwordx4 a[204:207], v0, s[70:71] offset:3072 sc1
 v_and_b32 v5, s26, v5
 v_mfma_f32_16x16x32_bf16 v[224:227], a[212:215], a[180:183], v[224:227]
 v_mul_f32 v6, v6, v62
 v_mul_f32 v5, v5, v63
 v_mfma_f32_16x16x32_bf16 v[224:227], a[208:211], a[176:179], v[224:227]
 global_load_dwordx4 a[200:203], v0, s[70:71] offset:2048 sc1
 v_cvt_pk_bf16_f32 v11, v6, v5
 v_mfma_f32_16x16x32_bf16 v[220:223], a[208:211], a[168:171], v[220:223]
 ds_write_b128 v3, v[8:11] offset:12288
 s_add_u32 s70, s70, 8192
 s_addc_u32 s71, s71, 0
 v_mfma_f32_16x16x32_bf16 v[220:223], a[212:215], a[172:175], v[220:223]
 buffer_store_dwordx4 v[8:11], v3, s[32:35], s68 offen offset:2048 sc1
 v_accvgpr_read_b32 v5, a44
 v_lshlrev_b32 v6, 16, v5
 v_and_b32 v5, s26, v5
 v_mfma_f32_16x16x32_bf16 v[216:219], a[212:215], a[164:167], v[216:219]
 v_mul_f32 v6, v6, v92
 v_mul_f32 v5, v5, v93
 v_mfma_f32_16x16x32_bf16 v[216:219], a[208:211], a[160:163], v[216:219]
 v_cvt_pk_bf16_f32 v12, v6, v5
 v_accvgpr_read_b32 v5, a45
 v_mfma_f32_16x16x32_bf16 v[212:215], a[208:211], a[152:155], v[212:215]
 v_lshlrev_b32 v6, 16, v5
 v_and_b32 v5, s26, v5
 v_mfma_f32_16x16x32_bf16 v[212:215], a[212:215], a[156:159], v[212:215]
 v_mul_f32 v6, v6, v94
 v_mul_f32 v5, v5, v95
 v_mfma_f32_16x16x32_bf16 v[208:211], a[212:215], a[148:151], v[208:211]
 v_cvt_pk_bf16_f32 v13, v6, v5
 v_accvgpr_read_b32 v5, a46
 v_mfma_f32_16x16x32_bf16 v[208:211], a[208:211], a[144:147], v[208:211]
 v_lshlrev_b32 v6, 16, v5
 v_and_b32 v5, s26, v5
 v_mfma_f32_16x16x32_bf16 v[204:207], a[208:211], a[136:139], v[204:207]
 v_mul_f32 v6, v6, v124
 v_mul_f32 v5, v5, v125
 v_mfma_f32_16x16x32_bf16 v[204:207], a[212:215], a[140:143], v[204:207]
 v_cvt_pk_bf16_f32 v14, v6, v5
 v_accvgpr_read_b32 v5, a47
 v_mfma_f32_16x16x32_bf16 v[200:203], a[212:215], a[132:135], v[200:203]
 v_lshlrev_b32 v6, 16, v5
 v_and_b32 v5, s26, v5
 v_mfma_f32_16x16x32_bf16 v[200:203], a[208:211], a[128:131], v[200:203]
 v_mul_f32 v6, v6, v126
 v_mul_f32 v5, v5, v127
 s_waitcnt vmcnt(14)
 v_mfma_f32_16x16x32_bf16 v[232:235], a[216:219], a[128:131], v[232:235]
 ds_read_b128 a[128:131], v2 offset:2048
 v_cvt_pk_bf16_f32 v15, v6, v5
 v_mfma_f32_16x16x32_bf16 v[232:235], a[220:223], a[132:135], v[232:235]
 global_load_dwordx4 a[212:215], v0, s[70:71] offset:-3072 sc1
 ds_read_b128 a[132:135], v2 offset:3072
 v_mfma_f32_16x16x32_bf16 v[236:239], a[220:223], a[140:143], v[236:239]
 ds_read_b128 a[140:143], v2 offset:7168
 ds_write_b128 v3, v[12:15] offset:13312
 v_mfma_f32_16x16x32_bf16 v[236:239], a[216:219], a[136:139], v[236:239]
 global_load_dwordx4 a[208:211], v0, s[70:71] offset:-4096 sc1
 ds_read_b128 a[136:139], v2 offset:6144
 v_mfma_f32_16x16x32_bf16 v[240:243], a[216:219], a[144:147], v[240:243]
 buffer_store_dwordx4 v[12:15], v3, s[32:35], s68 offen offset:3072 sc1
 ds_read_b128 a[144:147], v2 offset:10240
 v_accvgpr_read_b32 v5, a16
 v_lshlrev_b32 v6, 16, v5
 v_and_b32 v5, s26, v5
 v_mfma_f32_16x16x32_bf16 v[240:243], a[220:223], a[148:151], v[240:243]
 ds_read_b128 a[148:151], v2 offset:11264
 v_mul_f32 v6, v6, v32
 v_mfma_f32_16x16x32_bf16 v[244:247], a[220:223], a[156:159], v[244:247]
 ds_read_b128 a[156:159], v2 offset:15360
 v_mul_f32 v5, v5, v33
 v_cvt_pk_bf16_f32 v8, v6, v5
 v_mfma_f32_16x16x32_bf16 v[244:247], a[216:219], a[152:155], v[244:247]
 ds_read_b128 a[152:155], v2 offset:14336
 v_accvgpr_read_b32 v5, a17
 v_lshlrev_b32 v6, 16, v5
 v_mfma_f32_16x16x32_bf16 v[248:251], a[216:219], a[160:163], v[248:251]
 ds_read_b128 a[160:163], v2 offset:18432
 v_and_b32 v5, s26, v5
 v_mul_f32 v6, v6, v34
 v_mfma_f32_16x16x32_bf16 v[248:251], a[220:223], a[164:167], v[248:251]
 ds_read_b128 a[164:167], v2 offset:19456
 v_mul_f32 v5, v5, v35
 v_cvt_pk_bf16_f32 v9, v6, v5
 v_mfma_f32_16x16x32_bf16 v[252:255], a[220:223], a[172:175], v[252:255]
 ds_read_b128 a[172:175], v2 offset:23552
 v_accvgpr_read_b32 v5, a18
 v_mfma_f32_16x16x32_bf16 v[252:255], a[216:219], a[168:171], v[252:255]
 ds_read_b128 a[168:171], v2 offset:22528
 v_lshlrev_b32 v6, 16, v5
 v_mfma_f32_16x16x32_bf16 a[248:251], a[216:219], a[176:179], a[248:251]
 ds_read_b128 a[176:179], v2 offset:26624
 v_and_b32 v5, s26, v5
 v_mfma_f32_16x16x32_bf16 a[248:251], a[220:223], a[180:183], a[248:251]
 ds_read_b128 a[180:183], v2 offset:27648
 v_mul_f32 v6, v6, v64
 v_mfma_f32_16x16x32_bf16 a[252:255], a[220:223], a[188:191], a[252:255]
 ds_read_b128 a[188:191], v2 offset:31744
 v_mul_f32 v5, v5, v65
 v_mfma_f32_16x16x32_bf16 a[252:255], a[216:219], a[184:187], a[252:255]
 ds_read_b128 a[184:187], v2 offset:30720
 v_cvt_pk_bf16_f32 v10, v6, v5
 s_waitcnt vmcnt(14) lgkmcnt(8)
 v_mfma_f32_16x16x32_bf16 v[136:139], a[224:227], a[128:131], v[136:139]
 v_accvgpr_read_b32 v5, a19
 v_lshlrev_b32 v6, 16, v5
 v_mfma_f32_16x16x32_bf16 v[136:139], a[228:231], a[132:135], v[136:139]
 global_load_dwordx4 a[220:223], v0, s[70:71] offset:-1024 sc1
 v_and_b32 v5, s26, v5
 v_mfma_f32_16x16x32_bf16 v[140:143], a[228:231], a[140:143], v[140:143]
 v_mul_f32 v6, v6, v66
 v_mul_f32 v5, v5, v67
 v_mfma_f32_16x16x32_bf16 v[140:143], a[224:227], a[136:139], v[140:143]
 global_load_dwordx4 a[216:219], v0, s[70:71] offset:-2048 sc1
 v_cvt_pk_bf16_f32 v11, v6, v5
 v_mfma_f32_16x16x32_bf16 v[144:147], a[224:227], a[144:147], v[144:147]
 ds_write_b128 v3, v[8:11] offset:16384
 s_add_u32 s68, s29, 8192
 v_mfma_f32_16x16x32_bf16 v[144:147], a[228:231], a[148:151], v[144:147]
 buffer_store_dwordx4 v[8:11], v3, s[32:35], s68 offen sc1
 v_accvgpr_read_b32 v5, a48
 v_lshlrev_b32 v6, 16, v5
 v_and_b32 v5, s26, v5
 v_mul_f32 v6, v6, v96
 v_mfma_f32_16x16x32_bf16 v[148:151], a[228:231], a[156:159], v[148:151]
 v_mul_f32 v5, v5, v97
 v_cvt_pk_bf16_f32 v12, v6, v5
 v_mfma_f32_16x16x32_bf16 v[148:151], a[224:227], a[152:155], v[148:151]
 v_accvgpr_read_b32 v5, a49
 v_lshlrev_b32 v6, 16, v5
 s_waitcnt lgkmcnt(1)
 v_mfma_f32_16x16x32_bf16 v[152:155], a[224:227], a[160:163], v[152:155]
 v_and_b32 v5, s26, v5
 v_mul_f32 v6, v6, v98
 v_mfma_f32_16x16x32_bf16 v[152:155], a[228:231], a[164:167], v[152:155]
 v_mul_f32 v5, v5, v99
 v_cvt_pk_bf16_f32 v13, v6, v5
 v_mfma_f32_16x16x32_bf16 v[156:159], a[228:231], a[172:175], v[156:159]
 v_accvgpr_read_b32 v5, a50
 v_lshlrev_b32 v6, 16, v5
 v_mfma_f32_16x16x32_bf16 v[156:159], a[224:227], a[168:171], v[156:159]
 v_and_b32 v5, s26, v5
 v_mul_f32 v6, v6, v128
 v_mfma_f32_16x16x32_bf16 v[160:163], a[224:227], a[176:179], v[160:163]
 v_mul_f32 v5, v5, v129
 v_cvt_pk_bf16_f32 v14, v6, v5
 v_mfma_f32_16x16x32_bf16 v[160:163], a[228:231], a[180:183], v[160:163]
 v_accvgpr_read_b32 v5, a51
 v_lshlrev_b32 v6, 16, v5
 v_mfma_f32_16x16x32_bf16 v[164:167], a[228:231], a[188:191], v[164:167]
 v_and_b32 v5, s26, v5
 v_mul_f32 v6, v6, v130
 v_mfma_f32_16x16x32_bf16 v[164:167], a[224:227], a[184:187], v[164:167]
 v_mul_f32 v5, v5, v131
 v_cvt_pk_bf16_f32 v15, v6, v5
 s_waitcnt vmcnt(14)
 v_mfma_f32_16x16x32_bf16 v[196:199], a[232:235], a[184:187], v[196:199]
 ds_write_b128 v3, v[12:15] offset:17408
 v_mfma_f32_16x16x32_bf16 v[196:199], a[236:239], a[188:191], v[196:199]
 buffer_store_dwordx4 v[12:15], v3, s[32:35], s68 offen offset:1024 sc1
 global_load_dwordx4 a[228:231], v0, s[70:71] offset:1024 sc1
 v_accvgpr_read_b32 v5, a20
 v_lshlrev_b32 v6, 16, v5
 v_and_b32 v5, s26, v5
 v_mfma_f32_16x16x32_bf16 v[192:195], a[236:239], a[180:183], v[192:195]
 v_mul_f32 v6, v6, v36
 v_mul_f32 v5, v5, v37
 v_mfma_f32_16x16x32_bf16 v[192:195], a[232:235], a[176:179], v[192:195]
 global_load_dwordx4 a[224:227], v0, s[70:71] offset:0 sc1
 v_cvt_pk_bf16_f32 v8, v6, v5
 v_mfma_f32_16x16x32_bf16 v[188:191], a[232:235], a[168:171], v[188:191]
 v_accvgpr_read_b32 v5, a21
 v_lshlrev_b32 v6, 16, v5
 v_mfma_f32_16x16x32_bf16 v[188:191], a[236:239], a[172:175], v[188:191]
 v_and_b32 v5, s26, v5
 v_mul_f32 v6, v6, v38
 v_mfma_f32_16x16x32_bf16 v[184:187], a[236:239], a[164:167], v[184:187]
 v_mul_f32 v5, v5, v39
 v_cvt_pk_bf16_f32 v9, v6, v5
 v_mfma_f32_16x16x32_bf16 v[184:187], a[232:235], a[160:163], v[184:187]
 v_accvgpr_read_b32 v5, a22
 v_lshlrev_b32 v6, 16, v5
 v_mfma_f32_16x16x32_bf16 v[180:183], a[232:235], a[152:155], v[180:183]
 v_and_b32 v5, s26, v5
 v_mul_f32 v6, v6, v68
 v_mfma_f32_16x16x32_bf16 v[180:183], a[236:239], a[156:159], v[180:183]
 v_mul_f32 v5, v5, v69
 v_cvt_pk_bf16_f32 v10, v6, v5
 v_mfma_f32_16x16x32_bf16 v[176:179], a[236:239], a[148:151], v[176:179]
 v_accvgpr_read_b32 v5, a23
 v_lshlrev_b32 v6, 16, v5
 v_mfma_f32_16x16x32_bf16 v[176:179], a[232:235], a[144:147], v[176:179]
 v_and_b32 v5, s26, v5
 v_mul_f32 v6, v6, v70
 v_mfma_f32_16x16x32_bf16 v[172:175], a[232:235], a[136:139], v[172:175]
 v_mul_f32 v5, v5, v71
 v_cvt_pk_bf16_f32 v11, v6, v5
 v_mfma_f32_16x16x32_bf16 v[172:175], a[236:239], a[140:143], v[172:175]
 ds_write_b128 v3, v[8:11] offset:20480
 v_mfma_f32_16x16x32_bf16 v[168:171], a[236:239], a[132:135], v[168:171]
 buffer_store_dwordx4 v[8:11], v3, s[32:35], s68 offen offset:2048 sc1
 v_accvgpr_read_b32 v5, a52
 v_lshlrev_b32 v6, 16, v5
 v_and_b32 v5, s26, v5
 v_mfma_f32_16x16x32_bf16 v[168:171], a[232:235], a[128:131], v[168:171]
 v_mul_f32 v6, v6, v100
 v_mul_f32 v5, v5, v101
 s_waitcnt vmcnt(15)
 v_mfma_f32_16x16x32_bf16 v[200:203], a[192:195], a[128:131], v[200:203]
 v_cvt_pk_bf16_f32 v12, v6, v5
 v_accvgpr_read_b32 v5, a53
 v_mfma_f32_16x16x32_bf16 v[200:203], a[196:199], a[132:135], v[200:203]
 global_load_dwordx4 a[236:239], v0, s[70:71] offset:3072 sc1
 v_lshlrev_b32 v6, 16, v5
 v_mfma_f32_16x16x32_bf16 v[204:207], a[196:199], a[140:143], v[204:207]
 v_and_b32 v5, s26, v5
 s_waitcnt vmcnt(15)
 v_cmp_gt_i32 vcc, s27, v4
 s_cbranch_vccnz Lspin_w
Lok_w:
 s_add_u32 s27, s27, 64
 v_mfma_f32_16x16x32_bf16 v[204:207], a[192:195], a[136:139], v[204:207]
 global_load_dwordx4 a[232:235], v0, s[70:71] offset:2048 sc1
 v_mul_f32 v6, v6, v102
 v_mfma_f32_16x16x32_bf16 v[208:211], a[192:195], a[144:147], v[208:211]
 v_mul_f32 v5, v5, v103
 v_cvt_pk_bf16_f32 v13, v6, v5
 s_add_u32 s70, s70, 1843200
 s_addc_u32 s71, s71, 0
 v_mfma_f32_16x16x32_bf16 v[208:211], a[196:199], a[148:151], v[208:211]
 v_accvgpr_read_b32 v5, a54
 v_lshlrev_b32 v6, 16, v5
 v_mfma_f32_16x16x32_bf16 v[212:215], a[196:199], a[156:159], v[212:215]
 v_and_b32 v5, s26, v5
 v_mul_f32 v6, v6, v132
 v_mfma_f32_16x16x32_bf16 v[212:215], a[192:195], a[152:155], v[212:215]
 v_mul_f32 v5, v5, v133
 v_cvt_pk_bf16_f32 v14, v6, v5
 v_mfma_f32_16x16x32_bf16 v[216:219], a[192:195], a[160:163], v[216:219]
 v_accvgpr_read_b32 v5, a55
 v_lshlrev_b32 v6, 16, v5
 v_mfma_f32_16x16x32_bf16 v[216:219], a[196:199], a[164:167], v[216:219]
 v_and_b32 v5, s26, v5
 v_mul_f32 v6, v6, v134
 v_mfma_f32_16x16x32_bf16 v[220:223], a[196:199], a[172:175], v[220:223]
 v_mul_f32 v5, v5, v135
 v_cvt_pk_bf16_f32 v15, v6, v5
 v_mfma_f32_16x16x32_bf16 v[220:223], a[192:195], a[168:171], v[220:223]
 ds_write_b128 v3, v[12:15] offset:21504
 v_mfma_f32_16x16x32_bf16 v[224:227], a[192:195], a[176:179], v[224:227]
 buffer_store_dwordx4 v[12:15], v3, s[32:35], s68 offen offset:3072 sc1
 v_accvgpr_read_b32 v5, a24
 v_lshlrev_b32 v6, 16, v5
 v_and_b32 v5, s26, v5
 v_mul_f32 v6, v6, v40
 v_mfma_f32_16x16x32_bf16 v[224:227], a[196:199], a[180:183], v[224:227]
 v_mul_f32 v5, v5, v41
 v_cvt_pk_bf16_f32 v8, v6, v5
 v_mfma_f32_16x16x32_bf16 v[228:231], a[196:199], a[188:191], v[228:231]
 v_accvgpr_read_b32 v5, a25
 v_lshlrev_b32 v6, 16, v5
 v_mfma_f32_16x16x32_bf16 v[228:231], a[192:195], a[184:187], v[228:231]
 v_and_b32 v5, s26, v5
 v_mul_f32 v6, v6, v42
 s_waitcnt vmcnt(14)
 v_mfma_f32_16x16x32_bf16 a[252:255], a[200:203], a[184:187], a[252:255]
 ds_read_b128 a[184:187], v2 offset:63488
 v_mul_f32 v5, v5, v43
 v_mfma_f32_16x16x32_bf16 a[252:255], a[204:207], a[188:191], a[252:255]
 global_load_dwordx4 a[196:199], v0, s[70:71] offset:-3072 sc1
 ds_read_b128 a[188:191], v2 offset:64512
 v_mfma_f32_16x16x32_bf16 a[248:251], a[204:207], a[180:183], a[248:251]
 ds_read_b128 a[180:183], v2 offset:60416
 v_cvt_pk_bf16_f32 v9, v6, v5
 v_mfma_f32_16x16x32_bf16 a[248:251], a[200:203], a[176:179], a[248:251]
 global_load_dwordx4 a[192:195], v0, s[70:71] offset:-4096 sc1
 ds_read_b128 a[176:179], v2 offset:59392
 v_accvgpr_read_b32 v5, a26
 v_lshlrev_b32 v6, 16, v5
 v_mfma_f32_16x16x32_bf16 v[252:255], a[200:203], a[168:171], v[252:255]
 ds_read_b128 a[168:171], v2 offset:55296
 v_and_b32 v5, s26, v5
 v_mfma_f32_16x16x32_bf16 v[252:255], a[204:207], a[172:175], v[252:255]
 ds_read_b128 a[172:175], v2 offset:56320
 v_mul_f32 v6, v6, v72
 v_mfma_f32_16x16x32_bf16 v[248:251], a[204:207], a[164:167], v[248:251]
 ds_read_b128 a[164:167], v2 offset:52224
 v_mul_f32 v5, v5, v73
 v_mfma_f32_16x16x32_bf16 v[248:251], a[200:203], a[160:163], v[248:251]
 ds_read_b128 a[160:163], v2 offset:51200
 v_cvt_pk_bf16_f32 v10, v6, v5
 v_mfma_f32_16x16x32_bf16 v[244:247], a[200:203], a[152:155], v[244:247]
 ds_read_b128 a[152:155], v2 offset:47104
 v_accvgpr_read_b32 v5, a27
 v_mfma_f32_16x16x32_bf16 v[244:247], a[204:207], a[156:159], v[244:247]
 ds_read_b128 a[156:159], v2 offset:48128
 v_lshlrev_b32 v6, 16, v5
 v_mfma_f32_16x16x32_bf16 v[240:243], a[204:207], a[148:151], v[240:243]
 ds_read_b128 a[148:151], v2 offset:44032
 v_and_b32 v5, s26, v5
 v_mfma_f32_16x16x32_bf16 v[240:243], a[200:203], a[144:147], v[240:243]
 ds_read_b128 a[144:147], v2 offset:43008
 v_mul_f32 v6, v6, v74
 v_mfma_f32_16x16x32_bf16 v[236:239], a[200:203], a[136:139], v[236:239]
 ds_read_b128 a[136:139], v2 offset:38912
 v_mul_f32 v5, v5, v75
 v_mfma_f32_16x16x32_bf16 v[236:239], a[204:207], a[140:143], v[236:239]
 ds_read_b128 a[140:143], v2 offset:39936
 v_cvt_pk_bf16_f32 v11, v6, v5
 v_mfma_f32_16x16x32_bf16 v[232:235], a[204:207], a[132:135], v[232:235]
 ds_read_b128 a[132:135], v2 offset:35840
 ds_write_b128 v3, v[8:11] offset:24576
 s_add_u32 s68, s29, 12288
 buffer_store_dwordx4 v[8:11], v3, s[32:35], s68 offen sc1
 v_accvgpr_read_b32 v5, a56
 v_lshlrev_b32 v6, 16, v5
 v_and_b32 v5, s26, v5
 v_mul_f32 v6, v6, v104
 v_mfma_f32_16x16x32_bf16 v[232:235], a[200:203], a[128:131], v[232:235]
 ds_read_b128 a[128:131], v2 offset:34816
 v_mul_f32 v5, v5, v105
 v_cvt_pk_bf16_f32 v12, v6, v5
 s_waitcnt vmcnt(14) lgkmcnt(9)
 v_mfma_f32_16x16x32_bf16 v[164:167], a[208:211], a[184:187], v[164:167]
 v_accvgpr_read_b32 v5, a57
 v_lshlrev_b32 v6, 16, v5
 v_mfma_f32_16x16x32_bf16 v[164:167], a[212:215], a[188:191], v[164:167]
 global_load_dwordx4 a[204:207], v0, s[70:71] offset:-1024 sc1
 v_and_b32 v5, s26, v5
 v_mfma_f32_16x16x32_bf16 v[160:163], a[212:215], a[180:183], v[160:163]
 v_mul_f32 v6, v6, v106
 v_mul_f32 v5, v5, v107
 v_mfma_f32_16x16x32_bf16 v[160:163], a[208:211], a[176:179], v[160:163]
 global_load_dwordx4 a[200:203], v0, s[70:71] offset:-2048 sc1
 v_cvt_pk_bf16_f32 v13, v6, v5
 v_mfma_f32_16x16x32_bf16 v[156:159], a[208:211], a[168:171], v[156:159]
 v_accvgpr_read_b32 v5, a58
 v_accvgpr_read_b32 v7, a240
 v_mfma_f32_16x16x32_bf16 v[156:159], a[212:215], a[172:175], v[156:159]
 v_lshlrev_b32 v6, 16, v5
 v_and_b32 v5, s26, v5
 v_mfma_f32_16x16x32_bf16 v[152:155], a[212:215], a[164:167], v[152:155]
 v_mul_f32 v6, v6, v7
 v_accvgpr_read_b32 v7, a241
 v_mfma_f32_16x16x32_bf16 v[152:155], a[208:211], a[160:163], v[152:155]
 v_mul_f32 v5, v5, v7
 v_cvt_pk_bf16_f32 v14, v6, v5
 s_waitcnt lgkmcnt(0)
 v_mfma_f32_16x16x32_bf16 v[148:151], a[208:211], a[152:155], v[148:151]
 v_accvgpr_read_b32 v5, a59
 v_accvgpr_read_b32 v7, a242
 v_mfma_f32_16x16x32_bf16 v[148:151], a[212:215], a[156:159], v[148:151]
 v_lshlrev_b32 v6, 16, v5
 v_and_b32 v5, s26, v5
 v_mfma_f32_16x16x32_bf16 v[144:147], a[212:215], a[148:151], v[144:147]
 v_mul_f32 v6, v6, v7
 v_accvgpr_read_b32 v7, a243
 v_mfma_f32_16x16x32_bf16 v[144:147], a[208:211], a[144:147], v[144:147]
 v_mul_f32 v5, v5, v7
 v_cvt_pk_bf16_f32 v15, v6, v5
 v_mfma_f32_16x16x32_bf16 v[140:143], a[208:211], a[136:139], v[140:143]
 ds_write_b128 v3, v[12:15] offset:25600
 v_mfma_f32_16x16x32_bf16 v[140:143], a[212:215], a[140:143], v[140:143]
 buffer_store_dwordx4 v[12:15], v3, s[32:35], s68 offen offset:1024 sc1
 v_accvgpr_read_b32 v5, a28
 v_lshlrev_b32 v6, 16, v5
 v_and_b32 v5, s26, v5
 v_mul_f32 v6, v6, v44
 v_mfma_f32_16x16x32_bf16 v[136:139], a[212:215], a[132:135], v[136:139]
 v_mul_f32 v5, v5, v45
 v_cvt_pk_bf16_f32 v8, v6, v5
 v_mfma_f32_16x16x32_bf16 v[136:139], a[208:211], a[128:131], v[136:139]
 v_accvgpr_read_b32 v5, a29
 v_lshlrev_b32 v6, 16, v5
 s_waitcnt vmcnt(14)
 v_mfma_f32_16x16x32_bf16 v[168:171], a[216:219], a[128:131], v[168:171]
 v_and_b32 v5, s26, v5
 v_mul_f32 v6, v6, v46
 v_mfma_f32_16x16x32_bf16 v[168:171], a[220:223], a[132:135], v[168:171]
 global_load_dwordx4 a[212:215], v0, s[70:71] offset:1024 sc1
 v_mul_f32 v5, v5, v47
 v_mfma_f32_16x16x32_bf16 v[172:175], a[220:223], a[140:143], v[172:175]
 v_cvt_pk_bf16_f32 v9, v6, v5
 v_accvgpr_read_b32 v5, a30
 v_mfma_f32_16x16x32_bf16 v[172:175], a[216:219], a[136:139], v[172:175]
 global_load_dwordx4 a[208:211], v0, s[70:71] offset:0 sc1
 v_lshlrev_b32 v6, 16, v5
 v_mfma_f32_16x16x32_bf16 v[176:179], a[216:219], a[144:147], v[176:179]
 v_and_b32 v5, s26, v5
 v_mul_f32 v6, v6, v76
 v_mfma_f32_16x16x32_bf16 v[176:179], a[220:223], a[148:151], v[176:179]
 v_mul_f32 v5, v5, v77
 v_cvt_pk_bf16_f32 v10, v6, v5
 v_mfma_f32_16x16x32_bf16 v[180:183], a[220:223], a[156:159], v[180:183]
 v_accvgpr_read_b32 v5, a31
 v_lshlrev_b32 v6, 16, v5
 v_mfma_f32_16x16x32_bf16 v[180:183], a[216:219], a[152:155], v[180:183]
 v_and_b32 v5, s26, v5
 v_mul_f32 v6, v6, v78
 v_mfma_f32_16x16x32_bf16 v[184:187], a[216:219], a[160:163], v[184:187]
 v_mul_f32 v5, v5, v79
 v_cvt_pk_bf16_f32 v11, v6, v5
 v_mfma_f32_16x16x32_bf16 v[184:187], a[220:223], a[164:167], v[184:187]
 ds_write_b128 v3, v[8:11] offset:28672
 v_mfma_f32_16x16x32_bf16 v[188:191], a[220:223], a[172:175], v[188:191]
 buffer_store_dwordx4 v[8:11], v3, s[32:35], s68 offen offset:2048 sc1
 v_accvgpr_read_b32 v5, a60
 v_lshlrev_b32 v6, 16, v5
 v_and_b32 v5, s26, v5
 v_mul_f32 v6, v6, v108
 v_mfma_f32_16x16x32_bf16 v[188:191], a[216:219], a[168:171], v[188:191]
 v_mul_f32 v5, v5, v109
 v_cvt_pk_bf16_f32 v12, v6, v5
 v_mfma_f32_16x16x32_bf16 v[192:195], a[216:219], a[176:179], v[192:195]
 v_accvgpr_read_b32 v5, a61
 v_lshlrev_b32 v6, 16, v5
 v_mfma_f32_16x16x32_bf16 v[192:195], a[220:223], a[180:183], v[192:195]
 v_and_b32 v5, s26, v5
 v_mul_f32 v6, v6, v110
 v_mfma_f32_16x16x32_bf16 v[196:199], a[220:223], a[188:191], v[196:199]
 v_mul_f32 v5, v5, v111
 v_cvt_pk_bf16_f32 v13, v6, v5
 v_mfma_f32_16x16x32_bf16 v[196:199], a[216:219], a[184:187], v[196:199]
 v_accvgpr_read_b32 v5, a62
 v_accvgpr_read_b32 v7, a244
 s_waitcnt vmcnt(13)
 v_mfma_f32_16x16x32_bf16 v[228:231], a[224:227], a[184:187], v[228:231]
 v_lshlrev_b32 v6, 16, v5
 v_and_b32 v5, s26, v5
 v_mfma_f32_16x16x32_bf16 v[228:231], a[228:231], a[188:191], v[228:231]
 global_load_dwordx4 a[220:223], v0, s[70:71] offset:3072 sc1
 v_mul_f32 v6, v6, v7
 v_mfma_f32_16x16x32_bf16 v[224:227], a[228:231], a[180:183], v[224:227]
 v_accvgpr_read_b32 v7, a245
 v_mul_f32 v5, v5, v7
 v_mfma_f32_16x16x32_bf16 v[224:227], a[224:227], a[176:179], v[224:227]
 global_load_dwordx4 a[216:219], v0, s[70:71] offset:2048 sc1
 v_cvt_pk_bf16_f32 v14, v6, v5
 v_mfma_f32_16x16x32_bf16 v[220:223], a[224:227], a[168:171], v[220:223]
 v_accvgpr_read_b32 v5, a63
 v_accvgpr_read_b32 v7, a246
 s_add_u32 s70, s70, 8192
 s_addc_u32 s71, s71, 0
 v_mfma_f32_16x16x32_bf16 v[220:223], a[228:231], a[172:175], v[220:223]
 v_lshlrev_b32 v6, 16, v5
 v_and_b32 v5, s26, v5
 v_mfma_f32_16x16x32_bf16 v[216:219], a[228:231], a[164:167], v[216:219]
 v_mul_f32 v6, v6, v7
 v_accvgpr_read_b32 v7, a247
 v_mfma_f32_16x16x32_bf16 v[216:219], a[224:227], a[160:163], v[216:219]
 v_mul_f32 v5, v5, v7
 v_cvt_pk_bf16_f32 v15, v6, v5
 v_mfma_f32_16x16x32_bf16 v[212:215], a[224:227], a[152:155], v[212:215]
 ds_write_b128 v3, v[12:15] offset:29696
 v_mfma_f32_16x16x32_bf16 v[212:215], a[228:231], a[156:159], v[212:215]
 buffer_store_dwordx4 v[12:15], v3, s[32:35], s68 offen offset:3072 sc1
 v_mfma_f32_16x16x32_bf16 v[208:211], a[228:231], a[148:151], v[208:211]
 s_waitcnt lgkmcnt(0)
 s_barrier
 v_mfma_f32_16x16x32_bf16 v[208:211], a[224:227], a[144:147], v[208:211]
 v_mfma_f32_16x16x32_bf16 v[204:207], a[224:227], a[136:139], v[204:207]
 v_mfma_f32_16x16x32_bf16 v[204:207], a[228:231], a[140:143], v[204:207]
 v_mfma_f32_16x16x32_bf16 v[200:203], a[228:231], a[132:135], v[200:203]
 v_mfma_f32_16x16x32_bf16 v[200:203], a[224:227], a[128:131], v[200:203]
 s_waitcnt vmcnt(13)
 v_mfma_f32_16x16x32_bf16 v[232:235], a[232:235], a[128:131], v[232:235]
 ds_read_b128 a[128:131], v1
 v_mfma_f32_16x16x32_bf16 v[232:235], a[236:239], a[132:135], v[232:235]
 global_load_dwordx4 a[228:231], v0, s[70:71] offset:-3072 sc1
 ds_read_b128 a[132:135], v1 offset:1024
 v_mfma_f32_16x16x32_bf16 v[236:239], a[236:239], a[140:143], v[236:239]
 ds_read_b128 a[140:143], v1 offset:5120
 v_mfma_f32_16x16x32_bf16 v[236:239], a[232:235], a[136:139], v[236:239]
 global_load_dwordx4 a[224:227], v0, s[70:71] offset:-4096 sc1
 ds_read_b128 a[136:139], v1 offset:4096
 v_mfma_f32_16x16x32_bf16 v[240:243], a[232:235], a[144:147], v[240:243]
 ds_read_b128 a[144:147], v1 offset:8192
 v_mfma_f32_16x16x32_bf16 v[240:243], a[236:239], a[148:151], v[240:243]
 ds_read_b128 a[148:151], v1 offset:9216
 v_mfma_f32_16x16x32_bf16 v[244:247], a[236:239], a[156:159], v[244:247]
 ds_read_b128 a[156:159], v1 offset:13312
 v_mfma_f32_16x16x32_bf16 v[244:247], a[232:235], a[152:155], v[244:247]
 ds_read_b128 a[152:155], v1 offset:12288
 v_mfma_f32_16x16x32_bf16 v[248:251], a[232:235], a[160:163], v[248:251]
 ds_read_b128 a[160:163], v1 offset:16384
 v_mfma_f32_16x16x32_bf16 v[248:251], a[236:239], a[164:167], v[248:251]
 ds_read_b128 a[164:167], v1 offset:17408
 v_mfma_f32_16x16x32_bf16 v[252:255], a[236:239], a[172:175], v[252:255]
 ds_read_b128 a[172:175], v1 offset:21504
 v_mfma_f32_16x16x32_bf16 v[252:255], a[232:235], a[168:171], v[252:255]
 ds_read_b128 a[168:171], v1 offset:20480
 v_mfma_f32_16x16x32_bf16 a[248:251], a[232:235], a[176:179], a[248:251]
 ds_read_b128 a[176:179], v1 offset:24576
 v_mfma_f32_16x16x32_bf16 a[248:251], a[236:239], a[180:183], a[248:251]
 ds_read_b128 a[180:183], v1 offset:25600
 v_mfma_f32_16x16x32_bf16 a[252:255], a[236:239], a[188:191], a[252:255]
 global_load_dwordx4 a[236:239], v0, s[70:71] offset:-1024 sc1
 ds_read_b128 a[188:191], v1 offset:29696
 v_mfma_f32_16x16x32_bf16 a[252:255], a[232:235], a[184:187], a[252:255]
 global_load_dwordx4 a[232:235], v0, s[70:71] offset:-2048 sc1
 ds_read_b128 a[184:187], v1 offset:28672
 s_waitcnt vmcnt(14) lgkmcnt(8)
 v_mfma_f32_16x16x32_bf16 v[16:19], a[192:195], a[128:131], v[16:19]
 v_accvgpr_read_b32 v5, a64
 v_lshlrev_b32 v6, 16, v5
 v_mfma_f32_16x16x32_bf16 v[16:19], a[196:199], a[132:135], v[16:19]
 v_and_b32 v5, s26, v5
 v_mfma_f32_16x16x32_bf16 v[20:23], a[196:199], a[140:143], v[20:23]
 v_mul_f32 v6, v6, v136
 v_mul_f32 v5, v5, v137
 v_mfma_f32_16x16x32_bf16 v[20:23], a[192:195], a[136:139], v[20:23]
 v_cvt_pk_bf16_f32 v8, v6, v5
 v_accvgpr_read_b32 v5, a65
 v_mfma_f32_16x16x32_bf16 v[24:27], a[192:195], a[144:147], v[24:27]
 v_lshlrev_b32 v6, 16, v5
 v_mfma_f32_16x16x32_bf16 v[24:27], a[196:199], a[148:151], v[24:27]
 v_and_b32 v5, s26, v5
 v_mul_f32 v6, v6, v138
 v_mfma_f32_16x16x32_bf16 v[28:31], a[196:199], a[156:159], v[28:31]
 v_mul_f32 v5, v5, v139
 v_cvt_pk_bf16_f32 v9, v6, v5
 v_mfma_f32_16x16x32_bf16 v[28:31], a[192:195], a[152:155], v[28:31]
 v_accvgpr_read_b32 v5, a66
 v_lshlrev_b32 v6, 16, v5
 s_waitcnt lgkmcnt(0)
 v_mfma_f32_16x16x32_bf16 v[32:35], a[192:195], a[160:163], v[32:35]
 v_and_b32 v5, s26, v5
 v_mul_f32 v6, v6, v168
 v_mfma_f32_16x16x32_bf16 v[32:35], a[196:199], a[164:167], v[32:35]
 v_mul_f32 v5, v5, v169
 v_cvt_pk_bf16_f32 v10, v6, v5
 v_mfma_f32_16x16x32_bf16 v[36:39], a[196:199], a[172:175], v[36:39]
 v_accvgpr_read_b32 v5, a67
 v_lshlrev_b32 v6, 16, v5
 v_mfma_f32_16x16x32_bf16 v[36:39], a[192:195], a[168:171], v[36:39]
 v_and_b32 v5, s26, v5
 v_mul_f32 v6, v6, v170
 v_mfma_f32_16x16x32_bf16 v[40:43], a[192:195], a[176:179], v[40:43]
 v_mul_f32 v5, v5, v171
 v_cvt_pk_bf16_f32 v11, v6, v5
 v_mfma_f32_16x16x32_bf16 v[40:43], a[196:199], a[180:183], v[40:43]
 ds_write_b128 v3, v[8:11] offset:2048
 v_mfma_f32_16x16x32_bf16 v[44:47], a[196:199], a[188:191], v[44:47]
 s_add_u32 s68, s29, 16384
 buffer_store_dwordx4 v[8:11], v3, s[32:35], s68 offen sc1
 v_mfma_f32_16x16x32_bf16 v[44:47], a[192:195], a[184:187], v[44:47]
 v_accvgpr_read_b32 v5, a96
 s_waitcnt vmcnt(12)
 v_mfma_f32_16x16x32_bf16 v[76:79], a[200:203], a[184:187], v[76:79]
 v_lshlrev_b32 v6, 16, v5
 v_mfma_f32_16x16x32_bf16 v[76:79], a[204:207], a[188:191], v[76:79]
 global_load_dwordx4 a[196:199], v0, s[70:71] offset:1024 sc1
 v_and_b32 v5, s26, v5
 v_mfma_f32_16x16x32_bf16 v[72:75], a[204:207], a[180:183], v[72:75]
 v_mul_f32 v6, v6, v200
 v_mul_f32 v5, v5, v201
 v_mfma_f32_16x16x32_bf16 v[72:75], a[200:203], a[176:179], v[72:75]
 global_load_dwordx4 a[192:195], v0, s[70:71] offset:0 sc1
 v_cvt_pk_bf16_f32 v12, v6, v5
 v_mfma_f32_16x16x32_bf16 v[68:71], a[200:203], a[168:171], v[68:71]
 v_accvgpr_read_b32 v5, a97
 v_lshlrev_b32 v6, 16, v5
 v_mfma_f32_16x16x32_bf16 v[68:71], a[204:207], a[172:175], v[68:71]
 v_and_b32 v5, s26, v5
 v_mul_f32 v6, v6, v202
 v_mfma_f32_16x16x32_bf16 v[64:67], a[204:207], a[164:167], v[64:67]
 v_mul_f32 v5, v5, v203
 v_cvt_pk_bf16_f32 v13, v6, v5
 v_mfma_f32_16x16x32_bf16 v[64:67], a[200:203], a[160:163], v[64:67]
 v_accvgpr_read_b32 v5, a98
 v_lshlrev_b32 v6, 16, v5
 v_mfma_f32_16x16x32_bf16 v[60:63], a[200:203], a[152:155], v[60:63]
 v_and_b32 v5, s26, v5
 v_mul_f32 v6, v6, v232
 v_mfma_f32_16x16x32_bf16 v[60:63], a[204:207], a[156:159], v[60:63]
 v_mul_f32 v5, v5, v233
 v_cvt_pk_bf16_f32 v14, v6, v5
 v_mfma_f32_16x16x32_bf16 v[56:59], a[204:207], a[148:151], v[56:59]
 v_accvgpr_read_b32 v5, a99
 v_lshlrev_b32 v6, 16, v5
 v_mfma_f32_16x16x32_bf16 v[56:59], a[200:203], a[144:147], v[56:59]
 v_and_b32 v5, s26, v5
 v_mul_f32 v6, v6, v234
 v_mfma_f32_16x16x32_bf16 v[52:55], a[200:203], a[136:139], v[52:55]
 v_mul_f32 v5, v5, v235
 v_cvt_pk_bf16_f32 v15, v6, v5
 v_mfma_f32_16x16x32_bf16 v[52:55], a[204:207], a[140:143], v[52:55]
 ds_write_b128 v3, v[12:15] offset:3072
 v_mfma_f32_16x16x32_bf16 v[48:51], a[204:207], a[132:135], v[48:51]
 buffer_store_dwordx4 v[12:15], v3, s[32:35], s68 offen offset:1024 sc1
 v_mfma_f32_16x16x32_bf16 v[48:51], a[200:203], a[128:131], v[48:51]
 v_accvgpr_read_b32 v5, a68
 v_lshlrev_b32 v6, 16, v5
 s_waitcnt vmcnt(12)
 v_mfma_f32_16x16x32_bf16 v[80:83], a[208:211], a[128:131], v[80:83]
 v_and_b32 v5, s26, v5
 v_mul_f32 v6, v6, v140
 v_mfma_f32_16x16x32_bf16 v[80:83], a[212:215], a[132:135], v[80:83]
 global_load_dwordx4 a[204:207], v0, s[70:71] offset:3072 sc1
 v_mul_f32 v5, v5, v141
 v_mfma_f32_16x16x32_bf16 v[84:87], a[212:215], a[140:143], v[84:87]
 v_cvt_pk_bf16_f32 v8, v6, v5
 v_accvgpr_read_b32 v5, a69
 v_mfma_f32_16x16x32_bf16 v[84:87], a[208:211], a[136:139], v[84:87]
 global_load_dwordx4 a[200:203], v0, s[70:71] offset:2048 sc1
 v_lshlrev_b32 v6, 16, v5
 v_mfma_f32_16x16x32_bf16 v[88:91], a[208:211], a[144:147], v[88:91]
 v_and_b32 v5, s26, v5
 v_mul_f32 v6, v6, v142
 s_add_u32 s70, s70, 8192
 s_addc_u32 s71, s71, 0
 v_mfma_f32_16x16x32_bf16 v[88:91], a[212:215], a[148:151], v[88:91]
 v_mul_f32 v5, v5, v143
 v_cvt_pk_bf16_f32 v9, v6, v5
 v_mfma_f32_16x16x32_bf16 v[92:95], a[212:215], a[156:159], v[92:95]
 v_accvgpr_read_b32 v5, a70
 v_lshlrev_b32 v6, 16, v5
 v_mfma_f32_16x16x32_bf16 v[92:95], a[208:211], a[152:155], v[92:95]
 v_and_b32 v5, s26, v5
 v_mul_f32 v6, v6, v172
 v_mfma_f32_16x16x32_bf16 v[96:99], a[208:211], a[160:163], v[96:99]
 v_mul_f32 v5, v5, v173
 v_cvt_pk_bf16_f32 v10, v6, v5
 v_mfma_f32_16x16x32_bf16 v[96:99], a[212:215], a[164:167], v[96:99]
 v_accvgpr_read_b32 v5, a71
 v_lshlrev_b32 v6, 16, v5
 v_mfma_f32_16x16x32_bf16 v[100:103], a[212:215], a[172:175], v[100:103]
 v_and_b32 v5, s26, v5
 v_mul_f32 v6, v6, v174
 v_mfma_f32_16x16x32_bf16 v[100:103], a[208:211], a[168:171], v[100:103]
 v_mul_f32 v5, v5, v175
 v_cvt_pk_bf16_f32 v11, v6, v5
 v_mfma_f32_16x16x32_bf16 v[104:107], a[208:211], a[176:179], v[104:107]
 ds_write_b128 v3, v[8:11] offset:6144
 v_mfma_f32_16x16x32_bf16 v[104:107], a[212:215], a[180:183], v[104:107]
 buffer_store_dwordx4 v[8:11], v3, s[32:35], s68 offen offset:2048 sc1
 v_accvgpr_read_b32 v5, a100
 v_lshlrev_b32 v6, 16, v5
 v_and_b32 v5, s26, v5
 v_mul_f32 v6, v6, v204
 v_mfma_f32_16x16x32_bf16 v[108:111], a[212:215], a[188:191], v[108:111]
 v_mul_f32 v5, v5, v205
 v_cvt_pk_bf16_f32 v12, v6, v5
 v_mfma_f32_16x16x32_bf16 v[108:111], a[208:211], a[184:187], v[108:111]
 v_accvgpr_read_b32 v5, a101
 v_lshlrev_b32 v6, 16, v5
 s_waitcnt vmcnt(12)
 v_mfma_f32_16x16x32_bf16 a[244:247], a[216:219], a[184:187], a[244:247]
 ds_read_b128 a[184:187], v1 offset:61440
 v_and_b32 v5, s26, v5
 v_mfma_f32_16x16x32_bf16 a[244:247], a[220:223], a[188:191], a[244:247]
 global_load_dwordx4 a[212:215], v0, s[70:71] offset:-3072 sc1
 ds_read_b128 a[188:191], v1 offset:62464
 v_mfma_f32_16x16x32_bf16 a[240:243], a[220:223], a[180:183], a[240:243]
 ds_read_b128 a[180:183], v1 offset:58368
 v_mul_f32 v6, v6, v206
 v_mfma_f32_16x16x32_bf16 a[240:243], a[216:219], a[176:179], a[240:243]
 global_load_dwordx4 a[208:211], v0, s[70:71] offset:-4096 sc1
 ds_read_b128 a[176:179], v1 offset:57344
 v_mfma_f32_16x16x32_bf16 v[132:135], a[216:219], a[168:171], v[132:135]
 ds_read_b128 a[168:171], v1 offset:53248
 v_mul_f32 v5, v5, v207
 v_mfma_f32_16x16x32_bf16 v[132:135], a[220:223], a[172:175], v[132:135]
 ds_read_b128 a[172:175], v1 offset:54272
 v_cvt_pk_bf16_f32 v13, v6, v5
 v_mfma_f32_16x16x32_bf16 v[128:131], a[220:223], a[164:167], v[128:131]
 ds_read_b128 a[164:167], v1 offset:50176
 v_accvgpr_read_b32 v5, a102
 v_lshlrev_b32 v6, 16, v5
 v_mfma_f32_16x16x32_bf16 v[128:131], a[216:219], a[160:163], v[128:131]
 ds_read_b128 a[160:163], v1 offset:49152
 v_and_b32 v5, s26, v5
 v_mul_f32 v6, v6, v236
 v_mfma_f32_16x16x32_bf16 v[124:127], a[216:219], a[152:155], v[124:127]
 ds_read_b128 a[152:155], v1 offset:45056
 v_mul_f32 v5, v5, v237
 v_mfma_f32_16x16x32_bf16 v[124:127], a[220:223], a[156:159], v[124:127]
 ds_read_b128 a[156:159], v1 offset:46080
 v_cvt_pk_bf16_f32 v14, v6, v5
 v_mfma_f32_16x16x32_bf16 v[120:123], a[220:223], a[148:151], v[120:123]
 ds_read_b128 a[148:151], v1 offset:41984
 v_accvgpr_read_b32 v5, a103
 v_mfma_f32_16x16x32_bf16 v[120:123], a[216:219], a[144:147], v[120:123]
 ds_read_b128 a[144:147], v1 offset:40960
 v_lshlrev_b32 v6, 16, v5
 v_mfma_f32_16x16x32_bf16 v[116:119], a[216:219], a[136:139], v[116:119]
 ds_read_b128 a[136:139], v1 offset:36864
 v_and_b32 v5, s26, v5
 v_mfma_f32_16x16x32_bf16 v[116:119], a[220:223], a[140:143], v[116:119]
 ds_read_b128 a[140:143], v1 offset:37888
 v_mul_f32 v6, v6, v238
 v_mfma_f32_16x16x32_bf16 v[112:115], a[220:223], a[132:135], v[112:115]
 ds_read_b128 a[132:135], v1 offset:33792
 v_mul_f32 v5, v5, v239
 v_mfma_f32_16x16x32_bf16 v[112:115], a[216:219], a[128:131], v[112:115]
 ds_read_b128 a[128:131], v1 offset:32768
 v_cvt_pk_bf16_f32 v15, v6, v5
 s_waitcnt vmcnt(11) lgkmcnt(8)
 v_mfma_f32_16x16x32_bf16 v[44:47], a[224:227], a[184:187], v[44:47]
 ds_write_b128 v3, v[12:15] offset:7168
 v_mfma_f32_16x16x32_bf16 v[44:47], a[228:231], a[188:191], v[44:47]
 buffer_store_dwordx4 v[12:15], v3, s[32:35], s68 offen offset:3072 sc1
 global_load_dwordx4 a[220:223], v0, s[70:71] offset:-1024 sc1
 v_accvgpr_read_b32 v5, a72
 v_lshlrev_b32 v6, 16, v5
 v_and_b32 v5, s26, v5
 v_mfma_f32_16x16x32_bf16 v[40:43], a[228:231], a[180:183], v[40:43]
 v_mul_f32 v6, v6, v144
 v_mul_f32 v5, v5, v145
 v_mfma_f32_16x16x32_bf16 v[40:43], a[224:227], a[176:179], v[40:43]
 global_load_dwordx4 a[216:219], v0, s[70:71] offset:-2048 sc1
 v_cvt_pk_bf16_f32 v8, v6, v5
 v_mfma_f32_16x16x32_bf16 v[36:39], a[224:227], a[168:171], v[36:39]
 v_accvgpr_read_b32 v5, a73
 v_lshlrev_b32 v6, 16, v5
 v_mfma_f32_16x16x32_bf16 v[36:39], a[228:231], a[172:175], v[36:39]
 v_and_b32 v5, s26, v5
 v_mul_f32 v6, v6, v146
 v_mfma_f32_16x16x32_bf16 v[32:35], a[228:231], a[164:167], v[32:35]
 v_mul_f32 v5, v5, v147
 v_cvt_pk_bf16_f32 v9, v6, v5
 v_mfma_f32_16x16x32_bf16 v[32:35], a[224:227], a[160:163], v[32:35]
 v_accvgpr_read_b32 v5, a74
 v_lshlrev_b32 v6, 16, v5
 s_waitcnt lgkmcnt(1)
 v_mfma_f32_16x16x32_bf16 v[28:31], a[224:227], a[152:155], v[28:31]
 v_and_b32 v5, s26, v5
 v_mul_f32 v6, v6, v176
 v_mfma_f32_16x16x32_bf16 v[28:31], a[228:231], a[156:159], v[28:31]
 v_mul_f32 v5, v5, v177
 v_cvt_pk_bf16_f32 v10, v6, v5
 v_mfma_f32_16x16x32_bf16 v[24:27], a[228:231], a[148:151], v[24:27]
 v_accvgpr_read_b32 v5, a75
 v_lshlrev_b32 v6, 16, v5
 v_mfma_f32_16x16x32_bf16 v[24:27], a[224:227], a[144:147], v[24:27]
 v_and_b32 v5, s26, v5
 v_mul_f32 v6, v6, v178
 v_mfma_f32_16x16x32_bf16 v[20:23], a[224:227], a[136:139], v[20:23]
 v_mul_f32 v5, v5, v179
 v_cvt_pk_bf16_f32 v11, v6, v5
 v_mfma_f32_16x16x32_bf16 v[20:23], a[228:231], a[140:143], v[20:23]
 ds_write_b128 v3, v[8:11] offset:10240
 s_add_u32 s68, s29, 20480
 v_mfma_f32_16x16x32_bf16 v[16:19], a[228:231], a[132:135], v[16:19]
 buffer_store_dwordx4 v[8:11], v3, s[32:35], s68 offen sc1
 v_accvgpr_read_b32 v5, a104
 v_lshlrev_b32 v6, 16, v5
 v_mfma_f32_16x16x32_bf16 v[16:19], a[224:227], a[128:131], v[16:19]
 v_and_b32 v5, s26, v5
 v_mul_f32 v6, v6, v208
 s_waitcnt vmcnt(13)
 v_mfma_f32_16x16x32_bf16 v[48:51], a[232:235], a[128:131], v[48:51]
 v_mul_f32 v5, v5, v209
 v_cvt_pk_bf16_f32 v12, v6, v5
 v_mfma_f32_16x16x32_bf16 v[48:51], a[236:239], a[132:135], v[48:51]
 global_load_dwordx4 a[228:231], v0, s[70:71] offset:1024 sc1
 v_accvgpr_read_b32 v5, a105
 v_mfma_f32_16x16x32_bf16 v[52:55], a[236:239], a[140:143], v[52:55]
 v_lshlrev_b32 v6, 16, v5
 v_and_b32 v5, s26, v5
 v_mfma_f32_16x16x32_bf16 v[52:55], a[232:235], a[136:139], v[52:55]
 global_load_dwordx4 a[224:227], v0, s[70:71] offset:0 sc1
 v_mul_f32 v6, v6, v210
 v_mfma_f32_16x16x32_bf16 v[56:59], a[232:235], a[144:147], v[56:59]
 v_mul_f32 v5, v5, v211
 v_cvt_pk_bf16_f32 v13, v6, v5
 v_mfma_f32_16x16x32_bf16 v[56:59], a[236:239], a[148:151], v[56:59]
 v_accvgpr_read_b32 v5, a106
 v_lshlrev_b32 v6, 16, v5
 v_mfma_f32_16x16x32_bf16 v[60:63], a[236:239], a[156:159], v[60:63]
 v_and_b32 v5, s26, v5
 v_mfma_f32_16x16x32_bf16 v[60:63], a[232:235], a[152:155], v[60:63]
 v_mul_f32 v6, v6, v240
 v_mul_f32 v5, v5, v241
 v_mfma_f32_16x16x32_bf16 v[64:67], a[232:235], a[160:163], v[64:67]
 v_cvt_pk_bf16_f32 v14, v6, v5
 v_accvgpr_read_b32 v5, a107
 v_mfma_f32_16x16x32_bf16 v[64:67], a[236:239], a[164:167], v[64:67]
 v_lshlrev_b32 v6, 16, v5
 v_mfma_f32_16x16x32_bf16 v[68:71], a[236:239], a[172:175], v[68:71]
 v_and_b32 v5, s26, v5
 v_mul_f32 v6, v6, v242
 v_mfma_f32_16x16x32_bf16 v[68:71], a[232:235], a[168:171], v[68:71]
 v_mul_f32 v5, v5, v243
 v_cvt_pk_bf16_f32 v15, v6, v5
 v_mfma_f32_16x16x32_bf16 v[72:75], a[232:235], a[176:179], v[72:75]
 ds_write_b128 v3, v[12:15] offset:11264
 v_mfma_f32_16x16x32_bf16 v[72:75], a[236:239], a[180:183], v[72:75]
 buffer_store_dwordx4 v[12:15], v3, s[32:35], s68 offen offset:1024 sc1
 v_accvgpr_read_b32 v5, a76
 v_lshlrev_b32 v6, 16, v5
 v_mfma_f32_16x16x32_bf16 v[76:79], a[236:239], a[188:191], v[76:79]
 v_and_b32 v5, s26, v5
 v_mul_f32 v6, v6, v148
 v_mfma_f32_16x16x32_bf16 v[76:79], a[232:235], a[184:187], v[76:79]
 v_mul_f32 v5, v5, v149
 v_cvt_pk_bf16_f32 v8, v6, v5
 s_waitcnt vmcnt(13)
 v_mfma_f32_16x16x32_bf16 v[108:111], a[192:195], a[184:187], v[108:111]
 v_accvgpr_read_b32 v5, a77
 v_lshlrev_b32 v6, 16, v5
 v_mfma_f32_16x16x32_bf16 v[108:111], a[196:199], a[188:191], v[108:111]
 global_load_dwordx4 a[236:239], v0, s[70:71] offset:3072 sc1
 v_and_b32 v5, s26, v5
 v_mfma_f32_16x16x32_bf16 v[104:107], a[196:199], a[180:183], v[104:107]
 v_mul_f32 v6, v6, v150
 v_mul_f32 v5, v5, v151
 v_mfma_f32_16x16x32_bf16 v[104:107], a[192:195], a[176:179], v[104:107]
 global_load_dwordx4 a[232:235], v0, s[70:71] offset:2048 sc1
 v_cvt_pk_bf16_f32 v9, v6, v5
 v_mfma_f32_16x16x32_bf16 v[100:103], a[192:195], a[168:171], v[100:103]
 v_accvgpr_read_b32 v5, a78
 v_lshlrev_b32 v6, 16, v5
 s_add_u32 s70, s70, 8192
 s_addc_u32 s71, s71, 0
 v_mfma_f32_16x16x32_bf16 v[100:103], a[196:199], a[172:175], v[100:103]
 v_and_b32 v5, s26, v5
 v_mul_f32 v6, v6, v180
 v_mfma_f32_16x16x32_bf16 v[96:99], a[196:199], a[164:167], v[96:99]
 v_mul_f32 v5, v5, v181
 v_cvt_pk_bf16_f32 v10, v6, v5
 v_mfma_f32_16x16x32_bf16 v[96:99], a[192:195], a[160:163], v[96:99]
 v_accvgpr_read_b32 v5, a79
 v_lshlrev_b32 v6, 16, v5
 v_mfma_f32_16x16x32_bf16 v[92:95], a[192:195], a[152:155], v[92:95]
 v_and_b32 v5, s26, v5
 v_mul_f32 v6, v6, v182
 v_mfma_f32_16x16x32_bf16 v[92:95], a[196:199], a[156:159], v[92:95]
 v_mul_f32 v5, v5, v183
 v_cvt_pk_bf16_f32 v11, v6, v5
 v_mfma_f32_16x16x32_bf16 v[88:91], a[196:199], a[148:151], v[88:91]
 ds_write_b128 v3, v[8:11] offset:14336
 v_mfma_f32_16x16x32_bf16 v[88:91], a[192:195], a[144:147], v[88:91]
 buffer_store_dwordx4 v[8:11], v3, s[32:35], s68 offen offset:2048 sc1
 v_accvgpr_read_b32 v5, a108
 v_lshlrev_b32 v6, 16, v5
 v_and_b32 v5, s26, v5
 v_mul_f32 v6, v6, v212
 v_mfma_f32_16x16x32_bf16 v[84:87], a[192:195], a[136:139], v[84:87]
 v_mul_f32 v5, v5, v213
 v_cvt_pk_bf16_f32 v12, v6, v5
 v_mfma_f32_16x16x32_bf16 v[84:87], a[196:199], a[140:143], v[84:87]
 v_accvgpr_read_b32 v5, a109
 v_lshlrev_b32 v6, 16, v5
 v_mfma_f32_16x16x32_bf16 v[80:83], a[196:199], a[132:135], v[80:83]
 v_and_b32 v5, s26, v5
 v_mul_f32 v6, v6, v214
 v_mfma_f32_16x16x32_bf16 v[80:83], a[192:195], a[128:131], v[80:83]
 v_mul_f32 v5, v5, v215
 v_cvt_pk_bf16_f32 v13, v6, v5
 s_waitcnt vmcnt(13)
 v_mfma_f32_16x16x32_bf16 v[112:115], a[200:203], a[128:131], v[112:115]
 ds_read_b128 a[128:131], v2
 v_accvgpr_read_b32 v5, a110
 v_mfma_f32_16x16x32_bf16 v[112:115], a[204:207], a[132:135], v[112:115]
 global_load_dwordx4 a[196:199], v0, s[70:71] offset:-3072 sc1
 ds_read_b128 a[132:135], v2 offset:1024
 v_mfma_f32_16x16x32_bf16 v[116:119], a[204:207], a[140:143], v[116:119]
 ds_read_b128 a[140:143], v2 offset:5120
 v_lshlrev_b32 v6, 16, v5
 v_mfma_f32_16x16x32_bf16 v[116:119], a[200:203], a[136:139], v[116:119]
 global_load_dwordx4 a[192:195], v0, s[70:71] offset:-4096 sc1
 ds_read_b128 a[136:139], v2 offset:4096
 v_mfma_f32_16x16x32_bf16 v[120:123], a[200:203], a[144:147], v[120:123]
 ds_read_b128 a[144:147], v2 offset:8192
 v_and_b32 v5, s26, v5
 v_mfma_f32_16x16x32_bf16 v[120:123], a[204:207], a[148:151], v[120:123]
 ds_read_b128 a[148:151], v2 offset:9216
 v_mul_f32 v6, v6, v244
 v_mfma_f32_16x16x32_bf16 v[124:127], a[204:207], a[156:159], v[124:127]
 ds_read_b128 a[156:159], v2 offset:13312
 v_mul_f32 v5, v5, v245
 v_cvt_pk_bf16_f32 v14, v6, v5
 v_mfma_f32_16x16x32_bf16 v[124:127], a[200:203], a[152:155], v[124:127]
 ds_read_b128 a[152:155], v2 offset:12288
 v_accvgpr_read_b32 v5, a111
 v_mfma_f32_16x16x32_bf16 v[128:131], a[200:203], a[160:163], v[128:131]
 ds_read_b128 a[160:163], v2 offset:16384
 v_lshlrev_b32 v6, 16, v5
 v_mfma_f32_16x16x32_bf16 v[128:131], a[204:207], a[164:167], v[128:131]
 ds_read_b128 a[164:167], v2 offset:17408
 v_and_b32 v5, s26, v5
 v_mfma_f32_16x16x32_bf16 v[132:135], a[204:207], a[172:175], v[132:135]
 ds_read_b128 a[172:175], v2 offset:21504
 v_mul_f32 v6, v6, v246
 v_mfma_f32_16x16x32_bf16 v[132:135], a[200:203], a[168:171], v[132:135]
 ds_read_b128 a[168:171], v2 offset:20480
 v_mul_f32 v5, v5, v247
 v_mfma_f32_16x16x32_bf16 a[240:243], a[200:203], a[176:179], a[240:243]
 ds_read_b128 a[176:179], v2 offset:24576
 v_cvt_pk_bf16_f32 v15, v6, v5
 v_mfma_f32_16x16x32_bf16 a[240:243], a[204:207], a[180:183], a[240:243]
 ds_read_b128 a[180:183], v2 offset:25600
 ds_write_b128 v3, v[12:15] offset:15360
 s_add_u32 s31, s31, 1
 v_mov_b32 v7, s31
 v_mfma_f32_16x16x32_bf16 a[244:247], a[204:207], a[188:191], a[244:247]
 buffer_store_dword v7, v1, s[60:63], 0 offen sc1
 ds_read_b128 a[188:191], v2 offset:29696
 v_mfma_f32_16x16x32_bf16 a[244:247], a[200:203], a[184:187], a[244:247]
 buffer_store_dwordx4 v[12:15], v3, s[32:35], s68 offen offset:3072 sc1
 ds_read_b128 a[184:187], v2 offset:28672
 v_accvgpr_read_b32 v5, a80
 v_lshlrev_b32 v6, 16, v5
 v_and_b32 v5, s26, v5
 s_waitcnt vmcnt(14) lgkmcnt(9)
 v_mfma_f32_16x16x32_bf16 v[16:19], a[208:211], a[128:131], v[16:19]
 v_mul_f32 v6, v6, v152
 v_mul_f32 v5, v5, v153
 v_mfma_f32_16x16x32_bf16 v[16:19], a[212:215], a[132:135], v[16:19]
 global_load_dwordx4 a[204:207], v0, s[70:71] offset:-1024 sc1
 v_cvt_pk_bf16_f32 v8, v6, v5
 v_mfma_f32_16x16x32_bf16 v[20:23], a[212:215], a[140:143], v[20:23]
 v_accvgpr_read_b32 v5, a81
 v_lshlrev_b32 v6, 16, v5
 v_mfma_f32_16x16x32_bf16 v[20:23], a[208:211], a[136:139], v[20:23]
 global_load_dwordx4 a[200:203], v0, s[70:71] offset:-2048 sc1
 v_and_b32 v5, s26, v5
 v_mfma_f32_16x16x32_bf16 v[24:27], a[208:211], a[144:147], v[24:27]
 v_mul_f32 v6, v6, v154
 v_mul_f32 v5, v5, v155
 v_mfma_f32_16x16x32_bf16 v[24:27], a[212:215], a[148:151], v[24:27]
 v_cvt_pk_bf16_f32 v9, v6, v5
 v_accvgpr_read_b32 v5, a82
 v_mfma_f32_16x16x32_bf16 v[28:31], a[212:215], a[156:159], v[28:31]
 v_lshlrev_b32 v6, 16, v5
 v_and_b32 v5, s26, v5
 v_mfma_f32_16x16x32_bf16 v[28:31], a[208:211], a[152:155], v[28:31]
 v_mul_f32 v6, v6, v184
 s_waitcnt lgkmcnt(0)
 v_mfma_f32_16x16x32_bf16 v[32:35], a[208:211], a[160:163], v[32:35]
 v_mul_f32 v5, v5, v185
 v_cvt_pk_bf16_f32 v10, v6, v5
 v_mfma_f32_16x16x32_bf16 v[32:35], a[212:215], a[164:167], v[32:35]
 v_accvgpr_read_b32 v5, a83
 v_lshlrev_b32 v6, 16, v5
 v_mfma_f32_16x16x32_bf16 v[36:39], a[212:215], a[172:175], v[36:39]
 v_and_b32 v5, s26, v5
 v_mul_f32 v6, v6, v186
 v_mfma_f32_16x16x32_bf16 v[36:39], a[208:211], a[168:171], v[36:39]
 v_mul_f32 v5, v5, v187
 v_cvt_pk_bf16_f32 v11, v6, v5
 v_mfma_f32_16x16x32_bf16 v[40:43], a[208:211], a[176:179], v[40:43]
 ds_write_b128 v3, v[8:11] offset:18432
 v_mfma_f32_16x16x32_bf16 v[40:43], a[212:215], a[180:183], v[40:43]
 s_add_u32 s68, s29, 24576
 buffer_store_dwordx4 v[8:11], v3, s[32:35], s68 offen sc1
 v_mfma_f32_16x16x32_bf16 v[44:47], a[212:215], a[188:191], v[44:47]
 v_accvgpr_read_b32 v5, a112
 v_mfma_f32_16x16x32_bf16 v[44:47], a[208:211], a[184:187], v[44:47]
 v_lshlrev_b32 v6, 16, v5
 v_and_b32 v5, s26, v5
 s_waitcnt vmcnt(14)
 v_mfma_f32_16x16x32_bf16 v[76:79], a[216:219], a[184:187], v[76:79]
 v_mul_f32 v6, v6, v216
 v_mul_f32 v5, v5, v217
 v_mfma_f32_16x16x32_bf16 v[76:79], a[220:223], a[188:191], v[76:79]
 global_load_dwordx4 a[212:215], v0, s[70:71] offset:1024 sc1
 v_cvt_pk_bf16_f32 v12, v6, v5
 v_mfma_f32_16x16x32_bf16 v[72:75], a[220:223], a[180:183], v[72:75]
 v_accvgpr_read_b32 v5, a113
 v_lshlrev_b32 v6, 16, v5
 v_mfma_f32_16x16x32_bf16 v[72:75], a[216:219], a[176:179], v[72:75]
 global_load_dwordx4 a[208:211], v0, s[70:71] offset:0 sc1
 v_and_b32 v5, s26, v5
 v_mfma_f32_16x16x32_bf16 v[68:71], a[216:219], a[168:171], v[68:71]
 v_mul_f32 v6, v6, v218
 v_mul_f32 v5, v5, v219
 v_mfma_f32_16x16x32_bf16 v[68:71], a[220:223], a[172:175], v[68:71]
 v_cvt_pk_bf16_f32 v13, v6, v5
 v_accvgpr_read_b32 v5, a114
 v_mfma_f32_16x16x32_bf16 v[64:67], a[220:223], a[164:167], v[64:67]
 v_lshlrev_b32 v6, 16, v5
 v_and_b32 v5, s26, v5
 v_mfma_f32_16x16x32_bf16 v[64:67], a[216:219], a[160:163], v[64:67]
 v_mul_f32 v6, v6, v248
 v_mul_f32 v5, v5, v249
 v_mfma_f32_16x16x32_bf16 v[60:63], a[216:219], a[152:155], v[60:63]
 v_cvt_pk_bf16_f32 v14, v6, v5
 v_mfma_f32_16x16x32_bf16 v[60:63], a[220:223], a[156:159], v[60:63]
 v_accvgpr_read_b32 v5, a115
 v_lshlrev_b32 v6, 16, v5
 v_mfma_f32_16x16x32_bf16 v[56:59], a[220:223], a[148:151], v[56:59]
 v_and_b32 v5, s26, v5
 v_mul_f32 v6, v6, v250
 v_mfma_f32_16x16x32_bf16 v[56:59], a[216:219], a[144:147], v[56:59]
 v_mul_f32 v5, v5, v251
 v_cvt_pk_bf16_f32 v15, v6, v5
 v_mfma_f32_16x16x32_bf16 v[52:55], a[216:219], a[136:139], v[52:55]
 ds_write_b128 v3, v[12:15] offset:19456
 v_mfma_f32_16x16x32_bf16 v[52:55], a[220:223], a[140:143], v[52:55]
 buffer_store_dwordx4 v[12:15], v3, s[32:35], s68 offen offset:1024 sc1
 v_accvgpr_read_b32 v5, a84
 v_mfma_f32_16x16x32_bf16 v[48:51], a[220:223], a[132:135], v[48:51]
 v_lshlrev_b32 v6, 16, v5
 v_mfma_f32_16x16x32_bf16 v[48:51], a[216:219], a[128:131], v[48:51]
 v_and_b32 v5, s26, v5
 v_mul_f32 v6, v6, v156
 s_waitcnt vmcnt(14)
 v_mfma_f32_16x16x32_bf16 v[80:83], a[224:227], a[128:131], v[80:83]
 v_mul_f32 v5, v5, v157
 v_cvt_pk_bf16_f32 v8, v6, v5
 v_mfma_f32_16x16x32_bf16 v[80:83], a[228:231], a[132:135], v[80:83]
 global_load_dwordx4 a[220:223], v0, s[70:71] offset:3072 sc1
 v_accvgpr_read_b32 v5, a85
 v_mfma_f32_16x16x32_bf16 v[84:87], a[228:231], a[140:143], v[84:87]
 v_lshlrev_b32 v6, 16, v5
 v_and_b32 v5, s26, v5
 v_mfma_f32_16x16x32_bf16 v[84:87], a[224:227], a[136:139], v[84:87]
 global_load_dwordx4 a[216:219], v0, s[70:71] offset:2048 sc1
 v_mul_f32 v6, v6, v158
 v_mfma_f32_16x16x32_bf16 v[88:91], a[224:227], a[144:147], v[88:91]
 v_mul_f32 v5, v5, v159
 v_cvt_pk_bf16_f32 v9, v6, v5
 s_add_u32 s70, s70, 8192
 s_addc_u32 s71, s71, 0
 v_mfma_f32_16x16x32_bf16 v[88:91], a[228:231], a[148:151], v[88:91]
 v_accvgpr_read_b32 v5, a86
 v_lshlrev_b32 v6, 16, v5
 v_mfma_f32_16x16x32_bf16 v[92:95], a[228:231], a[156:159], v[92:95]
 v_and_b32 v5, s26, v5
 v_mul_f32 v6, v6, v188
 v_mfma_f32_16x16x32_bf16 v[92:95], a[224:227], a[152:155], v[92:95]
 v_mul_f32 v5, v5, v189
 v_cvt_pk_bf16_f32 v10, v6, v5
 v_mfma_f32_16x16x32_bf16 v[96:99], a[224:227], a[160:163], v[96:99]
 v_accvgpr_read_b32 v5, a87
 v_lshlrev_b32 v6, 16, v5
 v_mfma_f32_16x16x32_bf16 v[96:99], a[228:231], a[164:167], v[96:99]
 v_and_b32 v5, s26, v5
 v_mul_f32 v6, v6, v190
 v_mfma_f32_16x16x32_bf16 v[100:103], a[228:231], a[172:175], v[100:103]
 v_mul_f32 v5, v5, v191
 v_cvt_pk_bf16_f32 v11, v6, v5
 v_mfma_f32_16x16x32_bf16 v[100:103], a[224:227], a[168:171], v[100:103]
 ds_write_b128 v3, v[8:11] offset:22528
 v_mfma_f32_16x16x32_bf16 v[104:107], a[224:227], a[176:179], v[104:107]
 buffer_store_dwordx4 v[8:11], v3, s[32:35], s68 offen offset:2048 sc1
 v_accvgpr_read_b32 v5, a116
 v_lshlrev_b32 v6, 16, v5
 v_and_b32 v5, s26, v5
 v_mul_f32 v6, v6, v220
 v_mfma_f32_16x16x32_bf16 v[104:107], a[228:231], a[180:183], v[104:107]
 v_mul_f32 v5, v5, v221
 v_cvt_pk_bf16_f32 v12, v6, v5
 v_mfma_f32_16x16x32_bf16 v[108:111], a[228:231], a[188:191], v[108:111]
 v_accvgpr_read_b32 v5, a117
 v_lshlrev_b32 v6, 16, v5
 v_mfma_f32_16x16x32_bf16 v[108:111], a[224:227], a[184:187], v[108:111]
 v_and_b32 v5, s26, v5
 v_mul_f32 v6, v6, v222
 s_waitcnt vmcnt(14)
 v_mfma_f32_16x16x32_bf16 a[244:247], a[232:235], a[184:187], a[244:247]
 ds_read_b128 a[184:187], v2 offset:61440
 v_mul_f32 v5, v5, v223
 v_mfma_f32_16x16x32_bf16 a[244:247], a[236:239], a[188:191], a[244:247]
 global_load_dwordx4 a[228:231], v0, s[70:71] offset:-3072 sc1
 ds_read_b128 a[188:191], v2 offset:62464
 v_mfma_f32_16x16x32_bf16 a[240:243], a[236:239], a[180:183], a[240:243]
 ds_read_b128 a[180:183], v2 offset:58368
 v_cvt_pk_bf16_f32 v13, v6, v5
 v_mfma_f32_16x16x32_bf16 a[240:243], a[232:235], a[176:179], a[240:243]
 global_load_dwordx4 a[224:227], v0, s[70:71] offset:-4096 sc1
 ds_read_b128 a[176:179], v2 offset:57344
 v_accvgpr_read_b32 v5, a118
 v_mfma_f32_16x16x32_bf16 v[132:135], a[232:235], a[168:171], v[132:135]
 ds_read_b128 a[168:171], v2 offset:53248
 v_lshlrev_b32 v6, 16, v5
 v_mfma_f32_16x16x32_bf16 v[132:135], a[236:239], a[172:175], v[132:135]
 ds_read_b128 a[172:175], v2 offset:54272
 v_and_b32 v5, s26, v5
 v_mfma_f32_16x16x32_bf16 v[128:131], a[236:239], a[164:167], v[128:131]
 ds_read_b128 a[164:167], v2 offset:50176
 v_mul_f32 v6, v6, v252
 v_mfma_f32_16x16x32_bf16 v[128:131], a[232:235], a[160:163], v[128:131]
 ds_read_b128 a[160:163], v2 offset:49152
 v_mul_f32 v5, v5, v253
 v_mfma_f32_16x16x32_bf16 v[124:127], a[232:235], a[152:155], v[124:127]
 ds_read_b128 a[152:155], v2 offset:45056
 v_cvt_pk_bf16_f32 v14, v6, v5
 v_mfma_f32_16x16x32_bf16 v[124:127], a[236:239], a[156:159], v[124:127]
 ds_read_b128 a[156:159], v2 offset:46080
 v_accvgpr_read_b32 v5, a119
 v_mfma_f32_16x16x32_bf16 v[120:123], a[236:239], a[148:151], v[120:123]
 ds_read_b128 a[148:151], v2 offset:41984
 v_lshlrev_b32 v6, 16, v5
 v_mfma_f32_16x16x32_bf16 v[120:123], a[232:235], a[144:147], v[120:123]
 ds_read_b128 a[144:147], v2 offset:40960
 v_and_b32 v5, s26, v5
 v_mfma_f32_16x16x32_bf16 v[116:119], a[232:235], a[136:139], v[116:119]
 ds_read_b128 a[136:139], v2 offset:36864
 v_mul_f32 v6, v6, v254
 v_mfma_f32_16x16x32_bf16 v[116:119], a[236:239], a[140:143], v[116:119]
 ds_read_b128 a[140:143], v2 offset:37888
 v_mul_f32 v5, v5, v255
 v_mfma_f32_16x16x32_bf16 v[112:115], a[236:239], a[132:135], v[112:115]
 ds_read_b128 a[132:135], v2 offset:33792
 v_cvt_pk_bf16_f32 v15, v6, v5
 v_mfma_f32_16x16x32_bf16 v[112:115], a[232:235], a[128:131], v[112:115]
 ds_read_b128 a[128:131], v2 offset:32768
 ds_write_b128 v3, v[12:15] offset:23552
 buffer_store_dwordx4 v[12:15], v3, s[32:35], s68 offen offset:3072 sc1
 v_accvgpr_read_b32 v5, a88
 v_lshlrev_b32 v6, 16, v5
 v_and_b32 v5, s26, v5
 s_waitcnt vmcnt(14) lgkmcnt(9)
 v_mfma_f32_16x16x32_bf16 v[44:47], a[192:195], a[184:187], v[44:47]
 v_mul_f32 v6, v6, v160
 v_mul_f32 v5, v5, v161
 v_mfma_f32_16x16x32_bf16 v[44:47], a[196:199], a[188:191], v[44:47]
 global_load_dwordx4 a[236:239], v0, s[70:71] offset:-1024 sc1
 v_cvt_pk_bf16_f32 v8, v6, v5
 v_mfma_f32_16x16x32_bf16 v[40:43], a[196:199], a[180:183], v[40:43]
 v_accvgpr_read_b32 v5, a89
 v_lshlrev_b32 v6, 16, v5
 v_mfma_f32_16x16x32_bf16 v[40:43], a[192:195], a[176:179], v[40:43]
 global_load_dwordx4 a[232:235], v0, s[70:71] offset:-2048 sc1
 v_and_b32 v5, s26, v5
 v_mfma_f32_16x16x32_bf16 v[36:39], a[192:195], a[168:171], v[36:39]
 v_mul_f32 v6, v6, v162
 v_mul_f32 v5, v5, v163
 v_mfma_f32_16x16x32_bf16 v[36:39], a[196:199], a[172:175], v[36:39]
 v_cvt_pk_bf16_f32 v9, v6, v5
 v_accvgpr_read_b32 v5, a90
 v_mfma_f32_16x16x32_bf16 v[32:35], a[196:199], a[164:167], v[32:35]
 v_lshlrev_b32 v6, 16, v5
 v_and_b32 v5, s26, v5
 v_mfma_f32_16x16x32_bf16 v[32:35], a[192:195], a[160:163], v[32:35]
 v_mul_f32 v6, v6, v192
 v_mul_f32 v5, v5, v193
 s_waitcnt lgkmcnt(1)
 v_mfma_f32_16x16x32_bf16 v[28:31], a[192:195], a[152:155], v[28:31]
 v_cvt_pk_bf16_f32 v10, v6, v5
 v_accvgpr_read_b32 v5, a91
 v_mfma_f32_16x16x32_bf16 v[28:31], a[196:199], a[156:159], v[28:31]
 v_lshlrev_b32 v6, 16, v5
 v_and_b32 v5, s26, v5
 v_mfma_f32_16x16x32_bf16 v[24:27], a[196:199], a[148:151], v[24:27]
 v_mul_f32 v6, v6, v194
 v_mul_f32 v5, v5, v195
 v_mfma_f32_16x16x32_bf16 v[24:27], a[192:195], a[144:147], v[24:27]
 v_cvt_pk_bf16_f32 v11, v6, v5
 v_mfma_f32_16x16x32_bf16 v[20:23], a[192:195], a[136:139], v[20:23]
 ds_write_b128 v3, v[8:11] offset:26624
 s_add_u32 s68, s29, 28672
 v_mfma_f32_16x16x32_bf16 v[20:23], a[196:199], a[140:143], v[20:23]
 buffer_store_dwordx4 v[8:11], v3, s[32:35], s68 offen sc1
 v_accvgpr_read_b32 v5, a120
 v_lshlrev_b32 v6, 16, v5
 v_and_b32 v5, s26, v5
 v_mfma_f32_16x16x32_bf16 v[16:19], a[196:199], a[132:135], v[16:19]
 v_mul_f32 v6, v6, v224
 v_mul_f32 v5, v5, v225
 v_mfma_f32_16x16x32_bf16 v[16:19], a[192:195], a[128:131], v[16:19]
 v_cvt_pk_bf16_f32 v12, v6, v5
 v_accvgpr_read_b32 v5, a121
 s_waitcnt vmcnt(13)
 v_mfma_f32_16x16x32_bf16 v[48:51], a[200:203], a[128:131], v[48:51]
 v_lshlrev_b32 v6, 16, v5
 v_and_b32 v5, s26, v5
 v_mfma_f32_16x16x32_bf16 v[48:51], a[204:207], a[132:135], v[48:51]
 global_load_dwordx4 a[196:199], v0, s[70:71] offset:1024 sc1
 v_mul_f32 v6, v6, v226
 v_mfma_f32_16x16x32_bf16 v[52:55], a[204:207], a[140:143], v[52:55]
 v_mul_f32 v5, v5, v227
 v_cvt_pk_bf16_f32 v13, v6, v5
 v_mfma_f32_16x16x32_bf16 v[52:55], a[200:203], a[136:139], v[52:55]
 global_load_dwordx4 a[192:195], v0, s[70:71] offset:0 sc1
 v_accvgpr_read_b32 v5, a122
 v_mfma_f32_16x16x32_bf16 v[56:59], a[200:203], a[144:147], v[56:59]
 v_accvgpr_read_b32 v7, a248
 v_lshlrev_b32 v6, 16, v5
 v_mfma_f32_16x16x32_bf16 v[56:59], a[204:207], a[148:151], v[56:59]
 v_and_b32 v5, s26, v5
 v_mul_f32 v6, v6, v7
 v_mfma_f32_16x16x32_bf16 v[60:63], a[204:207], a[156:159], v[60:63]
 v_accvgpr_read_b32 v7, a249
 v_mfma_f32_16x16x32_bf16 v[60:63], a[200:203], a[152:155], v[60:63]
 v_mul_f32 v5, v5, v7
 v_cvt_pk_bf16_f32 v14, v6, v5
 v_mfma_f32_16x16x32_bf16 v[64:67], a[200:203], a[160:163], v[64:67]
 v_accvgpr_read_b32 v5, a123
 v_accvgpr_read_b32 v7, a250
 v_mfma_f32_16x16x32_bf16 v[64:67], a[204:207], a[164:167], v[64:67]
 v_lshlrev_b32 v6, 16, v5
 v_mfma_f32_16x16x32_bf16 v[68:71], a[204:207], a[172:175], v[68:71]
 v_and_b32 v5, s26, v5
 v_mul_f32 v6, v6, v7
 v_mfma_f32_16x16x32_bf16 v[68:71], a[200:203], a[168:171], v[68:71]
 v_accvgpr_read_b32 v7, a251
 v_mul_f32 v5, v5, v7
 v_mfma_f32_16x16x32_bf16 v[72:75], a[200:203], a[176:179], v[72:75]
 v_cvt_pk_bf16_f32 v15, v6, v5
 v_mfma_f32_16x16x32_bf16 v[72:75], a[204:207], a[180:183], v[72:75]
 ds_write_b128 v3, v[12:15] offset:27648
 v_mfma_f32_16x16x32_bf16 v[76:79], a[204:207], a[188:191], v[76:79]
 buffer_store_dwordx4 v[12:15], v3, s[32:35], s68 offen offset:1024 sc1
 v_accvgpr_read_b32 v5, a92
 v_lshlrev_b32 v6, 16, v5
 v_mfma_f32_16x16x32_bf16 v[76:79], a[200:203], a[184:187], v[76:79]
 v_and_b32 v5, s26, v5
 v_mul_f32 v6, v6, v164
 s_waitcnt vmcnt(13)
 v_mfma_f32_16x16x32_bf16 v[108:111], a[208:211], a[184:187], v[108:111]
 v_mul_f32 v5, v5, v165
 v_cvt_pk_bf16_f32 v8, v6, v5
 v_mfma_f32_16x16x32_bf16 v[108:111], a[212:215], a[188:191], v[108:111]
 global_load_dwordx4 a[204:207], v0, s[70:71] offset:3072 sc1
 v_accvgpr_read_b32 v5, a93
 v_mfma_f32_16x16x32_bf16 v[104:107], a[212:215], a[180:183], v[104:107]
 v_lshlrev_b32 v6, 16, v5
 v_and_b32 v5, s26, v5
 v_mfma_f32_16x16x32_bf16 v[104:107], a[208:211], a[176:179], v[104:107]
 global_load_dwordx4 a[200:203], v0, s[70:71] offset:2048 sc1
 v_mul_f32 v6, v6, v166
 v_mfma_f32_16x16x32_bf16 v[100:103], a[208:211], a[168:171], v[100:103]
 v_mul_f32 v5, v5, v167
 v_cvt_pk_bf16_f32 v9, v6, v5
 s_add_u32 s70, s70, 8192
 s_addc_u32 s71, s71, 0
 v_mfma_f32_16x16x32_bf16 v[100:103], a[212:215], a[172:175], v[100:103]
 v_accvgpr_read_b32 v5, a94
 v_lshlrev_b32 v6, 16, v5
 v_mfma_f32_16x16x32_bf16 v[96:99], a[212:215], a[164:167], v[96:99]
 v_and_b32 v5, s26, v5
 v_mul_f32 v6, v6, v196
 v_mfma_f32_16x16x32_bf16 v[96:99], a[208:211], a[160:163], v[96:99]
 v_mul_f32 v5, v5, v197
 v_cvt_pk_bf16_f32 v10, v6, v5
 v_mfma_f32_16x16x32_bf16 v[92:95], a[208:211], a[152:155], v[92:95]
 v_accvgpr_read_b32 v5, a95
 v_lshlrev_b32 v6, 16, v5
 v_mfma_f32_16x16x32_bf16 v[92:95], a[212:215], a[156:159], v[92:95]
 v_and_b32 v5, s26, v5
 v_mul_f32 v6, v6, v198
 v_mfma_f32_16x16x32_bf16 v[88:91], a[212:215], a[148:151], v[88:91]
 v_mul_f32 v5, v5, v199
 v_cvt_pk_bf16_f32 v11, v6, v5
 v_mfma_f32_16x16x32_bf16 v[88:91], a[208:211], a[144:147], v[88:91]
 ds_write_b128 v3, v[8:11] offset:30720
 v_mfma_f32_16x16x32_bf16 v[84:87], a[208:211], a[136:139], v[84:87]
 buffer_store_dwordx4 v[8:11], v3, s[32:35], s68 offen offset:2048 sc1
 v_accvgpr_read_b32 v5, a124
 v_lshlrev_b32 v6, 16, v5
 v_and_b32 v5, s26, v5
 v_mul_f32 v6, v6, v228
 v_mfma_f32_16x16x32_bf16 v[84:87], a[212:215], a[140:143], v[84:87]
 v_mul_f32 v5, v5, v229
 v_cvt_pk_bf16_f32 v12, v6, v5
 v_mfma_f32_16x16x32_bf16 v[80:83], a[212:215], a[132:135], v[80:83]
 v_accvgpr_read_b32 v5, a125
 v_lshlrev_b32 v6, 16, v5
 v_mfma_f32_16x16x32_bf16 v[80:83], a[208:211], a[128:131], v[80:83]
 v_and_b32 v5, s26, v5
 v_mul_f32 v6, v6, v230
 s_waitcnt vmcnt(13)
 v_mfma_f32_16x16x32_bf16 v[112:115], a[216:219], a[128:131], v[112:115]
 ds_read_b128 a[128:131], v1
 v_mul_f32 v5, v5, v231
 v_mfma_f32_16x16x32_bf16 v[112:115], a[220:223], a[132:135], v[112:115]
 global_load_dwordx4 a[212:215], v0, s[70:71] offset:-3072 sc1
 ds_read_b128 a[132:135], v1 offset:1024
 v_mfma_f32_16x16x32_bf16 v[116:119], a[220:223], a[140:143], v[116:119]
 ds_read_b128 a[140:143], v1 offset:5120
 v_cvt_pk_bf16_f32 v13, v6, v5
 v_mfma_f32_16x16x32_bf16 v[116:119], a[216:219], a[136:139], v[116:119]
 global_load_dwordx4 a[208:211], v0, s[70:71] offset:-4096 sc1
 ds_read_b128 a[136:139], v1 offset:4096
 v_mfma_f32_16x16x32_bf16 v[120:123], a[216:219], a[144:147], v[120:123]
 ds_read_b128 a[144:147], v1 offset:8192
 v_accvgpr_read_b32 v5, a126
 v_mfma_f32_16x16x32_bf16 v[120:123], a[220:223], a[148:151], v[120:123]
 ds_read_b128 a[148:151], v1 offset:9216
 v_accvgpr_read_b32 v7, a252
 v_lshlrev_b32 v6, 16, v5
 v_mfma_f32_16x16x32_bf16 v[124:127], a[220:223], a[156:159], v[124:127]
 ds_read_b128 a[156:159], v1 offset:13312
 v_and_b32 v5, s26, v5
 v_mfma_f32_16x16x32_bf16 v[124:127], a[216:219], a[152:155], v[124:127]
 ds_read_b128 a[152:155], v1 offset:12288
 v_mul_f32 v6, v6, v7
 v_accvgpr_read_b32 v7, a253
 v_mfma_f32_16x16x32_bf16 v[128:131], a[216:219], a[160:163], v[128:131]
 ds_read_b128 a[160:163], v1 offset:16384
 v_mul_f32 v5, v5, v7
 v_cvt_pk_bf16_f32 v14, v6, v5
 v_mfma_f32_16x16x32_bf16 v[128:131], a[220:223], a[164:167], v[128:131]
 ds_read_b128 a[164:167], v1 offset:17408
 v_accvgpr_read_b32 v5, a127
 v_accvgpr_read_b32 v7, a254
 v_mfma_f32_16x16x32_bf16 v[132:135], a[220:223], a[172:175], v[132:135]
 ds_read_b128 a[172:175], v1 offset:21504
 v_lshlrev_b32 v6, 16, v5
 v_mfma_f32_16x16x32_bf16 v[132:135], a[216:219], a[168:171], v[132:135]
 ds_read_b128 a[168:171], v1 offset:20480
 v_and_b32 v5, s26, v5
 v_mul_f32 v6, v6, v7
 v_mfma_f32_16x16x32_bf16 a[240:243], a[216:219], a[176:179], a[240:243]
 ds_read_b128 a[176:179], v1 offset:24576
 v_accvgpr_read_b32 v7, a255
 v_mul_f32 v5, v5, v7
 v_cvt_pk_bf16_f32 v15, v6, v5
 v_mfma_f32_16x16x32_bf16 a[240:243], a[220:223], a[180:183], a[240:243]
 ds_read_b128 a[180:183], v1 offset:25600
 ds_write_b128 v3, v[12:15] offset:31744
 v_mfma_f32_16x16x32_bf16 a[244:247], a[220:223], a[188:191], a[244:247]
 buffer_store_dwordx4 v[12:15], v3, s[32:35], s68 offen offset:3072 sc1
 global_load_dwordx4 a[220:223], v0, s[70:71] offset:-1024 sc1
 ds_read_b128 a[188:191], v1 offset:29696
 v_mfma_f32_16x16x32_bf16 a[244:247], a[216:219], a[184:187], a[244:247]
 global_load_dwordx4 a[216:219], v0, s[70:71] offset:-2048 sc1
 ds_read_b128 a[184:187], v1 offset:28672
 s_waitcnt vmcnt(15) lgkmcnt(9)
 s_branch Ls1b
Llast:
 v_mfma_f32_16x16x32_bf16 v[136:139], a[208:211], a[128:131], v[136:139]
 v_accvgpr_read_b32 v5, a0
 v_lshlrev_b32 v6, 16, v5
 v_mfma_f32_16x16x32_bf16 v[136:139], a[212:215], a[132:135], v[136:139]
 v_and_b32 v5, s26, v5
 v_mul_f32 v6, v6, v16
 v_mfma_f32_16x16x32_bf16 v[140:143], a[212:215], a[140:143], v[140:143]
 v_mul_f32 v5, v5, v17
 v_cvt_pk_bf16_f32 v8, v6, v5
 v_mfma_f32_16x16x32_bf16 v[140:143], a[208:211], a[136:139], v[140:143]
 v_accvgpr_read_b32 v5, a1
 v_lshlrev_b32 v6, 16, v5
 v_mfma_f32_16x16x32_bf16 v[144:147], a[208:211], a[144:147], v[144:147]
 v_and_b32 v5, s26, v5
 v_mul_f32 v6, v6, v18
 v_mfma_f32_16x16x32_bf16 v[144:147], a[212:215], a[148:151], v[144:147]
 v_mul_f32 v5, v5, v19
 v_cvt_pk_bf16_f32 v9, v6, v5
 v_mfma_f32_16x16x32_bf16 v[148:151], a[212:215], a[156:159], v[148:151]
 v_accvgpr_read_b32 v5, a2
 v_lshlrev_b32 v6, 16, v5
 v_mfma_f32_16x16x32_bf16 v[148:151], a[208:211], a[152:155], v[148:151]
 v_and_b32 v5, s26, v5
 v_mul_f32 v6, v6, v48
 s_waitcnt lgkmcnt(0)
 v_mfma_f32_16x16x32_bf16 v[152:155], a[208:211], a[160:163], v[152:155]
 v_mul_f32 v5, v5, v49
 v_cvt_pk_bf16_f32 v10, v6, v5
 v_mfma_f32_16x16x32_bf16 v[152:155], a[212:215], a[164:167], v[152:155]
 v_accvgpr_read_b32 v5, a3
 v_lshlrev_b32 v6, 16, v5
 v_mfma_f32_16x16x32_bf16 v[156:159], a[212:215], a[172:175], v[156:159]
 v_and_b32 v5, s26, v5
 v_mul_f32 v6, v6, v50
 v_mfma_f32_16x16x32_bf16 v[156:159], a[208:211], a[168:171], v[156:159]
 v_mul_f32 v5, v5, v51
 v_cvt_pk_bf16_f32 v11, v6, v5
 v_mfma_f32_16x16x32_bf16 v[160:163], a[208:211], a[176:179], v[160:163]
 v_lshrrev_b32 v5, 7, v1
 v_lshlrev_b32 v6, 4, v5
 v_mfma_f32_16x16x32_bf16 v[160:163], a[212:215], a[180:183], v[160:163]
 v_xor_b32 v6, v6, v1
 v_and_b32 v6, 112, v6
 v_mfma_f32_16x16x32_bf16 v[164:167], a[212:215], a[188:191], v[164:167]
 v_lshl_add_u32 v16, v5, 11, v6
 v_lshrrev_b32 v5, 4, v1
 v_mfma_f32_16x16x32_bf16 v[164:167], a[208:211], a[184:187], v[164:167]
 v_and_b32 v5, 48, v5
 v_xor_b32 v5, v5, v1
 s_waitcnt vmcnt(8)
 v_mfma_f32_16x16x32_bf16 v[196:199], a[216:219], a[184:187], v[196:199]
 v_and_b32 v5, 112, v5
 v_and_b32 v6, 240, v1
 v_mfma_f32_16x16x32_bf16 v[196:199], a[220:223], a[188:191], v[196:199]
 global_load_dwordx4 a[212:215], v0, s[70:71] offset:1024 sc1
 v_lshl_add_u32 v5, v6, 3, v5
 v_mfma_f32_16x16x32_bf16 v[192:195], a[220:223], a[180:183], v[192:195]
 v_add_u32 v17, s50, v5
 v_xor_b32 v18, 64, v17
 v_mfma_f32_16x16x32_bf16 v[192:195], a[216:219], a[176:179], v[192:195]
 global_load_dwordx4 a[208:211], v0, s[70:71] offset:0 sc1
 ds_write_b128 v17, v[8:11]
 v_mfma_f32_16x16x32_bf16 v[188:191], a[216:219], a[168:171], v[188:191]
 v_accvgpr_read_b32 v5, a32
 v_lshlrev_b32 v6, 16, v5
 v_mfma_f32_16x16x32_bf16 v[188:191], a[220:223], a[172:175], v[188:191]
 v_and_b32 v5, s26, v5
 v_mul_f32 v6, v6, v80
 v_mfma_f32_16x16x32_bf16 v[184:187], a[220:223], a[164:167], v[184:187]
 v_mul_f32 v5, v5, v81
 v_cvt_pk_bf16_f32 v12, v6, v5
 v_mfma_f32_16x16x32_bf16 v[184:187], a[216:219], a[160:163], v[184:187]
 v_accvgpr_read_b32 v5, a33
 v_lshlrev_b32 v6, 16, v5
 v_mfma_f32_16x16x32_bf16 v[180:183], a[216:219], a[152:155], v[180:183]
 v_and_b32 v5, s26, v5
 v_mul_f32 v6, v6, v82
 v_mfma_f32_16x16x32_bf16 v[180:183], a[220:223], a[156:159], v[180:183]
 v_mul_f32 v5, v5, v83
 v_cvt_pk_bf16_f32 v13, v6, v5
 v_mfma_f32_16x16x32_bf16 v[176:179], a[220:223], a[148:151], v[176:179]
 v_accvgpr_read_b32 v5, a34
 v_lshlrev_b32 v6, 16, v5
 v_mfma_f32_16x16x32_bf16 v[176:179], a[216:219], a[144:147], v[176:179]
 v_and_b32 v5, s26, v5
 v_mul_f32 v6, v6, v112
 v_mfma_f32_16x16x32_bf16 v[172:175], a[216:219], a[136:139], v[172:175]
 v_mul_f32 v5, v5, v113
 v_cvt_pk_bf16_f32 v14, v6, v5
 v_mfma_f32_16x16x32_bf16 v[172:175], a[220:223], a[140:143], v[172:175]
 v_accvgpr_read_b32 v5, a35
 v_lshlrev_b32 v6, 16, v5
 v_mfma_f32_16x16x32_bf16 v[168:171], a[220:223], a[132:135], v[168:171]
 v_and_b32 v5, s26, v5
 v_mul_f32 v6, v6, v114
 v_mfma_f32_16x16x32_bf16 v[168:171], a[216:219], a[128:131], v[168:171]
 v_mul_f32 v5, v5, v115
 v_cvt_pk_bf16_f32 v15, v6, v5
 s_waitcnt vmcnt(8)
 v_mfma_f32_16x16x32_bf16 v[200:203], a[224:227], a[128:131], v[200:203]
 ds_write_b128 v18, v[12:15]
 v_mfma_f32_16x16x32_bf16 v[200:203], a[228:231], a[132:135], v[200:203]
 global_load_dwordx4 a[220:223], v0, s[70:71] offset:3072 sc1
 ds_read_b128 v[48:51], v3
 v_mfma_f32_16x16x32_bf16 v[204:207], a[228:231], a[140:143], v[204:207]
 ds_read_b128 v[80:83], v3 offset:1024
 v_accvgpr_read_b32 v5, a4
 v_mfma_f32_16x16x32_bf16 v[204:207], a[224:227], a[136:139], v[204:207]
 global_load_dwordx4 a[216:219], v0, s[70:71] offset:2048 sc1
 v_lshlrev_b32 v6, 16, v5
 v_mfma_f32_16x16x32_bf16 v[208:211], a[224:227], a[144:147], v[208:211]
 v_and_b32 v5, s26, v5
 v_mul_f32 v6, v6, v20
 s_add_u32 s70, s70, 8192
 s_addc_u32 s71, s71, 0
 v_mfma_f32_16x16x32_bf16 v[208:211], a[228:231], a[148:151], v[208:211]
 v_mul_f32 v5, v5, v21
 v_cvt_pk_bf16_f32 v8, v6, v5
 v_mfma_f32_16x16x32_bf16 v[212:215], a[228:231], a[156:159], v[212:215]
 v_accvgpr_read_b32 v5, a5
 v_lshlrev_b32 v6, 16, v5
 v_mfma_f32_16x16x32_bf16 v[212:215], a[224:227], a[152:155], v[212:215]
 v_and_b32 v5, s26, v5
 v_mul_f32 v6, v6, v22
 v_mfma_f32_16x16x32_bf16 v[216:219], a[224:227], a[160:163], v[216:219]
 v_mul_f32 v5, v5, v23
 v_cvt_pk_bf16_f32 v9, v6, v5
 s_waitcnt lgkmcnt(1)
 s_add_u32 s3, s28, 0
 v_mfma_f32_16x16x32_bf16 v[216:219], a[228:231], a[164:167], v[216:219]
 buffer_store_dwordx4 v[48:51], v16, s[16:19], s3 offen nt
 s_waitcnt lgkmcnt(0)
 s_add_u32 s3, s28, 16384
 buffer_store_dwordx4 v[80:83], v16, s[16:19], s3 offen nt
 v_accvgpr_read_b32 v5, a6
 v_lshlrev_b32 v6, 16, v5
 v_and_b32 v5, s26, v5
 v_mul_f32 v6, v6, v52
 v_mfma_f32_16x16x32_bf16 v[220:223], a[228:231], a[172:175], v[220:223]
 v_mul_f32 v5, v5, v53
 v_cvt_pk_bf16_f32 v10, v6, v5
 v_mfma_f32_16x16x32_bf16 v[220:223], a[224:227], a[168:171], v[220:223]
 v_accvgpr_read_b32 v5, a7
 v_lshlrev_b32 v6, 16, v5
 v_mfma_f32_16x16x32_bf16 v[224:227], a[224:227], a[176:179], v[224:227]
 v_and_b32 v5, s26, v5
 v_mul_f32 v6, v6, v54
 v_mul_f32 v5, v5, v55
 v_cvt_pk_bf16_f32 v11, v6, v5
 v_mfma_f32_16x16x32_bf16 v[224:227], a[228:231], a[180:183], v[224:227]
 ds_write_b128 v17, v[8:11] offset:4096
 v_mfma_f32_16x16x32_bf16 v[228:231], a[228:231], a[188:191], v[228:231]
 v_accvgpr_read_b32 v5, a36
 v_lshlrev_b32 v6, 16, v5
 v_mfma_f32_16x16x32_bf16 v[228:231], a[224:227], a[184:187], v[228:231]
 v_and_b32 v5, s26, v5
 v_mul_f32 v6, v6, v84
 s_waitcnt vmcnt(10)
 v_mfma_f32_16x16x32_bf16 a[252:255], a[232:235], a[184:187], a[252:255]
 ds_read_b128 a[184:187], v1 offset:63488
 v_mul_f32 v5, v5, v85
 v_mfma_f32_16x16x32_bf16 a[252:255], a[236:239], a[188:191], a[252:255]
 global_load_dwordx4 a[228:231], v0, s[70:71] offset:-3072 sc1
 ds_read_b128 a[188:191], v1 offset:64512
 v_mfma_f32_16x16x32_bf16 a[248:251], a[236:239], a[180:183], a[248:251]
 ds_read_b128 a[180:183], v1 offset:60416
 v_cvt_pk_bf16_f32 v12, v6, v5
 v_mfma_f32_16x16x32_bf16 a[248:251], a[232:235], a[176:179], a[248:251]
 global_load_dwordx4 a[224:227], v0, s[70:71] offset:-4096 sc1
 ds_read_b128 a[176:179], v1 offset:59392
 v_mfma_f32_16x16x32_bf16 v[252:255], a[232:235], a[168:171], v[252:255]
 ds_read_b128 a[168:171], v1 offset:55296
 v_accvgpr_read_b32 v5, a37
 v_mfma_f32_16x16x32_bf16 v[252:255], a[236:239], a[172:175], v[252:255]
 ds_read_b128 a[172:175], v1 offset:56320
 v_lshlrev_b32 v6, 16, v5
 v_mfma_f32_16x16x32_bf16 v[248:251], a[236:239], a[164:167], v[248:251]
 ds_read_b128 a[164:167], v1 offset:52224
 v_and_b32 v5, s26, v5
 v_mfma_f32_16x16x32_bf16 v[248:251], a[232:235], a[160:163], v[248:251]
 ds_read_b128 a[160:163], v1 offset:51200
 v_mul_f32 v6, v6, v86
 v_mul_f32 v5, v5, v87
 v_mfma_f32_16x16x32_bf16 v[244:247], a[232:235], a[152:155], v[244:247]
 ds_read_b128 a[152:155], v1 offset:47104
 v_cvt_pk_bf16_f32 v13, v6, v5
 v_mfma_f32_16x16x32_bf16 v[244:247], a[236:239], a[156:159], v[244:247]
 ds_read_b128 a[156:159], v1 offset:48128
 v_accvgpr_read_b32 v5, a38
 v_lshlrev_b32 v6, 16, v5
 v_mfma_f32_16x16x32_bf16 v[240:243], a[236:239], a[148:151], v[240:243]
 ds_read_b128 a[148:151], v1 offset:44032
 v_and_b32 v5, s26, v5
 v_mul_f32 v6, v6, v116
 v_mfma_f32_16x16x32_bf16 v[240:243], a[232:235], a[144:147], v[240:243]
 ds_read_b128 a[144:147], v1 offset:43008
 v_mul_f32 v5, v5, v117
 v_mfma_f32_16x16x32_bf16 v[236:239], a[232:235], a[136:139], v[236:239]
 ds_read_b128 a[136:139], v1 offset:38912
 v_cvt_pk_bf16_f32 v14, v6, v5
 v_mfma_f32_16x16x32_bf16 v[236:239], a[236:239], a[140:143], v[236:239]
 ds_read_b128 a[140:143], v1 offset:39936
 v_accvgpr_read_b32 v5, a39
 v_mfma_f32_16x16x32_bf16 v[232:235], a[236:239], a[132:135], v[232:235]
 ds_read_b128 a[132:135], v1 offset:35840
 v_lshlrev_b32 v6, 16, v5
 v_mfma_f32_16x16x32_bf16 v[232:235], a[232:235], a[128:131], v[232:235]
 ds_read_b128 a[128:131], v1 offset:34816
 v_and_b32 v5, s26, v5
 s_waitcnt vmcnt(10) lgkmcnt(8)
 v_mfma_f32_16x16x32_bf16 v[164:167], a[192:195], a[184:187], v[164:167]
 v_mul_f32 v6, v6, v118
 v_mul_f32 v5, v5, v119
 v_mfma_f32_16x16x32_bf16 v[164:167], a[196:199], a[188:191], v[164:167]
 global_load_dwordx4 a[236:239], v0, s[70:71] offset:-1024 sc1
 v_cvt_pk_bf16_f32 v15, v6, v5
 v_mfma_f32_16x16x32_bf16 v[160:163], a[196:199], a[180:183], v[160:163]
 ds_write_b128 v18, v[12:15] offset:4096
 ds_read_b128 v[48:51], v3 offset:4096
 v_mfma_f32_16x16x32_bf16 v[160:163], a[192:195], a[176:179], v[160:163]
 global_load_dwordx4 a[232:235], v0, s[70:71] offset:-2048 sc1
 ds_read_b128 v[80:83], v3 offset:5120
 v_mfma_f32_16x16x32_bf16 v[156:159], a[192:195], a[168:171], v[156:159]
 v_accvgpr_read_b32 v5, a8
 v_lshlrev_b32 v6, 16, v5
 v_mfma_f32_16x16x32_bf16 v[156:159], a[196:199], a[172:175], v[156:159]
 v_and_b32 v5, s26, v5
 v_mul_f32 v6, v6, v24
 v_mfma_f32_16x16x32_bf16 v[152:155], a[196:199], a[164:167], v[152:155]
 v_mul_f32 v5, v5, v25
 v_cvt_pk_bf16_f32 v8, v6, v5
 v_mfma_f32_16x16x32_bf16 v[152:155], a[192:195], a[160:163], v[152:155]
 v_accvgpr_read_b32 v5, a9
 v_lshlrev_b32 v6, 16, v5
 s_waitcnt lgkmcnt(3)
 v_mfma_f32_16x16x32_bf16 v[148:151], a[192:195], a[152:155], v[148:151]
 v_and_b32 v5, s26, v5
 v_mul_f32 v6, v6, v26
 v_mfma_f32_16x16x32_bf16 v[148:151], a[196:199], a[156:159], v[148:151]
 v_mul_f32 v5, v5, v27
 v_cvt_pk_bf16_f32 v9, v6, v5
 s_waitcnt lgkmcnt(1)
 s_add_u32 s3, s28, 32768
 v_mfma_f32_16x16x32_bf16 v[144:147], a[196:199], a[148:151], v[144:147]
 buffer_store_dwordx4 v[48:51], v16, s[16:19], s3 offen nt
 s_waitcnt lgkmcnt(0)
 s_add_u32 s3, s28, 49152
 buffer_store_dwordx4 v[80:83], v16, s[16:19], s3 offen nt
 v_accvgpr_read_b32 v5, a10
 v_lshlrev_b32 v6, 16, v5
 v_and_b32 v5, s26, v5
 v_mul_f32 v6, v6, v56
 v_mfma_f32_16x16x32_bf16 v[144:147], a[192:195], a[144:147], v[144:147]
 v_mul_f32 v5, v5, v57
 v_cvt_pk_bf16_f32 v10, v6, v5
 v_mfma_f32_16x16x32_bf16 v[140:143], a[192:195], a[136:139], v[140:143]
 v_accvgpr_read_b32 v5, a11
 v_lshlrev_b32 v6, 16, v5
 v_mfma_f32_16x16x32_bf16 v[140:143], a[196:199], a[140:143], v[140:143]
 v_and_b32 v5, s26, v5
 v_mul_f32 v6, v6, v58
 v_mfma_f32_16x16x32_bf16 v[136:139], a[196:199], a[132:135], v[136:139]
 v_mul_f32 v5, v5, v59
 v_cvt_pk_bf16_f32 v11, v6, v5
 v_mfma_f32_16x16x32_bf16 v[136:139], a[192:195], a[128:131], v[136:139]
 ds_write_b128 v17, v[8:11] offset:8192
 s_waitcnt vmcnt(12)
 v_mfma_f32_16x16x32_bf16 v[168:171], a[200:203], a[128:131], v[168:171]
 v_accvgpr_read_b32 v5, a40
 v_lshlrev_b32 v6, 16, v5
 v_mfma_f32_16x16x32_bf16 v[168:171], a[204:207], a[132:135], v[168:171]
 global_load_dwordx4 a[196:199], v0, s[70:71] offset:1024 sc1
 v_and_b32 v5, s26, v5
 v_mfma_f32_16x16x32_bf16 v[172:175], a[204:207], a[140:143], v[172:175]
 v_mul_f32 v6, v6, v88
 v_mul_f32 v5, v5, v89
 v_mfma_f32_16x16x32_bf16 v[172:175], a[200:203], a[136:139], v[172:175]
 global_load_dwordx4 a[192:195], v0, s[70:71] offset:0 sc1
 v_cvt_pk_bf16_f32 v12, v6, v5
 v_mfma_f32_16x16x32_bf16 v[176:179], a[200:203], a[144:147], v[176:179]
 v_accvgpr_read_b32 v5, a41
 v_lshlrev_b32 v6, 16, v5
 v_mfma_f32_16x16x32_bf16 v[176:179], a[204:207], a[148:151], v[176:179]
 v_and_b32 v5, s26, v5
 v_mul_f32 v6, v6, v90
 v_mfma_f32_16x16x32_bf16 v[180:183], a[204:207], a[156:159], v[180:183]
 v_mul_f32 v5, v5, v91
 v_cvt_pk_bf16_f32 v13, v6, v5
 v_mfma_f32_16x16x32_bf16 v[180:183], a[200:203], a[152:155], v[180:183]
 v_accvgpr_read_b32 v5, a42
 v_lshlrev_b32 v6, 16, v5
 v_mfma_f32_16x16x32_bf16 v[184:187], a[200:203], a[160:163], v[184:187]
 v_and_b32 v5, s26, v5
 v_mul_f32 v6, v6, v120
 v_mfma_f32_16x16x32_bf16 v[184:187], a[204:207], a[164:167], v[184:187]
 v_mul_f32 v5, v5, v121
 v_cvt_pk_bf16_f32 v14, v6, v5
 v_mfma_f32_16x16x32_bf16 v[188:191], a[204:207], a[172:175], v[188:191]
 v_accvgpr_read_b32 v5, a43
 v_lshlrev_b32 v6, 16, v5
 v_mfma_f32_16x16x32_bf16 v[188:191], a[200:203], a[168:171], v[188:191]
 v_and_b32 v5, s26, v5
 v_mul_f32 v6, v6, v122
 v_mfma_f32_16x16x32_bf16 v[192:195], a[200:203], a[176:179], v[192:195]
 v_mul_f32 v5, v5, v123
 v_cvt_pk_bf16_f32 v15, v6, v5
 v_mfma_f32_16x16x32_bf16 v[192:195], a[204:207], a[180:183], v[192:195]
 ds_write_b128 v18, v[12:15] offset:8192
 v_mfma_f32_16x16x32_bf16 v[196:199], a[204:207], a[188:191], v[196:199]
 ds_read_b128 v[48:51], v3 offset:8192
 ds_read_b128 v[80:83], v3 offset:9216
 v_mfma_f32_16x16x32_bf16 v[196:199], a[200:203], a[184:187], v[196:199]
 v_accvgpr_read_b32 v5, a12
 v_lshlrev_b32 v6, 16, v5
 s_waitcnt vmcnt(12)
 v_mfma_f32_16x16x32_bf16 v[228:231], a[208:211], a[184:187], v[228:231]
 v_and_b32 v5, s26, v5
 v_mul_f32 v6, v6, v28
 v_mfma_f32_16x16x32_bf16 v[228:231], a[212:215], a[188:191], v[228:231]
 global_load_dwordx4 a[204:207], v0, s[70:71] offset:3072 sc1
 v_mul_f32 v5, v5, v29
 v_mfma_f32_16x16x32_bf16 v[224:227], a[212:215], a[180:183], v[224:227]
 v_cvt_pk_bf16_f32 v8, v6, v5
 v_accvgpr_read_b32 v5, a13
 v_mfma_f32_16x16x32_bf16 v[224:227], a[208:211], a[176:179], v[224:227]
 global_load_dwordx4 a[200:203], v0, s[70:71] offset:2048 sc1
 v_lshlrev_b32 v6, 16, v5
 v_mfma_f32_16x16x32_bf16 v[220:223], a[208:211], a[168:171], v[220:223]
 v_and_b32 v5, s26, v5
 v_mul_f32 v6, v6, v30
 s_add_u32 s70, s70, 8192
 s_addc_u32 s71, s71, 0
 v_mfma_f32_16x16x32_bf16 v[220:223], a[212:215], a[172:175], v[220:223]
 v_mul_f32 v5, v5, v31
 v_cvt_pk_bf16_f32 v9, v6, v5
 s_waitcnt lgkmcnt(1)
 v_mfma_f32_16x16x32_bf16 v[216:219], a[212:215], a[164:167], v[216:219]
 s_add_u32 s3, s28, 65536
 buffer_store_dwordx4 v[48:51], v16, s[16:19], s3 offen nt
 s_waitcnt lgkmcnt(0)
 v_mfma_f32_16x16x32_bf16 v[216:219], a[208:211], a[160:163], v[216:219]
 s_add_u32 s3, s28, 81920
 buffer_store_dwordx4 v[80:83], v16, s[16:19], s3 offen nt
 v_accvgpr_read_b32 v5, a14
 v_lshlrev_b32 v6, 16, v5
 v_and_b32 v5, s26, v5
 v_mul_f32 v6, v6, v60
 v_mfma_f32_16x16x32_bf16 v[212:215], a[208:211], a[152:155], v[212:215]
 v_mul_f32 v5, v5, v61
 v_cvt_pk_bf16_f32 v10, v6, v5
 v_mfma_f32_16x16x32_bf16 v[212:215], a[212:215], a[156:159], v[212:215]
 v_accvgpr_read_b32 v5, a15
 v_lshlrev_b32 v6, 16, v5
 v_mfma_f32_16x16x32_bf16 v[208:211], a[212:215], a[148:151], v[208:211]
 v_and_b32 v5, s26, v5
 v_mul_f32 v6, v6, v62
 v_mfma_f32_16x16x32_bf16 v[208:211], a[208:211], a[144:147], v[208:211]
 v_mul_f32 v5, v5, v63
 v_cvt_pk_bf16_f32 v11, v6, v5
 v_mfma_f32_16x16x32_bf16 v[204:207], a[208:211], a[136:139], v[204:207]
 ds_write_b128 v17, v[8:11] offset:12288
 v_mfma_f32_16x16x32_bf16 v[204:207], a[212:215], a[140:143], v[204:207]
 v_accvgpr_read_b32 v5, a44
 v_lshlrev_b32 v6, 16, v5
 v_mfma_f32_16x16x32_bf16 v[200:203], a[212:215], a[132:135], v[200:203]
 v_and_b32 v5, s26, v5
 v_mul_f32 v6, v6, v92
 v_mfma_f32_16x16x32_bf16 v[200:203], a[208:211], a[128:131], v[200:203]
 v_mul_f32 v5, v5, v93
 v_cvt_pk_bf16_f32 v12, v6, v5
 s_waitcnt vmcnt(14)
 v_mfma_f32_16x16x32_bf16 v[232:235], a[216:219], a[128:131], v[232:235]
 ds_read_b128 a[128:131], v2 offset:2048
 v_accvgpr_read_b32 v5, a45
 v_mfma_f32_16x16x32_bf16 v[232:235], a[220:223], a[132:135], v[232:235]
 global_load_dwordx4 a[212:215], v0, s[70:71] offset:-3072 sc1
 ds_read_b128 a[132:135], v2 offset:3072
 v_mfma_f32_16x16x32_bf16 v[236:239], a[220:223], a[140:143], v[236:239]
 ds_read_b128 a[140:143], v2 offset:7168
 v_lshlrev_b32 v6, 16, v5
 v_mfma_f32_16x16x32_bf16 v[236:239], a[216:219], a[136:139], v[236:239]
 global_load_dwordx4 a[208:211], v0, s[70:71] offset:-4096 sc1
 ds_read_b128 a[136:139], v2 offset:6144
 v_and_b32 v5, s26, v5
 v_mfma_f32_16x16x32_bf16 v[240:243], a[216:219], a[144:147], v[240:243]
 ds_read_b128 a[144:147], v2 offset:10240
 v_mul_f32 v6, v6, v94
 v_mul_f32 v5, v5, v95
 v_mfma_f32_16x16x32_bf16 v[240:243], a[220:223], a[148:151], v[240:243]
 ds_read_b128 a[148:151], v2 offset:11264
 v_cvt_pk_bf16_f32 v13, v6, v5
 v_mfma_f32_16x16x32_bf16 v[244:247], a[220:223], a[156:159], v[244:247]
 ds_read_b128 a[156:159], v2 offset:15360
 v_accvgpr_read_b32 v5, a46
 v_lshlrev_b32 v6, 16, v5
 v_mfma_f32_16x16x32_bf16 v[244:247], a[216:219], a[152:155], v[244:247]
 ds_read_b128 a[152:155], v2 offset:14336
 v_and_b32 v5, s26, v5
 v_mul_f32 v6, v6, v124
 v_mfma_f32_16x16x32_bf16 v[248:251], a[216:219], a[160:163], v[248:251]
 ds_read_b128 a[160:163], v2 offset:18432
 v_mul_f32 v5, v5, v125
 v_mfma_f32_16x16x32_bf16 v[248:251], a[220:223], a[164:167], v[248:251]
 ds_read_b128 a[164:167], v2 offset:19456
 v_cvt_pk_bf16_f32 v14, v6, v5
 v_mfma_f32_16x16x32_bf16 v[252:255], a[220:223], a[172:175], v[252:255]
 ds_read_b128 a[172:175], v2 offset:23552
 v_accvgpr_read_b32 v5, a47
 v_mfma_f32_16x16x32_bf16 v[252:255], a[216:219], a[168:171], v[252:255]
 ds_read_b128 a[168:171], v2 offset:22528
 v_lshlrev_b32 v6, 16, v5
 v_mfma_f32_16x16x32_bf16 a[248:251], a[216:219], a[176:179], a[248:251]
 ds_read_b128 a[176:179], v2 offset:26624
 v_and_b32 v5, s26, v5
 v_mfma_f32_16x16x32_bf16 a[248:251], a[220:223], a[180:183], a[248:251]
 ds_read_b128 a[180:183], v2 offset:27648
 v_mul_f32 v6, v6, v126
 v_mfma_f32_16x16x32_bf16 a[252:255], a[220:223], a[188:191], a[252:255]
 ds_read_b128 a[188:191], v2 offset:31744
 v_mul_f32 v5, v5, v127
 v_mfma_f32_16x16x32_bf16 a[252:255], a[216:219], a[184:187], a[252:255]
 ds_read_b128 a[184:187], v2 offset:30720
 v_cvt_pk_bf16_f32 v15, v6, v5
 s_waitcnt vmcnt(12) lgkmcnt(8)
 v_mfma_f32_16x16x32_bf16 v[136:139], a[224:227], a[128:131], v[136:139]
 ds_write_b128 v18, v[12:15] offset:12288
 ds_read_b128 v[48:51], v3 offset:12288
 ds_read_b128 v[80:83], v3 offset:13312
 v_mfma_f32_16x16x32_bf16 v[136:139], a[228:231], a[132:135], v[136:139]
 global_load_dwordx4 a[220:223], v0, s[70:71] offset:-1024 sc1
 v_accvgpr_read_b32 v5, a16
 v_mfma_f32_16x16x32_bf16 v[140:143], a[228:231], a[140:143], v[140:143]
 v_lshlrev_b32 v6, 16, v5
 v_and_b32 v5, s26, v5
 v_mfma_f32_16x16x32_bf16 v[140:143], a[224:227], a[136:139], v[140:143]
 global_load_dwordx4 a[216:219], v0, s[70:71] offset:-2048 sc1
 v_mul_f32 v6, v6, v32
 v_mfma_f32_16x16x32_bf16 v[144:147], a[224:227], a[144:147], v[144:147]
 v_mul_f32 v5, v5, v33
 v_cvt_pk_bf16_f32 v8, v6, v5
 v_mfma_f32_16x16x32_bf16 v[144:147], a[228:231], a[148:151], v[144:147]
 v_accvgpr_read_b32 v5, a17
 v_lshlrev_b32 v6, 16, v5
 v_mfma_f32_16x16x32_bf16 v[148:151], a[228:231], a[156:159], v[148:151]
 v_and_b32 v5, s26, v5
 v_mul_f32 v6, v6, v34
 v_mfma_f32_16x16x32_bf16 v[148:151], a[224:227], a[152:155], v[148:151]
 v_mul_f32 v5, v5, v35
 v_cvt_pk_bf16_f32 v9, v6, v5
 s_waitcnt lgkmcnt(1)
 s_add_u32 s3, s28, 98304
 v_mfma_f32_16x16x32_bf16 v[152:155], a[224:227], a[160:163], v[152:155]
 buffer_store_dwordx4 v[48:51], v16, s[16:19], s3 offen nt
 s_waitcnt lgkmcnt(0)
 s_add_u32 s3, s28, 114688
 buffer_store_dwordx4 v[80:83], v16, s[16:19], s3 offen nt
 v_accvgpr_read_b32 v5, a18
 v_lshlrev_b32 v6, 16, v5
 v_and_b32 v5, s26, v5
 v_mul_f32 v6, v6, v64
 v_mfma_f32_16x16x32_bf16 v[152:155], a[228:231], a[164:167], v[152:155]
 v_mul_f32 v5, v5, v65
 v_cvt_pk_bf16_f32 v10, v6, v5
 v_mfma_f32_16x16x32_bf16 v[156:159], a[228:231], a[172:175], v[156:159]
 v_accvgpr_read_b32 v5, a19
 v_lshlrev_b32 v6, 16, v5
 v_mfma_f32_16x16x32_bf16 v[156:159], a[224:227], a[168:171], v[156:159]
 v_and_b32 v5, s26, v5
 v_mul_f32 v6, v6, v66
 v_mfma_f32_16x16x32_bf16 v[160:163], a[224:227], a[176:179], v[160:163]
 v_mul_f32 v5, v5, v67
 v_cvt_pk_bf16_f32 v11, v6, v5
 v_mfma_f32_16x16x32_bf16 v[160:163], a[228:231], a[180:183], v[160:163]
 ds_write_b128 v17, v[8:11] offset:16384
 v_mfma_f32_16x16x32_bf16 v[164:167], a[228:231], a[188:191], v[164:167]
 v_accvgpr_read_b32 v5, a48
 v_lshlrev_b32 v6, 16, v5
 v_mfma_f32_16x16x32_bf16 v[164:167], a[224:227], a[184:187], v[164:167]
 v_and_b32 v5, s26, v5
 v_mul_f32 v6, v6, v96
 s_waitcnt vmcnt(14)
 v_mfma_f32_16x16x32_bf16 v[196:199], a[232:235], a[184:187], v[196:199]
 v_mul_f32 v5, v5, v97
 v_cvt_pk_bf16_f32 v12, v6, v5
 v_mfma_f32_16x16x32_bf16 v[196:199], a[236:239], a[188:191], v[196:199]
 global_load_dwordx4 a[228:231], v0, s[70:71] offset:1024 sc1
 v_accvgpr_read_b32 v5, a49
 v_mfma_f32_16x16x32_bf16 v[192:195], a[236:239], a[180:183], v[192:195]
 v_lshlrev_b32 v6, 16, v5
 v_and_b32 v5, s26, v5
 v_mfma_f32_16x16x32_bf16 v[192:195], a[232:235], a[176:179], v[192:195]
 global_load_dwordx4 a[224:227], v0, s[70:71] offset:0 sc1
 v_mul_f32 v6, v6, v98
 v_mfma_f32_16x16x32_bf16 v[188:191], a[232:235], a[168:171], v[188:191]
 v_mul_f32 v5, v5, v99
 v_cvt_pk_bf16_f32 v13, v6, v5
 v_mfma_f32_16x16x32_bf16 v[188:191], a[236:239], a[172:175], v[188:191]
 v_accvgpr_read_b32 v5, a50
 v_lshlrev_b32 v6, 16, v5
 v_mfma_f32_16x16x32_bf16 v[184:187], a[236:239], a[164:167], v[184:187]
 v_and_b32 v5, s26, v5
 v_mul_f32 v6, v6, v128
 v_mfma_f32_16x16x32_bf16 v[184:187], a[232:235], a[160:163], v[184:187]
 v_mul_f32 v5, v5, v129
 v_cvt_pk_bf16_f32 v14, v6, v5
 v_mfma_f32_16x16x32_bf16 v[180:183], a[232:235], a[152:155], v[180:183]
 v_accvgpr_read_b32 v5, a51
 v_lshlrev_b32 v6, 16, v5
 v_mfma_f32_16x16x32_bf16 v[180:183], a[236:239], a[156:159], v[180:183]
 v_and_b32 v5, s26, v5
 v_mul_f32 v6, v6, v130
 v_mfma_f32_16x16x32_bf16 v[176:179], a[236:239], a[148:151], v[176:179]
 v_mul_f32 v5, v5, v131
 v_cvt_pk_bf16_f32 v15, v6, v5
 v_mfma_f32_16x16x32_bf16 v[176:179], a[232:235], a[144:147], v[176:179]
 ds_write_b128 v18, v[12:15] offset:16384
 v_mfma_f32_16x16x32_bf16 v[172:175], a[232:235], a[136:139], v[172:175]
 ds_read_b128 v[48:51], v3 offset:16384
 ds_read_b128 v[80:83], v3 offset:17408
 v_mfma_f32_16x16x32_bf16 v[172:175], a[236:239], a[140:143], v[172:175]
 v_accvgpr_read_b32 v5, a20
 v_lshlrev_b32 v6, 16, v5
 v_mfma_f32_16x16x32_bf16 v[168:171], a[236:239], a[132:135], v[168:171]
 v_and_b32 v5, s26, v5
 v_mul_f32 v6, v6, v36
 v_mfma_f32_16x16x32_bf16 v[168:171], a[232:235], a[128:131], v[168:171]
 v_mul_f32 v5, v5, v37
 v_cvt_pk_bf16_f32 v8, v6, v5
 s_waitcnt vmcnt(12)
 v_mfma_f32_16x16x32_bf16 v[200:203], a[192:195], a[128:131], v[200:203]
 v_accvgpr_read_b32 v5, a21
 v_lshlrev_b32 v6, 16, v5
 v_mfma_f32_16x16x32_bf16 v[200:203], a[196:199], a[132:135], v[200:203]
 global_load_dwordx4 a[236:239], v0, s[70:71] offset:3072 sc1
 v_and_b32 v5, s26, v5
 v_mfma_f32_16x16x32_bf16 v[204:207], a[196:199], a[140:143], v[204:207]
 v_mul_f32 v6, v6, v38
 v_mul_f32 v5, v5, v39
 v_mfma_f32_16x16x32_bf16 v[204:207], a[192:195], a[136:139], v[204:207]
 global_load_dwordx4 a[232:235], v0, s[70:71] offset:2048 sc1
 v_cvt_pk_bf16_f32 v9, v6, v5
 s_waitcnt lgkmcnt(1)
 s_add_u32 s3, s28, 131072
 v_mfma_f32_16x16x32_bf16 v[208:211], a[192:195], a[144:147], v[208:211]
 buffer_store_dwordx4 v[48:51], v16, s[16:19], s3 offen nt
 s_waitcnt lgkmcnt(0)
 s_add_u32 s3, s28, 147456
 s_add_u32 s70, s70, 1843200
 s_addc_u32 s71, s71, 0
 v_mfma_f32_16x16x32_bf16 v[208:211], a[196:199], a[148:151], v[208:211]
 buffer_store_dwordx4 v[80:83], v16, s[16:19], s3 offen nt
 v_accvgpr_read_b32 v5, a22
 v_lshlrev_b32 v6, 16, v5
 v_and_b32 v5, s26, v5
 v_mul_f32 v6, v6, v68
 v_mfma_f32_16x16x32_bf16 v[212:215], a[196:199], a[156:159], v[212:215]
 v_mul_f32 v5, v5, v69
 v_cvt_pk_bf16_f32 v10, v6, v5
 v_mfma_f32_16x16x32_bf16 v[212:215], a[192:195], a[152:155], v[212:215]
 v_accvgpr_read_b32 v5, a23
 v_lshlrev_b32 v6, 16, v5
 v_mfma_f32_16x16x32_bf16 v[216:219], a[192:195], a[160:163], v[216:219]
 v_and_b32 v5, s26, v5
 v_mul_f32 v6, v6, v70
 v_mfma_f32_16x16x32_bf16 v[216:219], a[196:199], a[164:167], v[216:219]
 v_mul_f32 v5, v5, v71
 v_cvt_pk_bf16_f32 v11, v6, v5
 v_mfma_f32_16x16x32_bf16 v[220:223], a[196:199], a[172:175], v[220:223]
 ds_write_b128 v17, v[8:11] offset:20480
 v_mfma_f32_16x16x32_bf16 v[220:223], a[192:195], a[168:171], v[220:223]
 v_accvgpr_read_b32 v5, a52
 v_lshlrev_b32 v6, 16, v5
 v_mfma_f32_16x16x32_bf16 v[224:227], a[192:195], a[176:179], v[224:227]
 v_and_b32 v5, s26, v5
 v_mul_f32 v6, v6, v100
 v_mfma_f32_16x16x32_bf16 v[224:227], a[196:199], a[180:183], v[224:227]
 v_mul_f32 v5, v5, v101
 v_cvt_pk_bf16_f32 v12, v6, v5
 v_mfma_f32_16x16x32_bf16 v[228:231], a[196:199], a[188:191], v[228:231]
 v_accvgpr_read_b32 v5, a53
 v_lshlrev_b32 v6, 16, v5
 v_mfma_f32_16x16x32_bf16 v[228:231], a[192:195], a[184:187], v[228:231]
 v_and_b32 v5, s26, v5
 v_mul_f32 v6, v6, v102
 s_waitcnt vmcnt(14)
 v_mfma_f32_16x16x32_bf16 a[252:255], a[200:203], a[184:187], a[252:255]
 ds_read_b128 a[184:187], v2 offset:63488
 v_mul_f32 v5, v5, v103
 v_mfma_f32_16x16x32_bf16 a[252:255], a[204:207], a[188:191], a[252:255]
 ds_read_b128 a[188:191], v2 offset:64512
 v_cvt_pk_bf16_f32 v13, v6, v5
 v_mfma_f32_16x16x32_bf16 a[248:251], a[204:207], a[180:183], a[248:251]
 ds_read_b128 a[180:183], v2 offset:60416
 v_accvgpr_read_b32 v5, a54
 v_mfma_f32_16x16x32_bf16 a[248:251], a[200:203], a[176:179], a[248:251]
 ds_read_b128 a[176:179], v2 offset:59392
 v_lshlrev_b32 v6, 16, v5
 v_mfma_f32_16x16x32_bf16 v[252:255], a[200:203], a[168:171], v[252:255]
 ds_read_b128 a[168:171], v2 offset:55296
 v_and_b32 v5, s26, v5
 v_mfma_f32_16x16x32_bf16 v[252:255], a[204:207], a[172:175], v[252:255]
 ds_read_b128 a[172:175], v2 offset:56320
 v_mul_f32 v6, v6, v132
 v_mfma_f32_16x16x32_bf16 v[248:251], a[204:207], a[164:167], v[248:251]
 ds_read_b128 a[164:167], v2 offset:52224
 v_mul_f32 v5, v5, v133
 v_mfma_f32_16x16x32_bf16 v[248:251], a[200:203], a[160:163], v[248:251]
 ds_read_b128 a[160:163], v2 offset:51200
 v_cvt_pk_bf16_f32 v14, v6, v5
 v_mfma_f32_16x16x32_bf16 v[244:247], a[200:203], a[152:155], v[244:247]
 ds_read_b128 a[152:155], v2 offset:47104
 v_accvgpr_read_b32 v5, a55
 v_mfma_f32_16x16x32_bf16 v[244:247], a[204:207], a[156:159], v[244:247]
 ds_read_b128 a[156:159], v2 offset:48128
 v_lshlrev_b32 v6, 16, v5
 v_mfma_f32_16x16x32_bf16 v[240:243], a[204:207], a[148:151], v[240:243]
 ds_read_b128 a[148:151], v2 offset:44032
 v_and_b32 v5, s26, v5
 v_mfma_f32_16x16x32_bf16 v[240:243], a[200:203], a[144:147], v[240:243]
 ds_read_b128 a[144:147], v2 offset:43008
 v_mul_f32 v6, v6, v134
 v_mfma_f32_16x16x32_bf16 v[236:239], a[200:203], a[136:139], v[236:239]
 ds_read_b128 a[136:139], v2 offset:38912
 v_mul_f32 v5, v5, v135
 v_mfma_f32_16x16x32_bf16 v[236:239], a[204:207], a[140:143], v[236:239]
 ds_read_b128 a[140:143], v2 offset:39936
 v_cvt_pk_bf16_f32 v15, v6, v5
 v_mfma_f32_16x16x32_bf16 v[232:235], a[204:207], a[132:135], v[232:235]
 ds_read_b128 a[132:135], v2 offset:35840
 v_mfma_f32_16x16x32_bf16 v[232:235], a[200:203], a[128:131], v[232:235]
 ds_read_b128 a[128:131], v2 offset:34816
 ds_write_b128 v18, v[12:15] offset:20480
 ds_read_b128 v[48:51], v3 offset:20480
 ds_read_b128 v[80:83], v3 offset:21504
 v_accvgpr_read_b32 v5, a24
 v_lshlrev_b32 v6, 16, v5
 s_waitcnt vmcnt(10) lgkmcnt(11)
 v_mfma_f32_16x16x32_bf16 v[164:167], a[208:211], a[184:187], v[164:167]
 v_and_b32 v5, s26, v5
 v_mul_f32 v6, v6, v40
 v_mfma_f32_16x16x32_bf16 v[164:167], a[212:215], a[188:191], v[164:167]
 v_mul_f32 v5, v5, v41
 v_cvt_pk_bf16_f32 v8, v6, v5
 v_mfma_f32_16x16x32_bf16 v[160:163], a[212:215], a[180:183], v[160:163]
 v_accvgpr_read_b32 v5, a25
 v_lshlrev_b32 v6, 16, v5
 v_mfma_f32_16x16x32_bf16 v[160:163], a[208:211], a[176:179], v[160:163]
 v_and_b32 v5, s26, v5
 v_mul_f32 v6, v6, v42
 v_mfma_f32_16x16x32_bf16 v[156:159], a[208:211], a[168:171], v[156:159]
 v_mul_f32 v5, v5, v43
 v_cvt_pk_bf16_f32 v9, v6, v5
 s_waitcnt lgkmcnt(1)
 s_add_u32 s3, s28, 163840
 v_mfma_f32_16x16x32_bf16 v[156:159], a[212:215], a[172:175], v[156:159]
 buffer_store_dwordx4 v[48:51], v16, s[16:19], s3 offen nt
 s_waitcnt lgkmcnt(0)
 s_add_u32 s3, s28, 180224
 buffer_store_dwordx4 v[80:83], v16, s[16:19], s3 offen nt
 v_accvgpr_read_b32 v5, a26
 v_lshlrev_b32 v6, 16, v5
 v_and_b32 v5, s26, v5
 v_mul_f32 v6, v6, v72
 v_mfma_f32_16x16x32_bf16 v[152:155], a[212:215], a[164:167], v[152:155]
 v_mul_f32 v5, v5, v73
 v_cvt_pk_bf16_f32 v10, v6, v5
 v_mfma_f32_16x16x32_bf16 v[152:155], a[208:211], a[160:163], v[152:155]
 v_accvgpr_read_b32 v5, a27
 v_lshlrev_b32 v6, 16, v5
 v_mfma_f32_16x16x32_bf16 v[148:151], a[208:211], a[152:155], v[148:151]
 v_and_b32 v5, s26, v5
 v_mul_f32 v6, v6, v74
 v_mfma_f32_16x16x32_bf16 v[148:151], a[212:215], a[156:159], v[148:151]
 v_mul_f32 v5, v5, v75
 v_cvt_pk_bf16_f32 v11, v6, v5
 v_mfma_f32_16x16x32_bf16 v[144:147], a[212:215], a[148:151], v[144:147]
 ds_write_b128 v17, v[8:11] offset:24576
 v_mfma_f32_16x16x32_bf16 v[144:147], a[208:211], a[144:147], v[144:147]
 v_accvgpr_read_b32 v5, a56
 v_lshlrev_b32 v6, 16, v5
 v_mfma_f32_16x16x32_bf16 v[140:143], a[208:211], a[136:139], v[140:143]
 v_and_b32 v5, s26, v5
 v_mul_f32 v6, v6, v104
 v_mfma_f32_16x16x32_bf16 v[140:143], a[212:215], a[140:143], v[140:143]
 v_mul_f32 v5, v5, v105
 v_cvt_pk_bf16_f32 v12, v6, v5
 v_mfma_f32_16x16x32_bf16 v[136:139], a[212:215], a[132:135], v[136:139]
 v_accvgpr_read_b32 v5, a57
 v_lshlrev_b32 v6, 16, v5
 v_mfma_f32_16x16x32_bf16 v[136:139], a[208:211], a[128:131], v[136:139]
 v_and_b32 v5, s26, v5
 v_mul_f32 v6, v6, v106
 s_waitcnt vmcnt(10)
 v_mfma_f32_16x16x32_bf16 v[168:171], a[216:219], a[128:131], v[168:171]
 v_mul_f32 v5, v5, v107
 v_cvt_pk_bf16_f32 v13, v6, v5
 v_mfma_f32_16x16x32_bf16 v[168:171], a[220:223], a[132:135], v[168:171]
 v_accvgpr_read_b32 v5, a58
 v_accvgpr_read_b32 v7, a240
 v_mfma_f32_16x16x32_bf16 v[172:175], a[220:223], a[140:143], v[172:175]
 v_lshlrev_b32 v6, 16, v5
 v_and_b32 v5, s26, v5
 v_mfma_f32_16x16x32_bf16 v[172:175], a[216:219], a[136:139], v[172:175]
 v_mul_f32 v6, v6, v7
 v_accvgpr_read_b32 v7, a241
 v_mfma_f32_16x16x32_bf16 v[176:179], a[216:219], a[144:147], v[176:179]
 v_mul_f32 v5, v5, v7
 v_cvt_pk_bf16_f32 v14, v6, v5
 v_mfma_f32_16x16x32_bf16 v[176:179], a[220:223], a[148:151], v[176:179]
 v_accvgpr_read_b32 v5, a59
 v_accvgpr_read_b32 v7, a242
 v_mfma_f32_16x16x32_bf16 v[180:183], a[220:223], a[156:159], v[180:183]
 v_lshlrev_b32 v6, 16, v5
 v_and_b32 v5, s26, v5
 v_mfma_f32_16x16x32_bf16 v[180:183], a[216:219], a[152:155], v[180:183]
 v_mul_f32 v6, v6, v7
 v_accvgpr_read_b32 v7, a243
 v_mfma_f32_16x16x32_bf16 v[184:187], a[216:219], a[160:163], v[184:187]
 v_mul_f32 v5, v5, v7
 v_cvt_pk_bf16_f32 v15, v6, v5
 v_mfma_f32_16x16x32_bf16 v[184:187], a[220:223], a[164:167], v[184:187]
 ds_write_b128 v18, v[12:15] offset:24576
 v_mfma_f32_16x16x32_bf16 v[188:191], a[220:223], a[172:175], v[188:191]
 ds_read_b128 v[48:51], v3 offset:24576
 ds_read_b128 v[80:83], v3 offset:25600
 v_mfma_f32_16x16x32_bf16 v[188:191], a[216:219], a[168:171], v[188:191]
 v_accvgpr_read_b32 v5, a28
 v_mfma_f32_16x16x32_bf16 v[192:195], a[216:219], a[176:179], v[192:195]
 v_lshlrev_b32 v6, 16, v5
 v_and_b32 v5, s26, v5
 v_mfma_f32_16x16x32_bf16 v[192:195], a[220:223], a[180:183], v[192:195]
 v_mul_f32 v6, v6, v44
 v_mul_f32 v5, v5, v45
 v_mfma_f32_16x16x32_bf16 v[196:199], a[220:223], a[188:191], v[196:199]
 v_cvt_pk_bf16_f32 v8, v6, v5
 v_accvgpr_read_b32 v5, a29
 v_mfma_f32_16x16x32_bf16 v[196:199], a[216:219], a[184:187], v[196:199]
 v_lshlrev_b32 v6, 16, v5
 v_and_b32 v5, s26, v5
 s_waitcnt vmcnt(6)
 v_mfma_f32_16x16x32_bf16 v[228:231], a[224:227], a[184:187], v[228:231]
 v_mul_f32 v6, v6, v46
 v_mul_f32 v5, v5, v47
 v_mfma_f32_16x16x32_bf16 v[228:231], a[228:231], a[188:191], v[228:231]
 v_cvt_pk_bf16_f32 v9, v6, v5
 s_waitcnt lgkmcnt(1)
 v_mfma_f32_16x16x32_bf16 v[224:227], a[228:231], a[180:183], v[224:227]
 s_add_u32 s3, s28, 196608
 buffer_store_dwordx4 v[48:51], v16, s[16:19], s3 offen nt
 v_mfma_f32_16x16x32_bf16 v[224:227], a[224:227], a[176:179], v[224:227]
 s_waitcnt lgkmcnt(0)
 s_add_u32 s3, s28, 212992
 v_mfma_f32_16x16x32_bf16 v[220:223], a[224:227], a[168:171], v[220:223]
 buffer_store_dwordx4 v[80:83], v16, s[16:19], s3 offen nt
 v_accvgpr_read_b32 v5, a30
 v_mfma_f32_16x16x32_bf16 v[220:223], a[228:231], a[172:175], v[220:223]
 v_lshlrev_b32 v6, 16, v5
 v_mfma_f32_16x16x32_bf16 v[216:219], a[228:231], a[164:167], v[216:219]
 v_and_b32 v5, s26, v5
 v_mul_f32 v6, v6, v76
 v_mfma_f32_16x16x32_bf16 v[216:219], a[224:227], a[160:163], v[216:219]
 v_mul_f32 v5, v5, v77
 v_cvt_pk_bf16_f32 v10, v6, v5
 v_mfma_f32_16x16x32_bf16 v[212:215], a[224:227], a[152:155], v[212:215]
 v_accvgpr_read_b32 v5, a31
 v_lshlrev_b32 v6, 16, v5
 v_mfma_f32_16x16x32_bf16 v[212:215], a[228:231], a[156:159], v[212:215]
 v_and_b32 v5, s26, v5
 v_mul_f32 v6, v6, v78
 v_mfma_f32_16x16x32_bf16 v[208:211], a[228:231], a[148:151], v[208:211]
 v_mul_f32 v5, v5, v79
 v_cvt_pk_bf16_f32 v11, v6, v5
 v_mfma_f32_16x16x32_bf16 v[208:211], a[224:227], a[144:147], v[208:211]
 ds_write_b128 v17, v[8:11] offset:28672
 v_mfma_f32_16x16x32_bf16 v[204:207], a[224:227], a[136:139], v[204:207]
 v_accvgpr_read_b32 v5, a60
 v_lshlrev_b32 v6, 16, v5
 v_mfma_f32_16x16x32_bf16 v[204:207], a[228:231], a[140:143], v[204:207]
 v_and_b32 v5, s26, v5
 v_mul_f32 v6, v6, v108
 v_mfma_f32_16x16x32_bf16 v[200:203], a[228:231], a[132:135], v[200:203]
 v_mul_f32 v5, v5, v109
 v_cvt_pk_bf16_f32 v12, v6, v5
 v_mfma_f32_16x16x32_bf16 v[200:203], a[224:227], a[128:131], v[200:203]
 v_accvgpr_read_b32 v5, a61
 v_lshlrev_b32 v6, 16, v5
 s_waitcnt vmcnt(6)
 v_mfma_f32_16x16x32_bf16 v[232:235], a[232:235], a[128:131], v[232:235]
 v_and_b32 v5, s26, v5
 v_mul_f32 v6, v6, v110
 v_mfma_f32_16x16x32_bf16 v[232:235], a[236:239], a[132:135], v[232:235]
 v_mul_f32 v5, v5, v111
 v_cvt_pk_bf16_f32 v13, v6, v5
 v_mfma_f32_16x16x32_bf16 v[236:239], a[236:239], a[140:143], v[236:239]
 v_accvgpr_read_b32 v5, a62
 v_accvgpr_read_b32 v7, a244
 v_mfma_f32_16x16x32_bf16 v[236:239], a[232:235], a[136:139], v[236:239]
 v_lshlrev_b32 v6, 16, v5
 v_and_b32 v5, s26, v5
 v_mfma_f32_16x16x32_bf16 v[240:243], a[232:235], a[144:147], v[240:243]
 v_mul_f32 v6, v6, v7
 v_accvgpr_read_b32 v7, a245
 v_mfma_f32_16x16x32_bf16 v[240:243], a[236:239], a[148:151], v[240:243]
 v_mul_f32 v5, v5, v7
 v_cvt_pk_bf16_f32 v14, v6, v5
 v_mfma_f32_16x16x32_bf16 v[244:247], a[236:239], a[156:159], v[244:247]
 v_accvgpr_read_b32 v5, a63
 v_accvgpr_read_b32 v7, a246
 v_mfma_f32_16x16x32_bf16 v[244:247], a[232:235], a[152:155], v[244:247]
 v_lshlrev_b32 v6, 16, v5
 v_and_b32 v5, s26, v5
 v_mfma_f32_16x16x32_bf16 v[248:251], a[232:235], a[160:163], v[248:251]
 v_mul_f32 v6, v6, v7
 v_accvgpr_read_b32 v7, a247
 v_mfma_f32_16x16x32_bf16 v[248:251], a[236:239], a[164:167], v[248:251]
 v_mul_f32 v5, v5, v7
 v_cvt_pk_bf16_f32 v15, v6, v5
 v_mfma_f32_16x16x32_bf16 v[252:255], a[236:239], a[172:175], v[252:255]
 ds_write_b128 v18, v[12:15] offset:28672
 v_mfma_f32_16x16x32_bf16 v[252:255], a[232:235], a[168:171], v[252:255]
 ds_read_b128 v[48:51], v3 offset:28672
 ds_read_b128 v[80:83], v3 offset:29696
 v_mfma_f32_16x16x32_bf16 a[248:251], a[232:235], a[176:179], a[248:251]
 s_waitcnt lgkmcnt(1)
 s_add_u32 s3, s28, 229376
 v_mfma_f32_16x16x32_bf16 a[248:251], a[236:239], a[180:183], a[248:251]
 buffer_store_dwordx4 v[48:51], v16, s[16:19], s3 offen nt
 s_waitcnt lgkmcnt(0)
 v_mfma_f32_16x16x32_bf16 a[252:255], a[236:239], a[188:191], a[252:255]
 s_add_u32 s3, s28, 245760
 buffer_store_dwordx4 v[80:83], v16, s[16:19], s3 offen nt
 v_mfma_f32_16x16x32_bf16 a[252:255], a[232:235], a[184:187], a[252:255]
 s_nop 7
 v_accvgpr_read_b32 v7, a64
 v_lshlrev_b32 v6, 16, v7
 v_and_b32 v7, s26, v7
 v_pk_mul_f32 v[6:7], v[6:7], v[136:137]
 v_cvt_pk_bf16_f32 v8, v6, v7
 v_accvgpr_read_b32 v7, a65
 v_lshlrev_b32 v6, 16, v7
 v_and_b32 v7, s26, v7
 v_pk_mul_f32 v[6:7], v[6:7], v[138:139]
 v_cvt_pk_bf16_f32 v9, v6, v7
 v_accvgpr_read_b32 v7, a66
 v_lshlrev_b32 v6, 16, v7
 v_and_b32 v7, s26, v7
 v_pk_mul_f32 v[6:7], v[6:7], v[168:169]
 v_cvt_pk_bf16_f32 v10, v6, v7
 v_accvgpr_read_b32 v7, a67
 v_lshlrev_b32 v6, 16, v7
 v_and_b32 v7, s26, v7
 v_pk_mul_f32 v[6:7], v[6:7], v[170:171]
 v_cvt_pk_bf16_f32 v11, v6, v7
 ds_write_b128 v17, v[8:11]
 v_accvgpr_read_b32 v7, a96
 v_lshlrev_b32 v6, 16, v7
 v_and_b32 v7, s26, v7
 v_pk_mul_f32 v[6:7], v[6:7], v[200:201]
 v_cvt_pk_bf16_f32 v12, v6, v7
 v_accvgpr_read_b32 v7, a97
 v_lshlrev_b32 v6, 16, v7
 v_and_b32 v7, s26, v7
 v_pk_mul_f32 v[6:7], v[6:7], v[202:203]
 v_cvt_pk_bf16_f32 v13, v6, v7
 v_accvgpr_read_b32 v7, a98
 v_lshlrev_b32 v6, 16, v7
 v_and_b32 v7, s26, v7
 v_pk_mul_f32 v[6:7], v[6:7], v[232:233]
 v_cvt_pk_bf16_f32 v14, v6, v7
 v_accvgpr_read_b32 v7, a99
 v_lshlrev_b32 v6, 16, v7
 v_and_b32 v7, s26, v7
 v_pk_mul_f32 v[6:7], v[6:7], v[234:235]
 v_cvt_pk_bf16_f32 v15, v6, v7
 ds_write_b128 v18, v[12:15]
 ds_read_b128 v[48:51], v3
 ds_read_b128 v[80:83], v3 offset:1024
 v_accvgpr_read_b32 v7, a68
 v_lshlrev_b32 v6, 16, v7
 v_and_b32 v7, s26, v7
 v_pk_mul_f32 v[6:7], v[6:7], v[140:141]
 v_cvt_pk_bf16_f32 v8, v6, v7
 v_accvgpr_read_b32 v7, a69
 v_lshlrev_b32 v6, 16, v7
 v_and_b32 v7, s26, v7
 v_pk_mul_f32 v[6:7], v[6:7], v[142:143]
 v_cvt_pk_bf16_f32 v9, v6, v7
 v_accvgpr_read_b32 v7, a70
 v_lshlrev_b32 v6, 16, v7
 s_waitcnt lgkmcnt(1)
 s_add_u32 s3, s28, 0
 buffer_store_dwordx4 v[48:51], v16, s[16:19], s3 offen offset:128 nt
 s_waitcnt lgkmcnt(0)
 s_add_u32 s3, s28, 16384
 buffer_store_dwordx4 v[80:83], v16, s[16:19], s3 offen offset:128 nt
 v_and_b32 v7, s26, v7
 v_pk_mul_f32 v[6:7], v[6:7], v[172:173]
 v_cvt_pk_bf16_f32 v10, v6, v7
 v_accvgpr_read_b32 v7, a71
 v_lshlrev_b32 v6, 16, v7
 v_and_b32 v7, s26, v7
 v_pk_mul_f32 v[6:7], v[6:7], v[174:175]
 v_cvt_pk_bf16_f32 v11, v6, v7
 ds_write_b128 v17, v[8:11] offset:4096
 v_accvgpr_read_b32 v7, a100
 v_lshlrev_b32 v6, 16, v7
 v_and_b32 v7, s26, v7
 v_pk_mul_f32 v[6:7], v[6:7], v[204:205]
 v_cvt_pk_bf16_f32 v12, v6, v7
 v_accvgpr_read_b32 v7, a101
 v_lshlrev_b32 v6, 16, v7
 v_and_b32 v7, s26, v7
 v_pk_mul_f32 v[6:7], v[6:7], v[206:207]
 v_cvt_pk_bf16_f32 v13, v6, v7
 v_accvgpr_read_b32 v7, a102
 v_lshlrev_b32 v6, 16, v7
 v_and_b32 v7, s26, v7
 v_pk_mul_f32 v[6:7], v[6:7], v[236:237]
 v_cvt_pk_bf16_f32 v14, v6, v7
 v_accvgpr_read_b32 v7, a103
 v_lshlrev_b32 v6, 16, v7
 v_and_b32 v7, s26, v7
 v_pk_mul_f32 v[6:7], v[6:7], v[238:239]
 v_cvt_pk_bf16_f32 v15, v6, v7
 ds_write_b128 v18, v[12:15] offset:4096
 ds_read_b128 v[48:51], v3 offset:4096
 ds_read_b128 v[80:83], v3 offset:5120
 v_accvgpr_read_b32 v7, a72
 v_lshlrev_b32 v6, 16, v7
 v_and_b32 v7, s26, v7
 v_pk_mul_f32 v[6:7], v[6:7], v[144:145]
 v_cvt_pk_bf16_f32 v8, v6, v7
 v_accvgpr_read_b32 v7, a73
 v_lshlrev_b32 v6, 16, v7
 v_and_b32 v7, s26, v7
 v_pk_mul_f32 v[6:7], v[6:7], v[146:147]
 v_cvt_pk_bf16_f32 v9, v6, v7
 v_accvgpr_read_b32 v7, a74
 v_lshlrev_b32 v6, 16, v7
 s_waitcnt lgkmcnt(1)
 s_add_u32 s3, s28, 32768
 buffer_store_dwordx4 v[48:51], v16, s[16:19], s3 offen offset:128 nt
 s_waitcnt lgkmcnt(0)
 s_add_u32 s3, s28, 49152
 buffer_store_dwordx4 v[80:83], v16, s[16:19], s3 offen offset:128 nt
 v_and_b32 v7, s26, v7
 v_pk_mul_f32 v[6:7], v[6:7], v[176:177]
 v_cvt_pk_bf16_f32 v10, v6, v7
 v_accvgpr_read_b32 v7, a75
 v_lshlrev_b32 v6, 16, v7
 v_and_b32 v7, s26, v7
 v_pk_mul_f32 v[6:7], v[6:7], v[178:179]
 v_cvt_pk_bf16_f32 v11, v6, v7
 ds_write_b128 v17, v[8:11] offset:8192
 v_accvgpr_read_b32 v7, a104
 v_lshlrev_b32 v6, 16, v7
 v_and_b32 v7, s26, v7
 v_pk_mul_f32 v[6:7], v[6:7], v[208:209]
 v_cvt_pk_bf16_f32 v12, v6, v7
 v_accvgpr_read_b32 v7, a105
 v_lshlrev_b32 v6, 16, v7
 v_and_b32 v7, s26, v7
 v_pk_mul_f32 v[6:7], v[6:7], v[210:211]
 v_cvt_pk_bf16_f32 v13, v6, v7
 v_accvgpr_read_b32 v7, a106
 v_lshlrev_b32 v6, 16, v7
 v_and_b32 v7, s26, v7
 v_pk_mul_f32 v[6:7], v[6:7], v[240:241]
 v_cvt_pk_bf16_f32 v14, v6, v7
 v_accvgpr_read_b32 v7, a107
 v_lshlrev_b32 v6, 16, v7
 v_and_b32 v7, s26, v7
 v_pk_mul_f32 v[6:7], v[6:7], v[242:243]
 v_cvt_pk_bf16_f32 v15, v6, v7
 ds_write_b128 v18, v[12:15] offset:8192
 ds_read_b128 v[48:51], v3 offset:8192
 ds_read_b128 v[80:83], v3 offset:9216
 v_accvgpr_read_b32 v7, a76
 v_lshlrev_b32 v6, 16, v7
 v_and_b32 v7, s26, v7
 v_pk_mul_f32 v[6:7], v[6:7], v[148:149]
 v_cvt_pk_bf16_f32 v8, v6, v7
 v_accvgpr_read_b32 v7, a77
 v_lshlrev_b32 v6, 16, v7
 v_and_b32 v7, s26, v7
 v_pk_mul_f32 v[6:7], v[6:7], v[150:151]
 v_cvt_pk_bf16_f32 v9, v6, v7
 v_accvgpr_read_b32 v7, a78
 v_lshlrev_b32 v6, 16, v7
 s_waitcnt lgkmcnt(1)
 s_add_u32 s3, s28, 65536
 buffer_store_dwordx4 v[48:51], v16, s[16:19], s3 offen offset:128 nt
 s_waitcnt lgkmcnt(0)
 s_add_u32 s3, s28, 81920
 buffer_store_dwordx4 v[80:83], v16, s[16:19], s3 offen offset:128 nt
 v_and_b32 v7, s26, v7
 v_pk_mul_f32 v[6:7], v[6:7], v[180:181]
 v_cvt_pk_bf16_f32 v10, v6, v7
 v_accvgpr_read_b32 v7, a79
 v_lshlrev_b32 v6, 16, v7
 v_and_b32 v7, s26, v7
 v_pk_mul_f32 v[6:7], v[6:7], v[182:183]
 v_cvt_pk_bf16_f32 v11, v6, v7
 ds_write_b128 v17, v[8:11] offset:12288
 v_accvgpr_read_b32 v7, a108
 v_lshlrev_b32 v6, 16, v7
 v_and_b32 v7, s26, v7
 v_pk_mul_f32 v[6:7], v[6:7], v[212:213]
 v_cvt_pk_bf16_f32 v12, v6, v7
 v_accvgpr_read_b32 v7, a109
 v_lshlrev_b32 v6, 16, v7
 v_and_b32 v7, s26, v7
 v_pk_mul_f32 v[6:7], v[6:7], v[214:215]
 v_cvt_pk_bf16_f32 v13, v6, v7
 v_accvgpr_read_b32 v7, a110
 v_lshlrev_b32 v6, 16, v7
 v_and_b32 v7, s26, v7
 v_pk_mul_f32 v[6:7], v[6:7], v[244:245]
 v_cvt_pk_bf16_f32 v14, v6, v7
 v_accvgpr_read_b32 v7, a111
 v_lshlrev_b32 v6, 16, v7
 v_and_b32 v7, s26, v7
 v_pk_mul_f32 v[6:7], v[6:7], v[246:247]
 v_cvt_pk_bf16_f32 v15, v6, v7
 ds_write_b128 v18, v[12:15] offset:12288
 ds_read_b128 v[48:51], v3 offset:12288
 ds_read_b128 v[80:83], v3 offset:13312
 v_accvgpr_read_b32 v7, a80
 v_lshlrev_b32 v6, 16, v7
 v_and_b32 v7, s26, v7
 v_pk_mul_f32 v[6:7], v[6:7], v[152:153]
 v_cvt_pk_bf16_f32 v8, v6, v7
 v_accvgpr_read_b32 v7, a81
 v_lshlrev_b32 v6, 16, v7
 v_and_b32 v7, s26, v7
 v_pk_mul_f32 v[6:7], v[6:7], v[154:155]
 v_cvt_pk_bf16_f32 v9, v6, v7
 v_accvgpr_read_b32 v7, a82
 v_lshlrev_b32 v6, 16, v7
 s_waitcnt lgkmcnt(1)
 s_add_u32 s3, s28, 98304
 buffer_store_dwordx4 v[48:51], v16, s[16:19], s3 offen offset:128 nt
 s_waitcnt lgkmcnt(0)
 s_add_u32 s3, s28, 114688
 buffer_store_dwordx4 v[80:83], v16, s[16:19], s3 offen offset:128 nt
 v_and_b32 v7, s26, v7
 v_pk_mul_f32 v[6:7], v[6:7], v[184:185]
 v_cvt_pk_bf16_f32 v10, v6, v7
 v_accvgpr_read_b32 v7, a83
 v_lshlrev_b32 v6, 16, v7
 v_and_b32 v7, s26, v7
 v_pk_mul_f32 v[6:7], v[6:7], v[186:187]
 v_cvt_pk_bf16_f32 v11, v6, v7
 ds_write_b128 v17, v[8:11] offset:16384
 v_accvgpr_read_b32 v7, a112
 v_lshlrev_b32 v6, 16, v7
 v_and_b32 v7, s26, v7
 v_pk_mul_f32 v[6:7], v[6:7], v[216:217]
 v_cvt_pk_bf16_f32 v12, v6, v7
 v_accvgpr_read_b32 v7, a113
 v_lshlrev_b32 v6, 16, v7
 v_and_b32 v7, s26, v7
 v_pk_mul_f32 v[6:7], v[6:7], v[218:219]
 v_cvt_pk_bf16_f32 v13, v6, v7
 v_accvgpr_read_b32 v7, a114
 v_lshlrev_b32 v6, 16, v7
 v_and_b32 v7, s26, v7
 v_pk_mul_f32 v[6:7], v[6:7], v[248:249]
 v_cvt_pk_bf16_f32 v14, v6, v7
 v_accvgpr_read_b32 v7, a115
 v_lshlrev_b32 v6, 16, v7
 v_and_b32 v7, s26, v7
 v_pk_mul_f32 v[6:7], v[6:7], v[250:251]
 v_cvt_pk_bf16_f32 v15, v6, v7
 ds_write_b128 v18, v[12:15] offset:16384
 ds_read_b128 v[48:51], v3 offset:16384
 ds_read_b128 v[80:83], v3 offset:17408
 v_accvgpr_read_b32 v7, a84
 v_lshlrev_b32 v6, 16, v7
 v_and_b32 v7, s26, v7
 v_pk_mul_f32 v[6:7], v[6:7], v[156:157]
 v_cvt_pk_bf16_f32 v8, v6, v7
 v_accvgpr_read_b32 v7, a85
 v_lshlrev_b32 v6, 16, v7
 v_and_b32 v7, s26, v7
 v_pk_mul_f32 v[6:7], v[6:7], v[158:159]
 v_cvt_pk_bf16_f32 v9, v6, v7
 v_accvgpr_read_b32 v7, a86
 v_lshlrev_b32 v6, 16, v7
 s_waitcnt lgkmcnt(1)
 s_add_u32 s3, s28, 131072
 buffer_store_dwordx4 v[48:51], v16, s[16:19], s3 offen offset:128 nt
 s_waitcnt lgkmcnt(0)
 s_add_u32 s3, s28, 147456
 buffer_store_dwordx4 v[80:83], v16, s[16:19], s3 offen offset:128 nt
 v_and_b32 v7, s26, v7
 v_pk_mul_f32 v[6:7], v[6:7], v[188:189]
 v_cvt_pk_bf16_f32 v10, v6, v7
 v_accvgpr_read_b32 v7, a87
 v_lshlrev_b32 v6, 16, v7
 v_and_b32 v7, s26, v7
 v_pk_mul_f32 v[6:7], v[6:7], v[190:191]
 v_cvt_pk_bf16_f32 v11, v6, v7
 ds_write_b128 v17, v[8:11] offset:20480
 v_accvgpr_read_b32 v7, a116
 v_lshlrev_b32 v6, 16, v7
 v_and_b32 v7, s26, v7
 v_pk_mul_f32 v[6:7], v[6:7], v[220:221]
 v_cvt_pk_bf16_f32 v12, v6, v7
 v_accvgpr_read_b32 v7, a117
 v_lshlrev_b32 v6, 16, v7
 v_and_b32 v7, s26, v7
 v_pk_mul_f32 v[6:7], v[6:7], v[222:223]
 v_cvt_pk_bf16_f32 v13, v6, v7
 v_accvgpr_read_b32 v7, a118
 v_lshlrev_b32 v6, 16, v7
 v_and_b32 v7, s26, v7
 v_pk_mul_f32 v[6:7], v[6:7], v[252:253]
 v_cvt_pk_bf16_f32 v14, v6, v7
 v_accvgpr_read_b32 v7, a119
 v_lshlrev_b32 v6, 16, v7
 v_and_b32 v7, s26, v7
 v_pk_mul_f32 v[6:7], v[6:7], v[254:255]
 v_cvt_pk_bf16_f32 v15, v6, v7
 ds_write_b128 v18, v[12:15] offset:20480
 ds_read_b128 v[48:51], v3 offset:20480
 ds_read_b128 v[80:83], v3 offset:21504
 v_accvgpr_read_b32 v7, a88
 v_lshlrev_b32 v6, 16, v7
 v_and_b32 v7, s26, v7
 v_pk_mul_f32 v[6:7], v[6:7], v[160:161]
 v_cvt_pk_bf16_f32 v8, v6, v7
 v_accvgpr_read_b32 v7, a89
 v_lshlrev_b32 v6, 16, v7
 v_and_b32 v7, s26, v7
 v_pk_mul_f32 v[6:7], v[6:7], v[162:163]
 v_cvt_pk_bf16_f32 v9, v6, v7
 v_accvgpr_read_b32 v7, a90
 v_lshlrev_b32 v6, 16, v7
 s_waitcnt lgkmcnt(1)
 s_add_u32 s3, s28, 163840
 buffer_store_dwordx4 v[48:51], v16, s[16:19], s3 offen offset:128 nt
 s_waitcnt lgkmcnt(0)
 s_add_u32 s3, s28, 180224
 buffer_store_dwordx4 v[80:83], v16, s[16:19], s3 offen offset:128 nt
 v_and_b32 v7, s26, v7
 v_pk_mul_f32 v[6:7], v[6:7], v[192:193]
 v_cvt_pk_bf16_f32 v10, v6, v7
 v_accvgpr_read_b32 v7, a91
 v_lshlrev_b32 v6, 16, v7
 v_and_b32 v7, s26, v7
 v_pk_mul_f32 v[6:7], v[6:7], v[194:195]
 v_cvt_pk_bf16_f32 v11, v6, v7
 ds_write_b128 v17, v[8:11] offset:24576
 v_accvgpr_read_b32 v7, a120
 v_lshlrev_b32 v6, 16, v7
 v_and_b32 v7, s26, v7
 v_pk_mul_f32 v[6:7], v[6:7], v[224:225]
 v_cvt_pk_bf16_f32 v12, v6, v7
 v_accvgpr_read_b32 v7, a121
 v_lshlrev_b32 v6, 16, v7
 v_and_b32 v7, s26, v7
 v_pk_mul_f32 v[6:7], v[6:7], v[226:227]
 v_cvt_pk_bf16_f32 v13, v6, v7
 v_accvgpr_read_b32 v7, a122
 v_accvgpr_read_b32 v112, a248
 v_accvgpr_read_b32 v113, a249
 v_lshlrev_b32 v6, 16, v7
 v_and_b32 v7, s26, v7
 v_pk_mul_f32 v[6:7], v[6:7], v[112:113]
 v_cvt_pk_bf16_f32 v14, v6, v7
 v_accvgpr_read_b32 v7, a123
 v_accvgpr_read_b32 v112, a250
 v_accvgpr_read_b32 v113, a251
 v_lshlrev_b32 v6, 16, v7
 v_and_b32 v7, s26, v7
 v_pk_mul_f32 v[6:7], v[6:7], v[112:113]
 v_cvt_pk_bf16_f32 v15, v6, v7
 ds_write_b128 v18, v[12:15] offset:24576
 ds_read_b128 v[48:51], v3 offset:24576
 ds_read_b128 v[80:83], v3 offset:25600
 v_accvgpr_read_b32 v7, a92
 v_lshlrev_b32 v6, 16, v7
 v_and_b32 v7, s26, v7
 v_pk_mul_f32 v[6:7], v[6:7], v[164:165]
 v_cvt_pk_bf16_f32 v8, v6, v7
 v_accvgpr_read_b32 v7, a93
 v_lshlrev_b32 v6, 16, v7
 v_and_b32 v7, s26, v7
 v_pk_mul_f32 v[6:7], v[6:7], v[166:167]
 v_cvt_pk_bf16_f32 v9, v6, v7
 v_accvgpr_read_b32 v7, a94
 v_lshlrev_b32 v6, 16, v7
 s_waitcnt lgkmcnt(1)
 s_add_u32 s3, s28, 196608
 buffer_store_dwordx4 v[48:51], v16, s[16:19], s3 offen offset:128 nt
 s_waitcnt lgkmcnt(0)
 s_add_u32 s3, s28, 212992
 buffer_store_dwordx4 v[80:83], v16, s[16:19], s3 offen offset:128 nt
 v_and_b32 v7, s26, v7
 v_pk_mul_f32 v[6:7], v[6:7], v[196:197]
 v_cvt_pk_bf16_f32 v10, v6, v7
 v_accvgpr_read_b32 v7, a95
 v_lshlrev_b32 v6, 16, v7
 v_and_b32 v7, s26, v7
 v_pk_mul_f32 v[6:7], v[6:7], v[198:199]
 v_cvt_pk_bf16_f32 v11, v6, v7
 ds_write_b128 v17, v[8:11] offset:28672
 v_accvgpr_read_b32 v7, a124
 v_lshlrev_b32 v6, 16, v7
 v_and_b32 v7, s26, v7
 v_pk_mul_f32 v[6:7], v[6:7], v[228:229]
 v_cvt_pk_bf16_f32 v12, v6, v7
 v_accvgpr_read_b32 v7, a125
 v_lshlrev_b32 v6, 16, v7
 v_and_b32 v7, s26, v7
 v_pk_mul_f32 v[6:7], v[6:7], v[230:231]
 v_cvt_pk_bf16_f32 v13, v6, v7
 v_accvgpr_read_b32 v7, a126
 v_accvgpr_read_b32 v112, a252
 v_accvgpr_read_b32 v113, a253
 v_lshlrev_b32 v6, 16, v7
 v_and_b32 v7, s26, v7
 v_pk_mul_f32 v[6:7], v[6:7], v[112:113]
 v_cvt_pk_bf16_f32 v14, v6, v7
 v_accvgpr_read_b32 v7, a127
 v_accvgpr_read_b32 v112, a254
 v_accvgpr_read_b32 v113, a255
 v_lshlrev_b32 v6, 16, v7
 v_and_b32 v7, s26, v7
 v_pk_mul_f32 v[6:7], v[6:7], v[112:113]
 v_cvt_pk_bf16_f32 v15, v6, v7
 ds_write_b128 v18, v[12:15] offset:28672
 ds_read_b128 v[48:51], v3 offset:28672
 ds_read_b128 v[80:83], v3 offset:29696
 s_waitcnt lgkmcnt(1)
 s_add_u32 s3, s28, 229376
 buffer_store_dwordx4 v[48:51], v16, s[16:19], s3 offen offset:128 nt
 s_waitcnt lgkmcnt(0)
 s_add_u32 s3, s28, 245760
 buffer_store_dwordx4 v[80:83], v16, s[16:19], s3 offen offset:128 nt
Lend:
 s_endpgm
Lspin_pro:
 s_add_u32 s53, s53, 1
 v_lshlrev_b32 v4, 2, v1
 v_and_b32 v4, 192, v4
 buffer_load_dword v4, v4, s[44:47], 0 offen sc1
 s_cmp_ge_u32 s53, 0x100000
 s_cbranch_scc1 Lgiveup_pro
 s_waitcnt vmcnt(0)
 v_cmp_gt_i32 vcc, s27, v4
 s_cbranch_vccnz Lspin_pro
Lgiveup_pro:
 s_waitcnt vmcnt(0)
 s_branch Lok_pro
Lspin_pa:
 s_add_u32 s53, s53, 1
 buffer_load_dword v4, off, s[64:67], 0 sc1
 s_cmp_ge_u32 s53, 0x100000
 s_cbranch_scc1 Lgiveup_pa
 s_waitcnt vmcnt(0)
 v_cmp_gt_i32 vcc, s55, v4
 s_cbranch_vccnz Lspin_pa
Lgiveup_pa:
 s_waitcnt vmcnt(0)
 s_branch Lok_pa
Lgat0:
 v_and_b32 v5, 0xf0, v1
 v_lshrrev_b32 v6, 4, v1
 v_and_b32 v6, 0x30, v6
 v_lshl_add_u32 v6, v5, 7, v6
 s_branch Lgatr0
Lspin_pb:
 s_add_u32 s53, s53, 1
 buffer_load_dword v4, off, s[64:67], 0 sc1
 s_cmp_ge_u32 s53, 0x100000
 s_cbranch_scc1 Lgiveup_pb
 s_waitcnt vmcnt(0)
 v_cmp_gt_i32 vcc, s55, v4
 s_cbranch_vccnz Lspin_pb
Lgiveup_pb:
 s_waitcnt vmcnt(0)
 s_branch Lok_pb
Lgat1:
 v_and_b32 v5, 0xf0, v1
 v_lshrrev_b32 v6, 4, v1
 v_and_b32 v6, 0x30, v6
 v_lshl_add_u32 v6, v5, 7, v6
 s_branch Lgatr1
Lspin_w:
 s_add_u32 s53, s53, 1
 v_lshlrev_b32 v4, 2, v1
 v_and_b32 v4, 192, v4
 buffer_load_dword v4, v4, s[44:47], 0 offen sc1
 s_cmp_ge_u32 s53, 0x100000
 s_cbranch_scc1 Lgiveup_w
 s_waitcnt vmcnt(0)
 v_cmp_gt_i32 vcc, s27, v4
 s_cbranch_vccnz Lspin_w
Lgiveup_w:
 s_waitcnt vmcnt(0)
 s_branch Lok_w
.section .rodata,"a"
.p2align 6
.amdhsa_kernel standalone__cross_network_dcn__recsys_kernel
  .amdhsa_next_free_vgpr 512
  .amdhsa_next_free_sgpr 102
  .amdhsa_accum_offset 256
  .amdhsa_group_segment_fixed_size 0
  .amdhsa_kernarg_size 48
  .amdhsa_user_sgpr_count 2
  .amdhsa_user_sgpr_kernarg_segment_ptr 1
  .amdhsa_system_sgpr_workgroup_id_x 1
  .amdhsa_float_denorm_mode_32 3
.end_amdhsa_kernel
```

```asm
; @launch grid=(256,1,1) block=(256,1,1) lds=151552
.amdgcn_target "amdgcn-amd-amdhsa--gfx950"
.text
.globl standalone__cross_network_dcn__recsys_kernel
.p2align 8
.type standalone__cross_network_dcn__recsys_kernel,@function
standalone__cross_network_dcn__recsys_kernel:
 s_cmp_ge_u32 s2, 256
 s_cbranch_scc1 Lend
 s_load_dwordx4 s[56:59], s[0:1], 0
 s_load_dwordx4 s[60:63], s[0:1], 16
 s_load_dwordx4 s[64:67], s[0:1], 32
 v_lshrrev_b32 v9, 6, v0
 v_and_b32 v10, 63, v0
 v_readfirstlane_b32 s54, v9
 v_lshlrev_b32 v1, 4, v10
 s_getpc_b64 s[4:5]
Lpc:
 v_lshlrev_b32 v11, 6, v0
 s_bfe_u32 s3, s2, 0x20003
 s_lshl_b32 s3, s3, 14
 v_add_u32 v11, s3, v11
 v_min_u32 v12, Lend-Lpc, v11
 global_load_dword v60, v12, s[4:5]
 v_add_u32 v11, 16384, v11
 v_lshrrev_b32 v11, 7, v0
 v_and_b32 v12, 127, v0
 v_lshlrev_b32 v12, 3, v12
 v_lshl_add_u32 v30, v11, 11, v12
 v_lshlrev_b32 v31, 4, v0
 v_add_u32 v31, 131072, v31
 v_add_u32 v2, 65536, v1
 v_lshl_add_u32 v3, v9, 15, v1
 v_lshl_add_u32 v0, v9, 18, v1
 s_and_b32 s7, s2, 1
 s_lshr_b32 s28, s2, 1
 s_lshl_b32 s28, s28, 18
 s_lshl_b32 s6, s7, 10
 s_add_u32 s28, s28, s6
 s_lshl_b32 s6, s54, 8
 s_add_u32 s28, s28, s6
 s_mov_b32 s26, 0xffff0000
 s_lshl_b32 s24, s7, 20
 s_mov_b32 s25, 0
 s_mov_b32 s53, 0
 s_mov_b32 s31, -1
 s_mov_b32 s27, 64
 s_mov_b32 s55, -1
 s_lshl_b32 s50, s54, 15
 s_lshl_b32 s29, s2, 17
 s_add_u32 s29, s29, 33554432
 s_xor_b32 s30, s29, 131072
 s_lshr_b32 s4, s2, 3
 s_and_b32 s5, s2, 7
 s_lshl_b32 s48, s4, 16
 s_lshl_b32 s6, s5, 8
 s_add_u32 s48, s48, s6
 s_lshl_b32 s6, s54, 6
 s_add_u32 s48, s48, s6
 s_lshl_b32 s49, s5, 18
 s_and_b32 s6, s4, 1
 s_lshl_b32 s6, s6, 10
 s_add_u32 s49, s49, s6
 s_lshr_b32 s6, s4, 4
 s_lshr_b32 s5, s5, 2
 s_xor_b32 s5, s5, s6
 s_bfe_u32 s6, s4, 0x10001
 s_lshl_b32 s3, s5, 1
 s_add_u32 s3, s3, s6
 s_lshl_b32 s3, s3, 16
 s_add_u32 s49, s49, s3
 s_bfe_u32 s4, s4, 0x20002
 s_xor_b32 s5, s5, s6
 s_lshr_b32 s3, s54, 1
 s_lshl_b32 s3, s3, 4
 s_lshl_b32 s6, s4, 2
 s_add_u32 s3, s3, s6
 s_and_b32 s6, s54, 1
 s_lshl_b32 s6, s6, 1
 s_add_u32 s3, s3, s6
 s_lshl_b32 s4, s4, 3
 s_lshl_b32 s6, s54, 1
 s_add_u32 s4, s4, s6
 s_cmp_eq_u32 s5, 0
 s_cselect_b32 s3, s3, s4
 s_lshl_b32 s3, s3, 11
 s_add_u32 s49, s49, s3
 s_lshl_b32 s52, s54, 11
 s_add_u32 s52, s52, 143360
 s_lshl_b32 s51, s54, 9
 s_add_u32 s51, s51, 131072
 s_waitcnt lgkmcnt(0)
 s_mov_b32 s40, s58
 s_mov_b32 s41, s59
 s_mov_b32 s42, 0xc00000
 s_mov_b32 s43, 0x20000
 v_lshrrev_b32 v5, 6, v1
 v_and_b32 v6, 48, v1
 v_lshl_add_u32 v5, v5, 11, v6
 s_mov_b32 m0, s52
 s_add_u32 s3, s48, 31744
 buffer_load_dwordx4 v5, s[40:43], s48 offen lds
 buffer_load_dwordx4 v5, s[40:43], s3 offen offset:1024 lds
 s_add_u32 s48, s48, 2097152
 s_mov_b32 s20, s60
 s_mov_b32 s21, s61
 s_mov_b32 s22, 0x3000
 s_mov_b32 s23, 0x20000
 s_lshl_b32 s3, s7, 10
 buffer_load_dwordx2 v[32:33], v30, s[20:23], s3 offen
 s_add_u32 s3, s3, 4096
 buffer_load_dwordx2 v[34:35], v30, s[20:23], s3 offen
 s_add_u32 s3, s3, 4096
 buffer_load_dwordx2 v[36:37], v30, s[20:23], s3 offen
 s_add_u32 s3, s3, 4096
 s_mov_b32 s8, s56
 s_mov_b32 s9, s57
 s_mov_b32 s10, 0x2000000
 s_mov_b32 s11, 0x20000
 s_mov_b32 s16, s62
 s_mov_b32 s17, s63
 s_mov_b32 s18, 0x2000000
 s_mov_b32 s19, 0x20000
 s_mov_b32 s12, s66
 s_mov_b32 s13, s67
 s_mov_b32 s14, 0xc00000
 s_mov_b32 s15, 0x20000
 s_mov_b32 s32, s66
 s_mov_b32 s33, s67
 s_mov_b32 s34, 0x10000000
 s_mov_b32 s35, 0x20000
 s_mov_b32 s44, s64
 s_mov_b32 s45, s65
 s_mov_b32 s46, 0x100
 s_mov_b32 s47, 0x20000
 s_add_u32 s24, s24, 4096
 s_add_u32 s70, s66, s24
 s_addc_u32 s71, s67, 0
 s_sub_u32 s24, s24, 4096
 s_and_b32 s3, s2, 3
 s_lshl_b32 s3, s3, 6
 s_add_u32 s56, s44, s3
 s_addc_u32 s57, s45, 0
 s_mov_b32 s58, 0x4
 s_mov_b32 s59, 0x20000
 s_lshl_b32 s3, s2, 2
 s_add_u32 s3, s3, s54
 s_lshl_b32 s3, s3, 7
 s_add_u32 s3, s3, 15728640
 s_add_u32 s60, s32, s3
 s_addc_u32 s61, s33, 0
 s_mov_b32 s62, 0x4
 s_mov_b32 s63, 0x20000
 s_xor_b32 s3, s3, 512
 s_add_u32 s64, s32, s3
 s_addc_u32 s65, s33, 0
 s_mov_b32 s66, 0x4
 s_mov_b32 s67, 0x20000
 v_mov_b32 v7, 0
 buffer_store_dword v7, v1, s[60:63], 0 offen sc1
 v_lshrrev_b32 v5, 7, v1
 v_lshlrev_b32 v6, 4, v5
 v_xor_b32 v6, v6, v1
 v_and_b32 v6, 112, v6
 v_lshl_add_u32 v20, v5, 11, v6
 v_lshrrev_b32 v5, 4, v1
 v_and_b32 v5, 48, v5
 v_xor_b32 v5, v5, v1
 v_and_b32 v5, 112, v5
 v_and_b32 v6, 240, v1
 v_lshl_add_u32 v5, v6, 3, v5
 v_add_u32 v21, s50, v5
 v_xor_b32 v22, 64, v21
 s_add_u32 m0, s50, 0
 s_add_u32 s3, s28, 0
 buffer_load_dwordx4 v20, s[8:11], s3 offen lds
 s_add_u32 m0, s50, 1024
 s_add_u32 s3, s28, 16384
 buffer_load_dwordx4 v20, s[8:11], s3 offen lds
 s_add_u32 m0, s50, 4096
 s_add_u32 s3, s28, 32768
 buffer_load_dwordx4 v20, s[8:11], s3 offen lds
 s_add_u32 m0, s50, 5120
 s_add_u32 s3, s28, 49152
 buffer_load_dwordx4 v20, s[8:11], s3 offen lds
 v_mov_b32 v64, 1.0
 v_mov_b32 v65, 1.0
 v_mov_b32 v66, 1.0
 v_mov_b32 v67, 1.0
 v_mov_b32 v68, 1.0
 v_mov_b32 v69, 1.0
 v_mov_b32 v70, 1.0
 v_mov_b32 v71, 1.0
 v_mov_b32 v72, 1.0
 v_mov_b32 v73, 1.0
 v_mov_b32 v74, 1.0
 v_mov_b32 v75, 1.0
 v_mov_b32 v76, 1.0
 v_mov_b32 v77, 1.0
 v_mov_b32 v78, 1.0
 v_mov_b32 v79, 1.0
 v_mov_b32 v80, 1.0
 v_mov_b32 v81, 1.0
 v_mov_b32 v82, 1.0
 v_mov_b32 v83, 1.0
 v_mov_b32 v84, 1.0
 v_mov_b32 v85, 1.0
 v_mov_b32 v86, 1.0
 v_mov_b32 v87, 1.0
 v_mov_b32 v88, 1.0
 v_mov_b32 v89, 1.0
 v_mov_b32 v90, 1.0
 v_mov_b32 v91, 1.0
 v_mov_b32 v92, 1.0
 v_mov_b32 v93, 1.0
 v_mov_b32 v94, 1.0
 v_mov_b32 v95, 1.0
 v_mov_b32 v96, 1.0
 v_mov_b32 v97, 1.0
 v_mov_b32 v98, 1.0
 v_mov_b32 v99, 1.0
 v_mov_b32 v100, 1.0
 v_mov_b32 v101, 1.0
 v_mov_b32 v102, 1.0
 v_mov_b32 v103, 1.0
 v_mov_b32 v104, 1.0
 v_mov_b32 v105, 1.0
 v_mov_b32 v106, 1.0
 v_mov_b32 v107, 1.0
 v_mov_b32 v108, 1.0
 v_mov_b32 v109, 1.0
 v_mov_b32 v110, 1.0
 v_mov_b32 v111, 1.0
 v_mov_b32 v112, 1.0
 v_mov_b32 v113, 1.0
 v_mov_b32 v114, 1.0
 v_mov_b32 v115, 1.0
 v_mov_b32 v116, 1.0
 v_mov_b32 v117, 1.0
 v_mov_b32 v118, 1.0
 v_mov_b32 v119, 1.0
 v_mov_b32 v120, 1.0
 v_mov_b32 v121, 1.0
 v_mov_b32 v122, 1.0
 v_mov_b32 v123, 1.0
 v_mov_b32 v124, 1.0
 v_mov_b32 v125, 1.0
 v_mov_b32 v126, 1.0
 v_mov_b32 v127, 1.0
 v_mov_b32 v128, 1.0
 v_mov_b32 v129, 1.0
 v_mov_b32 v130, 1.0
 v_mov_b32 v131, 1.0
 v_mov_b32 v132, 1.0
 v_mov_b32 v133, 1.0
 v_mov_b32 v134, 1.0
 v_mov_b32 v135, 1.0
 v_accvgpr_write_b32 a240, 1.0
 v_accvgpr_write_b32 a241, 1.0
 v_accvgpr_write_b32 a242, 1.0
 v_accvgpr_write_b32 a243, 1.0
 v_accvgpr_write_b32 a244, 1.0
 v_accvgpr_write_b32 a245, 1.0
 v_accvgpr_write_b32 a246, 1.0
 v_accvgpr_write_b32 a247, 1.0
 v_mov_b32 v216, 1.0
 v_mov_b32 v217, 1.0
 v_mov_b32 v218, 1.0
 v_mov_b32 v219, 1.0
 v_mov_b32 v220, 1.0
 v_mov_b32 v221, 1.0
 v_mov_b32 v222, 1.0
 v_mov_b32 v223, 1.0
 v_mov_b32 v224, 1.0
 v_mov_b32 v225, 1.0
 v_mov_b32 v226, 1.0
 v_mov_b32 v227, 1.0
 v_mov_b32 v228, 1.0
 v_mov_b32 v229, 1.0
 v_mov_b32 v230, 1.0
 v_mov_b32 v231, 1.0
 v_mov_b32 v232, 1.0
 v_mov_b32 v233, 1.0
 v_mov_b32 v234, 1.0
 v_mov_b32 v235, 1.0
 v_mov_b32 v236, 1.0
 v_mov_b32 v237, 1.0
 v_mov_b32 v238, 1.0
 v_mov_b32 v239, 1.0
 v_mov_b32 v240, 1.0
 v_mov_b32 v241, 1.0
 v_mov_b32 v242, 1.0
 v_mov_b32 v243, 1.0
 v_mov_b32 v244, 1.0
 v_mov_b32 v245, 1.0
 v_mov_b32 v246, 1.0
 v_mov_b32 v247, 1.0
 v_mov_b32 v248, 1.0
 v_mov_b32 v249, 1.0
 v_mov_b32 v250, 1.0
 v_mov_b32 v251, 1.0
 v_mov_b32 v252, 1.0
 v_mov_b32 v253, 1.0
 v_mov_b32 v254, 1.0
 v_mov_b32 v255, 1.0
 v_accvgpr_write_b32 a248, 1.0
 v_accvgpr_write_b32 a249, 1.0
 v_accvgpr_write_b32 a250, 1.0
 v_accvgpr_write_b32 a251, 1.0
 v_accvgpr_write_b32 a252, 1.0
 v_accvgpr_write_b32 a253, 1.0
 v_accvgpr_write_b32 a254, 1.0
 v_accvgpr_write_b32 a255, 1.0
 v_and_b32 v5, 768, v1
 v_add3_u32 v5, v5, v1, s52
 s_waitcnt vmcnt(8)
 ds_read_b64_tr_b16 v[8:9], v5 offset:0
 ds_read_b64_tr_b16 v[10:11], v5 offset:256
 ds_read_b64_tr_b16 v[12:13], v5 offset:8
 ds_read_b64_tr_b16 v[14:15], v5 offset:264
 s_waitcnt lgkmcnt(2)
 buffer_store_dwordx4 v[8:11], v1, s[12:15], s49 offen sc1
 s_waitcnt lgkmcnt(0)
 buffer_store_dwordx4 v[12:15], v1, s[12:15], s49 offen offset:2048 sc1
 s_add_u32 s49, s49, 2097152
 s_waitcnt vmcnt(9)
 v_lshlrev_b32 v40, 16, v32
 v_and_b32 v41, s26, v32
 v_lshlrev_b32 v42, 16, v33
 v_and_b32 v43, s26, v33
 ds_write_b128 v31, v[40:43]
 s_waitcnt vmcnt(8)
 v_lshlrev_b32 v44, 16, v34
 v_and_b32 v45, s26, v34
 v_lshlrev_b32 v46, 16, v35
 v_and_b32 v47, s26, v35
 ds_write_b128 v31, v[44:47] offset:4096
 s_waitcnt vmcnt(7)
 v_lshlrev_b32 v48, 16, v36
 v_and_b32 v49, s26, v36
 v_lshlrev_b32 v50, 16, v37
 v_and_b32 v51, s26, v37
 ds_write_b128 v31, v[48:51] offset:8192
 s_waitcnt lgkmcnt(0)
 v_mov_b32 v32, 1.0
 v_mov_b32 v33, 1.0
 v_mov_b32 v34, 1.0
 v_mov_b32 v35, 1.0
 v_mov_b32 v36, 1.0
 v_mov_b32 v37, 1.0
 v_mov_b32 v38, 1.0
 v_mov_b32 v39, 1.0
 v_mov_b32 v40, 1.0
 v_mov_b32 v41, 1.0
 v_mov_b32 v42, 1.0
 v_mov_b32 v43, 1.0
 v_mov_b32 v44, 1.0
 v_mov_b32 v45, 1.0
 v_mov_b32 v46, 1.0
 v_mov_b32 v47, 1.0
 v_mov_b32 v48, 1.0
 v_mov_b32 v49, 1.0
 v_mov_b32 v50, 1.0
 v_mov_b32 v51, 1.0
 v_mov_b32 v52, 1.0
 v_mov_b32 v53, 1.0
 v_mov_b32 v54, 1.0
 v_mov_b32 v55, 1.0
 v_mov_b32 v56, 1.0
 v_mov_b32 v57, 1.0
 v_mov_b32 v58, 1.0
 v_mov_b32 v59, 1.0
 v_mov_b32 v60, 1.0
 v_mov_b32 v61, 1.0
 v_mov_b32 v62, 1.0
 v_mov_b32 v63, 1.0
 s_waitcnt vmcnt(0)
 s_barrier
 v_mov_b32 v7, 1
 buffer_atomic_add v7, v0, s[56:59], 0 offen sc1
 s_add_u32 m0, s50, 8192
 s_add_u32 s3, s28, 65536
 buffer_load_dwordx4 v20, s[8:11], s3 offen lds
 s_add_u32 m0, s50, 9216
 s_add_u32 s3, s28, 81920
 buffer_load_dwordx4 v20, s[8:11], s3 offen lds
 s_add_u32 m0, s50, 12288
 s_add_u32 s3, s28, 98304
 buffer_load_dwordx4 v20, s[8:11], s3 offen lds
 s_add_u32 m0, s50, 13312
 s_add_u32 s3, s28, 114688
 buffer_load_dwordx4 v20, s[8:11], s3 offen lds
 s_add_u32 m0, s50, 16384
 s_add_u32 s3, s28, 131072
 buffer_load_dwordx4 v20, s[8:11], s3 offen lds
 s_add_u32 m0, s50, 17408
 s_add_u32 s3, s28, 147456
 buffer_load_dwordx4 v20, s[8:11], s3 offen lds
 s_add_u32 m0, s50, 20480
 s_add_u32 s3, s28, 163840
 buffer_load_dwordx4 v20, s[8:11], s3 offen lds
 s_add_u32 m0, s50, 21504
 s_add_u32 s3, s28, 180224
 buffer_load_dwordx4 v20, s[8:11], s3 offen lds
 s_add_u32 m0, s50, 24576
 s_add_u32 s3, s28, 196608
 buffer_load_dwordx4 v20, s[8:11], s3 offen lds
 s_add_u32 m0, s50, 25600
 s_add_u32 s3, s28, 212992
 buffer_load_dwordx4 v20, s[8:11], s3 offen lds
 s_add_u32 m0, s50, 28672
 s_add_u32 s3, s28, 229376
 buffer_load_dwordx4 v20, s[8:11], s3 offen lds
 s_add_u32 m0, s50, 29696
 s_add_u32 s3, s28, 245760
 buffer_load_dwordx4 v20, s[8:11], s3 offen lds
 ds_read_b128 a[0:3], v21
 ds_read_b128 a[32:35], v22
 ds_read_b128 a[4:7], v21 offset:4096
 ds_read_b128 a[36:39], v22 offset:4096
 s_waitcnt lgkmcnt(2)
 ds_write_b128 v3, a[0:3]
 ds_write_b128 v3, a[32:35] offset:1024
 s_waitcnt vmcnt(10)
 ds_read_b128 a[8:11], v21 offset:8192
 ds_read_b128 a[40:43], v22 offset:8192
 s_waitcnt lgkmcnt(4)
 ds_write_b128 v3, a[4:7] offset:4096
 ds_write_b128 v3, a[36:39] offset:5120
 s_waitcnt vmcnt(8)
 ds_read_b128 a[12:15], v21 offset:12288
 ds_read_b128 a[44:47], v22 offset:12288
 s_waitcnt lgkmcnt(4)
 ds_write_b128 v3, a[8:11] offset:8192
 ds_write_b128 v3, a[40:43] offset:9216
 s_waitcnt vmcnt(6)
 ds_read_b128 a[16:19], v21 offset:16384
 ds_read_b128 a[48:51], v22 offset:16384
 s_waitcnt lgkmcnt(4)
 ds_write_b128 v3, a[12:15] offset:12288
 ds_write_b128 v3, a[44:47] offset:13312
 s_waitcnt vmcnt(4)
 ds_read_b128 a[20:23], v21 offset:20480
 ds_read_b128 a[52:55], v22 offset:20480
 s_waitcnt lgkmcnt(4)
 ds_write_b128 v3, a[16:19] offset:16384
 ds_write_b128 v3, a[48:51] offset:17408
 s_waitcnt vmcnt(2)
 ds_read_b128 a[24:27], v21 offset:24576
 ds_read_b128 a[56:59], v22 offset:24576
 s_waitcnt lgkmcnt(4)
 ds_write_b128 v3, a[20:23] offset:20480
 ds_write_b128 v3, a[52:55] offset:21504
 s_waitcnt vmcnt(0)
 ds_read_b128 a[28:31], v21 offset:28672
 ds_read_b128 a[60:63], v22 offset:28672
 s_waitcnt lgkmcnt(4)
 ds_write_b128 v3, a[24:27] offset:24576
 ds_write_b128 v3, a[56:59] offset:25600
 v_lshlrev_b32 v4, 2, v1
 v_and_b32 v4, 192, v4
 buffer_load_dword v4, v4, s[44:47], 0 offen sc1
 s_waitcnt lgkmcnt(2)
 ds_write_b128 v3, a[28:31] offset:28672
 ds_write_b128 v3, a[60:63] offset:29696
 s_waitcnt lgkmcnt(0)
 s_barrier
 ds_read_b128 a[128:131], v1
 ds_read_b128 a[132:135], v1 offset:1024
 ds_read_b128 a[140:143], v1 offset:5120
 ds_read_b128 a[136:139], v1 offset:4096
 ds_read_b128 a[144:147], v1 offset:8192
 ds_read_b128 a[148:151], v1 offset:9216
 ds_read_b128 a[156:159], v1 offset:13312
 ds_read_b128 a[152:155], v1 offset:12288
 ds_read_b128 a[160:163], v1 offset:16384
 ds_read_b128 a[164:167], v1 offset:17408
 ds_read_b128 a[172:175], v1 offset:21504
 ds_read_b128 a[168:171], v1 offset:20480
 ds_read_b128 a[176:179], v1 offset:24576
 ds_read_b128 a[180:183], v1 offset:25600
 ds_read_b128 a[188:191], v1 offset:29696
 ds_read_b128 a[184:187], v1 offset:28672
 s_waitcnt vmcnt(0)
 v_cmp_gt_i32 vcc, s27, v4
 s_cbranch_vccnz Lspin_pro
Lok_pro:
 s_add_u32 s27, s27, 64
 global_load_dwordx4 v[140:143], v0, s[70:71] offset:-3072 sc1
 global_load_dwordx4 v[136:139], v0, s[70:71] offset:-4096 sc1
 global_load_dwordx4 v[148:151], v0, s[70:71] offset:-1024 sc1
 global_load_dwordx4 v[144:147], v0, s[70:71] offset:-2048 sc1
 global_load_dwordx4 v[156:159], v0, s[70:71] offset:1024 sc1
 global_load_dwordx4 v[152:155], v0, s[70:71] offset:0 sc1
 global_load_dwordx4 v[164:167], v0, s[70:71] offset:3072 sc1
 global_load_dwordx4 v[160:163], v0, s[70:71] offset:2048 sc1
 s_add_u32 s70, s70, 8192
 s_addc_u32 s71, s71, 0
 global_load_dwordx4 v[172:175], v0, s[70:71] offset:-3072 sc1
 global_load_dwordx4 v[168:171], v0, s[70:71] offset:-4096 sc1
 global_load_dwordx4 v[180:183], v0, s[70:71] offset:-1024 sc1
 global_load_dwordx4 v[176:179], v0, s[70:71] offset:-2048 sc1
 global_load_dwordx4 v[188:191], v0, s[70:71] offset:1024 sc1
 global_load_dwordx4 v[184:187], v0, s[70:71] offset:0 sc1
 global_load_dwordx4 v[196:199], v0, s[70:71] offset:3072 sc1
 global_load_dwordx4 v[192:195], v0, s[70:71] offset:2048 sc1
 s_add_u32 s70, s70, 8192
 s_addc_u32 s71, s71, 0
 global_load_dwordx4 v[204:207], v0, s[70:71] offset:-3072 sc1
 global_load_dwordx4 v[200:203], v0, s[70:71] offset:-4096 sc1
 global_load_dwordx4 v[212:215], v0, s[70:71] offset:-1024 sc1
 global_load_dwordx4 v[208:211], v0, s[70:71] offset:-2048 sc1
 global_load_dwordx4 a[228:231], v0, s[70:71] offset:1024 sc1
 global_load_dwordx4 a[224:227], v0, s[70:71] offset:0 sc1
 global_load_dwordx4 a[236:239], v0, s[70:71] offset:3072 sc1
 global_load_dwordx4 a[232:235], v0, s[70:71] offset:2048 sc1
 s_add_u32 s70, s70, 8192
 s_addc_u32 s71, s71, 0
 global_load_dwordx4 a[196:199], v0, s[70:71] offset:-3072 sc1
 global_load_dwordx4 a[192:195], v0, s[70:71] offset:-4096 sc1
 global_load_dwordx4 a[204:207], v0, s[70:71] offset:-1024 sc1
 global_load_dwordx4 a[200:203], v0, s[70:71] offset:-2048 sc1
 global_load_dwordx4 a[212:215], v0, s[70:71] offset:1024 sc1
 global_load_dwordx4 a[208:211], v0, s[70:71] offset:0 sc1
 global_load_dwordx4 a[220:223], v0, s[70:71] offset:3072 sc1
 global_load_dwordx4 a[216:219], v0, s[70:71] offset:2048 sc1
 s_add_u32 s70, s70, 8192
 s_addc_u32 s71, s71, 0
 v_mov_b32 v8, v20
 v_mov_b32 v16, 1.0
 v_mov_b32 v17, 1.0
 v_mov_b32 v18, 1.0
 v_mov_b32 v19, 1.0
 v_mov_b32 v20, 1.0
 v_mov_b32 v21, 1.0
 v_mov_b32 v22, 1.0
 v_mov_b32 v23, 1.0
 v_mov_b32 v24, 1.0
 v_mov_b32 v25, 1.0
 v_mov_b32 v26, 1.0
 v_mov_b32 v27, 1.0
 v_mov_b32 v28, 1.0
 v_mov_b32 v29, 1.0
 v_mov_b32 v30, 1.0
 v_mov_b32 v31, 1.0
 s_xor_b32 s30, s28, 1024
 s_mov_b32 s20, 64
 s_mov_b32 s21, 32704
 s_mov_b32 s22, 0xfffc8040
 s_waitcnt vmcnt(30) lgkmcnt(8)
 v_mfma_f32_16x16x32_bf16 v[16:19], v[136:139], a[128:131], v[16:19]
 s_add_u32 m0, s50, 2048
 v_mfma_f32_16x16x32_bf16 v[16:19], v[140:143], a[132:135], v[16:19]
 s_add_u32 s3, s28, 128
 v_mfma_f32_16x16x32_bf16 v[20:23], v[140:143], a[140:143], v[20:23]
 buffer_load_dwordx4 v8, s[8:11], s3 offen lds
 s_add_u32 m0, s50, 3072
 v_mfma_f32_16x16x32_bf16 v[20:23], v[136:139], a[136:139], v[20:23]
 s_add_u32 s3, s28, 16512
 v_mfma_f32_16x16x32_bf16 v[24:27], v[136:139], a[144:147], v[24:27]
 buffer_load_dwordx4 v8, s[8:11], s3 offen lds
 v_mfma_f32_16x16x32_bf16 v[24:27], v[140:143], a[148:151], v[24:27]
 s_add_u32 m0, s50, 6144
 v_mfma_f32_16x16x32_bf16 v[28:31], v[140:143], a[156:159], v[28:31]
 s_add_u32 s3, s28, 32896
 v_mfma_f32_16x16x32_bf16 v[28:31], v[136:139], a[152:155], v[28:31]
 buffer_load_dwordx4 v8, s[8:11], s3 offen lds
 s_add_u32 m0, s50, 7168
 s_waitcnt lgkmcnt(0)
 v_mfma_f32_16x16x32_bf16 v[32:35], v[136:139], a[160:163], v[32:35]
 s_add_u32 s3, s28, 49280
 v_mfma_f32_16x16x32_bf16 v[32:35], v[140:143], a[164:167], v[32:35]
 buffer_load_dwordx4 v8, s[8:11], s3 offen lds
 v_mfma_f32_16x16x32_bf16 v[36:39], v[140:143], a[172:175], v[36:39]
 s_add_u32 m0, s50, 10240
 v_mfma_f32_16x16x32_bf16 v[36:39], v[136:139], a[168:171], v[36:39]
 s_add_u32 s3, s28, 65664
 v_mfma_f32_16x16x32_bf16 v[40:43], v[136:139], a[176:179], v[40:43]
 buffer_load_dwordx4 v8, s[8:11], s3 offen lds
 s_add_u32 m0, s50, 11264
 v_mfma_f32_16x16x32_bf16 v[40:43], v[140:143], a[180:183], v[40:43]
 s_add_u32 s3, s28, 82048
 v_mfma_f32_16x16x32_bf16 v[44:47], v[140:143], a[188:191], v[44:47]
 buffer_load_dwordx4 v8, s[8:11], s3 offen lds
 v_mfma_f32_16x16x32_bf16 v[44:47], v[136:139], a[184:187], v[44:47]
 s_add_u32 m0, s50, 14336
 s_waitcnt vmcnt(34)
 v_mfma_f32_16x16x32_bf16 v[76:79], v[144:147], a[184:187], v[76:79]
 s_add_u32 s3, s28, 98432
 v_mfma_f32_16x16x32_bf16 v[76:79], v[148:151], a[188:191], v[76:79]
 buffer_load_dwordx4 v8, s[8:11], s3 offen lds
 s_add_u32 m0, s50, 15360
 v_mfma_f32_16x16x32_bf16 v[72:75], v[148:151], a[180:183], v[72:75]
 s_add_u32 s3, s28, 114816
 v_mov_b32 v136, 1.0
 v_mfma_f32_16x16x32_bf16 v[72:75], v[144:147], a[176:179], v[72:75]
 buffer_load_dwordx4 v8, s[8:11], s3 offen lds
 v_mfma_f32_16x16x32_bf16 v[68:71], v[144:147], a[168:171], v[68:71]
 s_add_u32 m0, s50, 18432
 v_mov_b32 v137, 1.0
 v_mfma_f32_16x16x32_bf16 v[68:71], v[148:151], a[172:175], v[68:71]
 s_add_u32 s3, s28, 131200
 v_mov_b32 v138, 1.0
 v_mfma_f32_16x16x32_bf16 v[64:67], v[148:151], a[164:167], v[64:67]
 buffer_load_dwordx4 v8, s[8:11], s3 offen lds
 s_add_u32 m0, s50, 19456
 v_mfma_f32_16x16x32_bf16 v[64:67], v[144:147], a[160:163], v[64:67]
 s_add_u32 s3, s28, 147584
 v_mov_b32 v139, 1.0
 v_mfma_f32_16x16x32_bf16 v[60:63], v[144:147], a[152:155], v[60:63]
 v_mov_b32 v140, 1.0
 v_mfma_f32_16x16x32_bf16 v[60:63], v[148:151], a[156:159], v[60:63]
 buffer_load_dwordx4 v8, s[8:11], s3 offen lds
 s_add_u32 m0, s50, 22528
 v_mfma_f32_16x16x32_bf16 v[56:59], v[148:151], a[148:151], v[56:59]
 s_add_u32 s3, s28, 163968
 v_mov_b32 v141, 1.0
 v_mfma_f32_16x16x32_bf16 v[56:59], v[144:147], a[144:147], v[56:59]
 v_mov_b32 v142, 1.0
 v_mfma_f32_16x16x32_bf16 v[52:55], v[144:147], a[136:139], v[52:55]
 buffer_load_dwordx4 v8, s[8:11], s3 offen lds
 s_add_u32 m0, s50, 23552
 v_mfma_f32_16x16x32_bf16 v[52:55], v[148:151], a[140:143], v[52:55]
 s_add_u32 s3, s28, 180352
 v_mov_b32 v143, 1.0
 v_mfma_f32_16x16x32_bf16 v[48:51], v[148:151], a[132:135], v[48:51]
 buffer_load_dwordx4 v8, s[8:11], s3 offen lds
 s_add_u32 m0, s50, 26624
 v_mfma_f32_16x16x32_bf16 v[48:51], v[144:147], a[128:131], v[48:51]
 s_add_u32 s3, s28, 196736
 s_waitcnt vmcnt(38)
 v_mfma_f32_16x16x32_bf16 v[80:83], v[152:155], a[128:131], v[80:83]
 buffer_load_dwordx4 v8, s[8:11], s3 offen lds
 s_add_u32 m0, s50, 27648
 v_mfma_f32_16x16x32_bf16 v[80:83], v[156:159], a[132:135], v[80:83]
 s_add_u32 s3, s28, 213120
 buffer_load_dwordx4 v8, s[8:11], s3 offen lds
 v_mfma_f32_16x16x32_bf16 v[84:87], v[156:159], a[140:143], v[84:87]
 s_add_u32 m0, s50, 30720
 v_mov_b32 v144, 1.0
 v_mfma_f32_16x16x32_bf16 v[84:87], v[152:155], a[136:139], v[84:87]
 s_add_u32 s3, s28, 229504
 buffer_load_dwordx4 v8, s[8:11], s3 offen lds
 v_mfma_f32_16x16x32_bf16 v[88:91], v[152:155], a[144:147], v[88:91]
 v_mov_b32 v145, 1.0
 v_mfma_f32_16x16x32_bf16 v[88:91], v[156:159], a[148:151], v[88:91]
 s_add_u32 m0, s50, 31744
 v_mov_b32 v146, 1.0
 v_mfma_f32_16x16x32_bf16 v[92:95], v[156:159], a[156:159], v[92:95]
 s_add_u32 s3, s28, 245888
 buffer_load_dwordx4 v8, s[8:11], s3 offen lds
 v_mfma_f32_16x16x32_bf16 v[92:95], v[152:155], a[152:155], v[92:95]
 v_mov_b32 v147, 1.0
 v_mfma_f32_16x16x32_bf16 v[96:99], v[152:155], a[160:163], v[96:99]
 v_mov_b32 v148, 1.0
 v_mfma_f32_16x16x32_bf16 v[96:99], v[156:159], a[164:167], v[96:99]
 v_mfma_f32_16x16x32_bf16 v[100:103], v[156:159], a[172:175], v[100:103]
 v_mov_b32 v149, 1.0
 v_mfma_f32_16x16x32_bf16 v[100:103], v[152:155], a[168:171], v[100:103]
 v_mov_b32 v150, 1.0
 v_mfma_f32_16x16x32_bf16 v[104:107], v[152:155], a[176:179], v[104:107]
 v_mfma_f32_16x16x32_bf16 v[104:107], v[156:159], a[180:183], v[104:107]
 v_mov_b32 v151, 1.0
 v_mfma_f32_16x16x32_bf16 v[108:111], v[156:159], a[188:191], v[108:111]
 v_mfma_f32_16x16x32_bf16 v[108:111], v[152:155], a[184:187], v[108:111]
 s_waitcnt vmcnt(40)
 v_mfma_f32_16x16x32_bf16 a[244:247], v[160:163], a[184:187], a[244:247]
 ds_read_b128 a[184:187], v1 offset:61440
 v_mfma_f32_16x16x32_bf16 a[244:247], v[164:167], a[188:191], a[244:247]
 ds_read_b128 a[188:191], v1 offset:62464
 v_mfma_f32_16x16x32_bf16 a[240:243], v[164:167], a[180:183], a[240:243]
 ds_read_b128 a[180:183], v1 offset:58368
 v_mov_b32 v152, 1.0
 v_mfma_f32_16x16x32_bf16 a[240:243], v[160:163], a[176:179], a[240:243]
 ds_read_b128 a[176:179], v1 offset:57344
 v_mfma_f32_16x16x32_bf16 v[132:135], v[160:163], a[168:171], v[132:135]
 ds_read_b128 a[168:171], v1 offset:53248
 v_mov_b32 v153, 1.0
 v_mfma_f32_16x16x32_bf16 v[132:135], v[164:167], a[172:175], v[132:135]
 ds_read_b128 a[172:175], v1 offset:54272
 v_mov_b32 v154, 1.0
 v_mfma_f32_16x16x32_bf16 v[128:131], v[164:167], a[164:167], v[128:131]
 ds_read_b128 a[164:167], v1 offset:50176
 v_mfma_f32_16x16x32_bf16 v[128:131], v[160:163], a[160:163], v[128:131]
 ds_read_b128 a[160:163], v1 offset:49152
 v_mov_b32 v155, 1.0
 v_mfma_f32_16x16x32_bf16 v[124:127], v[160:163], a[152:155], v[124:127]
 ds_read_b128 a[152:155], v1 offset:45056
 v_mov_b32 v156, 1.0
 v_mfma_f32_16x16x32_bf16 v[124:127], v[164:167], a[156:159], v[124:127]
 ds_read_b128 a[156:159], v1 offset:46080
 v_mfma_f32_16x16x32_bf16 v[120:123], v[164:167], a[148:151], v[120:123]
 ds_read_b128 a[148:151], v1 offset:41984
 v_mov_b32 v157, 1.0
 v_mfma_f32_16x16x32_bf16 v[120:123], v[160:163], a[144:147], v[120:123]
 ds_read_b128 a[144:147], v1 offset:40960
 v_mov_b32 v158, 1.0
 v_mfma_f32_16x16x32_bf16 v[116:119], v[160:163], a[136:139], v[116:119]
 ds_read_b128 a[136:139], v1 offset:36864
 v_mfma_f32_16x16x32_bf16 v[116:119], v[164:167], a[140:143], v[116:119]
 ds_read_b128 a[140:143], v1 offset:37888
 v_mov_b32 v159, 1.0
 v_mfma_f32_16x16x32_bf16 v[112:115], v[164:167], a[132:135], v[112:115]
 ds_read_b128 a[132:135], v1 offset:33792
 v_mfma_f32_16x16x32_bf16 v[112:115], v[160:163], a[128:131], v[112:115]
 ds_read_b128 a[128:131], v1 offset:32768
 s_waitcnt vmcnt(38) lgkmcnt(8)
 v_mfma_f32_16x16x32_bf16 v[44:47], v[168:171], a[184:187], v[44:47]
 v_mfma_f32_16x16x32_bf16 v[44:47], v[172:175], a[188:191], v[44:47]
 v_mfma_f32_16x16x32_bf16 v[40:43], v[172:175], a[180:183], v[40:43]
 v_mov_b32 v160, 1.0
 v_mfma_f32_16x16x32_bf16 v[40:43], v[168:171], a[176:179], v[40:43]
 v_mfma_f32_16x16x32_bf16 v[36:39], v[168:171], a[168:171], v[36:39]
 v_mov_b32 v161, 1.0
 v_mfma_f32_16x16x32_bf16 v[36:39], v[172:175], a[172:175], v[36:39]
 v_mov_b32 v162, 1.0
 v_mfma_f32_16x16x32_bf16 v[32:35], v[172:175], a[164:167], v[32:35]
 v_mfma_f32_16x16x32_bf16 v[32:35], v[168:171], a[160:163], v[32:35]
 v_mov_b32 v163, 1.0
 s_waitcnt lgkmcnt(0)
 v_mfma_f32_16x16x32_bf16 v[28:31], v[168:171], a[152:155], v[28:31]
 v_mov_b32 v164, 1.0
 v_mfma_f32_16x16x32_bf16 v[28:31], v[172:175], a[156:159], v[28:31]
 v_mfma_f32_16x16x32_bf16 v[24:27], v[172:175], a[148:151], v[24:27]
 v_mov_b32 v165, 1.0
 v_mfma_f32_16x16x32_bf16 v[24:27], v[168:171], a[144:147], v[24:27]
 v_mov_b32 v166, 1.0
 v_mfma_f32_16x16x32_bf16 v[20:23], v[168:171], a[136:139], v[20:23]
 v_mfma_f32_16x16x32_bf16 v[20:23], v[172:175], a[140:143], v[20:23]
 v_mov_b32 v167, 1.0
 v_mfma_f32_16x16x32_bf16 v[16:19], v[172:175], a[132:135], v[16:19]
 v_mfma_f32_16x16x32_bf16 v[16:19], v[168:171], a[128:131], v[16:19]
 s_waitcnt vmcnt(36)
 v_mfma_f32_16x16x32_bf16 v[48:51], v[176:179], a[128:131], v[48:51]
 v_mfma_f32_16x16x32_bf16 v[48:51], v[180:183], a[132:135], v[48:51]
 v_mfma_f32_16x16x32_bf16 v[52:55], v[180:183], a[140:143], v[52:55]
 v_mov_b32 v168, 1.0
 v_mfma_f32_16x16x32_bf16 v[52:55], v[176:179], a[136:139], v[52:55]
 v_mfma_f32_16x16x32_bf16 v[56:59], v[176:179], a[144:147], v[56:59]
 v_mov_b32 v169, 1.0
 v_mfma_f32_16x16x32_bf16 v[56:59], v[180:183], a[148:151], v[56:59]
 v_mov_b32 v170, 1.0
 v_mfma_f32_16x16x32_bf16 v[60:63], v[180:183], a[156:159], v[60:63]
 v_mfma_f32_16x16x32_bf16 v[60:63], v[176:179], a[152:155], v[60:63]
 v_mov_b32 v171, 1.0
 v_mfma_f32_16x16x32_bf16 v[64:67], v[176:179], a[160:163], v[64:67]
 v_mov_b32 v172, 1.0
 v_mfma_f32_16x16x32_bf16 v[64:67], v[180:183], a[164:167], v[64:67]
 v_mfma_f32_16x16x32_bf16 v[68:71], v[180:183], a[172:175], v[68:71]
 v_mov_b32 v173, 1.0
 v_mfma_f32_16x16x32_bf16 v[68:71], v[176:179], a[168:171], v[68:71]
 v_mov_b32 v174, 1.0
 v_mfma_f32_16x16x32_bf16 v[72:75], v[176:179], a[176:179], v[72:75]
 v_mfma_f32_16x16x32_bf16 v[72:75], v[180:183], a[180:183], v[72:75]
 v_mov_b32 v175, 1.0
 v_mfma_f32_16x16x32_bf16 v[76:79], v[180:183], a[188:191], v[76:79]
 v_mfma_f32_16x16x32_bf16 v[76:79], v[176:179], a[184:187], v[76:79]
 s_waitcnt vmcnt(34)
 v_mfma_f32_16x16x32_bf16 v[108:111], v[184:187], a[184:187], v[108:111]
 v_mfma_f32_16x16x32_bf16 v[108:111], v[188:191], a[188:191], v[108:111]
 v_mfma_f32_16x16x32_bf16 v[104:107], v[188:191], a[180:183], v[104:107]
 v_mov_b32 v176, 1.0
 v_mfma_f32_16x16x32_bf16 v[104:107], v[184:187], a[176:179], v[104:107]
 v_mfma_f32_16x16x32_bf16 v[100:103], v[184:187], a[168:171], v[100:103]
 v_mov_b32 v177, 1.0
 v_mfma_f32_16x16x32_bf16 v[100:103], v[188:191], a[172:175], v[100:103]
 v_mov_b32 v178, 1.0
 v_mfma_f32_16x16x32_bf16 v[96:99], v[188:191], a[164:167], v[96:99]
 v_mfma_f32_16x16x32_bf16 v[96:99], v[184:187], a[160:163], v[96:99]
 v_mov_b32 v179, 1.0
 v_mfma_f32_16x16x32_bf16 v[92:95], v[184:187], a[152:155], v[92:95]
 v_mov_b32 v180, 1.0
 v_mfma_f32_16x16x32_bf16 v[92:95], v[188:191], a[156:159], v[92:95]
 v_mfma_f32_16x16x32_bf16 v[88:91], v[188:191], a[148:151], v[88:91]
 v_mov_b32 v181, 1.0
 v_mfma_f32_16x16x32_bf16 v[88:91], v[184:187], a[144:147], v[88:91]
 v_mov_b32 v182, 1.0
 v_mfma_f32_16x16x32_bf16 v[84:87], v[184:187], a[136:139], v[84:87]
 v_mfma_f32_16x16x32_bf16 v[84:87], v[188:191], a[140:143], v[84:87]
 v_mov_b32 v183, 1.0
 v_mfma_f32_16x16x32_bf16 v[80:83], v[188:191], a[132:135], v[80:83]
 v_mfma_f32_16x16x32_bf16 v[80:83], v[184:187], a[128:131], v[80:83]
 s_waitcnt vmcnt(32)
 v_mfma_f32_16x16x32_bf16 v[112:115], v[192:195], a[128:131], v[112:115]
 ds_read_b128 a[128:131], v2
 v_mfma_f32_16x16x32_bf16 v[112:115], v[196:199], a[132:135], v[112:115]
 ds_read_b128 a[132:135], v2 offset:1024
 v_mfma_f32_16x16x32_bf16 v[116:119], v[196:199], a[140:143], v[116:119]
 ds_read_b128 a[140:143], v2 offset:5120
 v_mov_b32 v184, 1.0
 v_mfma_f32_16x16x32_bf16 v[116:119], v[192:195], a[136:139], v[116:119]
 ds_read_b128 a[136:139], v2 offset:4096
 v_mfma_f32_16x16x32_bf16 v[120:123], v[192:195], a[144:147], v[120:123]
 ds_read_b128 a[144:147], v2 offset:8192
 v_mov_b32 v185, 1.0
 v_mfma_f32_16x16x32_bf16 v[120:123], v[196:199], a[148:151], v[120:123]
 ds_read_b128 a[148:151], v2 offset:9216
 v_mov_b32 v186, 1.0
 v_mfma_f32_16x16x32_bf16 v[124:127], v[196:199], a[156:159], v[124:127]
 ds_read_b128 a[156:159], v2 offset:13312
 v_mfma_f32_16x16x32_bf16 v[124:127], v[192:195], a[152:155], v[124:127]
 ds_read_b128 a[152:155], v2 offset:12288
 v_mov_b32 v187, 1.0
 v_mfma_f32_16x16x32_bf16 v[128:131], v[192:195], a[160:163], v[128:131]
 ds_read_b128 a[160:163], v2 offset:16384
 v_mov_b32 v188, 1.0
 v_mfma_f32_16x16x32_bf16 v[128:131], v[196:199], a[164:167], v[128:131]
 ds_read_b128 a[164:167], v2 offset:17408
 v_mfma_f32_16x16x32_bf16 v[132:135], v[196:199], a[172:175], v[132:135]
 ds_read_b128 a[172:175], v2 offset:21504
 v_mov_b32 v189, 1.0
 v_mfma_f32_16x16x32_bf16 v[132:135], v[192:195], a[168:171], v[132:135]
 ds_read_b128 a[168:171], v2 offset:20480
 v_mov_b32 v190, 1.0
 v_mfma_f32_16x16x32_bf16 a[240:243], v[192:195], a[176:179], a[240:243]
 ds_read_b128 a[176:179], v2 offset:24576
 v_mfma_f32_16x16x32_bf16 a[240:243], v[196:199], a[180:183], a[240:243]
 ds_read_b128 a[180:183], v2 offset:25600
 v_mov_b32 v191, 1.0
 v_mfma_f32_16x16x32_bf16 a[244:247], v[196:199], a[188:191], a[244:247]
 ds_read_b128 a[188:191], v2 offset:29696
 v_mfma_f32_16x16x32_bf16 a[244:247], v[192:195], a[184:187], a[244:247]
 ds_read_b128 a[184:187], v2 offset:28672
 s_waitcnt vmcnt(30) lgkmcnt(8)
 v_mfma_f32_16x16x32_bf16 v[16:19], v[200:203], a[128:131], v[16:19]
 v_mfma_f32_16x16x32_bf16 v[16:19], v[204:207], a[132:135], v[16:19]
 v_mfma_f32_16x16x32_bf16 v[20:23], v[204:207], a[140:143], v[20:23]
 v_mov_b32 v192, 1.0
 v_mfma_f32_16x16x32_bf16 v[20:23], v[200:203], a[136:139], v[20:23]
 v_mfma_f32_16x16x32_bf16 v[24:27], v[200:203], a[144:147], v[24:27]
 v_mov_b32 v193, 1.0
 v_mfma_f32_16x16x32_bf16 v[24:27], v[204:207], a[148:151], v[24:27]
 v_mov_b32 v194, 1.0
 v_mfma_f32_16x16x32_bf16 v[28:31], v[204:207], a[156:159], v[28:31]
 v_mfma_f32_16x16x32_bf16 v[28:31], v[200:203], a[152:155], v[28:31]
 v_mov_b32 v195, 1.0
 s_waitcnt lgkmcnt(0)
 v_mfma_f32_16x16x32_bf16 v[32:35], v[200:203], a[160:163], v[32:35]
 v_mov_b32 v196, 1.0
 v_mfma_f32_16x16x32_bf16 v[32:35], v[204:207], a[164:167], v[32:35]
 v_mfma_f32_16x16x32_bf16 v[36:39], v[204:207], a[172:175], v[36:39]
 v_mov_b32 v197, 1.0
 v_mfma_f32_16x16x32_bf16 v[36:39], v[200:203], a[168:171], v[36:39]
 v_mov_b32 v198, 1.0
 v_mfma_f32_16x16x32_bf16 v[40:43], v[200:203], a[176:179], v[40:43]
 v_mfma_f32_16x16x32_bf16 v[40:43], v[204:207], a[180:183], v[40:43]
 v_mov_b32 v199, 1.0
 v_mfma_f32_16x16x32_bf16 v[44:47], v[204:207], a[188:191], v[44:47]
 v_mfma_f32_16x16x32_bf16 v[44:47], v[200:203], a[184:187], v[44:47]
 s_waitcnt vmcnt(28)
 v_mfma_f32_16x16x32_bf16 v[76:79], v[208:211], a[184:187], v[76:79]
 v_mfma_f32_16x16x32_bf16 v[76:79], v[212:215], a[188:191], v[76:79]
 v_mfma_f32_16x16x32_bf16 v[72:75], v[212:215], a[180:183], v[72:75]
 v_mov_b32 v200, 1.0
 v_mfma_f32_16x16x32_bf16 v[72:75], v[208:211], a[176:179], v[72:75]
 v_mfma_f32_16x16x32_bf16 v[68:71], v[208:211], a[168:171], v[68:71]
 v_mov_b32 v201, 1.0
 v_mfma_f32_16x16x32_bf16 v[68:71], v[212:215], a[172:175], v[68:71]
 v_mov_b32 v202, 1.0
 v_mfma_f32_16x16x32_bf16 v[64:67], v[212:215], a[164:167], v[64:67]
 v_mfma_f32_16x16x32_bf16 v[64:67], v[208:211], a[160:163], v[64:67]
 v_mov_b32 v203, 1.0
 v_mfma_f32_16x16x32_bf16 v[60:63], v[208:211], a[152:155], v[60:63]
 v_mov_b32 v204, 1.0
 v_mfma_f32_16x16x32_bf16 v[60:63], v[212:215], a[156:159], v[60:63]
 v_mfma_f32_16x16x32_bf16 v[56:59], v[212:215], a[148:151], v[56:59]
 v_mov_b32 v205, 1.0
 v_mfma_f32_16x16x32_bf16 v[56:59], v[208:211], a[144:147], v[56:59]
 v_mov_b32 v206, 1.0
 v_mfma_f32_16x16x32_bf16 v[52:55], v[208:211], a[136:139], v[52:55]
 v_mfma_f32_16x16x32_bf16 v[52:55], v[212:215], a[140:143], v[52:55]
 v_mov_b32 v207, 1.0
 v_mfma_f32_16x16x32_bf16 v[48:51], v[212:215], a[132:135], v[48:51]
 v_mfma_f32_16x16x32_bf16 v[48:51], v[208:211], a[128:131], v[48:51]
 s_waitcnt vmcnt(26)
 v_mfma_f32_16x16x32_bf16 v[80:83], a[224:227], a[128:131], v[80:83]
 v_mfma_f32_16x16x32_bf16 v[80:83], a[228:231], a[132:135], v[80:83]
 v_mfma_f32_16x16x32_bf16 v[84:87], a[228:231], a[140:143], v[84:87]
 v_mov_b32 v208, 1.0
 v_mfma_f32_16x16x32_bf16 v[84:87], a[224:227], a[136:139], v[84:87]
 v_mfma_f32_16x16x32_bf16 v[88:91], a[224:227], a[144:147], v[88:91]
 v_mov_b32 v209, 1.0
 v_mfma_f32_16x16x32_bf16 v[88:91], a[228:231], a[148:151], v[88:91]
 v_mov_b32 v210, 1.0
 v_mfma_f32_16x16x32_bf16 v[92:95], a[228:231], a[156:159], v[92:95]
 v_mfma_f32_16x16x32_bf16 v[92:95], a[224:227], a[152:155], v[92:95]
 v_mov_b32 v211, 1.0
 v_mfma_f32_16x16x32_bf16 v[96:99], a[224:227], a[160:163], v[96:99]
 v_mov_b32 v212, 1.0
 v_mfma_f32_16x16x32_bf16 v[96:99], a[228:231], a[164:167], v[96:99]
 v_mfma_f32_16x16x32_bf16 v[100:103], a[228:231], a[172:175], v[100:103]
 v_mov_b32 v213, 1.0
 v_mfma_f32_16x16x32_bf16 v[100:103], a[224:227], a[168:171], v[100:103]
 v_mov_b32 v214, 1.0
 v_mfma_f32_16x16x32_bf16 v[104:107], a[224:227], a[176:179], v[104:107]
 v_mfma_f32_16x16x32_bf16 v[104:107], a[228:231], a[180:183], v[104:107]
 v_mov_b32 v215, 1.0
 v_mfma_f32_16x16x32_bf16 v[108:111], a[228:231], a[188:191], v[108:111]
 v_mfma_f32_16x16x32_bf16 v[108:111], a[224:227], a[184:187], v[108:111]
 s_waitcnt vmcnt(24)
 v_mfma_f32_16x16x32_bf16 a[244:247], a[232:235], a[184:187], a[244:247]
 ds_read_b128 a[184:187], v2 offset:61440
 v_mfma_f32_16x16x32_bf16 a[244:247], a[236:239], a[188:191], a[244:247]
 global_load_dwordx4 a[228:231], v0, s[70:71] offset:-3072 sc1
 ds_read_b128 a[188:191], v2 offset:62464
 v_mfma_f32_16x16x32_bf16 a[240:243], a[236:239], a[180:183], a[240:243]
 ds_read_b128 a[180:183], v2 offset:58368
 v_mfma_f32_16x16x32_bf16 a[240:243], a[232:235], a[176:179], a[240:243]
 global_load_dwordx4 a[224:227], v0, s[70:71] offset:-4096 sc1
 ds_read_b128 a[176:179], v2 offset:57344
 v_mfma_f32_16x16x32_bf16 v[132:135], a[232:235], a[168:171], v[132:135]
 ds_read_b128 a[168:171], v2 offset:53248
 v_mfma_f32_16x16x32_bf16 v[132:135], a[236:239], a[172:175], v[132:135]
 ds_read_b128 a[172:175], v2 offset:54272
 v_mfma_f32_16x16x32_bf16 v[128:131], a[236:239], a[164:167], v[128:131]
 ds_read_b128 a[164:167], v2 offset:50176
 v_mfma_f32_16x16x32_bf16 v[128:131], a[232:235], a[160:163], v[128:131]
 ds_read_b128 a[160:163], v2 offset:49152
 v_mfma_f32_16x16x32_bf16 v[124:127], a[232:235], a[152:155], v[124:127]
 ds_read_b128 a[152:155], v2 offset:45056
 v_mfma_f32_16x16x32_bf16 v[124:127], a[236:239], a[156:159], v[124:127]
 ds_read_b128 a[156:159], v2 offset:46080
 v_mfma_f32_16x16x32_bf16 v[120:123], a[236:239], a[148:151], v[120:123]
 ds_read_b128 a[148:151], v2 offset:41984
 v_mfma_f32_16x16x32_bf16 v[120:123], a[232:235], a[144:147], v[120:123]
 ds_read_b128 a[144:147], v2 offset:40960
 v_mfma_f32_16x16x32_bf16 v[116:119], a[232:235], a[136:139], v[116:119]
 ds_read_b128 a[136:139], v2 offset:36864
 v_mfma_f32_16x16x32_bf16 v[116:119], a[236:239], a[140:143], v[116:119]
 ds_read_b128 a[140:143], v2 offset:37888
 v_mfma_f32_16x16x32_bf16 v[112:115], a[236:239], a[132:135], v[112:115]
 ds_read_b128 a[132:135], v2 offset:33792
 v_mfma_f32_16x16x32_bf16 v[112:115], a[232:235], a[128:131], v[112:115]
 ds_read_b128 a[128:131], v2 offset:32768
 s_waitcnt vmcnt(24) lgkmcnt(8)
 v_mfma_f32_16x16x32_bf16 v[44:47], a[192:195], a[184:187], v[44:47]
 v_mfma_f32_16x16x32_bf16 v[44:47], a[196:199], a[188:191], v[44:47]
 global_load_dwordx4 a[236:239], v0, s[70:71] offset:-1024 sc1
 v_mfma_f32_16x16x32_bf16 v[40:43], a[196:199], a[180:183], v[40:43]
 v_mfma_f32_16x16x32_bf16 v[40:43], a[192:195], a[176:179], v[40:43]
 global_load_dwordx4 a[232:235], v0, s[70:71] offset:-2048 sc1
 v_mfma_f32_16x16x32_bf16 v[36:39], a[192:195], a[168:171], v[36:39]
 v_mfma_f32_16x16x32_bf16 v[36:39], a[196:199], a[172:175], v[36:39]
 v_mfma_f32_16x16x32_bf16 v[32:35], a[196:199], a[164:167], v[32:35]
 v_mfma_f32_16x16x32_bf16 v[32:35], a[192:195], a[160:163], v[32:35]
 s_waitcnt lgkmcnt(0)
 v_mfma_f32_16x16x32_bf16 v[28:31], a[192:195], a[152:155], v[28:31]
 v_mfma_f32_16x16x32_bf16 v[28:31], a[196:199], a[156:159], v[28:31]
 v_mfma_f32_16x16x32_bf16 v[24:27], a[196:199], a[148:151], v[24:27]
 v_mfma_f32_16x16x32_bf16 v[24:27], a[192:195], a[144:147], v[24:27]
 v_mfma_f32_16x16x32_bf16 v[20:23], a[192:195], a[136:139], v[20:23]
 v_mfma_f32_16x16x32_bf16 v[20:23], a[196:199], a[140:143], v[20:23]
 v_mfma_f32_16x16x32_bf16 v[16:19], a[196:199], a[132:135], v[16:19]
 v_mfma_f32_16x16x32_bf16 v[16:19], a[192:195], a[128:131], v[16:19]
 s_waitcnt vmcnt(24)
 v_mfma_f32_16x16x32_bf16 v[48:51], a[200:203], a[128:131], v[48:51]
 v_mfma_f32_16x16x32_bf16 v[48:51], a[204:207], a[132:135], v[48:51]
 global_load_dwordx4 a[196:199], v0, s[70:71] offset:1024 sc1
 v_mfma_f32_16x16x32_bf16 v[52:55], a[204:207], a[140:143], v[52:55]
 v_mfma_f32_16x16x32_bf16 v[52:55], a[200:203], a[136:139], v[52:55]
 global_load_dwordx4 a[192:195], v0, s[70:71] offset:0 sc1
 v_mfma_f32_16x16x32_bf16 v[56:59], a[200:203], a[144:147], v[56:59]
 v_mfma_f32_16x16x32_bf16 v[56:59], a[204:207], a[148:151], v[56:59]
 v_mfma_f32_16x16x32_bf16 v[60:63], a[204:207], a[156:159], v[60:63]
 v_mfma_f32_16x16x32_bf16 v[60:63], a[200:203], a[152:155], v[60:63]
 v_mfma_f32_16x16x32_bf16 v[64:67], a[200:203], a[160:163], v[64:67]
 v_mfma_f32_16x16x32_bf16 v[64:67], a[204:207], a[164:167], v[64:67]
 v_mfma_f32_16x16x32_bf16 v[68:71], a[204:207], a[172:175], v[68:71]
 v_mfma_f32_16x16x32_bf16 v[68:71], a[200:203], a[168:171], v[68:71]
 v_mfma_f32_16x16x32_bf16 v[72:75], a[200:203], a[176:179], v[72:75]
 v_mfma_f32_16x16x32_bf16 v[72:75], a[204:207], a[180:183], v[72:75]
 v_mfma_f32_16x16x32_bf16 v[76:79], a[204:207], a[188:191], v[76:79]
 v_mfma_f32_16x16x32_bf16 v[76:79], a[200:203], a[184:187], v[76:79]
 s_waitcnt vmcnt(24)
 v_mfma_f32_16x16x32_bf16 v[108:111], a[208:211], a[184:187], v[108:111]
 v_mfma_f32_16x16x32_bf16 v[108:111], a[212:215], a[188:191], v[108:111]
 global_load_dwordx4 a[204:207], v0, s[70:71] offset:3072 sc1
 v_mfma_f32_16x16x32_bf16 v[104:107], a[212:215], a[180:183], v[104:107]
 v_mfma_f32_16x16x32_bf16 v[104:107], a[208:211], a[176:179], v[104:107]
 global_load_dwordx4 a[200:203], v0, s[70:71] offset:2048 sc1
 v_mfma_f32_16x16x32_bf16 v[100:103], a[208:211], a[168:171], v[100:103]
 s_add_u32 s70, s70, 8192
 s_addc_u32 s71, s71, 0
 v_mfma_f32_16x16x32_bf16 v[100:103], a[212:215], a[172:175], v[100:103]
 v_mfma_f32_16x16x32_bf16 v[96:99], a[212:215], a[164:167], v[96:99]
 v_mfma_f32_16x16x32_bf16 v[96:99], a[208:211], a[160:163], v[96:99]
 v_mfma_f32_16x16x32_bf16 v[92:95], a[208:211], a[152:155], v[92:95]
 v_mfma_f32_16x16x32_bf16 v[92:95], a[212:215], a[156:159], v[92:95]
 v_mfma_f32_16x16x32_bf16 v[88:91], a[212:215], a[148:151], v[88:91]
 v_mfma_f32_16x16x32_bf16 v[88:91], a[208:211], a[144:147], v[88:91]
 v_mfma_f32_16x16x32_bf16 v[84:87], a[208:211], a[136:139], v[84:87]
 v_mfma_f32_16x16x32_bf16 v[84:87], a[212:215], a[140:143], v[84:87]
 v_mfma_f32_16x16x32_bf16 v[80:83], a[212:215], a[132:135], v[80:83]
 v_mfma_f32_16x16x32_bf16 v[80:83], a[208:211], a[128:131], v[80:83]
 s_waitcnt vmcnt(24)
 v_mfma_f32_16x16x32_bf16 v[112:115], a[216:219], a[128:131], v[112:115]
 ds_read_b128 a[128:131], v1
 v_mfma_f32_16x16x32_bf16 v[112:115], a[220:223], a[132:135], v[112:115]
 global_load_dwordx4 a[212:215], v0, s[70:71] offset:-3072 sc1
 ds_read_b128 a[132:135], v1 offset:1024
 v_mfma_f32_16x16x32_bf16 v[116:119], a[220:223], a[140:143], v[116:119]
 ds_read_b128 a[140:143], v1 offset:5120
 v_mfma_f32_16x16x32_bf16 v[116:119], a[216:219], a[136:139], v[116:119]
 global_load_dwordx4 a[208:211], v0, s[70:71] offset:-4096 sc1
 ds_read_b128 a[136:139], v1 offset:4096
 v_mfma_f32_16x16x32_bf16 v[120:123], a[216:219], a[144:147], v[120:123]
 ds_read_b128 a[144:147], v1 offset:8192
 v_mfma_f32_16x16x32_bf16 v[120:123], a[220:223], a[148:151], v[120:123]
 ds_read_b128 a[148:151], v1 offset:9216
 v_mfma_f32_16x16x32_bf16 v[124:127], a[220:223], a[156:159], v[124:127]
 ds_read_b128 a[156:159], v1 offset:13312
 v_mfma_f32_16x16x32_bf16 v[124:127], a[216:219], a[152:155], v[124:127]
 ds_read_b128 a[152:155], v1 offset:12288
 v_mfma_f32_16x16x32_bf16 v[128:131], a[216:219], a[160:163], v[128:131]
 ds_read_b128 a[160:163], v1 offset:16384
 v_mfma_f32_16x16x32_bf16 v[128:131], a[220:223], a[164:167], v[128:131]
 ds_read_b128 a[164:167], v1 offset:17408
 v_mfma_f32_16x16x32_bf16 v[132:135], a[220:223], a[172:175], v[132:135]
 ds_read_b128 a[172:175], v1 offset:21504
 v_mfma_f32_16x16x32_bf16 v[132:135], a[216:219], a[168:171], v[132:135]
 ds_read_b128 a[168:171], v1 offset:20480
 v_mfma_f32_16x16x32_bf16 a[240:243], a[216:219], a[176:179], a[240:243]
 ds_read_b128 a[176:179], v1 offset:24576
 v_mfma_f32_16x16x32_bf16 a[240:243], a[220:223], a[180:183], a[240:243]
 ds_read_b128 a[180:183], v1 offset:25600
 v_mfma_f32_16x16x32_bf16 a[244:247], a[220:223], a[188:191], a[244:247]
 global_load_dwordx4 a[220:223], v0, s[70:71] offset:-1024 sc1
 ds_read_b128 a[188:191], v1 offset:29696
 v_mfma_f32_16x16x32_bf16 a[244:247], a[216:219], a[184:187], a[244:247]
 global_load_dwordx4 a[216:219], v0, s[70:71] offset:-2048 sc1
 ds_read_b128 a[184:187], v1 offset:28672
 s_waitcnt vmcnt(10) lgkmcnt(8)
 v_mfma_f32_16x16x32_bf16 v[136:139], a[224:227], a[128:131], v[136:139]
 v_lshrrev_b32 v5, 4, v1
 v_mfma_f32_16x16x32_bf16 v[136:139], a[228:231], a[132:135], v[136:139]
 v_and_b32 v5, 48, v5
 v_mfma_f32_16x16x32_bf16 v[140:143], a[228:231], a[140:143], v[140:143]
 v_xor_b32 v5, v5, v1
 v_mfma_f32_16x16x32_bf16 v[140:143], a[224:227], a[136:139], v[140:143]
 v_and_b32 v5, 112, v5
 v_mfma_f32_16x16x32_bf16 v[144:147], a[224:227], a[144:147], v[144:147]
 v_and_b32 v6, 240, v1
 v_mfma_f32_16x16x32_bf16 v[144:147], a[228:231], a[148:151], v[144:147]
 v_lshl_add_u32 v5, v6, 3, v5
 v_mfma_f32_16x16x32_bf16 v[148:151], a[228:231], a[156:159], v[148:151]
 v_add_u32 v8, s50, v5
 v_mfma_f32_16x16x32_bf16 v[148:151], a[224:227], a[152:155], v[148:151]
 v_xor_b32 v9, 64, v8
 s_waitcnt lgkmcnt(0)
 v_mfma_f32_16x16x32_bf16 v[152:155], a[224:227], a[160:163], v[152:155]
 v_mfma_f32_16x16x32_bf16 v[152:155], a[228:231], a[164:167], v[152:155]
 ds_read_b128 a[64:67], v8 offset:2048
 ds_read_b128 a[96:99], v9 offset:2048
 v_mfma_f32_16x16x32_bf16 v[156:159], a[228:231], a[172:175], v[156:159]
 v_mfma_f32_16x16x32_bf16 v[156:159], a[224:227], a[168:171], v[156:159]
 v_mfma_f32_16x16x32_bf16 v[160:163], a[224:227], a[176:179], v[160:163]
 v_mfma_f32_16x16x32_bf16 v[160:163], a[228:231], a[180:183], v[160:163]
 v_mfma_f32_16x16x32_bf16 v[164:167], a[228:231], a[188:191], v[164:167]
 ds_read_b128 a[68:71], v8 offset:6144
 v_mfma_f32_16x16x32_bf16 v[164:167], a[224:227], a[184:187], v[164:167]
 ds_read_b128 a[100:103], v9 offset:6144
 s_waitcnt vmcnt(8)
 v_mfma_f32_16x16x32_bf16 v[196:199], a[232:235], a[184:187], v[196:199]
 v_mfma_f32_16x16x32_bf16 v[196:199], a[236:239], a[188:191], v[196:199]
 global_load_dwordx4 a[228:231], v0, s[70:71] offset:1024 sc1
 v_mfma_f32_16x16x32_bf16 v[192:195], a[236:239], a[180:183], v[192:195]
 v_mfma_f32_16x16x32_bf16 v[192:195], a[232:235], a[176:179], v[192:195]
 global_load_dwordx4 a[224:227], v0, s[70:71] offset:0 sc1
 s_waitcnt lgkmcnt(2)
 v_mfma_f32_16x16x32_bf16 v[188:191], a[232:235], a[168:171], v[188:191]
 ds_write_b128 v3, a[64:67] offset:2048
 v_mfma_f32_16x16x32_bf16 v[188:191], a[236:239], a[172:175], v[188:191]
 ds_write_b128 v3, a[96:99] offset:3072
 v_mfma_f32_16x16x32_bf16 v[184:187], a[236:239], a[164:167], v[184:187]
 v_mfma_f32_16x16x32_bf16 v[184:187], a[232:235], a[160:163], v[184:187]
 ds_read_b128 a[72:75], v8 offset:10240
 v_mfma_f32_16x16x32_bf16 v[180:183], a[232:235], a[152:155], v[180:183]
 ds_read_b128 a[104:107], v9 offset:10240
 v_mfma_f32_16x16x32_bf16 v[180:183], a[236:239], a[156:159], v[180:183]
 v_mfma_f32_16x16x32_bf16 v[176:179], a[236:239], a[148:151], v[176:179]
 v_mfma_f32_16x16x32_bf16 v[176:179], a[232:235], a[144:147], v[176:179]
 v_mfma_f32_16x16x32_bf16 v[172:175], a[232:235], a[136:139], v[172:175]
 s_waitcnt lgkmcnt(4)
 v_mfma_f32_16x16x32_bf16 v[172:175], a[236:239], a[140:143], v[172:175]
 ds_write_b128 v3, a[68:71] offset:6144
 ds_write_b128 v3, a[100:103] offset:7168
 v_mfma_f32_16x16x32_bf16 v[168:171], a[236:239], a[132:135], v[168:171]
 v_mfma_f32_16x16x32_bf16 v[168:171], a[232:235], a[128:131], v[168:171]
 ds_read_b128 a[76:79], v8 offset:14336
 s_waitcnt vmcnt(8)
 v_mfma_f32_16x16x32_bf16 v[200:203], a[192:195], a[128:131], v[200:203]
 ds_read_b128 a[108:111], v9 offset:14336
 v_mfma_f32_16x16x32_bf16 v[200:203], a[196:199], a[132:135], v[200:203]
 global_load_dwordx4 a[236:239], v0, s[70:71] offset:3072 sc1
 v_mfma_f32_16x16x32_bf16 v[204:207], a[196:199], a[140:143], v[204:207]
 v_mfma_f32_16x16x32_bf16 v[204:207], a[192:195], a[136:139], v[204:207]
 global_load_dwordx4 a[232:235], v0, s[70:71] offset:2048 sc1
 v_mfma_f32_16x16x32_bf16 v[208:211], a[192:195], a[144:147], v[208:211]
 s_waitcnt lgkmcnt(4)
 s_add_u32 s70, s70, 8192
 s_addc_u32 s71, s71, 0
 v_mfma_f32_16x16x32_bf16 v[208:211], a[196:199], a[148:151], v[208:211]
 ds_write_b128 v3, a[72:75] offset:10240
 v_mfma_f32_16x16x32_bf16 v[212:215], a[196:199], a[156:159], v[212:215]
 ds_write_b128 v3, a[104:107] offset:11264
 v_mfma_f32_16x16x32_bf16 v[212:215], a[192:195], a[152:155], v[212:215]
 v_mfma_f32_16x16x32_bf16 v[216:219], a[192:195], a[160:163], v[216:219]
 ds_read_b128 a[80:83], v8 offset:18432
 v_mfma_f32_16x16x32_bf16 v[216:219], a[196:199], a[164:167], v[216:219]
 ds_read_b128 a[112:115], v9 offset:18432
 v_mfma_f32_16x16x32_bf16 v[220:223], a[196:199], a[172:175], v[220:223]
 v_mfma_f32_16x16x32_bf16 v[220:223], a[192:195], a[168:171], v[220:223]
 v_mfma_f32_16x16x32_bf16 v[224:227], a[192:195], a[176:179], v[224:227]
 s_waitcnt lgkmcnt(4)
 ds_write_b128 v3, a[76:79] offset:14336
 ds_write_b128 v3, a[108:111] offset:15360
 v_mfma_f32_16x16x32_bf16 v[224:227], a[196:199], a[180:183], v[224:227]
 v_mfma_f32_16x16x32_bf16 v[228:231], a[196:199], a[188:191], v[228:231]
 v_mfma_f32_16x16x32_bf16 v[228:231], a[192:195], a[184:187], v[228:231]
 s_waitcnt vmcnt(8)
 v_mfma_f32_16x16x32_bf16 a[252:255], a[200:203], a[184:187], a[252:255]
 ds_read_b128 a[184:187], v1 offset:61440
 ds_read_b128 a[84:87], v8 offset:22528
 v_mfma_f32_16x16x32_bf16 a[252:255], a[204:207], a[188:191], a[252:255]
 global_load_dwordx4 a[196:199], v0, s[70:71] offset:-3072 sc1
 ds_read_b128 a[188:191], v1 offset:62464
 v_mfma_f32_16x16x32_bf16 a[248:251], a[204:207], a[180:183], a[248:251]
 ds_read_b128 a[180:183], v1 offset:58368
 ds_read_b128 a[116:119], v9 offset:22528
 v_mfma_f32_16x16x32_bf16 a[248:251], a[200:203], a[176:179], a[248:251]
 global_load_dwordx4 a[192:195], v0, s[70:71] offset:-4096 sc1
 ds_read_b128 a[176:179], v1 offset:57344
 v_mfma_f32_16x16x32_bf16 v[252:255], a[200:203], a[168:171], v[252:255]
 ds_read_b128 a[168:171], v1 offset:53248
 v_mfma_f32_16x16x32_bf16 v[252:255], a[204:207], a[172:175], v[252:255]
 ds_read_b128 a[172:175], v1 offset:54272
 s_waitcnt lgkmcnt(10)
 v_mfma_f32_16x16x32_bf16 v[248:251], a[204:207], a[164:167], v[248:251]
 ds_read_b128 a[164:167], v1 offset:50176
 v_mfma_f32_16x16x32_bf16 v[248:251], a[200:203], a[160:163], v[248:251]
 ds_read_b128 a[160:163], v1 offset:49152
 v_mfma_f32_16x16x32_bf16 v[244:247], a[200:203], a[152:155], v[244:247]
 ds_read_b128 a[152:155], v1 offset:45056
 v_mfma_f32_16x16x32_bf16 v[244:247], a[204:207], a[156:159], v[244:247]
 ds_read_b128 a[156:159], v1 offset:46080
 v_mfma_f32_16x16x32_bf16 v[240:243], a[204:207], a[148:151], v[240:243]
 ds_read_b128 a[148:151], v1 offset:41984
 v_mfma_f32_16x16x32_bf16 v[240:243], a[200:203], a[144:147], v[240:243]
 ds_read_b128 a[144:147], v1 offset:40960
 v_mfma_f32_16x16x32_bf16 v[236:239], a[200:203], a[136:139], v[236:239]
 ds_read_b128 a[136:139], v1 offset:36864
 v_mfma_f32_16x16x32_bf16 v[236:239], a[204:207], a[140:143], v[236:239]
 ds_read_b128 a[140:143], v1 offset:37888
 v_mfma_f32_16x16x32_bf16 v[232:235], a[204:207], a[132:135], v[232:235]
 ds_read_b128 a[132:135], v1 offset:33792
 v_mfma_f32_16x16x32_bf16 v[232:235], a[200:203], a[128:131], v[232:235]
 ds_read_b128 a[128:131], v1 offset:32768
 ds_write_b128 v3, a[80:83] offset:18432
 ds_write_b128 v3, a[112:115] offset:19456
 ds_read_b128 a[88:91], v8 offset:26624
 ds_read_b128 a[120:123], v9 offset:26624
 s_waitcnt vmcnt(8) lgkmcnt(12)
 v_mfma_f32_16x16x32_bf16 v[164:167], a[208:211], a[184:187], v[164:167]
 v_mfma_f32_16x16x32_bf16 v[164:167], a[212:215], a[188:191], v[164:167]
 global_load_dwordx4 a[204:207], v0, s[70:71] offset:-1024 sc1
 v_mfma_f32_16x16x32_bf16 v[160:163], a[212:215], a[180:183], v[160:163]
 ds_write_b128 v3, a[84:87] offset:22528
 ds_write_b128 v3, a[116:119] offset:23552
 v_mfma_f32_16x16x32_bf16 v[160:163], a[208:211], a[176:179], v[160:163]
 global_load_dwordx4 a[200:203], v0, s[70:71] offset:-2048 sc1
 ds_read_b128 a[92:95], v8 offset:30720
 v_mfma_f32_16x16x32_bf16 v[156:159], a[208:211], a[168:171], v[156:159]
 ds_read_b128 a[124:127], v9 offset:30720
 v_mfma_f32_16x16x32_bf16 v[156:159], a[212:215], a[172:175], v[156:159]
 v_mfma_f32_16x16x32_bf16 v[152:155], a[212:215], a[164:167], v[152:155]
 v_mfma_f32_16x16x32_bf16 v[152:155], a[208:211], a[160:163], v[152:155]
 s_waitcnt lgkmcnt(4)
 ds_write_b128 v3, a[88:91] offset:26624
 v_mfma_f32_16x16x32_bf16 v[148:151], a[208:211], a[152:155], v[148:151]
 ds_write_b128 v3, a[120:123] offset:27648
 v_mfma_f32_16x16x32_bf16 v[148:151], a[212:215], a[156:159], v[148:151]
 v_mfma_f32_16x16x32_bf16 v[144:147], a[212:215], a[148:151], v[144:147]
 v_mfma_f32_16x16x32_bf16 v[144:147], a[208:211], a[144:147], v[144:147]
 v_mfma_f32_16x16x32_bf16 v[140:143], a[208:211], a[136:139], v[140:143]
 v_mfma_f32_16x16x32_bf16 v[140:143], a[212:215], a[140:143], v[140:143]
 s_waitcnt lgkmcnt(2)
 v_mfma_f32_16x16x32_bf16 v[136:139], a[212:215], a[132:135], v[136:139]
 ds_write_b128 v3, a[92:95] offset:30720
 v_mfma_f32_16x16x32_bf16 v[136:139], a[208:211], a[128:131], v[136:139]
 ds_write_b128 v3, a[124:127] offset:31744
 s_waitcnt vmcnt(8)
 v_mfma_f32_16x16x32_bf16 v[168:171], a[216:219], a[128:131], v[168:171]
 v_lshrrev_b32 v4, 8, v1
 v_mfma_f32_16x16x32_bf16 v[168:171], a[220:223], a[132:135], v[168:171]
 global_load_dwordx4 a[212:215], v0, s[70:71] offset:1024 sc1
 v_lshl_add_u32 v4, v4, 5, s51
 v_mfma_f32_16x16x32_bf16 v[172:175], a[220:223], a[140:143], v[172:175]
 ds_read_b128 v[8:11], v4
 v_mfma_f32_16x16x32_bf16 v[172:175], a[216:219], a[136:139], v[172:175]
 global_load_dwordx4 a[208:211], v0, s[70:71] offset:0 sc1
 v_mfma_f32_16x16x32_bf16 v[176:179], a[216:219], a[144:147], v[176:179]
 v_mfma_f32_16x16x32_bf16 v[176:179], a[220:223], a[148:151], v[176:179]
 v_mfma_f32_16x16x32_bf16 v[180:183], a[220:223], a[156:159], v[180:183]
 v_mfma_f32_16x16x32_bf16 v[180:183], a[216:219], a[152:155], v[180:183]
 v_mfma_f32_16x16x32_bf16 v[184:187], a[216:219], a[160:163], v[184:187]
 v_mfma_f32_16x16x32_bf16 v[184:187], a[220:223], a[164:167], v[184:187]
 v_mfma_f32_16x16x32_bf16 v[188:191], a[220:223], a[172:175], v[188:191]
 v_mfma_f32_16x16x32_bf16 v[188:191], a[216:219], a[168:171], v[188:191]
 s_waitcnt lgkmcnt(0)
 v_add_f32 v16, v16, v8
 v_mfma_f32_16x16x32_bf16 v[192:195], a[216:219], a[176:179], v[192:195]
 ds_read_b128 v[12:15], v4 offset:16
 v_mfma_f32_16x16x32_bf16 v[192:195], a[220:223], a[180:183], v[192:195]
 v_add_f32 v17, v17, v9
 v_mfma_f32_16x16x32_bf16 v[196:199], a[220:223], a[188:191], v[196:199]
 v_add_f32 v18, v18, v10
 v_mfma_f32_16x16x32_bf16 v[196:199], a[216:219], a[184:187], v[196:199]
 v_add_f32 v19, v19, v11
 s_waitcnt vmcnt(8)
 v_mfma_f32_16x16x32_bf16 v[228:231], a[224:227], a[184:187], v[228:231]
 v_add_f32 v20, v20, v8
 v_mfma_f32_16x16x32_bf16 v[228:231], a[228:231], a[188:191], v[228:231]
 global_load_dwordx4 a[220:223], v0, s[70:71] offset:3072 sc1
 v_add_f32 v21, v21, v9
 v_mfma_f32_16x16x32_bf16 v[224:227], a[228:231], a[180:183], v[224:227]
 v_add_f32 v22, v22, v10
 v_mfma_f32_16x16x32_bf16 v[224:227], a[224:227], a[176:179], v[224:227]
 global_load_dwordx4 a[216:219], v0, s[70:71] offset:2048 sc1
 v_add_f32 v23, v23, v11
 v_mfma_f32_16x16x32_bf16 v[220:223], a[224:227], a[168:171], v[220:223]
 v_add_f32 v24, v24, v8
 s_add_u32 s70, s70, 8192
 s_addc_u32 s71, s71, 0
 v_mfma_f32_16x16x32_bf16 v[220:223], a[228:231], a[172:175], v[220:223]
 v_add_f32 v25, v25, v9
 v_mfma_f32_16x16x32_bf16 v[216:219], a[228:231], a[164:167], v[216:219]
 v_add_f32 v26, v26, v10
 v_mfma_f32_16x16x32_bf16 v[216:219], a[224:227], a[160:163], v[216:219]
 v_add_f32 v27, v27, v11
 v_mfma_f32_16x16x32_bf16 v[212:215], a[224:227], a[152:155], v[212:215]
 v_add_f32 v28, v28, v8
 v_mfma_f32_16x16x32_bf16 v[212:215], a[228:231], a[156:159], v[212:215]
 v_add_f32 v29, v29, v9
 v_mfma_f32_16x16x32_bf16 v[208:211], a[228:231], a[148:151], v[208:211]
 v_add_f32 v30, v30, v10
 v_mfma_f32_16x16x32_bf16 v[208:211], a[224:227], a[144:147], v[208:211]
 v_add_f32 v31, v31, v11
 v_add_f32 v32, v32, v8
 v_mfma_f32_16x16x32_bf16 v[204:207], a[224:227], a[136:139], v[204:207]
 v_add_f32 v33, v33, v9
 v_mfma_f32_16x16x32_bf16 v[204:207], a[228:231], a[140:143], v[204:207]
 v_add_f32 v34, v34, v10
 v_mfma_f32_16x16x32_bf16 v[200:203], a[228:231], a[132:135], v[200:203]
 v_add_f32 v35, v35, v11
 v_mfma_f32_16x16x32_bf16 v[200:203], a[224:227], a[128:131], v[200:203]
 v_add_f32 v36, v36, v8
 v_add_f32 v37, v37, v9
 s_waitcnt vmcnt(8)
 v_mfma_f32_16x16x32_bf16 v[232:235], a[232:235], a[128:131], v[232:235]
 ds_read_b128 a[128:131], v2
 v_add_f32 v38, v38, v10
 v_mfma_f32_16x16x32_bf16 v[232:235], a[236:239], a[132:135], v[232:235]
 global_load_dwordx4 a[228:231], v0, s[70:71] offset:-3072 sc1
 ds_read_b128 a[132:135], v2 offset:1024
 v_mfma_f32_16x16x32_bf16 v[236:239], a[236:239], a[140:143], v[236:239]
 ds_read_b128 a[140:143], v2 offset:5120
 v_add_f32 v39, v39, v11
 v_mfma_f32_16x16x32_bf16 v[236:239], a[232:235], a[136:139], v[236:239]
 global_load_dwordx4 a[224:227], v0, s[70:71] offset:-4096 sc1
 ds_read_b128 a[136:139], v2 offset:4096
 v_mfma_f32_16x16x32_bf16 v[240:243], a[232:235], a[144:147], v[240:243]
 ds_read_b128 a[144:147], v2 offset:8192
 v_add_f32 v40, v40, v8
 v_mfma_f32_16x16x32_bf16 v[240:243], a[236:239], a[148:151], v[240:243]
 ds_read_b128 a[148:151], v2 offset:9216
 v_add_f32 v41, v41, v9
 v_mfma_f32_16x16x32_bf16 v[244:247], a[236:239], a[156:159], v[244:247]
 ds_read_b128 a[156:159], v2 offset:13312
 v_add_f32 v42, v42, v10
 v_mfma_f32_16x16x32_bf16 v[244:247], a[232:235], a[152:155], v[244:247]
 ds_read_b128 a[152:155], v2 offset:12288
 v_add_f32 v43, v43, v11
 v_mfma_f32_16x16x32_bf16 v[248:251], a[232:235], a[160:163], v[248:251]
 ds_read_b128 a[160:163], v2 offset:16384
 v_add_f32 v44, v44, v8
 v_mfma_f32_16x16x32_bf16 v[248:251], a[236:239], a[164:167], v[248:251]
 ds_read_b128 a[164:167], v2 offset:17408
 v_add_f32 v45, v45, v9
 v_mfma_f32_16x16x32_bf16 v[252:255], a[236:239], a[172:175], v[252:255]
 ds_read_b128 a[172:175], v2 offset:21504
 v_add_f32 v46, v46, v10
 v_mfma_f32_16x16x32_bf16 v[252:255], a[232:235], a[168:171], v[252:255]
 ds_read_b128 a[168:171], v2 offset:20480
 v_add_f32 v47, v47, v11
 s_waitcnt lgkmcnt(12)
 v_mfma_f32_16x16x32_bf16 a[248:251], a[232:235], a[176:179], a[248:251]
 ds_read_b128 a[176:179], v2 offset:24576
 v_add_f32 v48, v48, v12
 v_mfma_f32_16x16x32_bf16 a[248:251], a[236:239], a[180:183], a[248:251]
 ds_read_b128 a[180:183], v2 offset:25600
 ds_read_b128 v[8:11], v4 offset:128
 v_mfma_f32_16x16x32_bf16 a[252:255], a[236:239], a[188:191], a[252:255]
 ds_read_b128 a[188:191], v2 offset:29696
 v_add_f32 v49, v49, v13
 v_mfma_f32_16x16x32_bf16 a[252:255], a[232:235], a[184:187], a[252:255]
 ds_read_b128 a[184:187], v2 offset:28672
 v_add_f32 v50, v50, v14
 s_waitcnt vmcnt(8) lgkmcnt(9)
 v_mfma_f32_16x16x32_bf16 v[136:139], a[192:195], a[128:131], v[136:139]
 v_add_f32 v51, v51, v15
 v_add_f32 v52, v52, v12
 v_mfma_f32_16x16x32_bf16 v[136:139], a[196:199], a[132:135], v[136:139]
 global_load_dwordx4 a[236:239], v0, s[70:71] offset:-1024 sc1
 v_add_f32 v53, v53, v13
 v_mfma_f32_16x16x32_bf16 v[140:143], a[196:199], a[140:143], v[140:143]
 v_add_f32 v54, v54, v14
 v_mfma_f32_16x16x32_bf16 v[140:143], a[192:195], a[136:139], v[140:143]
 global_load_dwordx4 a[232:235], v0, s[70:71] offset:-2048 sc1
 v_add_f32 v55, v55, v15
 v_mfma_f32_16x16x32_bf16 v[144:147], a[192:195], a[144:147], v[144:147]
 v_add_f32 v56, v56, v12
 v_mfma_f32_16x16x32_bf16 v[144:147], a[196:199], a[148:151], v[144:147]
 v_add_f32 v57, v57, v13
 v_mfma_f32_16x16x32_bf16 v[148:151], a[196:199], a[156:159], v[148:151]
 v_add_f32 v58, v58, v14
 v_mfma_f32_16x16x32_bf16 v[148:151], a[192:195], a[152:155], v[148:151]
 v_add_f32 v59, v59, v15
 s_waitcnt lgkmcnt(0)
 v_mfma_f32_16x16x32_bf16 v[152:155], a[192:195], a[160:163], v[152:155]
 v_add_f32 v60, v60, v12
 v_mfma_f32_16x16x32_bf16 v[152:155], a[196:199], a[164:167], v[152:155]
 v_add_f32 v61, v61, v13
 v_mfma_f32_16x16x32_bf16 v[156:159], a[196:199], a[172:175], v[156:159]
 v_add_f32 v62, v62, v14
 v_mfma_f32_16x16x32_bf16 v[156:159], a[192:195], a[168:171], v[156:159]
 v_add_f32 v63, v63, v15
 v_mfma_f32_16x16x32_bf16 v[160:163], a[192:195], a[176:179], v[160:163]
 v_add_f32 v64, v64, v12
 v_mfma_f32_16x16x32_bf16 v[160:163], a[196:199], a[180:183], v[160:163]
 v_add_f32 v65, v65, v13
 v_mfma_f32_16x16x32_bf16 v[164:167], a[196:199], a[188:191], v[164:167]
 v_add_f32 v66, v66, v14
 v_mfma_f32_16x16x32_bf16 v[164:167], a[192:195], a[184:187], v[164:167]
 v_add_f32 v67, v67, v15
 s_waitcnt vmcnt(8)
 v_mfma_f32_16x16x32_bf16 v[196:199], a[200:203], a[184:187], v[196:199]
 v_add_f32 v68, v68, v12
 v_mfma_f32_16x16x32_bf16 v[196:199], a[204:207], a[188:191], v[196:199]
 global_load_dwordx4 a[196:199], v0, s[70:71] offset:1024 sc1
 v_add_f32 v69, v69, v13
 v_mfma_f32_16x16x32_bf16 v[192:195], a[204:207], a[180:183], v[192:195]
 v_add_f32 v70, v70, v14
 v_add_f32 v71, v71, v15
 v_mfma_f32_16x16x32_bf16 v[192:195], a[200:203], a[176:179], v[192:195]
 global_load_dwordx4 a[192:195], v0, s[70:71] offset:0 sc1
 v_add_f32 v72, v72, v12
 v_mfma_f32_16x16x32_bf16 v[188:191], a[200:203], a[168:171], v[188:191]
 v_add_f32 v73, v73, v13
 v_mfma_f32_16x16x32_bf16 v[188:191], a[204:207], a[172:175], v[188:191]
 v_add_f32 v74, v74, v14
 v_mfma_f32_16x16x32_bf16 v[184:187], a[204:207], a[164:167], v[184:187]
 v_add_f32 v75, v75, v15
 v_mfma_f32_16x16x32_bf16 v[184:187], a[200:203], a[160:163], v[184:187]
 v_add_f32 v76, v76, v12
 v_mfma_f32_16x16x32_bf16 v[180:183], a[200:203], a[152:155], v[180:183]
 v_add_f32 v77, v77, v13
 v_mfma_f32_16x16x32_bf16 v[180:183], a[204:207], a[156:159], v[180:183]
 v_add_f32 v78, v78, v14
 v_mfma_f32_16x16x32_bf16 v[176:179], a[204:207], a[148:151], v[176:179]
 v_add_f32 v79, v79, v15
 v_mfma_f32_16x16x32_bf16 v[176:179], a[200:203], a[144:147], v[176:179]
 v_mfma_f32_16x16x32_bf16 v[172:175], a[200:203], a[136:139], v[172:175]
 v_add_f32 v80, v80, v8
 v_mfma_f32_16x16x32_bf16 v[172:175], a[204:207], a[140:143], v[172:175]
 ds_read_b128 v[12:15], v4 offset:144
 v_mfma_f32_16x16x32_bf16 v[168:171], a[204:207], a[132:135], v[168:171]
 v_add_f32 v81, v81, v9
 v_mfma_f32_16x16x32_bf16 v[168:171], a[200:203], a[128:131], v[168:171]
 v_add_f32 v82, v82, v10
 s_waitcnt vmcnt(8)
 v_mfma_f32_16x16x32_bf16 v[200:203], a[208:211], a[128:131], v[200:203]
 v_add_f32 v83, v83, v11
 v_mfma_f32_16x16x32_bf16 v[200:203], a[212:215], a[132:135], v[200:203]
 global_load_dwordx4 a[204:207], v0, s[70:71] offset:3072 sc1
 v_add_f32 v84, v84, v8
 v_mfma_f32_16x16x32_bf16 v[204:207], a[212:215], a[140:143], v[204:207]
 v_add_f32 v85, v85, v9
 v_mfma_f32_16x16x32_bf16 v[204:207], a[208:211], a[136:139], v[204:207]
 global_load_dwordx4 a[200:203], v0, s[70:71] offset:2048 sc1
 v_add_f32 v86, v86, v10
 v_mfma_f32_16x16x32_bf16 v[208:211], a[208:211], a[144:147], v[208:211]
 v_add_f32 v87, v87, v11
 s_add_u32 s70, s70, 8192
 s_addc_u32 s71, s71, 0
 v_mfma_f32_16x16x32_bf16 v[208:211], a[212:215], a[148:151], v[208:211]
 v_add_f32 v88, v88, v8
 v_add_f32 v89, v89, v9
 v_mfma_f32_16x16x32_bf16 v[212:215], a[212:215], a[156:159], v[212:215]
 v_add_f32 v90, v90, v10
 v_mfma_f32_16x16x32_bf16 v[212:215], a[208:211], a[152:155], v[212:215]
 v_add_f32 v91, v91, v11
 v_mfma_f32_16x16x32_bf16 v[216:219], a[208:211], a[160:163], v[216:219]
 v_add_f32 v92, v92, v8
 v_mfma_f32_16x16x32_bf16 v[216:219], a[212:215], a[164:167], v[216:219]
 v_add_f32 v93, v93, v9
 v_mfma_f32_16x16x32_bf16 v[220:223], a[212:215], a[172:175], v[220:223]
 v_add_f32 v94, v94, v10
 v_mfma_f32_16x16x32_bf16 v[220:223], a[208:211], a[168:171], v[220:223]
 v_add_f32 v95, v95, v11
 v_mfma_f32_16x16x32_bf16 v[224:227], a[208:211], a[176:179], v[224:227]
 v_add_f32 v96, v96, v8
 v_mfma_f32_16x16x32_bf16 v[224:227], a[212:215], a[180:183], v[224:227]
 v_add_f32 v97, v97, v9
 v_mfma_f32_16x16x32_bf16 v[228:231], a[212:215], a[188:191], v[228:231]
 v_add_f32 v98, v98, v10
 v_add_f32 v99, v99, v11
 v_mfma_f32_16x16x32_bf16 v[228:231], a[208:211], a[184:187], v[228:231]
 v_add_f32 v100, v100, v8
 v_add_f32 v101, v101, v9
 s_waitcnt vmcnt(8)
 v_mfma_f32_16x16x32_bf16 a[252:255], a[216:219], a[184:187], a[252:255]
 ds_read_b128 a[184:187], v2 offset:61440
 v_add_f32 v102, v102, v10
 v_mfma_f32_16x16x32_bf16 a[252:255], a[220:223], a[188:191], a[252:255]
 global_load_dwordx4 a[212:215], v0, s[70:71] offset:-3072 sc1
 ds_read_b128 a[188:191], v2 offset:62464
 v_mfma_f32_16x16x32_bf16 a[248:251], a[220:223], a[180:183], a[248:251]
 ds_read_b128 a[180:183], v2 offset:58368
 v_add_f32 v103, v103, v11
 v_mfma_f32_16x16x32_bf16 a[248:251], a[216:219], a[176:179], a[248:251]
 global_load_dwordx4 a[208:211], v0, s[70:71] offset:-4096 sc1
 ds_read_b128 a[176:179], v2 offset:57344
 v_mfma_f32_16x16x32_bf16 v[252:255], a[216:219], a[168:171], v[252:255]
 ds_read_b128 a[168:171], v2 offset:53248
 v_add_f32 v104, v104, v8
 v_mfma_f32_16x16x32_bf16 v[252:255], a[220:223], a[172:175], v[252:255]
 ds_read_b128 a[172:175], v2 offset:54272
 v_add_f32 v105, v105, v9
 v_mfma_f32_16x16x32_bf16 v[248:251], a[220:223], a[164:167], v[248:251]
 ds_read_b128 a[164:167], v2 offset:50176
 v_add_f32 v106, v106, v10
 v_mfma_f32_16x16x32_bf16 v[248:251], a[216:219], a[160:163], v[248:251]
 ds_read_b128 a[160:163], v2 offset:49152
 v_add_f32 v107, v107, v11
 v_mfma_f32_16x16x32_bf16 v[244:247], a[216:219], a[152:155], v[244:247]
 ds_read_b128 a[152:155], v2 offset:45056
 v_add_f32 v108, v108, v8
 v_mfma_f32_16x16x32_bf16 v[244:247], a[220:223], a[156:159], v[244:247]
 ds_read_b128 a[156:159], v2 offset:46080
 v_add_f32 v109, v109, v9
 v_mfma_f32_16x16x32_bf16 v[240:243], a[220:223], a[148:151], v[240:243]
 ds_read_b128 a[148:151], v2 offset:41984
 v_add_f32 v110, v110, v10
 v_mfma_f32_16x16x32_bf16 v[240:243], a[216:219], a[144:147], v[240:243]
 ds_read_b128 a[144:147], v2 offset:40960
 v_add_f32 v111, v111, v11
 s_waitcnt lgkmcnt(12)
 v_mfma_f32_16x16x32_bf16 v[236:239], a[216:219], a[136:139], v[236:239]
 ds_read_b128 a[136:139], v2 offset:36864
 v_add_f32 v112, v112, v12
 v_mfma_f32_16x16x32_bf16 v[236:239], a[220:223], a[140:143], v[236:239]
 ds_read_b128 a[140:143], v2 offset:37888
 v_add_f32 v113, v113, v13
 v_mfma_f32_16x16x32_bf16 v[232:235], a[220:223], a[132:135], v[232:235]
 ds_read_b128 a[132:135], v2 offset:33792
 v_add_f32 v114, v114, v14
 v_mfma_f32_16x16x32_bf16 v[232:235], a[216:219], a[128:131], v[232:235]
 ds_read_b128 a[128:131], v2 offset:32768
 v_add_f32 v115, v115, v15
 s_waitcnt vmcnt(8) lgkmcnt(8)
 v_mfma_f32_16x16x32_bf16 v[164:167], a[224:227], a[184:187], v[164:167]
 v_add_f32 v116, v116, v12
 v_mfma_f32_16x16x32_bf16 v[164:167], a[228:231], a[188:191], v[164:167]
 global_load_dwordx4 a[220:223], v0, s[70:71] offset:-1024 sc1
 v_add_f32 v117, v117, v13
 v_mfma_f32_16x16x32_bf16 v[160:163], a[228:231], a[180:183], v[160:163]
 v_add_f32 v118, v118, v14
 v_mfma_f32_16x16x32_bf16 v[160:163], a[224:227], a[176:179], v[160:163]
 global_load_dwordx4 a[216:219], v0, s[70:71] offset:-2048 sc1
 v_add_f32 v119, v119, v15
 v_mfma_f32_16x16x32_bf16 v[156:159], a[224:227], a[168:171], v[156:159]
 v_add_f32 v120, v120, v12
 v_mfma_f32_16x16x32_bf16 v[156:159], a[228:231], a[172:175], v[156:159]
 v_add_f32 v121, v121, v13
 v_mfma_f32_16x16x32_bf16 v[152:155], a[228:231], a[164:167], v[152:155]
 v_add_f32 v122, v122, v14
 v_mfma_f32_16x16x32_bf16 v[152:155], a[224:227], a[160:163], v[152:155]
 v_add_f32 v123, v123, v15
 s_waitcnt lgkmcnt(0)
 v_mfma_f32_16x16x32_bf16 v[148:151], a[224:227], a[152:155], v[148:151]
 v_add_f32 v124, v124, v12
 v_mfma_f32_16x16x32_bf16 v[148:151], a[228:231], a[156:159], v[148:151]
 v_add_f32 v125, v125, v13
 v_mfma_f32_16x16x32_bf16 v[144:147], a[228:231], a[148:151], v[144:147]
 v_add_f32 v126, v126, v14
 v_mfma_f32_16x16x32_bf16 v[144:147], a[224:227], a[144:147], v[144:147]
 v_add_f32 v127, v127, v15
 v_mfma_f32_16x16x32_bf16 v[140:143], a[224:227], a[136:139], v[140:143]
 v_add_f32 v128, v128, v12
 v_add_f32 v129, v129, v13
 v_mfma_f32_16x16x32_bf16 v[140:143], a[228:231], a[140:143], v[140:143]
 v_add_f32 v130, v130, v14
 v_mfma_f32_16x16x32_bf16 v[136:139], a[228:231], a[132:135], v[136:139]
 v_add_f32 v131, v131, v15
 v_mfma_f32_16x16x32_bf16 v[136:139], a[224:227], a[128:131], v[136:139]
 v_add_f32 v132, v132, v12
 s_waitcnt vmcnt(8)
 v_mfma_f32_16x16x32_bf16 v[168:171], a[232:235], a[128:131], v[168:171]
 v_add_f32 v133, v133, v13
 v_mfma_f32_16x16x32_bf16 v[168:171], a[236:239], a[132:135], v[168:171]
 global_load_dwordx4 a[228:231], v0, s[70:71] offset:1024 sc1
 v_add_f32 v134, v134, v14
 v_mfma_f32_16x16x32_bf16 v[172:175], a[236:239], a[140:143], v[172:175]
 v_add_f32 v135, v135, v15
 v_mfma_f32_16x16x32_bf16 v[172:175], a[232:235], a[136:139], v[172:175]
 global_load_dwordx4 a[224:227], v0, s[70:71] offset:0 sc1
 v_accvgpr_read_b32 v5, a240
 v_mfma_f32_16x16x32_bf16 v[176:179], a[232:235], a[144:147], v[176:179]
 v_add_f32 v5, v5, v12
 v_mfma_f32_16x16x32_bf16 v[176:179], a[236:239], a[148:151], v[176:179]
 v_accvgpr_write_b32 a240, v5
 v_mfma_f32_16x16x32_bf16 v[180:183], a[236:239], a[156:159], v[180:183]
 v_accvgpr_read_b32 v6, a241
 v_mfma_f32_16x16x32_bf16 v[180:183], a[232:235], a[152:155], v[180:183]
 v_add_f32 v6, v6, v13
 v_mfma_f32_16x16x32_bf16 v[184:187], a[232:235], a[160:163], v[184:187]
 v_accvgpr_write_b32 a241, v6
 v_mfma_f32_16x16x32_bf16 v[184:187], a[236:239], a[164:167], v[184:187]
 v_accvgpr_read_b32 v5, a242
 v_mfma_f32_16x16x32_bf16 v[188:191], a[236:239], a[172:175], v[188:191]
 v_add_f32 v5, v5, v14
 v_mfma_f32_16x16x32_bf16 v[188:191], a[232:235], a[168:171], v[188:191]
 v_accvgpr_write_b32 a242, v5
 v_mfma_f32_16x16x32_bf16 v[192:195], a[232:235], a[176:179], v[192:195]
 v_accvgpr_read_b32 v6, a243
 v_mfma_f32_16x16x32_bf16 v[192:195], a[236:239], a[180:183], v[192:195]
 v_add_f32 v6, v6, v15
 v_mfma_f32_16x16x32_bf16 v[196:199], a[236:239], a[188:191], v[196:199]
 v_accvgpr_write_b32 a243, v6
 v_mfma_f32_16x16x32_bf16 v[196:199], a[232:235], a[184:187], v[196:199]
 v_accvgpr_read_b32 v5, a244
 s_waitcnt vmcnt(8)
 v_mfma_f32_16x16x32_bf16 v[228:231], a[192:195], a[184:187], v[228:231]
 v_add_f32 v5, v5, v12
 v_accvgpr_write_b32 a244, v5
 v_mfma_f32_16x16x32_bf16 v[228:231], a[196:199], a[188:191], v[228:231]
 global_load_dwordx4 a[236:239], v0, s[70:71] offset:3072 sc1
 v_accvgpr_read_b32 v6, a245
 v_mfma_f32_16x16x32_bf16 v[224:227], a[196:199], a[180:183], v[224:227]
 v_add_f32 v6, v6, v13
 v_mfma_f32_16x16x32_bf16 v[224:227], a[192:195], a[176:179], v[224:227]
 global_load_dwordx4 a[232:235], v0, s[70:71] offset:2048 sc1
 v_accvgpr_write_b32 a245, v6
 v_mfma_f32_16x16x32_bf16 v[220:223], a[192:195], a[168:171], v[220:223]
 v_accvgpr_read_b32 v5, a246
 s_add_u32 s70, s70, 8192
 s_addc_u32 s71, s71, 0
 v_mfma_f32_16x16x32_bf16 v[220:223], a[196:199], a[172:175], v[220:223]
 v_add_f32 v5, v5, v14
 v_mfma_f32_16x16x32_bf16 v[216:219], a[196:199], a[164:167], v[216:219]
 v_accvgpr_write_b32 a246, v5
 v_mfma_f32_16x16x32_bf16 v[216:219], a[192:195], a[160:163], v[216:219]
 v_accvgpr_read_b32 v6, a247
 v_mfma_f32_16x16x32_bf16 v[212:215], a[192:195], a[152:155], v[212:215]
 v_add_f32 v6, v6, v15
 v_mfma_f32_16x16x32_bf16 v[212:215], a[196:199], a[156:159], v[212:215]
 v_accvgpr_write_b32 a247, v6
 v_mfma_f32_16x16x32_bf16 v[208:211], a[196:199], a[148:151], v[208:211]
 s_add_u32 s55, s55, 1
 s_waitcnt lgkmcnt(0)
 s_barrier
 v_mfma_f32_16x16x32_bf16 v[208:211], a[192:195], a[144:147], v[208:211]
 v_mfma_f32_16x16x32_bf16 v[204:207], a[192:195], a[136:139], v[204:207]
 v_mfma_f32_16x16x32_bf16 v[204:207], a[196:199], a[140:143], v[204:207]
 v_mfma_f32_16x16x32_bf16 v[200:203], a[196:199], a[132:135], v[200:203]
 v_mfma_f32_16x16x32_bf16 v[200:203], a[192:195], a[128:131], v[200:203]
 s_waitcnt vmcnt(8)
 v_mfma_f32_16x16x32_bf16 v[232:235], a[200:203], a[128:131], v[232:235]
 ds_read_b128 a[128:131], v1 offset:2048
 v_mfma_f32_16x16x32_bf16 v[232:235], a[204:207], a[132:135], v[232:235]
 global_load_dwordx4 a[196:199], v0, s[70:71] offset:-3072 sc1
 ds_read_b128 a[132:135], v1 offset:3072
 v_mfma_f32_16x16x32_bf16 v[236:239], a[204:207], a[140:143], v[236:239]
 ds_read_b128 a[140:143], v1 offset:7168
 v_mfma_f32_16x16x32_bf16 v[236:239], a[200:203], a[136:139], v[236:239]
 global_load_dwordx4 a[192:195], v0, s[70:71] offset:-4096 sc1
 ds_read_b128 a[136:139], v1 offset:6144
 v_mfma_f32_16x16x32_bf16 v[240:243], a[200:203], a[144:147], v[240:243]
 ds_read_b128 a[144:147], v1 offset:10240
 v_mfma_f32_16x16x32_bf16 v[240:243], a[204:207], a[148:151], v[240:243]
 ds_read_b128 a[148:151], v1 offset:11264
 v_mfma_f32_16x16x32_bf16 v[244:247], a[204:207], a[156:159], v[244:247]
 ds_read_b128 a[156:159], v1 offset:15360
 v_mfma_f32_16x16x32_bf16 v[244:247], a[200:203], a[152:155], v[244:247]
 ds_read_b128 a[152:155], v1 offset:14336
 v_mfma_f32_16x16x32_bf16 v[248:251], a[200:203], a[160:163], v[248:251]
 ds_read_b128 a[160:163], v1 offset:18432
 v_mfma_f32_16x16x32_bf16 v[248:251], a[204:207], a[164:167], v[248:251]
 ds_read_b128 a[164:167], v1 offset:19456
 v_mfma_f32_16x16x32_bf16 v[252:255], a[204:207], a[172:175], v[252:255]
 ds_read_b128 a[172:175], v1 offset:23552
 v_mfma_f32_16x16x32_bf16 v[252:255], a[200:203], a[168:171], v[252:255]
 ds_read_b128 a[168:171], v1 offset:22528
 v_mfma_f32_16x16x32_bf16 a[248:251], a[200:203], a[176:179], a[248:251]
 ds_read_b128 a[176:179], v1 offset:26624
 v_mfma_f32_16x16x32_bf16 a[248:251], a[204:207], a[180:183], a[248:251]
 ds_read_b128 a[180:183], v1 offset:27648
 v_mfma_f32_16x16x32_bf16 a[252:255], a[204:207], a[188:191], a[252:255]
 global_load_dwordx4 a[204:207], v0, s[70:71] offset:-1024 sc1
 ds_read_b128 a[188:191], v1 offset:31744
 v_mfma_f32_16x16x32_bf16 a[252:255], a[200:203], a[184:187], a[252:255]
 global_load_dwordx4 a[200:203], v0, s[70:71] offset:-2048 sc1
 ds_read_b128 a[184:187], v1 offset:30720
 s_waitcnt vmcnt(10) lgkmcnt(8)
Lloop:
 v_mfma_f32_16x16x32_bf16 v[16:19], a[208:211], a[128:131], v[16:19]
 v_mov_b32 v6, v3
 s_cmp_eq_u32 s25, 0
 s_cbranch_scc1 Lgat0
Lgatr0:
 v_mfma_f32_16x16x32_bf16 v[16:19], a[212:215], a[132:135], v[16:19]
 s_add_u32 s29, s29, 0x2000000
 v_mfma_f32_16x16x32_bf16 v[20:23], a[212:215], a[140:143], v[20:23]
 s_add_u32 m0, s50, 0
 v_mfma_f32_16x16x32_bf16 v[20:23], a[208:211], a[136:139], v[20:23]
 v_mfma_f32_16x16x32_bf16 v[24:27], a[208:211], a[144:147], v[24:27]
 v_mfma_f32_16x16x32_bf16 v[24:27], a[212:215], a[148:151], v[24:27]
 buffer_load_dwordx4 v6, s[8:11], s30 offen lds
 v_mfma_f32_16x16x32_bf16 v[28:31], a[212:215], a[156:159], v[28:31]
 s_add_u32 m0, m0, 1024
 v_mfma_f32_16x16x32_bf16 v[28:31], a[208:211], a[152:155], v[28:31]
 s_waitcnt lgkmcnt(0)
 v_mfma_f32_16x16x32_bf16 v[32:35], a[208:211], a[160:163], v[32:35]
 s_add_u32 s30, s30, s20
 v_mfma_f32_16x16x32_bf16 v[32:35], a[212:215], a[164:167], v[32:35]
 buffer_load_dwordx4 v6, s[8:11], s30 offen lds
 v_mfma_f32_16x16x32_bf16 v[36:39], a[212:215], a[172:175], v[36:39]
 v_mfma_f32_16x16x32_bf16 v[36:39], a[208:211], a[168:171], v[36:39]
 s_add_u32 m0, m0, 3072
 v_mfma_f32_16x16x32_bf16 v[40:43], a[208:211], a[176:179], v[40:43]
 s_add_u32 s30, s30, s21
 v_mfma_f32_16x16x32_bf16 v[40:43], a[212:215], a[180:183], v[40:43]
 v_mfma_f32_16x16x32_bf16 v[44:47], a[212:215], a[188:191], v[44:47]
 v_mfma_f32_16x16x32_bf16 v[44:47], a[208:211], a[184:187], v[44:47]
 s_waitcnt vmcnt(10)
 v_mfma_f32_16x16x32_bf16 v[76:79], a[216:219], a[184:187], v[76:79]
 v_mfma_f32_16x16x32_bf16 v[76:79], a[220:223], a[188:191], v[76:79]
 global_load_dwordx4 a[212:215], v0, s[70:71] offset:1024 sc1
 v_mfma_f32_16x16x32_bf16 v[72:75], a[220:223], a[180:183], v[72:75]
 v_mfma_f32_16x16x32_bf16 v[72:75], a[216:219], a[176:179], v[72:75]
 global_load_dwordx4 a[208:211], v0, s[70:71] offset:0 sc1
 v_mfma_f32_16x16x32_bf16 v[68:71], a[216:219], a[168:171], v[68:71]
 v_mfma_f32_16x16x32_bf16 v[68:71], a[220:223], a[172:175], v[68:71]
 v_mfma_f32_16x16x32_bf16 v[64:67], a[220:223], a[164:167], v[64:67]
 v_mfma_f32_16x16x32_bf16 v[64:67], a[216:219], a[160:163], v[64:67]
 v_mfma_f32_16x16x32_bf16 v[60:63], a[216:219], a[152:155], v[60:63]
 v_mfma_f32_16x16x32_bf16 v[60:63], a[220:223], a[156:159], v[60:63]
 v_mfma_f32_16x16x32_bf16 v[56:59], a[220:223], a[148:151], v[56:59]
 v_mfma_f32_16x16x32_bf16 v[56:59], a[216:219], a[144:147], v[56:59]
 v_mfma_f32_16x16x32_bf16 v[52:55], a[216:219], a[136:139], v[52:55]
 v_mfma_f32_16x16x32_bf16 v[52:55], a[220:223], a[140:143], v[52:55]
 v_mfma_f32_16x16x32_bf16 v[48:51], a[220:223], a[132:135], v[48:51]
 v_mfma_f32_16x16x32_bf16 v[48:51], a[216:219], a[128:131], v[48:51]
 s_waitcnt vmcnt(10)
 v_mfma_f32_16x16x32_bf16 v[80:83], a[224:227], a[128:131], v[80:83]
 v_mfma_f32_16x16x32_bf16 v[80:83], a[228:231], a[132:135], v[80:83]
 global_load_dwordx4 a[220:223], v0, s[70:71] offset:3072 sc1
 v_mfma_f32_16x16x32_bf16 v[84:87], a[228:231], a[140:143], v[84:87]
 v_mfma_f32_16x16x32_bf16 v[84:87], a[224:227], a[136:139], v[84:87]
 global_load_dwordx4 a[216:219], v0, s[70:71] offset:2048 sc1
 v_mfma_f32_16x16x32_bf16 v[88:91], a[224:227], a[144:147], v[88:91]
 s_add_u32 s70, s70, 8192
 s_addc_u32 s71, s71, 0
 v_mfma_f32_16x16x32_bf16 v[88:91], a[228:231], a[148:151], v[88:91]
 v_mfma_f32_16x16x32_bf16 v[92:95], a[228:231], a[156:159], v[92:95]
 v_mfma_f32_16x16x32_bf16 v[92:95], a[224:227], a[152:155], v[92:95]
 v_mfma_f32_16x16x32_bf16 v[96:99], a[224:227], a[160:163], v[96:99]
 v_mfma_f32_16x16x32_bf16 v[96:99], a[228:231], a[164:167], v[96:99]
 v_mfma_f32_16x16x32_bf16 v[100:103], a[228:231], a[172:175], v[100:103]
 v_mfma_f32_16x16x32_bf16 v[100:103], a[224:227], a[168:171], v[100:103]
 v_mfma_f32_16x16x32_bf16 v[104:107], a[224:227], a[176:179], v[104:107]
 v_mfma_f32_16x16x32_bf16 v[104:107], a[228:231], a[180:183], v[104:107]
 v_mfma_f32_16x16x32_bf16 v[108:111], a[228:231], a[188:191], v[108:111]
 v_mfma_f32_16x16x32_bf16 v[108:111], a[224:227], a[184:187], v[108:111]
 s_waitcnt vmcnt(10)
 v_mfma_f32_16x16x32_bf16 a[244:247], a[232:235], a[184:187], a[244:247]
 v_mfma_f32_16x16x32_bf16 a[244:247], a[236:239], a[188:191], a[244:247]
 global_load_dwordx4 a[228:231], v0, s[70:71] offset:-3072 sc1
 v_mfma_f32_16x16x32_bf16 a[240:243], a[236:239], a[180:183], a[240:243]
 v_mfma_f32_16x16x32_bf16 a[240:243], a[232:235], a[176:179], a[240:243]
 global_load_dwordx4 a[224:227], v0, s[70:71] offset:-4096 sc1
 v_mfma_f32_16x16x32_bf16 v[132:135], a[232:235], a[168:171], v[132:135]
 v_mfma_f32_16x16x32_bf16 v[132:135], a[236:239], a[172:175], v[132:135]
 v_mfma_f32_16x16x32_bf16 v[128:131], a[236:239], a[164:167], v[128:131]
 v_mfma_f32_16x16x32_bf16 v[128:131], a[232:235], a[160:163], v[128:131]
 v_mfma_f32_16x16x32_bf16 v[124:127], a[232:235], a[152:155], v[124:127]
 v_mfma_f32_16x16x32_bf16 v[124:127], a[236:239], a[156:159], v[124:127]
 v_mfma_f32_16x16x32_bf16 v[120:123], a[236:239], a[148:151], v[120:123]
 v_mfma_f32_16x16x32_bf16 v[120:123], a[232:235], a[144:147], v[120:123]
 buffer_load_dwordx4 v6, s[8:11], s30 offen lds
 v_mfma_f32_16x16x32_bf16 v[116:119], a[232:235], a[136:139], v[116:119]
 s_add_u32 m0, m0, 1024
 v_mfma_f32_16x16x32_bf16 v[116:119], a[236:239], a[140:143], v[116:119]
 v_mfma_f32_16x16x32_bf16 v[112:115], a[236:239], a[132:135], v[112:115]
 s_add_u32 s30, s30, s20
 v_mfma_f32_16x16x32_bf16 v[112:115], a[232:235], a[128:131], v[112:115]
 buffer_load_dwordx4 v6, s[8:11], s30 offen lds
 s_waitcnt vmcnt(12)
 v_mfma_f32_16x16x32_bf16 v[136:139], a[192:195], a[128:131], v[136:139]
 v_mfma_f32_16x16x32_bf16 v[136:139], a[196:199], a[132:135], v[136:139]
 global_load_dwordx4 a[236:239], v0, s[70:71] offset:-1024 sc1
 s_add_u32 m0, m0, 3072
 v_mfma_f32_16x16x32_bf16 v[140:143], a[196:199], a[140:143], v[140:143]
 s_add_u32 s30, s30, s21
 v_mfma_f32_16x16x32_bf16 v[140:143], a[192:195], a[136:139], v[140:143]
 global_load_dwordx4 a[232:235], v0, s[70:71] offset:-2048 sc1
 v_mfma_f32_16x16x32_bf16 v[144:147], a[192:195], a[144:147], v[144:147]
 v_mfma_f32_16x16x32_bf16 v[144:147], a[196:199], a[148:151], v[144:147]
 v_mfma_f32_16x16x32_bf16 v[148:151], a[196:199], a[156:159], v[148:151]
 v_mfma_f32_16x16x32_bf16 v[148:151], a[192:195], a[152:155], v[148:151]
 v_mfma_f32_16x16x32_bf16 v[152:155], a[192:195], a[160:163], v[152:155]
 v_mfma_f32_16x16x32_bf16 v[152:155], a[196:199], a[164:167], v[152:155]
 v_mfma_f32_16x16x32_bf16 v[156:159], a[196:199], a[172:175], v[156:159]
 v_mfma_f32_16x16x32_bf16 v[156:159], a[192:195], a[168:171], v[156:159]
 v_mfma_f32_16x16x32_bf16 v[160:163], a[192:195], a[176:179], v[160:163]
 v_mfma_f32_16x16x32_bf16 v[160:163], a[196:199], a[180:183], v[160:163]
 v_mfma_f32_16x16x32_bf16 v[164:167], a[196:199], a[188:191], v[164:167]
 v_mfma_f32_16x16x32_bf16 v[164:167], a[192:195], a[184:187], v[164:167]
 s_waitcnt vmcnt(12)
 v_mfma_f32_16x16x32_bf16 v[196:199], a[200:203], a[184:187], v[196:199]
 v_mfma_f32_16x16x32_bf16 v[196:199], a[204:207], a[188:191], v[196:199]
 global_load_dwordx4 a[196:199], v0, s[70:71] offset:1024 sc1
 v_mfma_f32_16x16x32_bf16 v[192:195], a[204:207], a[180:183], v[192:195]
 s_add_u32 s31, s31, 1
 v_mov_b32 v7, s31
 buffer_store_dword v7, v1, s[60:63], 0 offen sc1
 v_mfma_f32_16x16x32_bf16 v[192:195], a[200:203], a[176:179], v[192:195]
 global_load_dwordx4 a[192:195], v0, s[70:71] offset:0 sc1
 v_mfma_f32_16x16x32_bf16 v[188:191], a[200:203], a[168:171], v[188:191]
 v_mfma_f32_16x16x32_bf16 v[188:191], a[204:207], a[172:175], v[188:191]
 v_mfma_f32_16x16x32_bf16 v[184:187], a[204:207], a[164:167], v[184:187]
 v_mfma_f32_16x16x32_bf16 v[184:187], a[200:203], a[160:163], v[184:187]
 v_mfma_f32_16x16x32_bf16 v[180:183], a[200:203], a[152:155], v[180:183]
 v_mfma_f32_16x16x32_bf16 v[180:183], a[204:207], a[156:159], v[180:183]
 v_mfma_f32_16x16x32_bf16 v[176:179], a[204:207], a[148:151], v[176:179]
 v_mfma_f32_16x16x32_bf16 v[176:179], a[200:203], a[144:147], v[176:179]
 v_mfma_f32_16x16x32_bf16 v[172:175], a[200:203], a[136:139], v[172:175]
 v_mfma_f32_16x16x32_bf16 v[172:175], a[204:207], a[140:143], v[172:175]
 v_mfma_f32_16x16x32_bf16 v[168:171], a[204:207], a[132:135], v[168:171]
 v_mfma_f32_16x16x32_bf16 v[168:171], a[200:203], a[128:131], v[168:171]
 s_waitcnt vmcnt(11)
 v_mfma_f32_16x16x32_bf16 v[200:203], a[208:211], a[128:131], v[200:203]
 v_mfma_f32_16x16x32_bf16 v[200:203], a[212:215], a[132:135], v[200:203]
 global_load_dwordx4 a[204:207], v0, s[70:71] offset:3072 sc1
 v_mfma_f32_16x16x32_bf16 v[204:207], a[212:215], a[140:143], v[204:207]
 v_mfma_f32_16x16x32_bf16 v[204:207], a[208:211], a[136:139], v[204:207]
 global_load_dwordx4 a[200:203], v0, s[70:71] offset:2048 sc1
 v_mfma_f32_16x16x32_bf16 v[208:211], a[208:211], a[144:147], v[208:211]
 s_add_u32 s70, s70, 8192
 s_addc_u32 s71, s71, 0
 v_mfma_f32_16x16x32_bf16 v[208:211], a[212:215], a[148:151], v[208:211]
 v_mfma_f32_16x16x32_bf16 v[212:215], a[212:215], a[156:159], v[212:215]
 v_mfma_f32_16x16x32_bf16 v[212:215], a[208:211], a[152:155], v[212:215]
 v_mfma_f32_16x16x32_bf16 v[216:219], a[208:211], a[160:163], v[216:219]
 v_mfma_f32_16x16x32_bf16 v[216:219], a[212:215], a[164:167], v[216:219]
 v_mfma_f32_16x16x32_bf16 v[220:223], a[212:215], a[172:175], v[220:223]
 v_mfma_f32_16x16x32_bf16 v[220:223], a[208:211], a[168:171], v[220:223]
 v_mfma_f32_16x16x32_bf16 v[224:227], a[208:211], a[176:179], v[224:227]
 v_mfma_f32_16x16x32_bf16 v[224:227], a[212:215], a[180:183], v[224:227]
 v_mfma_f32_16x16x32_bf16 v[228:231], a[212:215], a[188:191], v[228:231]
 v_mfma_f32_16x16x32_bf16 v[228:231], a[208:211], a[184:187], v[228:231]
 buffer_load_dwordx4 v6, s[8:11], s30 offen lds
 s_waitcnt vmcnt(12)
 v_mfma_f32_16x16x32_bf16 a[252:255], a[216:219], a[184:187], a[252:255]
 ds_read_b128 a[184:187], v1 offset:63488
 v_mfma_f32_16x16x32_bf16 a[252:255], a[220:223], a[188:191], a[252:255]
 global_load_dwordx4 a[212:215], v0, s[70:71] offset:-3072 sc1
 ds_read_b128 a[188:191], v1 offset:64512
 v_mfma_f32_16x16x32_bf16 a[248:251], a[220:223], a[180:183], a[248:251]
 ds_read_b128 a[180:183], v1 offset:60416
 s_add_u32 m0, m0, 1024
 v_mfma_f32_16x16x32_bf16 a[248:251], a[216:219], a[176:179], a[248:251]
 global_load_dwordx4 a[208:211], v0, s[70:71] offset:-4096 sc1
 ds_read_b128 a[176:179], v1 offset:59392
 s_add_u32 s30, s30, s20
 v_mfma_f32_16x16x32_bf16 v[252:255], a[216:219], a[168:171], v[252:255]
 ds_read_b128 a[168:171], v1 offset:55296
 v_mfma_f32_16x16x32_bf16 v[252:255], a[220:223], a[172:175], v[252:255]
 ds_read_b128 a[172:175], v1 offset:56320
 buffer_load_dwordx4 v6, s[8:11], s30 offen lds
 v_mfma_f32_16x16x32_bf16 v[248:251], a[220:223], a[164:167], v[248:251]
 ds_read_b128 a[164:167], v1 offset:52224
 s_add_u32 m0, m0, 3072
 v_mfma_f32_16x16x32_bf16 v[248:251], a[216:219], a[160:163], v[248:251]
 ds_read_b128 a[160:163], v1 offset:51200
 v_mfma_f32_16x16x32_bf16 v[244:247], a[216:219], a[152:155], v[244:247]
 ds_read_b128 a[152:155], v1 offset:47104
 s_add_u32 s30, s30, s21
 v_mfma_f32_16x16x32_bf16 v[244:247], a[220:223], a[156:159], v[244:247]
 ds_read_b128 a[156:159], v1 offset:48128
 v_mfma_f32_16x16x32_bf16 v[240:243], a[220:223], a[148:151], v[240:243]
 ds_read_b128 a[148:151], v1 offset:44032
 v_mfma_f32_16x16x32_bf16 v[240:243], a[216:219], a[144:147], v[240:243]
 ds_read_b128 a[144:147], v1 offset:43008
 v_mfma_f32_16x16x32_bf16 v[236:239], a[216:219], a[136:139], v[236:239]
 ds_read_b128 a[136:139], v1 offset:38912
 v_mfma_f32_16x16x32_bf16 v[236:239], a[220:223], a[140:143], v[236:239]
 ds_read_b128 a[140:143], v1 offset:39936
 v_mfma_f32_16x16x32_bf16 v[232:235], a[220:223], a[132:135], v[232:235]
 ds_read_b128 a[132:135], v1 offset:35840
 v_mfma_f32_16x16x32_bf16 v[232:235], a[216:219], a[128:131], v[232:235]
 ds_read_b128 a[128:131], v1 offset:34816
 s_waitcnt vmcnt(13) lgkmcnt(8)
 v_mfma_f32_16x16x32_bf16 v[44:47], a[224:227], a[184:187], v[44:47]
 v_mfma_f32_16x16x32_bf16 v[44:47], a[228:231], a[188:191], v[44:47]
 global_load_dwordx4 a[220:223], v0, s[70:71] offset:-1024 sc1
 v_mfma_f32_16x16x32_bf16 v[40:43], a[228:231], a[180:183], v[40:43]
 v_mfma_f32_16x16x32_bf16 v[40:43], a[224:227], a[176:179], v[40:43]
 global_load_dwordx4 a[216:219], v0, s[70:71] offset:-2048 sc1
 v_mfma_f32_16x16x32_bf16 v[36:39], a[224:227], a[168:171], v[36:39]
 v_mfma_f32_16x16x32_bf16 v[36:39], a[228:231], a[172:175], v[36:39]
 v_mfma_f32_16x16x32_bf16 v[32:35], a[228:231], a[164:167], v[32:35]
 v_mfma_f32_16x16x32_bf16 v[32:35], a[224:227], a[160:163], v[32:35]
 s_waitcnt lgkmcnt(0)
 v_mfma_f32_16x16x32_bf16 v[28:31], a[224:227], a[152:155], v[28:31]
 v_mfma_f32_16x16x32_bf16 v[28:31], a[228:231], a[156:159], v[28:31]
 v_mfma_f32_16x16x32_bf16 v[24:27], a[228:231], a[148:151], v[24:27]
 v_mfma_f32_16x16x32_bf16 v[24:27], a[224:227], a[144:147], v[24:27]
 v_mfma_f32_16x16x32_bf16 v[20:23], a[224:227], a[136:139], v[20:23]
 v_mfma_f32_16x16x32_bf16 v[20:23], a[228:231], a[140:143], v[20:23]
 v_mfma_f32_16x16x32_bf16 v[16:19], a[228:231], a[132:135], v[16:19]
 v_mfma_f32_16x16x32_bf16 v[16:19], a[224:227], a[128:131], v[16:19]
 s_waitcnt vmcnt(11)
 v_mfma_f32_16x16x32_bf16 v[48:51], a[232:235], a[128:131], v[48:51]
 v_mfma_f32_16x16x32_bf16 v[48:51], a[236:239], a[132:135], v[48:51]
 global_load_dwordx4 a[228:231], v0, s[70:71] offset:1024 sc1
 v_mfma_f32_16x16x32_bf16 v[52:55], a[236:239], a[140:143], v[52:55]
 v_mfma_f32_16x16x32_bf16 v[52:55], a[232:235], a[136:139], v[52:55]
 global_load_dwordx4 a[224:227], v0, s[70:71] offset:0 sc1
 v_mfma_f32_16x16x32_bf16 v[56:59], a[232:235], a[144:147], v[56:59]
 v_mfma_f32_16x16x32_bf16 v[56:59], a[236:239], a[148:151], v[56:59]
 v_mfma_f32_16x16x32_bf16 v[60:63], a[236:239], a[156:159], v[60:63]
 v_mfma_f32_16x16x32_bf16 v[60:63], a[232:235], a[152:155], v[60:63]
 v_mfma_f32_16x16x32_bf16 v[64:67], a[232:235], a[160:163], v[64:67]
 v_mfma_f32_16x16x32_bf16 v[64:67], a[236:239], a[164:167], v[64:67]
 v_mfma_f32_16x16x32_bf16 v[68:71], a[236:239], a[172:175], v[68:71]
 v_mfma_f32_16x16x32_bf16 v[68:71], a[232:235], a[168:171], v[68:71]
 v_mfma_f32_16x16x32_bf16 v[72:75], a[232:235], a[176:179], v[72:75]
 v_mfma_f32_16x16x32_bf16 v[72:75], a[236:239], a[180:183], v[72:75]
 v_mfma_f32_16x16x32_bf16 v[76:79], a[236:239], a[188:191], v[76:79]
 v_mfma_f32_16x16x32_bf16 v[76:79], a[232:235], a[184:187], v[76:79]
 s_waitcnt vmcnt(10)
 v_mfma_f32_16x16x32_bf16 v[108:111], a[192:195], a[184:187], v[108:111]
 v_mfma_f32_16x16x32_bf16 v[108:111], a[196:199], a[188:191], v[108:111]
 global_load_dwordx4 a[236:239], v0, s[70:71] offset:3072 sc1
 v_mfma_f32_16x16x32_bf16 v[104:107], a[196:199], a[180:183], v[104:107]
 v_mfma_f32_16x16x32_bf16 v[104:107], a[192:195], a[176:179], v[104:107]
 global_load_dwordx4 a[232:235], v0, s[70:71] offset:2048 sc1
 v_mfma_f32_16x16x32_bf16 v[100:103], a[192:195], a[168:171], v[100:103]
 s_add_u32 s70, s70, 8192
 s_addc_u32 s71, s71, 0
 v_mfma_f32_16x16x32_bf16 v[100:103], a[196:199], a[172:175], v[100:103]
 v_mfma_f32_16x16x32_bf16 v[96:99], a[196:199], a[164:167], v[96:99]
 buffer_load_dwordx4 v6, s[8:11], s30 offen lds
 v_mfma_f32_16x16x32_bf16 v[96:99], a[192:195], a[160:163], v[96:99]
 v_mfma_f32_16x16x32_bf16 v[92:95], a[192:195], a[152:155], v[92:95]
 s_add_u32 m0, m0, 1024
 v_mfma_f32_16x16x32_bf16 v[92:95], a[196:199], a[156:159], v[92:95]
 s_add_u32 s30, s30, s20
 v_mfma_f32_16x16x32_bf16 v[88:91], a[196:199], a[148:151], v[88:91]
 v_mfma_f32_16x16x32_bf16 v[88:91], a[192:195], a[144:147], v[88:91]
 buffer_load_dwordx4 v6, s[8:11], s30 offen lds
 v_mfma_f32_16x16x32_bf16 v[84:87], a[192:195], a[136:139], v[84:87]
 s_add_u32 m0, m0, 3072
 v_mfma_f32_16x16x32_bf16 v[84:87], a[196:199], a[140:143], v[84:87]
 v_mfma_f32_16x16x32_bf16 v[80:83], a[196:199], a[132:135], v[80:83]
 s_add_u32 s30, s30, s21
 v_mfma_f32_16x16x32_bf16 v[80:83], a[192:195], a[128:131], v[80:83]
 s_waitcnt vmcnt(12)
 v_mfma_f32_16x16x32_bf16 v[112:115], a[200:203], a[128:131], v[112:115]
 v_mfma_f32_16x16x32_bf16 v[112:115], a[204:207], a[132:135], v[112:115]
 global_load_dwordx4 a[196:199], v0, s[70:71] offset:-3072 sc1
 v_mfma_f32_16x16x32_bf16 v[116:119], a[204:207], a[140:143], v[116:119]
 v_mfma_f32_16x16x32_bf16 v[116:119], a[200:203], a[136:139], v[116:119]
 global_load_dwordx4 a[192:195], v0, s[70:71] offset:-4096 sc1
 v_mfma_f32_16x16x32_bf16 v[120:123], a[200:203], a[144:147], v[120:123]
 v_mfma_f32_16x16x32_bf16 v[120:123], a[204:207], a[148:151], v[120:123]
 v_mfma_f32_16x16x32_bf16 v[124:127], a[204:207], a[156:159], v[124:127]
 v_mfma_f32_16x16x32_bf16 v[124:127], a[200:203], a[152:155], v[124:127]
 v_mfma_f32_16x16x32_bf16 v[128:131], a[200:203], a[160:163], v[128:131]
 v_mfma_f32_16x16x32_bf16 v[128:131], a[204:207], a[164:167], v[128:131]
 v_mfma_f32_16x16x32_bf16 v[132:135], a[204:207], a[172:175], v[132:135]
 v_mfma_f32_16x16x32_bf16 v[132:135], a[200:203], a[168:171], v[132:135]
 v_mfma_f32_16x16x32_bf16 a[240:243], a[200:203], a[176:179], a[240:243]
 v_mfma_f32_16x16x32_bf16 a[240:243], a[204:207], a[180:183], a[240:243]
 v_mfma_f32_16x16x32_bf16 a[244:247], a[204:207], a[188:191], a[244:247]
 v_mfma_f32_16x16x32_bf16 a[244:247], a[200:203], a[184:187], a[244:247]
 s_waitcnt vmcnt(11)
 v_mfma_f32_16x16x32_bf16 v[164:167], a[208:211], a[184:187], v[164:167]
 v_mfma_f32_16x16x32_bf16 v[164:167], a[212:215], a[188:191], v[164:167]
 global_load_dwordx4 a[204:207], v0, s[70:71] offset:-1024 sc1
 v_mfma_f32_16x16x32_bf16 v[160:163], a[212:215], a[180:183], v[160:163]
 v_mfma_f32_16x16x32_bf16 v[160:163], a[208:211], a[176:179], v[160:163]
 global_load_dwordx4 a[200:203], v0, s[70:71] offset:-2048 sc1
 v_mfma_f32_16x16x32_bf16 v[156:159], a[208:211], a[168:171], v[156:159]
 v_mfma_f32_16x16x32_bf16 v[156:159], a[212:215], a[172:175], v[156:159]
 v_mfma_f32_16x16x32_bf16 v[152:155], a[212:215], a[164:167], v[152:155]
 v_mfma_f32_16x16x32_bf16 v[152:155], a[208:211], a[160:163], v[152:155]
 v_mfma_f32_16x16x32_bf16 v[148:151], a[208:211], a[152:155], v[148:151]
 v_mfma_f32_16x16x32_bf16 v[148:151], a[212:215], a[156:159], v[148:151]
 v_mfma_f32_16x16x32_bf16 v[144:147], a[212:215], a[148:151], v[144:147]
 v_mfma_f32_16x16x32_bf16 v[144:147], a[208:211], a[144:147], v[144:147]
 v_mfma_f32_16x16x32_bf16 v[140:143], a[208:211], a[136:139], v[140:143]
 v_mfma_f32_16x16x32_bf16 v[140:143], a[212:215], a[140:143], v[140:143]
 v_mfma_f32_16x16x32_bf16 v[136:139], a[212:215], a[132:135], v[136:139]
 v_mfma_f32_16x16x32_bf16 v[136:139], a[208:211], a[128:131], v[136:139]
 s_waitcnt vmcnt(10)
 v_mfma_f32_16x16x32_bf16 v[168:171], a[216:219], a[128:131], v[168:171]
 v_mfma_f32_16x16x32_bf16 v[168:171], a[220:223], a[132:135], v[168:171]
 global_load_dwordx4 a[212:215], v0, s[70:71] offset:1024 sc1
 v_mfma_f32_16x16x32_bf16 v[172:175], a[220:223], a[140:143], v[172:175]
 v_mfma_f32_16x16x32_bf16 v[172:175], a[216:219], a[136:139], v[172:175]
 global_load_dwordx4 a[208:211], v0, s[70:71] offset:0 sc1
 v_mfma_f32_16x16x32_bf16 v[176:179], a[216:219], a[144:147], v[176:179]
 v_mfma_f32_16x16x32_bf16 v[176:179], a[220:223], a[148:151], v[176:179]
 v_mfma_f32_16x16x32_bf16 v[180:183], a[220:223], a[156:159], v[180:183]
 v_mfma_f32_16x16x32_bf16 v[180:183], a[216:219], a[152:155], v[180:183]
 v_mfma_f32_16x16x32_bf16 v[184:187], a[216:219], a[160:163], v[184:187]
 v_mfma_f32_16x16x32_bf16 v[184:187], a[220:223], a[164:167], v[184:187]
 v_mfma_f32_16x16x32_bf16 v[188:191], a[220:223], a[172:175], v[188:191]
 v_mfma_f32_16x16x32_bf16 v[188:191], a[216:219], a[168:171], v[188:191]
 v_mfma_f32_16x16x32_bf16 v[192:195], a[216:219], a[176:179], v[192:195]
 buffer_load_dwordx4 v6, s[8:11], s30 offen lds
 v_mfma_f32_16x16x32_bf16 v[192:195], a[220:223], a[180:183], v[192:195]
 s_add_u32 m0, m0, 1024
 v_mfma_f32_16x16x32_bf16 v[196:199], a[220:223], a[188:191], v[196:199]
 v_mfma_f32_16x16x32_bf16 v[196:199], a[216:219], a[184:187], v[196:199]
 s_add_u32 s30, s30, s20
 s_waitcnt vmcnt(11)
 v_mfma_f32_16x16x32_bf16 v[228:231], a[224:227], a[184:187], v[228:231]
 buffer_load_dwordx4 v6, s[8:11], s30 offen lds
 v_mfma_f32_16x16x32_bf16 v[228:231], a[228:231], a[188:191], v[228:231]
 global_load_dwordx4 a[220:223], v0, s[70:71] offset:3072 sc1
 v_mfma_f32_16x16x32_bf16 v[224:227], a[228:231], a[180:183], v[224:227]
 s_add_u32 m0, m0, 3072
 v_mfma_f32_16x16x32_bf16 v[224:227], a[224:227], a[176:179], v[224:227]
 global_load_dwordx4 a[216:219], v0, s[70:71] offset:2048 sc1
 s_add_u32 s30, s30, s21
 v_mfma_f32_16x16x32_bf16 v[220:223], a[224:227], a[168:171], v[220:223]
 s_add_u32 s70, s70, 8192
 s_addc_u32 s71, s71, 0
 v_mfma_f32_16x16x32_bf16 v[220:223], a[228:231], a[172:175], v[220:223]
 v_mfma_f32_16x16x32_bf16 v[216:219], a[228:231], a[164:167], v[216:219]
 v_mfma_f32_16x16x32_bf16 v[216:219], a[224:227], a[160:163], v[216:219]
 v_mfma_f32_16x16x32_bf16 v[212:215], a[224:227], a[152:155], v[212:215]
 v_mfma_f32_16x16x32_bf16 v[212:215], a[228:231], a[156:159], v[212:215]
 v_mfma_f32_16x16x32_bf16 v[208:211], a[228:231], a[148:151], v[208:211]
 v_mfma_f32_16x16x32_bf16 v[208:211], a[224:227], a[144:147], v[208:211]
 v_mfma_f32_16x16x32_bf16 v[204:207], a[224:227], a[136:139], v[204:207]
 v_mfma_f32_16x16x32_bf16 v[204:207], a[228:231], a[140:143], v[204:207]
 v_mfma_f32_16x16x32_bf16 v[200:203], a[228:231], a[132:135], v[200:203]
 v_mfma_f32_16x16x32_bf16 v[200:203], a[224:227], a[128:131], v[200:203]
 s_waitcnt vmcnt(12)
 v_mfma_f32_16x16x32_bf16 v[232:235], a[232:235], a[128:131], v[232:235]
 ds_read_b128 a[128:131], v2 offset:2048
 v_mfma_f32_16x16x32_bf16 v[232:235], a[236:239], a[132:135], v[232:235]
 global_load_dwordx4 a[228:231], v0, s[70:71] offset:-3072 sc1
 ds_read_b128 a[132:135], v2 offset:3072
 v_mfma_f32_16x16x32_bf16 v[236:239], a[236:239], a[140:143], v[236:239]
 ds_read_b128 a[140:143], v2 offset:7168
 v_mfma_f32_16x16x32_bf16 v[236:239], a[232:235], a[136:139], v[236:239]
 global_load_dwordx4 a[224:227], v0, s[70:71] offset:-4096 sc1
 ds_read_b128 a[136:139], v2 offset:6144
 v_mfma_f32_16x16x32_bf16 v[240:243], a[232:235], a[144:147], v[240:243]
 ds_read_b128 a[144:147], v2 offset:10240
 v_mfma_f32_16x16x32_bf16 v[240:243], a[236:239], a[148:151], v[240:243]
 ds_read_b128 a[148:151], v2 offset:11264
 v_mfma_f32_16x16x32_bf16 v[244:247], a[236:239], a[156:159], v[244:247]
 ds_read_b128 a[156:159], v2 offset:15360
 v_mfma_f32_16x16x32_bf16 v[244:247], a[232:235], a[152:155], v[244:247]
 ds_read_b128 a[152:155], v2 offset:14336
 v_mfma_f32_16x16x32_bf16 v[248:251], a[232:235], a[160:163], v[248:251]
 ds_read_b128 a[160:163], v2 offset:18432
 v_mfma_f32_16x16x32_bf16 v[248:251], a[236:239], a[164:167], v[248:251]
 ds_read_b128 a[164:167], v2 offset:19456
 v_mfma_f32_16x16x32_bf16 v[252:255], a[236:239], a[172:175], v[252:255]
 ds_read_b128 a[172:175], v2 offset:23552
 v_mfma_f32_16x16x32_bf16 v[252:255], a[232:235], a[168:171], v[252:255]
 ds_read_b128 a[168:171], v2 offset:22528
 v_mfma_f32_16x16x32_bf16 a[248:251], a[232:235], a[176:179], a[248:251]
 ds_read_b128 a[176:179], v2 offset:26624
 v_mfma_f32_16x16x32_bf16 a[248:251], a[236:239], a[180:183], a[248:251]
 ds_read_b128 a[180:183], v2 offset:27648
 v_mfma_f32_16x16x32_bf16 a[252:255], a[236:239], a[188:191], a[252:255]
 ds_read_b128 a[188:191], v2 offset:31744
 v_mfma_f32_16x16x32_bf16 a[252:255], a[232:235], a[184:187], a[252:255]
 ds_read_b128 a[184:187], v2 offset:30720
 s_waitcnt vmcnt(10) lgkmcnt(8)
 v_mfma_f32_16x16x32_bf16 v[16:19], a[192:195], a[128:131], v[16:19]
 v_mfma_f32_16x16x32_bf16 v[16:19], a[196:199], a[132:135], v[16:19]
 global_load_dwordx4 a[236:239], v0, s[70:71] offset:-1024 sc1
 v_mfma_f32_16x16x32_bf16 v[20:23], a[196:199], a[140:143], v[20:23]
 v_mfma_f32_16x16x32_bf16 v[20:23], a[192:195], a[136:139], v[20:23]
 global_load_dwordx4 a[232:235], v0, s[70:71] offset:-2048 sc1
 v_mfma_f32_16x16x32_bf16 v[24:27], a[192:195], a[144:147], v[24:27]
 v_mfma_f32_16x16x32_bf16 v[24:27], a[196:199], a[148:151], v[24:27]
 v_mfma_f32_16x16x32_bf16 v[28:31], a[196:199], a[156:159], v[28:31]
 v_mfma_f32_16x16x32_bf16 v[28:31], a[192:195], a[152:155], v[28:31]
 s_waitcnt lgkmcnt(0)
 v_mfma_f32_16x16x32_bf16 v[32:35], a[192:195], a[160:163], v[32:35]
 v_mfma_f32_16x16x32_bf16 v[32:35], a[196:199], a[164:167], v[32:35]
 v_mfma_f32_16x16x32_bf16 v[36:39], a[196:199], a[172:175], v[36:39]
 v_mfma_f32_16x16x32_bf16 v[36:39], a[192:195], a[168:171], v[36:39]
 v_mfma_f32_16x16x32_bf16 v[40:43], a[192:195], a[176:179], v[40:43]
 v_mfma_f32_16x16x32_bf16 v[40:43], a[196:199], a[180:183], v[40:43]
 v_mfma_f32_16x16x32_bf16 v[44:47], a[196:199], a[188:191], v[44:47]
 v_mfma_f32_16x16x32_bf16 v[44:47], a[192:195], a[184:187], v[44:47]
 s_waitcnt vmcnt(10)
 v_mfma_f32_16x16x32_bf16 v[76:79], a[200:203], a[184:187], v[76:79]
 v_mfma_f32_16x16x32_bf16 v[76:79], a[204:207], a[188:191], v[76:79]
 global_load_dwordx4 a[196:199], v0, s[70:71] offset:1024 sc1
 v_mfma_f32_16x16x32_bf16 v[72:75], a[204:207], a[180:183], v[72:75]
 buffer_load_dwordx4 v6, s[8:11], s30 offen lds
 v_mfma_f32_16x16x32_bf16 v[72:75], a[200:203], a[176:179], v[72:75]
 global_load_dwordx4 a[192:195], v0, s[70:71] offset:0 sc1
 s_add_u32 m0, m0, 1024
 v_mfma_f32_16x16x32_bf16 v[68:71], a[200:203], a[168:171], v[68:71]
 v_mfma_f32_16x16x32_bf16 v[68:71], a[204:207], a[172:175], v[68:71]
 s_add_u32 s30, s30, s20
 v_mfma_f32_16x16x32_bf16 v[64:67], a[204:207], a[164:167], v[64:67]
 buffer_load_dwordx4 v6, s[8:11], s30 offen lds
 v_mfma_f32_16x16x32_bf16 v[64:67], a[200:203], a[160:163], v[64:67]
 v_mfma_f32_16x16x32_bf16 v[60:63], a[200:203], a[152:155], v[60:63]
 s_add_u32 m0, m0, 3072
 v_mfma_f32_16x16x32_bf16 v[60:63], a[204:207], a[156:159], v[60:63]
 s_add_u32 s30, s30, s21
 v_mfma_f32_16x16x32_bf16 v[56:59], a[204:207], a[148:151], v[56:59]
 v_mfma_f32_16x16x32_bf16 v[56:59], a[200:203], a[144:147], v[56:59]
 v_mfma_f32_16x16x32_bf16 v[52:55], a[200:203], a[136:139], v[52:55]
 v_mfma_f32_16x16x32_bf16 v[52:55], a[204:207], a[140:143], v[52:55]
 v_mfma_f32_16x16x32_bf16 v[48:51], a[204:207], a[132:135], v[48:51]
 v_mfma_f32_16x16x32_bf16 v[48:51], a[200:203], a[128:131], v[48:51]
 s_waitcnt vmcnt(12)
 v_mfma_f32_16x16x32_bf16 v[80:83], a[208:211], a[128:131], v[80:83]
 v_mfma_f32_16x16x32_bf16 v[80:83], a[212:215], a[132:135], v[80:83]
 global_load_dwordx4 a[204:207], v0, s[70:71] offset:3072 sc1
 v_mfma_f32_16x16x32_bf16 v[84:87], a[212:215], a[140:143], v[84:87]
 v_mfma_f32_16x16x32_bf16 v[84:87], a[208:211], a[136:139], v[84:87]
 global_load_dwordx4 a[200:203], v0, s[70:71] offset:2048 sc1
 v_mfma_f32_16x16x32_bf16 v[88:91], a[208:211], a[144:147], v[88:91]
 s_add_u32 s70, s70, 8192
 s_addc_u32 s71, s71, 0
 v_mfma_f32_16x16x32_bf16 v[88:91], a[212:215], a[148:151], v[88:91]
 v_mfma_f32_16x16x32_bf16 v[92:95], a[212:215], a[156:159], v[92:95]
 v_mfma_f32_16x16x32_bf16 v[92:95], a[208:211], a[152:155], v[92:95]
 v_mfma_f32_16x16x32_bf16 v[96:99], a[208:211], a[160:163], v[96:99]
 v_mfma_f32_16x16x32_bf16 v[96:99], a[212:215], a[164:167], v[96:99]
 v_mfma_f32_16x16x32_bf16 v[100:103], a[212:215], a[172:175], v[100:103]
 v_mfma_f32_16x16x32_bf16 v[100:103], a[208:211], a[168:171], v[100:103]
 v_mfma_f32_16x16x32_bf16 v[104:107], a[208:211], a[176:179], v[104:107]
 v_mfma_f32_16x16x32_bf16 v[104:107], a[212:215], a[180:183], v[104:107]
 v_mfma_f32_16x16x32_bf16 v[108:111], a[212:215], a[188:191], v[108:111]
 v_mfma_f32_16x16x32_bf16 v[108:111], a[208:211], a[184:187], v[108:111]
 s_waitcnt vmcnt(10)
 v_mfma_f32_16x16x32_bf16 a[244:247], a[216:219], a[184:187], a[244:247]
 v_mfma_f32_16x16x32_bf16 a[244:247], a[220:223], a[188:191], a[244:247]
 global_load_dwordx4 a[212:215], v0, s[70:71] offset:-3072 sc1
 v_mfma_f32_16x16x32_bf16 a[240:243], a[220:223], a[180:183], a[240:243]
 v_mfma_f32_16x16x32_bf16 a[240:243], a[216:219], a[176:179], a[240:243]
 global_load_dwordx4 a[208:211], v0, s[70:71] offset:-4096 sc1
 v_mfma_f32_16x16x32_bf16 v[132:135], a[216:219], a[168:171], v[132:135]
 v_mfma_f32_16x16x32_bf16 v[132:135], a[220:223], a[172:175], v[132:135]
 v_mfma_f32_16x16x32_bf16 v[128:131], a[220:223], a[164:167], v[128:131]
 v_mfma_f32_16x16x32_bf16 v[128:131], a[216:219], a[160:163], v[128:131]
 v_mfma_f32_16x16x32_bf16 v[124:127], a[216:219], a[152:155], v[124:127]
 v_mfma_f32_16x16x32_bf16 v[124:127], a[220:223], a[156:159], v[124:127]
 v_mfma_f32_16x16x32_bf16 v[120:123], a[220:223], a[148:151], v[120:123]
 v_mfma_f32_16x16x32_bf16 v[120:123], a[216:219], a[144:147], v[120:123]
 v_mfma_f32_16x16x32_bf16 v[116:119], a[216:219], a[136:139], v[116:119]
 v_mfma_f32_16x16x32_bf16 v[116:119], a[220:223], a[140:143], v[116:119]
 v_mfma_f32_16x16x32_bf16 v[112:115], a[220:223], a[132:135], v[112:115]
 v_mfma_f32_16x16x32_bf16 v[112:115], a[216:219], a[128:131], v[112:115]
 s_waitcnt vmcnt(10)
 v_mfma_f32_16x16x32_bf16 v[136:139], a[224:227], a[128:131], v[136:139]
 v_mfma_f32_16x16x32_bf16 v[136:139], a[228:231], a[132:135], v[136:139]
 global_load_dwordx4 a[220:223], v0, s[70:71] offset:-1024 sc1
 v_mfma_f32_16x16x32_bf16 v[140:143], a[228:231], a[140:143], v[140:143]
 v_mfma_f32_16x16x32_bf16 v[140:143], a[224:227], a[136:139], v[140:143]
 global_load_dwordx4 a[216:219], v0, s[70:71] offset:-2048 sc1
 v_mfma_f32_16x16x32_bf16 v[144:147], a[224:227], a[144:147], v[144:147]
 v_mfma_f32_16x16x32_bf16 v[144:147], a[228:231], a[148:151], v[144:147]
 v_mfma_f32_16x16x32_bf16 v[148:151], a[228:231], a[156:159], v[148:151]
 v_mfma_f32_16x16x32_bf16 v[148:151], a[224:227], a[152:155], v[148:151]
 buffer_load_dwordx4 v6, s[8:11], s30 offen lds
 v_mfma_f32_16x16x32_bf16 v[152:155], a[224:227], a[160:163], v[152:155]
 v_mfma_f32_16x16x32_bf16 v[152:155], a[228:231], a[164:167], v[152:155]
 s_add_u32 m0, m0, 1024
 v_mfma_f32_16x16x32_bf16 v[156:159], a[228:231], a[172:175], v[156:159]
 s_add_u32 s30, s30, s20
 v_mfma_f32_16x16x32_bf16 v[156:159], a[224:227], a[168:171], v[156:159]
 v_mfma_f32_16x16x32_bf16 v[160:163], a[224:227], a[176:179], v[160:163]
 buffer_load_dwordx4 v6, s[8:11], s30 offen lds
 v_mfma_f32_16x16x32_bf16 v[160:163], a[228:231], a[180:183], v[160:163]
 s_add_u32 m0, m0, 3072
 v_mfma_f32_16x16x32_bf16 v[164:167], a[228:231], a[188:191], v[164:167]
 v_mfma_f32_16x16x32_bf16 v[164:167], a[224:227], a[184:187], v[164:167]
 s_add_u32 s30, s30, s21
 s_waitcnt vmcnt(12)
 v_mfma_f32_16x16x32_bf16 v[196:199], a[232:235], a[184:187], v[196:199]
 v_mfma_f32_16x16x32_bf16 v[196:199], a[236:239], a[188:191], v[196:199]
 global_load_dwordx4 a[228:231], v0, s[70:71] offset:1024 sc1
 v_mfma_f32_16x16x32_bf16 v[192:195], a[236:239], a[180:183], v[192:195]
 v_mfma_f32_16x16x32_bf16 v[192:195], a[232:235], a[176:179], v[192:195]
 global_load_dwordx4 a[224:227], v0, s[70:71] offset:0 sc1
 v_mfma_f32_16x16x32_bf16 v[188:191], a[232:235], a[168:171], v[188:191]
 v_mfma_f32_16x16x32_bf16 v[188:191], a[236:239], a[172:175], v[188:191]
 v_mfma_f32_16x16x32_bf16 v[184:187], a[236:239], a[164:167], v[184:187]
 v_mfma_f32_16x16x32_bf16 v[184:187], a[232:235], a[160:163], v[184:187]
 v_mfma_f32_16x16x32_bf16 v[180:183], a[232:235], a[152:155], v[180:183]
 v_mfma_f32_16x16x32_bf16 v[180:183], a[236:239], a[156:159], v[180:183]
 v_mfma_f32_16x16x32_bf16 v[176:179], a[236:239], a[148:151], v[176:179]
 v_mfma_f32_16x16x32_bf16 v[176:179], a[232:235], a[144:147], v[176:179]
 v_mfma_f32_16x16x32_bf16 v[172:175], a[232:235], a[136:139], v[172:175]
 v_mfma_f32_16x16x32_bf16 v[172:175], a[236:239], a[140:143], v[172:175]
 v_mfma_f32_16x16x32_bf16 v[168:171], a[236:239], a[132:135], v[168:171]
 v_mfma_f32_16x16x32_bf16 v[168:171], a[232:235], a[128:131], v[168:171]
 s_waitcnt vmcnt(11)
 v_mfma_f32_16x16x32_bf16 v[200:203], a[192:195], a[128:131], v[200:203]
 v_mfma_f32_16x16x32_bf16 v[200:203], a[196:199], a[132:135], v[200:203]
 global_load_dwordx4 a[236:239], v0, s[70:71] offset:3072 sc1
 v_mfma_f32_16x16x32_bf16 v[204:207], a[196:199], a[140:143], v[204:207]
 v_mfma_f32_16x16x32_bf16 v[204:207], a[192:195], a[136:139], v[204:207]
 global_load_dwordx4 a[232:235], v0, s[70:71] offset:2048 sc1
 v_mfma_f32_16x16x32_bf16 v[208:211], a[192:195], a[144:147], v[208:211]
 s_add_u32 s70, s70, 8192
 s_addc_u32 s71, s71, 0
 v_mfma_f32_16x16x32_bf16 v[208:211], a[196:199], a[148:151], v[208:211]
 v_mfma_f32_16x16x32_bf16 v[212:215], a[196:199], a[156:159], v[212:215]
 v_mfma_f32_16x16x32_bf16 v[212:215], a[192:195], a[152:155], v[212:215]
 v_mfma_f32_16x16x32_bf16 v[216:219], a[192:195], a[160:163], v[216:219]
 v_mfma_f32_16x16x32_bf16 v[216:219], a[196:199], a[164:167], v[216:219]
 v_mfma_f32_16x16x32_bf16 v[220:223], a[196:199], a[172:175], v[220:223]
 v_mfma_f32_16x16x32_bf16 v[220:223], a[192:195], a[168:171], v[220:223]
 v_mfma_f32_16x16x32_bf16 v[224:227], a[192:195], a[176:179], v[224:227]
 v_mfma_f32_16x16x32_bf16 v[224:227], a[196:199], a[180:183], v[224:227]
 v_mfma_f32_16x16x32_bf16 v[228:231], a[196:199], a[188:191], v[228:231]
 v_mfma_f32_16x16x32_bf16 v[228:231], a[192:195], a[184:187], v[228:231]
 s_waitcnt vmcnt(10)
 v_mfma_f32_16x16x32_bf16 a[252:255], a[200:203], a[184:187], a[252:255]
 ds_read_b128 a[184:187], v2 offset:63488
 v_mfma_f32_16x16x32_bf16 a[252:255], a[204:207], a[188:191], a[252:255]
 global_load_dwordx4 a[196:199], v0, s[70:71] offset:-3072 sc1
 ds_read_b128 a[188:191], v2 offset:64512
 v_mfma_f32_16x16x32_bf16 a[248:251], a[204:207], a[180:183], a[248:251]
 ds_read_b128 a[180:183], v2 offset:60416
 v_mfma_f32_16x16x32_bf16 a[248:251], a[200:203], a[176:179], a[248:251]
 global_load_dwordx4 a[192:195], v0, s[70:71] offset:-4096 sc1
 ds_read_b128 a[176:179], v2 offset:59392
 v_mfma_f32_16x16x32_bf16 v[252:255], a[200:203], a[168:171], v[252:255]
 ds_read_b128 a[168:171], v2 offset:55296
 v_mfma_f32_16x16x32_bf16 v[252:255], a[204:207], a[172:175], v[252:255]
 ds_read_b128 a[172:175], v2 offset:56320
 v_mfma_f32_16x16x32_bf16 v[248:251], a[204:207], a[164:167], v[248:251]
 ds_read_b128 a[164:167], v2 offset:52224
 v_mfma_f32_16x16x32_bf16 v[248:251], a[200:203], a[160:163], v[248:251]
 ds_read_b128 a[160:163], v2 offset:51200
 v_mfma_f32_16x16x32_bf16 v[244:247], a[200:203], a[152:155], v[244:247]
 ds_read_b128 a[152:155], v2 offset:47104
 v_mfma_f32_16x16x32_bf16 v[244:247], a[204:207], a[156:159], v[244:247]
 ds_read_b128 a[156:159], v2 offset:48128
 v_mfma_f32_16x16x32_bf16 v[240:243], a[204:207], a[148:151], v[240:243]
 ds_read_b128 a[148:151], v2 offset:44032
 v_mfma_f32_16x16x32_bf16 v[240:243], a[200:203], a[144:147], v[240:243]
 ds_read_b128 a[144:147], v2 offset:43008
 v_mfma_f32_16x16x32_bf16 v[236:239], a[200:203], a[136:139], v[236:239]
 ds_read_b128 a[136:139], v2 offset:38912
 v_mfma_f32_16x16x32_bf16 v[236:239], a[204:207], a[140:143], v[236:239]
 ds_read_b128 a[140:143], v2 offset:39936
 v_mfma_f32_16x16x32_bf16 v[232:235], a[204:207], a[132:135], v[232:235]
 ds_read_b128 a[132:135], v2 offset:35840
 v_mfma_f32_16x16x32_bf16 v[232:235], a[200:203], a[128:131], v[232:235]
 ds_read_b128 a[128:131], v2 offset:34816
 s_waitcnt vmcnt(10) lgkmcnt(8)
 v_mfma_f32_16x16x32_bf16 v[44:47], a[208:211], a[184:187], v[44:47]
 buffer_load_dwordx4 v6, s[8:11], s30 offen lds
 s_add_u32 m0, m0, 1024
 v_mfma_f32_16x16x32_bf16 v[44:47], a[212:215], a[188:191], v[44:47]
 global_load_dwordx4 a[204:207], v0, s[70:71] offset:-1024 sc1
 s_add_u32 s30, s30, s20
 v_mfma_f32_16x16x32_bf16 v[40:43], a[212:215], a[180:183], v[40:43]
 buffer_load_dword v4, off, s[64:67], 0 sc1
 v_mfma_f32_16x16x32_bf16 v[40:43], a[208:211], a[176:179], v[40:43]
 global_load_dwordx4 a[200:203], v0, s[70:71] offset:-2048 sc1
 v_mfma_f32_16x16x32_bf16 v[36:39], a[208:211], a[168:171], v[36:39]
 buffer_load_dwordx4 v6, s[8:11], s30 offen lds
 s_add_u32 m0, m0, 3072
 v_mfma_f32_16x16x32_bf16 v[36:39], a[212:215], a[172:175], v[36:39]
 s_add_u32 s30, s30, s22
 v_mfma_f32_16x16x32_bf16 v[32:35], a[212:215], a[164:167], v[32:35]
 v_mfma_f32_16x16x32_bf16 v[32:35], a[208:211], a[160:163], v[32:35]
 s_waitcnt lgkmcnt(0)
 v_mfma_f32_16x16x32_bf16 v[28:31], a[208:211], a[152:155], v[28:31]
 v_mfma_f32_16x16x32_bf16 v[28:31], a[212:215], a[156:159], v[28:31]
 v_mfma_f32_16x16x32_bf16 v[24:27], a[212:215], a[148:151], v[24:27]
 v_mfma_f32_16x16x32_bf16 v[24:27], a[208:211], a[144:147], v[24:27]
 v_mfma_f32_16x16x32_bf16 v[20:23], a[208:211], a[136:139], v[20:23]
 v_mfma_f32_16x16x32_bf16 v[20:23], a[212:215], a[140:143], v[20:23]
 v_mfma_f32_16x16x32_bf16 v[16:19], a[212:215], a[132:135], v[16:19]
 v_mfma_f32_16x16x32_bf16 v[16:19], a[208:211], a[128:131], v[16:19]
 s_waitcnt vmcnt(13)
 v_mfma_f32_16x16x32_bf16 v[48:51], a[216:219], a[128:131], v[48:51]
 v_lshrrev_b32 v5, 6, v1
 v_mfma_f32_16x16x32_bf16 v[48:51], a[220:223], a[132:135], v[48:51]
 global_load_dwordx4 a[212:215], v0, s[70:71] offset:1024 sc1
 v_mfma_f32_16x16x32_bf16 v[52:55], a[220:223], a[140:143], v[52:55]
 v_and_b32 v6, 48, v1
 v_mfma_f32_16x16x32_bf16 v[52:55], a[216:219], a[136:139], v[52:55]
 global_load_dwordx4 a[208:211], v0, s[70:71] offset:0 sc1
 v_lshl_add_u32 v5, v5, 11, v6
 v_mfma_f32_16x16x32_bf16 v[56:59], a[216:219], a[144:147], v[56:59]
 v_mfma_f32_16x16x32_bf16 v[56:59], a[220:223], a[148:151], v[56:59]
 s_mov_b32 m0, s52
 v_mfma_f32_16x16x32_bf16 v[60:63], a[220:223], a[156:159], v[60:63]
 s_add_u32 s3, s48, 31744
 v_mfma_f32_16x16x32_bf16 v[60:63], a[216:219], a[152:155], v[60:63]
 v_mfma_f32_16x16x32_bf16 v[64:67], a[216:219], a[160:163], v[64:67]
 buffer_load_dwordx4 v5, s[40:43], s48 offen lds
 v_mfma_f32_16x16x32_bf16 v[64:67], a[220:223], a[164:167], v[64:67]
 buffer_load_dwordx4 v5, s[40:43], s3 offen offset:1024 lds
 v_mfma_f32_16x16x32_bf16 v[68:71], a[220:223], a[172:175], v[68:71]
 v_mfma_f32_16x16x32_bf16 v[68:71], a[216:219], a[168:171], v[68:71]
 s_add_u32 s48, s48, 2097152
 v_mfma_f32_16x16x32_bf16 v[72:75], a[216:219], a[176:179], v[72:75]
 v_mfma_f32_16x16x32_bf16 v[72:75], a[220:223], a[180:183], v[72:75]
 v_mfma_f32_16x16x32_bf16 v[76:79], a[220:223], a[188:191], v[76:79]
 v_mfma_f32_16x16x32_bf16 v[76:79], a[216:219], a[184:187], v[76:79]
 s_waitcnt vmcnt(13)
 v_mfma_f32_16x16x32_bf16 v[108:111], a[224:227], a[184:187], v[108:111]
 v_mfma_f32_16x16x32_bf16 v[108:111], a[228:231], a[188:191], v[108:111]
 global_load_dwordx4 a[220:223], v0, s[70:71] offset:3072 sc1
 v_mfma_f32_16x16x32_bf16 v[104:107], a[228:231], a[180:183], v[104:107]
 v_mfma_f32_16x16x32_bf16 v[104:107], a[224:227], a[176:179], v[104:107]
 global_load_dwordx4 a[216:219], v0, s[70:71] offset:2048 sc1
 v_mfma_f32_16x16x32_bf16 v[100:103], a[224:227], a[168:171], v[100:103]
 s_add_u32 s70, s70, 8192
 s_addc_u32 s71, s71, 0
 v_mfma_f32_16x16x32_bf16 v[100:103], a[228:231], a[172:175], v[100:103]
 v_mfma_f32_16x16x32_bf16 v[96:99], a[228:231], a[164:167], v[96:99]
 v_mfma_f32_16x16x32_bf16 v[96:99], a[224:227], a[160:163], v[96:99]
 v_mfma_f32_16x16x32_bf16 v[92:95], a[224:227], a[152:155], v[92:95]
 v_mfma_f32_16x16x32_bf16 v[92:95], a[228:231], a[156:159], v[92:95]
 v_mfma_f32_16x16x32_bf16 v[88:91], a[228:231], a[148:151], v[88:91]
 v_mfma_f32_16x16x32_bf16 v[88:91], a[224:227], a[144:147], v[88:91]
 v_mfma_f32_16x16x32_bf16 v[84:87], a[224:227], a[136:139], v[84:87]
 v_mfma_f32_16x16x32_bf16 v[84:87], a[228:231], a[140:143], v[84:87]
 v_mfma_f32_16x16x32_bf16 v[80:83], a[228:231], a[132:135], v[80:83]
 v_mfma_f32_16x16x32_bf16 v[80:83], a[224:227], a[128:131], v[80:83]
 s_waitcnt vmcnt(13)
 v_mfma_f32_16x16x32_bf16 v[112:115], a[232:235], a[128:131], v[112:115]
 v_mfma_f32_16x16x32_bf16 v[112:115], a[236:239], a[132:135], v[112:115]
 global_load_dwordx4 a[228:231], v0, s[70:71] offset:-3072 sc1
 v_mfma_f32_16x16x32_bf16 v[116:119], a[236:239], a[140:143], v[116:119]
 v_mfma_f32_16x16x32_bf16 v[116:119], a[232:235], a[136:139], v[116:119]
 global_load_dwordx4 a[224:227], v0, s[70:71] offset:-4096 sc1
 v_mfma_f32_16x16x32_bf16 v[120:123], a[232:235], a[144:147], v[120:123]
 v_mfma_f32_16x16x32_bf16 v[120:123], a[236:239], a[148:151], v[120:123]
 v_mfma_f32_16x16x32_bf16 v[124:127], a[236:239], a[156:159], v[124:127]
 v_mfma_f32_16x16x32_bf16 v[124:127], a[232:235], a[152:155], v[124:127]
 v_mfma_f32_16x16x32_bf16 v[128:131], a[232:235], a[160:163], v[128:131]
 v_mfma_f32_16x16x32_bf16 v[128:131], a[236:239], a[164:167], v[128:131]
 v_mfma_f32_16x16x32_bf16 v[132:135], a[236:239], a[172:175], v[132:135]
 v_mfma_f32_16x16x32_bf16 v[132:135], a[232:235], a[168:171], v[132:135]
 v_mfma_f32_16x16x32_bf16 a[240:243], a[232:235], a[176:179], a[240:243]
 v_mfma_f32_16x16x32_bf16 a[240:243], a[236:239], a[180:183], a[240:243]
 v_mfma_f32_16x16x32_bf16 a[244:247], a[236:239], a[188:191], a[244:247]
 v_mfma_f32_16x16x32_bf16 a[244:247], a[232:235], a[184:187], a[244:247]
 s_waitcnt vmcnt(13)
 v_mfma_f32_16x16x32_bf16 v[164:167], a[192:195], a[184:187], v[164:167]
 v_mfma_f32_16x16x32_bf16 v[164:167], a[196:199], a[188:191], v[164:167]
 global_load_dwordx4 a[236:239], v0, s[70:71] offset:-1024 sc1
 v_mfma_f32_16x16x32_bf16 v[160:163], a[196:199], a[180:183], v[160:163]
 v_mfma_f32_16x16x32_bf16 v[160:163], a[192:195], a[176:179], v[160:163]
 global_load_dwordx4 a[232:235], v0, s[70:71] offset:-2048 sc1
 v_mfma_f32_16x16x32_bf16 v[156:159], a[192:195], a[168:171], v[156:159]
 v_mfma_f32_16x16x32_bf16 v[156:159], a[196:199], a[172:175], v[156:159]
 v_mfma_f32_16x16x32_bf16 v[152:155], a[196:199], a[164:167], v[152:155]
 v_mfma_f32_16x16x32_bf16 v[152:155], a[192:195], a[160:163], v[152:155]
 v_mfma_f32_16x16x32_bf16 v[148:151], a[192:195], a[152:155], v[148:151]
 v_mfma_f32_16x16x32_bf16 v[148:151], a[196:199], a[156:159], v[148:151]
 v_mfma_f32_16x16x32_bf16 v[144:147], a[196:199], a[148:151], v[144:147]
 v_mfma_f32_16x16x32_bf16 v[144:147], a[192:195], a[144:147], v[144:147]
 v_mfma_f32_16x16x32_bf16 v[140:143], a[192:195], a[136:139], v[140:143]
 v_mfma_f32_16x16x32_bf16 v[140:143], a[196:199], a[140:143], v[140:143]
 v_mfma_f32_16x16x32_bf16 v[136:139], a[196:199], a[132:135], v[136:139]
 v_mfma_f32_16x16x32_bf16 v[136:139], a[192:195], a[128:131], v[136:139]
 s_waitcnt vmcnt(11)
 v_mfma_f32_16x16x32_bf16 v[168:171], a[200:203], a[128:131], v[168:171]
 v_mfma_f32_16x16x32_bf16 v[168:171], a[204:207], a[132:135], v[168:171]
 global_load_dwordx4 a[196:199], v0, s[70:71] offset:1024 sc1
 v_mfma_f32_16x16x32_bf16 v[172:175], a[204:207], a[140:143], v[172:175]
 v_mfma_f32_16x16x32_bf16 v[172:175], a[200:203], a[136:139], v[172:175]
 global_load_dwordx4 a[192:195], v0, s[70:71] offset:0 sc1
 v_mfma_f32_16x16x32_bf16 v[176:179], a[200:203], a[144:147], v[176:179]
 v_mfma_f32_16x16x32_bf16 v[176:179], a[204:207], a[148:151], v[176:179]
 v_mfma_f32_16x16x32_bf16 v[180:183], a[204:207], a[156:159], v[180:183]
 v_mfma_f32_16x16x32_bf16 v[180:183], a[200:203], a[152:155], v[180:183]
 v_mfma_f32_16x16x32_bf16 v[184:187], a[200:203], a[160:163], v[184:187]
 v_mfma_f32_16x16x32_bf16 v[184:187], a[204:207], a[164:167], v[184:187]
 v_mfma_f32_16x16x32_bf16 v[188:191], a[204:207], a[172:175], v[188:191]
 v_mfma_f32_16x16x32_bf16 v[188:191], a[200:203], a[168:171], v[188:191]
 v_mfma_f32_16x16x32_bf16 v[192:195], a[200:203], a[176:179], v[192:195]
 v_mfma_f32_16x16x32_bf16 v[192:195], a[204:207], a[180:183], v[192:195]
 v_mfma_f32_16x16x32_bf16 v[196:199], a[204:207], a[188:191], v[196:199]
 v_mfma_f32_16x16x32_bf16 v[196:199], a[200:203], a[184:187], v[196:199]
 s_waitcnt vmcnt(10)
 v_mfma_f32_16x16x32_bf16 v[228:231], a[208:211], a[184:187], v[228:231]
 v_mfma_f32_16x16x32_bf16 v[228:231], a[212:215], a[188:191], v[228:231]
 global_load_dwordx4 a[204:207], v0, s[70:71] offset:3072 sc1
 v_mfma_f32_16x16x32_bf16 v[224:227], a[212:215], a[180:183], v[224:227]
 v_mfma_f32_16x16x32_bf16 v[224:227], a[208:211], a[176:179], v[224:227]
 global_load_dwordx4 a[200:203], v0, s[70:71] offset:2048 sc1
 v_mfma_f32_16x16x32_bf16 v[220:223], a[208:211], a[168:171], v[220:223]
 s_add_u32 s70, s70, 8192
 s_addc_u32 s71, s71, 0
 v_mfma_f32_16x16x32_bf16 v[220:223], a[212:215], a[172:175], v[220:223]
 v_mfma_f32_16x16x32_bf16 v[216:219], a[212:215], a[164:167], v[216:219]
 v_mfma_f32_16x16x32_bf16 v[216:219], a[208:211], a[160:163], v[216:219]
 v_mfma_f32_16x16x32_bf16 v[212:215], a[208:211], a[152:155], v[212:215]
 v_mfma_f32_16x16x32_bf16 v[212:215], a[212:215], a[156:159], v[212:215]
 v_mfma_f32_16x16x32_bf16 v[208:211], a[212:215], a[148:151], v[208:211]
 v_cmp_gt_i32 vcc, s55, v4
 s_cbranch_vccnz Lspin_pb
Lok_pb:
 s_add_u32 s55, s55, 1
 s_waitcnt lgkmcnt(0)
 s_barrier
 v_mfma_f32_16x16x32_bf16 v[208:211], a[208:211], a[144:147], v[208:211]
 v_mfma_f32_16x16x32_bf16 v[204:207], a[208:211], a[136:139], v[204:207]
 v_mfma_f32_16x16x32_bf16 v[204:207], a[212:215], a[140:143], v[204:207]
 v_mfma_f32_16x16x32_bf16 v[200:203], a[212:215], a[132:135], v[200:203]
 v_mfma_f32_16x16x32_bf16 v[200:203], a[208:211], a[128:131], v[200:203]
 s_waitcnt vmcnt(8)
 v_mfma_f32_16x16x32_bf16 v[232:235], a[216:219], a[128:131], v[232:235]
 ds_read_b128 a[128:131], v1
 v_mfma_f32_16x16x32_bf16 v[232:235], a[220:223], a[132:135], v[232:235]
 global_load_dwordx4 a[212:215], v0, s[70:71] offset:-3072 sc1
 ds_read_b128 a[132:135], v1 offset:1024
 v_mfma_f32_16x16x32_bf16 v[236:239], a[220:223], a[140:143], v[236:239]
 ds_read_b128 a[140:143], v1 offset:5120
 v_mfma_f32_16x16x32_bf16 v[236:239], a[216:219], a[136:139], v[236:239]
 global_load_dwordx4 a[208:211], v0, s[70:71] offset:-4096 sc1
 ds_read_b128 a[136:139], v1 offset:4096
 v_mfma_f32_16x16x32_bf16 v[240:243], a[216:219], a[144:147], v[240:243]
 ds_read_b128 a[144:147], v1 offset:8192
 v_mfma_f32_16x16x32_bf16 v[240:243], a[220:223], a[148:151], v[240:243]
 ds_read_b128 a[148:151], v1 offset:9216
 v_mfma_f32_16x16x32_bf16 v[244:247], a[220:223], a[156:159], v[244:247]
 ds_read_b128 a[156:159], v1 offset:13312
 v_mfma_f32_16x16x32_bf16 v[244:247], a[216:219], a[152:155], v[244:247]
 ds_read_b128 a[152:155], v1 offset:12288
 v_mfma_f32_16x16x32_bf16 v[248:251], a[216:219], a[160:163], v[248:251]
 ds_read_b128 a[160:163], v1 offset:16384
 v_mfma_f32_16x16x32_bf16 v[248:251], a[220:223], a[164:167], v[248:251]
 ds_read_b128 a[164:167], v1 offset:17408
 v_mfma_f32_16x16x32_bf16 v[252:255], a[220:223], a[172:175], v[252:255]
 ds_read_b128 a[172:175], v1 offset:21504
 v_mfma_f32_16x16x32_bf16 v[252:255], a[216:219], a[168:171], v[252:255]
 ds_read_b128 a[168:171], v1 offset:20480
 v_mfma_f32_16x16x32_bf16 a[248:251], a[216:219], a[176:179], a[248:251]
 ds_read_b128 a[176:179], v1 offset:24576
 v_mfma_f32_16x16x32_bf16 a[248:251], a[220:223], a[180:183], a[248:251]
 ds_read_b128 a[180:183], v1 offset:25600
 v_mfma_f32_16x16x32_bf16 a[252:255], a[220:223], a[188:191], a[252:255]
 global_load_dwordx4 a[220:223], v0, s[70:71] offset:-1024 sc1
 ds_read_b128 a[188:191], v1 offset:29696
 v_mfma_f32_16x16x32_bf16 a[252:255], a[216:219], a[184:187], a[252:255]
 global_load_dwordx4 a[216:219], v0, s[70:71] offset:-2048 sc1
 ds_read_b128 a[184:187], v1 offset:28672
 s_waitcnt vmcnt(10) lgkmcnt(8)
 v_mfma_f32_16x16x32_bf16 v[16:19], a[224:227], a[128:131], v[16:19]
 v_mov_b32 v6, v3
 s_cmp_eq_u32 s25, 0
 s_cbranch_scc1 Lgat1
Lgatr1:
 v_mfma_f32_16x16x32_bf16 v[16:19], a[228:231], a[132:135], v[16:19]
 v_mfma_f32_16x16x32_bf16 v[20:23], a[228:231], a[140:143], v[20:23]
 s_add_u32 m0, s50, 2048
 v_mfma_f32_16x16x32_bf16 v[20:23], a[224:227], a[136:139], v[20:23]
 v_mfma_f32_16x16x32_bf16 v[24:27], a[224:227], a[144:147], v[24:27]
 v_mfma_f32_16x16x32_bf16 v[24:27], a[228:231], a[148:151], v[24:27]
 buffer_load_dwordx4 v6, s[8:11], s30 offen lds
 v_mfma_f32_16x16x32_bf16 v[28:31], a[228:231], a[156:159], v[28:31]
 s_add_u32 m0, m0, 1024
 v_mfma_f32_16x16x32_bf16 v[28:31], a[224:227], a[152:155], v[28:31]
 s_waitcnt lgkmcnt(0)
 v_mfma_f32_16x16x32_bf16 v[32:35], a[224:227], a[160:163], v[32:35]
 s_add_u32 s30, s30, s20
 v_mfma_f32_16x16x32_bf16 v[32:35], a[228:231], a[164:167], v[32:35]
 buffer_load_dwordx4 v6, s[8:11], s30 offen lds
 v_mfma_f32_16x16x32_bf16 v[36:39], a[228:231], a[172:175], v[36:39]
 v_mfma_f32_16x16x32_bf16 v[36:39], a[224:227], a[168:171], v[36:39]
 s_add_u32 m0, m0, 3072
 v_mfma_f32_16x16x32_bf16 v[40:43], a[224:227], a[176:179], v[40:43]
 v_mfma_f32_16x16x32_bf16 v[40:43], a[228:231], a[180:183], v[40:43]
 s_add_u32 s30, s30, s21
 v_mfma_f32_16x16x32_bf16 v[44:47], a[228:231], a[188:191], v[44:47]
 v_mfma_f32_16x16x32_bf16 v[44:47], a[224:227], a[184:187], v[44:47]
 s_waitcnt vmcnt(10)
 v_mfma_f32_16x16x32_bf16 v[76:79], a[232:235], a[184:187], v[76:79]
 v_mfma_f32_16x16x32_bf16 v[76:79], a[236:239], a[188:191], v[76:79]
 global_load_dwordx4 a[228:231], v0, s[70:71] offset:1024 sc1
 v_mfma_f32_16x16x32_bf16 v[72:75], a[236:239], a[180:183], v[72:75]
 v_mfma_f32_16x16x32_bf16 v[72:75], a[232:235], a[176:179], v[72:75]
 global_load_dwordx4 a[224:227], v0, s[70:71] offset:0 sc1
 v_mfma_f32_16x16x32_bf16 v[68:71], a[232:235], a[168:171], v[68:71]
 v_mfma_f32_16x16x32_bf16 v[68:71], a[236:239], a[172:175], v[68:71]
 v_mfma_f32_16x16x32_bf16 v[64:67], a[236:239], a[164:167], v[64:67]
 v_mfma_f32_16x16x32_bf16 v[64:67], a[232:235], a[160:163], v[64:67]
 v_mfma_f32_16x16x32_bf16 v[60:63], a[232:235], a[152:155], v[60:63]
 v_mfma_f32_16x16x32_bf16 v[60:63], a[236:239], a[156:159], v[60:63]
 v_mfma_f32_16x16x32_bf16 v[56:59], a[236:239], a[148:151], v[56:59]
 v_mfma_f32_16x16x32_bf16 v[56:59], a[232:235], a[144:147], v[56:59]
 v_mfma_f32_16x16x32_bf16 v[52:55], a[232:235], a[136:139], v[52:55]
 v_mfma_f32_16x16x32_bf16 v[52:55], a[236:239], a[140:143], v[52:55]
 v_mfma_f32_16x16x32_bf16 v[48:51], a[236:239], a[132:135], v[48:51]
 v_mfma_f32_16x16x32_bf16 v[48:51], a[232:235], a[128:131], v[48:51]
 s_waitcnt vmcnt(10)
 v_mfma_f32_16x16x32_bf16 v[80:83], a[192:195], a[128:131], v[80:83]
 v_mfma_f32_16x16x32_bf16 v[80:83], a[196:199], a[132:135], v[80:83]
 global_load_dwordx4 a[236:239], v0, s[70:71] offset:3072 sc1
 v_mfma_f32_16x16x32_bf16 v[84:87], a[196:199], a[140:143], v[84:87]
 v_mfma_f32_16x16x32_bf16 v[84:87], a[192:195], a[136:139], v[84:87]
 global_load_dwordx4 a[232:235], v0, s[70:71] offset:2048 sc1
 v_mfma_f32_16x16x32_bf16 v[88:91], a[192:195], a[144:147], v[88:91]
 s_add_u32 s70, s70, 8192
 s_addc_u32 s71, s71, 0
 v_mfma_f32_16x16x32_bf16 v[88:91], a[196:199], a[148:151], v[88:91]
 v_mfma_f32_16x16x32_bf16 v[92:95], a[196:199], a[156:159], v[92:95]
 v_mfma_f32_16x16x32_bf16 v[92:95], a[192:195], a[152:155], v[92:95]
 v_mfma_f32_16x16x32_bf16 v[96:99], a[192:195], a[160:163], v[96:99]
 v_mfma_f32_16x16x32_bf16 v[96:99], a[196:199], a[164:167], v[96:99]
 v_mfma_f32_16x16x32_bf16 v[100:103], a[196:199], a[172:175], v[100:103]
 v_mfma_f32_16x16x32_bf16 v[100:103], a[192:195], a[168:171], v[100:103]
 v_mfma_f32_16x16x32_bf16 v[104:107], a[192:195], a[176:179], v[104:107]
 v_mfma_f32_16x16x32_bf16 v[104:107], a[196:199], a[180:183], v[104:107]
 v_mfma_f32_16x16x32_bf16 v[108:111], a[196:199], a[188:191], v[108:111]
 v_mfma_f32_16x16x32_bf16 v[108:111], a[192:195], a[184:187], v[108:111]
 s_waitcnt vmcnt(10)
 v_mfma_f32_16x16x32_bf16 a[244:247], a[200:203], a[184:187], a[244:247]
 v_mfma_f32_16x16x32_bf16 a[244:247], a[204:207], a[188:191], a[244:247]
 global_load_dwordx4 a[196:199], v0, s[70:71] offset:-3072 sc1
 v_mfma_f32_16x16x32_bf16 a[240:243], a[204:207], a[180:183], a[240:243]
 v_mfma_f32_16x16x32_bf16 a[240:243], a[200:203], a[176:179], a[240:243]
 global_load_dwordx4 a[192:195], v0, s[70:71] offset:-4096 sc1
 v_mfma_f32_16x16x32_bf16 v[132:135], a[200:203], a[168:171], v[132:135]
 v_mfma_f32_16x16x32_bf16 v[132:135], a[204:207], a[172:175], v[132:135]
 v_mfma_f32_16x16x32_bf16 v[128:131], a[204:207], a[164:167], v[128:131]
 v_mfma_f32_16x16x32_bf16 v[128:131], a[200:203], a[160:163], v[128:131]
 v_mfma_f32_16x16x32_bf16 v[124:127], a[200:203], a[152:155], v[124:127]
 v_mfma_f32_16x16x32_bf16 v[124:127], a[204:207], a[156:159], v[124:127]
 v_mfma_f32_16x16x32_bf16 v[120:123], a[204:207], a[148:151], v[120:123]
 v_mfma_f32_16x16x32_bf16 v[120:123], a[200:203], a[144:147], v[120:123]
 v_mfma_f32_16x16x32_bf16 v[116:119], a[200:203], a[136:139], v[116:119]
 buffer_load_dwordx4 v6, s[8:11], s30 offen lds
 v_mfma_f32_16x16x32_bf16 v[116:119], a[204:207], a[140:143], v[116:119]
 v_mfma_f32_16x16x32_bf16 v[112:115], a[204:207], a[132:135], v[112:115]
 s_add_u32 m0, m0, 1024
 v_mfma_f32_16x16x32_bf16 v[112:115], a[200:203], a[128:131], v[112:115]
 s_add_u32 s30, s30, s20
 s_waitcnt vmcnt(11)
 v_mfma_f32_16x16x32_bf16 v[136:139], a[208:211], a[128:131], v[136:139]
 buffer_load_dwordx4 v6, s[8:11], s30 offen lds
 v_mfma_f32_16x16x32_bf16 v[136:139], a[212:215], a[132:135], v[136:139]
 global_load_dwordx4 a[204:207], v0, s[70:71] offset:-1024 sc1
 v_mfma_f32_16x16x32_bf16 v[140:143], a[212:215], a[140:143], v[140:143]
 s_add_u32 m0, m0, 3072
 v_mfma_f32_16x16x32_bf16 v[140:143], a[208:211], a[136:139], v[140:143]
 global_load_dwordx4 a[200:203], v0, s[70:71] offset:-2048 sc1
 v_mfma_f32_16x16x32_bf16 v[144:147], a[208:211], a[144:147], v[144:147]
 s_add_u32 s30, s30, s21
 v_mfma_f32_16x16x32_bf16 v[144:147], a[212:215], a[148:151], v[144:147]
 v_mfma_f32_16x16x32_bf16 v[148:151], a[212:215], a[156:159], v[148:151]
 v_mfma_f32_16x16x32_bf16 v[148:151], a[208:211], a[152:155], v[148:151]
 v_mfma_f32_16x16x32_bf16 v[152:155], a[208:211], a[160:163], v[152:155]
 v_mfma_f32_16x16x32_bf16 v[152:155], a[212:215], a[164:167], v[152:155]
 v_mfma_f32_16x16x32_bf16 v[156:159], a[212:215], a[172:175], v[156:159]
 v_mfma_f32_16x16x32_bf16 v[156:159], a[208:211], a[168:171], v[156:159]
 v_mfma_f32_16x16x32_bf16 v[160:163], a[208:211], a[176:179], v[160:163]
 v_mfma_f32_16x16x32_bf16 v[160:163], a[212:215], a[180:183], v[160:163]
 v_mfma_f32_16x16x32_bf16 v[164:167], a[212:215], a[188:191], v[164:167]
 v_mfma_f32_16x16x32_bf16 v[164:167], a[208:211], a[184:187], v[164:167]
 s_waitcnt vmcnt(12)
 v_mfma_f32_16x16x32_bf16 v[196:199], a[216:219], a[184:187], v[196:199]
 v_mfma_f32_16x16x32_bf16 v[196:199], a[220:223], a[188:191], v[196:199]
 global_load_dwordx4 a[212:215], v0, s[70:71] offset:1024 sc1
 v_mfma_f32_16x16x32_bf16 v[192:195], a[220:223], a[180:183], v[192:195]
 v_mfma_f32_16x16x32_bf16 v[192:195], a[216:219], a[176:179], v[192:195]
 global_load_dwordx4 a[208:211], v0, s[70:71] offset:0 sc1
 v_mfma_f32_16x16x32_bf16 v[188:191], a[216:219], a[168:171], v[188:191]
 v_mfma_f32_16x16x32_bf16 v[188:191], a[220:223], a[172:175], v[188:191]
 v_mfma_f32_16x16x32_bf16 v[184:187], a[220:223], a[164:167], v[184:187]
 v_mfma_f32_16x16x32_bf16 v[184:187], a[216:219], a[160:163], v[184:187]
 v_mfma_f32_16x16x32_bf16 v[180:183], a[216:219], a[152:155], v[180:183]
 v_mfma_f32_16x16x32_bf16 v[180:183], a[220:223], a[156:159], v[180:183]
 v_mfma_f32_16x16x32_bf16 v[176:179], a[220:223], a[148:151], v[176:179]
 v_mfma_f32_16x16x32_bf16 v[176:179], a[216:219], a[144:147], v[176:179]
 v_mfma_f32_16x16x32_bf16 v[172:175], a[216:219], a[136:139], v[172:175]
 v_mfma_f32_16x16x32_bf16 v[172:175], a[220:223], a[140:143], v[172:175]
 v_mfma_f32_16x16x32_bf16 v[168:171], a[220:223], a[132:135], v[168:171]
 v_mfma_f32_16x16x32_bf16 v[168:171], a[216:219], a[128:131], v[168:171]
 s_waitcnt vmcnt(10)
 v_mfma_f32_16x16x32_bf16 v[200:203], a[224:227], a[128:131], v[200:203]
 v_mfma_f32_16x16x32_bf16 v[200:203], a[228:231], a[132:135], v[200:203]
 global_load_dwordx4 a[220:223], v0, s[70:71] offset:3072 sc1
 v_mfma_f32_16x16x32_bf16 v[204:207], a[228:231], a[140:143], v[204:207]
 v_mfma_f32_16x16x32_bf16 v[204:207], a[224:227], a[136:139], v[204:207]
 global_load_dwordx4 a[216:219], v0, s[70:71] offset:2048 sc1
 v_mfma_f32_16x16x32_bf16 v[208:211], a[224:227], a[144:147], v[208:211]
 s_add_u32 s70, s70, 8192
 s_addc_u32 s71, s71, 0
 v_mfma_f32_16x16x32_bf16 v[208:211], a[228:231], a[148:151], v[208:211]
 v_mfma_f32_16x16x32_bf16 v[212:215], a[228:231], a[156:159], v[212:215]
 v_mfma_f32_16x16x32_bf16 v[212:215], a[224:227], a[152:155], v[212:215]
 v_mfma_f32_16x16x32_bf16 v[216:219], a[224:227], a[160:163], v[216:219]
 v_mfma_f32_16x16x32_bf16 v[216:219], a[228:231], a[164:167], v[216:219]
 v_mfma_f32_16x16x32_bf16 v[220:223], a[228:231], a[172:175], v[220:223]
 v_mfma_f32_16x16x32_bf16 v[220:223], a[224:227], a[168:171], v[220:223]
 v_mfma_f32_16x16x32_bf16 v[224:227], a[224:227], a[176:179], v[224:227]
 v_mfma_f32_16x16x32_bf16 v[224:227], a[228:231], a[180:183], v[224:227]
 v_mfma_f32_16x16x32_bf16 v[228:231], a[228:231], a[188:191], v[228:231]
 v_mfma_f32_16x16x32_bf16 v[228:231], a[224:227], a[184:187], v[228:231]
 buffer_load_dwordx4 v6, s[8:11], s30 offen lds
 s_waitcnt vmcnt(11)
 v_mfma_f32_16x16x32_bf16 a[252:255], a[232:235], a[184:187], a[252:255]
 ds_read_b128 a[184:187], v1 offset:61440
 v_mfma_f32_16x16x32_bf16 a[252:255], a[236:239], a[188:191], a[252:255]
 global_load_dwordx4 a[228:231], v0, s[70:71] offset:-3072 sc1
 ds_read_b128 a[188:191], v1 offset:62464
 v_mfma_f32_16x16x32_bf16 a[248:251], a[236:239], a[180:183], a[248:251]
 ds_read_b128 a[180:183], v1 offset:58368
 v_mfma_f32_16x16x32_bf16 a[248:251], a[232:235], a[176:179], a[248:251]
 global_load_dwordx4 a[224:227], v0, s[70:71] offset:-4096 sc1
 ds_read_b128 a[176:179], v1 offset:57344
 v_mfma_f32_16x16x32_bf16 v[252:255], a[232:235], a[168:171], v[252:255]
 ds_read_b128 a[168:171], v1 offset:53248
 v_mfma_f32_16x16x32_bf16 v[252:255], a[236:239], a[172:175], v[252:255]
 ds_read_b128 a[172:175], v1 offset:54272
 s_add_u32 m0, m0, 1024
 v_mfma_f32_16x16x32_bf16 v[248:251], a[236:239], a[164:167], v[248:251]
 ds_read_b128 a[164:167], v1 offset:50176
 s_add_u32 s30, s30, s20
 v_mfma_f32_16x16x32_bf16 v[248:251], a[232:235], a[160:163], v[248:251]
 ds_read_b128 a[160:163], v1 offset:49152
 v_mfma_f32_16x16x32_bf16 v[244:247], a[232:235], a[152:155], v[244:247]
 ds_read_b128 a[152:155], v1 offset:45056
 buffer_load_dwordx4 v6, s[8:11], s30 offen lds
 v_mfma_f32_16x16x32_bf16 v[244:247], a[236:239], a[156:159], v[244:247]
 ds_read_b128 a[156:159], v1 offset:46080
 s_add_u32 m0, m0, 3072
 v_mfma_f32_16x16x32_bf16 v[240:243], a[236:239], a[148:151], v[240:243]
 ds_read_b128 a[148:151], v1 offset:41984
 v_mfma_f32_16x16x32_bf16 v[240:243], a[232:235], a[144:147], v[240:243]
 ds_read_b128 a[144:147], v1 offset:40960
 s_add_u32 s30, s30, s21
 v_mfma_f32_16x16x32_bf16 v[236:239], a[232:235], a[136:139], v[236:239]
 ds_read_b128 a[136:139], v1 offset:36864
 v_mfma_f32_16x16x32_bf16 v[236:239], a[236:239], a[140:143], v[236:239]
 ds_read_b128 a[140:143], v1 offset:37888
 v_mfma_f32_16x16x32_bf16 v[232:235], a[236:239], a[132:135], v[232:235]
 ds_read_b128 a[132:135], v1 offset:33792
 v_mfma_f32_16x16x32_bf16 v[232:235], a[232:235], a[128:131], v[232:235]
 ds_read_b128 a[128:131], v1 offset:32768
 s_waitcnt vmcnt(12) lgkmcnt(8)
 v_mfma_f32_16x16x32_bf16 v[44:47], a[192:195], a[184:187], v[44:47]
 v_mfma_f32_16x16x32_bf16 v[44:47], a[196:199], a[188:191], v[44:47]
 v_mfma_f32_16x16x32_bf16 v[40:43], a[196:199], a[180:183], v[40:43]
 v_mfma_f32_16x16x32_bf16 v[40:43], a[192:195], a[176:179], v[40:43]
 v_mfma_f32_16x16x32_bf16 v[36:39], a[192:195], a[168:171], v[36:39]
 v_mfma_f32_16x16x32_bf16 v[36:39], a[196:199], a[172:175], v[36:39]
 v_mfma_f32_16x16x32_bf16 v[32:35], a[196:199], a[164:167], v[32:35]
 v_mfma_f32_16x16x32_bf16 v[32:35], a[192:195], a[160:163], v[32:35]
 s_waitcnt lgkmcnt(0)
 v_mfma_f32_16x16x32_bf16 v[28:31], a[192:195], a[152:155], v[28:31]
 v_mfma_f32_16x16x32_bf16 v[28:31], a[196:199], a[156:159], v[28:31]
 v_mfma_f32_16x16x32_bf16 v[24:27], a[196:199], a[148:151], v[24:27]
 v_mfma_f32_16x16x32_bf16 v[24:27], a[192:195], a[144:147], v[24:27]
 v_mfma_f32_16x16x32_bf16 v[20:23], a[192:195], a[136:139], v[20:23]
 v_mfma_f32_16x16x32_bf16 v[20:23], a[196:199], a[140:143], v[20:23]
 v_mfma_f32_16x16x32_bf16 v[16:19], a[196:199], a[132:135], v[16:19]
 v_mfma_f32_16x16x32_bf16 v[16:19], a[192:195], a[128:131], v[16:19]
 s_waitcnt vmcnt(8)
 v_mfma_f32_16x16x32_bf16 v[48:51], a[200:203], a[128:131], v[48:51]
 v_mfma_f32_16x16x32_bf16 v[48:51], a[204:207], a[132:135], v[48:51]
 global_load_dwordx4 a[196:199], v0, s[70:71] offset:-1024 sc1
 v_mfma_f32_16x16x32_bf16 v[52:55], a[204:207], a[140:143], v[52:55]
 v_mfma_f32_16x16x32_bf16 v[52:55], a[200:203], a[136:139], v[52:55]
 global_load_dwordx4 a[192:195], v0, s[70:71] offset:-2048 sc1
 v_mfma_f32_16x16x32_bf16 v[56:59], a[200:203], a[144:147], v[56:59]
 v_mfma_f32_16x16x32_bf16 v[56:59], a[204:207], a[148:151], v[56:59]
 v_mfma_f32_16x16x32_bf16 v[60:63], a[204:207], a[156:159], v[60:63]
 v_mfma_f32_16x16x32_bf16 v[60:63], a[200:203], a[152:155], v[60:63]
 v_mfma_f32_16x16x32_bf16 v[64:67], a[200:203], a[160:163], v[64:67]
 v_mfma_f32_16x16x32_bf16 v[64:67], a[204:207], a[164:167], v[64:67]
 v_mfma_f32_16x16x32_bf16 v[68:71], a[204:207], a[172:175], v[68:71]
 v_mfma_f32_16x16x32_bf16 v[68:71], a[200:203], a[168:171], v[68:71]
 v_mfma_f32_16x16x32_bf16 v[72:75], a[200:203], a[176:179], v[72:75]
 v_mfma_f32_16x16x32_bf16 v[72:75], a[204:207], a[180:183], v[72:75]
 v_mfma_f32_16x16x32_bf16 v[76:79], a[204:207], a[188:191], v[76:79]
 v_mfma_f32_16x16x32_bf16 v[76:79], a[200:203], a[184:187], v[76:79]
 s_waitcnt vmcnt(8)
 v_mfma_f32_16x16x32_bf16 v[108:111], a[208:211], a[184:187], v[108:111]
 v_mfma_f32_16x16x32_bf16 v[108:111], a[212:215], a[188:191], v[108:111]
 global_load_dwordx4 a[204:207], v0, s[70:71] offset:1024 sc1
 v_mfma_f32_16x16x32_bf16 v[104:107], a[212:215], a[180:183], v[104:107]
 v_mfma_f32_16x16x32_bf16 v[104:107], a[208:211], a[176:179], v[104:107]
 global_load_dwordx4 a[200:203], v0, s[70:71] offset:0 sc1
 v_mfma_f32_16x16x32_bf16 v[100:103], a[208:211], a[168:171], v[100:103]
 v_mfma_f32_16x16x32_bf16 v[100:103], a[212:215], a[172:175], v[100:103]
 v_mfma_f32_16x16x32_bf16 v[96:99], a[212:215], a[164:167], v[96:99]
 v_mfma_f32_16x16x32_bf16 v[96:99], a[208:211], a[160:163], v[96:99]
 v_mfma_f32_16x16x32_bf16 v[92:95], a[208:211], a[152:155], v[92:95]
 v_mfma_f32_16x16x32_bf16 v[92:95], a[212:215], a[156:159], v[92:95]
 v_mfma_f32_16x16x32_bf16 v[88:91], a[212:215], a[148:151], v[88:91]
 buffer_load_dwordx4 v6, s[8:11], s30 offen lds
 v_mfma_f32_16x16x32_bf16 v[88:91], a[208:211], a[144:147], v[88:91]
 v_mfma_f32_16x16x32_bf16 v[84:87], a[208:211], a[136:139], v[84:87]
 s_add_u32 m0, m0, 1024
 v_mfma_f32_16x16x32_bf16 v[84:87], a[212:215], a[140:143], v[84:87]
 s_add_u32 s30, s30, s20
 v_mfma_f32_16x16x32_bf16 v[80:83], a[212:215], a[132:135], v[80:83]
 v_mfma_f32_16x16x32_bf16 v[80:83], a[208:211], a[128:131], v[80:83]
 buffer_load_dwordx4 v6, s[8:11], s30 offen lds
 s_waitcnt vmcnt(10)
 v_mfma_f32_16x16x32_bf16 v[112:115], a[216:219], a[128:131], v[112:115]
 v_mfma_f32_16x16x32_bf16 v[112:115], a[220:223], a[132:135], v[112:115]
 global_load_dwordx4 a[212:215], v0, s[70:71] offset:3072 sc1
 s_add_u32 m0, m0, 3072
 v_mfma_f32_16x16x32_bf16 v[116:119], a[220:223], a[140:143], v[116:119]
 s_add_u32 s30, s30, s21
 v_mfma_f32_16x16x32_bf16 v[116:119], a[216:219], a[136:139], v[116:119]
 global_load_dwordx4 a[208:211], v0, s[70:71] offset:2048 sc1
 v_mfma_f32_16x16x32_bf16 v[120:123], a[216:219], a[144:147], v[120:123]
 s_add_u32 s70, s70, 8192
 s_addc_u32 s71, s71, 0
 v_mfma_f32_16x16x32_bf16 v[120:123], a[220:223], a[148:151], v[120:123]
 v_mfma_f32_16x16x32_bf16 v[124:127], a[220:223], a[156:159], v[124:127]
 v_mfma_f32_16x16x32_bf16 v[124:127], a[216:219], a[152:155], v[124:127]
 v_mfma_f32_16x16x32_bf16 v[128:131], a[216:219], a[160:163], v[128:131]
 v_mfma_f32_16x16x32_bf16 v[128:131], a[220:223], a[164:167], v[128:131]
 v_mfma_f32_16x16x32_bf16 v[132:135], a[220:223], a[172:175], v[132:135]
 v_mfma_f32_16x16x32_bf16 v[132:135], a[216:219], a[168:171], v[132:135]
 v_mfma_f32_16x16x32_bf16 a[240:243], a[216:219], a[176:179], a[240:243]
 v_mfma_f32_16x16x32_bf16 a[240:243], a[220:223], a[180:183], a[240:243]
 v_mfma_f32_16x16x32_bf16 a[244:247], a[220:223], a[188:191], a[244:247]
 v_mfma_f32_16x16x32_bf16 a[244:247], a[216:219], a[184:187], a[244:247]
 s_waitcnt vmcnt(9)
 v_mfma_f32_16x16x32_bf16 v[164:167], a[224:227], a[184:187], v[164:167]
 v_mfma_f32_16x16x32_bf16 v[164:167], a[228:231], a[188:191], v[164:167]
 global_load_dwordx4 a[220:223], v0, s[70:71] offset:-3072 sc1
 v_mfma_f32_16x16x32_bf16 v[160:163], a[228:231], a[180:183], v[160:163]
 v_mfma_f32_16x16x32_bf16 v[160:163], a[224:227], a[176:179], v[160:163]
 global_load_dwordx4 a[216:219], v0, s[70:71] offset:-4096 sc1
 v_mfma_f32_16x16x32_bf16 v[156:159], a[224:227], a[168:171], v[156:159]
 v_mfma_f32_16x16x32_bf16 v[156:159], a[228:231], a[172:175], v[156:159]
 v_mfma_f32_16x16x32_bf16 v[152:155], a[228:231], a[164:167], v[152:155]
 v_mfma_f32_16x16x32_bf16 v[152:155], a[224:227], a[160:163], v[152:155]
 v_mfma_f32_16x16x32_bf16 v[148:151], a[224:227], a[152:155], v[148:151]
 v_mfma_f32_16x16x32_bf16 v[148:151], a[228:231], a[156:159], v[148:151]
 v_mfma_f32_16x16x32_bf16 v[144:147], a[228:231], a[148:151], v[144:147]
 v_mfma_f32_16x16x32_bf16 v[144:147], a[224:227], a[144:147], v[144:147]
 v_mfma_f32_16x16x32_bf16 v[140:143], a[224:227], a[136:139], v[140:143]
 v_mfma_f32_16x16x32_bf16 v[140:143], a[228:231], a[140:143], v[140:143]
 v_mfma_f32_16x16x32_bf16 v[136:139], a[228:231], a[132:135], v[136:139]
 v_mfma_f32_16x16x32_bf16 v[136:139], a[224:227], a[128:131], v[136:139]
 s_waitcnt vmcnt(8)
 v_mfma_f32_16x16x32_bf16 v[168:171], a[192:195], a[128:131], v[168:171]
 v_mfma_f32_16x16x32_bf16 v[168:171], a[196:199], a[132:135], v[168:171]
 global_load_dwordx4 a[228:231], v0, s[70:71] offset:-1024 sc1
 v_mfma_f32_16x16x32_bf16 v[172:175], a[196:199], a[140:143], v[172:175]
 v_mfma_f32_16x16x32_bf16 v[172:175], a[192:195], a[136:139], v[172:175]
 global_load_dwordx4 a[224:227], v0, s[70:71] offset:-2048 sc1
 v_mfma_f32_16x16x32_bf16 v[176:179], a[192:195], a[144:147], v[176:179]
 v_mfma_f32_16x16x32_bf16 v[176:179], a[196:199], a[148:151], v[176:179]
 v_mfma_f32_16x16x32_bf16 v[180:183], a[196:199], a[156:159], v[180:183]
 v_mfma_f32_16x16x32_bf16 v[180:183], a[192:195], a[152:155], v[180:183]
 v_mfma_f32_16x16x32_bf16 v[184:187], a[192:195], a[160:163], v[184:187]
 v_mfma_f32_16x16x32_bf16 v[184:187], a[196:199], a[164:167], v[184:187]
 v_mfma_f32_16x16x32_bf16 v[188:191], a[196:199], a[172:175], v[188:191]
 v_mfma_f32_16x16x32_bf16 v[188:191], a[192:195], a[168:171], v[188:191]
 v_mfma_f32_16x16x32_bf16 v[192:195], a[192:195], a[176:179], v[192:195]
 v_mfma_f32_16x16x32_bf16 v[192:195], a[196:199], a[180:183], v[192:195]
 v_mfma_f32_16x16x32_bf16 v[196:199], a[196:199], a[188:191], v[196:199]
 v_mfma_f32_16x16x32_bf16 v[196:199], a[192:195], a[184:187], v[196:199]
 s_waitcnt vmcnt(8)
 v_mfma_f32_16x16x32_bf16 v[228:231], a[200:203], a[184:187], v[228:231]
 v_mfma_f32_16x16x32_bf16 v[228:231], a[204:207], a[188:191], v[228:231]
 global_load_dwordx4 a[196:199], v0, s[70:71] offset:1024 sc1
 v_mfma_f32_16x16x32_bf16 v[224:227], a[204:207], a[180:183], v[224:227]
 buffer_load_dwordx4 v6, s[8:11], s30 offen lds
 v_mfma_f32_16x16x32_bf16 v[224:227], a[200:203], a[176:179], v[224:227]
 global_load_dwordx4 a[192:195], v0, s[70:71] offset:0 sc1
 s_add_u32 m0, m0, 1024
 v_mfma_f32_16x16x32_bf16 v[220:223], a[200:203], a[168:171], v[220:223]
 v_mfma_f32_16x16x32_bf16 v[220:223], a[204:207], a[172:175], v[220:223]
 s_add_u32 s30, s30, s20
 v_mfma_f32_16x16x32_bf16 v[216:219], a[204:207], a[164:167], v[216:219]
 buffer_load_dwordx4 v6, s[8:11], s30 offen lds
 v_mfma_f32_16x16x32_bf16 v[216:219], a[200:203], a[160:163], v[216:219]
 v_mfma_f32_16x16x32_bf16 v[212:215], a[200:203], a[152:155], v[212:215]
 s_add_u32 m0, m0, 3072
 v_mfma_f32_16x16x32_bf16 v[212:215], a[204:207], a[156:159], v[212:215]
 s_add_u32 s30, s30, s21
 v_mfma_f32_16x16x32_bf16 v[208:211], a[204:207], a[148:151], v[208:211]
 v_mfma_f32_16x16x32_bf16 v[208:211], a[200:203], a[144:147], v[208:211]
 v_mfma_f32_16x16x32_bf16 v[204:207], a[200:203], a[136:139], v[204:207]
 v_mfma_f32_16x16x32_bf16 v[204:207], a[204:207], a[140:143], v[204:207]
 v_mfma_f32_16x16x32_bf16 v[200:203], a[204:207], a[132:135], v[200:203]
 v_mfma_f32_16x16x32_bf16 v[200:203], a[200:203], a[128:131], v[200:203]
 s_waitcnt vmcnt(8)
 v_mfma_f32_16x16x32_bf16 v[232:235], a[208:211], a[128:131], v[232:235]
 ds_read_b128 a[128:131], v2
 v_mfma_f32_16x16x32_bf16 v[232:235], a[212:215], a[132:135], v[232:235]
 global_load_dwordx4 a[204:207], v0, s[70:71] offset:3072 sc1
 ds_read_b128 a[132:135], v2 offset:1024
 v_mfma_f32_16x16x32_bf16 v[236:239], a[212:215], a[140:143], v[236:239]
 ds_read_b128 a[140:143], v2 offset:5120
 v_mfma_f32_16x16x32_bf16 v[236:239], a[208:211], a[136:139], v[236:239]
 global_load_dwordx4 a[200:203], v0, s[70:71] offset:2048 sc1
 ds_read_b128 a[136:139], v2 offset:4096
 v_mfma_f32_16x16x32_bf16 v[240:243], a[208:211], a[144:147], v[240:243]
 s_add_u32 s70, s70, 8192
 s_addc_u32 s71, s71, 0
 ds_read_b128 a[144:147], v2 offset:8192
 v_mfma_f32_16x16x32_bf16 v[240:243], a[212:215], a[148:151], v[240:243]
 ds_read_b128 a[148:151], v2 offset:9216
 v_mfma_f32_16x16x32_bf16 v[244:247], a[212:215], a[156:159], v[244:247]
 ds_read_b128 a[156:159], v2 offset:13312
 v_mfma_f32_16x16x32_bf16 v[244:247], a[208:211], a[152:155], v[244:247]
 ds_read_b128 a[152:155], v2 offset:12288
 v_mfma_f32_16x16x32_bf16 v[248:251], a[208:211], a[160:163], v[248:251]
 ds_read_b128 a[160:163], v2 offset:16384
 v_mfma_f32_16x16x32_bf16 v[248:251], a[212:215], a[164:167], v[248:251]
 ds_read_b128 a[164:167], v2 offset:17408
 v_mfma_f32_16x16x32_bf16 v[252:255], a[212:215], a[172:175], v[252:255]
 ds_read_b128 a[172:175], v2 offset:21504
 v_mfma_f32_16x16x32_bf16 v[252:255], a[208:211], a[168:171], v[252:255]
 ds_read_b128 a[168:171], v2 offset:20480
 v_mfma_f32_16x16x32_bf16 a[248:251], a[208:211], a[176:179], a[248:251]
 ds_read_b128 a[176:179], v2 offset:24576
 v_mfma_f32_16x16x32_bf16 a[248:251], a[212:215], a[180:183], a[248:251]
 ds_read_b128 a[180:183], v2 offset:25600
 v_mfma_f32_16x16x32_bf16 a[252:255], a[212:215], a[188:191], a[252:255]
 ds_read_b128 a[188:191], v2 offset:29696
 v_mfma_f32_16x16x32_bf16 a[252:255], a[208:211], a[184:187], a[252:255]
 ds_read_b128 a[184:187], v2 offset:28672
 s_waitcnt vmcnt(8) lgkmcnt(8)
 v_mfma_f32_16x16x32_bf16 v[16:19], a[216:219], a[128:131], v[16:19]
 v_mfma_f32_16x16x32_bf16 v[16:19], a[220:223], a[132:135], v[16:19]
 global_load_dwordx4 a[212:215], v0, s[70:71] offset:-3072 sc1
 v_mfma_f32_16x16x32_bf16 v[20:23], a[220:223], a[140:143], v[20:23]
 v_mfma_f32_16x16x32_bf16 v[20:23], a[216:219], a[136:139], v[20:23]
 global_load_dwordx4 a[208:211], v0, s[70:71] offset:-4096 sc1
 v_mfma_f32_16x16x32_bf16 v[24:27], a[216:219], a[144:147], v[24:27]
 v_mfma_f32_16x16x32_bf16 v[24:27], a[220:223], a[148:151], v[24:27]
 v_mfma_f32_16x16x32_bf16 v[28:31], a[220:223], a[156:159], v[28:31]
 v_mfma_f32_16x16x32_bf16 v[28:31], a[216:219], a[152:155], v[28:31]
 s_waitcnt lgkmcnt(0)
 v_mfma_f32_16x16x32_bf16 v[32:35], a[216:219], a[160:163], v[32:35]
 v_mfma_f32_16x16x32_bf16 v[32:35], a[220:223], a[164:167], v[32:35]
 v_mfma_f32_16x16x32_bf16 v[36:39], a[220:223], a[172:175], v[36:39]
 v_mfma_f32_16x16x32_bf16 v[36:39], a[216:219], a[168:171], v[36:39]
 v_mfma_f32_16x16x32_bf16 v[40:43], a[216:219], a[176:179], v[40:43]
 v_mfma_f32_16x16x32_bf16 v[40:43], a[220:223], a[180:183], v[40:43]
 v_mfma_f32_16x16x32_bf16 v[44:47], a[220:223], a[188:191], v[44:47]
 v_mfma_f32_16x16x32_bf16 v[44:47], a[216:219], a[184:187], v[44:47]
 s_waitcnt vmcnt(8)
 v_mfma_f32_16x16x32_bf16 v[76:79], a[224:227], a[184:187], v[76:79]
 v_mfma_f32_16x16x32_bf16 v[76:79], a[228:231], a[188:191], v[76:79]
 global_load_dwordx4 a[220:223], v0, s[70:71] offset:-1024 sc1
 v_mfma_f32_16x16x32_bf16 v[72:75], a[228:231], a[180:183], v[72:75]
 v_mfma_f32_16x16x32_bf16 v[72:75], a[224:227], a[176:179], v[72:75]
 global_load_dwordx4 a[216:219], v0, s[70:71] offset:-2048 sc1
 v_mfma_f32_16x16x32_bf16 v[68:71], a[224:227], a[168:171], v[68:71]
 v_mfma_f32_16x16x32_bf16 v[68:71], a[228:231], a[172:175], v[68:71]
 v_mfma_f32_16x16x32_bf16 v[64:67], a[228:231], a[164:167], v[64:67]
 v_mfma_f32_16x16x32_bf16 v[64:67], a[224:227], a[160:163], v[64:67]
 v_mfma_f32_16x16x32_bf16 v[60:63], a[224:227], a[152:155], v[60:63]
 v_mfma_f32_16x16x32_bf16 v[60:63], a[228:231], a[156:159], v[60:63]
 buffer_load_dwordx4 v6, s[8:11], s30 offen lds
 v_mfma_f32_16x16x32_bf16 v[56:59], a[228:231], a[148:151], v[56:59]
 s_add_u32 m0, m0, 1024
 v_mfma_f32_16x16x32_bf16 v[56:59], a[224:227], a[144:147], v[56:59]
 v_mfma_f32_16x16x32_bf16 v[52:55], a[224:227], a[136:139], v[52:55]
 s_add_u32 s30, s30, s20
 v_mfma_f32_16x16x32_bf16 v[52:55], a[228:231], a[140:143], v[52:55]
 buffer_load_dwordx4 v6, s[8:11], s30 offen lds
 v_mfma_f32_16x16x32_bf16 v[48:51], a[228:231], a[132:135], v[48:51]
 v_mfma_f32_16x16x32_bf16 v[48:51], a[224:227], a[128:131], v[48:51]
 s_add_u32 m0, m0, 3072
 s_waitcnt vmcnt(9)
 v_mfma_f32_16x16x32_bf16 v[80:83], a[192:195], a[128:131], v[80:83]
 s_add_u32 s30, s30, s21
 v_mfma_f32_16x16x32_bf16 v[80:83], a[196:199], a[132:135], v[80:83]
 global_load_dwordx4 a[228:231], v0, s[70:71] offset:1024 sc1
 v_mfma_f32_16x16x32_bf16 v[84:87], a[196:199], a[140:143], v[84:87]
 v_mfma_f32_16x16x32_bf16 v[84:87], a[192:195], a[136:139], v[84:87]
 global_load_dwordx4 a[224:227], v0, s[70:71] offset:0 sc1
 v_mfma_f32_16x16x32_bf16 v[88:91], a[192:195], a[144:147], v[88:91]
 v_mfma_f32_16x16x32_bf16 v[88:91], a[196:199], a[148:151], v[88:91]
 v_mfma_f32_16x16x32_bf16 v[92:95], a[196:199], a[156:159], v[92:95]
 v_mfma_f32_16x16x32_bf16 v[92:95], a[192:195], a[152:155], v[92:95]
 v_mfma_f32_16x16x32_bf16 v[96:99], a[192:195], a[160:163], v[96:99]
 v_mfma_f32_16x16x32_bf16 v[96:99], a[196:199], a[164:167], v[96:99]
 v_mfma_f32_16x16x32_bf16 v[100:103], a[196:199], a[172:175], v[100:103]
 v_mfma_f32_16x16x32_bf16 v[100:103], a[192:195], a[168:171], v[100:103]
 v_mfma_f32_16x16x32_bf16 v[104:107], a[192:195], a[176:179], v[104:107]
 v_mfma_f32_16x16x32_bf16 v[104:107], a[196:199], a[180:183], v[104:107]
 v_mfma_f32_16x16x32_bf16 v[108:111], a[196:199], a[188:191], v[108:111]
 v_mfma_f32_16x16x32_bf16 v[108:111], a[192:195], a[184:187], v[108:111]
 s_waitcnt vmcnt(8)
 v_mfma_f32_16x16x32_bf16 a[244:247], a[200:203], a[184:187], a[244:247]
 v_mfma_f32_16x16x32_bf16 a[244:247], a[204:207], a[188:191], a[244:247]
 global_load_dwordx4 a[196:199], v0, s[70:71] offset:3072 sc1
 v_mfma_f32_16x16x32_bf16 a[240:243], a[204:207], a[180:183], a[240:243]
 v_mfma_f32_16x16x32_bf16 a[240:243], a[200:203], a[176:179], a[240:243]
 global_load_dwordx4 a[192:195], v0, s[70:71] offset:2048 sc1
 v_mfma_f32_16x16x32_bf16 v[132:135], a[200:203], a[168:171], v[132:135]
 s_add_u32 s70, s70, 8192
 s_addc_u32 s71, s71, 0
 v_mfma_f32_16x16x32_bf16 v[132:135], a[204:207], a[172:175], v[132:135]
 v_mfma_f32_16x16x32_bf16 v[128:131], a[204:207], a[164:167], v[128:131]
 v_mfma_f32_16x16x32_bf16 v[128:131], a[200:203], a[160:163], v[128:131]
 v_mfma_f32_16x16x32_bf16 v[124:127], a[200:203], a[152:155], v[124:127]
 v_mfma_f32_16x16x32_bf16 v[124:127], a[204:207], a[156:159], v[124:127]
 v_mfma_f32_16x16x32_bf16 v[120:123], a[204:207], a[148:151], v[120:123]
 v_mfma_f32_16x16x32_bf16 v[120:123], a[200:203], a[144:147], v[120:123]
 v_mfma_f32_16x16x32_bf16 v[116:119], a[200:203], a[136:139], v[116:119]
 v_mfma_f32_16x16x32_bf16 v[116:119], a[204:207], a[140:143], v[116:119]
 v_mfma_f32_16x16x32_bf16 v[112:115], a[204:207], a[132:135], v[112:115]
 v_mfma_f32_16x16x32_bf16 v[112:115], a[200:203], a[128:131], v[112:115]
 s_waitcnt vmcnt(8)
 v_mfma_f32_16x16x32_bf16 v[136:139], a[208:211], a[128:131], v[136:139]
 v_mfma_f32_16x16x32_bf16 v[136:139], a[212:215], a[132:135], v[136:139]
 global_load_dwordx4 a[204:207], v0, s[70:71] offset:-3072 sc1
 v_mfma_f32_16x16x32_bf16 v[140:143], a[212:215], a[140:143], v[140:143]
 v_mfma_f32_16x16x32_bf16 v[140:143], a[208:211], a[136:139], v[140:143]
 global_load_dwordx4 a[200:203], v0, s[70:71] offset:-4096 sc1
 v_mfma_f32_16x16x32_bf16 v[144:147], a[208:211], a[144:147], v[144:147]
 v_mfma_f32_16x16x32_bf16 v[144:147], a[212:215], a[148:151], v[144:147]
 v_mfma_f32_16x16x32_bf16 v[148:151], a[212:215], a[156:159], v[148:151]
 v_mfma_f32_16x16x32_bf16 v[148:151], a[208:211], a[152:155], v[148:151]
 v_mfma_f32_16x16x32_bf16 v[152:155], a[208:211], a[160:163], v[152:155]
 v_mfma_f32_16x16x32_bf16 v[152:155], a[212:215], a[164:167], v[152:155]
 v_mfma_f32_16x16x32_bf16 v[156:159], a[212:215], a[172:175], v[156:159]
 v_and_b32 v5, 768, v1
 v_mfma_f32_16x16x32_bf16 v[156:159], a[208:211], a[168:171], v[156:159]
 v_mfma_f32_16x16x32_bf16 v[160:163], a[208:211], a[176:179], v[160:163]
 v_add3_u32 v5, v5, v1, s52
 v_mfma_f32_16x16x32_bf16 v[160:163], a[212:215], a[180:183], v[160:163]
 v_mfma_f32_16x16x32_bf16 v[164:167], a[212:215], a[188:191], v[164:167]
 ds_read_b64_tr_b16 v[8:9], v5 offset:0
 v_mfma_f32_16x16x32_bf16 v[164:167], a[208:211], a[184:187], v[164:167]
 buffer_load_dwordx4 v6, s[8:11], s30 offen lds
 s_waitcnt vmcnt(9)
 v_mfma_f32_16x16x32_bf16 v[196:199], a[216:219], a[184:187], v[196:199]
 ds_read_b64_tr_b16 v[10:11], v5 offset:256
 v_mfma_f32_16x16x32_bf16 v[196:199], a[220:223], a[188:191], v[196:199]
 global_load_dwordx4 a[212:215], v0, s[70:71] offset:-1024 sc1
 s_add_u32 m0, m0, 1024
 ds_read_b64_tr_b16 v[12:13], v5 offset:8
 v_mfma_f32_16x16x32_bf16 v[192:195], a[220:223], a[180:183], v[192:195]
 ds_read_b64_tr_b16 v[14:15], v5 offset:264
 v_mfma_f32_16x16x32_bf16 v[192:195], a[216:219], a[176:179], v[192:195]
 global_load_dwordx4 a[208:211], v0, s[70:71] offset:-2048 sc1
 s_add_u32 s30, s30, s20
 v_mfma_f32_16x16x32_bf16 v[188:191], a[216:219], a[168:171], v[188:191]
 buffer_load_dwordx4 v6, s[8:11], s30 offen lds
 v_mfma_f32_16x16x32_bf16 v[188:191], a[220:223], a[172:175], v[188:191]
 v_mfma_f32_16x16x32_bf16 v[184:187], a[220:223], a[164:167], v[184:187]
 s_add_u32 m0, m0, 3072
 v_mfma_f32_16x16x32_bf16 v[184:187], a[216:219], a[160:163], v[184:187]
 v_mfma_f32_16x16x32_bf16 v[180:183], a[216:219], a[152:155], v[180:183]
 s_add_u32 s30, s30, s21
 v_mfma_f32_16x16x32_bf16 v[180:183], a[220:223], a[156:159], v[180:183]
 v_mfma_f32_16x16x32_bf16 v[176:179], a[220:223], a[148:151], v[176:179]
 v_mfma_f32_16x16x32_bf16 v[176:179], a[216:219], a[144:147], v[176:179]
 v_mfma_f32_16x16x32_bf16 v[172:175], a[216:219], a[136:139], v[172:175]
 v_mfma_f32_16x16x32_bf16 v[172:175], a[220:223], a[140:143], v[172:175]
 v_mfma_f32_16x16x32_bf16 v[168:171], a[220:223], a[132:135], v[168:171]
 v_mfma_f32_16x16x32_bf16 v[168:171], a[216:219], a[128:131], v[168:171]
 s_waitcnt vmcnt(8)
 v_mfma_f32_16x16x32_bf16 v[200:203], a[224:227], a[128:131], v[200:203]
 v_mfma_f32_16x16x32_bf16 v[200:203], a[228:231], a[132:135], v[200:203]
 global_load_dwordx4 a[220:223], v0, s[70:71] offset:1024 sc1
 s_waitcnt lgkmcnt(2)
 v_mfma_f32_16x16x32_bf16 v[204:207], a[228:231], a[140:143], v[204:207]
 v_mfma_f32_16x16x32_bf16 v[204:207], a[224:227], a[136:139], v[204:207]
 global_load_dwordx4 a[216:219], v0, s[70:71] offset:0 sc1
 v_mfma_f32_16x16x32_bf16 v[208:211], a[224:227], a[144:147], v[208:211]
 buffer_store_dwordx4 v[8:11], v1, s[12:15], s49 offen sc1
 s_waitcnt lgkmcnt(0)
 v_mfma_f32_16x16x32_bf16 v[208:211], a[228:231], a[148:151], v[208:211]
 buffer_store_dwordx4 v[12:15], v1, s[12:15], s49 offen offset:2048 sc1
 v_mfma_f32_16x16x32_bf16 v[212:215], a[228:231], a[156:159], v[212:215]
 v_mfma_f32_16x16x32_bf16 v[212:215], a[224:227], a[152:155], v[212:215]
 s_add_u32 s49, s49, 2097152
 v_mfma_f32_16x16x32_bf16 v[216:219], a[224:227], a[160:163], v[216:219]
 v_mfma_f32_16x16x32_bf16 v[216:219], a[228:231], a[164:167], v[216:219]
 v_mfma_f32_16x16x32_bf16 v[220:223], a[228:231], a[172:175], v[220:223]
 v_mfma_f32_16x16x32_bf16 v[220:223], a[224:227], a[168:171], v[220:223]
 v_mfma_f32_16x16x32_bf16 v[224:227], a[224:227], a[176:179], v[224:227]
 v_mfma_f32_16x16x32_bf16 v[224:227], a[228:231], a[180:183], v[224:227]
 v_mfma_f32_16x16x32_bf16 v[228:231], a[228:231], a[188:191], v[228:231]
 v_mfma_f32_16x16x32_bf16 v[228:231], a[224:227], a[184:187], v[228:231]
 s_waitcnt vmcnt(10)
 v_mfma_f32_16x16x32_bf16 a[252:255], a[192:195], a[184:187], a[252:255]
 ds_read_b128 a[184:187], v2 offset:61440
 v_mfma_f32_16x16x32_bf16 a[252:255], a[196:199], a[188:191], a[252:255]
 global_load_dwordx4 a[228:231], v0, s[70:71] offset:3072 sc1
 ds_read_b128 a[188:191], v2 offset:62464
 v_mfma_f32_16x16x32_bf16 a[248:251], a[196:199], a[180:183], a[248:251]
 ds_read_b128 a[180:183], v2 offset:58368
 v_mfma_f32_16x16x32_bf16 a[248:251], a[192:195], a[176:179], a[248:251]
 global_load_dwordx4 a[224:227], v0, s[70:71] offset:2048 sc1
 ds_read_b128 a[176:179], v2 offset:57344
 v_mfma_f32_16x16x32_bf16 v[252:255], a[192:195], a[168:171], v[252:255]
 s_add_u32 s70, s70, 8192
 s_addc_u32 s71, s71, 0
 ds_read_b128 a[168:171], v2 offset:53248
 v_mfma_f32_16x16x32_bf16 v[252:255], a[196:199], a[172:175], v[252:255]
 ds_read_b128 a[172:175], v2 offset:54272
 v_mfma_f32_16x16x32_bf16 v[248:251], a[196:199], a[164:167], v[248:251]
 ds_read_b128 a[164:167], v2 offset:50176
 v_mfma_f32_16x16x32_bf16 v[248:251], a[192:195], a[160:163], v[248:251]
 ds_read_b128 a[160:163], v2 offset:49152
 v_mfma_f32_16x16x32_bf16 v[244:247], a[192:195], a[152:155], v[244:247]
 ds_read_b128 a[152:155], v2 offset:45056
 v_mfma_f32_16x16x32_bf16 v[244:247], a[196:199], a[156:159], v[244:247]
 ds_read_b128 a[156:159], v2 offset:46080
 v_mfma_f32_16x16x32_bf16 v[240:243], a[196:199], a[148:151], v[240:243]
 ds_read_b128 a[148:151], v2 offset:41984
 v_mfma_f32_16x16x32_bf16 v[240:243], a[192:195], a[144:147], v[240:243]
 ds_read_b128 a[144:147], v2 offset:40960
 v_mfma_f32_16x16x32_bf16 v[236:239], a[192:195], a[136:139], v[236:239]
 ds_read_b128 a[136:139], v2 offset:36864
 v_mfma_f32_16x16x32_bf16 v[236:239], a[196:199], a[140:143], v[236:239]
 ds_read_b128 a[140:143], v2 offset:37888
 v_mfma_f32_16x16x32_bf16 v[232:235], a[196:199], a[132:135], v[232:235]
 ds_read_b128 a[132:135], v2 offset:33792
 v_mfma_f32_16x16x32_bf16 v[232:235], a[192:195], a[128:131], v[232:235]
 ds_read_b128 a[128:131], v2 offset:32768
 s_waitcnt vmcnt(10) lgkmcnt(8)
 v_mfma_f32_16x16x32_bf16 v[44:47], a[200:203], a[184:187], v[44:47]
 v_mfma_f32_16x16x32_bf16 v[44:47], a[204:207], a[188:191], v[44:47]
 global_load_dwordx4 a[196:199], v0, s[70:71] offset:-3072 sc1
 v_mfma_f32_16x16x32_bf16 v[40:43], a[204:207], a[180:183], v[40:43]
 v_mfma_f32_16x16x32_bf16 v[40:43], a[200:203], a[176:179], v[40:43]
 global_load_dwordx4 a[192:195], v0, s[70:71] offset:-4096 sc1
 v_mfma_f32_16x16x32_bf16 v[36:39], a[200:203], a[168:171], v[36:39]
 v_mfma_f32_16x16x32_bf16 v[36:39], a[204:207], a[172:175], v[36:39]
 v_mfma_f32_16x16x32_bf16 v[32:35], a[204:207], a[164:167], v[32:35]
 v_mfma_f32_16x16x32_bf16 v[32:35], a[200:203], a[160:163], v[32:35]
 buffer_load_dwordx4 v6, s[8:11], s30 offen lds
 s_waitcnt lgkmcnt(0)
 v_mfma_f32_16x16x32_bf16 v[28:31], a[200:203], a[152:155], v[28:31]
 v_mfma_f32_16x16x32_bf16 v[28:31], a[204:207], a[156:159], v[28:31]
 s_add_u32 m0, m0, 1024
 v_mfma_f32_16x16x32_bf16 v[24:27], a[204:207], a[148:151], v[24:27]
 s_add_u32 s30, s30, s20
 v_mfma_f32_16x16x32_bf16 v[24:27], a[200:203], a[144:147], v[24:27]
 v_mfma_f32_16x16x32_bf16 v[20:23], a[200:203], a[136:139], v[20:23]
 buffer_load_dwordx4 v6, s[8:11], s30 offen lds
 v_mfma_f32_16x16x32_bf16 v[20:23], a[204:207], a[140:143], v[20:23]
 s_add_u32 m0, m0, 3072
 v_mfma_f32_16x16x32_bf16 v[16:19], a[204:207], a[132:135], v[16:19]
 v_mfma_f32_16x16x32_bf16 v[16:19], a[200:203], a[128:131], v[16:19]
 s_add_u32 s30, s30, s22
 s_waitcnt vmcnt(11)
 v_mfma_f32_16x16x32_bf16 v[48:51], a[208:211], a[128:131], v[48:51]
 v_mfma_f32_16x16x32_bf16 v[48:51], a[212:215], a[132:135], v[48:51]
 global_load_dwordx4 a[204:207], v0, s[70:71] offset:-1024 sc1
 v_mfma_f32_16x16x32_bf16 v[52:55], a[212:215], a[140:143], v[52:55]
 v_mfma_f32_16x16x32_bf16 v[52:55], a[208:211], a[136:139], v[52:55]
 global_load_dwordx4 a[200:203], v0, s[70:71] offset:-2048 sc1
 v_mfma_f32_16x16x32_bf16 v[56:59], a[208:211], a[144:147], v[56:59]
 v_mfma_f32_16x16x32_bf16 v[56:59], a[212:215], a[148:151], v[56:59]
 v_mfma_f32_16x16x32_bf16 v[60:63], a[212:215], a[156:159], v[60:63]
 v_mfma_f32_16x16x32_bf16 v[60:63], a[208:211], a[152:155], v[60:63]
 v_mfma_f32_16x16x32_bf16 v[64:67], a[208:211], a[160:163], v[64:67]
 v_mfma_f32_16x16x32_bf16 v[64:67], a[212:215], a[164:167], v[64:67]
 v_mfma_f32_16x16x32_bf16 v[68:71], a[212:215], a[172:175], v[68:71]
 v_mfma_f32_16x16x32_bf16 v[68:71], a[208:211], a[168:171], v[68:71]
 v_mfma_f32_16x16x32_bf16 v[72:75], a[208:211], a[176:179], v[72:75]
 v_mfma_f32_16x16x32_bf16 v[72:75], a[212:215], a[180:183], v[72:75]
 v_mfma_f32_16x16x32_bf16 v[76:79], a[212:215], a[188:191], v[76:79]
 v_mfma_f32_16x16x32_bf16 v[76:79], a[208:211], a[184:187], v[76:79]
 s_waitcnt vmcnt(10)
 v_mfma_f32_16x16x32_bf16 v[108:111], a[216:219], a[184:187], v[108:111]
 v_mfma_f32_16x16x32_bf16 v[108:111], a[220:223], a[188:191], v[108:111]
 global_load_dwordx4 a[212:215], v0, s[70:71] offset:1024 sc1
 v_mfma_f32_16x16x32_bf16 v[104:107], a[220:223], a[180:183], v[104:107]
 v_mfma_f32_16x16x32_bf16 v[104:107], a[216:219], a[176:179], v[104:107]
 global_load_dwordx4 a[208:211], v0, s[70:71] offset:0 sc1
 v_mfma_f32_16x16x32_bf16 v[100:103], a[216:219], a[168:171], v[100:103]
 v_mfma_f32_16x16x32_bf16 v[100:103], a[220:223], a[172:175], v[100:103]
 v_mfma_f32_16x16x32_bf16 v[96:99], a[220:223], a[164:167], v[96:99]
 v_mfma_f32_16x16x32_bf16 v[96:99], a[216:219], a[160:163], v[96:99]
 v_mfma_f32_16x16x32_bf16 v[92:95], a[216:219], a[152:155], v[92:95]
 v_mfma_f32_16x16x32_bf16 v[92:95], a[220:223], a[156:159], v[92:95]
 v_mfma_f32_16x16x32_bf16 v[88:91], a[220:223], a[148:151], v[88:91]
 v_mfma_f32_16x16x32_bf16 v[88:91], a[216:219], a[144:147], v[88:91]
 v_mfma_f32_16x16x32_bf16 v[84:87], a[216:219], a[136:139], v[84:87]
 v_mfma_f32_16x16x32_bf16 v[84:87], a[220:223], a[140:143], v[84:87]
 v_mfma_f32_16x16x32_bf16 v[80:83], a[220:223], a[132:135], v[80:83]
 v_mfma_f32_16x16x32_bf16 v[80:83], a[216:219], a[128:131], v[80:83]
 s_waitcnt vmcnt(8)
 v_mfma_f32_16x16x32_bf16 v[112:115], a[224:227], a[128:131], v[112:115]
 v_mfma_f32_16x16x32_bf16 v[112:115], a[228:231], a[132:135], v[112:115]
 global_load_dwordx4 a[220:223], v0, s[70:71] offset:3072 sc1
 v_mfma_f32_16x16x32_bf16 v[116:119], a[228:231], a[140:143], v[116:119]
 v_mfma_f32_16x16x32_bf16 v[116:119], a[224:227], a[136:139], v[116:119]
 global_load_dwordx4 a[216:219], v0, s[70:71] offset:2048 sc1
 v_mfma_f32_16x16x32_bf16 v[120:123], a[224:227], a[144:147], v[120:123]
 s_add_u32 s70, s70, 8192
 s_addc_u32 s71, s71, 0
 v_mfma_f32_16x16x32_bf16 v[120:123], a[228:231], a[148:151], v[120:123]
 v_mfma_f32_16x16x32_bf16 v[124:127], a[228:231], a[156:159], v[124:127]
 v_mfma_f32_16x16x32_bf16 v[124:127], a[224:227], a[152:155], v[124:127]
 v_mfma_f32_16x16x32_bf16 v[128:131], a[224:227], a[160:163], v[128:131]
 v_mfma_f32_16x16x32_bf16 v[128:131], a[228:231], a[164:167], v[128:131]
 v_mfma_f32_16x16x32_bf16 v[132:135], a[228:231], a[172:175], v[132:135]
 v_mfma_f32_16x16x32_bf16 v[132:135], a[224:227], a[168:171], v[132:135]
 v_mfma_f32_16x16x32_bf16 a[240:243], a[224:227], a[176:179], a[240:243]
 v_mfma_f32_16x16x32_bf16 a[240:243], a[228:231], a[180:183], a[240:243]
 v_mfma_f32_16x16x32_bf16 a[244:247], a[228:231], a[188:191], a[244:247]
 v_mfma_f32_16x16x32_bf16 a[244:247], a[224:227], a[184:187], a[244:247]
 s_waitcnt vmcnt(8)
 v_mfma_f32_16x16x32_bf16 v[164:167], a[192:195], a[184:187], v[164:167]
 v_mfma_f32_16x16x32_bf16 v[164:167], a[196:199], a[188:191], v[164:167]
 global_load_dwordx4 a[228:231], v0, s[70:71] offset:-3072 sc1
 v_mfma_f32_16x16x32_bf16 v[160:163], a[196:199], a[180:183], v[160:163]
 v_mfma_f32_16x16x32_bf16 v[160:163], a[192:195], a[176:179], v[160:163]
 global_load_dwordx4 a[224:227], v0, s[70:71] offset:-4096 sc1
 v_mfma_f32_16x16x32_bf16 v[156:159], a[192:195], a[168:171], v[156:159]
 v_mfma_f32_16x16x32_bf16 v[156:159], a[196:199], a[172:175], v[156:159]
 global_load_dwordx4 a[236:239], v0, s[70:71] offset:-1024 sc1
 v_mfma_f32_16x16x32_bf16 v[152:155], a[196:199], a[164:167], v[152:155]
 v_mfma_f32_16x16x32_bf16 v[152:155], a[192:195], a[160:163], v[152:155]
 global_load_dwordx4 a[232:235], v0, s[70:71] offset:-2048 sc1
 v_mfma_f32_16x16x32_bf16 v[148:151], a[192:195], a[152:155], v[148:151]
 v_mfma_f32_16x16x32_bf16 v[148:151], a[196:199], a[156:159], v[148:151]
 v_mfma_f32_16x16x32_bf16 v[144:147], a[196:199], a[148:151], v[144:147]
 v_mfma_f32_16x16x32_bf16 v[144:147], a[192:195], a[144:147], v[144:147]
 v_mfma_f32_16x16x32_bf16 v[140:143], a[192:195], a[136:139], v[140:143]
 v_mfma_f32_16x16x32_bf16 v[140:143], a[196:199], a[140:143], v[140:143]
 v_mfma_f32_16x16x32_bf16 v[136:139], a[196:199], a[132:135], v[136:139]
 v_mfma_f32_16x16x32_bf16 v[136:139], a[192:195], a[128:131], v[136:139]
 s_waitcnt vmcnt(8)
 v_mfma_f32_16x16x32_bf16 v[168:171], a[200:203], a[128:131], v[168:171]
 v_mfma_f32_16x16x32_bf16 v[168:171], a[204:207], a[132:135], v[168:171]
 global_load_dwordx4 a[196:199], v0, s[70:71] offset:1024 sc1
 v_mfma_f32_16x16x32_bf16 v[172:175], a[204:207], a[140:143], v[172:175]
 v_mfma_f32_16x16x32_bf16 v[172:175], a[200:203], a[136:139], v[172:175]
 global_load_dwordx4 a[192:195], v0, s[70:71] offset:0 sc1
 v_mfma_f32_16x16x32_bf16 v[176:179], a[200:203], a[144:147], v[176:179]
 v_mfma_f32_16x16x32_bf16 v[176:179], a[204:207], a[148:151], v[176:179]
 v_mfma_f32_16x16x32_bf16 v[180:183], a[204:207], a[156:159], v[180:183]
 v_mfma_f32_16x16x32_bf16 v[180:183], a[200:203], a[152:155], v[180:183]
 v_mfma_f32_16x16x32_bf16 v[184:187], a[200:203], a[160:163], v[184:187]
 v_mfma_f32_16x16x32_bf16 v[184:187], a[204:207], a[164:167], v[184:187]
 v_mfma_f32_16x16x32_bf16 v[188:191], a[204:207], a[172:175], v[188:191]
 v_mfma_f32_16x16x32_bf16 v[188:191], a[200:203], a[168:171], v[188:191]
 v_mfma_f32_16x16x32_bf16 v[192:195], a[200:203], a[176:179], v[192:195]
 v_mfma_f32_16x16x32_bf16 v[192:195], a[204:207], a[180:183], v[192:195]
 v_mfma_f32_16x16x32_bf16 v[196:199], a[204:207], a[188:191], v[196:199]
 v_mfma_f32_16x16x32_bf16 v[196:199], a[200:203], a[184:187], v[196:199]
 s_waitcnt vmcnt(8)
 v_mfma_f32_16x16x32_bf16 v[228:231], a[208:211], a[184:187], v[228:231]
 v_mfma_f32_16x16x32_bf16 v[228:231], a[212:215], a[188:191], v[228:231]
 global_load_dwordx4 a[204:207], v0, s[70:71] offset:3072 sc1
 v_mfma_f32_16x16x32_bf16 v[224:227], a[212:215], a[180:183], v[224:227]
 v_mfma_f32_16x16x32_bf16 v[224:227], a[208:211], a[176:179], v[224:227]
 global_load_dwordx4 a[200:203], v0, s[70:71] offset:2048 sc1
 v_mfma_f32_16x16x32_bf16 v[220:223], a[208:211], a[168:171], v[220:223]
 s_add_u32 s70, s70, 8192
 s_addc_u32 s71, s71, 0
 v_mfma_f32_16x16x32_bf16 v[220:223], a[212:215], a[172:175], v[220:223]
 v_mfma_f32_16x16x32_bf16 v[216:219], a[212:215], a[164:167], v[216:219]
 v_mfma_f32_16x16x32_bf16 v[216:219], a[208:211], a[160:163], v[216:219]
 v_mfma_f32_16x16x32_bf16 v[212:215], a[208:211], a[152:155], v[212:215]
 v_mfma_f32_16x16x32_bf16 v[212:215], a[212:215], a[156:159], v[212:215]
 v_mfma_f32_16x16x32_bf16 v[208:211], a[212:215], a[148:151], v[208:211]
 s_waitcnt lgkmcnt(0)
 s_barrier
 v_mfma_f32_16x16x32_bf16 v[208:211], a[208:211], a[144:147], v[208:211]
 v_mfma_f32_16x16x32_bf16 v[204:207], a[208:211], a[136:139], v[204:207]
 v_mfma_f32_16x16x32_bf16 v[204:207], a[212:215], a[140:143], v[204:207]
 v_mfma_f32_16x16x32_bf16 v[200:203], a[212:215], a[132:135], v[200:203]
 v_mfma_f32_16x16x32_bf16 v[200:203], a[208:211], a[128:131], v[200:203]
 s_waitcnt vmcnt(8)
 v_mfma_f32_16x16x32_bf16 v[232:235], a[216:219], a[128:131], v[232:235]
 ds_read_b128 a[128:131], v1 offset:2048
 v_mfma_f32_16x16x32_bf16 v[232:235], a[220:223], a[132:135], v[232:235]
 global_load_dwordx4 a[212:215], v0, s[70:71] offset:-3072 sc1
 ds_read_b128 a[132:135], v1 offset:3072
 v_mfma_f32_16x16x32_bf16 v[236:239], a[220:223], a[140:143], v[236:239]
 ds_read_b128 a[140:143], v1 offset:7168
 v_mfma_f32_16x16x32_bf16 v[236:239], a[216:219], a[136:139], v[236:239]
 global_load_dwordx4 a[208:211], v0, s[70:71] offset:-4096 sc1
 ds_read_b128 a[136:139], v1 offset:6144
 v_mfma_f32_16x16x32_bf16 v[240:243], a[216:219], a[144:147], v[240:243]
 ds_read_b128 a[144:147], v1 offset:10240
 v_mfma_f32_16x16x32_bf16 v[240:243], a[220:223], a[148:151], v[240:243]
 ds_read_b128 a[148:151], v1 offset:11264
 v_mfma_f32_16x16x32_bf16 v[244:247], a[220:223], a[156:159], v[244:247]
 ds_read_b128 a[156:159], v1 offset:15360
 v_mfma_f32_16x16x32_bf16 v[244:247], a[216:219], a[152:155], v[244:247]
 ds_read_b128 a[152:155], v1 offset:14336
 v_mfma_f32_16x16x32_bf16 v[248:251], a[216:219], a[160:163], v[248:251]
 ds_read_b128 a[160:163], v1 offset:18432
 v_mfma_f32_16x16x32_bf16 v[248:251], a[220:223], a[164:167], v[248:251]
 ds_read_b128 a[164:167], v1 offset:19456
 v_mfma_f32_16x16x32_bf16 v[252:255], a[220:223], a[172:175], v[252:255]
 ds_read_b128 a[172:175], v1 offset:23552
 v_mfma_f32_16x16x32_bf16 v[252:255], a[216:219], a[168:171], v[252:255]
 ds_read_b128 a[168:171], v1 offset:22528
 v_mfma_f32_16x16x32_bf16 a[248:251], a[216:219], a[176:179], a[248:251]
 ds_read_b128 a[176:179], v1 offset:26624
 v_mfma_f32_16x16x32_bf16 a[248:251], a[220:223], a[180:183], a[248:251]
 ds_read_b128 a[180:183], v1 offset:27648
 v_mfma_f32_16x16x32_bf16 a[252:255], a[220:223], a[188:191], a[252:255]
 global_load_dwordx4 a[220:223], v0, s[70:71] offset:-1024 sc1
 ds_read_b128 a[188:191], v1 offset:31744
 v_mfma_f32_16x16x32_bf16 a[252:255], a[216:219], a[184:187], a[252:255]
 global_load_dwordx4 a[216:219], v0, s[70:71] offset:-2048 sc1
 ds_read_b128 a[184:187], v1 offset:30720
 s_waitcnt vmcnt(10) lgkmcnt(8)
 v_mfma_f32_16x16x32_bf16 v[16:19], a[224:227], a[128:131], v[16:19]
 v_mov_b32 v7, 1
 v_mfma_f32_16x16x32_bf16 v[16:19], a[228:231], a[132:135], v[16:19]
 v_mfma_f32_16x16x32_bf16 v[20:23], a[228:231], a[140:143], v[20:23]
 buffer_atomic_add v7, v0, s[56:59], 0 offen sc1
 v_mfma_f32_16x16x32_bf16 v[20:23], a[224:227], a[136:139], v[20:23]
 v_lshrrev_b32 v4, 8, v1
 v_mfma_f32_16x16x32_bf16 v[24:27], a[224:227], a[144:147], v[24:27]
 v_mfma_f32_16x16x32_bf16 v[24:27], a[228:231], a[148:151], v[24:27]
 v_lshl_add_u32 v4, v4, 5, s51
 v_mfma_f32_16x16x32_bf16 v[28:31], a[228:231], a[156:159], v[28:31]
 ds_read_b128 v[8:11], v4 offset:256
 v_mfma_f32_16x16x32_bf16 v[28:31], a[224:227], a[152:155], v[28:31]
 s_waitcnt lgkmcnt(1)
 v_mfma_f32_16x16x32_bf16 v[32:35], a[224:227], a[160:163], v[32:35]
 v_mfma_f32_16x16x32_bf16 v[32:35], a[228:231], a[164:167], v[32:35]
 v_mfma_f32_16x16x32_bf16 v[36:39], a[228:231], a[172:175], v[36:39]
 v_mfma_f32_16x16x32_bf16 v[36:39], a[224:227], a[168:171], v[36:39]
 v_mfma_f32_16x16x32_bf16 v[40:43], a[224:227], a[176:179], v[40:43]
 v_mfma_f32_16x16x32_bf16 v[40:43], a[228:231], a[180:183], v[40:43]
 v_mfma_f32_16x16x32_bf16 v[44:47], a[228:231], a[188:191], v[44:47]
 v_mfma_f32_16x16x32_bf16 v[44:47], a[224:227], a[184:187], v[44:47]
 s_waitcnt vmcnt(9)
 v_mfma_f32_16x16x32_bf16 v[76:79], a[232:235], a[184:187], v[76:79]
 v_mfma_f32_16x16x32_bf16 v[76:79], a[236:239], a[188:191], v[76:79]
 global_load_dwordx4 a[228:231], v0, s[70:71] offset:1024 sc1
 v_mfma_f32_16x16x32_bf16 v[72:75], a[236:239], a[180:183], v[72:75]
 v_mfma_f32_16x16x32_bf16 v[72:75], a[232:235], a[176:179], v[72:75]
 global_load_dwordx4 a[224:227], v0, s[70:71] offset:0 sc1
 v_mfma_f32_16x16x32_bf16 v[68:71], a[232:235], a[168:171], v[68:71]
 s_waitcnt lgkmcnt(0)
 v_mfma_f32_16x16x32_bf16 v[68:71], a[236:239], a[172:175], v[68:71]
 v_mfma_f32_16x16x32_bf16 v[64:67], a[236:239], a[164:167], v[64:67]
 v_add_f32 v136, v136, v8
 v_mfma_f32_16x16x32_bf16 v[64:67], a[232:235], a[160:163], v[64:67]
 v_mfma_f32_16x16x32_bf16 v[60:63], a[232:235], a[152:155], v[60:63]
 ds_read_b128 v[12:15], v4 offset:272
 v_mfma_f32_16x16x32_bf16 v[60:63], a[236:239], a[156:159], v[60:63]
 v_add_f32 v137, v137, v9
 v_mfma_f32_16x16x32_bf16 v[56:59], a[236:239], a[148:151], v[56:59]
 v_mfma_f32_16x16x32_bf16 v[56:59], a[232:235], a[144:147], v[56:59]
 v_add_f32 v138, v138, v10
 v_mfma_f32_16x16x32_bf16 v[52:55], a[232:235], a[136:139], v[52:55]
 v_add_f32 v139, v139, v11
 v_mfma_f32_16x16x32_bf16 v[52:55], a[236:239], a[140:143], v[52:55]
 v_mfma_f32_16x16x32_bf16 v[48:51], a[236:239], a[132:135], v[48:51]
 v_add_f32 v140, v140, v8
 v_mfma_f32_16x16x32_bf16 v[48:51], a[232:235], a[128:131], v[48:51]
 v_add_f32 v141, v141, v9
 s_waitcnt vmcnt(9)
 v_mfma_f32_16x16x32_bf16 v[80:83], a[192:195], a[128:131], v[80:83]
 v_mfma_f32_16x16x32_bf16 v[80:83], a[196:199], a[132:135], v[80:83]
 global_load_dwordx4 a[236:239], v0, s[70:71] offset:3072 sc1
 v_add_f32 v142, v142, v10
 v_mfma_f32_16x16x32_bf16 v[84:87], a[196:199], a[140:143], v[84:87]
 v_add_f32 v143, v143, v11
 v_mfma_f32_16x16x32_bf16 v[84:87], a[192:195], a[136:139], v[84:87]
 global_load_dwordx4 a[232:235], v0, s[70:71] offset:2048 sc1
 v_mfma_f32_16x16x32_bf16 v[88:91], a[192:195], a[144:147], v[88:91]
 v_add_f32 v144, v144, v8
 s_add_u32 s70, s70, 8192
 s_addc_u32 s71, s71, 0
 v_mfma_f32_16x16x32_bf16 v[88:91], a[196:199], a[148:151], v[88:91]
 v_mfma_f32_16x16x32_bf16 v[92:95], a[196:199], a[156:159], v[92:95]
 v_add_f32 v145, v145, v9
 v_mfma_f32_16x16x32_bf16 v[92:95], a[192:195], a[152:155], v[92:95]
 v_add_f32 v146, v146, v10
 v_mfma_f32_16x16x32_bf16 v[96:99], a[192:195], a[160:163], v[96:99]
 v_mfma_f32_16x16x32_bf16 v[96:99], a[196:199], a[164:167], v[96:99]
 v_add_f32 v147, v147, v11
 v_mfma_f32_16x16x32_bf16 v[100:103], a[196:199], a[172:175], v[100:103]
 v_add_f32 v148, v148, v8
 v_mfma_f32_16x16x32_bf16 v[100:103], a[192:195], a[168:171], v[100:103]
 v_mfma_f32_16x16x32_bf16 v[104:107], a[192:195], a[176:179], v[104:107]
 v_add_f32 v149, v149, v9
 v_mfma_f32_16x16x32_bf16 v[104:107], a[196:199], a[180:183], v[104:107]
 v_add_f32 v150, v150, v10
 v_mfma_f32_16x16x32_bf16 v[108:111], a[196:199], a[188:191], v[108:111]
 v_mfma_f32_16x16x32_bf16 v[108:111], a[192:195], a[184:187], v[108:111]
 v_add_f32 v151, v151, v11
 s_waitcnt vmcnt(9)
 v_mfma_f32_16x16x32_bf16 a[244:247], a[200:203], a[184:187], a[244:247]
 ds_read_b128 a[184:187], v1 offset:63488
 v_add_f32 v152, v152, v8
 v_mfma_f32_16x16x32_bf16 a[244:247], a[204:207], a[188:191], a[244:247]
 global_load_dwordx4 a[196:199], v0, s[70:71] offset:-3072 sc1
 ds_read_b128 a[188:191], v1 offset:64512
 v_mfma_f32_16x16x32_bf16 a[240:243], a[204:207], a[180:183], a[240:243]
 ds_read_b128 a[180:183], v1 offset:60416
 v_add_f32 v153, v153, v9
 v_mfma_f32_16x16x32_bf16 a[240:243], a[200:203], a[176:179], a[240:243]
 global_load_dwordx4 a[192:195], v0, s[70:71] offset:-4096 sc1
 ds_read_b128 a[176:179], v1 offset:59392
 v_mfma_f32_16x16x32_bf16 v[132:135], a[200:203], a[168:171], v[132:135]
 ds_read_b128 a[168:171], v1 offset:55296
 v_add_f32 v154, v154, v10
 v_mfma_f32_16x16x32_bf16 v[132:135], a[204:207], a[172:175], v[132:135]
 ds_read_b128 a[172:175], v1 offset:56320
 v_add_f32 v155, v155, v11
 v_mfma_f32_16x16x32_bf16 v[128:131], a[204:207], a[164:167], v[128:131]
 ds_read_b128 a[164:167], v1 offset:52224
 v_mfma_f32_16x16x32_bf16 v[128:131], a[200:203], a[160:163], v[128:131]
 ds_read_b128 a[160:163], v1 offset:51200
 v_add_f32 v156, v156, v8
 v_mfma_f32_16x16x32_bf16 v[124:127], a[200:203], a[152:155], v[124:127]
 ds_read_b128 a[152:155], v1 offset:47104
 v_add_f32 v157, v157, v9
 v_mfma_f32_16x16x32_bf16 v[124:127], a[204:207], a[156:159], v[124:127]
 ds_read_b128 a[156:159], v1 offset:48128
 v_mfma_f32_16x16x32_bf16 v[120:123], a[204:207], a[148:151], v[120:123]
 ds_read_b128 a[148:151], v1 offset:44032
 v_add_f32 v158, v158, v10
 v_mfma_f32_16x16x32_bf16 v[120:123], a[200:203], a[144:147], v[120:123]
 ds_read_b128 a[144:147], v1 offset:43008
 v_add_f32 v159, v159, v11
 v_mfma_f32_16x16x32_bf16 v[116:119], a[200:203], a[136:139], v[116:119]
 ds_read_b128 a[136:139], v1 offset:38912
 v_mfma_f32_16x16x32_bf16 v[116:119], a[204:207], a[140:143], v[116:119]
 ds_read_b128 a[140:143], v1 offset:39936
 v_add_f32 v160, v160, v8
 v_mfma_f32_16x16x32_bf16 v[112:115], a[204:207], a[132:135], v[112:115]
 ds_read_b128 a[132:135], v1 offset:35840
 v_add_f32 v161, v161, v9
 v_mfma_f32_16x16x32_bf16 v[112:115], a[200:203], a[128:131], v[112:115]
 ds_read_b128 a[128:131], v1 offset:34816
 s_waitcnt vmcnt(9) lgkmcnt(8)
 v_mfma_f32_16x16x32_bf16 v[44:47], a[208:211], a[184:187], v[44:47]
 v_add_f32 v162, v162, v10
 v_mfma_f32_16x16x32_bf16 v[44:47], a[212:215], a[188:191], v[44:47]
 global_load_dwordx4 a[204:207], v0, s[70:71] offset:-1024 sc1
 v_mfma_f32_16x16x32_bf16 v[40:43], a[212:215], a[180:183], v[40:43]
 v_add_f32 v163, v163, v11
 v_mfma_f32_16x16x32_bf16 v[40:43], a[208:211], a[176:179], v[40:43]
 global_load_dwordx4 a[200:203], v0, s[70:71] offset:-2048 sc1
 v_add_f32 v164, v164, v8
 v_mfma_f32_16x16x32_bf16 v[36:39], a[208:211], a[168:171], v[36:39]
 v_mfma_f32_16x16x32_bf16 v[36:39], a[212:215], a[172:175], v[36:39]
 v_add_f32 v165, v165, v9
 v_mfma_f32_16x16x32_bf16 v[32:35], a[212:215], a[164:167], v[32:35]
 v_add_f32 v166, v166, v10
 v_mfma_f32_16x16x32_bf16 v[32:35], a[208:211], a[160:163], v[32:35]
 s_waitcnt lgkmcnt(0)
 v_mfma_f32_16x16x32_bf16 v[28:31], a[208:211], a[152:155], v[28:31]
 v_add_f32 v167, v167, v11
 v_mfma_f32_16x16x32_bf16 v[28:31], a[212:215], a[156:159], v[28:31]
 v_mfma_f32_16x16x32_bf16 v[24:27], a[212:215], a[148:151], v[24:27]
 v_mfma_f32_16x16x32_bf16 v[24:27], a[208:211], a[144:147], v[24:27]
 v_add_f32 v168, v168, v12
 v_mfma_f32_16x16x32_bf16 v[20:23], a[208:211], a[136:139], v[20:23]
 ds_read_b128 v[8:11], v4 offset:384
 v_mfma_f32_16x16x32_bf16 v[20:23], a[212:215], a[140:143], v[20:23]
 v_mfma_f32_16x16x32_bf16 v[16:19], a[212:215], a[132:135], v[16:19]
 v_add_f32 v169, v169, v13
 v_mfma_f32_16x16x32_bf16 v[16:19], a[208:211], a[128:131], v[16:19]
 s_waitcnt vmcnt(9)
 v_mfma_f32_16x16x32_bf16 v[48:51], a[216:219], a[128:131], v[48:51]
 v_add_f32 v170, v170, v14
 v_mfma_f32_16x16x32_bf16 v[48:51], a[220:223], a[132:135], v[48:51]
 global_load_dwordx4 a[212:215], v0, s[70:71] offset:1024 sc1
 v_add_f32 v171, v171, v15
 v_mfma_f32_16x16x32_bf16 v[52:55], a[220:223], a[140:143], v[52:55]
 v_mfma_f32_16x16x32_bf16 v[52:55], a[216:219], a[136:139], v[52:55]
 global_load_dwordx4 a[208:211], v0, s[70:71] offset:0 sc1
 v_add_f32 v172, v172, v12
 v_mfma_f32_16x16x32_bf16 v[56:59], a[216:219], a[144:147], v[56:59]
 v_add_f32 v173, v173, v13
 v_mfma_f32_16x16x32_bf16 v[56:59], a[220:223], a[148:151], v[56:59]
 v_mfma_f32_16x16x32_bf16 v[60:63], a[220:223], a[156:159], v[60:63]
 v_add_f32 v174, v174, v14
 v_mfma_f32_16x16x32_bf16 v[60:63], a[216:219], a[152:155], v[60:63]
 v_add_f32 v175, v175, v15
 v_mfma_f32_16x16x32_bf16 v[64:67], a[216:219], a[160:163], v[64:67]
 v_mfma_f32_16x16x32_bf16 v[64:67], a[220:223], a[164:167], v[64:67]
 v_add_f32 v176, v176, v12
 v_mfma_f32_16x16x32_bf16 v[68:71], a[220:223], a[172:175], v[68:71]
 v_add_f32 v177, v177, v13
 v_mfma_f32_16x16x32_bf16 v[68:71], a[216:219], a[168:171], v[68:71]
 v_mfma_f32_16x16x32_bf16 v[72:75], a[216:219], a[176:179], v[72:75]
 v_add_f32 v178, v178, v14
 v_mfma_f32_16x16x32_bf16 v[72:75], a[220:223], a[180:183], v[72:75]
 v_mfma_f32_16x16x32_bf16 v[76:79], a[220:223], a[188:191], v[76:79]
 v_add_f32 v179, v179, v15
 v_mfma_f32_16x16x32_bf16 v[76:79], a[216:219], a[184:187], v[76:79]
 v_add_f32 v180, v180, v12
 s_waitcnt vmcnt(8)
 v_mfma_f32_16x16x32_bf16 v[108:111], a[224:227], a[184:187], v[108:111]
 v_mfma_f32_16x16x32_bf16 v[108:111], a[228:231], a[188:191], v[108:111]
 global_load_dwordx4 a[220:223], v0, s[70:71] offset:3072 sc1
 v_add_f32 v181, v181, v13
 v_mfma_f32_16x16x32_bf16 v[104:107], a[228:231], a[180:183], v[104:107]
 v_add_f32 v182, v182, v14
 v_mfma_f32_16x16x32_bf16 v[104:107], a[224:227], a[176:179], v[104:107]
 global_load_dwordx4 a[216:219], v0, s[70:71] offset:2048 sc1
 v_mfma_f32_16x16x32_bf16 v[100:103], a[224:227], a[168:171], v[100:103]
 v_add_f32 v183, v183, v15
 s_add_u32 s70, s70, 8192
 s_addc_u32 s71, s71, 0
 v_mfma_f32_16x16x32_bf16 v[100:103], a[228:231], a[172:175], v[100:103]
 v_add_f32 v184, v184, v12
 v_mfma_f32_16x16x32_bf16 v[96:99], a[228:231], a[164:167], v[96:99]
 v_mfma_f32_16x16x32_bf16 v[96:99], a[224:227], a[160:163], v[96:99]
 v_add_f32 v185, v185, v13
 v_mfma_f32_16x16x32_bf16 v[92:95], a[224:227], a[152:155], v[92:95]
 v_add_f32 v186, v186, v14
 v_mfma_f32_16x16x32_bf16 v[92:95], a[228:231], a[156:159], v[92:95]
 v_mfma_f32_16x16x32_bf16 v[88:91], a[228:231], a[148:151], v[88:91]
 v_add_f32 v187, v187, v15
 v_mfma_f32_16x16x32_bf16 v[88:91], a[224:227], a[144:147], v[88:91]
 v_mfma_f32_16x16x32_bf16 v[84:87], a[224:227], a[136:139], v[84:87]
 v_add_f32 v188, v188, v12
 v_mfma_f32_16x16x32_bf16 v[84:87], a[228:231], a[140:143], v[84:87]
 v_add_f32 v189, v189, v13
 v_mfma_f32_16x16x32_bf16 v[80:83], a[228:231], a[132:135], v[80:83]
 v_mfma_f32_16x16x32_bf16 v[80:83], a[224:227], a[128:131], v[80:83]
 v_add_f32 v190, v190, v14
 s_waitcnt vmcnt(8)
 v_mfma_f32_16x16x32_bf16 v[112:115], a[232:235], a[128:131], v[112:115]
 ds_read_b128 a[128:131], v2 offset:2048
 v_add_f32 v191, v191, v15
 v_mfma_f32_16x16x32_bf16 v[112:115], a[236:239], a[132:135], v[112:115]
 global_load_dwordx4 a[228:231], v0, s[70:71] offset:-3072 sc1
 ds_read_b128 a[132:135], v2 offset:3072
 v_mfma_f32_16x16x32_bf16 v[116:119], a[236:239], a[140:143], v[116:119]
 ds_read_b128 a[140:143], v2 offset:7168
 v_add_f32 v192, v192, v12
 v_mfma_f32_16x16x32_bf16 v[116:119], a[232:235], a[136:139], v[116:119]
 global_load_dwordx4 a[224:227], v0, s[70:71] offset:-4096 sc1
 ds_read_b128 a[136:139], v2 offset:6144
 v_mfma_f32_16x16x32_bf16 v[120:123], a[232:235], a[144:147], v[120:123]
 ds_read_b128 a[144:147], v2 offset:10240
 v_add_f32 v193, v193, v13
 v_mfma_f32_16x16x32_bf16 v[120:123], a[236:239], a[148:151], v[120:123]
 ds_read_b128 a[148:151], v2 offset:11264
 v_add_f32 v194, v194, v14
 v_mfma_f32_16x16x32_bf16 v[124:127], a[236:239], a[156:159], v[124:127]
 ds_read_b128 a[156:159], v2 offset:15360
 v_add_f32 v195, v195, v15
 v_mfma_f32_16x16x32_bf16 v[124:127], a[232:235], a[152:155], v[124:127]
 ds_read_b128 a[152:155], v2 offset:14336
 v_mfma_f32_16x16x32_bf16 v[128:131], a[232:235], a[160:163], v[128:131]
 ds_read_b128 a[160:163], v2 offset:18432
 v_add_f32 v196, v196, v12
 v_mfma_f32_16x16x32_bf16 v[128:131], a[236:239], a[164:167], v[128:131]
 ds_read_b128 a[164:167], v2 offset:19456
 v_mfma_f32_16x16x32_bf16 v[132:135], a[236:239], a[172:175], v[132:135]
 ds_read_b128 a[172:175], v2 offset:23552
 v_add_f32 v197, v197, v13
 v_mfma_f32_16x16x32_bf16 v[132:135], a[232:235], a[168:171], v[132:135]
 ds_read_b128 a[168:171], v2 offset:22528
 v_add_f32 v198, v198, v14
 v_mfma_f32_16x16x32_bf16 a[240:243], a[232:235], a[176:179], a[240:243]
 ds_read_b128 a[176:179], v2 offset:26624
 v_mfma_f32_16x16x32_bf16 a[240:243], a[236:239], a[180:183], a[240:243]
 ds_read_b128 a[180:183], v2 offset:27648
 v_add_f32 v199, v199, v15
 v_mfma_f32_16x16x32_bf16 a[244:247], a[236:239], a[188:191], a[244:247]
 ds_read_b128 a[188:191], v2 offset:31744
 s_waitcnt lgkmcnt(15)
 v_mfma_f32_16x16x32_bf16 a[244:247], a[232:235], a[184:187], a[244:247]
 ds_read_b128 a[184:187], v2 offset:30720
 s_waitcnt vmcnt(8) lgkmcnt(8)
 v_mfma_f32_16x16x32_bf16 v[16:19], a[192:195], a[128:131], v[16:19]
 v_add_f32 v200, v200, v8
 v_mfma_f32_16x16x32_bf16 v[16:19], a[196:199], a[132:135], v[16:19]
 global_load_dwordx4 a[236:239], v0, s[70:71] offset:-1024 sc1
 ds_read_b128 v[12:15], v4 offset:400
 v_mfma_f32_16x16x32_bf16 v[20:23], a[196:199], a[140:143], v[20:23]
 v_mfma_f32_16x16x32_bf16 v[20:23], a[192:195], a[136:139], v[20:23]
 global_load_dwordx4 a[232:235], v0, s[70:71] offset:-2048 sc1
 v_add_f32 v201, v201, v9
 v_mfma_f32_16x16x32_bf16 v[24:27], a[192:195], a[144:147], v[24:27]
 v_add_f32 v202, v202, v10
 v_mfma_f32_16x16x32_bf16 v[24:27], a[196:199], a[148:151], v[24:27]
 v_mfma_f32_16x16x32_bf16 v[28:31], a[196:199], a[156:159], v[28:31]
 v_add_f32 v203, v203, v11
 v_mfma_f32_16x16x32_bf16 v[28:31], a[192:195], a[152:155], v[28:31]
 s_waitcnt lgkmcnt(1)
 v_mfma_f32_16x16x32_bf16 v[32:35], a[192:195], a[160:163], v[32:35]
 v_add_f32 v204, v204, v8
 v_mfma_f32_16x16x32_bf16 v[32:35], a[196:199], a[164:167], v[32:35]
 v_add_f32 v205, v205, v9
 v_mfma_f32_16x16x32_bf16 v[36:39], a[196:199], a[172:175], v[36:39]
 v_mfma_f32_16x16x32_bf16 v[36:39], a[192:195], a[168:171], v[36:39]
 v_add_f32 v206, v206, v10
 v_mfma_f32_16x16x32_bf16 v[40:43], a[192:195], a[176:179], v[40:43]
 v_add_f32 v207, v207, v11
 v_mfma_f32_16x16x32_bf16 v[40:43], a[196:199], a[180:183], v[40:43]
 v_mfma_f32_16x16x32_bf16 v[44:47], a[196:199], a[188:191], v[44:47]
 v_add_f32 v208, v208, v8
 v_mfma_f32_16x16x32_bf16 v[44:47], a[192:195], a[184:187], v[44:47]
 v_add_f32 v209, v209, v9
 s_waitcnt vmcnt(8)
 v_mfma_f32_16x16x32_bf16 v[76:79], a[200:203], a[184:187], v[76:79]
 v_mfma_f32_16x16x32_bf16 v[76:79], a[204:207], a[188:191], v[76:79]
 global_load_dwordx4 a[196:199], v0, s[70:71] offset:1024 sc1
 v_add_f32 v210, v210, v10
 v_mfma_f32_16x16x32_bf16 v[72:75], a[204:207], a[180:183], v[72:75]
 v_add_f32 v211, v211, v11
 v_mfma_f32_16x16x32_bf16 v[72:75], a[200:203], a[176:179], v[72:75]
 global_load_dwordx4 a[192:195], v0, s[70:71] offset:0 sc1
 v_mfma_f32_16x16x32_bf16 v[68:71], a[200:203], a[168:171], v[68:71]
 v_add_f32 v212, v212, v8
 v_mfma_f32_16x16x32_bf16 v[68:71], a[204:207], a[172:175], v[68:71]
 v_mfma_f32_16x16x32_bf16 v[64:67], a[204:207], a[164:167], v[64:67]
 v_add_f32 v213, v213, v9
 v_mfma_f32_16x16x32_bf16 v[64:67], a[200:203], a[160:163], v[64:67]
 v_add_f32 v214, v214, v10
 v_mfma_f32_16x16x32_bf16 v[60:63], a[200:203], a[152:155], v[60:63]
 v_mfma_f32_16x16x32_bf16 v[60:63], a[204:207], a[156:159], v[60:63]
 v_add_f32 v215, v215, v11
 v_mfma_f32_16x16x32_bf16 v[56:59], a[204:207], a[148:151], v[56:59]
 v_add_f32 v216, v216, v8
 v_mfma_f32_16x16x32_bf16 v[56:59], a[200:203], a[144:147], v[56:59]
 v_mfma_f32_16x16x32_bf16 v[52:55], a[200:203], a[136:139], v[52:55]
 v_add_f32 v217, v217, v9
 v_mfma_f32_16x16x32_bf16 v[52:55], a[204:207], a[140:143], v[52:55]
 v_add_f32 v218, v218, v10
 v_mfma_f32_16x16x32_bf16 v[48:51], a[204:207], a[132:135], v[48:51]
 v_mfma_f32_16x16x32_bf16 v[48:51], a[200:203], a[128:131], v[48:51]
 v_add_f32 v219, v219, v11
 s_waitcnt vmcnt(8)
 v_mfma_f32_16x16x32_bf16 v[80:83], a[208:211], a[128:131], v[80:83]
 v_add_f32 v220, v220, v8
 v_mfma_f32_16x16x32_bf16 v[80:83], a[212:215], a[132:135], v[80:83]
 global_load_dwordx4 a[204:207], v0, s[70:71] offset:3072 sc1
 v_mfma_f32_16x16x32_bf16 v[84:87], a[212:215], a[140:143], v[84:87]
 v_add_f32 v221, v221, v9
 v_mfma_f32_16x16x32_bf16 v[84:87], a[208:211], a[136:139], v[84:87]
 global_load_dwordx4 a[200:203], v0, s[70:71] offset:2048 sc1
 v_mfma_f32_16x16x32_bf16 v[88:91], a[208:211], a[144:147], v[88:91]
 v_add_f32 v222, v222, v10
 s_add_u32 s70, s70, 8192
 s_addc_u32 s71, s71, 0
 v_mfma_f32_16x16x32_bf16 v[88:91], a[212:215], a[148:151], v[88:91]
 v_add_f32 v223, v223, v11
 v_mfma_f32_16x16x32_bf16 v[92:95], a[212:215], a[156:159], v[92:95]
 v_mfma_f32_16x16x32_bf16 v[92:95], a[208:211], a[152:155], v[92:95]
 v_add_f32 v224, v224, v8
 v_mfma_f32_16x16x32_bf16 v[96:99], a[208:211], a[160:163], v[96:99]
 v_add_f32 v225, v225, v9
 v_mfma_f32_16x16x32_bf16 v[96:99], a[212:215], a[164:167], v[96:99]
 v_mfma_f32_16x16x32_bf16 v[100:103], a[212:215], a[172:175], v[100:103]
 v_add_f32 v226, v226, v10
 v_mfma_f32_16x16x32_bf16 v[100:103], a[208:211], a[168:171], v[100:103]
 v_add_f32 v227, v227, v11
 v_mfma_f32_16x16x32_bf16 v[104:107], a[208:211], a[176:179], v[104:107]
 v_mfma_f32_16x16x32_bf16 v[104:107], a[212:215], a[180:183], v[104:107]
 v_add_f32 v228, v228, v8
 v_mfma_f32_16x16x32_bf16 v[108:111], a[212:215], a[188:191], v[108:111]
 v_add_f32 v229, v229, v9
 v_mfma_f32_16x16x32_bf16 v[108:111], a[208:211], a[184:187], v[108:111]
 s_waitcnt vmcnt(8)
 v_mfma_f32_16x16x32_bf16 a[244:247], a[216:219], a[184:187], a[244:247]
 ds_read_b128 a[184:187], v2 offset:63488
 v_add_f32 v230, v230, v10
 v_mfma_f32_16x16x32_bf16 a[244:247], a[220:223], a[188:191], a[244:247]
 global_load_dwordx4 a[212:215], v0, s[70:71] offset:-3072 sc1
 ds_read_b128 a[188:191], v2 offset:64512
 v_mfma_f32_16x16x32_bf16 a[240:243], a[220:223], a[180:183], a[240:243]
 ds_read_b128 a[180:183], v2 offset:60416
 v_add_f32 v231, v231, v11
 v_mfma_f32_16x16x32_bf16 a[240:243], a[216:219], a[176:179], a[240:243]
 global_load_dwordx4 a[208:211], v0, s[70:71] offset:-4096 sc1
 ds_read_b128 a[176:179], v2 offset:59392
 s_waitcnt lgkmcnt(4)
 v_mfma_f32_16x16x32_bf16 v[132:135], a[216:219], a[168:171], v[132:135]
 ds_read_b128 a[168:171], v2 offset:55296
 v_mfma_f32_16x16x32_bf16 v[132:135], a[220:223], a[172:175], v[132:135]
 ds_read_b128 a[172:175], v2 offset:56320
 v_add_f32 v232, v232, v12
 v_mfma_f32_16x16x32_bf16 v[128:131], a[220:223], a[164:167], v[128:131]
 ds_read_b128 a[164:167], v2 offset:52224
 v_add_f32 v233, v233, v13
 v_mfma_f32_16x16x32_bf16 v[128:131], a[216:219], a[160:163], v[128:131]
 ds_read_b128 a[160:163], v2 offset:51200
 v_mfma_f32_16x16x32_bf16 v[124:127], a[216:219], a[152:155], v[124:127]
 ds_read_b128 a[152:155], v2 offset:47104
 v_add_f32 v234, v234, v14
 v_mfma_f32_16x16x32_bf16 v[124:127], a[220:223], a[156:159], v[124:127]
 ds_read_b128 a[156:159], v2 offset:48128
 v_add_f32 v235, v235, v15
 v_mfma_f32_16x16x32_bf16 v[120:123], a[220:223], a[148:151], v[120:123]
 ds_read_b128 a[148:151], v2 offset:44032
 v_mfma_f32_16x16x32_bf16 v[120:123], a[216:219], a[144:147], v[120:123]
 ds_read_b128 a[144:147], v2 offset:43008
 v_add_f32 v236, v236, v12
 v_mfma_f32_16x16x32_bf16 v[116:119], a[216:219], a[136:139], v[116:119]
 ds_read_b128 a[136:139], v2 offset:38912
 v_add_f32 v237, v237, v13
 v_mfma_f32_16x16x32_bf16 v[116:119], a[220:223], a[140:143], v[116:119]
 ds_read_b128 a[140:143], v2 offset:39936
 v_mfma_f32_16x16x32_bf16 v[112:115], a[220:223], a[132:135], v[112:115]
 ds_read_b128 a[132:135], v2 offset:35840
 v_add_f32 v238, v238, v14
 v_mfma_f32_16x16x32_bf16 v[112:115], a[216:219], a[128:131], v[112:115]
 ds_read_b128 a[128:131], v2 offset:34816
 s_waitcnt vmcnt(8) lgkmcnt(8)
 v_mfma_f32_16x16x32_bf16 v[44:47], a[224:227], a[184:187], v[44:47]
 v_add_f32 v239, v239, v15
 v_mfma_f32_16x16x32_bf16 v[44:47], a[228:231], a[188:191], v[44:47]
 global_load_dwordx4 a[220:223], v0, s[70:71] offset:-1024 sc1
 v_add_f32 v240, v240, v12
 v_mfma_f32_16x16x32_bf16 v[40:43], a[228:231], a[180:183], v[40:43]
 v_mfma_f32_16x16x32_bf16 v[40:43], a[224:227], a[176:179], v[40:43]
 global_load_dwordx4 a[216:219], v0, s[70:71] offset:-2048 sc1
 v_add_f32 v241, v241, v13
 v_mfma_f32_16x16x32_bf16 v[36:39], a[224:227], a[168:171], v[36:39]
 v_add_f32 v242, v242, v14
 v_mfma_f32_16x16x32_bf16 v[36:39], a[228:231], a[172:175], v[36:39]
 v_mfma_f32_16x16x32_bf16 v[32:35], a[228:231], a[164:167], v[32:35]
 v_add_f32 v243, v243, v15
 v_mfma_f32_16x16x32_bf16 v[32:35], a[224:227], a[160:163], v[32:35]
 v_add_f32 v244, v244, v12
 s_waitcnt lgkmcnt(0)
 v_mfma_f32_16x16x32_bf16 v[28:31], a[224:227], a[152:155], v[28:31]
 v_mfma_f32_16x16x32_bf16 v[28:31], a[228:231], a[156:159], v[28:31]
 v_add_f32 v245, v245, v13
 v_mfma_f32_16x16x32_bf16 v[24:27], a[228:231], a[148:151], v[24:27]
 v_add_f32 v246, v246, v14
 v_mfma_f32_16x16x32_bf16 v[24:27], a[224:227], a[144:147], v[24:27]
 v_mfma_f32_16x16x32_bf16 v[20:23], a[224:227], a[136:139], v[20:23]
 v_add_f32 v247, v247, v15
 v_mfma_f32_16x16x32_bf16 v[20:23], a[228:231], a[140:143], v[20:23]
 v_mfma_f32_16x16x32_bf16 v[16:19], a[228:231], a[132:135], v[16:19]
 v_add_f32 v248, v248, v12
 v_mfma_f32_16x16x32_bf16 v[16:19], a[224:227], a[128:131], v[16:19]
 v_add_f32 v249, v249, v13
 s_waitcnt vmcnt(8)
 v_mfma_f32_16x16x32_bf16 v[48:51], a[232:235], a[128:131], v[48:51]
 v_mfma_f32_16x16x32_bf16 v[48:51], a[236:239], a[132:135], v[48:51]
 global_load_dwordx4 a[228:231], v0, s[70:71] offset:1024 sc1
 v_add_f32 v250, v250, v14
 v_mfma_f32_16x16x32_bf16 v[52:55], a[236:239], a[140:143], v[52:55]
 v_add_f32 v251, v251, v15
 v_mfma_f32_16x16x32_bf16 v[52:55], a[232:235], a[136:139], v[52:55]
 global_load_dwordx4 a[224:227], v0, s[70:71] offset:0 sc1
 v_mfma_f32_16x16x32_bf16 v[56:59], a[232:235], a[144:147], v[56:59]
 v_add_f32 v252, v252, v12
 v_mfma_f32_16x16x32_bf16 v[56:59], a[236:239], a[148:151], v[56:59]
 v_add_f32 v253, v253, v13
 v_mfma_f32_16x16x32_bf16 v[60:63], a[236:239], a[156:159], v[60:63]
 v_mfma_f32_16x16x32_bf16 v[60:63], a[232:235], a[152:155], v[60:63]
 v_add_f32 v254, v254, v14
 v_mfma_f32_16x16x32_bf16 v[64:67], a[232:235], a[160:163], v[64:67]
 v_add_f32 v255, v255, v15
 v_mfma_f32_16x16x32_bf16 v[64:67], a[236:239], a[164:167], v[64:67]
 v_mfma_f32_16x16x32_bf16 v[68:71], a[236:239], a[172:175], v[68:71]
 v_accvgpr_read_b32 v5, a248
 v_mfma_f32_16x16x32_bf16 v[68:71], a[232:235], a[168:171], v[68:71]
 v_mfma_f32_16x16x32_bf16 v[72:75], a[232:235], a[176:179], v[72:75]
 v_add_f32 v5, v5, v12
 v_mfma_f32_16x16x32_bf16 v[72:75], a[236:239], a[180:183], v[72:75]
 v_accvgpr_write_b32 a248, v5
 v_mfma_f32_16x16x32_bf16 v[76:79], a[236:239], a[188:191], v[76:79]
 v_mfma_f32_16x16x32_bf16 v[76:79], a[232:235], a[184:187], v[76:79]
 v_accvgpr_read_b32 v6, a249
 s_waitcnt vmcnt(8)
 v_mfma_f32_16x16x32_bf16 v[108:111], a[192:195], a[184:187], v[108:111]
 v_add_f32 v6, v6, v13
 v_mfma_f32_16x16x32_bf16 v[108:111], a[196:199], a[188:191], v[108:111]
 global_load_dwordx4 a[236:239], v0, s[70:71] offset:3072 sc1
 v_mfma_f32_16x16x32_bf16 v[104:107], a[196:199], a[180:183], v[104:107]
 v_accvgpr_write_b32 a249, v6
 v_mfma_f32_16x16x32_bf16 v[104:107], a[192:195], a[176:179], v[104:107]
 global_load_dwordx4 a[232:235], v0, s[70:71] offset:2048 sc1
 v_accvgpr_read_b32 v5, a250
 v_mfma_f32_16x16x32_bf16 v[100:103], a[192:195], a[168:171], v[100:103]
 s_add_u32 s70, s70, 8192
 s_addc_u32 s71, s71, 0
 v_mfma_f32_16x16x32_bf16 v[100:103], a[196:199], a[172:175], v[100:103]
 v_add_f32 v5, v5, v14
 v_mfma_f32_16x16x32_bf16 v[96:99], a[196:199], a[164:167], v[96:99]
 v_accvgpr_write_b32 a250, v5
 v_mfma_f32_16x16x32_bf16 v[96:99], a[192:195], a[160:163], v[96:99]
 v_mfma_f32_16x16x32_bf16 v[92:95], a[192:195], a[152:155], v[92:95]
 v_accvgpr_read_b32 v6, a251
 v_mfma_f32_16x16x32_bf16 v[92:95], a[196:199], a[156:159], v[92:95]
 v_mfma_f32_16x16x32_bf16 v[88:91], a[196:199], a[148:151], v[88:91]
 v_add_f32 v6, v6, v15
 v_mfma_f32_16x16x32_bf16 v[88:91], a[192:195], a[144:147], v[88:91]
 v_accvgpr_write_b32 a251, v6
 v_mfma_f32_16x16x32_bf16 v[84:87], a[192:195], a[136:139], v[84:87]
 v_mfma_f32_16x16x32_bf16 v[84:87], a[196:199], a[140:143], v[84:87]
 v_accvgpr_read_b32 v5, a252
 v_mfma_f32_16x16x32_bf16 v[80:83], a[196:199], a[132:135], v[80:83]
 v_add_f32 v5, v5, v12
 v_mfma_f32_16x16x32_bf16 v[80:83], a[192:195], a[128:131], v[80:83]
 s_waitcnt vmcnt(8)
 v_mfma_f32_16x16x32_bf16 v[112:115], a[200:203], a[128:131], v[112:115]
 ds_read_b128 a[128:131], v1 offset:2048
 v_accvgpr_write_b32 a252, v5
 v_mfma_f32_16x16x32_bf16 v[112:115], a[204:207], a[132:135], v[112:115]
 global_load_dwordx4 a[196:199], v0, s[70:71] offset:-3072 sc1
 ds_read_b128 a[132:135], v1 offset:3072
 v_mfma_f32_16x16x32_bf16 v[116:119], a[204:207], a[140:143], v[116:119]
 ds_read_b128 a[140:143], v1 offset:7168
 v_accvgpr_read_b32 v6, a253
 v_mfma_f32_16x16x32_bf16 v[116:119], a[200:203], a[136:139], v[116:119]
 global_load_dwordx4 a[192:195], v0, s[70:71] offset:-4096 sc1
 ds_read_b128 a[136:139], v1 offset:6144
 v_mfma_f32_16x16x32_bf16 v[120:123], a[200:203], a[144:147], v[120:123]
 ds_read_b128 a[144:147], v1 offset:10240
 v_add_f32 v6, v6, v13
 v_mfma_f32_16x16x32_bf16 v[120:123], a[204:207], a[148:151], v[120:123]
 ds_read_b128 a[148:151], v1 offset:11264
 v_accvgpr_write_b32 a253, v6
 v_mfma_f32_16x16x32_bf16 v[124:127], a[204:207], a[156:159], v[124:127]
 ds_read_b128 a[156:159], v1 offset:15360
 v_accvgpr_read_b32 v5, a254
 v_mfma_f32_16x16x32_bf16 v[124:127], a[200:203], a[152:155], v[124:127]
 ds_read_b128 a[152:155], v1 offset:14336
 v_mfma_f32_16x16x32_bf16 v[128:131], a[200:203], a[160:163], v[128:131]
 ds_read_b128 a[160:163], v1 offset:18432
 v_add_f32 v5, v5, v14
 v_mfma_f32_16x16x32_bf16 v[128:131], a[204:207], a[164:167], v[128:131]
 ds_read_b128 a[164:167], v1 offset:19456
 v_accvgpr_write_b32 a254, v5
 v_mfma_f32_16x16x32_bf16 v[132:135], a[204:207], a[172:175], v[132:135]
 ds_read_b128 a[172:175], v1 offset:23552
 v_mfma_f32_16x16x32_bf16 v[132:135], a[200:203], a[168:171], v[132:135]
 ds_read_b128 a[168:171], v1 offset:22528
 v_accvgpr_read_b32 v6, a255
 v_mfma_f32_16x16x32_bf16 a[240:243], a[200:203], a[176:179], a[240:243]
 ds_read_b128 a[176:179], v1 offset:26624
 v_add_f32 v6, v6, v15
 v_mfma_f32_16x16x32_bf16 a[240:243], a[204:207], a[180:183], a[240:243]
 ds_read_b128 a[180:183], v1 offset:27648
 v_accvgpr_write_b32 a255, v6
 v_mfma_f32_16x16x32_bf16 a[244:247], a[204:207], a[188:191], a[244:247]
 global_load_dwordx4 a[204:207], v0, s[70:71] offset:-1024 sc1
 ds_read_b128 a[188:191], v1 offset:31744
 v_mfma_f32_16x16x32_bf16 a[244:247], a[200:203], a[184:187], a[244:247]
 global_load_dwordx4 a[200:203], v0, s[70:71] offset:-2048 sc1
 ds_read_b128 a[184:187], v1 offset:30720
 s_waitcnt vmcnt(10) lgkmcnt(8)
 s_mov_b32 s8, s32
 s_mov_b32 s9, s33
 s_mov_b32 s10, s34
 s_mov_b32 s20, 1024
 s_mov_b32 s21, 1024
 s_mov_b32 s22, 1024
 s_xor_b32 s30, s29, 131072
 s_add_u32 s51, s51, 2048
 s_add_u32 s25, s25, 1
 s_cmp_eq_u32 s25, 6
 s_cbranch_scc1 Llast
 v_mfma_f32_16x16x32_bf16 v[136:139], a[208:211], a[128:131], v[136:139]
 v_accvgpr_read_b32 v5, a0
 v_lshlrev_b32 v6, 16, v5
 v_mfma_f32_16x16x32_bf16 v[136:139], a[212:215], a[132:135], v[136:139]
 v_and_b32 v5, s26, v5
 v_mul_f32 v6, v6, v16
 v_mfma_f32_16x16x32_bf16 v[140:143], a[212:215], a[140:143], v[140:143]
 v_mul_f32 v5, v5, v17
 v_cvt_pk_bf16_f32 v8, v6, v5
 v_mfma_f32_16x16x32_bf16 v[140:143], a[208:211], a[136:139], v[140:143]
 v_accvgpr_read_b32 v5, a1
 v_mfma_f32_16x16x32_bf16 v[144:147], a[208:211], a[144:147], v[144:147]
 v_lshlrev_b32 v6, 16, v5
 v_and_b32 v5, s26, v5
 v_mfma_f32_16x16x32_bf16 v[144:147], a[212:215], a[148:151], v[144:147]
 v_mul_f32 v6, v6, v18
 v_mul_f32 v5, v5, v19
 v_mfma_f32_16x16x32_bf16 v[148:151], a[212:215], a[156:159], v[148:151]
 v_cvt_pk_bf16_f32 v9, v6, v5
 v_accvgpr_read_b32 v5, a2
 v_mfma_f32_16x16x32_bf16 v[148:151], a[208:211], a[152:155], v[148:151]
 v_lshlrev_b32 v6, 16, v5
 v_and_b32 v5, s26, v5
 s_waitcnt lgkmcnt(0)
 v_mfma_f32_16x16x32_bf16 v[152:155], a[208:211], a[160:163], v[152:155]
 v_mul_f32 v6, v6, v48
 v_mul_f32 v5, v5, v49
 v_mfma_f32_16x16x32_bf16 v[152:155], a[212:215], a[164:167], v[152:155]
 v_cvt_pk_bf16_f32 v10, v6, v5
 v_mfma_f32_16x16x32_bf16 v[156:159], a[212:215], a[172:175], v[156:159]
 v_accvgpr_read_b32 v5, a3
 v_lshlrev_b32 v6, 16, v5
 v_mfma_f32_16x16x32_bf16 v[156:159], a[208:211], a[168:171], v[156:159]
 v_and_b32 v5, s26, v5
 v_mul_f32 v6, v6, v50
 v_mfma_f32_16x16x32_bf16 v[160:163], a[208:211], a[176:179], v[160:163]
 v_mul_f32 v5, v5, v51
 v_cvt_pk_bf16_f32 v11, v6, v5
 v_mfma_f32_16x16x32_bf16 v[160:163], a[212:215], a[180:183], v[160:163]
 ds_write_b128 v3, v[8:11]
 s_add_u32 s68, s29, 0
 v_mfma_f32_16x16x32_bf16 v[164:167], a[212:215], a[188:191], v[164:167]
 buffer_store_dwordx4 v[8:11], v3, s[32:35], s68 offen sc1
 v_accvgpr_read_b32 v5, a32
 v_mfma_f32_16x16x32_bf16 v[164:167], a[208:211], a[184:187], v[164:167]
 v_lshlrev_b32 v6, 16, v5
 v_and_b32 v5, s26, v5
 s_waitcnt vmcnt(9)
 v_mfma_f32_16x16x32_bf16 v[196:199], a[216:219], a[184:187], v[196:199]
 v_mul_f32 v6, v6, v80
 v_mul_f32 v5, v5, v81
 v_mfma_f32_16x16x32_bf16 v[196:199], a[220:223], a[188:191], v[196:199]
 global_load_dwordx4 a[212:215], v0, s[70:71] offset:1024 sc1
 v_cvt_pk_bf16_f32 v12, v6, v5
 v_mfma_f32_16x16x32_bf16 v[192:195], a[220:223], a[180:183], v[192:195]
 v_accvgpr_read_b32 v5, a33
 v_lshlrev_b32 v6, 16, v5
 v_mfma_f32_16x16x32_bf16 v[192:195], a[216:219], a[176:179], v[192:195]
 global_load_dwordx4 a[208:211], v0, s[70:71] offset:0 sc1
 v_and_b32 v5, s26, v5
 v_mfma_f32_16x16x32_bf16 v[188:191], a[216:219], a[168:171], v[188:191]
 v_mul_f32 v6, v6, v82
 v_mul_f32 v5, v5, v83
 v_mfma_f32_16x16x32_bf16 v[188:191], a[220:223], a[172:175], v[188:191]
 v_cvt_pk_bf16_f32 v13, v6, v5
 v_accvgpr_read_b32 v5, a34
 v_mfma_f32_16x16x32_bf16 v[184:187], a[220:223], a[164:167], v[184:187]
 v_lshlrev_b32 v6, 16, v5
 v_and_b32 v5, s26, v5
 v_mfma_f32_16x16x32_bf16 v[184:187], a[216:219], a[160:163], v[184:187]
 v_mul_f32 v6, v6, v112
 v_mul_f32 v5, v5, v113
 v_mfma_f32_16x16x32_bf16 v[180:183], a[216:219], a[152:155], v[180:183]
 v_cvt_pk_bf16_f32 v14, v6, v5
 v_accvgpr_read_b32 v5, a35
 v_mfma_f32_16x16x32_bf16 v[180:183], a[220:223], a[156:159], v[180:183]
 v_lshlrev_b32 v6, 16, v5
 v_and_b32 v5, s26, v5
 v_mfma_f32_16x16x32_bf16 v[176:179], a[220:223], a[148:151], v[176:179]
 v_mul_f32 v6, v6, v114
 v_mul_f32 v5, v5, v115
 v_mfma_f32_16x16x32_bf16 v[176:179], a[216:219], a[144:147], v[176:179]
 v_cvt_pk_bf16_f32 v15, v6, v5
 v_mfma_f32_16x16x32_bf16 v[172:175], a[216:219], a[136:139], v[172:175]
 ds_write_b128 v3, v[12:15] offset:1024
 v_mfma_f32_16x16x32_bf16 v[172:175], a[220:223], a[140:143], v[172:175]
 buffer_store_dwordx4 v[12:15], v3, s[32:35], s68 offen offset:1024 sc1
 v_accvgpr_read_b32 v5, a4
 v_lshlrev_b32 v6, 16, v5
 v_and_b32 v5, s26, v5
 v_mul_f32 v6, v6, v20
 v_mfma_f32_16x16x32_bf16 v[168:171], a[220:223], a[132:135], v[168:171]
 v_mul_f32 v5, v5, v21
 v_cvt_pk_bf16_f32 v8, v6, v5
 v_mfma_f32_16x16x32_bf16 v[168:171], a[216:219], a[128:131], v[168:171]
 v_accvgpr_read_b32 v5, a5
 v_lshlrev_b32 v6, 16, v5
 s_waitcnt vmcnt(10)
 v_mfma_f32_16x16x32_bf16 v[200:203], a[224:227], a[128:131], v[200:203]
 v_and_b32 v5, s26, v5
 v_mul_f32 v6, v6, v22
 v_mfma_f32_16x16x32_bf16 v[200:203], a[228:231], a[132:135], v[200:203]
 global_load_dwordx4 a[220:223], v0, s[70:71] offset:3072 sc1
 v_mul_f32 v5, v5, v23
 v_mfma_f32_16x16x32_bf16 v[204:207], a[228:231], a[140:143], v[204:207]
 v_cvt_pk_bf16_f32 v9, v6, v5
 v_accvgpr_read_b32 v5, a6
 v_mfma_f32_16x16x32_bf16 v[204:207], a[224:227], a[136:139], v[204:207]
 global_load_dwordx4 a[216:219], v0, s[70:71] offset:2048 sc1
 v_lshlrev_b32 v6, 16, v5
 v_mfma_f32_16x16x32_bf16 v[208:211], a[224:227], a[144:147], v[208:211]
 v_and_b32 v5, s26, v5
 v_mul_f32 v6, v6, v52
 s_add_u32 s70, s70, 8192
 s_addc_u32 s71, s71, 0
 v_mfma_f32_16x16x32_bf16 v[208:211], a[228:231], a[148:151], v[208:211]
 v_mul_f32 v5, v5, v53
 v_cvt_pk_bf16_f32 v10, v6, v5
 v_mfma_f32_16x16x32_bf16 v[212:215], a[228:231], a[156:159], v[212:215]
 v_accvgpr_read_b32 v5, a7
 v_lshlrev_b32 v6, 16, v5
 v_mfma_f32_16x16x32_bf16 v[212:215], a[224:227], a[152:155], v[212:215]
 v_and_b32 v5, s26, v5
 v_mul_f32 v6, v6, v54
 v_mfma_f32_16x16x32_bf16 v[216:219], a[224:227], a[160:163], v[216:219]
 v_mul_f32 v5, v5, v55
 v_cvt_pk_bf16_f32 v11, v6, v5
 v_mfma_f32_16x16x32_bf16 v[216:219], a[228:231], a[164:167], v[216:219]
 ds_write_b128 v3, v[8:11] offset:4096
 v_mfma_f32_16x16x32_bf16 v[220:223], a[228:231], a[172:175], v[220:223]
 buffer_store_dwordx4 v[8:11], v3, s[32:35], s68 offen offset:2048 sc1
 v_accvgpr_read_b32 v5, a36
 v_lshlrev_b32 v6, 16, v5
 v_and_b32 v5, s26, v5
 v_mul_f32 v6, v6, v84
 v_mfma_f32_16x16x32_bf16 v[220:223], a[224:227], a[168:171], v[220:223]
 v_mul_f32 v5, v5, v85
 v_cvt_pk_bf16_f32 v12, v6, v5
 v_mfma_f32_16x16x32_bf16 v[224:227], a[224:227], a[176:179], v[224:227]
 v_accvgpr_read_b32 v5, a37
 v_lshlrev_b32 v6, 16, v5
 v_mfma_f32_16x16x32_bf16 v[224:227], a[228:231], a[180:183], v[224:227]
 v_and_b32 v5, s26, v5
 v_mul_f32 v6, v6, v86
 v_mfma_f32_16x16x32_bf16 v[228:231], a[228:231], a[188:191], v[228:231]
 v_mul_f32 v5, v5, v87
 v_cvt_pk_bf16_f32 v13, v6, v5
 v_mfma_f32_16x16x32_bf16 v[228:231], a[224:227], a[184:187], v[228:231]
 v_accvgpr_read_b32 v5, a38
 v_lshlrev_b32 v6, 16, v5
 s_waitcnt vmcnt(11)
 v_mfma_f32_16x16x32_bf16 a[252:255], a[232:235], a[184:187], a[252:255]
 ds_read_b128 a[184:187], v1 offset:63488
 v_and_b32 v5, s26, v5
 v_mfma_f32_16x16x32_bf16 a[252:255], a[236:239], a[188:191], a[252:255]
 global_load_dwordx4 a[228:231], v0, s[70:71] offset:-3072 sc1
 ds_read_b128 a[188:191], v1 offset:64512
 v_mfma_f32_16x16x32_bf16 a[248:251], a[236:239], a[180:183], a[248:251]
 ds_read_b128 a[180:183], v1 offset:60416
 v_mul_f32 v6, v6, v116
 v_mfma_f32_16x16x32_bf16 a[248:251], a[232:235], a[176:179], a[248:251]
 global_load_dwordx4 a[224:227], v0, s[70:71] offset:-4096 sc1
 ds_read_b128 a[176:179], v1 offset:59392
 v_mul_f32 v5, v5, v117
 v_mfma_f32_16x16x32_bf16 v[252:255], a[232:235], a[168:171], v[252:255]
 ds_read_b128 a[168:171], v1 offset:55296
 v_cvt_pk_bf16_f32 v14, v6, v5
 v_accvgpr_read_b32 v5, a39
 v_mfma_f32_16x16x32_bf16 v[252:255], a[236:239], a[172:175], v[252:255]
 ds_read_b128 a[172:175], v1 offset:56320
 v_lshlrev_b32 v6, 16, v5
 v_mfma_f32_16x16x32_bf16 v[248:251], a[236:239], a[164:167], v[248:251]
 ds_read_b128 a[164:167], v1 offset:52224
 v_and_b32 v5, s26, v5
 v_mul_f32 v6, v6, v118
 v_mfma_f32_16x16x32_bf16 v[248:251], a[232:235], a[160:163], v[248:251]
 ds_read_b128 a[160:163], v1 offset:51200
 v_mul_f32 v5, v5, v119
 v_cvt_pk_bf16_f32 v15, v6, v5
 v_mfma_f32_16x16x32_bf16 v[244:247], a[232:235], a[152:155], v[244:247]
 ds_read_b128 a[152:155], v1 offset:47104
 ds_write_b128 v3, v[12:15] offset:5120
 v_mfma_f32_16x16x32_bf16 v[244:247], a[236:239], a[156:159], v[244:247]
 buffer_store_dwordx4 v[12:15], v3, s[32:35], s68 offen offset:3072 sc1
 ds_read_b128 a[156:159], v1 offset:48128
 v_accvgpr_read_b32 v5, a8
 v_lshlrev_b32 v6, 16, v5
 v_and_b32 v5, s26, v5
 v_mfma_f32_16x16x32_bf16 v[240:243], a[236:239], a[148:151], v[240:243]
 ds_read_b128 a[148:151], v1 offset:44032
 v_mul_f32 v6, v6, v24
 v_mfma_f32_16x16x32_bf16 v[240:243], a[232:235], a[144:147], v[240:243]
 ds_read_b128 a[144:147], v1 offset:43008
 v_mul_f32 v5, v5, v25
 v_cvt_pk_bf16_f32 v8, v6, v5
 v_mfma_f32_16x16x32_bf16 v[236:239], a[232:235], a[136:139], v[236:239]
 ds_read_b128 a[136:139], v1 offset:38912
 v_accvgpr_read_b32 v5, a9
 v_mfma_f32_16x16x32_bf16 v[236:239], a[236:239], a[140:143], v[236:239]
 ds_read_b128 a[140:143], v1 offset:39936
 v_lshlrev_b32 v6, 16, v5
 v_mfma_f32_16x16x32_bf16 v[232:235], a[236:239], a[132:135], v[232:235]
 ds_read_b128 a[132:135], v1 offset:35840
 v_and_b32 v5, s26, v5
 v_mfma_f32_16x16x32_bf16 v[232:235], a[232:235], a[128:131], v[232:235]
 ds_read_b128 a[128:131], v1 offset:34816
 v_mul_f32 v6, v6, v26
 s_waitcnt vmcnt(12) lgkmcnt(9)
 v_mfma_f32_16x16x32_bf16 v[164:167], a[192:195], a[184:187], v[164:167]
 v_mul_f32 v5, v5, v27
 v_cvt_pk_bf16_f32 v9, v6, v5
 v_mfma_f32_16x16x32_bf16 v[164:167], a[196:199], a[188:191], v[164:167]
 global_load_dwordx4 a[236:239], v0, s[70:71] offset:-1024 sc1
 v_accvgpr_read_b32 v5, a10
 v_mfma_f32_16x16x32_bf16 v[160:163], a[196:199], a[180:183], v[160:163]
 v_lshlrev_b32 v6, 16, v5
 v_and_b32 v5, s26, v5
 v_mfma_f32_16x16x32_bf16 v[160:163], a[192:195], a[176:179], v[160:163]
 global_load_dwordx4 a[232:235], v0, s[70:71] offset:-2048 sc1
 v_mul_f32 v6, v6, v56
 v_mfma_f32_16x16x32_bf16 v[156:159], a[192:195], a[168:171], v[156:159]
 v_mul_f32 v5, v5, v57
 v_cvt_pk_bf16_f32 v10, v6, v5
 v_mfma_f32_16x16x32_bf16 v[156:159], a[196:199], a[172:175], v[156:159]
 v_accvgpr_read_b32 v5, a11
 v_lshlrev_b32 v6, 16, v5
 v_mfma_f32_16x16x32_bf16 v[152:155], a[196:199], a[164:167], v[152:155]
 v_and_b32 v5, s26, v5
 v_mul_f32 v6, v6, v58
 v_mfma_f32_16x16x32_bf16 v[152:155], a[192:195], a[160:163], v[152:155]
 v_mul_f32 v5, v5, v59
 v_cvt_pk_bf16_f32 v11, v6, v5
 s_waitcnt lgkmcnt(0)
 v_mfma_f32_16x16x32_bf16 v[148:151], a[192:195], a[152:155], v[148:151]
 ds_write_b128 v3, v[8:11] offset:8192
 s_add_u32 s68, s29, 4096
 v_mfma_f32_16x16x32_bf16 v[148:151], a[196:199], a[156:159], v[148:151]
 buffer_store_dwordx4 v[8:11], v3, s[32:35], s68 offen sc1
 v_accvgpr_read_b32 v5, a40
 v_lshlrev_b32 v6, 16, v5
 v_and_b32 v5, s26, v5
 v_mul_f32 v6, v6, v88
 v_mfma_f32_16x16x32_bf16 v[144:147], a[196:199], a[148:151], v[144:147]
 v_mul_f32 v5, v5, v89
 v_cvt_pk_bf16_f32 v12, v6, v5
 v_mfma_f32_16x16x32_bf16 v[144:147], a[192:195], a[144:147], v[144:147]
 v_accvgpr_read_b32 v5, a41
 v_lshlrev_b32 v6, 16, v5
 v_mfma_f32_16x16x32_bf16 v[140:143], a[192:195], a[136:139], v[140:143]
 v_and_b32 v5, s26, v5
 v_mul_f32 v6, v6, v90
 v_mfma_f32_16x16x32_bf16 v[140:143], a[196:199], a[140:143], v[140:143]
 v_mul_f32 v5, v5, v91
 v_cvt_pk_bf16_f32 v13, v6, v5
 v_mfma_f32_16x16x32_bf16 v[136:139], a[196:199], a[132:135], v[136:139]
 v_accvgpr_read_b32 v5, a42
 v_lshlrev_b32 v6, 16, v5
 v_mfma_f32_16x16x32_bf16 v[136:139], a[192:195], a[128:131], v[136:139]
 v_and_b32 v5, s26, v5
 v_mul_f32 v6, v6, v120
 s_waitcnt vmcnt(13)
 v_mfma_f32_16x16x32_bf16 v[168:171], a[200:203], a[128:131], v[168:171]
 v_mul_f32 v5, v5, v121
 v_cvt_pk_bf16_f32 v14, v6, v5
 v_mfma_f32_16x16x32_bf16 v[168:171], a[204:207], a[132:135], v[168:171]
 global_load_dwordx4 a[196:199], v0, s[70:71] offset:1024 sc1
 v_accvgpr_read_b32 v5, a43
 v_mfma_f32_16x16x32_bf16 v[172:175], a[204:207], a[140:143], v[172:175]
 v_lshlrev_b32 v6, 16, v5
 v_and_b32 v5, s26, v5
 v_mfma_f32_16x16x32_bf16 v[172:175], a[200:203], a[136:139], v[172:175]
 global_load_dwordx4 a[192:195], v0, s[70:71] offset:0 sc1
 v_mul_f32 v6, v6, v122
 v_mfma_f32_16x16x32_bf16 v[176:179], a[200:203], a[144:147], v[176:179]
 v_mul_f32 v5, v5, v123
 v_cvt_pk_bf16_f32 v15, v6, v5
 v_mfma_f32_16x16x32_bf16 v[176:179], a[204:207], a[148:151], v[176:179]
 ds_write_b128 v3, v[12:15] offset:9216
 v_mfma_f32_16x16x32_bf16 v[180:183], a[204:207], a[156:159], v[180:183]
 v_lshlrev_b32 v4, 2, v1
 v_and_b32 v4, 192, v4
 v_mfma_f32_16x16x32_bf16 v[180:183], a[200:203], a[152:155], v[180:183]
 buffer_load_dword v4, v4, s[44:47], 0 offen sc1
 v_mfma_f32_16x16x32_bf16 v[184:187], a[200:203], a[160:163], v[184:187]
 buffer_store_dwordx4 v[12:15], v3, s[32:35], s68 offen offset:1024 sc1
 v_accvgpr_read_b32 v5, a12
 v_lshlrev_b32 v6, 16, v5
 v_and_b32 v5, s26, v5
 v_mul_f32 v6, v6, v28
 v_mfma_f32_16x16x32_bf16 v[184:187], a[204:207], a[164:167], v[184:187]
 v_mul_f32 v5, v5, v29
 v_cvt_pk_bf16_f32 v8, v6, v5
 v_mfma_f32_16x16x32_bf16 v[188:191], a[204:207], a[172:175], v[188:191]
 v_accvgpr_read_b32 v5, a13
 v_lshlrev_b32 v6, 16, v5
 v_mfma_f32_16x16x32_bf16 v[188:191], a[200:203], a[168:171], v[188:191]
 v_and_b32 v5, s26, v5
 v_mul_f32 v6, v6, v30
 v_mfma_f32_16x16x32_bf16 v[192:195], a[200:203], a[176:179], v[192:195]
 v_mul_f32 v5, v5, v31
 v_cvt_pk_bf16_f32 v9, v6, v5
 v_mfma_f32_16x16x32_bf16 v[192:195], a[204:207], a[180:183], v[192:195]
 v_accvgpr_read_b32 v5, a14
 v_lshlrev_b32 v6, 16, v5
 v_mfma_f32_16x16x32_bf16 v[196:199], a[204:207], a[188:191], v[196:199]
 v_and_b32 v5, s26, v5
 v_mul_f32 v6, v6, v60
 v_mfma_f32_16x16x32_bf16 v[196:199], a[200:203], a[184:187], v[196:199]
 v_mul_f32 v5, v5, v61
 v_cvt_pk_bf16_f32 v10, v6, v5
 s_waitcnt vmcnt(14)
 v_mfma_f32_16x16x32_bf16 v[228:231], a[208:211], a[184:187], v[228:231]
 v_accvgpr_read_b32 v5, a15
 v_lshlrev_b32 v6, 16, v5
 v_mfma_f32_16x16x32_bf16 v[228:231], a[212:215], a[188:191], v[228:231]
 global_load_dwordx4 a[204:207], v0, s[70:71] offset:3072 sc1
 v_and_b32 v5, s26, v5
 v_mfma_f32_16x16x32_bf16 v[224:227], a[212:215], a[180:183], v[224:227]
 v_mul_f32 v6, v6, v62
 v_mul_f32 v5, v5, v63
 v_mfma_f32_16x16x32_bf16 v[224:227], a[208:211], a[176:179], v[224:227]
 global_load_dwordx4 a[200:203], v0, s[70:71] offset:2048 sc1
 v_cvt_pk_bf16_f32 v11, v6, v5
 v_mfma_f32_16x16x32_bf16 v[220:223], a[208:211], a[168:171], v[220:223]
 ds_write_b128 v3, v[8:11] offset:12288
 s_add_u32 s70, s70, 8192
 s_addc_u32 s71, s71, 0
 v_mfma_f32_16x16x32_bf16 v[220:223], a[212:215], a[172:175], v[220:223]
 buffer_store_dwordx4 v[8:11], v3, s[32:35], s68 offen offset:2048 sc1
 v_accvgpr_read_b32 v5, a44
 v_lshlrev_b32 v6, 16, v5
 v_and_b32 v5, s26, v5
 v_mfma_f32_16x16x32_bf16 v[216:219], a[212:215], a[164:167], v[216:219]
 v_mul_f32 v6, v6, v92
 v_mul_f32 v5, v5, v93
 v_mfma_f32_16x16x32_bf16 v[216:219], a[208:211], a[160:163], v[216:219]
 v_cvt_pk_bf16_f32 v12, v6, v5
 v_accvgpr_read_b32 v5, a45
 v_mfma_f32_16x16x32_bf16 v[212:215], a[208:211], a[152:155], v[212:215]
 v_lshlrev_b32 v6, 16, v5
 v_and_b32 v5, s26, v5
 v_mfma_f32_16x16x32_bf16 v[212:215], a[212:215], a[156:159], v[212:215]
 v_mul_f32 v6, v6, v94
 v_mul_f32 v5, v5, v95
 v_mfma_f32_16x16x32_bf16 v[208:211], a[212:215], a[148:151], v[208:211]
 v_cvt_pk_bf16_f32 v13, v6, v5
 v_accvgpr_read_b32 v5, a46
 v_mfma_f32_16x16x32_bf16 v[208:211], a[208:211], a[144:147], v[208:211]
 v_lshlrev_b32 v6, 16, v5
 v_and_b32 v5, s26, v5
 v_mfma_f32_16x16x32_bf16 v[204:207], a[208:211], a[136:139], v[204:207]
 v_mul_f32 v6, v6, v124
 v_mul_f32 v5, v5, v125
 v_mfma_f32_16x16x32_bf16 v[204:207], a[212:215], a[140:143], v[204:207]
 v_cvt_pk_bf16_f32 v14, v6, v5
 v_accvgpr_read_b32 v5, a47
 v_mfma_f32_16x16x32_bf16 v[200:203], a[212:215], a[132:135], v[200:203]
 v_lshlrev_b32 v6, 16, v5
 v_and_b32 v5, s26, v5
 v_mfma_f32_16x16x32_bf16 v[200:203], a[208:211], a[128:131], v[200:203]
 v_mul_f32 v6, v6, v126
 v_mul_f32 v5, v5, v127
 s_waitcnt vmcnt(14)
 v_mfma_f32_16x16x32_bf16 v[232:235], a[216:219], a[128:131], v[232:235]
 ds_read_b128 a[128:131], v2 offset:2048
 v_cvt_pk_bf16_f32 v15, v6, v5
 v_mfma_f32_16x16x32_bf16 v[232:235], a[220:223], a[132:135], v[232:235]
 global_load_dwordx4 a[212:215], v0, s[70:71] offset:-3072 sc1
 ds_read_b128 a[132:135], v2 offset:3072
 v_mfma_f32_16x16x32_bf16 v[236:239], a[220:223], a[140:143], v[236:239]
 ds_read_b128 a[140:143], v2 offset:7168
 ds_write_b128 v3, v[12:15] offset:13312
 v_mfma_f32_16x16x32_bf16 v[236:239], a[216:219], a[136:139], v[236:239]
 global_load_dwordx4 a[208:211], v0, s[70:71] offset:-4096 sc1
 ds_read_b128 a[136:139], v2 offset:6144
 v_mfma_f32_16x16x32_bf16 v[240:243], a[216:219], a[144:147], v[240:243]
 buffer_store_dwordx4 v[12:15], v3, s[32:35], s68 offen offset:3072 sc1
 ds_read_b128 a[144:147], v2 offset:10240
 v_accvgpr_read_b32 v5, a16
 v_lshlrev_b32 v6, 16, v5
 v_and_b32 v5, s26, v5
 v_mfma_f32_16x16x32_bf16 v[240:243], a[220:223], a[148:151], v[240:243]
 ds_read_b128 a[148:151], v2 offset:11264
 v_mul_f32 v6, v6, v32
 v_mfma_f32_16x16x32_bf16 v[244:247], a[220:223], a[156:159], v[244:247]
 ds_read_b128 a[156:159], v2 offset:15360
 v_mul_f32 v5, v5, v33
 v_cvt_pk_bf16_f32 v8, v6, v5
 v_mfma_f32_16x16x32_bf16 v[244:247], a[216:219], a[152:155], v[244:247]
 ds_read_b128 a[152:155], v2 offset:14336
 v_accvgpr_read_b32 v5, a17
 v_lshlrev_b32 v6, 16, v5
 v_mfma_f32_16x16x32_bf16 v[248:251], a[216:219], a[160:163], v[248:251]
 ds_read_b128 a[160:163], v2 offset:18432
 v_and_b32 v5, s26, v5
 v_mul_f32 v6, v6, v34
 v_mfma_f32_16x16x32_bf16 v[248:251], a[220:223], a[164:167], v[248:251]
 ds_read_b128 a[164:167], v2 offset:19456
 v_mul_f32 v5, v5, v35
 v_cvt_pk_bf16_f32 v9, v6, v5
 v_mfma_f32_16x16x32_bf16 v[252:255], a[220:223], a[172:175], v[252:255]
 ds_read_b128 a[172:175], v2 offset:23552
 v_accvgpr_read_b32 v5, a18
 v_mfma_f32_16x16x32_bf16 v[252:255], a[216:219], a[168:171], v[252:255]
 ds_read_b128 a[168:171], v2 offset:22528
 v_lshlrev_b32 v6, 16, v5
 v_mfma_f32_16x16x32_bf16 a[248:251], a[216:219], a[176:179], a[248:251]
 ds_read_b128 a[176:179], v2 offset:26624
 v_and_b32 v5, s26, v5
 v_mfma_f32_16x16x32_bf16 a[248:251], a[220:223], a[180:183], a[248:251]
 ds_read_b128 a[180:183], v2 offset:27648
 v_mul_f32 v6, v6, v64
 v_mfma_f32_16x16x32_bf16 a[252:255], a[220:223], a[188:191], a[252:255]
 ds_read_b128 a[188:191], v2 offset:31744
 v_mul_f32 v5, v5, v65
 v_mfma_f32_16x16x32_bf16 a[252:255], a[216:219], a[184:187], a[252:255]
 ds_read_b128 a[184:187], v2 offset:30720
 v_cvt_pk_bf16_f32 v10, v6, v5
 s_waitcnt vmcnt(14) lgkmcnt(8)
 v_mfma_f32_16x16x32_bf16 v[136:139], a[224:227], a[128:131], v[136:139]
 v_accvgpr_read_b32 v5, a19
 v_lshlrev_b32 v6, 16, v5
 v_mfma_f32_16x16x32_bf16 v[136:139], a[228:231], a[132:135], v[136:139]
 global_load_dwordx4 a[220:223], v0, s[70:71] offset:-1024 sc1
 v_and_b32 v5, s26, v5
 v_mfma_f32_16x16x32_bf16 v[140:143], a[228:231], a[140:143], v[140:143]
 v_mul_f32 v6, v6, v66
 v_mul_f32 v5, v5, v67
 v_mfma_f32_16x16x32_bf16 v[140:143], a[224:227], a[136:139], v[140:143]
 global_load_dwordx4 a[216:219], v0, s[70:71] offset:-2048 sc1
 v_cvt_pk_bf16_f32 v11, v6, v5
 v_mfma_f32_16x16x32_bf16 v[144:147], a[224:227], a[144:147], v[144:147]
 ds_write_b128 v3, v[8:11] offset:16384
 s_add_u32 s68, s29, 8192
 v_mfma_f32_16x16x32_bf16 v[144:147], a[228:231], a[148:151], v[144:147]
 buffer_store_dwordx4 v[8:11], v3, s[32:35], s68 offen sc1
 v_accvgpr_read_b32 v5, a48
 v_lshlrev_b32 v6, 16, v5
 v_and_b32 v5, s26, v5
 v_mul_f32 v6, v6, v96
 v_mfma_f32_16x16x32_bf16 v[148:151], a[228:231], a[156:159], v[148:151]
 v_mul_f32 v5, v5, v97
 v_cvt_pk_bf16_f32 v12, v6, v5
 v_mfma_f32_16x16x32_bf16 v[148:151], a[224:227], a[152:155], v[148:151]
 v_accvgpr_read_b32 v5, a49
 v_lshlrev_b32 v6, 16, v5
 s_waitcnt lgkmcnt(1)
 v_mfma_f32_16x16x32_bf16 v[152:155], a[224:227], a[160:163], v[152:155]
 v_and_b32 v5, s26, v5
 v_mul_f32 v6, v6, v98
 v_mfma_f32_16x16x32_bf16 v[152:155], a[228:231], a[164:167], v[152:155]
 v_mul_f32 v5, v5, v99
 v_cvt_pk_bf16_f32 v13, v6, v5
 v_mfma_f32_16x16x32_bf16 v[156:159], a[228:231], a[172:175], v[156:159]
 v_accvgpr_read_b32 v5, a50
 v_lshlrev_b32 v6, 16, v5
 v_mfma_f32_16x16x32_bf16 v[156:159], a[224:227], a[168:171], v[156:159]
 v_and_b32 v5, s26, v5
 v_mul_f32 v6, v6, v128
 v_mfma_f32_16x16x32_bf16 v[160:163], a[224:227], a[176:179], v[160:163]
 v_mul_f32 v5, v5, v129
 v_cvt_pk_bf16_f32 v14, v6, v5
 v_mfma_f32_16x16x32_bf16 v[160:163], a[228:231], a[180:183], v[160:163]
 v_accvgpr_read_b32 v5, a51
 v_lshlrev_b32 v6, 16, v5
 v_mfma_f32_16x16x32_bf16 v[164:167], a[228:231], a[188:191], v[164:167]
 v_and_b32 v5, s26, v5
 v_mul_f32 v6, v6, v130
 v_mfma_f32_16x16x32_bf16 v[164:167], a[224:227], a[184:187], v[164:167]
 v_mul_f32 v5, v5, v131
 v_cvt_pk_bf16_f32 v15, v6, v5
 s_waitcnt vmcnt(14)
 v_mfma_f32_16x16x32_bf16 v[196:199], a[232:235], a[184:187], v[196:199]
 ds_write_b128 v3, v[12:15] offset:17408
 v_mfma_f32_16x16x32_bf16 v[196:199], a[236:239], a[188:191], v[196:199]
 buffer_store_dwordx4 v[12:15], v3, s[32:35], s68 offen offset:1024 sc1
 global_load_dwordx4 a[228:231], v0, s[70:71] offset:1024 sc1
 v_accvgpr_read_b32 v5, a20
 v_lshlrev_b32 v6, 16, v5
 v_and_b32 v5, s26, v5
 v_mfma_f32_16x16x32_bf16 v[192:195], a[236:239], a[180:183], v[192:195]
 v_mul_f32 v6, v6, v36
 v_mul_f32 v5, v5, v37
 v_mfma_f32_16x16x32_bf16 v[192:195], a[232:235], a[176:179], v[192:195]
 global_load_dwordx4 a[224:227], v0, s[70:71] offset:0 sc1
 v_cvt_pk_bf16_f32 v8, v6, v5
 v_mfma_f32_16x16x32_bf16 v[188:191], a[232:235], a[168:171], v[188:191]
 v_accvgpr_read_b32 v5, a21
 v_lshlrev_b32 v6, 16, v5
 v_mfma_f32_16x16x32_bf16 v[188:191], a[236:239], a[172:175], v[188:191]
 v_and_b32 v5, s26, v5
 v_mul_f32 v6, v6, v38
 v_mfma_f32_16x16x32_bf16 v[184:187], a[236:239], a[164:167], v[184:187]
 v_mul_f32 v5, v5, v39
 v_cvt_pk_bf16_f32 v9, v6, v5
 v_mfma_f32_16x16x32_bf16 v[184:187], a[232:235], a[160:163], v[184:187]
 v_accvgpr_read_b32 v5, a22
 v_lshlrev_b32 v6, 16, v5
 v_mfma_f32_16x16x32_bf16 v[180:183], a[232:235], a[152:155], v[180:183]
 v_and_b32 v5, s26, v5
 v_mul_f32 v6, v6, v68
 v_mfma_f32_16x16x32_bf16 v[180:183], a[236:239], a[156:159], v[180:183]
 v_mul_f32 v5, v5, v69
 v_cvt_pk_bf16_f32 v10, v6, v5
 v_mfma_f32_16x16x32_bf16 v[176:179], a[236:239], a[148:151], v[176:179]
 v_accvgpr_read_b32 v5, a23
 v_lshlrev_b32 v6, 16, v5
 v_mfma_f32_16x16x32_bf16 v[176:179], a[232:235], a[144:147], v[176:179]
 v_and_b32 v5, s26, v5
 v_mul_f32 v6, v6, v70
 v_mfma_f32_16x16x32_bf16 v[172:175], a[232:235], a[136:139], v[172:175]
 v_mul_f32 v5, v5, v71
 v_cvt_pk_bf16_f32 v11, v6, v5
 v_mfma_f32_16x16x32_bf16 v[172:175], a[236:239], a[140:143], v[172:175]
 ds_write_b128 v3, v[8:11] offset:20480
 v_mfma_f32_16x16x32_bf16 v[168:171], a[236:239], a[132:135], v[168:171]
 buffer_store_dwordx4 v[8:11], v3, s[32:35], s68 offen offset:2048 sc1
 v_accvgpr_read_b32 v5, a52
 v_lshlrev_b32 v6, 16, v5
 v_and_b32 v5, s26, v5
 v_mfma_f32_16x16x32_bf16 v[168:171], a[232:235], a[128:131], v[168:171]
 v_mul_f32 v6, v6, v100
 v_mul_f32 v5, v5, v101
 s_waitcnt vmcnt(15)
 v_mfma_f32_16x16x32_bf16 v[200:203], a[192:195], a[128:131], v[200:203]
 v_cvt_pk_bf16_f32 v12, v6, v5
 v_accvgpr_read_b32 v5, a53
 v_mfma_f32_16x16x32_bf16 v[200:203], a[196:199], a[132:135], v[200:203]
 global_load_dwordx4 a[236:239], v0, s[70:71] offset:3072 sc1
 v_lshlrev_b32 v6, 16, v5
 v_mfma_f32_16x16x32_bf16 v[204:207], a[196:199], a[140:143], v[204:207]
 v_and_b32 v5, s26, v5
 s_waitcnt vmcnt(15)
 v_cmp_gt_i32 vcc, s27, v4
 s_cbranch_vccnz Lspin_w
Lok_w:
 s_add_u32 s27, s27, 64
 v_mfma_f32_16x16x32_bf16 v[204:207], a[192:195], a[136:139], v[204:207]
 global_load_dwordx4 a[232:235], v0, s[70:71] offset:2048 sc1
 v_mul_f32 v6, v6, v102
 v_mfma_f32_16x16x32_bf16 v[208:211], a[192:195], a[144:147], v[208:211]
 v_mul_f32 v5, v5, v103
 v_cvt_pk_bf16_f32 v13, v6, v5
 s_add_u32 s70, s70, 1843200
 s_addc_u32 s71, s71, 0
 v_mfma_f32_16x16x32_bf16 v[208:211], a[196:199], a[148:151], v[208:211]
 v_accvgpr_read_b32 v5, a54
 v_lshlrev_b32 v6, 16, v5
 v_mfma_f32_16x16x32_bf16 v[212:215], a[196:199], a[156:159], v[212:215]
 v_and_b32 v5, s26, v5
 v_mul_f32 v6, v6, v132
 v_mfma_f32_16x16x32_bf16 v[212:215], a[192:195], a[152:155], v[212:215]
 v_mul_f32 v5, v5, v133
 v_cvt_pk_bf16_f32 v14, v6, v5
 v_mfma_f32_16x16x32_bf16 v[216:219], a[192:195], a[160:163], v[216:219]
 v_accvgpr_read_b32 v5, a55
 v_lshlrev_b32 v6, 16, v5
 v_mfma_f32_16x16x32_bf16 v[216:219], a[196:199], a[164:167], v[216:219]
 v_and_b32 v5, s26, v5
 v_mul_f32 v6, v6, v134
 v_mfma_f32_16x16x32_bf16 v[220:223], a[196:199], a[172:175], v[220:223]
 v_mul_f32 v5, v5, v135
 v_cvt_pk_bf16_f32 v15, v6, v5
 v_mfma_f32_16x16x32_bf16 v[220:223], a[192:195], a[168:171], v[220:223]
 ds_write_b128 v3, v[12:15] offset:21504
 v_mfma_f32_16x16x32_bf16 v[224:227], a[192:195], a[176:179], v[224:227]
 buffer_store_dwordx4 v[12:15], v3, s[32:35], s68 offen offset:3072 sc1
 v_accvgpr_read_b32 v5, a24
 v_lshlrev_b32 v6, 16, v5
 v_and_b32 v5, s26, v5
 v_mul_f32 v6, v6, v40
 v_mfma_f32_16x16x32_bf16 v[224:227], a[196:199], a[180:183], v[224:227]
 v_mul_f32 v5, v5, v41
 v_cvt_pk_bf16_f32 v8, v6, v5
 v_mfma_f32_16x16x32_bf16 v[228:231], a[196:199], a[188:191], v[228:231]
 v_accvgpr_read_b32 v5, a25
 v_lshlrev_b32 v6, 16, v5
 v_mfma_f32_16x16x32_bf16 v[228:231], a[192:195], a[184:187], v[228:231]
 v_and_b32 v5, s26, v5
 v_mul_f32 v6, v6, v42
 s_waitcnt vmcnt(14)
 v_mfma_f32_16x16x32_bf16 a[252:255], a[200:203], a[184:187], a[252:255]
 ds_read_b128 a[184:187], v2 offset:63488
 v_mul_f32 v5, v5, v43
 v_mfma_f32_16x16x32_bf16 a[252:255], a[204:207], a[188:191], a[252:255]
 global_load_dwordx4 a[196:199], v0, s[70:71] offset:-3072 sc1
 ds_read_b128 a[188:191], v2 offset:64512
 v_mfma_f32_16x16x32_bf16 a[248:251], a[204:207], a[180:183], a[248:251]
 ds_read_b128 a[180:183], v2 offset:60416
 v_cvt_pk_bf16_f32 v9, v6, v5
 v_mfma_f32_16x16x32_bf16 a[248:251], a[200:203], a[176:179], a[248:251]
 global_load_dwordx4 a[192:195], v0, s[70:71] offset:-4096 sc1
 ds_read_b128 a[176:179], v2 offset:59392
 v_accvgpr_read_b32 v5, a26
 v_lshlrev_b32 v6, 16, v5
 v_mfma_f32_16x16x32_bf16 v[252:255], a[200:203], a[168:171], v[252:255]
 ds_read_b128 a[168:171], v2 offset:55296
 v_and_b32 v5, s26, v5
 v_mfma_f32_16x16x32_bf16 v[252:255], a[204:207], a[172:175], v[252:255]
 ds_read_b128 a[172:175], v2 offset:56320
 v_mul_f32 v6, v6, v72
 v_mfma_f32_16x16x32_bf16 v[248:251], a[204:207], a[164:167], v[248:251]
 ds_read_b128 a[164:167], v2 offset:52224
 v_mul_f32 v5, v5, v73
 v_mfma_f32_16x16x32_bf16 v[248:251], a[200:203], a[160:163], v[248:251]
 ds_read_b128 a[160:163], v2 offset:51200
 v_cvt_pk_bf16_f32 v10, v6, v5
 v_mfma_f32_16x16x32_bf16 v[244:247], a[200:203], a[152:155], v[244:247]
 ds_read_b128 a[152:155], v2 offset:47104
 v_accvgpr_read_b32 v5, a27
 v_mfma_f32_16x16x32_bf16 v[244:247], a[204:207], a[156:159], v[244:247]
 ds_read_b128 a[156:159], v2 offset:48128
 v_lshlrev_b32 v6, 16, v5
 v_mfma_f32_16x16x32_bf16 v[240:243], a[204:207], a[148:151], v[240:243]
 ds_read_b128 a[148:151], v2 offset:44032
 v_and_b32 v5, s26, v5
 v_mfma_f32_16x16x32_bf16 v[240:243], a[200:203], a[144:147], v[240:243]
 ds_read_b128 a[144:147], v2 offset:43008
 v_mul_f32 v6, v6, v74
 v_mfma_f32_16x16x32_bf16 v[236:239], a[200:203], a[136:139], v[236:239]
 ds_read_b128 a[136:139], v2 offset:38912
 v_mul_f32 v5, v5, v75
 v_mfma_f32_16x16x32_bf16 v[236:239], a[204:207], a[140:143], v[236:239]
 ds_read_b128 a[140:143], v2 offset:39936
 v_cvt_pk_bf16_f32 v11, v6, v5
 v_mfma_f32_16x16x32_bf16 v[232:235], a[204:207], a[132:135], v[232:235]
 ds_read_b128 a[132:135], v2 offset:35840
 ds_write_b128 v3, v[8:11] offset:24576
 s_add_u32 s68, s29, 12288
 buffer_store_dwordx4 v[8:11], v3, s[32:35], s68 offen sc1
 v_accvgpr_read_b32 v5, a56
 v_lshlrev_b32 v6, 16, v5
 v_and_b32 v5, s26, v5
 v_mul_f32 v6, v6, v104
 v_mfma_f32_16x16x32_bf16 v[232:235], a[200:203], a[128:131], v[232:235]
 ds_read_b128 a[128:131], v2 offset:34816
 v_mul_f32 v5, v5, v105
 v_cvt_pk_bf16_f32 v12, v6, v5
 s_waitcnt vmcnt(14) lgkmcnt(9)
 v_mfma_f32_16x16x32_bf16 v[164:167], a[208:211], a[184:187], v[164:167]
 v_accvgpr_read_b32 v5, a57
 v_lshlrev_b32 v6, 16, v5
 v_mfma_f32_16x16x32_bf16 v[164:167], a[212:215], a[188:191], v[164:167]
 global_load_dwordx4 a[204:207], v0, s[70:71] offset:-1024 sc1
 v_and_b32 v5, s26, v5
 v_mfma_f32_16x16x32_bf16 v[160:163], a[212:215], a[180:183], v[160:163]
 v_mul_f32 v6, v6, v106
 v_mul_f32 v5, v5, v107
 v_mfma_f32_16x16x32_bf16 v[160:163], a[208:211], a[176:179], v[160:163]
 global_load_dwordx4 a[200:203], v0, s[70:71] offset:-2048 sc1
 v_cvt_pk_bf16_f32 v13, v6, v5
 v_mfma_f32_16x16x32_bf16 v[156:159], a[208:211], a[168:171], v[156:159]
 v_accvgpr_read_b32 v5, a58
 v_accvgpr_read_b32 v7, a240
 v_mfma_f32_16x16x32_bf16 v[156:159], a[212:215], a[172:175], v[156:159]
 v_lshlrev_b32 v6, 16, v5
 v_and_b32 v5, s26, v5
 v_mfma_f32_16x16x32_bf16 v[152:155], a[212:215], a[164:167], v[152:155]
 v_mul_f32 v6, v6, v7
 v_accvgpr_read_b32 v7, a241
 v_mfma_f32_16x16x32_bf16 v[152:155], a[208:211], a[160:163], v[152:155]
 v_mul_f32 v5, v5, v7
 v_cvt_pk_bf16_f32 v14, v6, v5
 s_waitcnt lgkmcnt(0)
 v_mfma_f32_16x16x32_bf16 v[148:151], a[208:211], a[152:155], v[148:151]
 v_accvgpr_read_b32 v5, a59
 v_accvgpr_read_b32 v7, a242
 v_mfma_f32_16x16x32_bf16 v[148:151], a[212:215], a[156:159], v[148:151]
 v_lshlrev_b32 v6, 16, v5
 v_and_b32 v5, s26, v5
 v_mfma_f32_16x16x32_bf16 v[144:147], a[212:215], a[148:151], v[144:147]
 v_mul_f32 v6, v6, v7
 v_accvgpr_read_b32 v7, a243
 v_mfma_f32_16x16x32_bf16 v[144:147], a[208:211], a[144:147], v[144:147]
 v_mul_f32 v5, v5, v7
 v_cvt_pk_bf16_f32 v15, v6, v5
 v_mfma_f32_16x16x32_bf16 v[140:143], a[208:211], a[136:139], v[140:143]
 ds_write_b128 v3, v[12:15] offset:25600
 v_mfma_f32_16x16x32_bf16 v[140:143], a[212:215], a[140:143], v[140:143]
 buffer_store_dwordx4 v[12:15], v3, s[32:35], s68 offen offset:1024 sc1
 v_accvgpr_read_b32 v5, a28
 v_lshlrev_b32 v6, 16, v5
 v_and_b32 v5, s26, v5
 v_mul_f32 v6, v6, v44
 v_mfma_f32_16x16x32_bf16 v[136:139], a[212:215], a[132:135], v[136:139]
 v_mul_f32 v5, v5, v45
 v_cvt_pk_bf16_f32 v8, v6, v5
 v_mfma_f32_16x16x32_bf16 v[136:139], a[208:211], a[128:131], v[136:139]
 v_accvgpr_read_b32 v5, a29
 v_lshlrev_b32 v6, 16, v5
 s_waitcnt vmcnt(14)
 v_mfma_f32_16x16x32_bf16 v[168:171], a[216:219], a[128:131], v[168:171]
 v_and_b32 v5, s26, v5
 v_mul_f32 v6, v6, v46
 v_mfma_f32_16x16x32_bf16 v[168:171], a[220:223], a[132:135], v[168:171]
 global_load_dwordx4 a[212:215], v0, s[70:71] offset:1024 sc1
 v_mul_f32 v5, v5, v47
 v_mfma_f32_16x16x32_bf16 v[172:175], a[220:223], a[140:143], v[172:175]
 v_cvt_pk_bf16_f32 v9, v6, v5
 v_accvgpr_read_b32 v5, a30
 v_mfma_f32_16x16x32_bf16 v[172:175], a[216:219], a[136:139], v[172:175]
 global_load_dwordx4 a[208:211], v0, s[70:71] offset:0 sc1
 v_lshlrev_b32 v6, 16, v5
 v_mfma_f32_16x16x32_bf16 v[176:179], a[216:219], a[144:147], v[176:179]
 v_and_b32 v5, s26, v5
 v_mul_f32 v6, v6, v76
 v_mfma_f32_16x16x32_bf16 v[176:179], a[220:223], a[148:151], v[176:179]
 v_mul_f32 v5, v5, v77
 v_cvt_pk_bf16_f32 v10, v6, v5
 v_mfma_f32_16x16x32_bf16 v[180:183], a[220:223], a[156:159], v[180:183]
 v_accvgpr_read_b32 v5, a31
 v_lshlrev_b32 v6, 16, v5
 v_mfma_f32_16x16x32_bf16 v[180:183], a[216:219], a[152:155], v[180:183]
 v_and_b32 v5, s26, v5
 v_mul_f32 v6, v6, v78
 v_mfma_f32_16x16x32_bf16 v[184:187], a[216:219], a[160:163], v[184:187]
 v_mul_f32 v5, v5, v79
 v_cvt_pk_bf16_f32 v11, v6, v5
 v_mfma_f32_16x16x32_bf16 v[184:187], a[220:223], a[164:167], v[184:187]
 ds_write_b128 v3, v[8:11] offset:28672
 v_mfma_f32_16x16x32_bf16 v[188:191], a[220:223], a[172:175], v[188:191]
 buffer_store_dwordx4 v[8:11], v3, s[32:35], s68 offen offset:2048 sc1
 v_accvgpr_read_b32 v5, a60
 v_lshlrev_b32 v6, 16, v5
 v_and_b32 v5, s26, v5
 v_mul_f32 v6, v6, v108
 v_mfma_f32_16x16x32_bf16 v[188:191], a[216:219], a[168:171], v[188:191]
 v_mul_f32 v5, v5, v109
 v_cvt_pk_bf16_f32 v12, v6, v5
 v_mfma_f32_16x16x32_bf16 v[192:195], a[216:219], a[176:179], v[192:195]
 v_accvgpr_read_b32 v5, a61
 v_lshlrev_b32 v6, 16, v5
 v_mfma_f32_16x16x32_bf16 v[192:195], a[220:223], a[180:183], v[192:195]
 v_and_b32 v5, s26, v5
 v_mul_f32 v6, v6, v110
 v_mfma_f32_16x16x32_bf16 v[196:199], a[220:223], a[188:191], v[196:199]
 v_mul_f32 v5, v5, v111
 v_cvt_pk_bf16_f32 v13, v6, v5
 v_mfma_f32_16x16x32_bf16 v[196:199], a[216:219], a[184:187], v[196:199]
 v_accvgpr_read_b32 v5, a62
 v_accvgpr_read_b32 v7, a244
 s_waitcnt vmcnt(13)
 v_mfma_f32_16x16x32_bf16 v[228:231], a[224:227], a[184:187], v[228:231]
 v_lshlrev_b32 v6, 16, v5
 v_and_b32 v5, s26, v5
 v_mfma_f32_16x16x32_bf16 v[228:231], a[228:231], a[188:191], v[228:231]
 global_load_dwordx4 a[220:223], v0, s[70:71] offset:3072 sc1
 v_mul_f32 v6, v6, v7
 v_mfma_f32_16x16x32_bf16 v[224:227], a[228:231], a[180:183], v[224:227]
 v_accvgpr_read_b32 v7, a245
 v_mul_f32 v5, v5, v7
 v_mfma_f32_16x16x32_bf16 v[224:227], a[224:227], a[176:179], v[224:227]
 global_load_dwordx4 a[216:219], v0, s[70:71] offset:2048 sc1
 v_cvt_pk_bf16_f32 v14, v6, v5
 v_mfma_f32_16x16x32_bf16 v[220:223], a[224:227], a[168:171], v[220:223]
 v_accvgpr_read_b32 v5, a63
 v_accvgpr_read_b32 v7, a246
 s_add_u32 s70, s70, 8192
 s_addc_u32 s71, s71, 0
 v_mfma_f32_16x16x32_bf16 v[220:223], a[228:231], a[172:175], v[220:223]
 v_lshlrev_b32 v6, 16, v5
 v_and_b32 v5, s26, v5
 v_mfma_f32_16x16x32_bf16 v[216:219], a[228:231], a[164:167], v[216:219]
 v_mul_f32 v6, v6, v7
 v_accvgpr_read_b32 v7, a247
 v_mfma_f32_16x16x32_bf16 v[216:219], a[224:227], a[160:163], v[216:219]
 v_mul_f32 v5, v5, v7
 v_cvt_pk_bf16_f32 v15, v6, v5
 v_mfma_f32_16x16x32_bf16 v[212:215], a[224:227], a[152:155], v[212:215]
 ds_write_b128 v3, v[12:15] offset:29696
 v_mfma_f32_16x16x32_bf16 v[212:215], a[228:231], a[156:159], v[212:215]
 buffer_store_dwordx4 v[12:15], v3, s[32:35], s68 offen offset:3072 sc1
 v_mfma_f32_16x16x32_bf16 v[208:211], a[228:231], a[148:151], v[208:211]
 s_waitcnt lgkmcnt(0)
 s_barrier
 v_mfma_f32_16x16x32_bf16 v[208:211], a[224:227], a[144:147], v[208:211]
 v_mfma_f32_16x16x32_bf16 v[204:207], a[224:227], a[136:139], v[204:207]
 v_mfma_f32_16x16x32_bf16 v[204:207], a[228:231], a[140:143], v[204:207]
 v_mfma_f32_16x16x32_bf16 v[200:203], a[228:231], a[132:135], v[200:203]
 v_mfma_f32_16x16x32_bf16 v[200:203], a[224:227], a[128:131], v[200:203]
 s_waitcnt vmcnt(13)
 v_mfma_f32_16x16x32_bf16 v[232:235], a[232:235], a[128:131], v[232:235]
 ds_read_b128 a[128:131], v1
 v_mfma_f32_16x16x32_bf16 v[232:235], a[236:239], a[132:135], v[232:235]
 global_load_dwordx4 a[228:231], v0, s[70:71] offset:-3072 sc1
 ds_read_b128 a[132:135], v1 offset:1024
 v_mfma_f32_16x16x32_bf16 v[236:239], a[236:239], a[140:143], v[236:239]
 ds_read_b128 a[140:143], v1 offset:5120
 v_mfma_f32_16x16x32_bf16 v[236:239], a[232:235], a[136:139], v[236:239]
 global_load_dwordx4 a[224:227], v0, s[70:71] offset:-4096 sc1
 ds_read_b128 a[136:139], v1 offset:4096
 v_mfma_f32_16x16x32_bf16 v[240:243], a[232:235], a[144:147], v[240:243]
 ds_read_b128 a[144:147], v1 offset:8192
 v_mfma_f32_16x16x32_bf16 v[240:243], a[236:239], a[148:151], v[240:243]
 ds_read_b128 a[148:151], v1 offset:9216
 v_mfma_f32_16x16x32_bf16 v[244:247], a[236:239], a[156:159], v[244:247]
 ds_read_b128 a[156:159], v1 offset:13312
 v_mfma_f32_16x16x32_bf16 v[244:247], a[232:235], a[152:155], v[244:247]
 ds_read_b128 a[152:155], v1 offset:12288
 v_mfma_f32_16x16x32_bf16 v[248:251], a[232:235], a[160:163], v[248:251]
 ds_read_b128 a[160:163], v1 offset:16384
 v_mfma_f32_16x16x32_bf16 v[248:251], a[236:239], a[164:167], v[248:251]
 ds_read_b128 a[164:167], v1 offset:17408
 v_mfma_f32_16x16x32_bf16 v[252:255], a[236:239], a[172:175], v[252:255]
 ds_read_b128 a[172:175], v1 offset:21504
 v_mfma_f32_16x16x32_bf16 v[252:255], a[232:235], a[168:171], v[252:255]
 ds_read_b128 a[168:171], v1 offset:20480
 v_mfma_f32_16x16x32_bf16 a[248:251], a[232:235], a[176:179], a[248:251]
 ds_read_b128 a[176:179], v1 offset:24576
 v_mfma_f32_16x16x32_bf16 a[248:251], a[236:239], a[180:183], a[248:251]
 ds_read_b128 a[180:183], v1 offset:25600
 v_mfma_f32_16x16x32_bf16 a[252:255], a[236:239], a[188:191], a[252:255]
 global_load_dwordx4 a[236:239], v0, s[70:71] offset:-1024 sc1
 ds_read_b128 a[188:191], v1 offset:29696
 v_mfma_f32_16x16x32_bf16 a[252:255], a[232:235], a[184:187], a[252:255]
 global_load_dwordx4 a[232:235], v0, s[70:71] offset:-2048 sc1
 ds_read_b128 a[184:187], v1 offset:28672
 s_waitcnt vmcnt(14) lgkmcnt(8)
 v_mfma_f32_16x16x32_bf16 v[16:19], a[192:195], a[128:131], v[16:19]
 v_accvgpr_read_b32 v5, a64
 v_lshlrev_b32 v6, 16, v5
 v_mfma_f32_16x16x32_bf16 v[16:19], a[196:199], a[132:135], v[16:19]
 v_and_b32 v5, s26, v5
 v_mfma_f32_16x16x32_bf16 v[20:23], a[196:199], a[140:143], v[20:23]
 v_mul_f32 v6, v6, v136
 v_mul_f32 v5, v5, v137
 v_mfma_f32_16x16x32_bf16 v[20:23], a[192:195], a[136:139], v[20:23]
 v_cvt_pk_bf16_f32 v8, v6, v5
 v_accvgpr_read_b32 v5, a65
 v_mfma_f32_16x16x32_bf16 v[24:27], a[192:195], a[144:147], v[24:27]
 v_lshlrev_b32 v6, 16, v5
 v_mfma_f32_16x16x32_bf16 v[24:27], a[196:199], a[148:151], v[24:27]
 v_and_b32 v5, s26, v5
 v_mul_f32 v6, v6, v138
 v_mfma_f32_16x16x32_bf16 v[28:31], a[196:199], a[156:159], v[28:31]
 v_mul_f32 v5, v5, v139
 v_cvt_pk_bf16_f32 v9, v6, v5
 v_mfma_f32_16x16x32_bf16 v[28:31], a[192:195], a[152:155], v[28:31]
 v_accvgpr_read_b32 v5, a66
 v_lshlrev_b32 v6, 16, v5
 s_waitcnt lgkmcnt(0)
 v_mfma_f32_16x16x32_bf16 v[32:35], a[192:195], a[160:163], v[32:35]
 v_and_b32 v5, s26, v5
 v_mul_f32 v6, v6, v168
 v_mfma_f32_16x16x32_bf16 v[32:35], a[196:199], a[164:167], v[32:35]
 v_mul_f32 v5, v5, v169
 v_cvt_pk_bf16_f32 v10, v6, v5
 v_mfma_f32_16x16x32_bf16 v[36:39], a[196:199], a[172:175], v[36:39]
 v_accvgpr_read_b32 v5, a67
 v_lshlrev_b32 v6, 16, v5
 v_mfma_f32_16x16x32_bf16 v[36:39], a[192:195], a[168:171], v[36:39]
 v_and_b32 v5, s26, v5
 v_mul_f32 v6, v6, v170
 v_mfma_f32_16x16x32_bf16 v[40:43], a[192:195], a[176:179], v[40:43]
 v_mul_f32 v5, v5, v171
 v_cvt_pk_bf16_f32 v11, v6, v5
 v_mfma_f32_16x16x32_bf16 v[40:43], a[196:199], a[180:183], v[40:43]
 ds_write_b128 v3, v[8:11] offset:2048
 v_mfma_f32_16x16x32_bf16 v[44:47], a[196:199], a[188:191], v[44:47]
 s_add_u32 s68, s29, 16384
 buffer_store_dwordx4 v[8:11], v3, s[32:35], s68 offen sc1
 v_mfma_f32_16x16x32_bf16 v[44:47], a[192:195], a[184:187], v[44:47]
 v_accvgpr_read_b32 v5, a96
 s_waitcnt vmcnt(12)
 v_mfma_f32_16x16x32_bf16 v[76:79], a[200:203], a[184:187], v[76:79]
 v_lshlrev_b32 v6, 16, v5
 v_mfma_f32_16x16x32_bf16 v[76:79], a[204:207], a[188:191], v[76:79]
 global_load_dwordx4 a[196:199], v0, s[70:71] offset:1024 sc1
 v_and_b32 v5, s26, v5
 v_mfma_f32_16x16x32_bf16 v[72:75], a[204:207], a[180:183], v[72:75]
 v_mul_f32 v6, v6, v200
 v_mul_f32 v5, v5, v201
 v_mfma_f32_16x16x32_bf16 v[72:75], a[200:203], a[176:179], v[72:75]
 global_load_dwordx4 a[192:195], v0, s[70:71] offset:0 sc1
 v_cvt_pk_bf16_f32 v12, v6, v5
 v_mfma_f32_16x16x32_bf16 v[68:71], a[200:203], a[168:171], v[68:71]
 v_accvgpr_read_b32 v5, a97
 v_lshlrev_b32 v6, 16, v5
 v_mfma_f32_16x16x32_bf16 v[68:71], a[204:207], a[172:175], v[68:71]
 v_and_b32 v5, s26, v5
 v_mul_f32 v6, v6, v202
 v_mfma_f32_16x16x32_bf16 v[64:67], a[204:207], a[164:167], v[64:67]
 v_mul_f32 v5, v5, v203
 v_cvt_pk_bf16_f32 v13, v6, v5
 v_mfma_f32_16x16x32_bf16 v[64:67], a[200:203], a[160:163], v[64:67]
 v_accvgpr_read_b32 v5, a98
 v_lshlrev_b32 v6, 16, v5
 v_mfma_f32_16x16x32_bf16 v[60:63], a[200:203], a[152:155], v[60:63]
 v_and_b32 v5, s26, v5
 v_mul_f32 v6, v6, v232
 v_mfma_f32_16x16x32_bf16 v[60:63], a[204:207], a[156:159], v[60:63]
 v_mul_f32 v5, v5, v233
 v_cvt_pk_bf16_f32 v14, v6, v5
 v_mfma_f32_16x16x32_bf16 v[56:59], a[204:207], a[148:151], v[56:59]
 v_accvgpr_read_b32 v5, a99
 v_lshlrev_b32 v6, 16, v5
 v_mfma_f32_16x16x32_bf16 v[56:59], a[200:203], a[144:147], v[56:59]
 v_and_b32 v5, s26, v5
 v_mul_f32 v6, v6, v234
 v_mfma_f32_16x16x32_bf16 v[52:55], a[200:203], a[136:139], v[52:55]
 v_mul_f32 v5, v5, v235
 v_cvt_pk_bf16_f32 v15, v6, v5
 v_mfma_f32_16x16x32_bf16 v[52:55], a[204:207], a[140:143], v[52:55]
 ds_write_b128 v3, v[12:15] offset:3072
 v_mfma_f32_16x16x32_bf16 v[48:51], a[204:207], a[132:135], v[48:51]
 buffer_store_dwordx4 v[12:15], v3, s[32:35], s68 offen offset:1024 sc1
 v_mfma_f32_16x16x32_bf16 v[48:51], a[200:203], a[128:131], v[48:51]
 v_accvgpr_read_b32 v5, a68
 v_lshlrev_b32 v6, 16, v5
 s_waitcnt vmcnt(12)
 v_mfma_f32_16x16x32_bf16 v[80:83], a[208:211], a[128:131], v[80:83]
 v_and_b32 v5, s26, v5
 v_mul_f32 v6, v6, v140
 v_mfma_f32_16x16x32_bf16 v[80:83], a[212:215], a[132:135], v[80:83]
 global_load_dwordx4 a[204:207], v0, s[70:71] offset:3072 sc1
 v_mul_f32 v5, v5, v141
 v_mfma_f32_16x16x32_bf16 v[84:87], a[212:215], a[140:143], v[84:87]
 v_cvt_pk_bf16_f32 v8, v6, v5
 v_accvgpr_read_b32 v5, a69
 v_mfma_f32_16x16x32_bf16 v[84:87], a[208:211], a[136:139], v[84:87]
 global_load_dwordx4 a[200:203], v0, s[70:71] offset:2048 sc1
 v_lshlrev_b32 v6, 16, v5
 v_mfma_f32_16x16x32_bf16 v[88:91], a[208:211], a[144:147], v[88:91]
 v_and_b32 v5, s26, v5
 v_mul_f32 v6, v6, v142
 s_add_u32 s70, s70, 8192
 s_addc_u32 s71, s71, 0
 v_mfma_f32_16x16x32_bf16 v[88:91], a[212:215], a[148:151], v[88:91]
 v_mul_f32 v5, v5, v143
 v_cvt_pk_bf16_f32 v9, v6, v5
 v_mfma_f32_16x16x32_bf16 v[92:95], a[212:215], a[156:159], v[92:95]
 v_accvgpr_read_b32 v5, a70
 v_lshlrev_b32 v6, 16, v5
 v_mfma_f32_16x16x32_bf16 v[92:95], a[208:211], a[152:155], v[92:95]
 v_and_b32 v5, s26, v5
 v_mul_f32 v6, v6, v172
 v_mfma_f32_16x16x32_bf16 v[96:99], a[208:211], a[160:163], v[96:99]
 v_mul_f32 v5, v5, v173
 v_cvt_pk_bf16_f32 v10, v6, v5
 v_mfma_f32_16x16x32_bf16 v[96:99], a[212:215], a[164:167], v[96:99]
 v_accvgpr_read_b32 v5, a71
 v_lshlrev_b32 v6, 16, v5
 v_mfma_f32_16x16x32_bf16 v[100:103], a[212:215], a[172:175], v[100:103]
 v_and_b32 v5, s26, v5
 v_mul_f32 v6, v6, v174
 v_mfma_f32_16x16x32_bf16 v[100:103], a[208:211], a[168:171], v[100:103]
 v_mul_f32 v5, v5, v175
 v_cvt_pk_bf16_f32 v11, v6, v5
 v_mfma_f32_16x16x32_bf16 v[104:107], a[208:211], a[176:179], v[104:107]
 ds_write_b128 v3, v[8:11] offset:6144
 v_mfma_f32_16x16x32_bf16 v[104:107], a[212:215], a[180:183], v[104:107]
 buffer_store_dwordx4 v[8:11], v3, s[32:35], s68 offen offset:2048 sc1
 v_accvgpr_read_b32 v5, a100
 v_lshlrev_b32 v6, 16, v5
 v_and_b32 v5, s26, v5
 v_mul_f32 v6, v6, v204
 v_mfma_f32_16x16x32_bf16 v[108:111], a[212:215], a[188:191], v[108:111]
 v_mul_f32 v5, v5, v205
 v_cvt_pk_bf16_f32 v12, v6, v5
 v_mfma_f32_16x16x32_bf16 v[108:111], a[208:211], a[184:187], v[108:111]
 v_accvgpr_read_b32 v5, a101
 v_lshlrev_b32 v6, 16, v5
 s_waitcnt vmcnt(12)
 v_mfma_f32_16x16x32_bf16 a[244:247], a[216:219], a[184:187], a[244:247]
 ds_read_b128 a[184:187], v1 offset:61440
 v_and_b32 v5, s26, v5
 v_mfma_f32_16x16x32_bf16 a[244:247], a[220:223], a[188:191], a[244:247]
 global_load_dwordx4 a[212:215], v0, s[70:71] offset:-3072 sc1
 ds_read_b128 a[188:191], v1 offset:62464
 v_mfma_f32_16x16x32_bf16 a[240:243], a[220:223], a[180:183], a[240:243]
 ds_read_b128 a[180:183], v1 offset:58368
 v_mul_f32 v6, v6, v206
 v_mfma_f32_16x16x32_bf16 a[240:243], a[216:219], a[176:179], a[240:243]
 global_load_dwordx4 a[208:211], v0, s[70:71] offset:-4096 sc1
 ds_read_b128 a[176:179], v1 offset:57344
 v_mfma_f32_16x16x32_bf16 v[132:135], a[216:219], a[168:171], v[132:135]
 ds_read_b128 a[168:171], v1 offset:53248
 v_mul_f32 v5, v5, v207
 v_mfma_f32_16x16x32_bf16 v[132:135], a[220:223], a[172:175], v[132:135]
 ds_read_b128 a[172:175], v1 offset:54272
 v_cvt_pk_bf16_f32 v13, v6, v5
 v_mfma_f32_16x16x32_bf16 v[128:131], a[220:223], a[164:167], v[128:131]
 ds_read_b128 a[164:167], v1 offset:50176
 v_accvgpr_read_b32 v5, a102
 v_lshlrev_b32 v6, 16, v5
 v_mfma_f32_16x16x32_bf16 v[128:131], a[216:219], a[160:163], v[128:131]
 ds_read_b128 a[160:163], v1 offset:49152
 v_and_b32 v5, s26, v5
 v_mul_f32 v6, v6, v236
 v_mfma_f32_16x16x32_bf16 v[124:127], a[216:219], a[152:155], v[124:127]
 ds_read_b128 a[152:155], v1 offset:45056
 v_mul_f32 v5, v5, v237
 v_mfma_f32_16x16x32_bf16 v[124:127], a[220:223], a[156:159], v[124:127]
 ds_read_b128 a[156:159], v1 offset:46080
 v_cvt_pk_bf16_f32 v14, v6, v5
 v_mfma_f32_16x16x32_bf16 v[120:123], a[220:223], a[148:151], v[120:123]
 ds_read_b128 a[148:151], v1 offset:41984
 v_accvgpr_read_b32 v5, a103
 v_mfma_f32_16x16x32_bf16 v[120:123], a[216:219], a[144:147], v[120:123]
 ds_read_b128 a[144:147], v1 offset:40960
 v_lshlrev_b32 v6, 16, v5
 v_mfma_f32_16x16x32_bf16 v[116:119], a[216:219], a[136:139], v[116:119]
 ds_read_b128 a[136:139], v1 offset:36864
 v_and_b32 v5, s26, v5
 v_mfma_f32_16x16x32_bf16 v[116:119], a[220:223], a[140:143], v[116:119]
 ds_read_b128 a[140:143], v1 offset:37888
 v_mul_f32 v6, v6, v238
 v_mfma_f32_16x16x32_bf16 v[112:115], a[220:223], a[132:135], v[112:115]
 ds_read_b128 a[132:135], v1 offset:33792
 v_mul_f32 v5, v5, v239
 v_mfma_f32_16x16x32_bf16 v[112:115], a[216:219], a[128:131], v[112:115]
 ds_read_b128 a[128:131], v1 offset:32768
 v_cvt_pk_bf16_f32 v15, v6, v5
 s_waitcnt vmcnt(11) lgkmcnt(8)
 v_mfma_f32_16x16x32_bf16 v[44:47], a[224:227], a[184:187], v[44:47]
 ds_write_b128 v3, v[12:15] offset:7168
 v_mfma_f32_16x16x32_bf16 v[44:47], a[228:231], a[188:191], v[44:47]
 buffer_store_dwordx4 v[12:15], v3, s[32:35], s68 offen offset:3072 sc1
 global_load_dwordx4 a[220:223], v0, s[70:71] offset:-1024 sc1
 v_accvgpr_read_b32 v5, a72
 v_lshlrev_b32 v6, 16, v5
 v_and_b32 v5, s26, v5
 v_mfma_f32_16x16x32_bf16 v[40:43], a[228:231], a[180:183], v[40:43]
 v_mul_f32 v6, v6, v144
 v_mul_f32 v5, v5, v145
 v_mfma_f32_16x16x32_bf16 v[40:43], a[224:227], a[176:179], v[40:43]
 global_load_dwordx4 a[216:219], v0, s[70:71] offset:-2048 sc1
 v_cvt_pk_bf16_f32 v8, v6, v5
 v_mfma_f32_16x16x32_bf16 v[36:39], a[224:227], a[168:171], v[36:39]
 v_accvgpr_read_b32 v5, a73
 v_lshlrev_b32 v6, 16, v5
 v_mfma_f32_16x16x32_bf16 v[36:39], a[228:231], a[172:175], v[36:39]
 v_and_b32 v5, s26, v5
 v_mul_f32 v6, v6, v146
 v_mfma_f32_16x16x32_bf16 v[32:35], a[228:231], a[164:167], v[32:35]
 v_mul_f32 v5, v5, v147
 v_cvt_pk_bf16_f32 v9, v6, v5
 v_mfma_f32_16x16x32_bf16 v[32:35], a[224:227], a[160:163], v[32:35]
 v_accvgpr_read_b32 v5, a74
 v_lshlrev_b32 v6, 16, v5
 s_waitcnt lgkmcnt(1)
 v_mfma_f32_16x16x32_bf16 v[28:31], a[224:227], a[152:155], v[28:31]
 v_and_b32 v5, s26, v5
 v_mul_f32 v6, v6, v176
 v_mfma_f32_16x16x32_bf16 v[28:31], a[228:231], a[156:159], v[28:31]
 v_mul_f32 v5, v5, v177
 v_cvt_pk_bf16_f32 v10, v6, v5
 v_mfma_f32_16x16x32_bf16 v[24:27], a[228:231], a[148:151], v[24:27]
 v_accvgpr_read_b32 v5, a75
 v_lshlrev_b32 v6, 16, v5
 v_mfma_f32_16x16x32_bf16 v[24:27], a[224:227], a[144:147], v[24:27]
 v_and_b32 v5, s26, v5
 v_mul_f32 v6, v6, v178
 v_mfma_f32_16x16x32_bf16 v[20:23], a[224:227], a[136:139], v[20:23]
 v_mul_f32 v5, v5, v179
 v_cvt_pk_bf16_f32 v11, v6, v5
 v_mfma_f32_16x16x32_bf16 v[20:23], a[228:231], a[140:143], v[20:23]
 ds_write_b128 v3, v[8:11] offset:10240
 s_add_u32 s68, s29, 20480
 v_mfma_f32_16x16x32_bf16 v[16:19], a[228:231], a[132:135], v[16:19]
 buffer_store_dwordx4 v[8:11], v3, s[32:35], s68 offen sc1
 v_accvgpr_read_b32 v5, a104
 v_lshlrev_b32 v6, 16, v5
 v_mfma_f32_16x16x32_bf16 v[16:19], a[224:227], a[128:131], v[16:19]
 v_and_b32 v5, s26, v5
 v_mul_f32 v6, v6, v208
 s_waitcnt vmcnt(13)
 v_mfma_f32_16x16x32_bf16 v[48:51], a[232:235], a[128:131], v[48:51]
 v_mul_f32 v5, v5, v209
 v_cvt_pk_bf16_f32 v12, v6, v5
 v_mfma_f32_16x16x32_bf16 v[48:51], a[236:239], a[132:135], v[48:51]
 global_load_dwordx4 a[228:231], v0, s[70:71] offset:1024 sc1
 v_accvgpr_read_b32 v5, a105
 v_mfma_f32_16x16x32_bf16 v[52:55], a[236:239], a[140:143], v[52:55]
 v_lshlrev_b32 v6, 16, v5
 v_and_b32 v5, s26, v5
 v_mfma_f32_16x16x32_bf16 v[52:55], a[232:235], a[136:139], v[52:55]
 global_load_dwordx4 a[224:227], v0, s[70:71] offset:0 sc1
 v_mul_f32 v6, v6, v210
 v_mfma_f32_16x16x32_bf16 v[56:59], a[232:235], a[144:147], v[56:59]
 v_mul_f32 v5, v5, v211
 v_cvt_pk_bf16_f32 v13, v6, v5
 v_mfma_f32_16x16x32_bf16 v[56:59], a[236:239], a[148:151], v[56:59]
 v_accvgpr_read_b32 v5, a106
 v_lshlrev_b32 v6, 16, v5
 v_mfma_f32_16x16x32_bf16 v[60:63], a[236:239], a[156:159], v[60:63]
 v_and_b32 v5, s26, v5
 v_mfma_f32_16x16x32_bf16 v[60:63], a[232:235], a[152:155], v[60:63]
 v_mul_f32 v6, v6, v240
 v_mul_f32 v5, v5, v241
 v_mfma_f32_16x16x32_bf16 v[64:67], a[232:235], a[160:163], v[64:67]
 v_cvt_pk_bf16_f32 v14, v6, v5
 v_accvgpr_read_b32 v5, a107
 v_mfma_f32_16x16x32_bf16 v[64:67], a[236:239], a[164:167], v[64:67]
 v_lshlrev_b32 v6, 16, v5
 v_mfma_f32_16x16x32_bf16 v[68:71], a[236:239], a[172:175], v[68:71]
 v_and_b32 v5, s26, v5
 v_mul_f32 v6, v6, v242
 v_mfma_f32_16x16x32_bf16 v[68:71], a[232:235], a[168:171], v[68:71]
 v_mul_f32 v5, v5, v243
 v_cvt_pk_bf16_f32 v15, v6, v5
 v_mfma_f32_16x16x32_bf16 v[72:75], a[232:235], a[176:179], v[72:75]
 ds_write_b128 v3, v[12:15] offset:11264
 v_mfma_f32_16x16x32_bf16 v[72:75], a[236:239], a[180:183], v[72:75]
 buffer_store_dwordx4 v[12:15], v3, s[32:35], s68 offen offset:1024 sc1
 v_accvgpr_read_b32 v5, a76
 v_lshlrev_b32 v6, 16, v5
 v_mfma_f32_16x16x32_bf16 v[76:79], a[236:239], a[188:191], v[76:79]
 v_and_b32 v5, s26, v5
 v_mul_f32 v6, v6, v148
 v_mfma_f32_16x16x32_bf16 v[76:79], a[232:235], a[184:187], v[76:79]
 v_mul_f32 v5, v5, v149
 v_cvt_pk_bf16_f32 v8, v6, v5
 s_waitcnt vmcnt(13)
 v_mfma_f32_16x16x32_bf16 v[108:111], a[192:195], a[184:187], v[108:111]
 v_accvgpr_read_b32 v5, a77
 v_lshlrev_b32 v6, 16, v5
 v_mfma_f32_16x16x32_bf16 v[108:111], a[196:199], a[188:191], v[108:111]
 global_load_dwordx4 a[236:239], v0, s[70:71] offset:3072 sc1
 v_and_b32 v5, s26, v5
 v_mfma_f32_16x16x32_bf16 v[104:107], a[196:199], a[180:183], v[104:107]
 v_mul_f32 v6, v6, v150
 v_mul_f32 v5, v5, v151
 v_mfma_f32_16x16x32_bf16 v[104:107], a[192:195], a[176:179], v[104:107]
 global_load_dwordx4 a[232:235], v0, s[70:71] offset:2048 sc1
 v_cvt_pk_bf16_f32 v9, v6, v5
 v_mfma_f32_16x16x32_bf16 v[100:103], a[192:195], a[168:171], v[100:103]
 v_accvgpr_read_b32 v5, a78
 v_lshlrev_b32 v6, 16, v5
 s_add_u32 s70, s70, 8192
 s_addc_u32 s71, s71, 0
 v_mfma_f32_16x16x32_bf16 v[100:103], a[196:199], a[172:175], v[100:103]
 v_and_b32 v5, s26, v5
 v_mul_f32 v6, v6, v180
 v_mfma_f32_16x16x32_bf16 v[96:99], a[196:199], a[164:167], v[96:99]
 v_mul_f32 v5, v5, v181
 v_cvt_pk_bf16_f32 v10, v6, v5
 v_mfma_f32_16x16x32_bf16 v[96:99], a[192:195], a[160:163], v[96:99]
 v_accvgpr_read_b32 v5, a79
 v_lshlrev_b32 v6, 16, v5
 v_mfma_f32_16x16x32_bf16 v[92:95], a[192:195], a[152:155], v[92:95]
 v_and_b32 v5, s26, v5
 v_mul_f32 v6, v6, v182
 v_mfma_f32_16x16x32_bf16 v[92:95], a[196:199], a[156:159], v[92:95]
 v_mul_f32 v5, v5, v183
 v_cvt_pk_bf16_f32 v11, v6, v5
 v_mfma_f32_16x16x32_bf16 v[88:91], a[196:199], a[148:151], v[88:91]
 ds_write_b128 v3, v[8:11] offset:14336
 v_mfma_f32_16x16x32_bf16 v[88:91], a[192:195], a[144:147], v[88:91]
 buffer_store_dwordx4 v[8:11], v3, s[32:35], s68 offen offset:2048 sc1
 v_accvgpr_read_b32 v5, a108
 v_lshlrev_b32 v6, 16, v5
 v_and_b32 v5, s26, v5
 v_mul_f32 v6, v6, v212
 v_mfma_f32_16x16x32_bf16 v[84:87], a[192:195], a[136:139], v[84:87]
 v_mul_f32 v5, v5, v213
 v_cvt_pk_bf16_f32 v12, v6, v5
 v_mfma_f32_16x16x32_bf16 v[84:87], a[196:199], a[140:143], v[84:87]
 v_accvgpr_read_b32 v5, a109
 v_lshlrev_b32 v6, 16, v5
 v_mfma_f32_16x16x32_bf16 v[80:83], a[196:199], a[132:135], v[80:83]
 v_and_b32 v5, s26, v5
 v_mul_f32 v6, v6, v214
 v_mfma_f32_16x16x32_bf16 v[80:83], a[192:195], a[128:131], v[80:83]
 v_mul_f32 v5, v5, v215
 v_cvt_pk_bf16_f32 v13, v6, v5
 s_waitcnt vmcnt(13)
 v_mfma_f32_16x16x32_bf16 v[112:115], a[200:203], a[128:131], v[112:115]
 ds_read_b128 a[128:131], v2
 v_accvgpr_read_b32 v5, a110
 v_mfma_f32_16x16x32_bf16 v[112:115], a[204:207], a[132:135], v[112:115]
 global_load_dwordx4 a[196:199], v0, s[70:71] offset:-3072 sc1
 ds_read_b128 a[132:135], v2 offset:1024
 v_mfma_f32_16x16x32_bf16 v[116:119], a[204:207], a[140:143], v[116:119]
 ds_read_b128 a[140:143], v2 offset:5120
 v_lshlrev_b32 v6, 16, v5
 v_mfma_f32_16x16x32_bf16 v[116:119], a[200:203], a[136:139], v[116:119]
 global_load_dwordx4 a[192:195], v0, s[70:71] offset:-4096 sc1
 ds_read_b128 a[136:139], v2 offset:4096
 v_mfma_f32_16x16x32_bf16 v[120:123], a[200:203], a[144:147], v[120:123]
 ds_read_b128 a[144:147], v2 offset:8192
 v_and_b32 v5, s26, v5
 v_mfma_f32_16x16x32_bf16 v[120:123], a[204:207], a[148:151], v[120:123]
 ds_read_b128 a[148:151], v2 offset:9216
 v_mul_f32 v6, v6, v244
 v_mfma_f32_16x16x32_bf16 v[124:127], a[204:207], a[156:159], v[124:127]
 ds_read_b128 a[156:159], v2 offset:13312
 v_mul_f32 v5, v5, v245
 v_cvt_pk_bf16_f32 v14, v6, v5
 v_mfma_f32_16x16x32_bf16 v[124:127], a[200:203], a[152:155], v[124:127]
 ds_read_b128 a[152:155], v2 offset:12288
 v_accvgpr_read_b32 v5, a111
 v_mfma_f32_16x16x32_bf16 v[128:131], a[200:203], a[160:163], v[128:131]
 ds_read_b128 a[160:163], v2 offset:16384
 v_lshlrev_b32 v6, 16, v5
 v_mfma_f32_16x16x32_bf16 v[128:131], a[204:207], a[164:167], v[128:131]
 ds_read_b128 a[164:167], v2 offset:17408
 v_and_b32 v5, s26, v5
 v_mfma_f32_16x16x32_bf16 v[132:135], a[204:207], a[172:175], v[132:135]
 ds_read_b128 a[172:175], v2 offset:21504
 v_mul_f32 v6, v6, v246
 v_mfma_f32_16x16x32_bf16 v[132:135], a[200:203], a[168:171], v[132:135]
 ds_read_b128 a[168:171], v2 offset:20480
 v_mul_f32 v5, v5, v247
 v_mfma_f32_16x16x32_bf16 a[240:243], a[200:203], a[176:179], a[240:243]
 ds_read_b128 a[176:179], v2 offset:24576
 v_cvt_pk_bf16_f32 v15, v6, v5
 v_mfma_f32_16x16x32_bf16 a[240:243], a[204:207], a[180:183], a[240:243]
 ds_read_b128 a[180:183], v2 offset:25600
 ds_write_b128 v3, v[12:15] offset:15360
 s_add_u32 s31, s31, 1
 v_mov_b32 v7, s31
 v_mfma_f32_16x16x32_bf16 a[244:247], a[204:207], a[188:191], a[244:247]
 buffer_store_dword v7, v1, s[60:63], 0 offen sc1
 ds_read_b128 a[188:191], v2 offset:29696
 v_mfma_f32_16x16x32_bf16 a[244:247], a[200:203], a[184:187], a[244:247]
 buffer_store_dwordx4 v[12:15], v3, s[32:35], s68 offen offset:3072 sc1
 ds_read_b128 a[184:187], v2 offset:28672
 v_accvgpr_read_b32 v5, a80
 v_lshlrev_b32 v6, 16, v5
 v_and_b32 v5, s26, v5
 s_waitcnt vmcnt(14) lgkmcnt(9)
 v_mfma_f32_16x16x32_bf16 v[16:19], a[208:211], a[128:131], v[16:19]
 v_mul_f32 v6, v6, v152
 v_mul_f32 v5, v5, v153
 v_mfma_f32_16x16x32_bf16 v[16:19], a[212:215], a[132:135], v[16:19]
 global_load_dwordx4 a[204:207], v0, s[70:71] offset:-1024 sc1
 v_cvt_pk_bf16_f32 v8, v6, v5
 v_mfma_f32_16x16x32_bf16 v[20:23], a[212:215], a[140:143], v[20:23]
 v_accvgpr_read_b32 v5, a81
 v_lshlrev_b32 v6, 16, v5
 v_mfma_f32_16x16x32_bf16 v[20:23], a[208:211], a[136:139], v[20:23]
 global_load_dwordx4 a[200:203], v0, s[70:71] offset:-2048 sc1
 v_and_b32 v5, s26, v5
 v_mfma_f32_16x16x32_bf16 v[24:27], a[208:211], a[144:147], v[24:27]
 v_mul_f32 v6, v6, v154
 v_mul_f32 v5, v5, v155
 v_mfma_f32_16x16x32_bf16 v[24:27], a[212:215], a[148:151], v[24:27]
 v_cvt_pk_bf16_f32 v9, v6, v5
 v_accvgpr_read_b32 v5, a82
 v_mfma_f32_16x16x32_bf16 v[28:31], a[212:215], a[156:159], v[28:31]
 v_lshlrev_b32 v6, 16, v5
 v_and_b32 v5, s26, v5
 v_mfma_f32_16x16x32_bf16 v[28:31], a[208:211], a[152:155], v[28:31]
 v_mul_f32 v6, v6, v184
 s_waitcnt lgkmcnt(0)
 v_mfma_f32_16x16x32_bf16 v[32:35], a[208:211], a[160:163], v[32:35]
 v_mul_f32 v5, v5, v185
 v_cvt_pk_bf16_f32 v10, v6, v5
 v_mfma_f32_16x16x32_bf16 v[32:35], a[212:215], a[164:167], v[32:35]
 v_accvgpr_read_b32 v5, a83
 v_lshlrev_b32 v6, 16, v5
 v_mfma_f32_16x16x32_bf16 v[36:39], a[212:215], a[172:175], v[36:39]
 v_and_b32 v5, s26, v5
 v_mul_f32 v6, v6, v186
 v_mfma_f32_16x16x32_bf16 v[36:39], a[208:211], a[168:171], v[36:39]
 v_mul_f32 v5, v5, v187
 v_cvt_pk_bf16_f32 v11, v6, v5
 v_mfma_f32_16x16x32_bf16 v[40:43], a[208:211], a[176:179], v[40:43]
 ds_write_b128 v3, v[8:11] offset:18432
 v_mfma_f32_16x16x32_bf16 v[40:43], a[212:215], a[180:183], v[40:43]
 s_add_u32 s68, s29, 24576
 buffer_store_dwordx4 v[8:11], v3, s[32:35], s68 offen sc1
 v_mfma_f32_16x16x32_bf16 v[44:47], a[212:215], a[188:191], v[44:47]
 v_accvgpr_read_b32 v5, a112
 v_mfma_f32_16x16x32_bf16 v[44:47], a[208:211], a[184:187], v[44:47]
 v_lshlrev_b32 v6, 16, v5
 v_and_b32 v5, s26, v5
 s_waitcnt vmcnt(14)
 v_mfma_f32_16x16x32_bf16 v[76:79], a[216:219], a[184:187], v[76:79]
 v_mul_f32 v6, v6, v216
 v_mul_f32 v5, v5, v217
 v_mfma_f32_16x16x32_bf16 v[76:79], a[220:223], a[188:191], v[76:79]
 global_load_dwordx4 a[212:215], v0, s[70:71] offset:1024 sc1
 v_cvt_pk_bf16_f32 v12, v6, v5
 v_mfma_f32_16x16x32_bf16 v[72:75], a[220:223], a[180:183], v[72:75]
 v_accvgpr_read_b32 v5, a113
 v_lshlrev_b32 v6, 16, v5
 v_mfma_f32_16x16x32_bf16 v[72:75], a[216:219], a[176:179], v[72:75]
 global_load_dwordx4 a[208:211], v0, s[70:71] offset:0 sc1
 v_and_b32 v5, s26, v5
 v_mfma_f32_16x16x32_bf16 v[68:71], a[216:219], a[168:171], v[68:71]
 v_mul_f32 v6, v6, v218
 v_mul_f32 v5, v5, v219
 v_mfma_f32_16x16x32_bf16 v[68:71], a[220:223], a[172:175], v[68:71]
 v_cvt_pk_bf16_f32 v13, v6, v5
 v_accvgpr_read_b32 v5, a114
 v_mfma_f32_16x16x32_bf16 v[64:67], a[220:223], a[164:167], v[64:67]
 v_lshlrev_b32 v6, 16, v5
 v_and_b32 v5, s26, v5
 v_mfma_f32_16x16x32_bf16 v[64:67], a[216:219], a[160:163], v[64:67]
 v_mul_f32 v6, v6, v248
 v_mul_f32 v5, v5, v249
 v_mfma_f32_16x16x32_bf16 v[60:63], a[216:219], a[152:155], v[60:63]
 v_cvt_pk_bf16_f32 v14, v6, v5
 v_mfma_f32_16x16x32_bf16 v[60:63], a[220:223], a[156:159], v[60:63]
 v_accvgpr_read_b32 v5, a115
 v_lshlrev_b32 v6, 16, v5
 v_mfma_f32_16x16x32_bf16 v[56:59], a[220:223], a[148:151], v[56:59]
 v_and_b32 v5, s26, v5
 v_mul_f32 v6, v6, v250
 v_mfma_f32_16x16x32_bf16 v[56:59], a[216:219], a[144:147], v[56:59]
 v_mul_f32 v5, v5, v251
 v_cvt_pk_bf16_f32 v15, v6, v5
 v_mfma_f32_16x16x32_bf16 v[52:55], a[216:219], a[136:139], v[52:55]
 ds_write_b128 v3, v[12:15] offset:19456
 v_mfma_f32_16x16x32_bf16 v[52:55], a[220:223], a[140:143], v[52:55]
 buffer_store_dwordx4 v[12:15], v3, s[32:35], s68 offen offset:1024 sc1
 v_accvgpr_read_b32 v5, a84
 v_mfma_f32_16x16x32_bf16 v[48:51], a[220:223], a[132:135], v[48:51]
 v_lshlrev_b32 v6, 16, v5
 v_mfma_f32_16x16x32_bf16 v[48:51], a[216:219], a[128:131], v[48:51]
 v_and_b32 v5, s26, v5
 v_mul_f32 v6, v6, v156
 s_waitcnt vmcnt(14)
 v_mfma_f32_16x16x32_bf16 v[80:83], a[224:227], a[128:131], v[80:83]
 v_mul_f32 v5, v5, v157
 v_cvt_pk_bf16_f32 v8, v6, v5
 v_mfma_f32_16x16x32_bf16 v[80:83], a[228:231], a[132:135], v[80:83]
 global_load_dwordx4 a[220:223], v0, s[70:71] offset:3072 sc1
 v_accvgpr_read_b32 v5, a85
 v_mfma_f32_16x16x32_bf16 v[84:87], a[228:231], a[140:143], v[84:87]
 v_lshlrev_b32 v6, 16, v5
 v_and_b32 v5, s26, v5
 v_mfma_f32_16x16x32_bf16 v[84:87], a[224:227], a[136:139], v[84:87]
 global_load_dwordx4 a[216:219], v0, s[70:71] offset:2048 sc1
 v_mul_f32 v6, v6, v158
 v_mfma_f32_16x16x32_bf16 v[88:91], a[224:227], a[144:147], v[88:91]
 v_mul_f32 v5, v5, v159
 v_cvt_pk_bf16_f32 v9, v6, v5
 s_add_u32 s70, s70, 8192
 s_addc_u32 s71, s71, 0
 v_mfma_f32_16x16x32_bf16 v[88:91], a[228:231], a[148:151], v[88:91]
 v_accvgpr_read_b32 v5, a86
 v_lshlrev_b32 v6, 16, v5
 v_mfma_f32_16x16x32_bf16 v[92:95], a[228:231], a[156:159], v[92:95]
 v_and_b32 v5, s26, v5
 v_mul_f32 v6, v6, v188
 v_mfma_f32_16x16x32_bf16 v[92:95], a[224:227], a[152:155], v[92:95]
 v_mul_f32 v5, v5, v189
 v_cvt_pk_bf16_f32 v10, v6, v5
 v_mfma_f32_16x16x32_bf16 v[96:99], a[224:227], a[160:163], v[96:99]
 v_accvgpr_read_b32 v5, a87
 v_lshlrev_b32 v6, 16, v5
 v_mfma_f32_16x16x32_bf16 v[96:99], a[228:231], a[164:167], v[96:99]
 v_and_b32 v5, s26, v5
 v_mul_f32 v6, v6, v190
 v_mfma_f32_16x16x32_bf16 v[100:103], a[228:231], a[172:175], v[100:103]
 v_mul_f32 v5, v5, v191
 v_cvt_pk_bf16_f32 v11, v6, v5
 v_mfma_f32_16x16x32_bf16 v[100:103], a[224:227], a[168:171], v[100:103]
 ds_write_b128 v3, v[8:11] offset:22528
 v_mfma_f32_16x16x32_bf16 v[104:107], a[224:227], a[176:179], v[104:107]
 buffer_store_dwordx4 v[8:11], v3, s[32:35], s68 offen offset:2048 sc1
 v_accvgpr_read_b32 v5, a116
 v_lshlrev_b32 v6, 16, v5
 v_and_b32 v5, s26, v5
 v_mul_f32 v6, v6, v220
 v_mfma_f32_16x16x32_bf16 v[104:107], a[228:231], a[180:183], v[104:107]
 v_mul_f32 v5, v5, v221
 v_cvt_pk_bf16_f32 v12, v6, v5
 v_mfma_f32_16x16x32_bf16 v[108:111], a[228:231], a[188:191], v[108:111]
 v_accvgpr_read_b32 v5, a117
 v_lshlrev_b32 v6, 16, v5
 v_mfma_f32_16x16x32_bf16 v[108:111], a[224:227], a[184:187], v[108:111]
 v_and_b32 v5, s26, v5
 v_mul_f32 v6, v6, v222
 s_waitcnt vmcnt(14)
 v_mfma_f32_16x16x32_bf16 a[244:247], a[232:235], a[184:187], a[244:247]
 ds_read_b128 a[184:187], v2 offset:61440
 v_mul_f32 v5, v5, v223
 v_mfma_f32_16x16x32_bf16 a[244:247], a[236:239], a[188:191], a[244:247]
 global_load_dwordx4 a[228:231], v0, s[70:71] offset:-3072 sc1
 ds_read_b128 a[188:191], v2 offset:62464
 v_mfma_f32_16x16x32_bf16 a[240:243], a[236:239], a[180:183], a[240:243]
 ds_read_b128 a[180:183], v2 offset:58368
 v_cvt_pk_bf16_f32 v13, v6, v5
 v_mfma_f32_16x16x32_bf16 a[240:243], a[232:235], a[176:179], a[240:243]
 global_load_dwordx4 a[224:227], v0, s[70:71] offset:-4096 sc1
 ds_read_b128 a[176:179], v2 offset:57344
 v_accvgpr_read_b32 v5, a118
 v_mfma_f32_16x16x32_bf16 v[132:135], a[232:235], a[168:171], v[132:135]
 ds_read_b128 a[168:171], v2 offset:53248
 v_lshlrev_b32 v6, 16, v5
 v_mfma_f32_16x16x32_bf16 v[132:135], a[236:239], a[172:175], v[132:135]
 ds_read_b128 a[172:175], v2 offset:54272
 v_and_b32 v5, s26, v5
 v_mfma_f32_16x16x32_bf16 v[128:131], a[236:239], a[164:167], v[128:131]
 ds_read_b128 a[164:167], v2 offset:50176
 v_mul_f32 v6, v6, v252
 v_mfma_f32_16x16x32_bf16 v[128:131], a[232:235], a[160:163], v[128:131]
 ds_read_b128 a[160:163], v2 offset:49152
 v_mul_f32 v5, v5, v253
 v_mfma_f32_16x16x32_bf16 v[124:127], a[232:235], a[152:155], v[124:127]
 ds_read_b128 a[152:155], v2 offset:45056
 v_cvt_pk_bf16_f32 v14, v6, v5
 v_mfma_f32_16x16x32_bf16 v[124:127], a[236:239], a[156:159], v[124:127]
 ds_read_b128 a[156:159], v2 offset:46080
 v_accvgpr_read_b32 v5, a119
 v_mfma_f32_16x16x32_bf16 v[120:123], a[236:239], a[148:151], v[120:123]
 ds_read_b128 a[148:151], v2 offset:41984
 v_lshlrev_b32 v6, 16, v5
 v_mfma_f32_16x16x32_bf16 v[120:123], a[232:235], a[144:147], v[120:123]
 ds_read_b128 a[144:147], v2 offset:40960
 v_and_b32 v5, s26, v5
 v_mfma_f32_16x16x32_bf16 v[116:119], a[232:235], a[136:139], v[116:119]
 ds_read_b128 a[136:139], v2 offset:36864
 v_mul_f32 v6, v6, v254
 v_mfma_f32_16x16x32_bf16 v[116:119], a[236:239], a[140:143], v[116:119]
 ds_read_b128 a[140:143], v2 offset:37888
 v_mul_f32 v5, v5, v255
 v_mfma_f32_16x16x32_bf16 v[112:115], a[236:239], a[132:135], v[112:115]
 ds_read_b128 a[132:135], v2 offset:33792
 v_cvt_pk_bf16_f32 v15, v6, v5
 v_mfma_f32_16x16x32_bf16 v[112:115], a[232:235], a[128:131], v[112:115]
 ds_read_b128 a[128:131], v2 offset:32768
 ds_write_b128 v3, v[12:15] offset:23552
 buffer_store_dwordx4 v[12:15], v3, s[32:35], s68 offen offset:3072 sc1
 v_accvgpr_read_b32 v5, a88
 v_lshlrev_b32 v6, 16, v5
 v_and_b32 v5, s26, v5
 s_waitcnt vmcnt(14) lgkmcnt(9)
 v_mfma_f32_16x16x32_bf16 v[44:47], a[192:195], a[184:187], v[44:47]
 v_mul_f32 v6, v6, v160
 v_mul_f32 v5, v5, v161
 v_mfma_f32_16x16x32_bf16 v[44:47], a[196:199], a[188:191], v[44:47]
 global_load_dwordx4 a[236:239], v0, s[70:71] offset:-1024 sc1
 v_cvt_pk_bf16_f32 v8, v6, v5
 v_mfma_f32_16x16x32_bf16 v[40:43], a[196:199], a[180:183], v[40:43]
 v_accvgpr_read_b32 v5, a89
 v_lshlrev_b32 v6, 16, v5
 v_mfma_f32_16x16x32_bf16 v[40:43], a[192:195], a[176:179], v[40:43]
 global_load_dwordx4 a[232:235], v0, s[70:71] offset:-2048 sc1
 v_and_b32 v5, s26, v5
 v_mfma_f32_16x16x32_bf16 v[36:39], a[192:195], a[168:171], v[36:39]
 v_mul_f32 v6, v6, v162
 v_mul_f32 v5, v5, v163
 v_mfma_f32_16x16x32_bf16 v[36:39], a[196:199], a[172:175], v[36:39]
 v_cvt_pk_bf16_f32 v9, v6, v5
 v_accvgpr_read_b32 v5, a90
 v_mfma_f32_16x16x32_bf16 v[32:35], a[196:199], a[164:167], v[32:35]
 v_lshlrev_b32 v6, 16, v5
 v_and_b32 v5, s26, v5
 v_mfma_f32_16x16x32_bf16 v[32:35], a[192:195], a[160:163], v[32:35]
 v_mul_f32 v6, v6, v192
 v_mul_f32 v5, v5, v193
 s_waitcnt lgkmcnt(1)
 v_mfma_f32_16x16x32_bf16 v[28:31], a[192:195], a[152:155], v[28:31]
 v_cvt_pk_bf16_f32 v10, v6, v5
 v_accvgpr_read_b32 v5, a91
 v_mfma_f32_16x16x32_bf16 v[28:31], a[196:199], a[156:159], v[28:31]
 v_lshlrev_b32 v6, 16, v5
 v_and_b32 v5, s26, v5
 v_mfma_f32_16x16x32_bf16 v[24:27], a[196:199], a[148:151], v[24:27]
 v_mul_f32 v6, v6, v194
 v_mul_f32 v5, v5, v195
 v_mfma_f32_16x16x32_bf16 v[24:27], a[192:195], a[144:147], v[24:27]
 v_cvt_pk_bf16_f32 v11, v6, v5
 v_mfma_f32_16x16x32_bf16 v[20:23], a[192:195], a[136:139], v[20:23]
 ds_write_b128 v3, v[8:11] offset:26624
 s_add_u32 s68, s29, 28672
 v_mfma_f32_16x16x32_bf16 v[20:23], a[196:199], a[140:143], v[20:23]
 buffer_store_dwordx4 v[8:11], v3, s[32:35], s68 offen sc1
 v_accvgpr_read_b32 v5, a120
 v_lshlrev_b32 v6, 16, v5
 v_and_b32 v5, s26, v5
 v_mfma_f32_16x16x32_bf16 v[16:19], a[196:199], a[132:135], v[16:19]
 v_mul_f32 v6, v6, v224
 v_mul_f32 v5, v5, v225
 v_mfma_f32_16x16x32_bf16 v[16:19], a[192:195], a[128:131], v[16:19]
 v_cvt_pk_bf16_f32 v12, v6, v5
 v_accvgpr_read_b32 v5, a121
 s_waitcnt vmcnt(13)
 v_mfma_f32_16x16x32_bf16 v[48:51], a[200:203], a[128:131], v[48:51]
 v_lshlrev_b32 v6, 16, v5
 v_and_b32 v5, s26, v5
 v_mfma_f32_16x16x32_bf16 v[48:51], a[204:207], a[132:135], v[48:51]
 global_load_dwordx4 a[196:199], v0, s[70:71] offset:1024 sc1
 v_mul_f32 v6, v6, v226
 v_mfma_f32_16x16x32_bf16 v[52:55], a[204:207], a[140:143], v[52:55]
 v_mul_f32 v5, v5, v227
 v_cvt_pk_bf16_f32 v13, v6, v5
 v_mfma_f32_16x16x32_bf16 v[52:55], a[200:203], a[136:139], v[52:55]
 global_load_dwordx4 a[192:195], v0, s[70:71] offset:0 sc1
 v_accvgpr_read_b32 v5, a122
 v_mfma_f32_16x16x32_bf16 v[56:59], a[200:203], a[144:147], v[56:59]
 v_accvgpr_read_b32 v7, a248
 v_lshlrev_b32 v6, 16, v5
 v_mfma_f32_16x16x32_bf16 v[56:59], a[204:207], a[148:151], v[56:59]
 v_and_b32 v5, s26, v5
 v_mul_f32 v6, v6, v7
 v_mfma_f32_16x16x32_bf16 v[60:63], a[204:207], a[156:159], v[60:63]
 v_accvgpr_read_b32 v7, a249
 v_mfma_f32_16x16x32_bf16 v[60:63], a[200:203], a[152:155], v[60:63]
 v_mul_f32 v5, v5, v7
 v_cvt_pk_bf16_f32 v14, v6, v5
 v_mfma_f32_16x16x32_bf16 v[64:67], a[200:203], a[160:163], v[64:67]
 v_accvgpr_read_b32 v5, a123
 v_accvgpr_read_b32 v7, a250
 v_mfma_f32_16x16x32_bf16 v[64:67], a[204:207], a[164:167], v[64:67]
 v_lshlrev_b32 v6, 16, v5
 v_mfma_f32_16x16x32_bf16 v[68:71], a[204:207], a[172:175], v[68:71]
 v_and_b32 v5, s26, v5
 v_mul_f32 v6, v6, v7
 v_mfma_f32_16x16x32_bf16 v[68:71], a[200:203], a[168:171], v[68:71]
 v_accvgpr_read_b32 v7, a251
 v_mul_f32 v5, v5, v7
 v_mfma_f32_16x16x32_bf16 v[72:75], a[200:203], a[176:179], v[72:75]
 v_cvt_pk_bf16_f32 v15, v6, v5
 v_mfma_f32_16x16x32_bf16 v[72:75], a[204:207], a[180:183], v[72:75]
 ds_write_b128 v3, v[12:15] offset:27648
 v_mfma_f32_16x16x32_bf16 v[76:79], a[204:207], a[188:191], v[76:79]
 buffer_store_dwordx4 v[12:15], v3, s[32:35], s68 offen offset:1024 sc1
 v_accvgpr_read_b32 v5, a92
 v_lshlrev_b32 v6, 16, v5
 v_mfma_f32_16x16x32_bf16 v[76:79], a[200:203], a[184:187], v[76:79]
 v_and_b32 v5, s26, v5
 v_mul_f32 v6, v6, v164
 s_waitcnt vmcnt(13)
 v_mfma_f32_16x16x32_bf16 v[108:111], a[208:211], a[184:187], v[108:111]
 v_mul_f32 v5, v5, v165
 v_cvt_pk_bf16_f32 v8, v6, v5
 v_mfma_f32_16x16x32_bf16 v[108:111], a[212:215], a[188:191], v[108:111]
 global_load_dwordx4 a[204:207], v0, s[70:71] offset:3072 sc1
 v_accvgpr_read_b32 v5, a93
 v_mfma_f32_16x16x32_bf16 v[104:107], a[212:215], a[180:183], v[104:107]
 v_lshlrev_b32 v6, 16, v5
 v_and_b32 v5, s26, v5
 v_mfma_f32_16x16x32_bf16 v[104:107], a[208:211], a[176:179], v[104:107]
 global_load_dwordx4 a[200:203], v0, s[70:71] offset:2048 sc1
 v_mul_f32 v6, v6, v166
 v_mfma_f32_16x16x32_bf16 v[100:103], a[208:211], a[168:171], v[100:103]
 v_mul_f32 v5, v5, v167
 v_cvt_pk_bf16_f32 v9, v6, v5
 s_add_u32 s70, s70, 8192
 s_addc_u32 s71, s71, 0
 v_mfma_f32_16x16x32_bf16 v[100:103], a[212:215], a[172:175], v[100:103]
 v_accvgpr_read_b32 v5, a94
 v_lshlrev_b32 v6, 16, v5
 v_mfma_f32_16x16x32_bf16 v[96:99], a[212:215], a[164:167], v[96:99]
 v_and_b32 v5, s26, v5
 v_mul_f32 v6, v6, v196
 v_mfma_f32_16x16x32_bf16 v[96:99], a[208:211], a[160:163], v[96:99]
 v_mul_f32 v5, v5, v197
 v_cvt_pk_bf16_f32 v10, v6, v5
 v_mfma_f32_16x16x32_bf16 v[92:95], a[208:211], a[152:155], v[92:95]
 v_accvgpr_read_b32 v5, a95
 v_lshlrev_b32 v6, 16, v5
 v_mfma_f32_16x16x32_bf16 v[92:95], a[212:215], a[156:159], v[92:95]
 v_and_b32 v5, s26, v5
 v_mul_f32 v6, v6, v198
 v_mfma_f32_16x16x32_bf16 v[88:91], a[212:215], a[148:151], v[88:91]
 v_mul_f32 v5, v5, v199
 v_cvt_pk_bf16_f32 v11, v6, v5
 v_mfma_f32_16x16x32_bf16 v[88:91], a[208:211], a[144:147], v[88:91]
 ds_write_b128 v3, v[8:11] offset:30720
 v_mfma_f32_16x16x32_bf16 v[84:87], a[208:211], a[136:139], v[84:87]
 buffer_store_dwordx4 v[8:11], v3, s[32:35], s68 offen offset:2048 sc1
 v_accvgpr_read_b32 v5, a124
 v_lshlrev_b32 v6, 16, v5
 v_and_b32 v5, s26, v5
 v_mul_f32 v6, v6, v228
 v_mfma_f32_16x16x32_bf16 v[84:87], a[212:215], a[140:143], v[84:87]
 v_mul_f32 v5, v5, v229
 v_cvt_pk_bf16_f32 v12, v6, v5
 v_mfma_f32_16x16x32_bf16 v[80:83], a[212:215], a[132:135], v[80:83]
 v_accvgpr_read_b32 v5, a125
 v_lshlrev_b32 v6, 16, v5
 v_mfma_f32_16x16x32_bf16 v[80:83], a[208:211], a[128:131], v[80:83]
 v_and_b32 v5, s26, v5
 v_mul_f32 v6, v6, v230
 s_waitcnt vmcnt(13)
 v_mfma_f32_16x16x32_bf16 v[112:115], a[216:219], a[128:131], v[112:115]
 ds_read_b128 a[128:131], v1
 v_mul_f32 v5, v5, v231
 v_mfma_f32_16x16x32_bf16 v[112:115], a[220:223], a[132:135], v[112:115]
 global_load_dwordx4 a[212:215], v0, s[70:71] offset:-3072 sc1
 ds_read_b128 a[132:135], v1 offset:1024
 v_mfma_f32_16x16x32_bf16 v[116:119], a[220:223], a[140:143], v[116:119]
 ds_read_b128 a[140:143], v1 offset:5120
 v_cvt_pk_bf16_f32 v13, v6, v5
 v_mfma_f32_16x16x32_bf16 v[116:119], a[216:219], a[136:139], v[116:119]
 global_load_dwordx4 a[208:211], v0, s[70:71] offset:-4096 sc1
 ds_read_b128 a[136:139], v1 offset:4096
 v_mfma_f32_16x16x32_bf16 v[120:123], a[216:219], a[144:147], v[120:123]
 ds_read_b128 a[144:147], v1 offset:8192
 v_accvgpr_read_b32 v5, a126
 v_mfma_f32_16x16x32_bf16 v[120:123], a[220:223], a[148:151], v[120:123]
 ds_read_b128 a[148:151], v1 offset:9216
 v_accvgpr_read_b32 v7, a252
 v_lshlrev_b32 v6, 16, v5
 v_mfma_f32_16x16x32_bf16 v[124:127], a[220:223], a[156:159], v[124:127]
 ds_read_b128 a[156:159], v1 offset:13312
 v_and_b32 v5, s26, v5
 v_mfma_f32_16x16x32_bf16 v[124:127], a[216:219], a[152:155], v[124:127]
 ds_read_b128 a[152:155], v1 offset:12288
 v_mul_f32 v6, v6, v7
 v_accvgpr_read_b32 v7, a253
 v_mfma_f32_16x16x32_bf16 v[128:131], a[216:219], a[160:163], v[128:131]
 ds_read_b128 a[160:163], v1 offset:16384
 v_mul_f32 v5, v5, v7
 v_cvt_pk_bf16_f32 v14, v6, v5
 v_mfma_f32_16x16x32_bf16 v[128:131], a[220:223], a[164:167], v[128:131]
 ds_read_b128 a[164:167], v1 offset:17408
 v_accvgpr_read_b32 v5, a127
 v_accvgpr_read_b32 v7, a254
 v_mfma_f32_16x16x32_bf16 v[132:135], a[220:223], a[172:175], v[132:135]
 ds_read_b128 a[172:175], v1 offset:21504
 v_lshlrev_b32 v6, 16, v5
 v_mfma_f32_16x16x32_bf16 v[132:135], a[216:219], a[168:171], v[132:135]
 ds_read_b128 a[168:171], v1 offset:20480
 v_and_b32 v5, s26, v5
 v_mul_f32 v6, v6, v7
 v_mfma_f32_16x16x32_bf16 a[240:243], a[216:219], a[176:179], a[240:243]
 ds_read_b128 a[176:179], v1 offset:24576
 v_accvgpr_read_b32 v7, a255
 v_mul_f32 v5, v5, v7
 v_cvt_pk_bf16_f32 v15, v6, v5
 v_mfma_f32_16x16x32_bf16 a[240:243], a[220:223], a[180:183], a[240:243]
 ds_read_b128 a[180:183], v1 offset:25600
 ds_write_b128 v3, v[12:15] offset:31744
 v_mfma_f32_16x16x32_bf16 a[244:247], a[220:223], a[188:191], a[244:247]
 buffer_store_dwordx4 v[12:15], v3, s[32:35], s68 offen offset:3072 sc1
 global_load_dwordx4 a[220:223], v0, s[70:71] offset:-1024 sc1
 ds_read_b128 a[188:191], v1 offset:29696
 v_mfma_f32_16x16x32_bf16 a[244:247], a[216:219], a[184:187], a[244:247]
 global_load_dwordx4 a[216:219], v0, s[70:71] offset:-2048 sc1
 ds_read_b128 a[184:187], v1 offset:28672
 s_waitcnt vmcnt(15) lgkmcnt(9)
Ls1b:
 v_mfma_f32_16x16x32_bf16 v[136:139], a[224:227], a[128:131], v[136:139]
 v_lshrrev_b32 v4, 8, v1
 v_mfma_f32_16x16x32_bf16 v[136:139], a[228:231], a[132:135], v[136:139]
 v_mfma_f32_16x16x32_bf16 v[140:143], a[228:231], a[140:143], v[140:143]
 v_lshl_add_u32 v4, v4, 5, s51
 v_mfma_f32_16x16x32_bf16 v[140:143], a[224:227], a[136:139], v[140:143]
 ds_read_b128 v[8:11], v4
 v_mfma_f32_16x16x32_bf16 v[144:147], a[224:227], a[144:147], v[144:147]
 v_mfma_f32_16x16x32_bf16 v[144:147], a[228:231], a[148:151], v[144:147]
 v_mfma_f32_16x16x32_bf16 v[148:151], a[228:231], a[156:159], v[148:151]
 v_mfma_f32_16x16x32_bf16 v[148:151], a[224:227], a[152:155], v[148:151]
 s_waitcnt lgkmcnt(1)
 v_mfma_f32_16x16x32_bf16 v[152:155], a[224:227], a[160:163], v[152:155]
 v_mfma_f32_16x16x32_bf16 v[152:155], a[228:231], a[164:167], v[152:155]
 v_mfma_f32_16x16x32_bf16 v[156:159], a[228:231], a[172:175], v[156:159]
 v_mfma_f32_16x16x32_bf16 v[156:159], a[224:227], a[168:171], v[156:159]
 v_mfma_f32_16x16x32_bf16 v[160:163], a[224:227], a[176:179], v[160:163]
 v_mfma_f32_16x16x32_bf16 v[160:163], a[228:231], a[180:183], v[160:163]
 v_mfma_f32_16x16x32_bf16 v[164:167], a[228:231], a[188:191], v[164:167]
 v_mfma_f32_16x16x32_bf16 v[164:167], a[224:227], a[184:187], v[164:167]
 s_waitcnt vmcnt(12)
 v_mfma_f32_16x16x32_bf16 v[196:199], a[232:235], a[184:187], v[196:199]
 s_waitcnt lgkmcnt(0)
 v_mfma_f32_16x16x32_bf16 v[196:199], a[236:239], a[188:191], v[196:199]
 global_load_dwordx4 a[228:231], v0, s[70:71] offset:1024 sc1
 v_add_f32 v16, v16, v8
 v_mfma_f32_16x16x32_bf16 v[192:195], a[236:239], a[180:183], v[192:195]
 v_mfma_f32_16x16x32_bf16 v[192:195], a[232:235], a[176:179], v[192:195]
 global_load_dwordx4 a[224:227], v0, s[70:71] offset:0 sc1
 ds_read_b128 v[12:15], v4 offset:16
 v_mfma_f32_16x16x32_bf16 v[188:191], a[232:235], a[168:171], v[188:191]
 v_add_f32 v17, v17, v9
 v_mfma_f32_16x16x32_bf16 v[188:191], a[236:239], a[172:175], v[188:191]
 v_mfma_f32_16x16x32_bf16 v[184:187], a[236:239], a[164:167], v[184:187]
 v_add_f32 v18, v18, v10
 v_mfma_f32_16x16x32_bf16 v[184:187], a[232:235], a[160:163], v[184:187]
 v_add_f32 v19, v19, v11
 v_mfma_f32_16x16x32_bf16 v[180:183], a[232:235], a[152:155], v[180:183]
 v_mfma_f32_16x16x32_bf16 v[180:183], a[236:239], a[156:159], v[180:183]
 v_add_f32 v20, v20, v8
 v_mfma_f32_16x16x32_bf16 v[176:179], a[236:239], a[148:151], v[176:179]
 v_add_f32 v21, v21, v9
 v_mfma_f32_16x16x32_bf16 v[176:179], a[232:235], a[144:147], v[176:179]
 v_add_f32 v22, v22, v10
 v_mfma_f32_16x16x32_bf16 v[172:175], a[232:235], a[136:139], v[172:175]
 v_mfma_f32_16x16x32_bf16 v[172:175], a[236:239], a[140:143], v[172:175]
 v_add_f32 v23, v23, v11
 v_mfma_f32_16x16x32_bf16 v[168:171], a[236:239], a[132:135], v[168:171]
 v_add_f32 v24, v24, v8
 v_mfma_f32_16x16x32_bf16 v[168:171], a[232:235], a[128:131], v[168:171]
 s_waitcnt vmcnt(11)
 v_mfma_f32_16x16x32_bf16 v[200:203], a[192:195], a[128:131], v[200:203]
 v_add_f32 v25, v25, v9
 v_mfma_f32_16x16x32_bf16 v[200:203], a[196:199], a[132:135], v[200:203]
 global_load_dwordx4 a[236:239], v0, s[70:71] offset:3072 sc1
 v_add_f32 v26, v26, v10
 v_mfma_f32_16x16x32_bf16 v[204:207], a[196:199], a[140:143], v[204:207]
 v_mfma_f32_16x16x32_bf16 v[204:207], a[192:195], a[136:139], v[204:207]
 global_load_dwordx4 a[232:235], v0, s[70:71] offset:2048 sc1
 v_add_f32 v27, v27, v11
 v_mfma_f32_16x16x32_bf16 v[208:211], a[192:195], a[144:147], v[208:211]
 v_add_f32 v28, v28, v8
 s_add_u32 s70, s70, 8192
 s_addc_u32 s71, s71, 0
 v_mfma_f32_16x16x32_bf16 v[208:211], a[196:199], a[148:151], v[208:211]
 v_mfma_f32_16x16x32_bf16 v[212:215], a[196:199], a[156:159], v[212:215]
 v_add_f32 v29, v29, v9
 v_mfma_f32_16x16x32_bf16 v[212:215], a[192:195], a[152:155], v[212:215]
 v_add_f32 v30, v30, v10
 v_mfma_f32_16x16x32_bf16 v[216:219], a[192:195], a[160:163], v[216:219]
 v_add_f32 v31, v31, v11
 v_mfma_f32_16x16x32_bf16 v[216:219], a[196:199], a[164:167], v[216:219]
 v_mfma_f32_16x16x32_bf16 v[220:223], a[196:199], a[172:175], v[220:223]
 v_add_f32 v32, v32, v8
 v_mfma_f32_16x16x32_bf16 v[220:223], a[192:195], a[168:171], v[220:223]
 v_add_f32 v33, v33, v9
 v_mfma_f32_16x16x32_bf16 v[224:227], a[192:195], a[176:179], v[224:227]
 v_mfma_f32_16x16x32_bf16 v[224:227], a[196:199], a[180:183], v[224:227]
 v_add_f32 v34, v34, v10
 v_mfma_f32_16x16x32_bf16 v[228:231], a[196:199], a[188:191], v[228:231]
 v_add_f32 v35, v35, v11
 v_mfma_f32_16x16x32_bf16 v[228:231], a[192:195], a[184:187], v[228:231]
 v_add_f32 v36, v36, v8
 s_waitcnt vmcnt(10)
 v_mfma_f32_16x16x32_bf16 a[252:255], a[200:203], a[184:187], a[252:255]
 ds_read_b128 a[184:187], v1 offset:61440
 v_add_f32 v37, v37, v9
 v_mfma_f32_16x16x32_bf16 a[252:255], a[204:207], a[188:191], a[252:255]
 global_load_dwordx4 a[196:199], v0, s[70:71] offset:-3072 sc1
 ds_read_b128 a[188:191], v1 offset:62464
 v_mfma_f32_16x16x32_bf16 a[248:251], a[204:207], a[180:183], a[248:251]
 ds_read_b128 a[180:183], v1 offset:58368
 v_add_f32 v38, v38, v10
 v_mfma_f32_16x16x32_bf16 a[248:251], a[200:203], a[176:179], a[248:251]
 global_load_dwordx4 a[192:195], v0, s[70:71] offset:-4096 sc1
 ds_read_b128 a[176:179], v1 offset:57344
 v_mfma_f32_16x16x32_bf16 v[252:255], a[200:203], a[168:171], v[252:255]
 ds_read_b128 a[168:171], v1 offset:53248
 v_add_f32 v39, v39, v11
 v_mfma_f32_16x16x32_bf16 v[252:255], a[204:207], a[172:175], v[252:255]
 ds_read_b128 a[172:175], v1 offset:54272
 v_add_f32 v40, v40, v8
 v_mfma_f32_16x16x32_bf16 v[248:251], a[204:207], a[164:167], v[248:251]
 ds_read_b128 a[164:167], v1 offset:50176
 v_mfma_f32_16x16x32_bf16 v[248:251], a[200:203], a[160:163], v[248:251]
 ds_read_b128 a[160:163], v1 offset:49152
 v_add_f32 v41, v41, v9
 v_mfma_f32_16x16x32_bf16 v[244:247], a[200:203], a[152:155], v[244:247]
 ds_read_b128 a[152:155], v1 offset:45056
 v_add_f32 v42, v42, v10
 v_mfma_f32_16x16x32_bf16 v[244:247], a[204:207], a[156:159], v[244:247]
 ds_read_b128 a[156:159], v1 offset:46080
 v_mfma_f32_16x16x32_bf16 v[240:243], a[204:207], a[148:151], v[240:243]
 ds_read_b128 a[148:151], v1 offset:41984
 v_add_f32 v43, v43, v11
 v_mfma_f32_16x16x32_bf16 v[240:243], a[200:203], a[144:147], v[240:243]
 ds_read_b128 a[144:147], v1 offset:40960
 v_add_f32 v44, v44, v8
 v_mfma_f32_16x16x32_bf16 v[236:239], a[200:203], a[136:139], v[236:239]
 ds_read_b128 a[136:139], v1 offset:36864
 v_mfma_f32_16x16x32_bf16 v[236:239], a[204:207], a[140:143], v[236:239]
 ds_read_b128 a[140:143], v1 offset:37888
 v_add_f32 v45, v45, v9
 v_mfma_f32_16x16x32_bf16 v[232:235], a[204:207], a[132:135], v[232:235]
 ds_read_b128 a[132:135], v1 offset:33792
 v_add_f32 v46, v46, v10
 v_mfma_f32_16x16x32_bf16 v[232:235], a[200:203], a[128:131], v[232:235]
 ds_read_b128 a[128:131], v1 offset:32768
 v_add_f32 v47, v47, v11
 s_waitcnt vmcnt(9) lgkmcnt(8)
 v_mfma_f32_16x16x32_bf16 v[164:167], a[208:211], a[184:187], v[164:167]
 v_mfma_f32_16x16x32_bf16 v[164:167], a[212:215], a[188:191], v[164:167]
 global_load_dwordx4 a[204:207], v0, s[70:71] offset:-1024 sc1
 v_mfma_f32_16x16x32_bf16 v[160:163], a[212:215], a[180:183], v[160:163]
 v_add_f32 v48, v48, v12
 v_mfma_f32_16x16x32_bf16 v[160:163], a[208:211], a[176:179], v[160:163]
 global_load_dwordx4 a[200:203], v0, s[70:71] offset:-2048 sc1
 v_mfma_f32_16x16x32_bf16 v[156:159], a[208:211], a[168:171], v[156:159]
 ds_read_b128 v[8:11], v4 offset:128
 v_mfma_f32_16x16x32_bf16 v[156:159], a[212:215], a[172:175], v[156:159]
 v_add_f32 v49, v49, v13
 v_mfma_f32_16x16x32_bf16 v[152:155], a[212:215], a[164:167], v[152:155]
 v_mfma_f32_16x16x32_bf16 v[152:155], a[208:211], a[160:163], v[152:155]
 v_add_f32 v50, v50, v14
 s_waitcnt lgkmcnt(1)
 v_mfma_f32_16x16x32_bf16 v[148:151], a[208:211], a[152:155], v[148:151]
 v_add_f32 v51, v51, v15
 v_mfma_f32_16x16x32_bf16 v[148:151], a[212:215], a[156:159], v[148:151]
 v_add_f32 v52, v52, v12
 v_mfma_f32_16x16x32_bf16 v[144:147], a[212:215], a[148:151], v[144:147]
 v_mfma_f32_16x16x32_bf16 v[144:147], a[208:211], a[144:147], v[144:147]
 v_add_f32 v53, v53, v13
 v_mfma_f32_16x16x32_bf16 v[140:143], a[208:211], a[136:139], v[140:143]
 v_add_f32 v54, v54, v14
 v_mfma_f32_16x16x32_bf16 v[140:143], a[212:215], a[140:143], v[140:143]
 v_mfma_f32_16x16x32_bf16 v[136:139], a[212:215], a[132:135], v[136:139]
 v_add_f32 v55, v55, v15
 v_mfma_f32_16x16x32_bf16 v[136:139], a[208:211], a[128:131], v[136:139]
 v_add_f32 v56, v56, v12
 s_waitcnt vmcnt(8)
 v_mfma_f32_16x16x32_bf16 v[168:171], a[216:219], a[128:131], v[168:171]
 v_mfma_f32_16x16x32_bf16 v[168:171], a[220:223], a[132:135], v[168:171]
 global_load_dwordx4 a[212:215], v0, s[70:71] offset:1024 sc1
 v_add_f32 v57, v57, v13
 v_mfma_f32_16x16x32_bf16 v[172:175], a[220:223], a[140:143], v[172:175]
 v_add_f32 v58, v58, v14
 v_mfma_f32_16x16x32_bf16 v[172:175], a[216:219], a[136:139], v[172:175]
 global_load_dwordx4 a[208:211], v0, s[70:71] offset:0 sc1
 v_add_f32 v59, v59, v15
 v_mfma_f32_16x16x32_bf16 v[176:179], a[216:219], a[144:147], v[176:179]
 v_mfma_f32_16x16x32_bf16 v[176:179], a[220:223], a[148:151], v[176:179]
 v_add_f32 v60, v60, v12
 v_mfma_f32_16x16x32_bf16 v[180:183], a[220:223], a[156:159], v[180:183]
 v_add_f32 v61, v61, v13
 v_mfma_f32_16x16x32_bf16 v[180:183], a[216:219], a[152:155], v[180:183]
 v_mfma_f32_16x16x32_bf16 v[184:187], a[216:219], a[160:163], v[184:187]
 v_add_f32 v62, v62, v14
 v_mfma_f32_16x16x32_bf16 v[184:187], a[220:223], a[164:167], v[184:187]
 v_add_f32 v63, v63, v15
 v_mfma_f32_16x16x32_bf16 v[188:191], a[220:223], a[172:175], v[188:191]
 v_mfma_f32_16x16x32_bf16 v[188:191], a[216:219], a[168:171], v[188:191]
 v_add_f32 v64, v64, v12
 v_mfma_f32_16x16x32_bf16 v[192:195], a[216:219], a[176:179], v[192:195]
 v_add_f32 v65, v65, v13
 v_mfma_f32_16x16x32_bf16 v[192:195], a[220:223], a[180:183], v[192:195]
 v_mfma_f32_16x16x32_bf16 v[196:199], a[220:223], a[188:191], v[196:199]
 v_add_f32 v66, v66, v14
 v_mfma_f32_16x16x32_bf16 v[196:199], a[216:219], a[184:187], v[196:199]
 v_add_f32 v67, v67, v15
 s_waitcnt vmcnt(8)
 v_mfma_f32_16x16x32_bf16 v[228:231], a[224:227], a[184:187], v[228:231]
 v_add_f32 v68, v68, v12
 v_mfma_f32_16x16x32_bf16 v[228:231], a[228:231], a[188:191], v[228:231]
 global_load_dwordx4 a[220:223], v0, s[70:71] offset:3072 sc1
 v_mfma_f32_16x16x32_bf16 v[224:227], a[228:231], a[180:183], v[224:227]
 v_add_f32 v69, v69, v13
 v_mfma_f32_16x16x32_bf16 v[224:227], a[224:227], a[176:179], v[224:227]
 global_load_dwordx4 a[216:219], v0, s[70:71] offset:2048 sc1
 v_add_f32 v70, v70, v14
 v_mfma_f32_16x16x32_bf16 v[220:223], a[224:227], a[168:171], v[220:223]
 s_add_u32 s70, s70, 8192
 s_addc_u32 s71, s71, 0
 v_mfma_f32_16x16x32_bf16 v[220:223], a[228:231], a[172:175], v[220:223]
 v_add_f32 v71, v71, v15
 v_mfma_f32_16x16x32_bf16 v[216:219], a[228:231], a[164:167], v[216:219]
 v_add_f32 v72, v72, v12
 v_mfma_f32_16x16x32_bf16 v[216:219], a[224:227], a[160:163], v[216:219]
 v_mfma_f32_16x16x32_bf16 v[212:215], a[224:227], a[152:155], v[212:215]
 v_add_f32 v73, v73, v13
 v_mfma_f32_16x16x32_bf16 v[212:215], a[228:231], a[156:159], v[212:215]
 v_add_f32 v74, v74, v14
 v_mfma_f32_16x16x32_bf16 v[208:211], a[228:231], a[148:151], v[208:211]
 v_add_f32 v75, v75, v15
 v_mfma_f32_16x16x32_bf16 v[208:211], a[224:227], a[144:147], v[208:211]
 v_mfma_f32_16x16x32_bf16 v[204:207], a[224:227], a[136:139], v[204:207]
 v_add_f32 v76, v76, v12
 v_mfma_f32_16x16x32_bf16 v[204:207], a[228:231], a[140:143], v[204:207]
 v_add_f32 v77, v77, v13
 v_mfma_f32_16x16x32_bf16 v[200:203], a[228:231], a[132:135], v[200:203]
 v_mfma_f32_16x16x32_bf16 v[200:203], a[224:227], a[128:131], v[200:203]
 v_add_f32 v78, v78, v14
 s_waitcnt vmcnt(8)
 v_mfma_f32_16x16x32_bf16 v[232:235], a[232:235], a[128:131], v[232:235]
 ds_read_b128 a[128:131], v2
 v_add_f32 v79, v79, v15
 v_mfma_f32_16x16x32_bf16 v[232:235], a[236:239], a[132:135], v[232:235]
 global_load_dwordx4 a[228:231], v0, s[70:71] offset:-3072 sc1
 ds_read_b128 a[132:135], v2 offset:1024
 v_mfma_f32_16x16x32_bf16 v[236:239], a[236:239], a[140:143], v[236:239]
 ds_read_b128 a[140:143], v2 offset:5120
 s_waitcnt lgkmcnt(3)
 v_mfma_f32_16x16x32_bf16 v[236:239], a[232:235], a[136:139], v[236:239]
 global_load_dwordx4 a[224:227], v0, s[70:71] offset:-4096 sc1
 ds_read_b128 a[136:139], v2 offset:4096
 v_mfma_f32_16x16x32_bf16 v[240:243], a[232:235], a[144:147], v[240:243]
 ds_read_b128 a[144:147], v2 offset:8192
 v_add_f32 v80, v80, v8
 v_mfma_f32_16x16x32_bf16 v[240:243], a[236:239], a[148:151], v[240:243]
 ds_read_b128 a[148:151], v2 offset:9216
 ds_read_b128 v[12:15], v4 offset:144
 v_mfma_f32_16x16x32_bf16 v[244:247], a[236:239], a[156:159], v[244:247]
 ds_read_b128 a[156:159], v2 offset:13312
 v_add_f32 v81, v81, v9
 v_mfma_f32_16x16x32_bf16 v[244:247], a[232:235], a[152:155], v[244:247]
 ds_read_b128 a[152:155], v2 offset:12288
 v_add_f32 v82, v82, v10
 v_mfma_f32_16x16x32_bf16 v[248:251], a[232:235], a[160:163], v[248:251]
 ds_read_b128 a[160:163], v2 offset:16384
 v_mfma_f32_16x16x32_bf16 v[248:251], a[236:239], a[164:167], v[248:251]
 ds_read_b128 a[164:167], v2 offset:17408
 v_add_f32 v83, v83, v11
 v_mfma_f32_16x16x32_bf16 v[252:255], a[236:239], a[172:175], v[252:255]
 ds_read_b128 a[172:175], v2 offset:21504
 v_add_f32 v84, v84, v8
 v_mfma_f32_16x16x32_bf16 v[252:255], a[232:235], a[168:171], v[252:255]
 ds_read_b128 a[168:171], v2 offset:20480
 v_mfma_f32_16x16x32_bf16 a[248:251], a[232:235], a[176:179], a[248:251]
 ds_read_b128 a[176:179], v2 offset:24576
 v_add_f32 v85, v85, v9
 v_mfma_f32_16x16x32_bf16 a[248:251], a[236:239], a[180:183], a[248:251]
 ds_read_b128 a[180:183], v2 offset:25600
 v_add_f32 v86, v86, v10
 v_mfma_f32_16x16x32_bf16 a[252:255], a[236:239], a[188:191], a[252:255]
 ds_read_b128 a[188:191], v2 offset:29696
 v_mfma_f32_16x16x32_bf16 a[252:255], a[232:235], a[184:187], a[252:255]
 ds_read_b128 a[184:187], v2 offset:28672
 v_add_f32 v87, v87, v11
 s_waitcnt vmcnt(8) lgkmcnt(8)
 v_mfma_f32_16x16x32_bf16 v[136:139], a[192:195], a[128:131], v[136:139]
 v_add_f32 v88, v88, v8
 v_mfma_f32_16x16x32_bf16 v[136:139], a[196:199], a[132:135], v[136:139]
 global_load_dwordx4 a[236:239], v0, s[70:71] offset:-1024 sc1
 v_add_f32 v89, v89, v9
 v_mfma_f32_16x16x32_bf16 v[140:143], a[196:199], a[140:143], v[140:143]
 v_mfma_f32_16x16x32_bf16 v[140:143], a[192:195], a[136:139], v[140:143]
 global_load_dwordx4 a[232:235], v0, s[70:71] offset:-2048 sc1
 v_add_f32 v90, v90, v10
 v_mfma_f32_16x16x32_bf16 v[144:147], a[192:195], a[144:147], v[144:147]
 v_add_f32 v91, v91, v11
 v_mfma_f32_16x16x32_bf16 v[144:147], a[196:199], a[148:151], v[144:147]
 v_mfma_f32_16x16x32_bf16 v[148:151], a[196:199], a[156:159], v[148:151]
 v_add_f32 v92, v92, v8
 v_mfma_f32_16x16x32_bf16 v[148:151], a[192:195], a[152:155], v[148:151]
 v_add_f32 v93, v93, v9
 s_waitcnt lgkmcnt(0)
 v_mfma_f32_16x16x32_bf16 v[152:155], a[192:195], a[160:163], v[152:155]
 v_mfma_f32_16x16x32_bf16 v[152:155], a[196:199], a[164:167], v[152:155]
 v_add_f32 v94, v94, v10
 v_mfma_f32_16x16x32_bf16 v[156:159], a[196:199], a[172:175], v[156:159]
 v_add_f32 v95, v95, v11
 v_mfma_f32_16x16x32_bf16 v[156:159], a[192:195], a[168:171], v[156:159]
 buffer_load_dword v4, off, s[64:67], 0 sc1
 v_mfma_f32_16x16x32_bf16 v[160:163], a[192:195], a[176:179], v[160:163]
 v_mfma_f32_16x16x32_bf16 v[160:163], a[196:199], a[180:183], v[160:163]
 v_add_f32 v96, v96, v8
 v_mfma_f32_16x16x32_bf16 v[164:167], a[196:199], a[188:191], v[164:167]
 v_add_f32 v97, v97, v9
 v_mfma_f32_16x16x32_bf16 v[164:167], a[192:195], a[184:187], v[164:167]
 s_waitcnt vmcnt(9)
 v_mfma_f32_16x16x32_bf16 v[196:199], a[200:203], a[184:187], v[196:199]
 v_add_f32 v98, v98, v10
 v_mfma_f32_16x16x32_bf16 v[196:199], a[204:207], a[188:191], v[196:199]
 global_load_dwordx4 a[196:199], v0, s[70:71] offset:1024 sc1
 v_add_f32 v99, v99, v11
 v_mfma_f32_16x16x32_bf16 v[192:195], a[204:207], a[180:183], v[192:195]
 v_mfma_f32_16x16x32_bf16 v[192:195], a[200:203], a[176:179], v[192:195]
 global_load_dwordx4 a[192:195], v0, s[70:71] offset:0 sc1
 v_add_f32 v100, v100, v8
 v_mfma_f32_16x16x32_bf16 v[188:191], a[200:203], a[168:171], v[188:191]
 v_add_f32 v101, v101, v9
 v_mfma_f32_16x16x32_bf16 v[188:191], a[204:207], a[172:175], v[188:191]
 v_mfma_f32_16x16x32_bf16 v[184:187], a[204:207], a[164:167], v[184:187]
 v_add_f32 v102, v102, v10
 v_mfma_f32_16x16x32_bf16 v[184:187], a[200:203], a[160:163], v[184:187]
 v_add_f32 v103, v103, v11
 v_mfma_f32_16x16x32_bf16 v[180:183], a[200:203], a[152:155], v[180:183]
 v_add_f32 v104, v104, v8
 v_mfma_f32_16x16x32_bf16 v[180:183], a[204:207], a[156:159], v[180:183]
 v_mfma_f32_16x16x32_bf16 v[176:179], a[204:207], a[148:151], v[176:179]
 v_add_f32 v105, v105, v9
 v_mfma_f32_16x16x32_bf16 v[176:179], a[200:203], a[144:147], v[176:179]
 v_add_f32 v106, v106, v10
 v_mfma_f32_16x16x32_bf16 v[172:175], a[200:203], a[136:139], v[172:175]
 v_mfma_f32_16x16x32_bf16 v[172:175], a[204:207], a[140:143], v[172:175]
 v_add_f32 v107, v107, v11
 v_mfma_f32_16x16x32_bf16 v[168:171], a[204:207], a[132:135], v[168:171]
 v_add_f32 v108, v108, v8
 v_mfma_f32_16x16x32_bf16 v[168:171], a[200:203], a[128:131], v[168:171]
 s_waitcnt vmcnt(9)
 v_mfma_f32_16x16x32_bf16 v[200:203], a[208:211], a[128:131], v[200:203]
 v_add_f32 v109, v109, v9
 v_mfma_f32_16x16x32_bf16 v[200:203], a[212:215], a[132:135], v[200:203]
 global_load_dwordx4 a[204:207], v0, s[70:71] offset:3072 sc1
 v_add_f32 v110, v110, v10
 v_mfma_f32_16x16x32_bf16 v[204:207], a[212:215], a[140:143], v[204:207]
 v_add_f32 v111, v111, v11
 v_mfma_f32_16x16x32_bf16 v[204:207], a[208:211], a[136:139], v[204:207]
 global_load_dwordx4 a[200:203], v0, s[70:71] offset:2048 sc1
 v_mfma_f32_16x16x32_bf16 v[208:211], a[208:211], a[144:147], v[208:211]
 s_add_u32 s70, s70, 8192
 s_addc_u32 s71, s71, 0
 v_mfma_f32_16x16x32_bf16 v[208:211], a[212:215], a[148:151], v[208:211]
 v_add_f32 v112, v112, v12
 v_mfma_f32_16x16x32_bf16 v[212:215], a[212:215], a[156:159], v[212:215]
 v_mfma_f32_16x16x32_bf16 v[212:215], a[208:211], a[152:155], v[212:215]
 v_add_f32 v113, v113, v13
 v_mfma_f32_16x16x32_bf16 v[216:219], a[208:211], a[160:163], v[216:219]
 v_add_f32 v114, v114, v14
 v_mfma_f32_16x16x32_bf16 v[216:219], a[212:215], a[164:167], v[216:219]
 v_mfma_f32_16x16x32_bf16 v[220:223], a[212:215], a[172:175], v[220:223]
 v_add_f32 v115, v115, v15
 v_mfma_f32_16x16x32_bf16 v[220:223], a[208:211], a[168:171], v[220:223]
 v_add_f32 v116, v116, v12
 v_mfma_f32_16x16x32_bf16 v[224:227], a[208:211], a[176:179], v[224:227]
 v_add_f32 v117, v117, v13
 v_mfma_f32_16x16x32_bf16 v[224:227], a[212:215], a[180:183], v[224:227]
 v_mfma_f32_16x16x32_bf16 v[228:231], a[212:215], a[188:191], v[228:231]
 v_add_f32 v118, v118, v14
 v_mfma_f32_16x16x32_bf16 v[228:231], a[208:211], a[184:187], v[228:231]
 v_add_f32 v119, v119, v15
 s_waitcnt vmcnt(9)
 v_mfma_f32_16x16x32_bf16 a[252:255], a[216:219], a[184:187], a[252:255]
 ds_read_b128 a[184:187], v2 offset:61440
 v_add_f32 v120, v120, v12
 v_mfma_f32_16x16x32_bf16 a[252:255], a[220:223], a[188:191], a[252:255]
 global_load_dwordx4 a[212:215], v0, s[70:71] offset:-3072 sc1
 ds_read_b128 a[188:191], v2 offset:62464
 v_mfma_f32_16x16x32_bf16 a[248:251], a[220:223], a[180:183], a[248:251]
 ds_read_b128 a[180:183], v2 offset:58368
 v_add_f32 v121, v121, v13
 v_mfma_f32_16x16x32_bf16 a[248:251], a[216:219], a[176:179], a[248:251]
 global_load_dwordx4 a[208:211], v0, s[70:71] offset:-4096 sc1
 ds_read_b128 a[176:179], v2 offset:57344
 v_mfma_f32_16x16x32_bf16 v[252:255], a[216:219], a[168:171], v[252:255]
 ds_read_b128 a[168:171], v2 offset:53248
 v_add_f32 v122, v122, v14
 v_mfma_f32_16x16x32_bf16 v[252:255], a[220:223], a[172:175], v[252:255]
 ds_read_b128 a[172:175], v2 offset:54272
 v_add_f32 v123, v123, v15
 v_mfma_f32_16x16x32_bf16 v[248:251], a[220:223], a[164:167], v[248:251]
 ds_read_b128 a[164:167], v2 offset:50176
 v_mfma_f32_16x16x32_bf16 v[248:251], a[216:219], a[160:163], v[248:251]
 ds_read_b128 a[160:163], v2 offset:49152
 v_add_f32 v124, v124, v12
 v_mfma_f32_16x16x32_bf16 v[244:247], a[216:219], a[152:155], v[244:247]
 ds_read_b128 a[152:155], v2 offset:45056
 v_add_f32 v125, v125, v13
 v_mfma_f32_16x16x32_bf16 v[244:247], a[220:223], a[156:159], v[244:247]
 ds_read_b128 a[156:159], v2 offset:46080
 v_add_f32 v126, v126, v14
 v_mfma_f32_16x16x32_bf16 v[240:243], a[220:223], a[148:151], v[240:243]
 ds_read_b128 a[148:151], v2 offset:41984
 v_mfma_f32_16x16x32_bf16 v[240:243], a[216:219], a[144:147], v[240:243]
 ds_read_b128 a[144:147], v2 offset:40960
 v_add_f32 v127, v127, v15
 v_mfma_f32_16x16x32_bf16 v[236:239], a[216:219], a[136:139], v[236:239]
 ds_read_b128 a[136:139], v2 offset:36864
 v_add_f32 v128, v128, v12
 v_mfma_f32_16x16x32_bf16 v[236:239], a[220:223], a[140:143], v[236:239]
 ds_read_b128 a[140:143], v2 offset:37888
 v_mfma_f32_16x16x32_bf16 v[232:235], a[220:223], a[132:135], v[232:235]
 ds_read_b128 a[132:135], v2 offset:33792
 v_add_f32 v129, v129, v13
 v_mfma_f32_16x16x32_bf16 v[232:235], a[216:219], a[128:131], v[232:235]
 ds_read_b128 a[128:131], v2 offset:32768
 v_add_f32 v130, v130, v14
 s_waitcnt vmcnt(9) lgkmcnt(8)
 v_mfma_f32_16x16x32_bf16 v[164:167], a[224:227], a[184:187], v[164:167]
 v_mfma_f32_16x16x32_bf16 v[164:167], a[228:231], a[188:191], v[164:167]
 global_load_dwordx4 a[220:223], v0, s[70:71] offset:-1024 sc1
 v_add_f32 v131, v131, v15
 v_mfma_f32_16x16x32_bf16 v[160:163], a[228:231], a[180:183], v[160:163]
 v_add_f32 v132, v132, v12
 v_mfma_f32_16x16x32_bf16 v[160:163], a[224:227], a[176:179], v[160:163]
 global_load_dwordx4 a[216:219], v0, s[70:71] offset:-2048 sc1
 v_add_f32 v133, v133, v13
 v_mfma_f32_16x16x32_bf16 v[156:159], a[224:227], a[168:171], v[156:159]
 v_mfma_f32_16x16x32_bf16 v[156:159], a[228:231], a[172:175], v[156:159]
 v_add_f32 v134, v134, v14
 v_mfma_f32_16x16x32_bf16 v[152:155], a[228:231], a[164:167], v[152:155]
 v_add_f32 v135, v135, v15
 v_mfma_f32_16x16x32_bf16 v[152:155], a[224:227], a[160:163], v[152:155]
 s_waitcnt lgkmcnt(0)
 v_mfma_f32_16x16x32_bf16 v[148:151], a[224:227], a[152:155], v[148:151]
 v_accvgpr_read_b32 v5, a240
 v_mfma_f32_16x16x32_bf16 v[148:151], a[228:231], a[156:159], v[148:151]
 v_add_f32 v5, v5, v12
 v_mfma_f32_16x16x32_bf16 v[144:147], a[228:231], a[148:151], v[144:147]
 v_mfma_f32_16x16x32_bf16 v[144:147], a[224:227], a[144:147], v[144:147]
 v_accvgpr_write_b32 a240, v5
 v_mfma_f32_16x16x32_bf16 v[140:143], a[224:227], a[136:139], v[140:143]
 v_accvgpr_read_b32 v6, a241
 v_mfma_f32_16x16x32_bf16 v[140:143], a[228:231], a[140:143], v[140:143]
 v_mfma_f32_16x16x32_bf16 v[136:139], a[228:231], a[132:135], v[136:139]
 v_add_f32 v6, v6, v13
 v_mfma_f32_16x16x32_bf16 v[136:139], a[224:227], a[128:131], v[136:139]
 v_accvgpr_write_b32 a241, v6
 s_waitcnt vmcnt(9)
 v_mfma_f32_16x16x32_bf16 v[168:171], a[232:235], a[128:131], v[168:171]
 v_accvgpr_read_b32 v5, a242
 v_mfma_f32_16x16x32_bf16 v[168:171], a[236:239], a[132:135], v[168:171]
 global_load_dwordx4 a[228:231], v0, s[70:71] offset:1024 sc1
 v_mfma_f32_16x16x32_bf16 v[172:175], a[236:239], a[140:143], v[172:175]
 v_add_f32 v5, v5, v14
 v_mfma_f32_16x16x32_bf16 v[172:175], a[232:235], a[136:139], v[172:175]
 global_load_dwordx4 a[224:227], v0, s[70:71] offset:0 sc1
 v_accvgpr_write_b32 a242, v5
 v_mfma_f32_16x16x32_bf16 v[176:179], a[232:235], a[144:147], v[176:179]
 v_mfma_f32_16x16x32_bf16 v[176:179], a[236:239], a[148:151], v[176:179]
 v_accvgpr_read_b32 v6, a243
 v_mfma_f32_16x16x32_bf16 v[180:183], a[236:239], a[156:159], v[180:183]
 v_add_f32 v6, v6, v15
 v_mfma_f32_16x16x32_bf16 v[180:183], a[232:235], a[152:155], v[180:183]
 v_mfma_f32_16x16x32_bf16 v[184:187], a[232:235], a[160:163], v[184:187]
 v_accvgpr_write_b32 a243, v6
 v_mfma_f32_16x16x32_bf16 v[184:187], a[236:239], a[164:167], v[184:187]
 v_accvgpr_read_b32 v5, a244
 v_mfma_f32_16x16x32_bf16 v[188:191], a[236:239], a[172:175], v[188:191]
 v_add_f32 v5, v5, v12
 v_mfma_f32_16x16x32_bf16 v[188:191], a[232:235], a[168:171], v[188:191]
 v_mfma_f32_16x16x32_bf16 v[192:195], a[232:235], a[176:179], v[192:195]
 v_accvgpr_write_b32 a244, v5
 v_mfma_f32_16x16x32_bf16 v[192:195], a[236:239], a[180:183], v[192:195]
 v_accvgpr_read_b32 v6, a245
 v_mfma_f32_16x16x32_bf16 v[196:199], a[236:239], a[188:191], v[196:199]
 v_mfma_f32_16x16x32_bf16 v[196:199], a[232:235], a[184:187], v[196:199]
 v_add_f32 v6, v6, v13
 s_waitcnt vmcnt(8)
 v_mfma_f32_16x16x32_bf16 v[228:231], a[192:195], a[184:187], v[228:231]
 v_accvgpr_write_b32 a245, v6
 v_mfma_f32_16x16x32_bf16 v[228:231], a[196:199], a[188:191], v[228:231]
 global_load_dwordx4 a[236:239], v0, s[70:71] offset:3072 sc1
 v_mfma_f32_16x16x32_bf16 v[224:227], a[196:199], a[180:183], v[224:227]
 v_accvgpr_read_b32 v5, a246
 v_mfma_f32_16x16x32_bf16 v[224:227], a[192:195], a[176:179], v[224:227]
 global_load_dwordx4 a[232:235], v0, s[70:71] offset:2048 sc1
 v_add_f32 v5, v5, v14
 v_mfma_f32_16x16x32_bf16 v[220:223], a[192:195], a[168:171], v[220:223]
 v_accvgpr_write_b32 a246, v5
 s_add_u32 s70, s70, 8192
 s_addc_u32 s71, s71, 0
 v_mfma_f32_16x16x32_bf16 v[220:223], a[196:199], a[172:175], v[220:223]
 v_mfma_f32_16x16x32_bf16 v[216:219], a[196:199], a[164:167], v[216:219]
 v_accvgpr_read_b32 v6, a247
 v_mfma_f32_16x16x32_bf16 v[216:219], a[192:195], a[160:163], v[216:219]
 v_add_f32 v6, v6, v15
 v_mfma_f32_16x16x32_bf16 v[212:215], a[192:195], a[152:155], v[212:215]
 v_mfma_f32_16x16x32_bf16 v[212:215], a[196:199], a[156:159], v[212:215]
 v_accvgpr_write_b32 a247, v6
 v_mfma_f32_16x16x32_bf16 v[208:211], a[196:199], a[148:151], v[208:211]
 v_cmp_gt_i32 vcc, s55, v4
 s_cbranch_vccnz Lspin_pa
Lok_pa:
 s_add_u32 s55, s55, 1
 s_waitcnt lgkmcnt(0)
 s_barrier
 v_mfma_f32_16x16x32_bf16 v[208:211], a[192:195], a[144:147], v[208:211]
 v_mfma_f32_16x16x32_bf16 v[204:207], a[192:195], a[136:139], v[204:207]
 v_mfma_f32_16x16x32_bf16 v[204:207], a[196:199], a[140:143], v[204:207]
 v_mfma_f32_16x16x32_bf16 v[200:203], a[196:199], a[132:135], v[200:203]
 v_mfma_f32_16x16x32_bf16 v[200:203], a[192:195], a[128:131], v[200:203]
 s_waitcnt vmcnt(8)
 v_mfma_f32_16x16x32_bf16 v[232:235], a[200:203], a[128:131], v[232:235]
 ds_read_b128 a[128:131], v1 offset:2048
 v_mfma_f32_16x16x32_bf16 v[232:235], a[204:207], a[132:135], v[232:235]
 global_load_dwordx4 a[196:199], v0, s[70:71] offset:-3072 sc1
 ds_read_b128 a[132:135], v1 offset:3072
 v_mfma_f32_16x16x32_bf16 v[236:239], a[204:207], a[140:143], v[236:239]
 ds_read_b128 a[140:143], v1 offset:7168
 v_mfma_f32_16x16x32_bf16 v[236:239], a[200:203], a[136:139], v[236:239]
 global_load_dwordx4 a[192:195], v0, s[70:71] offset:-4096 sc1
 ds_read_b128 a[136:139], v1 offset:6144
 v_mfma_f32_16x16x32_bf16 v[240:243], a[200:203], a[144:147], v[240:243]
 ds_read_b128 a[144:147], v1 offset:10240
 v_mfma_f32_16x16x32_bf16 v[240:243], a[204:207], a[148:151], v[240:243]
 ds_read_b128 a[148:151], v1 offset:11264
 v_mfma_f32_16x16x32_bf16 v[244:247], a[204:207], a[156:159], v[244:247]
 ds_read_b128 a[156:159], v1 offset:15360
 v_mfma_f32_16x16x32_bf16 v[244:247], a[200:203], a[152:155], v[244:247]
 ds_read_b128 a[152:155], v1 offset:14336
 v_mfma_f32_16x16x32_bf16 v[248:251], a[200:203], a[160:163], v[248:251]
 ds_read_b128 a[160:163], v1 offset:18432
 v_mfma_f32_16x16x32_bf16 v[248:251], a[204:207], a[164:167], v[248:251]
 ds_read_b128 a[164:167], v1 offset:19456
 v_mfma_f32_16x16x32_bf16 v[252:255], a[204:207], a[172:175], v[252:255]
 ds_read_b128 a[172:175], v1 offset:23552
 v_mfma_f32_16x16x32_bf16 v[252:255], a[200:203], a[168:171], v[252:255]
 ds_read_b128 a[168:171], v1 offset:22528
 v_mfma_f32_16x16x32_bf16 a[248:251], a[200:203], a[176:179], a[248:251]
 ds_read_b128 a[176:179], v1 offset:26624
 v_mfma_f32_16x16x32_bf16 a[248:251], a[204:207], a[180:183], a[248:251]
 ds_read_b128 a[180:183], v1 offset:27648
 v_mfma_f32_16x16x32_bf16 a[252:255], a[204:207], a[188:191], a[252:255]
 global_load_dwordx4 a[204:207], v0, s[70:71] offset:-1024 sc1
 ds_read_b128 a[188:191], v1 offset:31744
 v_mfma_f32_16x16x32_bf16 a[252:255], a[200:203], a[184:187], a[252:255]
 global_load_dwordx4 a[200:203], v0, s[70:71] offset:-2048 sc1
 ds_read_b128 a[184:187], v1 offset:30720
 s_waitcnt vmcnt(10) lgkmcnt(8)
 s_branch Lloop
Llast:
 v_mfma_f32_16x16x32_bf16 v[136:139], a[208:211], a[128:131], v[136:139]
 v_accvgpr_read_b32 v5, a0
 v_lshlrev_b32 v6, 16, v5
 v_mfma_f32_16x16x32_bf16 v[136:139], a[212:215], a[132:135], v[136:139]
 v_and_b32 v5, s26, v5
 v_mul_f32 v6, v6, v16
 v_mfma_f32_16x16x32_bf16 v[140:143], a[212:215], a[140:143], v[140:143]
 v_mul_f32 v5, v5, v17
 v_cvt_pk_bf16_f32 v8, v6, v5
 v_mfma_f32_16x16x32_bf16 v[140:143], a[208:211], a[136:139], v[140:143]
 v_accvgpr_read_b32 v5, a1
 v_lshlrev_b32 v6, 16, v5
 v_mfma_f32_16x16x32_bf16 v[144:147], a[208:211], a[144:147], v[144:147]
 v_and_b32 v5, s26, v5
 v_mul_f32 v6, v6, v18
 v_mfma_f32_16x16x32_bf16 v[144:147], a[212:215], a[148:151], v[144:147]
 v_mul_f32 v5, v5, v19
 v_cvt_pk_bf16_f32 v9, v6, v5
 v_mfma_f32_16x16x32_bf16 v[148:151], a[212:215], a[156:159], v[148:151]
 v_accvgpr_read_b32 v5, a2
 v_lshlrev_b32 v6, 16, v5
 v_mfma_f32_16x16x32_bf16 v[148:151], a[208:211], a[152:155], v[148:151]
 v_and_b32 v5, s26, v5
 v_mul_f32 v6, v6, v48
 s_waitcnt lgkmcnt(0)
 v_mfma_f32_16x16x32_bf16 v[152:155], a[208:211], a[160:163], v[152:155]
 v_mul_f32 v5, v5, v49
 v_cvt_pk_bf16_f32 v10, v6, v5
 v_mfma_f32_16x16x32_bf16 v[152:155], a[212:215], a[164:167], v[152:155]
 v_accvgpr_read_b32 v5, a3
 v_lshlrev_b32 v6, 16, v5
 v_mfma_f32_16x16x32_bf16 v[156:159], a[212:215], a[172:175], v[156:159]
 v_and_b32 v5, s26, v5
 v_mul_f32 v6, v6, v50
 v_mfma_f32_16x16x32_bf16 v[156:159], a[208:211], a[168:171], v[156:159]
 v_mul_f32 v5, v5, v51
 v_cvt_pk_bf16_f32 v11, v6, v5
 v_mfma_f32_16x16x32_bf16 v[160:163], a[208:211], a[176:179], v[160:163]
 v_lshrrev_b32 v5, 7, v1
 v_lshlrev_b32 v6, 4, v5
 v_mfma_f32_16x16x32_bf16 v[160:163], a[212:215], a[180:183], v[160:163]
 v_xor_b32 v6, v6, v1
 v_and_b32 v6, 112, v6
 v_mfma_f32_16x16x32_bf16 v[164:167], a[212:215], a[188:191], v[164:167]
 v_lshl_add_u32 v16, v5, 11, v6
 v_lshrrev_b32 v5, 4, v1
 v_mfma_f32_16x16x32_bf16 v[164:167], a[208:211], a[184:187], v[164:167]
 v_and_b32 v5, 48, v5
 v_xor_b32 v5, v5, v1
 s_waitcnt vmcnt(8)
 v_mfma_f32_16x16x32_bf16 v[196:199], a[216:219], a[184:187], v[196:199]
 v_and_b32 v5, 112, v5
 v_and_b32 v6, 240, v1
 v_mfma_f32_16x16x32_bf16 v[196:199], a[220:223], a[188:191], v[196:199]
 global_load_dwordx4 a[212:215], v0, s[70:71] offset:1024 sc1
 v_lshl_add_u32 v5, v6, 3, v5
 v_mfma_f32_16x16x32_bf16 v[192:195], a[220:223], a[180:183], v[192:195]
 v_add_u32 v17, s50, v5
 v_xor_b32 v18, 64, v17
 v_mfma_f32_16x16x32_bf16 v[192:195], a[216:219], a[176:179], v[192:195]
 global_load_dwordx4 a[208:211], v0, s[70:71] offset:0 sc1
 ds_write_b128 v17, v[8:11]
 v_mfma_f32_16x16x32_bf16 v[188:191], a[216:219], a[168:171], v[188:191]
 v_accvgpr_read_b32 v5, a32
 v_lshlrev_b32 v6, 16, v5
 v_mfma_f32_16x16x32_bf16 v[188:191], a[220:223], a[172:175], v[188:191]
 v_and_b32 v5, s26, v5
 v_mul_f32 v6, v6, v80
 v_mfma_f32_16x16x32_bf16 v[184:187], a[220:223], a[164:167], v[184:187]
 v_mul_f32 v5, v5, v81
 v_cvt_pk_bf16_f32 v12, v6, v5
 v_mfma_f32_16x16x32_bf16 v[184:187], a[216:219], a[160:163], v[184:187]
 v_accvgpr_read_b32 v5, a33
 v_lshlrev_b32 v6, 16, v5
 v_mfma_f32_16x16x32_bf16 v[180:183], a[216:219], a[152:155], v[180:183]
 v_and_b32 v5, s26, v5
 v_mul_f32 v6, v6, v82
 v_mfma_f32_16x16x32_bf16 v[180:183], a[220:223], a[156:159], v[180:183]
 v_mul_f32 v5, v5, v83
 v_cvt_pk_bf16_f32 v13, v6, v5
 v_mfma_f32_16x16x32_bf16 v[176:179], a[220:223], a[148:151], v[176:179]
 v_accvgpr_read_b32 v5, a34
 v_lshlrev_b32 v6, 16, v5
 v_mfma_f32_16x16x32_bf16 v[176:179], a[216:219], a[144:147], v[176:179]
 v_and_b32 v5, s26, v5
 v_mul_f32 v6, v6, v112
 v_mfma_f32_16x16x32_bf16 v[172:175], a[216:219], a[136:139], v[172:175]
 v_mul_f32 v5, v5, v113
 v_cvt_pk_bf16_f32 v14, v6, v5
 v_mfma_f32_16x16x32_bf16 v[172:175], a[220:223], a[140:143], v[172:175]
 v_accvgpr_read_b32 v5, a35
 v_lshlrev_b32 v6, 16, v5
 v_mfma_f32_16x16x32_bf16 v[168:171], a[220:223], a[132:135], v[168:171]
 v_and_b32 v5, s26, v5
 v_mul_f32 v6, v6, v114
 v_mfma_f32_16x16x32_bf16 v[168:171], a[216:219], a[128:131], v[168:171]
 v_mul_f32 v5, v5, v115
 v_cvt_pk_bf16_f32 v15, v6, v5
 s_waitcnt vmcnt(8)
 v_mfma_f32_16x16x32_bf16 v[200:203], a[224:227], a[128:131], v[200:203]
 ds_write_b128 v18, v[12:15]
 v_mfma_f32_16x16x32_bf16 v[200:203], a[228:231], a[132:135], v[200:203]
 global_load_dwordx4 a[220:223], v0, s[70:71] offset:3072 sc1
 ds_read_b128 v[48:51], v3
 v_mfma_f32_16x16x32_bf16 v[204:207], a[228:231], a[140:143], v[204:207]
 ds_read_b128 v[80:83], v3 offset:1024
 v_accvgpr_read_b32 v5, a4
 v_mfma_f32_16x16x32_bf16 v[204:207], a[224:227], a[136:139], v[204:207]
 global_load_dwordx4 a[216:219], v0, s[70:71] offset:2048 sc1
 v_lshlrev_b32 v6, 16, v5
 v_mfma_f32_16x16x32_bf16 v[208:211], a[224:227], a[144:147], v[208:211]
 v_and_b32 v5, s26, v5
 v_mul_f32 v6, v6, v20
 s_add_u32 s70, s70, 8192
 s_addc_u32 s71, s71, 0
 v_mfma_f32_16x16x32_bf16 v[208:211], a[228:231], a[148:151], v[208:211]
 v_mul_f32 v5, v5, v21
 v_cvt_pk_bf16_f32 v8, v6, v5
 v_mfma_f32_16x16x32_bf16 v[212:215], a[228:231], a[156:159], v[212:215]
 v_accvgpr_read_b32 v5, a5
 v_lshlrev_b32 v6, 16, v5
 v_mfma_f32_16x16x32_bf16 v[212:215], a[224:227], a[152:155], v[212:215]
 v_and_b32 v5, s26, v5
 v_mul_f32 v6, v6, v22
 v_mfma_f32_16x16x32_bf16 v[216:219], a[224:227], a[160:163], v[216:219]
 v_mul_f32 v5, v5, v23
 v_cvt_pk_bf16_f32 v9, v6, v5
 s_waitcnt lgkmcnt(1)
 s_add_u32 s3, s28, 0
 v_mfma_f32_16x16x32_bf16 v[216:219], a[228:231], a[164:167], v[216:219]
 buffer_store_dwordx4 v[48:51], v16, s[16:19], s3 offen nt
 s_waitcnt lgkmcnt(0)
 s_add_u32 s3, s28, 16384
 buffer_store_dwordx4 v[80:83], v16, s[16:19], s3 offen nt
 v_accvgpr_read_b32 v5, a6
 v_lshlrev_b32 v6, 16, v5
 v_and_b32 v5, s26, v5
 v_mul_f32 v6, v6, v52
 v_mfma_f32_16x16x32_bf16 v[220:223], a[228:231], a[172:175], v[220:223]
 v_mul_f32 v5, v5, v53
 v_cvt_pk_bf16_f32 v10, v6, v5
 v_mfma_f32_16x16x32_bf16 v[220:223], a[224:227], a[168:171], v[220:223]
 v_accvgpr_read_b32 v5, a7
 v_lshlrev_b32 v6, 16, v5
 v_mfma_f32_16x16x32_bf16 v[224:227], a[224:227], a[176:179], v[224:227]
 v_and_b32 v5, s26, v5
 v_mul_f32 v6, v6, v54
 v_mul_f32 v5, v5, v55
 v_cvt_pk_bf16_f32 v11, v6, v5
 v_mfma_f32_16x16x32_bf16 v[224:227], a[228:231], a[180:183], v[224:227]
 ds_write_b128 v17, v[8:11] offset:4096
 v_mfma_f32_16x16x32_bf16 v[228:231], a[228:231], a[188:191], v[228:231]
 v_accvgpr_read_b32 v5, a36
 v_lshlrev_b32 v6, 16, v5
 v_mfma_f32_16x16x32_bf16 v[228:231], a[224:227], a[184:187], v[228:231]
 v_and_b32 v5, s26, v5
 v_mul_f32 v6, v6, v84
 s_waitcnt vmcnt(10)
 v_mfma_f32_16x16x32_bf16 a[252:255], a[232:235], a[184:187], a[252:255]
 ds_read_b128 a[184:187], v1 offset:63488
 v_mul_f32 v5, v5, v85
 v_mfma_f32_16x16x32_bf16 a[252:255], a[236:239], a[188:191], a[252:255]
 global_load_dwordx4 a[228:231], v0, s[70:71] offset:-3072 sc1
 ds_read_b128 a[188:191], v1 offset:64512
 v_mfma_f32_16x16x32_bf16 a[248:251], a[236:239], a[180:183], a[248:251]
 ds_read_b128 a[180:183], v1 offset:60416
 v_cvt_pk_bf16_f32 v12, v6, v5
 v_mfma_f32_16x16x32_bf16 a[248:251], a[232:235], a[176:179], a[248:251]
 global_load_dwordx4 a[224:227], v0, s[70:71] offset:-4096 sc1
 ds_read_b128 a[176:179], v1 offset:59392
 v_mfma_f32_16x16x32_bf16 v[252:255], a[232:235], a[168:171], v[252:255]
 ds_read_b128 a[168:171], v1 offset:55296
 v_accvgpr_read_b32 v5, a37
 v_mfma_f32_16x16x32_bf16 v[252:255], a[236:239], a[172:175], v[252:255]
 ds_read_b128 a[172:175], v1 offset:56320
 v_lshlrev_b32 v6, 16, v5
 v_mfma_f32_16x16x32_bf16 v[248:251], a[236:239], a[164:167], v[248:251]
 ds_read_b128 a[164:167], v1 offset:52224
 v_and_b32 v5, s26, v5
 v_mfma_f32_16x16x32_bf16 v[248:251], a[232:235], a[160:163], v[248:251]
 ds_read_b128 a[160:163], v1 offset:51200
 v_mul_f32 v6, v6, v86
 v_mul_f32 v5, v5, v87
 v_mfma_f32_16x16x32_bf16 v[244:247], a[232:235], a[152:155], v[244:247]
 ds_read_b128 a[152:155], v1 offset:47104
 v_cvt_pk_bf16_f32 v13, v6, v5
 v_mfma_f32_16x16x32_bf16 v[244:247], a[236:239], a[156:159], v[244:247]
 ds_read_b128 a[156:159], v1 offset:48128
 v_accvgpr_read_b32 v5, a38
 v_lshlrev_b32 v6, 16, v5
 v_mfma_f32_16x16x32_bf16 v[240:243], a[236:239], a[148:151], v[240:243]
 ds_read_b128 a[148:151], v1 offset:44032
 v_and_b32 v5, s26, v5
 v_mul_f32 v6, v6, v116
 v_mfma_f32_16x16x32_bf16 v[240:243], a[232:235], a[144:147], v[240:243]
 ds_read_b128 a[144:147], v1 offset:43008
 v_mul_f32 v5, v5, v117
 v_mfma_f32_16x16x32_bf16 v[236:239], a[232:235], a[136:139], v[236:239]
 ds_read_b128 a[136:139], v1 offset:38912
 v_cvt_pk_bf16_f32 v14, v6, v5
 v_mfma_f32_16x16x32_bf16 v[236:239], a[236:239], a[140:143], v[236:239]
 ds_read_b128 a[140:143], v1 offset:39936
 v_accvgpr_read_b32 v5, a39
 v_mfma_f32_16x16x32_bf16 v[232:235], a[236:239], a[132:135], v[232:235]
 ds_read_b128 a[132:135], v1 offset:35840
 v_lshlrev_b32 v6, 16, v5
 v_mfma_f32_16x16x32_bf16 v[232:235], a[232:235], a[128:131], v[232:235]
 ds_read_b128 a[128:131], v1 offset:34816
 v_and_b32 v5, s26, v5
 s_waitcnt vmcnt(10) lgkmcnt(8)
 v_mfma_f32_16x16x32_bf16 v[164:167], a[192:195], a[184:187], v[164:167]
 v_mul_f32 v6, v6, v118
 v_mul_f32 v5, v5, v119
 v_mfma_f32_16x16x32_bf16 v[164:167], a[196:199], a[188:191], v[164:167]
 global_load_dwordx4 a[236:239], v0, s[70:71] offset:-1024 sc1
 v_cvt_pk_bf16_f32 v15, v6, v5
 v_mfma_f32_16x16x32_bf16 v[160:163], a[196:199], a[180:183], v[160:163]
 ds_write_b128 v18, v[12:15] offset:4096
 ds_read_b128 v[48:51], v3 offset:4096
 v_mfma_f32_16x16x32_bf16 v[160:163], a[192:195], a[176:179], v[160:163]
 global_load_dwordx4 a[232:235], v0, s[70:71] offset:-2048 sc1
 ds_read_b128 v[80:83], v3 offset:5120
 v_mfma_f32_16x16x32_bf16 v[156:159], a[192:195], a[168:171], v[156:159]
 v_accvgpr_read_b32 v5, a8
 v_lshlrev_b32 v6, 16, v5
 v_mfma_f32_16x16x32_bf16 v[156:159], a[196:199], a[172:175], v[156:159]
 v_and_b32 v5, s26, v5
 v_mul_f32 v6, v6, v24
 v_mfma_f32_16x16x32_bf16 v[152:155], a[196:199], a[164:167], v[152:155]
 v_mul_f32 v5, v5, v25
 v_cvt_pk_bf16_f32 v8, v6, v5
 v_mfma_f32_16x16x32_bf16 v[152:155], a[192:195], a[160:163], v[152:155]
 v_accvgpr_read_b32 v5, a9
 v_lshlrev_b32 v6, 16, v5
 s_waitcnt lgkmcnt(3)
 v_mfma_f32_16x16x32_bf16 v[148:151], a[192:195], a[152:155], v[148:151]
 v_and_b32 v5, s26, v5
 v_mul_f32 v6, v6, v26
 v_mfma_f32_16x16x32_bf16 v[148:151], a[196:199], a[156:159], v[148:151]
 v_mul_f32 v5, v5, v27
 v_cvt_pk_bf16_f32 v9, v6, v5
 s_waitcnt lgkmcnt(1)
 s_add_u32 s3, s28, 32768
 v_mfma_f32_16x16x32_bf16 v[144:147], a[196:199], a[148:151], v[144:147]
 buffer_store_dwordx4 v[48:51], v16, s[16:19], s3 offen nt
 s_waitcnt lgkmcnt(0)
 s_add_u32 s3, s28, 49152
 buffer_store_dwordx4 v[80:83], v16, s[16:19], s3 offen nt
 v_accvgpr_read_b32 v5, a10
 v_lshlrev_b32 v6, 16, v5
 v_and_b32 v5, s26, v5
 v_mul_f32 v6, v6, v56
 v_mfma_f32_16x16x32_bf16 v[144:147], a[192:195], a[144:147], v[144:147]
 v_mul_f32 v5, v5, v57
 v_cvt_pk_bf16_f32 v10, v6, v5
 v_mfma_f32_16x16x32_bf16 v[140:143], a[192:195], a[136:139], v[140:143]
 v_accvgpr_read_b32 v5, a11
 v_lshlrev_b32 v6, 16, v5
 v_mfma_f32_16x16x32_bf16 v[140:143], a[196:199], a[140:143], v[140:143]
 v_and_b32 v5, s26, v5
 v_mul_f32 v6, v6, v58
 v_mfma_f32_16x16x32_bf16 v[136:139], a[196:199], a[132:135], v[136:139]
 v_mul_f32 v5, v5, v59
 v_cvt_pk_bf16_f32 v11, v6, v5
 v_mfma_f32_16x16x32_bf16 v[136:139], a[192:195], a[128:131], v[136:139]
 ds_write_b128 v17, v[8:11] offset:8192
 s_waitcnt vmcnt(12)
 v_mfma_f32_16x16x32_bf16 v[168:171], a[200:203], a[128:131], v[168:171]
 v_accvgpr_read_b32 v5, a40
 v_lshlrev_b32 v6, 16, v5
 v_mfma_f32_16x16x32_bf16 v[168:171], a[204:207], a[132:135], v[168:171]
 global_load_dwordx4 a[196:199], v0, s[70:71] offset:1024 sc1
 v_and_b32 v5, s26, v5
 v_mfma_f32_16x16x32_bf16 v[172:175], a[204:207], a[140:143], v[172:175]
 v_mul_f32 v6, v6, v88
 v_mul_f32 v5, v5, v89
 v_mfma_f32_16x16x32_bf16 v[172:175], a[200:203], a[136:139], v[172:175]
 global_load_dwordx4 a[192:195], v0, s[70:71] offset:0 sc1
 v_cvt_pk_bf16_f32 v12, v6, v5
 v_mfma_f32_16x16x32_bf16 v[176:179], a[200:203], a[144:147], v[176:179]
 v_accvgpr_read_b32 v5, a41
 v_lshlrev_b32 v6, 16, v5
 v_mfma_f32_16x16x32_bf16 v[176:179], a[204:207], a[148:151], v[176:179]
 v_and_b32 v5, s26, v5
 v_mul_f32 v6, v6, v90
 v_mfma_f32_16x16x32_bf16 v[180:183], a[204:207], a[156:159], v[180:183]
 v_mul_f32 v5, v5, v91
 v_cvt_pk_bf16_f32 v13, v6, v5
 v_mfma_f32_16x16x32_bf16 v[180:183], a[200:203], a[152:155], v[180:183]
 v_accvgpr_read_b32 v5, a42
 v_lshlrev_b32 v6, 16, v5
 v_mfma_f32_16x16x32_bf16 v[184:187], a[200:203], a[160:163], v[184:187]
 v_and_b32 v5, s26, v5
 v_mul_f32 v6, v6, v120
 v_mfma_f32_16x16x32_bf16 v[184:187], a[204:207], a[164:167], v[184:187]
 v_mul_f32 v5, v5, v121
 v_cvt_pk_bf16_f32 v14, v6, v5
 v_mfma_f32_16x16x32_bf16 v[188:191], a[204:207], a[172:175], v[188:191]
 v_accvgpr_read_b32 v5, a43
 v_lshlrev_b32 v6, 16, v5
 v_mfma_f32_16x16x32_bf16 v[188:191], a[200:203], a[168:171], v[188:191]
 v_and_b32 v5, s26, v5
 v_mul_f32 v6, v6, v122
 v_mfma_f32_16x16x32_bf16 v[192:195], a[200:203], a[176:179], v[192:195]
 v_mul_f32 v5, v5, v123
 v_cvt_pk_bf16_f32 v15, v6, v5
 v_mfma_f32_16x16x32_bf16 v[192:195], a[204:207], a[180:183], v[192:195]
 ds_write_b128 v18, v[12:15] offset:8192
 v_mfma_f32_16x16x32_bf16 v[196:199], a[204:207], a[188:191], v[196:199]
 ds_read_b128 v[48:51], v3 offset:8192
 ds_read_b128 v[80:83], v3 offset:9216
 v_mfma_f32_16x16x32_bf16 v[196:199], a[200:203], a[184:187], v[196:199]
 v_accvgpr_read_b32 v5, a12
 v_lshlrev_b32 v6, 16, v5
 s_waitcnt vmcnt(12)
 v_mfma_f32_16x16x32_bf16 v[228:231], a[208:211], a[184:187], v[228:231]
 v_and_b32 v5, s26, v5
 v_mul_f32 v6, v6, v28
 v_mfma_f32_16x16x32_bf16 v[228:231], a[212:215], a[188:191], v[228:231]
 global_load_dwordx4 a[204:207], v0, s[70:71] offset:3072 sc1
 v_mul_f32 v5, v5, v29
 v_mfma_f32_16x16x32_bf16 v[224:227], a[212:215], a[180:183], v[224:227]
 v_cvt_pk_bf16_f32 v8, v6, v5
 v_accvgpr_read_b32 v5, a13
 v_mfma_f32_16x16x32_bf16 v[224:227], a[208:211], a[176:179], v[224:227]
 global_load_dwordx4 a[200:203], v0, s[70:71] offset:2048 sc1
 v_lshlrev_b32 v6, 16, v5
 v_mfma_f32_16x16x32_bf16 v[220:223], a[208:211], a[168:171], v[220:223]
 v_and_b32 v5, s26, v5
 v_mul_f32 v6, v6, v30
 s_add_u32 s70, s70, 8192
 s_addc_u32 s71, s71, 0
 v_mfma_f32_16x16x32_bf16 v[220:223], a[212:215], a[172:175], v[220:223]
 v_mul_f32 v5, v5, v31
 v_cvt_pk_bf16_f32 v9, v6, v5
 s_waitcnt lgkmcnt(1)
 v_mfma_f32_16x16x32_bf16 v[216:219], a[212:215], a[164:167], v[216:219]
 s_add_u32 s3, s28, 65536
 buffer_store_dwordx4 v[48:51], v16, s[16:19], s3 offen nt
 s_waitcnt lgkmcnt(0)
 v_mfma_f32_16x16x32_bf16 v[216:219], a[208:211], a[160:163], v[216:219]
 s_add_u32 s3, s28, 81920
 buffer_store_dwordx4 v[80:83], v16, s[16:19], s3 offen nt
 v_accvgpr_read_b32 v5, a14
 v_lshlrev_b32 v6, 16, v5
 v_and_b32 v5, s26, v5
 v_mul_f32 v6, v6, v60
 v_mfma_f32_16x16x32_bf16 v[212:215], a[208:211], a[152:155], v[212:215]
 v_mul_f32 v5, v5, v61
 v_cvt_pk_bf16_f32 v10, v6, v5
 v_mfma_f32_16x16x32_bf16 v[212:215], a[212:215], a[156:159], v[212:215]
 v_accvgpr_read_b32 v5, a15
 v_lshlrev_b32 v6, 16, v5
 v_mfma_f32_16x16x32_bf16 v[208:211], a[212:215], a[148:151], v[208:211]
 v_and_b32 v5, s26, v5
 v_mul_f32 v6, v6, v62
 v_mfma_f32_16x16x32_bf16 v[208:211], a[208:211], a[144:147], v[208:211]
 v_mul_f32 v5, v5, v63
 v_cvt_pk_bf16_f32 v11, v6, v5
 v_mfma_f32_16x16x32_bf16 v[204:207], a[208:211], a[136:139], v[204:207]
 ds_write_b128 v17, v[8:11] offset:12288
 v_mfma_f32_16x16x32_bf16 v[204:207], a[212:215], a[140:143], v[204:207]
 v_accvgpr_read_b32 v5, a44
 v_lshlrev_b32 v6, 16, v5
 v_mfma_f32_16x16x32_bf16 v[200:203], a[212:215], a[132:135], v[200:203]
 v_and_b32 v5, s26, v5
 v_mul_f32 v6, v6, v92
 v_mfma_f32_16x16x32_bf16 v[200:203], a[208:211], a[128:131], v[200:203]
 v_mul_f32 v5, v5, v93
 v_cvt_pk_bf16_f32 v12, v6, v5
 s_waitcnt vmcnt(14)
 v_mfma_f32_16x16x32_bf16 v[232:235], a[216:219], a[128:131], v[232:235]
 ds_read_b128 a[128:131], v2 offset:2048
 v_accvgpr_read_b32 v5, a45
 v_mfma_f32_16x16x32_bf16 v[232:235], a[220:223], a[132:135], v[232:235]
 global_load_dwordx4 a[212:215], v0, s[70:71] offset:-3072 sc1
 ds_read_b128 a[132:135], v2 offset:3072
 v_mfma_f32_16x16x32_bf16 v[236:239], a[220:223], a[140:143], v[236:239]
 ds_read_b128 a[140:143], v2 offset:7168
 v_lshlrev_b32 v6, 16, v5
 v_mfma_f32_16x16x32_bf16 v[236:239], a[216:219], a[136:139], v[236:239]
 global_load_dwordx4 a[208:211], v0, s[70:71] offset:-4096 sc1
 ds_read_b128 a[136:139], v2 offset:6144
 v_and_b32 v5, s26, v5
 v_mfma_f32_16x16x32_bf16 v[240:243], a[216:219], a[144:147], v[240:243]
 ds_read_b128 a[144:147], v2 offset:10240
 v_mul_f32 v6, v6, v94
 v_mul_f32 v5, v5, v95
 v_mfma_f32_16x16x32_bf16 v[240:243], a[220:223], a[148:151], v[240:243]
 ds_read_b128 a[148:151], v2 offset:11264
 v_cvt_pk_bf16_f32 v13, v6, v5
 v_mfma_f32_16x16x32_bf16 v[244:247], a[220:223], a[156:159], v[244:247]
 ds_read_b128 a[156:159], v2 offset:15360
 v_accvgpr_read_b32 v5, a46
 v_lshlrev_b32 v6, 16, v5
 v_mfma_f32_16x16x32_bf16 v[244:247], a[216:219], a[152:155], v[244:247]
 ds_read_b128 a[152:155], v2 offset:14336
 v_and_b32 v5, s26, v5
 v_mul_f32 v6, v6, v124
 v_mfma_f32_16x16x32_bf16 v[248:251], a[216:219], a[160:163], v[248:251]
 ds_read_b128 a[160:163], v2 offset:18432
 v_mul_f32 v5, v5, v125
 v_mfma_f32_16x16x32_bf16 v[248:251], a[220:223], a[164:167], v[248:251]
 ds_read_b128 a[164:167], v2 offset:19456
 v_cvt_pk_bf16_f32 v14, v6, v5
 v_mfma_f32_16x16x32_bf16 v[252:255], a[220:223], a[172:175], v[252:255]
 ds_read_b128 a[172:175], v2 offset:23552
 v_accvgpr_read_b32 v5, a47
 v_mfma_f32_16x16x32_bf16 v[252:255], a[216:219], a[168:171], v[252:255]
 ds_read_b128 a[168:171], v2 offset:22528
 v_lshlrev_b32 v6, 16, v5
 v_mfma_f32_16x16x32_bf16 a[248:251], a[216:219], a[176:179], a[248:251]
 ds_read_b128 a[176:179], v2 offset:26624
 v_and_b32 v5, s26, v5
 v_mfma_f32_16x16x32_bf16 a[248:251], a[220:223], a[180:183], a[248:251]
 ds_read_b128 a[180:183], v2 offset:27648
 v_mul_f32 v6, v6, v126
 v_mfma_f32_16x16x32_bf16 a[252:255], a[220:223], a[188:191], a[252:255]
 ds_read_b128 a[188:191], v2 offset:31744
 v_mul_f32 v5, v5, v127
 v_mfma_f32_16x16x32_bf16 a[252:255], a[216:219], a[184:187], a[252:255]
 ds_read_b128 a[184:187], v2 offset:30720
 v_cvt_pk_bf16_f32 v15, v6, v5
 s_waitcnt vmcnt(12) lgkmcnt(8)
 v_mfma_f32_16x16x32_bf16 v[136:139], a[224:227], a[128:131], v[136:139]
 ds_write_b128 v18, v[12:15] offset:12288
 ds_read_b128 v[48:51], v3 offset:12288
 ds_read_b128 v[80:83], v3 offset:13312
 v_mfma_f32_16x16x32_bf16 v[136:139], a[228:231], a[132:135], v[136:139]
 global_load_dwordx4 a[220:223], v0, s[70:71] offset:-1024 sc1
 v_accvgpr_read_b32 v5, a16
 v_mfma_f32_16x16x32_bf16 v[140:143], a[228:231], a[140:143], v[140:143]
 v_lshlrev_b32 v6, 16, v5
 v_and_b32 v5, s26, v5
 v_mfma_f32_16x16x32_bf16 v[140:143], a[224:227], a[136:139], v[140:143]
 global_load_dwordx4 a[216:219], v0, s[70:71] offset:-2048 sc1
 v_mul_f32 v6, v6, v32
 v_mfma_f32_16x16x32_bf16 v[144:147], a[224:227], a[144:147], v[144:147]
 v_mul_f32 v5, v5, v33
 v_cvt_pk_bf16_f32 v8, v6, v5
 v_mfma_f32_16x16x32_bf16 v[144:147], a[228:231], a[148:151], v[144:147]
 v_accvgpr_read_b32 v5, a17
 v_lshlrev_b32 v6, 16, v5
 v_mfma_f32_16x16x32_bf16 v[148:151], a[228:231], a[156:159], v[148:151]
 v_and_b32 v5, s26, v5
 v_mul_f32 v6, v6, v34
 v_mfma_f32_16x16x32_bf16 v[148:151], a[224:227], a[152:155], v[148:151]
 v_mul_f32 v5, v5, v35
 v_cvt_pk_bf16_f32 v9, v6, v5
 s_waitcnt lgkmcnt(1)
 s_add_u32 s3, s28, 98304
 v_mfma_f32_16x16x32_bf16 v[152:155], a[224:227], a[160:163], v[152:155]
 buffer_store_dwordx4 v[48:51], v16, s[16:19], s3 offen nt
 s_waitcnt lgkmcnt(0)
 s_add_u32 s3, s28, 114688
 buffer_store_dwordx4 v[80:83], v16, s[16:19], s3 offen nt
 v_accvgpr_read_b32 v5, a18
 v_lshlrev_b32 v6, 16, v5
 v_and_b32 v5, s26, v5
 v_mul_f32 v6, v6, v64
 v_mfma_f32_16x16x32_bf16 v[152:155], a[228:231], a[164:167], v[152:155]
 v_mul_f32 v5, v5, v65
 v_cvt_pk_bf16_f32 v10, v6, v5
 v_mfma_f32_16x16x32_bf16 v[156:159], a[228:231], a[172:175], v[156:159]
 v_accvgpr_read_b32 v5, a19
 v_lshlrev_b32 v6, 16, v5
 v_mfma_f32_16x16x32_bf16 v[156:159], a[224:227], a[168:171], v[156:159]
 v_and_b32 v5, s26, v5
 v_mul_f32 v6, v6, v66
 v_mfma_f32_16x16x32_bf16 v[160:163], a[224:227], a[176:179], v[160:163]
 v_mul_f32 v5, v5, v67
 v_cvt_pk_bf16_f32 v11, v6, v5
 v_mfma_f32_16x16x32_bf16 v[160:163], a[228:231], a[180:183], v[160:163]
 ds_write_b128 v17, v[8:11] offset:16384
 v_mfma_f32_16x16x32_bf16 v[164:167], a[228:231], a[188:191], v[164:167]
 v_accvgpr_read_b32 v5, a48
 v_lshlrev_b32 v6, 16, v5
 v_mfma_f32_16x16x32_bf16 v[164:167], a[224:227], a[184:187], v[164:167]
 v_and_b32 v5, s26, v5
 v_mul_f32 v6, v6, v96
 s_waitcnt vmcnt(14)
 v_mfma_f32_16x16x32_bf16 v[196:199], a[232:235], a[184:187], v[196:199]
 v_mul_f32 v5, v5, v97
 v_cvt_pk_bf16_f32 v12, v6, v5
 v_mfma_f32_16x16x32_bf16 v[196:199], a[236:239], a[188:191], v[196:199]
 global_load_dwordx4 a[228:231], v0, s[70:71] offset:1024 sc1
 v_accvgpr_read_b32 v5, a49
 v_mfma_f32_16x16x32_bf16 v[192:195], a[236:239], a[180:183], v[192:195]
 v_lshlrev_b32 v6, 16, v5
 v_and_b32 v5, s26, v5
 v_mfma_f32_16x16x32_bf16 v[192:195], a[232:235], a[176:179], v[192:195]
 global_load_dwordx4 a[224:227], v0, s[70:71] offset:0 sc1
 v_mul_f32 v6, v6, v98
 v_mfma_f32_16x16x32_bf16 v[188:191], a[232:235], a[168:171], v[188:191]
 v_mul_f32 v5, v5, v99
 v_cvt_pk_bf16_f32 v13, v6, v5
 v_mfma_f32_16x16x32_bf16 v[188:191], a[236:239], a[172:175], v[188:191]
 v_accvgpr_read_b32 v5, a50
 v_lshlrev_b32 v6, 16, v5
 v_mfma_f32_16x16x32_bf16 v[184:187], a[236:239], a[164:167], v[184:187]
 v_and_b32 v5, s26, v5
 v_mul_f32 v6, v6, v128
 v_mfma_f32_16x16x32_bf16 v[184:187], a[232:235], a[160:163], v[184:187]
 v_mul_f32 v5, v5, v129
 v_cvt_pk_bf16_f32 v14, v6, v5
 v_mfma_f32_16x16x32_bf16 v[180:183], a[232:235], a[152:155], v[180:183]
 v_accvgpr_read_b32 v5, a51
 v_lshlrev_b32 v6, 16, v5
 v_mfma_f32_16x16x32_bf16 v[180:183], a[236:239], a[156:159], v[180:183]
 v_and_b32 v5, s26, v5
 v_mul_f32 v6, v6, v130
 v_mfma_f32_16x16x32_bf16 v[176:179], a[236:239], a[148:151], v[176:179]
 v_mul_f32 v5, v5, v131
 v_cvt_pk_bf16_f32 v15, v6, v5
 v_mfma_f32_16x16x32_bf16 v[176:179], a[232:235], a[144:147], v[176:179]
 ds_write_b128 v18, v[12:15] offset:16384
 v_mfma_f32_16x16x32_bf16 v[172:175], a[232:235], a[136:139], v[172:175]
 ds_read_b128 v[48:51], v3 offset:16384
 ds_read_b128 v[80:83], v3 offset:17408
 v_mfma_f32_16x16x32_bf16 v[172:175], a[236:239], a[140:143], v[172:175]
 v_accvgpr_read_b32 v5, a20
 v_lshlrev_b32 v6, 16, v5
 v_mfma_f32_16x16x32_bf16 v[168:171], a[236:239], a[132:135], v[168:171]
 v_and_b32 v5, s26, v5
 v_mul_f32 v6, v6, v36
 v_mfma_f32_16x16x32_bf16 v[168:171], a[232:235], a[128:131], v[168:171]
 v_mul_f32 v5, v5, v37
 v_cvt_pk_bf16_f32 v8, v6, v5
 s_waitcnt vmcnt(12)
 v_mfma_f32_16x16x32_bf16 v[200:203], a[192:195], a[128:131], v[200:203]
 v_accvgpr_read_b32 v5, a21
 v_lshlrev_b32 v6, 16, v5
 v_mfma_f32_16x16x32_bf16 v[200:203], a[196:199], a[132:135], v[200:203]
 global_load_dwordx4 a[236:239], v0, s[70:71] offset:3072 sc1
 v_and_b32 v5, s26, v5
 v_mfma_f32_16x16x32_bf16 v[204:207], a[196:199], a[140:143], v[204:207]
 v_mul_f32 v6, v6, v38
 v_mul_f32 v5, v5, v39
 v_mfma_f32_16x16x32_bf16 v[204:207], a[192:195], a[136:139], v[204:207]
 global_load_dwordx4 a[232:235], v0, s[70:71] offset:2048 sc1
 v_cvt_pk_bf16_f32 v9, v6, v5
 s_waitcnt lgkmcnt(1)
 s_add_u32 s3, s28, 131072
 v_mfma_f32_16x16x32_bf16 v[208:211], a[192:195], a[144:147], v[208:211]
 buffer_store_dwordx4 v[48:51], v16, s[16:19], s3 offen nt
 s_waitcnt lgkmcnt(0)
 s_add_u32 s3, s28, 147456
 s_add_u32 s70, s70, 1843200
 s_addc_u32 s71, s71, 0
 v_mfma_f32_16x16x32_bf16 v[208:211], a[196:199], a[148:151], v[208:211]
 buffer_store_dwordx4 v[80:83], v16, s[16:19], s3 offen nt
 v_accvgpr_read_b32 v5, a22
 v_lshlrev_b32 v6, 16, v5
 v_and_b32 v5, s26, v5
 v_mul_f32 v6, v6, v68
 v_mfma_f32_16x16x32_bf16 v[212:215], a[196:199], a[156:159], v[212:215]
 v_mul_f32 v5, v5, v69
 v_cvt_pk_bf16_f32 v10, v6, v5
 v_mfma_f32_16x16x32_bf16 v[212:215], a[192:195], a[152:155], v[212:215]
 v_accvgpr_read_b32 v5, a23
 v_lshlrev_b32 v6, 16, v5
 v_mfma_f32_16x16x32_bf16 v[216:219], a[192:195], a[160:163], v[216:219]
 v_and_b32 v5, s26, v5
 v_mul_f32 v6, v6, v70
 v_mfma_f32_16x16x32_bf16 v[216:219], a[196:199], a[164:167], v[216:219]
 v_mul_f32 v5, v5, v71
 v_cvt_pk_bf16_f32 v11, v6, v5
 v_mfma_f32_16x16x32_bf16 v[220:223], a[196:199], a[172:175], v[220:223]
 ds_write_b128 v17, v[8:11] offset:20480
 v_mfma_f32_16x16x32_bf16 v[220:223], a[192:195], a[168:171], v[220:223]
 v_accvgpr_read_b32 v5, a52
 v_lshlrev_b32 v6, 16, v5
 v_mfma_f32_16x16x32_bf16 v[224:227], a[192:195], a[176:179], v[224:227]
 v_and_b32 v5, s26, v5
 v_mul_f32 v6, v6, v100
 v_mfma_f32_16x16x32_bf16 v[224:227], a[196:199], a[180:183], v[224:227]
 v_mul_f32 v5, v5, v101
 v_cvt_pk_bf16_f32 v12, v6, v5
 v_mfma_f32_16x16x32_bf16 v[228:231], a[196:199], a[188:191], v[228:231]
 v_accvgpr_read_b32 v5, a53
 v_lshlrev_b32 v6, 16, v5
 v_mfma_f32_16x16x32_bf16 v[228:231], a[192:195], a[184:187], v[228:231]
 v_and_b32 v5, s26, v5
 v_mul_f32 v6, v6, v102
 s_waitcnt vmcnt(14)
 v_mfma_f32_16x16x32_bf16 a[252:255], a[200:203], a[184:187], a[252:255]
 ds_read_b128 a[184:187], v2 offset:63488
 v_mul_f32 v5, v5, v103
 v_mfma_f32_16x16x32_bf16 a[252:255], a[204:207], a[188:191], a[252:255]
 ds_read_b128 a[188:191], v2 offset:64512
 v_cvt_pk_bf16_f32 v13, v6, v5
 v_mfma_f32_16x16x32_bf16 a[248:251], a[204:207], a[180:183], a[248:251]
 ds_read_b128 a[180:183], v2 offset:60416
 v_accvgpr_read_b32 v5, a54
 v_mfma_f32_16x16x32_bf16 a[248:251], a[200:203], a[176:179], a[248:251]
 ds_read_b128 a[176:179], v2 offset:59392
 v_lshlrev_b32 v6, 16, v5
 v_mfma_f32_16x16x32_bf16 v[252:255], a[200:203], a[168:171], v[252:255]
 ds_read_b128 a[168:171], v2 offset:55296
 v_and_b32 v5, s26, v5
 v_mfma_f32_16x16x32_bf16 v[252:255], a[204:207], a[172:175], v[252:255]
 ds_read_b128 a[172:175], v2 offset:56320
 v_mul_f32 v6, v6, v132
 v_mfma_f32_16x16x32_bf16 v[248:251], a[204:207], a[164:167], v[248:251]
 ds_read_b128 a[164:167], v2 offset:52224
 v_mul_f32 v5, v5, v133
 v_mfma_f32_16x16x32_bf16 v[248:251], a[200:203], a[160:163], v[248:251]
 ds_read_b128 a[160:163], v2 offset:51200
 v_cvt_pk_bf16_f32 v14, v6, v5
 v_mfma_f32_16x16x32_bf16 v[244:247], a[200:203], a[152:155], v[244:247]
 ds_read_b128 a[152:155], v2 offset:47104
 v_accvgpr_read_b32 v5, a55
 v_mfma_f32_16x16x32_bf16 v[244:247], a[204:207], a[156:159], v[244:247]
 ds_read_b128 a[156:159], v2 offset:48128
 v_lshlrev_b32 v6, 16, v5
 v_mfma_f32_16x16x32_bf16 v[240:243], a[204:207], a[148:151], v[240:243]
 ds_read_b128 a[148:151], v2 offset:44032
 v_and_b32 v5, s26, v5
 v_mfma_f32_16x16x32_bf16 v[240:243], a[200:203], a[144:147], v[240:243]
 ds_read_b128 a[144:147], v2 offset:43008
 v_mul_f32 v6, v6, v134
 v_mfma_f32_16x16x32_bf16 v[236:239], a[200:203], a[136:139], v[236:239]
 ds_read_b128 a[136:139], v2 offset:38912
 v_mul_f32 v5, v5, v135
 v_mfma_f32_16x16x32_bf16 v[236:239], a[204:207], a[140:143], v[236:239]
 ds_read_b128 a[140:143], v2 offset:39936
 v_cvt_pk_bf16_f32 v15, v6, v5
 v_mfma_f32_16x16x32_bf16 v[232:235], a[204:207], a[132:135], v[232:235]
 ds_read_b128 a[132:135], v2 offset:35840
 v_mfma_f32_16x16x32_bf16 v[232:235], a[200:203], a[128:131], v[232:235]
 ds_read_b128 a[128:131], v2 offset:34816
 ds_write_b128 v18, v[12:15] offset:20480
 ds_read_b128 v[48:51], v3 offset:20480
 ds_read_b128 v[80:83], v3 offset:21504
 v_accvgpr_read_b32 v5, a24
 v_lshlrev_b32 v6, 16, v5
 s_waitcnt vmcnt(10) lgkmcnt(11)
 v_mfma_f32_16x16x32_bf16 v[164:167], a[208:211], a[184:187], v[164:167]
 v_and_b32 v5, s26, v5
 v_mul_f32 v6, v6, v40
 v_mfma_f32_16x16x32_bf16 v[164:167], a[212:215], a[188:191], v[164:167]
 v_mul_f32 v5, v5, v41
 v_cvt_pk_bf16_f32 v8, v6, v5
 v_mfma_f32_16x16x32_bf16 v[160:163], a[212:215], a[180:183], v[160:163]
 v_accvgpr_read_b32 v5, a25
 v_lshlrev_b32 v6, 16, v5
 v_mfma_f32_16x16x32_bf16 v[160:163], a[208:211], a[176:179], v[160:163]
 v_and_b32 v5, s26, v5
 v_mul_f32 v6, v6, v42
 v_mfma_f32_16x16x32_bf16 v[156:159], a[208:211], a[168:171], v[156:159]
 v_mul_f32 v5, v5, v43
 v_cvt_pk_bf16_f32 v9, v6, v5
 s_waitcnt lgkmcnt(1)
 s_add_u32 s3, s28, 163840
 v_mfma_f32_16x16x32_bf16 v[156:159], a[212:215], a[172:175], v[156:159]
 buffer_store_dwordx4 v[48:51], v16, s[16:19], s3 offen nt
 s_waitcnt lgkmcnt(0)
 s_add_u32 s3, s28, 180224
 buffer_store_dwordx4 v[80:83], v16, s[16:19], s3 offen nt
 v_accvgpr_read_b32 v5, a26
 v_lshlrev_b32 v6, 16, v5
 v_and_b32 v5, s26, v5
 v_mul_f32 v6, v6, v72
 v_mfma_f32_16x16x32_bf16 v[152:155], a[212:215], a[164:167], v[152:155]
 v_mul_f32 v5, v5, v73
 v_cvt_pk_bf16_f32 v10, v6, v5
 v_mfma_f32_16x16x32_bf16 v[152:155], a[208:211], a[160:163], v[152:155]
 v_accvgpr_read_b32 v5, a27
 v_lshlrev_b32 v6, 16, v5
 v_mfma_f32_16x16x32_bf16 v[148:151], a[208:211], a[152:155], v[148:151]
 v_and_b32 v5, s26, v5
 v_mul_f32 v6, v6, v74
 v_mfma_f32_16x16x32_bf16 v[148:151], a[212:215], a[156:159], v[148:151]
 v_mul_f32 v5, v5, v75
 v_cvt_pk_bf16_f32 v11, v6, v5
 v_mfma_f32_16x16x32_bf16 v[144:147], a[212:215], a[148:151], v[144:147]
 ds_write_b128 v17, v[8:11] offset:24576
 v_mfma_f32_16x16x32_bf16 v[144:147], a[208:211], a[144:147], v[144:147]
 v_accvgpr_read_b32 v5, a56
 v_lshlrev_b32 v6, 16, v5
 v_mfma_f32_16x16x32_bf16 v[140:143], a[208:211], a[136:139], v[140:143]
 v_and_b32 v5, s26, v5
 v_mul_f32 v6, v6, v104
 v_mfma_f32_16x16x32_bf16 v[140:143], a[212:215], a[140:143], v[140:143]
 v_mul_f32 v5, v5, v105
 v_cvt_pk_bf16_f32 v12, v6, v5
 v_mfma_f32_16x16x32_bf16 v[136:139], a[212:215], a[132:135], v[136:139]
 v_accvgpr_read_b32 v5, a57
 v_lshlrev_b32 v6, 16, v5
 v_mfma_f32_16x16x32_bf16 v[136:139], a[208:211], a[128:131], v[136:139]
 v_and_b32 v5, s26, v5
 v_mul_f32 v6, v6, v106
 s_waitcnt vmcnt(10)
 v_mfma_f32_16x16x32_bf16 v[168:171], a[216:219], a[128:131], v[168:171]
 v_mul_f32 v5, v5, v107
 v_cvt_pk_bf16_f32 v13, v6, v5
 v_mfma_f32_16x16x32_bf16 v[168:171], a[220:223], a[132:135], v[168:171]
 v_accvgpr_read_b32 v5, a58
 v_accvgpr_read_b32 v7, a240
 v_mfma_f32_16x16x32_bf16 v[172:175], a[220:223], a[140:143], v[172:175]
 v_lshlrev_b32 v6, 16, v5
 v_and_b32 v5, s26, v5
 v_mfma_f32_16x16x32_bf16 v[172:175], a[216:219], a[136:139], v[172:175]
 v_mul_f32 v6, v6, v7
 v_accvgpr_read_b32 v7, a241
 v_mfma_f32_16x16x32_bf16 v[176:179], a[216:219], a[144:147], v[176:179]
 v_mul_f32 v5, v5, v7
 v_cvt_pk_bf16_f32 v14, v6, v5
 v_mfma_f32_16x16x32_bf16 v[176:179], a[220:223], a[148:151], v[176:179]
 v_accvgpr_read_b32 v5, a59
 v_accvgpr_read_b32 v7, a242
 v_mfma_f32_16x16x32_bf16 v[180:183], a[220:223], a[156:159], v[180:183]
 v_lshlrev_b32 v6, 16, v5
 v_and_b32 v5, s26, v5
 v_mfma_f32_16x16x32_bf16 v[180:183], a[216:219], a[152:155], v[180:183]
 v_mul_f32 v6, v6, v7
 v_accvgpr_read_b32 v7, a243
 v_mfma_f32_16x16x32_bf16 v[184:187], a[216:219], a[160:163], v[184:187]
 v_mul_f32 v5, v5, v7
 v_cvt_pk_bf16_f32 v15, v6, v5
 v_mfma_f32_16x16x32_bf16 v[184:187], a[220:223], a[164:167], v[184:187]
 ds_write_b128 v18, v[12:15] offset:24576
 v_mfma_f32_16x16x32_bf16 v[188:191], a[220:223], a[172:175], v[188:191]
 ds_read_b128 v[48:51], v3 offset:24576
 ds_read_b128 v[80:83], v3 offset:25600
 v_mfma_f32_16x16x32_bf16 v[188:191], a[216:219], a[168:171], v[188:191]
 v_accvgpr_read_b32 v5, a28
 v_mfma_f32_16x16x32_bf16 v[192:195], a[216:219], a[176:179], v[192:195]
 v_lshlrev_b32 v6, 16, v5
 v_and_b32 v5, s26, v5
 v_mfma_f32_16x16x32_bf16 v[192:195], a[220:223], a[180:183], v[192:195]
 v_mul_f32 v6, v6, v44
 v_mul_f32 v5, v5, v45
 v_mfma_f32_16x16x32_bf16 v[196:199], a[220:223], a[188:191], v[196:199]
 v_cvt_pk_bf16_f32 v8, v6, v5
 v_accvgpr_read_b32 v5, a29
 v_mfma_f32_16x16x32_bf16 v[196:199], a[216:219], a[184:187], v[196:199]
 v_lshlrev_b32 v6, 16, v5
 v_and_b32 v5, s26, v5
 s_waitcnt vmcnt(6)
 v_mfma_f32_16x16x32_bf16 v[228:231], a[224:227], a[184:187], v[228:231]
 v_mul_f32 v6, v6, v46
 v_mul_f32 v5, v5, v47
 v_mfma_f32_16x16x32_bf16 v[228:231], a[228:231], a[188:191], v[228:231]
 v_cvt_pk_bf16_f32 v9, v6, v5
 s_waitcnt lgkmcnt(1)
 v_mfma_f32_16x16x32_bf16 v[224:227], a[228:231], a[180:183], v[224:227]
 s_add_u32 s3, s28, 196608
 buffer_store_dwordx4 v[48:51], v16, s[16:19], s3 offen nt
 v_mfma_f32_16x16x32_bf16 v[224:227], a[224:227], a[176:179], v[224:227]
 s_waitcnt lgkmcnt(0)
 s_add_u32 s3, s28, 212992
 v_mfma_f32_16x16x32_bf16 v[220:223], a[224:227], a[168:171], v[220:223]
 buffer_store_dwordx4 v[80:83], v16, s[16:19], s3 offen nt
 v_accvgpr_read_b32 v5, a30
 v_mfma_f32_16x16x32_bf16 v[220:223], a[228:231], a[172:175], v[220:223]
 v_lshlrev_b32 v6, 16, v5
 v_mfma_f32_16x16x32_bf16 v[216:219], a[228:231], a[164:167], v[216:219]
 v_and_b32 v5, s26, v5
 v_mul_f32 v6, v6, v76
 v_mfma_f32_16x16x32_bf16 v[216:219], a[224:227], a[160:163], v[216:219]
 v_mul_f32 v5, v5, v77
 v_cvt_pk_bf16_f32 v10, v6, v5
 v_mfma_f32_16x16x32_bf16 v[212:215], a[224:227], a[152:155], v[212:215]
 v_accvgpr_read_b32 v5, a31
 v_lshlrev_b32 v6, 16, v5
 v_mfma_f32_16x16x32_bf16 v[212:215], a[228:231], a[156:159], v[212:215]
 v_and_b32 v5, s26, v5
 v_mul_f32 v6, v6, v78
 v_mfma_f32_16x16x32_bf16 v[208:211], a[228:231], a[148:151], v[208:211]
 v_mul_f32 v5, v5, v79
 v_cvt_pk_bf16_f32 v11, v6, v5
 v_mfma_f32_16x16x32_bf16 v[208:211], a[224:227], a[144:147], v[208:211]
 ds_write_b128 v17, v[8:11] offset:28672
 v_mfma_f32_16x16x32_bf16 v[204:207], a[224:227], a[136:139], v[204:207]
 v_accvgpr_read_b32 v5, a60
 v_lshlrev_b32 v6, 16, v5
 v_mfma_f32_16x16x32_bf16 v[204:207], a[228:231], a[140:143], v[204:207]
 v_and_b32 v5, s26, v5
 v_mul_f32 v6, v6, v108
 v_mfma_f32_16x16x32_bf16 v[200:203], a[228:231], a[132:135], v[200:203]
 v_mul_f32 v5, v5, v109
 v_cvt_pk_bf16_f32 v12, v6, v5
 v_mfma_f32_16x16x32_bf16 v[200:203], a[224:227], a[128:131], v[200:203]
 v_accvgpr_read_b32 v5, a61
 v_lshlrev_b32 v6, 16, v5
 s_waitcnt vmcnt(6)
 v_mfma_f32_16x16x32_bf16 v[232:235], a[232:235], a[128:131], v[232:235]
 v_and_b32 v5, s26, v5
 v_mul_f32 v6, v6, v110
 v_mfma_f32_16x16x32_bf16 v[232:235], a[236:239], a[132:135], v[232:235]
 v_mul_f32 v5, v5, v111
 v_cvt_pk_bf16_f32 v13, v6, v5
 v_mfma_f32_16x16x32_bf16 v[236:239], a[236:239], a[140:143], v[236:239]
 v_accvgpr_read_b32 v5, a62
 v_accvgpr_read_b32 v7, a244
 v_mfma_f32_16x16x32_bf16 v[236:239], a[232:235], a[136:139], v[236:239]
 v_lshlrev_b32 v6, 16, v5
 v_and_b32 v5, s26, v5
 v_mfma_f32_16x16x32_bf16 v[240:243], a[232:235], a[144:147], v[240:243]
 v_mul_f32 v6, v6, v7
 v_accvgpr_read_b32 v7, a245
 v_mfma_f32_16x16x32_bf16 v[240:243], a[236:239], a[148:151], v[240:243]
 v_mul_f32 v5, v5, v7
 v_cvt_pk_bf16_f32 v14, v6, v5
 v_mfma_f32_16x16x32_bf16 v[244:247], a[236:239], a[156:159], v[244:247]
 v_accvgpr_read_b32 v5, a63
 v_accvgpr_read_b32 v7, a246
 v_mfma_f32_16x16x32_bf16 v[244:247], a[232:235], a[152:155], v[244:247]
 v_lshlrev_b32 v6, 16, v5
 v_and_b32 v5, s26, v5
 v_mfma_f32_16x16x32_bf16 v[248:251], a[232:235], a[160:163], v[248:251]
 v_mul_f32 v6, v6, v7
 v_accvgpr_read_b32 v7, a247
 v_mfma_f32_16x16x32_bf16 v[248:251], a[236:239], a[164:167], v[248:251]
 v_mul_f32 v5, v5, v7
 v_cvt_pk_bf16_f32 v15, v6, v5
 v_mfma_f32_16x16x32_bf16 v[252:255], a[236:239], a[172:175], v[252:255]
 ds_write_b128 v18, v[12:15] offset:28672
 v_mfma_f32_16x16x32_bf16 v[252:255], a[232:235], a[168:171], v[252:255]
 ds_read_b128 v[48:51], v3 offset:28672
 ds_read_b128 v[80:83], v3 offset:29696
 v_mfma_f32_16x16x32_bf16 a[248:251], a[232:235], a[176:179], a[248:251]
 s_waitcnt lgkmcnt(1)
 s_add_u32 s3, s28, 229376
 v_mfma_f32_16x16x32_bf16 a[248:251], a[236:239], a[180:183], a[248:251]
 buffer_store_dwordx4 v[48:51], v16, s[16:19], s3 offen nt
 s_waitcnt lgkmcnt(0)
 v_mfma_f32_16x16x32_bf16 a[252:255], a[236:239], a[188:191], a[252:255]
 s_add_u32 s3, s28, 245760
 buffer_store_dwordx4 v[80:83], v16, s[16:19], s3 offen nt
 v_mfma_f32_16x16x32_bf16 a[252:255], a[232:235], a[184:187], a[252:255]
 s_nop 7
 v_accvgpr_read_b32 v7, a64
 v_lshlrev_b32 v6, 16, v7
 v_and_b32 v7, s26, v7
 v_pk_mul_f32 v[6:7], v[6:7], v[136:137]
 v_cvt_pk_bf16_f32 v8, v6, v7
 v_accvgpr_read_b32 v7, a65
 v_lshlrev_b32 v6, 16, v7
 v_and_b32 v7, s26, v7
 v_pk_mul_f32 v[6:7], v[6:7], v[138:139]
 v_cvt_pk_bf16_f32 v9, v6, v7
 v_accvgpr_read_b32 v7, a66
 v_lshlrev_b32 v6, 16, v7
 v_and_b32 v7, s26, v7
 v_pk_mul_f32 v[6:7], v[6:7], v[168:169]
 v_cvt_pk_bf16_f32 v10, v6, v7
 v_accvgpr_read_b32 v7, a67
 v_lshlrev_b32 v6, 16, v7
 v_and_b32 v7, s26, v7
 v_pk_mul_f32 v[6:7], v[6:7], v[170:171]
 v_cvt_pk_bf16_f32 v11, v6, v7
 ds_write_b128 v17, v[8:11]
 v_accvgpr_read_b32 v7, a96
 v_lshlrev_b32 v6, 16, v7
 v_and_b32 v7, s26, v7
 v_pk_mul_f32 v[6:7], v[6:7], v[200:201]
 v_cvt_pk_bf16_f32 v12, v6, v7
 v_accvgpr_read_b32 v7, a97
 v_lshlrev_b32 v6, 16, v7
 v_and_b32 v7, s26, v7
 v_pk_mul_f32 v[6:7], v[6:7], v[202:203]
 v_cvt_pk_bf16_f32 v13, v6, v7
 v_accvgpr_read_b32 v7, a98
 v_lshlrev_b32 v6, 16, v7
 v_and_b32 v7, s26, v7
 v_pk_mul_f32 v[6:7], v[6:7], v[232:233]
 v_cvt_pk_bf16_f32 v14, v6, v7
 v_accvgpr_read_b32 v7, a99
 v_lshlrev_b32 v6, 16, v7
 v_and_b32 v7, s26, v7
 v_pk_mul_f32 v[6:7], v[6:7], v[234:235]
 v_cvt_pk_bf16_f32 v15, v6, v7
 ds_write_b128 v18, v[12:15]
 ds_read_b128 v[48:51], v3
 ds_read_b128 v[80:83], v3 offset:1024
 v_accvgpr_read_b32 v7, a68
 v_lshlrev_b32 v6, 16, v7
 v_and_b32 v7, s26, v7
 v_pk_mul_f32 v[6:7], v[6:7], v[140:141]
 v_cvt_pk_bf16_f32 v8, v6, v7
 v_accvgpr_read_b32 v7, a69
 v_lshlrev_b32 v6, 16, v7
 v_and_b32 v7, s26, v7
 v_pk_mul_f32 v[6:7], v[6:7], v[142:143]
 v_cvt_pk_bf16_f32 v9, v6, v7
 v_accvgpr_read_b32 v7, a70
 v_lshlrev_b32 v6, 16, v7
 s_waitcnt lgkmcnt(1)
 s_add_u32 s3, s28, 0
 buffer_store_dwordx4 v[48:51], v16, s[16:19], s3 offen offset:128 nt
 s_waitcnt lgkmcnt(0)
 s_add_u32 s3, s28, 16384
 buffer_store_dwordx4 v[80:83], v16, s[16:19], s3 offen offset:128 nt
 v_and_b32 v7, s26, v7
 v_pk_mul_f32 v[6:7], v[6:7], v[172:173]
 v_cvt_pk_bf16_f32 v10, v6, v7
 v_accvgpr_read_b32 v7, a71
 v_lshlrev_b32 v6, 16, v7
 v_and_b32 v7, s26, v7
 v_pk_mul_f32 v[6:7], v[6:7], v[174:175]
 v_cvt_pk_bf16_f32 v11, v6, v7
 ds_write_b128 v17, v[8:11] offset:4096
 v_accvgpr_read_b32 v7, a100
 v_lshlrev_b32 v6, 16, v7
 v_and_b32 v7, s26, v7
 v_pk_mul_f32 v[6:7], v[6:7], v[204:205]
 v_cvt_pk_bf16_f32 v12, v6, v7
 v_accvgpr_read_b32 v7, a101
 v_lshlrev_b32 v6, 16, v7
 v_and_b32 v7, s26, v7
 v_pk_mul_f32 v[6:7], v[6:7], v[206:207]
 v_cvt_pk_bf16_f32 v13, v6, v7
 v_accvgpr_read_b32 v7, a102
 v_lshlrev_b32 v6, 16, v7
 v_and_b32 v7, s26, v7
 v_pk_mul_f32 v[6:7], v[6:7], v[236:237]
 v_cvt_pk_bf16_f32 v14, v6, v7
 v_accvgpr_read_b32 v7, a103
 v_lshlrev_b32 v6, 16, v7
 v_and_b32 v7, s26, v7
 v_pk_mul_f32 v[6:7], v[6:7], v[238:239]
 v_cvt_pk_bf16_f32 v15, v6, v7
 ds_write_b128 v18, v[12:15] offset:4096
 ds_read_b128 v[48:51], v3 offset:4096
 ds_read_b128 v[80:83], v3 offset:5120
 v_accvgpr_read_b32 v7, a72
 v_lshlrev_b32 v6, 16, v7
 v_and_b32 v7, s26, v7
 v_pk_mul_f32 v[6:7], v[6:7], v[144:145]
 v_cvt_pk_bf16_f32 v8, v6, v7
 v_accvgpr_read_b32 v7, a73
 v_lshlrev_b32 v6, 16, v7
 v_and_b32 v7, s26, v7
 v_pk_mul_f32 v[6:7], v[6:7], v[146:147]
 v_cvt_pk_bf16_f32 v9, v6, v7
 v_accvgpr_read_b32 v7, a74
 v_lshlrev_b32 v6, 16, v7
 s_waitcnt lgkmcnt(1)
 s_add_u32 s3, s28, 32768
 buffer_store_dwordx4 v[48:51], v16, s[16:19], s3 offen offset:128 nt
 s_waitcnt lgkmcnt(0)
 s_add_u32 s3, s28, 49152
 buffer_store_dwordx4 v[80:83], v16, s[16:19], s3 offen offset:128 nt
 v_and_b32 v7, s26, v7
 v_pk_mul_f32 v[6:7], v[6:7], v[176:177]
 v_cvt_pk_bf16_f32 v10, v6, v7
 v_accvgpr_read_b32 v7, a75
 v_lshlrev_b32 v6, 16, v7
 v_and_b32 v7, s26, v7
 v_pk_mul_f32 v[6:7], v[6:7], v[178:179]
 v_cvt_pk_bf16_f32 v11, v6, v7
 ds_write_b128 v17, v[8:11] offset:8192
 v_accvgpr_read_b32 v7, a104
 v_lshlrev_b32 v6, 16, v7
 v_and_b32 v7, s26, v7
 v_pk_mul_f32 v[6:7], v[6:7], v[208:209]
 v_cvt_pk_bf16_f32 v12, v6, v7
 v_accvgpr_read_b32 v7, a105
 v_lshlrev_b32 v6, 16, v7
 v_and_b32 v7, s26, v7
 v_pk_mul_f32 v[6:7], v[6:7], v[210:211]
 v_cvt_pk_bf16_f32 v13, v6, v7
 v_accvgpr_read_b32 v7, a106
 v_lshlrev_b32 v6, 16, v7
 v_and_b32 v7, s26, v7
 v_pk_mul_f32 v[6:7], v[6:7], v[240:241]
 v_cvt_pk_bf16_f32 v14, v6, v7
 v_accvgpr_read_b32 v7, a107
 v_lshlrev_b32 v6, 16, v7
 v_and_b32 v7, s26, v7
 v_pk_mul_f32 v[6:7], v[6:7], v[242:243]
 v_cvt_pk_bf16_f32 v15, v6, v7
 ds_write_b128 v18, v[12:15] offset:8192
 ds_read_b128 v[48:51], v3 offset:8192
 ds_read_b128 v[80:83], v3 offset:9216
 v_accvgpr_read_b32 v7, a76
 v_lshlrev_b32 v6, 16, v7
 v_and_b32 v7, s26, v7
 v_pk_mul_f32 v[6:7], v[6:7], v[148:149]
 v_cvt_pk_bf16_f32 v8, v6, v7
 v_accvgpr_read_b32 v7, a77
 v_lshlrev_b32 v6, 16, v7
 v_and_b32 v7, s26, v7
 v_pk_mul_f32 v[6:7], v[6:7], v[150:151]
 v_cvt_pk_bf16_f32 v9, v6, v7
 v_accvgpr_read_b32 v7, a78
 v_lshlrev_b32 v6, 16, v7
 s_waitcnt lgkmcnt(1)
 s_add_u32 s3, s28, 65536
 buffer_store_dwordx4 v[48:51], v16, s[16:19], s3 offen offset:128 nt
 s_waitcnt lgkmcnt(0)
 s_add_u32 s3, s28, 81920
 buffer_store_dwordx4 v[80:83], v16, s[16:19], s3 offen offset:128 nt
 v_and_b32 v7, s26, v7
 v_pk_mul_f32 v[6:7], v[6:7], v[180:181]
 v_cvt_pk_bf16_f32 v10, v6, v7
 v_accvgpr_read_b32 v7, a79
 v_lshlrev_b32 v6, 16, v7
 v_and_b32 v7, s26, v7
 v_pk_mul_f32 v[6:7], v[6:7], v[182:183]
 v_cvt_pk_bf16_f32 v11, v6, v7
 ds_write_b128 v17, v[8:11] offset:12288
 v_accvgpr_read_b32 v7, a108
 v_lshlrev_b32 v6, 16, v7
 v_and_b32 v7, s26, v7
 v_pk_mul_f32 v[6:7], v[6:7], v[212:213]
 v_cvt_pk_bf16_f32 v12, v6, v7
 v_accvgpr_read_b32 v7, a109
 v_lshlrev_b32 v6, 16, v7
 v_and_b32 v7, s26, v7
 v_pk_mul_f32 v[6:7], v[6:7], v[214:215]
 v_cvt_pk_bf16_f32 v13, v6, v7
 v_accvgpr_read_b32 v7, a110
 v_lshlrev_b32 v6, 16, v7
 v_and_b32 v7, s26, v7
 v_pk_mul_f32 v[6:7], v[6:7], v[244:245]
 v_cvt_pk_bf16_f32 v14, v6, v7
 v_accvgpr_read_b32 v7, a111
 v_lshlrev_b32 v6, 16, v7
 v_and_b32 v7, s26, v7
 v_pk_mul_f32 v[6:7], v[6:7], v[246:247]
 v_cvt_pk_bf16_f32 v15, v6, v7
 ds_write_b128 v18, v[12:15] offset:12288
 ds_read_b128 v[48:51], v3 offset:12288
 ds_read_b128 v[80:83], v3 offset:13312
 v_accvgpr_read_b32 v7, a80
 v_lshlrev_b32 v6, 16, v7
 v_and_b32 v7, s26, v7
 v_pk_mul_f32 v[6:7], v[6:7], v[152:153]
 v_cvt_pk_bf16_f32 v8, v6, v7
 v_accvgpr_read_b32 v7, a81
 v_lshlrev_b32 v6, 16, v7
 v_and_b32 v7, s26, v7
 v_pk_mul_f32 v[6:7], v[6:7], v[154:155]
 v_cvt_pk_bf16_f32 v9, v6, v7
 v_accvgpr_read_b32 v7, a82
 v_lshlrev_b32 v6, 16, v7
 s_waitcnt lgkmcnt(1)
 s_add_u32 s3, s28, 98304
 buffer_store_dwordx4 v[48:51], v16, s[16:19], s3 offen offset:128 nt
 s_waitcnt lgkmcnt(0)
 s_add_u32 s3, s28, 114688
 buffer_store_dwordx4 v[80:83], v16, s[16:19], s3 offen offset:128 nt
 v_and_b32 v7, s26, v7
 v_pk_mul_f32 v[6:7], v[6:7], v[184:185]
 v_cvt_pk_bf16_f32 v10, v6, v7
 v_accvgpr_read_b32 v7, a83
 v_lshlrev_b32 v6, 16, v7
 v_and_b32 v7, s26, v7
 v_pk_mul_f32 v[6:7], v[6:7], v[186:187]
 v_cvt_pk_bf16_f32 v11, v6, v7
 ds_write_b128 v17, v[8:11] offset:16384
 v_accvgpr_read_b32 v7, a112
 v_lshlrev_b32 v6, 16, v7
 v_and_b32 v7, s26, v7
 v_pk_mul_f32 v[6:7], v[6:7], v[216:217]
 v_cvt_pk_bf16_f32 v12, v6, v7
 v_accvgpr_read_b32 v7, a113
 v_lshlrev_b32 v6, 16, v7
 v_and_b32 v7, s26, v7
 v_pk_mul_f32 v[6:7], v[6:7], v[218:219]
 v_cvt_pk_bf16_f32 v13, v6, v7
 v_accvgpr_read_b32 v7, a114
 v_lshlrev_b32 v6, 16, v7
 v_and_b32 v7, s26, v7
 v_pk_mul_f32 v[6:7], v[6:7], v[248:249]
 v_cvt_pk_bf16_f32 v14, v6, v7
 v_accvgpr_read_b32 v7, a115
 v_lshlrev_b32 v6, 16, v7
 v_and_b32 v7, s26, v7
 v_pk_mul_f32 v[6:7], v[6:7], v[250:251]
 v_cvt_pk_bf16_f32 v15, v6, v7
 ds_write_b128 v18, v[12:15] offset:16384
 ds_read_b128 v[48:51], v3 offset:16384
 ds_read_b128 v[80:83], v3 offset:17408
 v_accvgpr_read_b32 v7, a84
 v_lshlrev_b32 v6, 16, v7
 v_and_b32 v7, s26, v7
 v_pk_mul_f32 v[6:7], v[6:7], v[156:157]
 v_cvt_pk_bf16_f32 v8, v6, v7
 v_accvgpr_read_b32 v7, a85
 v_lshlrev_b32 v6, 16, v7
 v_and_b32 v7, s26, v7
 v_pk_mul_f32 v[6:7], v[6:7], v[158:159]
 v_cvt_pk_bf16_f32 v9, v6, v7
 v_accvgpr_read_b32 v7, a86
 v_lshlrev_b32 v6, 16, v7
 s_waitcnt lgkmcnt(1)
 s_add_u32 s3, s28, 131072
 buffer_store_dwordx4 v[48:51], v16, s[16:19], s3 offen offset:128 nt
 s_waitcnt lgkmcnt(0)
 s_add_u32 s3, s28, 147456
 buffer_store_dwordx4 v[80:83], v16, s[16:19], s3 offen offset:128 nt
 v_and_b32 v7, s26, v7
 v_pk_mul_f32 v[6:7], v[6:7], v[188:189]
 v_cvt_pk_bf16_f32 v10, v6, v7
 v_accvgpr_read_b32 v7, a87
 v_lshlrev_b32 v6, 16, v7
 v_and_b32 v7, s26, v7
 v_pk_mul_f32 v[6:7], v[6:7], v[190:191]
 v_cvt_pk_bf16_f32 v11, v6, v7
 ds_write_b128 v17, v[8:11] offset:20480
 v_accvgpr_read_b32 v7, a116
 v_lshlrev_b32 v6, 16, v7
 v_and_b32 v7, s26, v7
 v_pk_mul_f32 v[6:7], v[6:7], v[220:221]
 v_cvt_pk_bf16_f32 v12, v6, v7
 v_accvgpr_read_b32 v7, a117
 v_lshlrev_b32 v6, 16, v7
 v_and_b32 v7, s26, v7
 v_pk_mul_f32 v[6:7], v[6:7], v[222:223]
 v_cvt_pk_bf16_f32 v13, v6, v7
 v_accvgpr_read_b32 v7, a118
 v_lshlrev_b32 v6, 16, v7
 v_and_b32 v7, s26, v7
 v_pk_mul_f32 v[6:7], v[6:7], v[252:253]
 v_cvt_pk_bf16_f32 v14, v6, v7
 v_accvgpr_read_b32 v7, a119
 v_lshlrev_b32 v6, 16, v7
 v_and_b32 v7, s26, v7
 v_pk_mul_f32 v[6:7], v[6:7], v[254:255]
 v_cvt_pk_bf16_f32 v15, v6, v7
 ds_write_b128 v18, v[12:15] offset:20480
 ds_read_b128 v[48:51], v3 offset:20480
 ds_read_b128 v[80:83], v3 offset:21504
 v_accvgpr_read_b32 v7, a88
 v_lshlrev_b32 v6, 16, v7
 v_and_b32 v7, s26, v7
 v_pk_mul_f32 v[6:7], v[6:7], v[160:161]
 v_cvt_pk_bf16_f32 v8, v6, v7
 v_accvgpr_read_b32 v7, a89
 v_lshlrev_b32 v6, 16, v7
 v_and_b32 v7, s26, v7
 v_pk_mul_f32 v[6:7], v[6:7], v[162:163]
 v_cvt_pk_bf16_f32 v9, v6, v7
 v_accvgpr_read_b32 v7, a90
 v_lshlrev_b32 v6, 16, v7
 s_waitcnt lgkmcnt(1)
 s_add_u32 s3, s28, 163840
 buffer_store_dwordx4 v[48:51], v16, s[16:19], s3 offen offset:128 nt
 s_waitcnt lgkmcnt(0)
 s_add_u32 s3, s28, 180224
 buffer_store_dwordx4 v[80:83], v16, s[16:19], s3 offen offset:128 nt
 v_and_b32 v7, s26, v7
 v_pk_mul_f32 v[6:7], v[6:7], v[192:193]
 v_cvt_pk_bf16_f32 v10, v6, v7
 v_accvgpr_read_b32 v7, a91
 v_lshlrev_b32 v6, 16, v7
 v_and_b32 v7, s26, v7
 v_pk_mul_f32 v[6:7], v[6:7], v[194:195]
 v_cvt_pk_bf16_f32 v11, v6, v7
 ds_write_b128 v17, v[8:11] offset:24576
 v_accvgpr_read_b32 v7, a120
 v_lshlrev_b32 v6, 16, v7
 v_and_b32 v7, s26, v7
 v_pk_mul_f32 v[6:7], v[6:7], v[224:225]
 v_cvt_pk_bf16_f32 v12, v6, v7
 v_accvgpr_read_b32 v7, a121
 v_lshlrev_b32 v6, 16, v7
 v_and_b32 v7, s26, v7
 v_pk_mul_f32 v[6:7], v[6:7], v[226:227]
 v_cvt_pk_bf16_f32 v13, v6, v7
 v_accvgpr_read_b32 v7, a122
 v_accvgpr_read_b32 v112, a248
 v_accvgpr_read_b32 v113, a249
 v_lshlrev_b32 v6, 16, v7
 v_and_b32 v7, s26, v7
 v_pk_mul_f32 v[6:7], v[6:7], v[112:113]
 v_cvt_pk_bf16_f32 v14, v6, v7
 v_accvgpr_read_b32 v7, a123
 v_accvgpr_read_b32 v112, a250
 v_accvgpr_read_b32 v113, a251
 v_lshlrev_b32 v6, 16, v7
 v_and_b32 v7, s26, v7
 v_pk_mul_f32 v[6:7], v[6:7], v[112:113]
 v_cvt_pk_bf16_f32 v15, v6, v7
 ds_write_b128 v18, v[12:15] offset:24576
 ds_read_b128 v[48:51], v3 offset:24576
 ds_read_b128 v[80:83], v3 offset:25600
 v_accvgpr_read_b32 v7, a92
 v_lshlrev_b32 v6, 16, v7
 v_and_b32 v7, s26, v7
 v_pk_mul_f32 v[6:7], v[6:7], v[164:165]
 v_cvt_pk_bf16_f32 v8, v6, v7
 v_accvgpr_read_b32 v7, a93
 v_lshlrev_b32 v6, 16, v7
 v_and_b32 v7, s26, v7
 v_pk_mul_f32 v[6:7], v[6:7], v[166:167]
 v_cvt_pk_bf16_f32 v9, v6, v7
 v_accvgpr_read_b32 v7, a94
 v_lshlrev_b32 v6, 16, v7
 s_waitcnt lgkmcnt(1)
 s_add_u32 s3, s28, 196608
 buffer_store_dwordx4 v[48:51], v16, s[16:19], s3 offen offset:128 nt
 s_waitcnt lgkmcnt(0)
 s_add_u32 s3, s28, 212992
 buffer_store_dwordx4 v[80:83], v16, s[16:19], s3 offen offset:128 nt
 v_and_b32 v7, s26, v7
 v_pk_mul_f32 v[6:7], v[6:7], v[196:197]
 v_cvt_pk_bf16_f32 v10, v6, v7
 v_accvgpr_read_b32 v7, a95
 v_lshlrev_b32 v6, 16, v7
 v_and_b32 v7, s26, v7
 v_pk_mul_f32 v[6:7], v[6:7], v[198:199]
 v_cvt_pk_bf16_f32 v11, v6, v7
 ds_write_b128 v17, v[8:11] offset:28672
 v_accvgpr_read_b32 v7, a124
 v_lshlrev_b32 v6, 16, v7
 v_and_b32 v7, s26, v7
 v_pk_mul_f32 v[6:7], v[6:7], v[228:229]
 v_cvt_pk_bf16_f32 v12, v6, v7
 v_accvgpr_read_b32 v7, a125
 v_lshlrev_b32 v6, 16, v7
 v_and_b32 v7, s26, v7
 v_pk_mul_f32 v[6:7], v[6:7], v[230:231]
 v_cvt_pk_bf16_f32 v13, v6, v7
 v_accvgpr_read_b32 v7, a126
 v_accvgpr_read_b32 v112, a252
 v_accvgpr_read_b32 v113, a253
 v_lshlrev_b32 v6, 16, v7
 v_and_b32 v7, s26, v7
 v_pk_mul_f32 v[6:7], v[6:7], v[112:113]
 v_cvt_pk_bf16_f32 v14, v6, v7
 v_accvgpr_read_b32 v7, a127
 v_accvgpr_read_b32 v112, a254
 v_accvgpr_read_b32 v113, a255
 v_lshlrev_b32 v6, 16, v7
 v_and_b32 v7, s26, v7
 v_pk_mul_f32 v[6:7], v[6:7], v[112:113]
 v_cvt_pk_bf16_f32 v15, v6, v7
 ds_write_b128 v18, v[12:15] offset:28672
 ds_read_b128 v[48:51], v3 offset:28672
 ds_read_b128 v[80:83], v3 offset:29696
 s_waitcnt lgkmcnt(1)
 s_add_u32 s3, s28, 229376
 buffer_store_dwordx4 v[48:51], v16, s[16:19], s3 offen offset:128 nt
 s_waitcnt lgkmcnt(0)
 s_add_u32 s3, s28, 245760
 buffer_store_dwordx4 v[80:83], v16, s[16:19], s3 offen offset:128 nt
Lend:
 s_endpgm
Lspin_pro:
 s_add_u32 s53, s53, 1
 v_lshlrev_b32 v4, 2, v1
 v_and_b32 v4, 192, v4
 buffer_load_dword v4, v4, s[44:47], 0 offen sc1
 s_cmp_ge_u32 s53, 0x100000
 s_cbranch_scc1 Lgiveup_pro
 s_waitcnt vmcnt(0)
 v_cmp_gt_i32 vcc, s27, v4
 s_cbranch_vccnz Lspin_pro
Lgiveup_pro:
 s_waitcnt vmcnt(0)
 s_branch Lok_pro
Lspin_pa:
 s_add_u32 s53, s53, 1
 buffer_load_dword v4, off, s[64:67], 0 sc1
 s_cmp_ge_u32 s53, 0x100000
 s_cbranch_scc1 Lgiveup_pa
 s_waitcnt vmcnt(0)
 v_cmp_gt_i32 vcc, s55, v4
 s_cbranch_vccnz Lspin_pa
Lgiveup_pa:
 s_waitcnt vmcnt(0)
 s_branch Lok_pa
Lgat0:
 v_and_b32 v5, 0xf0, v1
 v_lshrrev_b32 v6, 4, v1
 v_and_b32 v6, 0x30, v6
 v_lshl_add_u32 v6, v5, 7, v6
 s_branch Lgatr0
Lspin_pb:
 s_add_u32 s53, s53, 1
 buffer_load_dword v4, off, s[64:67], 0 sc1
 s_cmp_ge_u32 s53, 0x100000
 s_cbranch_scc1 Lgiveup_pb
 s_waitcnt vmcnt(0)
 v_cmp_gt_i32 vcc, s55, v4
 s_cbranch_vccnz Lspin_pb
Lgiveup_pb:
 s_waitcnt vmcnt(0)
 s_branch Lok_pb
Lgat1:
 v_and_b32 v5, 0xf0, v1
 v_lshrrev_b32 v6, 4, v1
 v_and_b32 v6, 0x30, v6
 v_lshl_add_u32 v6, v5, 7, v6
 s_branch Lgatr1
Lspin_w:
 s_add_u32 s53, s53, 1
 v_lshlrev_b32 v4, 2, v1
 v_and_b32 v4, 192, v4
 buffer_load_dword v4, v4, s[44:47], 0 offen sc1
 s_cmp_ge_u32 s53, 0x100000
 s_cbranch_scc1 Lgiveup_w
 s_waitcnt vmcnt(0)
 v_cmp_gt_i32 vcc, s27, v4
 s_cbranch_vccnz Lspin_w
Lgiveup_w:
 s_waitcnt vmcnt(0)
 s_branch Lok_w
.section .rodata,"a"
.p2align 6
.amdhsa_kernel standalone__cross_network_dcn__recsys_kernel
  .amdhsa_next_free_vgpr 512
  .amdhsa_next_free_sgpr 102
  .amdhsa_accum_offset 256
  .amdhsa_group_segment_fixed_size 0
  .amdhsa_kernarg_size 48
  .amdhsa_user_sgpr_count 2
  .amdhsa_user_sgpr_kernarg_segment_ptr 1
  .amdhsa_system_sgpr_workgroup_id_x 1
  .amdhsa_float_denorm_mode_32 3
.end_amdhsa_kernel
```

```asm
; @launch grid=(256,1,1) block=(256,1,1) lds=151552
.amdgcn_target "amdgcn-amd-amdhsa--gfx950"
.text
.globl standalone__cross_network_dcn__recsys_kernel
.p2align 8
.type standalone__cross_network_dcn__recsys_kernel,@function
standalone__cross_network_dcn__recsys_kernel:
 s_cmp_ge_u32 s2, 256
 s_cbranch_scc1 Lend
 s_load_dwordx4 s[56:59], s[0:1], 0
 s_load_dwordx4 s[60:63], s[0:1], 16
 s_load_dwordx4 s[64:67], s[0:1], 32
 v_lshrrev_b32 v9, 6, v0
 v_and_b32 v10, 63, v0
 v_readfirstlane_b32 s54, v9
 v_lshlrev_b32 v1, 4, v10
 s_getpc_b64 s[4:5]
Lpc:
 v_lshlrev_b32 v11, 6, v0
 s_bfe_u32 s3, s2, 0x20003
 s_lshl_b32 s3, s3, 14
 v_add_u32 v11, s3, v11
 v_min_u32 v12, Lend-Lpc, v11
 global_load_dword v60, v12, s[4:5]
 v_add_u32 v11, 16384, v11
 v_lshrrev_b32 v11, 7, v0
 v_and_b32 v12, 127, v0
 v_lshlrev_b32 v12, 3, v12
 v_lshl_add_u32 v30, v11, 11, v12
 v_lshlrev_b32 v31, 4, v0
 v_add_u32 v31, 131072, v31
 v_add_u32 v2, 65536, v1
 v_lshl_add_u32 v3, v9, 15, v1
 v_lshl_add_u32 v0, v9, 18, v1
 s_and_b32 s7, s2, 1
 s_lshr_b32 s28, s2, 1
 s_lshl_b32 s28, s28, 18
 s_lshl_b32 s6, s7, 10
 s_add_u32 s28, s28, s6
 s_lshl_b32 s6, s54, 8
 s_add_u32 s28, s28, s6
 s_mov_b32 s26, 0xffff0000
 s_lshl_b32 s24, s7, 20
 s_mov_b32 s25, 0
 s_mov_b32 s53, 0
 s_mov_b32 s31, -1
 s_mov_b32 s27, 64
 s_mov_b32 s55, -1
 s_lshl_b32 s50, s54, 15
 s_lshl_b32 s29, s2, 17
 s_add_u32 s29, s29, 33554432
 s_xor_b32 s30, s29, 131072
 s_lshr_b32 s4, s2, 3
 s_and_b32 s5, s2, 7
 s_lshl_b32 s48, s4, 16
 s_lshl_b32 s6, s5, 8
 s_add_u32 s48, s48, s6
 s_lshl_b32 s6, s54, 6
 s_add_u32 s48, s48, s6
 s_lshl_b32 s49, s5, 18
 s_and_b32 s6, s4, 1
 s_lshl_b32 s6, s6, 10
 s_add_u32 s49, s49, s6
 s_lshr_b32 s6, s4, 4
 s_lshr_b32 s5, s5, 2
 s_xor_b32 s5, s5, s6
 s_bfe_u32 s6, s4, 0x10001
 s_lshl_b32 s3, s5, 1
 s_add_u32 s3, s3, s6
 s_lshl_b32 s3, s3, 16
 s_add_u32 s49, s49, s3
 s_bfe_u32 s4, s4, 0x20002
 s_xor_b32 s5, s5, s6
 s_lshr_b32 s3, s54, 1
 s_lshl_b32 s3, s3, 4
 s_lshl_b32 s6, s4, 2
 s_add_u32 s3, s3, s6
 s_and_b32 s6, s54, 1
 s_lshl_b32 s6, s6, 1
 s_add_u32 s3, s3, s6
 s_lshl_b32 s4, s4, 3
 s_lshl_b32 s6, s54, 1
 s_add_u32 s4, s4, s6
 s_cmp_eq_u32 s5, 0
 s_cselect_b32 s3, s3, s4
 s_lshl_b32 s3, s3, 11
 s_add_u32 s49, s49, s3
 s_lshl_b32 s52, s54, 11
 s_add_u32 s52, s52, 143360
 s_lshl_b32 s51, s54, 9
 s_add_u32 s51, s51, 131072
 s_waitcnt lgkmcnt(0)
 s_mov_b32 s40, s58
 s_mov_b32 s41, s59
 s_mov_b32 s42, 0xc00000
 s_mov_b32 s43, 0x20000
 v_lshrrev_b32 v5, 6, v1
 v_and_b32 v6, 48, v1
 v_lshl_add_u32 v5, v5, 11, v6
 s_mov_b32 m0, s52
 s_add_u32 s3, s48, 31744
 buffer_load_dwordx4 v5, s[40:43], s48 offen lds
 buffer_load_dwordx4 v5, s[40:43], s3 offen offset:1024 lds
 s_add_u32 s48, s48, 2097152
 s_mov_b32 s20, s60
 s_mov_b32 s21, s61
 s_mov_b32 s22, 0x3000
 s_mov_b32 s23, 0x20000
 s_lshl_b32 s3, s7, 10
 buffer_load_dwordx2 v[32:33], v30, s[20:23], s3 offen
 s_add_u32 s3, s3, 4096
 buffer_load_dwordx2 v[34:35], v30, s[20:23], s3 offen
 s_add_u32 s3, s3, 4096
 buffer_load_dwordx2 v[36:37], v30, s[20:23], s3 offen
 s_add_u32 s3, s3, 4096
 s_mov_b32 s8, s56
 s_mov_b32 s9, s57
 s_mov_b32 s10, 0x2000000
 s_mov_b32 s11, 0x20000
 s_mov_b32 s16, s62
 s_mov_b32 s17, s63
 s_mov_b32 s18, 0x2000000
 s_mov_b32 s19, 0x20000
 s_mov_b32 s12, s66
 s_mov_b32 s13, s67
 s_mov_b32 s14, 0xc00000
 s_mov_b32 s15, 0x20000
 s_mov_b32 s32, s66
 s_mov_b32 s33, s67
 s_mov_b32 s34, 0x10000000
 s_mov_b32 s35, 0x20000
 s_mov_b32 s44, s64
 s_mov_b32 s45, s65
 s_mov_b32 s46, 0x100
 s_mov_b32 s47, 0x20000
 s_add_u32 s24, s24, 4096
 s_add_u32 s70, s66, s24
 s_addc_u32 s71, s67, 0
 s_sub_u32 s24, s24, 4096
 s_and_b32 s3, s2, 3
 s_lshl_b32 s3, s3, 6
 s_add_u32 s56, s44, s3
 s_addc_u32 s57, s45, 0
 s_mov_b32 s58, 0x4
 s_mov_b32 s59, 0x20000
 s_lshl_b32 s3, s2, 2
 s_add_u32 s3, s3, s54
 s_lshl_b32 s3, s3, 7
 s_add_u32 s3, s3, 15728640
 s_add_u32 s60, s32, s3
 s_addc_u32 s61, s33, 0
 s_mov_b32 s62, 0x4
 s_mov_b32 s63, 0x20000
 s_xor_b32 s3, s3, 512
 s_add_u32 s64, s32, s3
 s_addc_u32 s65, s33, 0
 s_mov_b32 s66, 0x4
 s_mov_b32 s67, 0x20000
 v_mov_b32 v7, 0
 buffer_store_dword v7, v1, s[60:63], 0 offen sc1
 v_lshrrev_b32 v5, 7, v1
 v_lshlrev_b32 v6, 4, v5
 v_xor_b32 v6, v6, v1
 v_and_b32 v6, 112, v6
 v_lshl_add_u32 v20, v5, 11, v6
 v_lshrrev_b32 v5, 4, v1
 v_and_b32 v5, 48, v5
 v_xor_b32 v5, v5, v1
 v_and_b32 v5, 112, v5
 v_and_b32 v6, 240, v1
 v_lshl_add_u32 v5, v6, 3, v5
 v_add_u32 v21, s50, v5
 v_xor_b32 v22, 64, v21
 s_add_u32 m0, s50, 0
 s_add_u32 s3, s28, 0
 buffer_load_dwordx4 v20, s[8:11], s3 offen lds
 s_add_u32 m0, s50, 1024
 s_add_u32 s3, s28, 16384
 buffer_load_dwordx4 v20, s[8:11], s3 offen lds
 s_add_u32 m0, s50, 4096
 s_add_u32 s3, s28, 32768
 buffer_load_dwordx4 v20, s[8:11], s3 offen lds
 s_add_u32 m0, s50, 5120
 s_add_u32 s3, s28, 49152
 buffer_load_dwordx4 v20, s[8:11], s3 offen lds
 v_mov_b32 v64, 1.0
 v_mov_b32 v65, 1.0
 v_mov_b32 v66, 1.0
 v_mov_b32 v67, 1.0
 v_mov_b32 v68, 1.0
 v_mov_b32 v69, 1.0
 v_mov_b32 v70, 1.0
 v_mov_b32 v71, 1.0
 v_mov_b32 v72, 1.0
 v_mov_b32 v73, 1.0
 v_mov_b32 v74, 1.0
 v_mov_b32 v75, 1.0
 v_mov_b32 v76, 1.0
 v_mov_b32 v77, 1.0
 v_mov_b32 v78, 1.0
 v_mov_b32 v79, 1.0
 v_mov_b32 v80, 1.0
 v_mov_b32 v81, 1.0
 v_mov_b32 v82, 1.0
 v_mov_b32 v83, 1.0
 v_mov_b32 v84, 1.0
 v_mov_b32 v85, 1.0
 v_mov_b32 v86, 1.0
 v_mov_b32 v87, 1.0
 v_mov_b32 v88, 1.0
 v_mov_b32 v89, 1.0
 v_mov_b32 v90, 1.0
 v_mov_b32 v91, 1.0
 v_mov_b32 v92, 1.0
 v_mov_b32 v93, 1.0
 v_mov_b32 v94, 1.0
 v_mov_b32 v95, 1.0
 v_mov_b32 v96, 1.0
 v_mov_b32 v97, 1.0
 v_mov_b32 v98, 1.0
 v_mov_b32 v99, 1.0
 v_mov_b32 v100, 1.0
 v_mov_b32 v101, 1.0
 v_mov_b32 v102, 1.0
 v_mov_b32 v103, 1.0
 v_mov_b32 v104, 1.0
 v_mov_b32 v105, 1.0
 v_mov_b32 v106, 1.0
 v_mov_b32 v107, 1.0
 v_mov_b32 v108, 1.0
 v_mov_b32 v109, 1.0
 v_mov_b32 v110, 1.0
 v_mov_b32 v111, 1.0
 v_mov_b32 v112, 1.0
 v_mov_b32 v113, 1.0
 v_mov_b32 v114, 1.0
 v_mov_b32 v115, 1.0
 v_mov_b32 v116, 1.0
 v_mov_b32 v117, 1.0
 v_mov_b32 v118, 1.0
 v_mov_b32 v119, 1.0
 v_mov_b32 v120, 1.0
 v_mov_b32 v121, 1.0
 v_mov_b32 v122, 1.0
 v_mov_b32 v123, 1.0
 v_mov_b32 v124, 1.0
 v_mov_b32 v125, 1.0
 v_mov_b32 v126, 1.0
 v_mov_b32 v127, 1.0
 v_mov_b32 v128, 1.0
 v_mov_b32 v129, 1.0
 v_mov_b32 v130, 1.0
 v_mov_b32 v131, 1.0
 v_mov_b32 v132, 1.0
 v_mov_b32 v133, 1.0
 v_mov_b32 v134, 1.0
 v_mov_b32 v135, 1.0
 v_accvgpr_write_b32 a240, 1.0
 v_accvgpr_write_b32 a241, 1.0
 v_accvgpr_write_b32 a242, 1.0
 v_accvgpr_write_b32 a243, 1.0
 v_accvgpr_write_b32 a244, 1.0
 v_accvgpr_write_b32 a245, 1.0
 v_accvgpr_write_b32 a246, 1.0
 v_accvgpr_write_b32 a247, 1.0
 v_mov_b32 v216, 1.0
 v_mov_b32 v217, 1.0
 v_mov_b32 v218, 1.0
 v_mov_b32 v219, 1.0
 v_mov_b32 v220, 1.0
 v_mov_b32 v221, 1.0
 v_mov_b32 v222, 1.0
 v_mov_b32 v223, 1.0
 v_mov_b32 v224, 1.0
 v_mov_b32 v225, 1.0
 v_mov_b32 v226, 1.0
 v_mov_b32 v227, 1.0
 v_mov_b32 v228, 1.0
 v_mov_b32 v229, 1.0
 v_mov_b32 v230, 1.0
 v_mov_b32 v231, 1.0
 v_mov_b32 v232, 1.0
 v_mov_b32 v233, 1.0
 v_mov_b32 v234, 1.0
 v_mov_b32 v235, 1.0
 v_mov_b32 v236, 1.0
 v_mov_b32 v237, 1.0
 v_mov_b32 v238, 1.0
 v_mov_b32 v239, 1.0
 v_mov_b32 v240, 1.0
 v_mov_b32 v241, 1.0
 v_mov_b32 v242, 1.0
 v_mov_b32 v243, 1.0
 v_mov_b32 v244, 1.0
 v_mov_b32 v245, 1.0
 v_mov_b32 v246, 1.0
 v_mov_b32 v247, 1.0
 v_mov_b32 v248, 1.0
 v_mov_b32 v249, 1.0
 v_mov_b32 v250, 1.0
 v_mov_b32 v251, 1.0
 v_mov_b32 v252, 1.0
 v_mov_b32 v253, 1.0
 v_mov_b32 v254, 1.0
 v_mov_b32 v255, 1.0
 v_accvgpr_write_b32 a248, 1.0
 v_accvgpr_write_b32 a249, 1.0
 v_accvgpr_write_b32 a250, 1.0
 v_accvgpr_write_b32 a251, 1.0
 v_accvgpr_write_b32 a252, 1.0
 v_accvgpr_write_b32 a253, 1.0
 v_accvgpr_write_b32 a254, 1.0
 v_accvgpr_write_b32 a255, 1.0
 v_and_b32 v5, 768, v3
 v_and_b32 v7, 1023, v3
 v_add3_u32 v5, v5, v7, s52
 s_waitcnt vmcnt(8)
 ds_read_b64_tr_b16 v[8:9], v5 offset:0
 ds_read_b64_tr_b16 v[10:11], v5 offset:256
 ds_read_b64_tr_b16 v[12:13], v5 offset:8
 ds_read_b64_tr_b16 v[14:15], v5 offset:264
 s_waitcnt lgkmcnt(2)
 buffer_store_dwordx4 v[8:11], v7, s[12:15], s49 offen sc1
 s_waitcnt lgkmcnt(0)
 buffer_store_dwordx4 v[12:15], v7, s[12:15], s49 offen offset:2048 sc1
 s_add_u32 s49, s49, 2097152
 s_waitcnt vmcnt(9)
 v_lshlrev_b32 v40, 16, v32
 v_and_b32 v41, s26, v32
 v_lshlrev_b32 v42, 16, v33
 v_and_b32 v43, s26, v33
 ds_write_b128 v31, v[40:43]
 s_waitcnt vmcnt(8)
 v_lshlrev_b32 v44, 16, v34
 v_and_b32 v45, s26, v34
 v_lshlrev_b32 v46, 16, v35
 v_and_b32 v47, s26, v35
 ds_write_b128 v31, v[44:47] offset:4096
 s_waitcnt vmcnt(7)
 v_lshlrev_b32 v48, 16, v36
 v_and_b32 v49, s26, v36
 v_lshlrev_b32 v50, 16, v37
 v_and_b32 v51, s26, v37
 ds_write_b128 v31, v[48:51] offset:8192
 s_waitcnt lgkmcnt(0)
 v_mov_b32 v32, 1.0
 v_mov_b32 v33, 1.0
 v_mov_b32 v34, 1.0
 v_mov_b32 v35, 1.0
 v_mov_b32 v36, 1.0
 v_mov_b32 v37, 1.0
 v_mov_b32 v38, 1.0
 v_mov_b32 v39, 1.0
 v_mov_b32 v40, 1.0
 v_mov_b32 v41, 1.0
 v_mov_b32 v42, 1.0
 v_mov_b32 v43, 1.0
 v_mov_b32 v44, 1.0
 v_mov_b32 v45, 1.0
 v_mov_b32 v46, 1.0
 v_mov_b32 v47, 1.0
 v_mov_b32 v48, 1.0
 v_mov_b32 v49, 1.0
 v_mov_b32 v50, 1.0
 v_mov_b32 v51, 1.0
 v_mov_b32 v52, 1.0
 v_mov_b32 v53, 1.0
 v_mov_b32 v54, 1.0
 v_mov_b32 v55, 1.0
 v_mov_b32 v56, 1.0
 v_mov_b32 v57, 1.0
 v_mov_b32 v58, 1.0
 v_mov_b32 v59, 1.0
 v_mov_b32 v60, 1.0
 v_mov_b32 v61, 1.0
 v_mov_b32 v62, 1.0
 v_mov_b32 v63, 1.0
 s_waitcnt vmcnt(0)
 s_barrier
 v_mov_b32 v7, 1
 buffer_atomic_add v7, v0, s[56:59], 0 offen sc1
 s_add_u32 m0, s50, 8192
 s_add_u32 s3, s28, 65536
 buffer_load_dwordx4 v20, s[8:11], s3 offen lds
 s_add_u32 m0, s50, 9216
 s_add_u32 s3, s28, 81920
 buffer_load_dwordx4 v20, s[8:11], s3 offen lds
 s_add_u32 m0, s50, 12288
 s_add_u32 s3, s28, 98304
 buffer_load_dwordx4 v20, s[8:11], s3 offen lds
 s_add_u32 m0, s50, 13312
 s_add_u32 s3, s28, 114688
 buffer_load_dwordx4 v20, s[8:11], s3 offen lds
 s_add_u32 m0, s50, 16384
 s_add_u32 s3, s28, 131072
 buffer_load_dwordx4 v20, s[8:11], s3 offen lds
 s_add_u32 m0, s50, 17408
 s_add_u32 s3, s28, 147456
 buffer_load_dwordx4 v20, s[8:11], s3 offen lds
 s_add_u32 m0, s50, 20480
 s_add_u32 s3, s28, 163840
 buffer_load_dwordx4 v20, s[8:11], s3 offen lds
 s_add_u32 m0, s50, 21504
 s_add_u32 s3, s28, 180224
 buffer_load_dwordx4 v20, s[8:11], s3 offen lds
 s_add_u32 m0, s50, 24576
 s_add_u32 s3, s28, 196608
 buffer_load_dwordx4 v20, s[8:11], s3 offen lds
 s_add_u32 m0, s50, 25600
 s_add_u32 s3, s28, 212992
 buffer_load_dwordx4 v20, s[8:11], s3 offen lds
 s_add_u32 m0, s50, 28672
 s_add_u32 s3, s28, 229376
 buffer_load_dwordx4 v20, s[8:11], s3 offen lds
 s_add_u32 m0, s50, 29696
 s_add_u32 s3, s28, 245760
 buffer_load_dwordx4 v20, s[8:11], s3 offen lds
 ds_read_b128 a[0:3], v21
 ds_read_b128 a[32:35], v22
 ds_read_b128 a[4:7], v21 offset:4096
 ds_read_b128 a[36:39], v22 offset:4096
 s_waitcnt lgkmcnt(2)
 ds_write_b128 v3, a[0:3]
 ds_write_b128 v3, a[32:35] offset:1024
 s_waitcnt vmcnt(10)
 ds_read_b128 a[8:11], v21 offset:8192
 ds_read_b128 a[40:43], v22 offset:8192
 s_waitcnt lgkmcnt(4)
 ds_write_b128 v3, a[4:7] offset:4096
 ds_write_b128 v3, a[36:39] offset:5120
 s_waitcnt vmcnt(8)
 ds_read_b128 a[12:15], v21 offset:12288
 ds_read_b128 a[44:47], v22 offset:12288
 s_waitcnt lgkmcnt(4)
 ds_write_b128 v3, a[8:11] offset:8192
 ds_write_b128 v3, a[40:43] offset:9216
 s_waitcnt vmcnt(6)
 ds_read_b128 a[16:19], v21 offset:16384
 ds_read_b128 a[48:51], v22 offset:16384
 s_waitcnt lgkmcnt(4)
 ds_write_b128 v3, a[12:15] offset:12288
 ds_write_b128 v3, a[44:47] offset:13312
 s_waitcnt vmcnt(4)
 ds_read_b128 a[20:23], v21 offset:20480
 ds_read_b128 a[52:55], v22 offset:20480
 s_waitcnt lgkmcnt(4)
 ds_write_b128 v3, a[16:19] offset:16384
 ds_write_b128 v3, a[48:51] offset:17408
 s_waitcnt vmcnt(2)
 ds_read_b128 a[24:27], v21 offset:24576
 ds_read_b128 a[56:59], v22 offset:24576
 s_waitcnt lgkmcnt(4)
 ds_write_b128 v3, a[20:23] offset:20480
 ds_write_b128 v3, a[52:55] offset:21504
 s_waitcnt vmcnt(0)
 ds_read_b128 a[28:31], v21 offset:28672
 ds_read_b128 a[60:63], v22 offset:28672
 s_waitcnt lgkmcnt(4)
 ds_write_b128 v3, a[24:27] offset:24576
 ds_write_b128 v3, a[56:59] offset:25600
 s_cmp_eq_u32 s54, 0
 s_cbranch_scc0 Lseg1
 v_lshlrev_b32 v4, 2, v3
 v_and_b32 v4, 192, v4
 buffer_load_dword v4, v4, s[44:47], 0 offen sc1
Lseg1:
 s_waitcnt lgkmcnt(2)
 ds_write_b128 v3, a[28:31] offset:28672
 ds_write_b128 v3, a[60:63] offset:29696
 s_cmp_eq_u32 s54, 0
 s_cbranch_scc0 Lseg2
 s_waitcnt vmcnt(0)
 v_cmp_gt_i32 vcc, s27, v4
 s_and_b64 vcc, exec, vcc
 s_cbranch_vccnz Lspin_pro
Lok_pro:
Lseg2:
 s_add_u32 s27, s27, 64
 s_waitcnt lgkmcnt(0)
 s_barrier
 global_load_dwordx4 v[140:143], v0, s[70:71] offset:-3072 sc1
 global_load_dwordx4 v[136:139], v0, s[70:71] offset:-4096 sc1
 global_load_dwordx4 v[148:151], v0, s[70:71] offset:-1024 sc1
 global_load_dwordx4 v[144:147], v0, s[70:71] offset:-2048 sc1
 global_load_dwordx4 v[156:159], v0, s[70:71] offset:1024 sc1
 global_load_dwordx4 v[152:155], v0, s[70:71] offset:0 sc1
 global_load_dwordx4 v[164:167], v0, s[70:71] offset:3072 sc1
 global_load_dwordx4 v[160:163], v0, s[70:71] offset:2048 sc1
 s_add_u32 s70, s70, 8192
 s_addc_u32 s71, s71, 0
 ds_read_b128 a[128:131], v1
 ds_read_b128 a[132:135], v1 offset:1024
 ds_read_b128 a[140:143], v1 offset:5120
 ds_read_b128 a[136:139], v1 offset:4096
 ds_read_b128 a[144:147], v1 offset:8192
 ds_read_b128 a[148:151], v1 offset:9216
 ds_read_b128 a[156:159], v1 offset:13312
 ds_read_b128 a[152:155], v1 offset:12288
 ds_read_b128 a[160:163], v1 offset:16384
 ds_read_b128 a[164:167], v1 offset:17408
 ds_read_b128 a[172:175], v1 offset:21504
 ds_read_b128 a[168:171], v1 offset:20480
 ds_read_b128 a[176:179], v1 offset:24576
 ds_read_b128 a[180:183], v1 offset:25600
 ds_read_b128 a[188:191], v1 offset:29696
 ds_read_b128 a[184:187], v1 offset:28672
 global_load_dwordx4 v[172:175], v0, s[70:71] offset:-3072 sc1
 global_load_dwordx4 v[168:171], v0, s[70:71] offset:-4096 sc1
 global_load_dwordx4 v[180:183], v0, s[70:71] offset:-1024 sc1
 global_load_dwordx4 v[176:179], v0, s[70:71] offset:-2048 sc1
 global_load_dwordx4 v[188:191], v0, s[70:71] offset:1024 sc1
 global_load_dwordx4 v[184:187], v0, s[70:71] offset:0 sc1
 global_load_dwordx4 v[196:199], v0, s[70:71] offset:3072 sc1
 global_load_dwordx4 v[192:195], v0, s[70:71] offset:2048 sc1
 s_add_u32 s70, s70, 8192
 s_addc_u32 s71, s71, 0
 global_load_dwordx4 v[204:207], v0, s[70:71] offset:-3072 sc1
 global_load_dwordx4 v[200:203], v0, s[70:71] offset:-4096 sc1
 global_load_dwordx4 v[212:215], v0, s[70:71] offset:-1024 sc1
 global_load_dwordx4 v[208:211], v0, s[70:71] offset:-2048 sc1
 global_load_dwordx4 a[228:231], v0, s[70:71] offset:1024 sc1
 global_load_dwordx4 a[224:227], v0, s[70:71] offset:0 sc1
 global_load_dwordx4 a[236:239], v0, s[70:71] offset:3072 sc1
 global_load_dwordx4 a[232:235], v0, s[70:71] offset:2048 sc1
 s_add_u32 s70, s70, 8192
 s_addc_u32 s71, s71, 0
 global_load_dwordx4 a[196:199], v0, s[70:71] offset:-3072 sc1
 global_load_dwordx4 a[192:195], v0, s[70:71] offset:-4096 sc1
 global_load_dwordx4 a[204:207], v0, s[70:71] offset:-1024 sc1
 global_load_dwordx4 a[200:203], v0, s[70:71] offset:-2048 sc1
 global_load_dwordx4 a[212:215], v0, s[70:71] offset:1024 sc1
 global_load_dwordx4 a[208:211], v0, s[70:71] offset:0 sc1
 global_load_dwordx4 a[220:223], v0, s[70:71] offset:3072 sc1
 global_load_dwordx4 a[216:219], v0, s[70:71] offset:2048 sc1
 s_add_u32 s70, s70, 8192
 s_addc_u32 s71, s71, 0
 v_mov_b32 v8, v20
 v_mov_b32 v16, 1.0
 v_mov_b32 v17, 1.0
 v_mov_b32 v18, 1.0
 v_mov_b32 v19, 1.0
 v_mov_b32 v20, 1.0
 v_mov_b32 v21, 1.0
 v_mov_b32 v22, 1.0
 v_mov_b32 v23, 1.0
 v_mov_b32 v24, 1.0
 v_mov_b32 v25, 1.0
 v_mov_b32 v26, 1.0
 v_mov_b32 v27, 1.0
 v_mov_b32 v28, 1.0
 v_mov_b32 v29, 1.0
 v_mov_b32 v30, 1.0
 v_mov_b32 v31, 1.0
 s_xor_b32 s30, s28, 1024
 s_mov_b32 s20, 64
 s_mov_b32 s21, 32704
 s_mov_b32 s22, 0xfffc8040
 s_waitcnt vmcnt(30) lgkmcnt(8)
 v_mfma_f32_16x16x32_bf16 v[16:19], v[136:139], a[128:131], v[16:19]
 s_add_u32 m0, s50, 2048
 v_mfma_f32_16x16x32_bf16 v[16:19], v[140:143], a[132:135], v[16:19]
 s_add_u32 s3, s28, 128
 v_mfma_f32_16x16x32_bf16 v[20:23], v[140:143], a[140:143], v[20:23]
 buffer_load_dwordx4 v8, s[8:11], s3 offen lds
 s_add_u32 m0, s50, 3072
 v_mfma_f32_16x16x32_bf16 v[20:23], v[136:139], a[136:139], v[20:23]
 s_add_u32 s3, s28, 16512
 v_mfma_f32_16x16x32_bf16 v[24:27], v[136:139], a[144:147], v[24:27]
 buffer_load_dwordx4 v8, s[8:11], s3 offen lds
 v_mfma_f32_16x16x32_bf16 v[24:27], v[140:143], a[148:151], v[24:27]
 s_add_u32 m0, s50, 6144
 v_mfma_f32_16x16x32_bf16 v[28:31], v[140:143], a[156:159], v[28:31]
 s_add_u32 s3, s28, 32896
 v_mfma_f32_16x16x32_bf16 v[28:31], v[136:139], a[152:155], v[28:31]
 buffer_load_dwordx4 v8, s[8:11], s3 offen lds
 s_add_u32 m0, s50, 7168
 s_waitcnt lgkmcnt(0)
 v_mfma_f32_16x16x32_bf16 v[32:35], v[136:139], a[160:163], v[32:35]
 s_add_u32 s3, s28, 49280
 v_mfma_f32_16x16x32_bf16 v[32:35], v[140:143], a[164:167], v[32:35]
 buffer_load_dwordx4 v8, s[8:11], s3 offen lds
 v_mfma_f32_16x16x32_bf16 v[36:39], v[140:143], a[172:175], v[36:39]
 s_add_u32 m0, s50, 10240
 v_mfma_f32_16x16x32_bf16 v[36:39], v[136:139], a[168:171], v[36:39]
 s_add_u32 s3, s28, 65664
 v_mfma_f32_16x16x32_bf16 v[40:43], v[136:139], a[176:179], v[40:43]
 buffer_load_dwordx4 v8, s[8:11], s3 offen lds
 s_add_u32 m0, s50, 11264
 v_mfma_f32_16x16x32_bf16 v[40:43], v[140:143], a[180:183], v[40:43]
 s_add_u32 s3, s28, 82048
 v_mfma_f32_16x16x32_bf16 v[44:47], v[140:143], a[188:191], v[44:47]
 buffer_load_dwordx4 v8, s[8:11], s3 offen lds
 v_mfma_f32_16x16x32_bf16 v[44:47], v[136:139], a[184:187], v[44:47]
 s_add_u32 m0, s50, 14336
 s_waitcnt vmcnt(34)
 v_mfma_f32_16x16x32_bf16 v[76:79], v[144:147], a[184:187], v[76:79]
 s_add_u32 s3, s28, 98432
 v_mfma_f32_16x16x32_bf16 v[76:79], v[148:151], a[188:191], v[76:79]
 buffer_load_dwordx4 v8, s[8:11], s3 offen lds
 s_add_u32 m0, s50, 15360
 v_mfma_f32_16x16x32_bf16 v[72:75], v[148:151], a[180:183], v[72:75]
 s_add_u32 s3, s28, 114816
 v_mov_b32 v136, 1.0
 v_mfma_f32_16x16x32_bf16 v[72:75], v[144:147], a[176:179], v[72:75]
 buffer_load_dwordx4 v8, s[8:11], s3 offen lds
 v_mfma_f32_16x16x32_bf16 v[68:71], v[144:147], a[168:171], v[68:71]
 s_add_u32 m0, s50, 18432
 v_mov_b32 v137, 1.0
 v_mfma_f32_16x16x32_bf16 v[68:71], v[148:151], a[172:175], v[68:71]
 s_add_u32 s3, s28, 131200
 v_mov_b32 v138, 1.0
 v_mfma_f32_16x16x32_bf16 v[64:67], v[148:151], a[164:167], v[64:67]
 buffer_load_dwordx4 v8, s[8:11], s3 offen lds
 s_add_u32 m0, s50, 19456
 v_mfma_f32_16x16x32_bf16 v[64:67], v[144:147], a[160:163], v[64:67]
 s_add_u32 s3, s28, 147584
 v_mov_b32 v139, 1.0
 v_mfma_f32_16x16x32_bf16 v[60:63], v[144:147], a[152:155], v[60:63]
 v_mov_b32 v140, 1.0
 v_mfma_f32_16x16x32_bf16 v[60:63], v[148:151], a[156:159], v[60:63]
 buffer_load_dwordx4 v8, s[8:11], s3 offen lds
 s_add_u32 m0, s50, 22528
 v_mfma_f32_16x16x32_bf16 v[56:59], v[148:151], a[148:151], v[56:59]
 s_add_u32 s3, s28, 163968
 v_mov_b32 v141, 1.0
 v_mfma_f32_16x16x32_bf16 v[56:59], v[144:147], a[144:147], v[56:59]
 v_mov_b32 v142, 1.0
 v_mfma_f32_16x16x32_bf16 v[52:55], v[144:147], a[136:139], v[52:55]
 buffer_load_dwordx4 v8, s[8:11], s3 offen lds
 s_add_u32 m0, s50, 23552
 v_mfma_f32_16x16x32_bf16 v[52:55], v[148:151], a[140:143], v[52:55]
 s_add_u32 s3, s28, 180352
 v_mov_b32 v143, 1.0
 v_mfma_f32_16x16x32_bf16 v[48:51], v[148:151], a[132:135], v[48:51]
 buffer_load_dwordx4 v8, s[8:11], s3 offen lds
 s_add_u32 m0, s50, 26624
 v_mfma_f32_16x16x32_bf16 v[48:51], v[144:147], a[128:131], v[48:51]
 s_add_u32 s3, s28, 196736
 s_waitcnt vmcnt(38)
 v_mfma_f32_16x16x32_bf16 v[80:83], v[152:155], a[128:131], v[80:83]
 buffer_load_dwordx4 v8, s[8:11], s3 offen lds
 s_add_u32 m0, s50, 27648
 v_mfma_f32_16x16x32_bf16 v[80:83], v[156:159], a[132:135], v[80:83]
 s_add_u32 s3, s28, 213120
 buffer_load_dwordx4 v8, s[8:11], s3 offen lds
 v_mfma_f32_16x16x32_bf16 v[84:87], v[156:159], a[140:143], v[84:87]
 s_add_u32 m0, s50, 30720
 v_mov_b32 v144, 1.0
 v_mfma_f32_16x16x32_bf16 v[84:87], v[152:155], a[136:139], v[84:87]
 s_add_u32 s3, s28, 229504
 buffer_load_dwordx4 v8, s[8:11], s3 offen lds
 v_mfma_f32_16x16x32_bf16 v[88:91], v[152:155], a[144:147], v[88:91]
 v_mov_b32 v145, 1.0
 v_mfma_f32_16x16x32_bf16 v[88:91], v[156:159], a[148:151], v[88:91]
 s_add_u32 m0, s50, 31744
 v_mov_b32 v146, 1.0
 v_mfma_f32_16x16x32_bf16 v[92:95], v[156:159], a[156:159], v[92:95]
 s_add_u32 s3, s28, 245888
 buffer_load_dwordx4 v8, s[8:11], s3 offen lds
 v_mfma_f32_16x16x32_bf16 v[92:95], v[152:155], a[152:155], v[92:95]
 v_mov_b32 v147, 1.0
 v_mfma_f32_16x16x32_bf16 v[96:99], v[152:155], a[160:163], v[96:99]
 v_mov_b32 v148, 1.0
 v_mfma_f32_16x16x32_bf16 v[96:99], v[156:159], a[164:167], v[96:99]
 v_mfma_f32_16x16x32_bf16 v[100:103], v[156:159], a[172:175], v[100:103]
 v_mov_b32 v149, 1.0
 v_mfma_f32_16x16x32_bf16 v[100:103], v[152:155], a[168:171], v[100:103]
 v_mov_b32 v150, 1.0
 v_mfma_f32_16x16x32_bf16 v[104:107], v[152:155], a[176:179], v[104:107]
 v_mfma_f32_16x16x32_bf16 v[104:107], v[156:159], a[180:183], v[104:107]
 v_mov_b32 v151, 1.0
 v_mfma_f32_16x16x32_bf16 v[108:111], v[156:159], a[188:191], v[108:111]
 v_mfma_f32_16x16x32_bf16 v[108:111], v[152:155], a[184:187], v[108:111]
 s_waitcnt vmcnt(40)
 v_mfma_f32_16x16x32_bf16 a[244:247], v[160:163], a[184:187], a[244:247]
 ds_read_b128 a[184:187], v1 offset:61440
 v_mfma_f32_16x16x32_bf16 a[244:247], v[164:167], a[188:191], a[244:247]
 ds_read_b128 a[188:191], v1 offset:62464
 v_mfma_f32_16x16x32_bf16 a[240:243], v[164:167], a[180:183], a[240:243]
 ds_read_b128 a[180:183], v1 offset:58368
 v_mov_b32 v152, 1.0
 v_mfma_f32_16x16x32_bf16 a[240:243], v[160:163], a[176:179], a[240:243]
 ds_read_b128 a[176:179], v1 offset:57344
 v_mfma_f32_16x16x32_bf16 v[132:135], v[160:163], a[168:171], v[132:135]
 ds_read_b128 a[168:171], v1 offset:53248
 v_mov_b32 v153, 1.0
 v_mfma_f32_16x16x32_bf16 v[132:135], v[164:167], a[172:175], v[132:135]
 ds_read_b128 a[172:175], v1 offset:54272
 v_mov_b32 v154, 1.0
 v_mfma_f32_16x16x32_bf16 v[128:131], v[164:167], a[164:167], v[128:131]
 ds_read_b128 a[164:167], v1 offset:50176
 v_mfma_f32_16x16x32_bf16 v[128:131], v[160:163], a[160:163], v[128:131]
 ds_read_b128 a[160:163], v1 offset:49152
 v_mov_b32 v155, 1.0
 v_mfma_f32_16x16x32_bf16 v[124:127], v[160:163], a[152:155], v[124:127]
 ds_read_b128 a[152:155], v1 offset:45056
 v_mov_b32 v156, 1.0
 v_mfma_f32_16x16x32_bf16 v[124:127], v[164:167], a[156:159], v[124:127]
 ds_read_b128 a[156:159], v1 offset:46080
 v_mfma_f32_16x16x32_bf16 v[120:123], v[164:167], a[148:151], v[120:123]
 ds_read_b128 a[148:151], v1 offset:41984
 v_mov_b32 v157, 1.0
 v_mfma_f32_16x16x32_bf16 v[120:123], v[160:163], a[144:147], v[120:123]
 ds_read_b128 a[144:147], v1 offset:40960
 v_mov_b32 v158, 1.0
 v_mfma_f32_16x16x32_bf16 v[116:119], v[160:163], a[136:139], v[116:119]
 ds_read_b128 a[136:139], v1 offset:36864
 v_mfma_f32_16x16x32_bf16 v[116:119], v[164:167], a[140:143], v[116:119]
 ds_read_b128 a[140:143], v1 offset:37888
 v_mov_b32 v159, 1.0
 v_mfma_f32_16x16x32_bf16 v[112:115], v[164:167], a[132:135], v[112:115]
 ds_read_b128 a[132:135], v1 offset:33792
 v_mfma_f32_16x16x32_bf16 v[112:115], v[160:163], a[128:131], v[112:115]
 ds_read_b128 a[128:131], v1 offset:32768
 s_waitcnt vmcnt(38) lgkmcnt(8)
 v_mfma_f32_16x16x32_bf16 v[44:47], v[168:171], a[184:187], v[44:47]
 v_mfma_f32_16x16x32_bf16 v[44:47], v[172:175], a[188:191], v[44:47]
 v_mfma_f32_16x16x32_bf16 v[40:43], v[172:175], a[180:183], v[40:43]
 v_mov_b32 v160, 1.0
 v_mfma_f32_16x16x32_bf16 v[40:43], v[168:171], a[176:179], v[40:43]
 v_mfma_f32_16x16x32_bf16 v[36:39], v[168:171], a[168:171], v[36:39]
 v_mov_b32 v161, 1.0
 v_mfma_f32_16x16x32_bf16 v[36:39], v[172:175], a[172:175], v[36:39]
 v_mov_b32 v162, 1.0
 v_mfma_f32_16x16x32_bf16 v[32:35], v[172:175], a[164:167], v[32:35]
 v_mfma_f32_16x16x32_bf16 v[32:35], v[168:171], a[160:163], v[32:35]
 v_mov_b32 v163, 1.0
 s_waitcnt lgkmcnt(0)
 v_mfma_f32_16x16x32_bf16 v[28:31], v[168:171], a[152:155], v[28:31]
 v_mov_b32 v164, 1.0
 v_mfma_f32_16x16x32_bf16 v[28:31], v[172:175], a[156:159], v[28:31]
 v_mfma_f32_16x16x32_bf16 v[24:27], v[172:175], a[148:151], v[24:27]
 v_mov_b32 v165, 1.0
 v_mfma_f32_16x16x32_bf16 v[24:27], v[168:171], a[144:147], v[24:27]
 v_mov_b32 v166, 1.0
 v_mfma_f32_16x16x32_bf16 v[20:23], v[168:171], a[136:139], v[20:23]
 v_mfma_f32_16x16x32_bf16 v[20:23], v[172:175], a[140:143], v[20:23]
 v_mov_b32 v167, 1.0
 v_mfma_f32_16x16x32_bf16 v[16:19], v[172:175], a[132:135], v[16:19]
 v_mfma_f32_16x16x32_bf16 v[16:19], v[168:171], a[128:131], v[16:19]
 s_waitcnt vmcnt(36)
 v_mfma_f32_16x16x32_bf16 v[48:51], v[176:179], a[128:131], v[48:51]
 v_mfma_f32_16x16x32_bf16 v[48:51], v[180:183], a[132:135], v[48:51]
 v_mfma_f32_16x16x32_bf16 v[52:55], v[180:183], a[140:143], v[52:55]
 v_mov_b32 v168, 1.0
 v_mfma_f32_16x16x32_bf16 v[52:55], v[176:179], a[136:139], v[52:55]
 v_mfma_f32_16x16x32_bf16 v[56:59], v[176:179], a[144:147], v[56:59]
 v_mov_b32 v169, 1.0
 v_mfma_f32_16x16x32_bf16 v[56:59], v[180:183], a[148:151], v[56:59]
 v_mov_b32 v170, 1.0
 v_mfma_f32_16x16x32_bf16 v[60:63], v[180:183], a[156:159], v[60:63]
 v_mfma_f32_16x16x32_bf16 v[60:63], v[176:179], a[152:155], v[60:63]
 v_mov_b32 v171, 1.0
 v_mfma_f32_16x16x32_bf16 v[64:67], v[176:179], a[160:163], v[64:67]
 v_mov_b32 v172, 1.0
 v_mfma_f32_16x16x32_bf16 v[64:67], v[180:183], a[164:167], v[64:67]
 v_mfma_f32_16x16x32_bf16 v[68:71], v[180:183], a[172:175], v[68:71]
 v_mov_b32 v173, 1.0
 v_mfma_f32_16x16x32_bf16 v[68:71], v[176:179], a[168:171], v[68:71]
 v_mov_b32 v174, 1.0
 v_mfma_f32_16x16x32_bf16 v[72:75], v[176:179], a[176:179], v[72:75]
 v_mfma_f32_16x16x32_bf16 v[72:75], v[180:183], a[180:183], v[72:75]
 v_mov_b32 v175, 1.0
 v_mfma_f32_16x16x32_bf16 v[76:79], v[180:183], a[188:191], v[76:79]
 v_mfma_f32_16x16x32_bf16 v[76:79], v[176:179], a[184:187], v[76:79]
 s_waitcnt vmcnt(34)
 v_mfma_f32_16x16x32_bf16 v[108:111], v[184:187], a[184:187], v[108:111]
 v_mfma_f32_16x16x32_bf16 v[108:111], v[188:191], a[188:191], v[108:111]
 v_mfma_f32_16x16x32_bf16 v[104:107], v[188:191], a[180:183], v[104:107]
 v_mov_b32 v176, 1.0
 v_mfma_f32_16x16x32_bf16 v[104:107], v[184:187], a[176:179], v[104:107]
 v_mfma_f32_16x16x32_bf16 v[100:103], v[184:187], a[168:171], v[100:103]
 v_mov_b32 v177, 1.0
 v_mfma_f32_16x16x32_bf16 v[100:103], v[188:191], a[172:175], v[100:103]
 v_mov_b32 v178, 1.0
 v_mfma_f32_16x16x32_bf16 v[96:99], v[188:191], a[164:167], v[96:99]
 v_mfma_f32_16x16x32_bf16 v[96:99], v[184:187], a[160:163], v[96:99]
 v_mov_b32 v179, 1.0
 v_mfma_f32_16x16x32_bf16 v[92:95], v[184:187], a[152:155], v[92:95]
 v_mov_b32 v180, 1.0
 v_mfma_f32_16x16x32_bf16 v[92:95], v[188:191], a[156:159], v[92:95]
 v_mfma_f32_16x16x32_bf16 v[88:91], v[188:191], a[148:151], v[88:91]
 v_mov_b32 v181, 1.0
 v_mfma_f32_16x16x32_bf16 v[88:91], v[184:187], a[144:147], v[88:91]
 v_mov_b32 v182, 1.0
 v_mfma_f32_16x16x32_bf16 v[84:87], v[184:187], a[136:139], v[84:87]
 v_mfma_f32_16x16x32_bf16 v[84:87], v[188:191], a[140:143], v[84:87]
 v_mov_b32 v183, 1.0
 v_mfma_f32_16x16x32_bf16 v[80:83], v[188:191], a[132:135], v[80:83]
 v_mfma_f32_16x16x32_bf16 v[80:83], v[184:187], a[128:131], v[80:83]
 s_waitcnt vmcnt(32)
 v_mfma_f32_16x16x32_bf16 v[112:115], v[192:195], a[128:131], v[112:115]
 ds_read_b128 a[128:131], v2
 v_mfma_f32_16x16x32_bf16 v[112:115], v[196:199], a[132:135], v[112:115]
 ds_read_b128 a[132:135], v2 offset:1024
 v_mfma_f32_16x16x32_bf16 v[116:119], v[196:199], a[140:143], v[116:119]
 ds_read_b128 a[140:143], v2 offset:5120
 v_mov_b32 v184, 1.0
 v_mfma_f32_16x16x32_bf16 v[116:119], v[192:195], a[136:139], v[116:119]
 ds_read_b128 a[136:139], v2 offset:4096
 v_mfma_f32_16x16x32_bf16 v[120:123], v[192:195], a[144:147], v[120:123]
 ds_read_b128 a[144:147], v2 offset:8192
 v_mov_b32 v185, 1.0
 v_mfma_f32_16x16x32_bf16 v[120:123], v[196:199], a[148:151], v[120:123]
 ds_read_b128 a[148:151], v2 offset:9216
 v_mov_b32 v186, 1.0
 v_mfma_f32_16x16x32_bf16 v[124:127], v[196:199], a[156:159], v[124:127]
 ds_read_b128 a[156:159], v2 offset:13312
 v_mfma_f32_16x16x32_bf16 v[124:127], v[192:195], a[152:155], v[124:127]
 ds_read_b128 a[152:155], v2 offset:12288
 v_mov_b32 v187, 1.0
 v_mfma_f32_16x16x32_bf16 v[128:131], v[192:195], a[160:163], v[128:131]
 ds_read_b128 a[160:163], v2 offset:16384
 v_mov_b32 v188, 1.0
 v_mfma_f32_16x16x32_bf16 v[128:131], v[196:199], a[164:167], v[128:131]
 ds_read_b128 a[164:167], v2 offset:17408
 v_mfma_f32_16x16x32_bf16 v[132:135], v[196:199], a[172:175], v[132:135]
 ds_read_b128 a[172:175], v2 offset:21504
 v_mov_b32 v189, 1.0
 v_mfma_f32_16x16x32_bf16 v[132:135], v[192:195], a[168:171], v[132:135]
 ds_read_b128 a[168:171], v2 offset:20480
 v_mov_b32 v190, 1.0
 v_mfma_f32_16x16x32_bf16 a[240:243], v[192:195], a[176:179], a[240:243]
 ds_read_b128 a[176:179], v2 offset:24576
 v_mfma_f32_16x16x32_bf16 a[240:243], v[196:199], a[180:183], a[240:243]
 ds_read_b128 a[180:183], v2 offset:25600
 v_mov_b32 v191, 1.0
 v_mfma_f32_16x16x32_bf16 a[244:247], v[196:199], a[188:191], a[244:247]
 ds_read_b128 a[188:191], v2 offset:29696
 v_mfma_f32_16x16x32_bf16 a[244:247], v[192:195], a[184:187], a[244:247]
 ds_read_b128 a[184:187], v2 offset:28672
 s_waitcnt vmcnt(30) lgkmcnt(8)
 v_mfma_f32_16x16x32_bf16 v[16:19], v[200:203], a[128:131], v[16:19]
 v_mfma_f32_16x16x32_bf16 v[16:19], v[204:207], a[132:135], v[16:19]
 v_mfma_f32_16x16x32_bf16 v[20:23], v[204:207], a[140:143], v[20:23]
 v_mov_b32 v192, 1.0
 v_mfma_f32_16x16x32_bf16 v[20:23], v[200:203], a[136:139], v[20:23]
 v_mfma_f32_16x16x32_bf16 v[24:27], v[200:203], a[144:147], v[24:27]
 v_mov_b32 v193, 1.0
 v_mfma_f32_16x16x32_bf16 v[24:27], v[204:207], a[148:151], v[24:27]
 v_mov_b32 v194, 1.0
 v_mfma_f32_16x16x32_bf16 v[28:31], v[204:207], a[156:159], v[28:31]
 v_mfma_f32_16x16x32_bf16 v[28:31], v[200:203], a[152:155], v[28:31]
 v_mov_b32 v195, 1.0
 s_waitcnt lgkmcnt(0)
 v_mfma_f32_16x16x32_bf16 v[32:35], v[200:203], a[160:163], v[32:35]
 v_mov_b32 v196, 1.0
 v_mfma_f32_16x16x32_bf16 v[32:35], v[204:207], a[164:167], v[32:35]
 v_mfma_f32_16x16x32_bf16 v[36:39], v[204:207], a[172:175], v[36:39]
 v_mov_b32 v197, 1.0
 v_mfma_f32_16x16x32_bf16 v[36:39], v[200:203], a[168:171], v[36:39]
 v_mov_b32 v198, 1.0
 v_mfma_f32_16x16x32_bf16 v[40:43], v[200:203], a[176:179], v[40:43]
 v_mfma_f32_16x16x32_bf16 v[40:43], v[204:207], a[180:183], v[40:43]
 v_mov_b32 v199, 1.0
 v_mfma_f32_16x16x32_bf16 v[44:47], v[204:207], a[188:191], v[44:47]
 v_mfma_f32_16x16x32_bf16 v[44:47], v[200:203], a[184:187], v[44:47]
 s_waitcnt vmcnt(28)
 v_mfma_f32_16x16x32_bf16 v[76:79], v[208:211], a[184:187], v[76:79]
 v_mfma_f32_16x16x32_bf16 v[76:79], v[212:215], a[188:191], v[76:79]
 v_mfma_f32_16x16x32_bf16 v[72:75], v[212:215], a[180:183], v[72:75]
 v_mov_b32 v200, 1.0
 v_mfma_f32_16x16x32_bf16 v[72:75], v[208:211], a[176:179], v[72:75]
 v_mfma_f32_16x16x32_bf16 v[68:71], v[208:211], a[168:171], v[68:71]
 v_mov_b32 v201, 1.0
 v_mfma_f32_16x16x32_bf16 v[68:71], v[212:215], a[172:175], v[68:71]
 v_mov_b32 v202, 1.0
 v_mfma_f32_16x16x32_bf16 v[64:67], v[212:215], a[164:167], v[64:67]
 v_mfma_f32_16x16x32_bf16 v[64:67], v[208:211], a[160:163], v[64:67]
 v_mov_b32 v203, 1.0
 v_mfma_f32_16x16x32_bf16 v[60:63], v[208:211], a[152:155], v[60:63]
 v_mov_b32 v204, 1.0
 v_mfma_f32_16x16x32_bf16 v[60:63], v[212:215], a[156:159], v[60:63]
 v_mfma_f32_16x16x32_bf16 v[56:59], v[212:215], a[148:151], v[56:59]
 v_mov_b32 v205, 1.0
 v_mfma_f32_16x16x32_bf16 v[56:59], v[208:211], a[144:147], v[56:59]
 v_mov_b32 v206, 1.0
 v_mfma_f32_16x16x32_bf16 v[52:55], v[208:211], a[136:139], v[52:55]
 v_mfma_f32_16x16x32_bf16 v[52:55], v[212:215], a[140:143], v[52:55]
 v_mov_b32 v207, 1.0
 v_mfma_f32_16x16x32_bf16 v[48:51], v[212:215], a[132:135], v[48:51]
 v_mfma_f32_16x16x32_bf16 v[48:51], v[208:211], a[128:131], v[48:51]
 s_waitcnt vmcnt(26)
 v_mfma_f32_16x16x32_bf16 v[80:83], a[224:227], a[128:131], v[80:83]
 v_mfma_f32_16x16x32_bf16 v[80:83], a[228:231], a[132:135], v[80:83]
 v_mfma_f32_16x16x32_bf16 v[84:87], a[228:231], a[140:143], v[84:87]
 v_mov_b32 v208, 1.0
 v_mfma_f32_16x16x32_bf16 v[84:87], a[224:227], a[136:139], v[84:87]
 v_mfma_f32_16x16x32_bf16 v[88:91], a[224:227], a[144:147], v[88:91]
 v_mov_b32 v209, 1.0
 v_mfma_f32_16x16x32_bf16 v[88:91], a[228:231], a[148:151], v[88:91]
 v_mov_b32 v210, 1.0
 v_mfma_f32_16x16x32_bf16 v[92:95], a[228:231], a[156:159], v[92:95]
 v_mfma_f32_16x16x32_bf16 v[92:95], a[224:227], a[152:155], v[92:95]
 v_mov_b32 v211, 1.0
 v_mfma_f32_16x16x32_bf16 v[96:99], a[224:227], a[160:163], v[96:99]
 v_mov_b32 v212, 1.0
 v_mfma_f32_16x16x32_bf16 v[96:99], a[228:231], a[164:167], v[96:99]
 v_mfma_f32_16x16x32_bf16 v[100:103], a[228:231], a[172:175], v[100:103]
 v_mov_b32 v213, 1.0
 v_mfma_f32_16x16x32_bf16 v[100:103], a[224:227], a[168:171], v[100:103]
 v_mov_b32 v214, 1.0
 v_mfma_f32_16x16x32_bf16 v[104:107], a[224:227], a[176:179], v[104:107]
 v_mfma_f32_16x16x32_bf16 v[104:107], a[228:231], a[180:183], v[104:107]
 v_mov_b32 v215, 1.0
 v_mfma_f32_16x16x32_bf16 v[108:111], a[228:231], a[188:191], v[108:111]
 v_mfma_f32_16x16x32_bf16 v[108:111], a[224:227], a[184:187], v[108:111]
 s_waitcnt vmcnt(24)
 v_mfma_f32_16x16x32_bf16 a[244:247], a[232:235], a[184:187], a[244:247]
 ds_read_b128 a[184:187], v2 offset:61440
 v_mfma_f32_16x16x32_bf16 a[244:247], a[236:239], a[188:191], a[244:247]
 global_load_dwordx4 a[228:231], v0, s[70:71] offset:-3072 sc1
 ds_read_b128 a[188:191], v2 offset:62464
 v_mfma_f32_16x16x32_bf16 a[240:243], a[236:239], a[180:183], a[240:243]
 ds_read_b128 a[180:183], v2 offset:58368
 v_mfma_f32_16x16x32_bf16 a[240:243], a[232:235], a[176:179], a[240:243]
 global_load_dwordx4 a[224:227], v0, s[70:71] offset:-4096 sc1
 ds_read_b128 a[176:179], v2 offset:57344
 v_mfma_f32_16x16x32_bf16 v[132:135], a[232:235], a[168:171], v[132:135]
 ds_read_b128 a[168:171], v2 offset:53248
 v_mfma_f32_16x16x32_bf16 v[132:135], a[236:239], a[172:175], v[132:135]
 ds_read_b128 a[172:175], v2 offset:54272
 v_mfma_f32_16x16x32_bf16 v[128:131], a[236:239], a[164:167], v[128:131]
 ds_read_b128 a[164:167], v2 offset:50176
 v_mfma_f32_16x16x32_bf16 v[128:131], a[232:235], a[160:163], v[128:131]
 ds_read_b128 a[160:163], v2 offset:49152
 v_mfma_f32_16x16x32_bf16 v[124:127], a[232:235], a[152:155], v[124:127]
 ds_read_b128 a[152:155], v2 offset:45056
 v_mfma_f32_16x16x32_bf16 v[124:127], a[236:239], a[156:159], v[124:127]
 ds_read_b128 a[156:159], v2 offset:46080
 v_mfma_f32_16x16x32_bf16 v[120:123], a[236:239], a[148:151], v[120:123]
 ds_read_b128 a[148:151], v2 offset:41984
 v_mfma_f32_16x16x32_bf16 v[120:123], a[232:235], a[144:147], v[120:123]
 ds_read_b128 a[144:147], v2 offset:40960
 v_mfma_f32_16x16x32_bf16 v[116:119], a[232:235], a[136:139], v[116:119]
 ds_read_b128 a[136:139], v2 offset:36864
 v_mfma_f32_16x16x32_bf16 v[116:119], a[236:239], a[140:143], v[116:119]
 ds_read_b128 a[140:143], v2 offset:37888
 v_mfma_f32_16x16x32_bf16 v[112:115], a[236:239], a[132:135], v[112:115]
 ds_read_b128 a[132:135], v2 offset:33792
 v_mfma_f32_16x16x32_bf16 v[112:115], a[232:235], a[128:131], v[112:115]
 ds_read_b128 a[128:131], v2 offset:32768
 s_waitcnt vmcnt(24) lgkmcnt(8)
 v_mfma_f32_16x16x32_bf16 v[44:47], a[192:195], a[184:187], v[44:47]
 v_mfma_f32_16x16x32_bf16 v[44:47], a[196:199], a[188:191], v[44:47]
 global_load_dwordx4 a[236:239], v0, s[70:71] offset:-1024 sc1
 v_mfma_f32_16x16x32_bf16 v[40:43], a[196:199], a[180:183], v[40:43]
 v_mfma_f32_16x16x32_bf16 v[40:43], a[192:195], a[176:179], v[40:43]
 global_load_dwordx4 a[232:235], v0, s[70:71] offset:-2048 sc1
 v_mfma_f32_16x16x32_bf16 v[36:39], a[192:195], a[168:171], v[36:39]
 v_mfma_f32_16x16x32_bf16 v[36:39], a[196:199], a[172:175], v[36:39]
 v_mfma_f32_16x16x32_bf16 v[32:35], a[196:199], a[164:167], v[32:35]
 v_mfma_f32_16x16x32_bf16 v[32:35], a[192:195], a[160:163], v[32:35]
 s_waitcnt lgkmcnt(0)
 v_mfma_f32_16x16x32_bf16 v[28:31], a[192:195], a[152:155], v[28:31]
 v_mfma_f32_16x16x32_bf16 v[28:31], a[196:199], a[156:159], v[28:31]
 v_mfma_f32_16x16x32_bf16 v[24:27], a[196:199], a[148:151], v[24:27]
 v_mfma_f32_16x16x32_bf16 v[24:27], a[192:195], a[144:147], v[24:27]
 v_mfma_f32_16x16x32_bf16 v[20:23], a[192:195], a[136:139], v[20:23]
 v_mfma_f32_16x16x32_bf16 v[20:23], a[196:199], a[140:143], v[20:23]
 v_mfma_f32_16x16x32_bf16 v[16:19], a[196:199], a[132:135], v[16:19]
 v_mfma_f32_16x16x32_bf16 v[16:19], a[192:195], a[128:131], v[16:19]
 s_waitcnt vmcnt(24)
 v_mfma_f32_16x16x32_bf16 v[48:51], a[200:203], a[128:131], v[48:51]
 v_mfma_f32_16x16x32_bf16 v[48:51], a[204:207], a[132:135], v[48:51]
 global_load_dwordx4 a[196:199], v0, s[70:71] offset:1024 sc1
 v_mfma_f32_16x16x32_bf16 v[52:55], a[204:207], a[140:143], v[52:55]
 v_mfma_f32_16x16x32_bf16 v[52:55], a[200:203], a[136:139], v[52:55]
 global_load_dwordx4 a[192:195], v0, s[70:71] offset:0 sc1
 v_mfma_f32_16x16x32_bf16 v[56:59], a[200:203], a[144:147], v[56:59]
 v_mfma_f32_16x16x32_bf16 v[56:59], a[204:207], a[148:151], v[56:59]
 v_mfma_f32_16x16x32_bf16 v[60:63], a[204:207], a[156:159], v[60:63]
 v_mfma_f32_16x16x32_bf16 v[60:63], a[200:203], a[152:155], v[60:63]
 v_mfma_f32_16x16x32_bf16 v[64:67], a[200:203], a[160:163], v[64:67]
 v_mfma_f32_16x16x32_bf16 v[64:67], a[204:207], a[164:167], v[64:67]
 v_mfma_f32_16x16x32_bf16 v[68:71], a[204:207], a[172:175], v[68:71]
 v_mfma_f32_16x16x32_bf16 v[68:71], a[200:203], a[168:171], v[68:71]
 v_mfma_f32_16x16x32_bf16 v[72:75], a[200:203], a[176:179], v[72:75]
 v_mfma_f32_16x16x32_bf16 v[72:75], a[204:207], a[180:183], v[72:75]
 v_mfma_f32_16x16x32_bf16 v[76:79], a[204:207], a[188:191], v[76:79]
 v_mfma_f32_16x16x32_bf16 v[76:79], a[200:203], a[184:187], v[76:79]
 s_waitcnt vmcnt(24)
 v_mfma_f32_16x16x32_bf16 v[108:111], a[208:211], a[184:187], v[108:111]
 v_mfma_f32_16x16x32_bf16 v[108:111], a[212:215], a[188:191], v[108:111]
 global_load_dwordx4 a[204:207], v0, s[70:71] offset:3072 sc1
 v_mfma_f32_16x16x32_bf16 v[104:107], a[212:215], a[180:183], v[104:107]
 v_mfma_f32_16x16x32_bf16 v[104:107], a[208:211], a[176:179], v[104:107]
 global_load_dwordx4 a[200:203], v0, s[70:71] offset:2048 sc1
 v_mfma_f32_16x16x32_bf16 v[100:103], a[208:211], a[168:171], v[100:103]
 s_add_u32 s70, s70, 8192
 s_addc_u32 s71, s71, 0
 v_mfma_f32_16x16x32_bf16 v[100:103], a[212:215], a[172:175], v[100:103]
 v_mfma_f32_16x16x32_bf16 v[96:99], a[212:215], a[164:167], v[96:99]
 v_mfma_f32_16x16x32_bf16 v[96:99], a[208:211], a[160:163], v[96:99]
 v_mfma_f32_16x16x32_bf16 v[92:95], a[208:211], a[152:155], v[92:95]
 v_mfma_f32_16x16x32_bf16 v[92:95], a[212:215], a[156:159], v[92:95]
 v_mfma_f32_16x16x32_bf16 v[88:91], a[212:215], a[148:151], v[88:91]
 v_mfma_f32_16x16x32_bf16 v[88:91], a[208:211], a[144:147], v[88:91]
 v_mfma_f32_16x16x32_bf16 v[84:87], a[208:211], a[136:139], v[84:87]
 v_mfma_f32_16x16x32_bf16 v[84:87], a[212:215], a[140:143], v[84:87]
 v_mfma_f32_16x16x32_bf16 v[80:83], a[212:215], a[132:135], v[80:83]
 v_mfma_f32_16x16x32_bf16 v[80:83], a[208:211], a[128:131], v[80:83]
 s_waitcnt vmcnt(24)
 v_mfma_f32_16x16x32_bf16 v[112:115], a[216:219], a[128:131], v[112:115]
 ds_read_b128 a[128:131], v1
 v_mfma_f32_16x16x32_bf16 v[112:115], a[220:223], a[132:135], v[112:115]
 global_load_dwordx4 a[212:215], v0, s[70:71] offset:-3072 sc1
 ds_read_b128 a[132:135], v1 offset:1024
 v_mfma_f32_16x16x32_bf16 v[116:119], a[220:223], a[140:143], v[116:119]
 ds_read_b128 a[140:143], v1 offset:5120
 v_mfma_f32_16x16x32_bf16 v[116:119], a[216:219], a[136:139], v[116:119]
 global_load_dwordx4 a[208:211], v0, s[70:71] offset:-4096 sc1
 ds_read_b128 a[136:139], v1 offset:4096
 v_mfma_f32_16x16x32_bf16 v[120:123], a[216:219], a[144:147], v[120:123]
 ds_read_b128 a[144:147], v1 offset:8192
 v_mfma_f32_16x16x32_bf16 v[120:123], a[220:223], a[148:151], v[120:123]
 ds_read_b128 a[148:151], v1 offset:9216
 v_mfma_f32_16x16x32_bf16 v[124:127], a[220:223], a[156:159], v[124:127]
 ds_read_b128 a[156:159], v1 offset:13312
 v_mfma_f32_16x16x32_bf16 v[124:127], a[216:219], a[152:155], v[124:127]
 ds_read_b128 a[152:155], v1 offset:12288
 v_mfma_f32_16x16x32_bf16 v[128:131], a[216:219], a[160:163], v[128:131]
 ds_read_b128 a[160:163], v1 offset:16384
 v_mfma_f32_16x16x32_bf16 v[128:131], a[220:223], a[164:167], v[128:131]
 ds_read_b128 a[164:167], v1 offset:17408
 v_mfma_f32_16x16x32_bf16 v[132:135], a[220:223], a[172:175], v[132:135]
 ds_read_b128 a[172:175], v1 offset:21504
 v_mfma_f32_16x16x32_bf16 v[132:135], a[216:219], a[168:171], v[132:135]
 ds_read_b128 a[168:171], v1 offset:20480
 v_mfma_f32_16x16x32_bf16 a[240:243], a[216:219], a[176:179], a[240:243]
 ds_read_b128 a[176:179], v1 offset:24576
 v_mfma_f32_16x16x32_bf16 a[240:243], a[220:223], a[180:183], a[240:243]
 ds_read_b128 a[180:183], v1 offset:25600
 v_mfma_f32_16x16x32_bf16 a[244:247], a[220:223], a[188:191], a[244:247]
 global_load_dwordx4 a[220:223], v0, s[70:71] offset:-1024 sc1
 ds_read_b128 a[188:191], v1 offset:29696
 v_mfma_f32_16x16x32_bf16 a[244:247], a[216:219], a[184:187], a[244:247]
 global_load_dwordx4 a[216:219], v0, s[70:71] offset:-2048 sc1
 ds_read_b128 a[184:187], v1 offset:28672
 s_waitcnt vmcnt(10) lgkmcnt(8)
 v_mfma_f32_16x16x32_bf16 v[136:139], a[224:227], a[128:131], v[136:139]
 v_lshrrev_b32 v5, 4, v1
 v_mfma_f32_16x16x32_bf16 v[136:139], a[228:231], a[132:135], v[136:139]
 v_and_b32 v5, 48, v5
 v_mfma_f32_16x16x32_bf16 v[140:143], a[228:231], a[140:143], v[140:143]
 v_xor_b32 v5, v5, v1
 v_mfma_f32_16x16x32_bf16 v[140:143], a[224:227], a[136:139], v[140:143]
 v_and_b32 v5, 112, v5
 v_mfma_f32_16x16x32_bf16 v[144:147], a[224:227], a[144:147], v[144:147]
 v_and_b32 v6, 240, v1
 v_mfma_f32_16x16x32_bf16 v[144:147], a[228:231], a[148:151], v[144:147]
 v_lshl_add_u32 v5, v6, 3, v5
 v_mfma_f32_16x16x32_bf16 v[148:151], a[228:231], a[156:159], v[148:151]
 v_add_u32 v8, s50, v5
 v_mfma_f32_16x16x32_bf16 v[148:151], a[224:227], a[152:155], v[148:151]
 v_xor_b32 v9, 64, v8
 s_waitcnt lgkmcnt(0)
 v_mfma_f32_16x16x32_bf16 v[152:155], a[224:227], a[160:163], v[152:155]
 v_mfma_f32_16x16x32_bf16 v[152:155], a[228:231], a[164:167], v[152:155]
 ds_read_b128 a[64:67], v8 offset:2048
 ds_read_b128 a[96:99], v9 offset:2048
 v_mfma_f32_16x16x32_bf16 v[156:159], a[228:231], a[172:175], v[156:159]
 v_mfma_f32_16x16x32_bf16 v[156:159], a[224:227], a[168:171], v[156:159]
 v_mfma_f32_16x16x32_bf16 v[160:163], a[224:227], a[176:179], v[160:163]
 v_mfma_f32_16x16x32_bf16 v[160:163], a[228:231], a[180:183], v[160:163]
 v_mfma_f32_16x16x32_bf16 v[164:167], a[228:231], a[188:191], v[164:167]
 ds_read_b128 a[68:71], v8 offset:6144
 v_mfma_f32_16x16x32_bf16 v[164:167], a[224:227], a[184:187], v[164:167]
 ds_read_b128 a[100:103], v9 offset:6144
 s_waitcnt vmcnt(8)
 v_mfma_f32_16x16x32_bf16 v[196:199], a[232:235], a[184:187], v[196:199]
 v_mfma_f32_16x16x32_bf16 v[196:199], a[236:239], a[188:191], v[196:199]
 global_load_dwordx4 a[228:231], v0, s[70:71] offset:1024 sc1
 v_mfma_f32_16x16x32_bf16 v[192:195], a[236:239], a[180:183], v[192:195]
 v_mfma_f32_16x16x32_bf16 v[192:195], a[232:235], a[176:179], v[192:195]
 global_load_dwordx4 a[224:227], v0, s[70:71] offset:0 sc1
 s_waitcnt lgkmcnt(2)
 v_mfma_f32_16x16x32_bf16 v[188:191], a[232:235], a[168:171], v[188:191]
 ds_write_b128 v3, a[64:67] offset:2048
 v_mfma_f32_16x16x32_bf16 v[188:191], a[236:239], a[172:175], v[188:191]
 ds_write_b128 v3, a[96:99] offset:3072
 v_mfma_f32_16x16x32_bf16 v[184:187], a[236:239], a[164:167], v[184:187]
 v_mfma_f32_16x16x32_bf16 v[184:187], a[232:235], a[160:163], v[184:187]
 ds_read_b128 a[72:75], v8 offset:10240
 v_mfma_f32_16x16x32_bf16 v[180:183], a[232:235], a[152:155], v[180:183]
 ds_read_b128 a[104:107], v9 offset:10240
 v_mfma_f32_16x16x32_bf16 v[180:183], a[236:239], a[156:159], v[180:183]
 v_mfma_f32_16x16x32_bf16 v[176:179], a[236:239], a[148:151], v[176:179]
 v_mfma_f32_16x16x32_bf16 v[176:179], a[232:235], a[144:147], v[176:179]
 v_mfma_f32_16x16x32_bf16 v[172:175], a[232:235], a[136:139], v[172:175]
 s_waitcnt lgkmcnt(4)
 v_mfma_f32_16x16x32_bf16 v[172:175], a[236:239], a[140:143], v[172:175]
 ds_write_b128 v3, a[68:71] offset:6144
 ds_write_b128 v3, a[100:103] offset:7168
 v_mfma_f32_16x16x32_bf16 v[168:171], a[236:239], a[132:135], v[168:171]
 v_mfma_f32_16x16x32_bf16 v[168:171], a[232:235], a[128:131], v[168:171]
 ds_read_b128 a[76:79], v8 offset:14336
 s_waitcnt vmcnt(8)
 v_mfma_f32_16x16x32_bf16 v[200:203], a[192:195], a[128:131], v[200:203]
 ds_read_b128 a[108:111], v9 offset:14336
 v_mfma_f32_16x16x32_bf16 v[200:203], a[196:199], a[132:135], v[200:203]
 global_load_dwordx4 a[236:239], v0, s[70:71] offset:3072 sc1
 v_mfma_f32_16x16x32_bf16 v[204:207], a[196:199], a[140:143], v[204:207]
 v_mfma_f32_16x16x32_bf16 v[204:207], a[192:195], a[136:139], v[204:207]
 global_load_dwordx4 a[232:235], v0, s[70:71] offset:2048 sc1
 v_mfma_f32_16x16x32_bf16 v[208:211], a[192:195], a[144:147], v[208:211]
 s_waitcnt lgkmcnt(4)
 s_add_u32 s70, s70, 8192
 s_addc_u32 s71, s71, 0
 v_mfma_f32_16x16x32_bf16 v[208:211], a[196:199], a[148:151], v[208:211]
 ds_write_b128 v3, a[72:75] offset:10240
 v_mfma_f32_16x16x32_bf16 v[212:215], a[196:199], a[156:159], v[212:215]
 ds_write_b128 v3, a[104:107] offset:11264
 v_mfma_f32_16x16x32_bf16 v[212:215], a[192:195], a[152:155], v[212:215]
 v_mfma_f32_16x16x32_bf16 v[216:219], a[192:195], a[160:163], v[216:219]
 ds_read_b128 a[80:83], v8 offset:18432
 v_mfma_f32_16x16x32_bf16 v[216:219], a[196:199], a[164:167], v[216:219]
 ds_read_b128 a[112:115], v9 offset:18432
 v_mfma_f32_16x16x32_bf16 v[220:223], a[196:199], a[172:175], v[220:223]
 v_mfma_f32_16x16x32_bf16 v[220:223], a[192:195], a[168:171], v[220:223]
 v_mfma_f32_16x16x32_bf16 v[224:227], a[192:195], a[176:179], v[224:227]
 s_waitcnt lgkmcnt(4)
 ds_write_b128 v3, a[76:79] offset:14336
 ds_write_b128 v3, a[108:111] offset:15360
 v_mfma_f32_16x16x32_bf16 v[224:227], a[196:199], a[180:183], v[224:227]
 v_mfma_f32_16x16x32_bf16 v[228:231], a[196:199], a[188:191], v[228:231]
 v_mfma_f32_16x16x32_bf16 v[228:231], a[192:195], a[184:187], v[228:231]
 s_waitcnt vmcnt(8)
 v_mfma_f32_16x16x32_bf16 a[252:255], a[200:203], a[184:187], a[252:255]
 ds_read_b128 a[184:187], v1 offset:61440
 ds_read_b128 a[84:87], v8 offset:22528
 v_mfma_f32_16x16x32_bf16 a[252:255], a[204:207], a[188:191], a[252:255]
 global_load_dwordx4 a[196:199], v0, s[70:71] offset:-3072 sc1
 ds_read_b128 a[188:191], v1 offset:62464
 v_mfma_f32_16x16x32_bf16 a[248:251], a[204:207], a[180:183], a[248:251]
 ds_read_b128 a[180:183], v1 offset:58368
 ds_read_b128 a[116:119], v9 offset:22528
 v_mfma_f32_16x16x32_bf16 a[248:251], a[200:203], a[176:179], a[248:251]
 global_load_dwordx4 a[192:195], v0, s[70:71] offset:-4096 sc1
 ds_read_b128 a[176:179], v1 offset:57344
 v_mfma_f32_16x16x32_bf16 v[252:255], a[200:203], a[168:171], v[252:255]
 ds_read_b128 a[168:171], v1 offset:53248
 v_mfma_f32_16x16x32_bf16 v[252:255], a[204:207], a[172:175], v[252:255]
 ds_read_b128 a[172:175], v1 offset:54272
 s_waitcnt lgkmcnt(10)
 v_mfma_f32_16x16x32_bf16 v[248:251], a[204:207], a[164:167], v[248:251]
 ds_read_b128 a[164:167], v1 offset:50176
 v_mfma_f32_16x16x32_bf16 v[248:251], a[200:203], a[160:163], v[248:251]
 ds_read_b128 a[160:163], v1 offset:49152
 v_mfma_f32_16x16x32_bf16 v[244:247], a[200:203], a[152:155], v[244:247]
 ds_read_b128 a[152:155], v1 offset:45056
 v_mfma_f32_16x16x32_bf16 v[244:247], a[204:207], a[156:159], v[244:247]
 ds_read_b128 a[156:159], v1 offset:46080
 v_mfma_f32_16x16x32_bf16 v[240:243], a[204:207], a[148:151], v[240:243]
 ds_read_b128 a[148:151], v1 offset:41984
 v_mfma_f32_16x16x32_bf16 v[240:243], a[200:203], a[144:147], v[240:243]
 ds_read_b128 a[144:147], v1 offset:40960
 v_mfma_f32_16x16x32_bf16 v[236:239], a[200:203], a[136:139], v[236:239]
 ds_read_b128 a[136:139], v1 offset:36864
 v_mfma_f32_16x16x32_bf16 v[236:239], a[204:207], a[140:143], v[236:239]
 ds_read_b128 a[140:143], v1 offset:37888
 v_mfma_f32_16x16x32_bf16 v[232:235], a[204:207], a[132:135], v[232:235]
 ds_read_b128 a[132:135], v1 offset:33792
 v_mfma_f32_16x16x32_bf16 v[232:235], a[200:203], a[128:131], v[232:235]
 ds_read_b128 a[128:131], v1 offset:32768
 ds_write_b128 v3, a[80:83] offset:18432
 ds_write_b128 v3, a[112:115] offset:19456
 ds_read_b128 a[88:91], v8 offset:26624
 ds_read_b128 a[120:123], v9 offset:26624
 s_waitcnt vmcnt(8) lgkmcnt(12)
 v_mfma_f32_16x16x32_bf16 v[164:167], a[208:211], a[184:187], v[164:167]
 v_mfma_f32_16x16x32_bf16 v[164:167], a[212:215], a[188:191], v[164:167]
 global_load_dwordx4 a[204:207], v0, s[70:71] offset:-1024 sc1
 v_mfma_f32_16x16x32_bf16 v[160:163], a[212:215], a[180:183], v[160:163]
 ds_write_b128 v3, a[84:87] offset:22528
 ds_write_b128 v3, a[116:119] offset:23552
 v_mfma_f32_16x16x32_bf16 v[160:163], a[208:211], a[176:179], v[160:163]
 global_load_dwordx4 a[200:203], v0, s[70:71] offset:-2048 sc1
 ds_read_b128 a[92:95], v8 offset:30720
 v_mfma_f32_16x16x32_bf16 v[156:159], a[208:211], a[168:171], v[156:159]
 ds_read_b128 a[124:127], v9 offset:30720
 v_mfma_f32_16x16x32_bf16 v[156:159], a[212:215], a[172:175], v[156:159]
 v_mfma_f32_16x16x32_bf16 v[152:155], a[212:215], a[164:167], v[152:155]
 v_mfma_f32_16x16x32_bf16 v[152:155], a[208:211], a[160:163], v[152:155]
 s_waitcnt lgkmcnt(4)
 ds_write_b128 v3, a[88:91] offset:26624
 v_mfma_f32_16x16x32_bf16 v[148:151], a[208:211], a[152:155], v[148:151]
 ds_write_b128 v3, a[120:123] offset:27648
 v_mfma_f32_16x16x32_bf16 v[148:151], a[212:215], a[156:159], v[148:151]
 v_mfma_f32_16x16x32_bf16 v[144:147], a[212:215], a[148:151], v[144:147]
 v_mfma_f32_16x16x32_bf16 v[144:147], a[208:211], a[144:147], v[144:147]
 v_mfma_f32_16x16x32_bf16 v[140:143], a[208:211], a[136:139], v[140:143]
 v_mfma_f32_16x16x32_bf16 v[140:143], a[212:215], a[140:143], v[140:143]
 s_waitcnt lgkmcnt(2)
 v_mfma_f32_16x16x32_bf16 v[136:139], a[212:215], a[132:135], v[136:139]
 ds_write_b128 v3, a[92:95] offset:30720
 v_mfma_f32_16x16x32_bf16 v[136:139], a[208:211], a[128:131], v[136:139]
 ds_write_b128 v3, a[124:127] offset:31744
 s_waitcnt vmcnt(8)
 v_mfma_f32_16x16x32_bf16 v[168:171], a[216:219], a[128:131], v[168:171]
 v_bfe_u32 v4, v3, 8, 2
 v_mfma_f32_16x16x32_bf16 v[168:171], a[220:223], a[132:135], v[168:171]
 global_load_dwordx4 a[212:215], v0, s[70:71] offset:1024 sc1
 v_lshl_add_u32 v4, v4, 5, s51
 v_mfma_f32_16x16x32_bf16 v[172:175], a[220:223], a[140:143], v[172:175]
 ds_read_b128 v[8:11], v4
 v_mfma_f32_16x16x32_bf16 v[172:175], a[216:219], a[136:139], v[172:175]
 global_load_dwordx4 a[208:211], v0, s[70:71] offset:0 sc1
 v_mfma_f32_16x16x32_bf16 v[176:179], a[216:219], a[144:147], v[176:179]
 v_mfma_f32_16x16x32_bf16 v[176:179], a[220:223], a[148:151], v[176:179]
 v_mfma_f32_16x16x32_bf16 v[180:183], a[220:223], a[156:159], v[180:183]
 v_mfma_f32_16x16x32_bf16 v[180:183], a[216:219], a[152:155], v[180:183]
 v_mfma_f32_16x16x32_bf16 v[184:187], a[216:219], a[160:163], v[184:187]
 v_mfma_f32_16x16x32_bf16 v[184:187], a[220:223], a[164:167], v[184:187]
 v_mfma_f32_16x16x32_bf16 v[188:191], a[220:223], a[172:175], v[188:191]
 v_mfma_f32_16x16x32_bf16 v[188:191], a[216:219], a[168:171], v[188:191]
 s_waitcnt lgkmcnt(0)
 v_add_f32 v16, v16, v8
 v_mfma_f32_16x16x32_bf16 v[192:195], a[216:219], a[176:179], v[192:195]
 ds_read_b128 v[12:15], v4 offset:16
 v_mfma_f32_16x16x32_bf16 v[192:195], a[220:223], a[180:183], v[192:195]
 v_add_f32 v17, v17, v9
 v_mfma_f32_16x16x32_bf16 v[196:199], a[220:223], a[188:191], v[196:199]
 v_add_f32 v18, v18, v10
 v_mfma_f32_16x16x32_bf16 v[196:199], a[216:219], a[184:187], v[196:199]
 v_add_f32 v19, v19, v11
 s_waitcnt vmcnt(8)
 v_mfma_f32_16x16x32_bf16 v[228:231], a[224:227], a[184:187], v[228:231]
 v_add_f32 v20, v20, v8
 v_mfma_f32_16x16x32_bf16 v[228:231], a[228:231], a[188:191], v[228:231]
 global_load_dwordx4 a[220:223], v0, s[70:71] offset:3072 sc1
 v_add_f32 v21, v21, v9
 v_mfma_f32_16x16x32_bf16 v[224:227], a[228:231], a[180:183], v[224:227]
 v_add_f32 v22, v22, v10
 v_mfma_f32_16x16x32_bf16 v[224:227], a[224:227], a[176:179], v[224:227]
 global_load_dwordx4 a[216:219], v0, s[70:71] offset:2048 sc1
 v_add_f32 v23, v23, v11
 v_mfma_f32_16x16x32_bf16 v[220:223], a[224:227], a[168:171], v[220:223]
 v_add_f32 v24, v24, v8
 s_add_u32 s70, s70, 8192
 s_addc_u32 s71, s71, 0
 v_mfma_f32_16x16x32_bf16 v[220:223], a[228:231], a[172:175], v[220:223]
 v_add_f32 v25, v25, v9
 v_mfma_f32_16x16x32_bf16 v[216:219], a[228:231], a[164:167], v[216:219]
 v_add_f32 v26, v26, v10
 v_mfma_f32_16x16x32_bf16 v[216:219], a[224:227], a[160:163], v[216:219]
 v_add_f32 v27, v27, v11
 v_mfma_f32_16x16x32_bf16 v[212:215], a[224:227], a[152:155], v[212:215]
 v_add_f32 v28, v28, v8
 v_mfma_f32_16x16x32_bf16 v[212:215], a[228:231], a[156:159], v[212:215]
 v_add_f32 v29, v29, v9
 v_mfma_f32_16x16x32_bf16 v[208:211], a[228:231], a[148:151], v[208:211]
 v_add_f32 v30, v30, v10
 v_mfma_f32_16x16x32_bf16 v[208:211], a[224:227], a[144:147], v[208:211]
 v_add_f32 v31, v31, v11
 v_add_f32 v32, v32, v8
 v_mfma_f32_16x16x32_bf16 v[204:207], a[224:227], a[136:139], v[204:207]
 v_add_f32 v33, v33, v9
 v_mfma_f32_16x16x32_bf16 v[204:207], a[228:231], a[140:143], v[204:207]
 v_add_f32 v34, v34, v10
 v_mfma_f32_16x16x32_bf16 v[200:203], a[228:231], a[132:135], v[200:203]
 v_add_f32 v35, v35, v11
 v_mfma_f32_16x16x32_bf16 v[200:203], a[224:227], a[128:131], v[200:203]
 v_add_f32 v36, v36, v8
 v_add_f32 v37, v37, v9
 s_waitcnt vmcnt(8)
 v_mfma_f32_16x16x32_bf16 v[232:235], a[232:235], a[128:131], v[232:235]
 ds_read_b128 a[128:131], v2
 v_add_f32 v38, v38, v10
 v_mfma_f32_16x16x32_bf16 v[232:235], a[236:239], a[132:135], v[232:235]
 global_load_dwordx4 a[228:231], v0, s[70:71] offset:-3072 sc1
 ds_read_b128 a[132:135], v2 offset:1024
 v_mfma_f32_16x16x32_bf16 v[236:239], a[236:239], a[140:143], v[236:239]
 ds_read_b128 a[140:143], v2 offset:5120
 v_add_f32 v39, v39, v11
 v_mfma_f32_16x16x32_bf16 v[236:239], a[232:235], a[136:139], v[236:239]
 global_load_dwordx4 a[224:227], v0, s[70:71] offset:-4096 sc1
 ds_read_b128 a[136:139], v2 offset:4096
 v_mfma_f32_16x16x32_bf16 v[240:243], a[232:235], a[144:147], v[240:243]
 ds_read_b128 a[144:147], v2 offset:8192
 v_add_f32 v40, v40, v8
 v_mfma_f32_16x16x32_bf16 v[240:243], a[236:239], a[148:151], v[240:243]
 ds_read_b128 a[148:151], v2 offset:9216
 v_add_f32 v41, v41, v9
 v_mfma_f32_16x16x32_bf16 v[244:247], a[236:239], a[156:159], v[244:247]
 ds_read_b128 a[156:159], v2 offset:13312
 v_add_f32 v42, v42, v10
 v_mfma_f32_16x16x32_bf16 v[244:247], a[232:235], a[152:155], v[244:247]
 ds_read_b128 a[152:155], v2 offset:12288
 v_add_f32 v43, v43, v11
 v_mfma_f32_16x16x32_bf16 v[248:251], a[232:235], a[160:163], v[248:251]
 ds_read_b128 a[160:163], v2 offset:16384
 v_add_f32 v44, v44, v8
 v_mfma_f32_16x16x32_bf16 v[248:251], a[236:239], a[164:167], v[248:251]
 ds_read_b128 a[164:167], v2 offset:17408
 v_add_f32 v45, v45, v9
 v_mfma_f32_16x16x32_bf16 v[252:255], a[236:239], a[172:175], v[252:255]
 ds_read_b128 a[172:175], v2 offset:21504
 v_add_f32 v46, v46, v10
 v_mfma_f32_16x16x32_bf16 v[252:255], a[232:235], a[168:171], v[252:255]
 ds_read_b128 a[168:171], v2 offset:20480
 v_add_f32 v47, v47, v11
 s_waitcnt lgkmcnt(12)
 v_mfma_f32_16x16x32_bf16 a[248:251], a[232:235], a[176:179], a[248:251]
 ds_read_b128 a[176:179], v2 offset:24576
 v_add_f32 v48, v48, v12
 v_mfma_f32_16x16x32_bf16 a[248:251], a[236:239], a[180:183], a[248:251]
 ds_read_b128 a[180:183], v2 offset:25600
 ds_read_b128 v[8:11], v4 offset:128
 v_mfma_f32_16x16x32_bf16 a[252:255], a[236:239], a[188:191], a[252:255]
 ds_read_b128 a[188:191], v2 offset:29696
 v_add_f32 v49, v49, v13
 v_mfma_f32_16x16x32_bf16 a[252:255], a[232:235], a[184:187], a[252:255]
 ds_read_b128 a[184:187], v2 offset:28672
 v_add_f32 v50, v50, v14
 s_waitcnt vmcnt(8) lgkmcnt(9)
 v_mfma_f32_16x16x32_bf16 v[136:139], a[192:195], a[128:131], v[136:139]
 v_add_f32 v51, v51, v15
 v_add_f32 v52, v52, v12
 v_mfma_f32_16x16x32_bf16 v[136:139], a[196:199], a[132:135], v[136:139]
 global_load_dwordx4 a[236:239], v0, s[70:71] offset:-1024 sc1
 v_add_f32 v53, v53, v13
 v_mfma_f32_16x16x32_bf16 v[140:143], a[196:199], a[140:143], v[140:143]
 v_add_f32 v54, v54, v14
 v_mfma_f32_16x16x32_bf16 v[140:143], a[192:195], a[136:139], v[140:143]
 global_load_dwordx4 a[232:235], v0, s[70:71] offset:-2048 sc1
 v_add_f32 v55, v55, v15
 v_mfma_f32_16x16x32_bf16 v[144:147], a[192:195], a[144:147], v[144:147]
 v_add_f32 v56, v56, v12
 v_mfma_f32_16x16x32_bf16 v[144:147], a[196:199], a[148:151], v[144:147]
 v_add_f32 v57, v57, v13
 v_mfma_f32_16x16x32_bf16 v[148:151], a[196:199], a[156:159], v[148:151]
 v_add_f32 v58, v58, v14
 v_mfma_f32_16x16x32_bf16 v[148:151], a[192:195], a[152:155], v[148:151]
 v_add_f32 v59, v59, v15
 s_waitcnt lgkmcnt(0)
 v_mfma_f32_16x16x32_bf16 v[152:155], a[192:195], a[160:163], v[152:155]
 v_add_f32 v60, v60, v12
 v_mfma_f32_16x16x32_bf16 v[152:155], a[196:199], a[164:167], v[152:155]
 v_add_f32 v61, v61, v13
 v_mfma_f32_16x16x32_bf16 v[156:159], a[196:199], a[172:175], v[156:159]
 v_add_f32 v62, v62, v14
 v_mfma_f32_16x16x32_bf16 v[156:159], a[192:195], a[168:171], v[156:159]
 v_add_f32 v63, v63, v15
 v_mfma_f32_16x16x32_bf16 v[160:163], a[192:195], a[176:179], v[160:163]
 v_add_f32 v64, v64, v12
 v_mfma_f32_16x16x32_bf16 v[160:163], a[196:199], a[180:183], v[160:163]
 v_add_f32 v65, v65, v13
 v_mfma_f32_16x16x32_bf16 v[164:167], a[196:199], a[188:191], v[164:167]
 v_add_f32 v66, v66, v14
 v_mfma_f32_16x16x32_bf16 v[164:167], a[192:195], a[184:187], v[164:167]
 v_add_f32 v67, v67, v15
 s_waitcnt vmcnt(8)
 v_mfma_f32_16x16x32_bf16 v[196:199], a[200:203], a[184:187], v[196:199]
 v_add_f32 v68, v68, v12
 v_mfma_f32_16x16x32_bf16 v[196:199], a[204:207], a[188:191], v[196:199]
 global_load_dwordx4 a[196:199], v0, s[70:71] offset:1024 sc1
 v_add_f32 v69, v69, v13
 v_mfma_f32_16x16x32_bf16 v[192:195], a[204:207], a[180:183], v[192:195]
 v_add_f32 v70, v70, v14
 v_add_f32 v71, v71, v15
 v_mfma_f32_16x16x32_bf16 v[192:195], a[200:203], a[176:179], v[192:195]
 global_load_dwordx4 a[192:195], v0, s[70:71] offset:0 sc1
 v_add_f32 v72, v72, v12
 v_mfma_f32_16x16x32_bf16 v[188:191], a[200:203], a[168:171], v[188:191]
 v_add_f32 v73, v73, v13
 v_mfma_f32_16x16x32_bf16 v[188:191], a[204:207], a[172:175], v[188:191]
 v_add_f32 v74, v74, v14
 v_mfma_f32_16x16x32_bf16 v[184:187], a[204:207], a[164:167], v[184:187]
 v_add_f32 v75, v75, v15
 v_mfma_f32_16x16x32_bf16 v[184:187], a[200:203], a[160:163], v[184:187]
 v_add_f32 v76, v76, v12
 v_mfma_f32_16x16x32_bf16 v[180:183], a[200:203], a[152:155], v[180:183]
 v_add_f32 v77, v77, v13
 v_mfma_f32_16x16x32_bf16 v[180:183], a[204:207], a[156:159], v[180:183]
 v_add_f32 v78, v78, v14
 v_mfma_f32_16x16x32_bf16 v[176:179], a[204:207], a[148:151], v[176:179]
 v_add_f32 v79, v79, v15
 v_mfma_f32_16x16x32_bf16 v[176:179], a[200:203], a[144:147], v[176:179]
 v_mfma_f32_16x16x32_bf16 v[172:175], a[200:203], a[136:139], v[172:175]
 v_add_f32 v80, v80, v8
 v_mfma_f32_16x16x32_bf16 v[172:175], a[204:207], a[140:143], v[172:175]
 ds_read_b128 v[12:15], v4 offset:144
 v_mfma_f32_16x16x32_bf16 v[168:171], a[204:207], a[132:135], v[168:171]
 v_add_f32 v81, v81, v9
 v_mfma_f32_16x16x32_bf16 v[168:171], a[200:203], a[128:131], v[168:171]
 v_add_f32 v82, v82, v10
 s_waitcnt vmcnt(8)
 v_mfma_f32_16x16x32_bf16 v[200:203], a[208:211], a[128:131], v[200:203]
 v_add_f32 v83, v83, v11
 v_mfma_f32_16x16x32_bf16 v[200:203], a[212:215], a[132:135], v[200:203]
 global_load_dwordx4 a[204:207], v0, s[70:71] offset:3072 sc1
 v_add_f32 v84, v84, v8
 v_mfma_f32_16x16x32_bf16 v[204:207], a[212:215], a[140:143], v[204:207]
 v_add_f32 v85, v85, v9
 v_mfma_f32_16x16x32_bf16 v[204:207], a[208:211], a[136:139], v[204:207]
 global_load_dwordx4 a[200:203], v0, s[70:71] offset:2048 sc1
 v_add_f32 v86, v86, v10
 v_mfma_f32_16x16x32_bf16 v[208:211], a[208:211], a[144:147], v[208:211]
 v_add_f32 v87, v87, v11
 s_add_u32 s70, s70, 8192
 s_addc_u32 s71, s71, 0
 v_mfma_f32_16x16x32_bf16 v[208:211], a[212:215], a[148:151], v[208:211]
 v_add_f32 v88, v88, v8
 v_add_f32 v89, v89, v9
 v_mfma_f32_16x16x32_bf16 v[212:215], a[212:215], a[156:159], v[212:215]
 v_add_f32 v90, v90, v10
 v_mfma_f32_16x16x32_bf16 v[212:215], a[208:211], a[152:155], v[212:215]
 v_add_f32 v91, v91, v11
 v_mfma_f32_16x16x32_bf16 v[216:219], a[208:211], a[160:163], v[216:219]
 v_add_f32 v92, v92, v8
 v_mfma_f32_16x16x32_bf16 v[216:219], a[212:215], a[164:167], v[216:219]
 v_add_f32 v93, v93, v9
 v_mfma_f32_16x16x32_bf16 v[220:223], a[212:215], a[172:175], v[220:223]
 v_add_f32 v94, v94, v10
 v_mfma_f32_16x16x32_bf16 v[220:223], a[208:211], a[168:171], v[220:223]
 v_add_f32 v95, v95, v11
 v_mfma_f32_16x16x32_bf16 v[224:227], a[208:211], a[176:179], v[224:227]
 v_add_f32 v96, v96, v8
 v_mfma_f32_16x16x32_bf16 v[224:227], a[212:215], a[180:183], v[224:227]
 v_add_f32 v97, v97, v9
 v_mfma_f32_16x16x32_bf16 v[228:231], a[212:215], a[188:191], v[228:231]
 v_add_f32 v98, v98, v10
 v_add_f32 v99, v99, v11
 v_mfma_f32_16x16x32_bf16 v[228:231], a[208:211], a[184:187], v[228:231]
 v_add_f32 v100, v100, v8
 v_add_f32 v101, v101, v9
 s_waitcnt vmcnt(8)
 v_mfma_f32_16x16x32_bf16 a[252:255], a[216:219], a[184:187], a[252:255]
 ds_read_b128 a[184:187], v2 offset:61440
 v_add_f32 v102, v102, v10
 v_mfma_f32_16x16x32_bf16 a[252:255], a[220:223], a[188:191], a[252:255]
 global_load_dwordx4 a[212:215], v0, s[70:71] offset:-3072 sc1
 ds_read_b128 a[188:191], v2 offset:62464
 v_mfma_f32_16x16x32_bf16 a[248:251], a[220:223], a[180:183], a[248:251]
 ds_read_b128 a[180:183], v2 offset:58368
 v_add_f32 v103, v103, v11
 v_mfma_f32_16x16x32_bf16 a[248:251], a[216:219], a[176:179], a[248:251]
 global_load_dwordx4 a[208:211], v0, s[70:71] offset:-4096 sc1
 ds_read_b128 a[176:179], v2 offset:57344
 v_mfma_f32_16x16x32_bf16 v[252:255], a[216:219], a[168:171], v[252:255]
 ds_read_b128 a[168:171], v2 offset:53248
 v_add_f32 v104, v104, v8
 v_mfma_f32_16x16x32_bf16 v[252:255], a[220:223], a[172:175], v[252:255]
 ds_read_b128 a[172:175], v2 offset:54272
 v_add_f32 v105, v105, v9
 v_mfma_f32_16x16x32_bf16 v[248:251], a[220:223], a[164:167], v[248:251]
 ds_read_b128 a[164:167], v2 offset:50176
 v_add_f32 v106, v106, v10
 v_mfma_f32_16x16x32_bf16 v[248:251], a[216:219], a[160:163], v[248:251]
 ds_read_b128 a[160:163], v2 offset:49152
 v_add_f32 v107, v107, v11
 v_mfma_f32_16x16x32_bf16 v[244:247], a[216:219], a[152:155], v[244:247]
 ds_read_b128 a[152:155], v2 offset:45056
 v_add_f32 v108, v108, v8
 v_mfma_f32_16x16x32_bf16 v[244:247], a[220:223], a[156:159], v[244:247]
 ds_read_b128 a[156:159], v2 offset:46080
 v_add_f32 v109, v109, v9
 v_mfma_f32_16x16x32_bf16 v[240:243], a[220:223], a[148:151], v[240:243]
 ds_read_b128 a[148:151], v2 offset:41984
 v_add_f32 v110, v110, v10
 v_mfma_f32_16x16x32_bf16 v[240:243], a[216:219], a[144:147], v[240:243]
 ds_read_b128 a[144:147], v2 offset:40960
 v_add_f32 v111, v111, v11
 s_waitcnt lgkmcnt(12)
 v_mfma_f32_16x16x32_bf16 v[236:239], a[216:219], a[136:139], v[236:239]
 ds_read_b128 a[136:139], v2 offset:36864
 v_add_f32 v112, v112, v12
 v_mfma_f32_16x16x32_bf16 v[236:239], a[220:223], a[140:143], v[236:239]
 ds_read_b128 a[140:143], v2 offset:37888
 v_add_f32 v113, v113, v13
 v_mfma_f32_16x16x32_bf16 v[232:235], a[220:223], a[132:135], v[232:235]
 ds_read_b128 a[132:135], v2 offset:33792
 v_add_f32 v114, v114, v14
 v_mfma_f32_16x16x32_bf16 v[232:235], a[216:219], a[128:131], v[232:235]
 ds_read_b128 a[128:131], v2 offset:32768
 v_add_f32 v115, v115, v15
 s_waitcnt vmcnt(8) lgkmcnt(8)
 v_mfma_f32_16x16x32_bf16 v[164:167], a[224:227], a[184:187], v[164:167]
 v_add_f32 v116, v116, v12
 v_mfma_f32_16x16x32_bf16 v[164:167], a[228:231], a[188:191], v[164:167]
 global_load_dwordx4 a[220:223], v0, s[70:71] offset:-1024 sc1
 v_add_f32 v117, v117, v13
 v_mfma_f32_16x16x32_bf16 v[160:163], a[228:231], a[180:183], v[160:163]
 v_add_f32 v118, v118, v14
 v_mfma_f32_16x16x32_bf16 v[160:163], a[224:227], a[176:179], v[160:163]
 global_load_dwordx4 a[216:219], v0, s[70:71] offset:-2048 sc1
 v_add_f32 v119, v119, v15
 v_mfma_f32_16x16x32_bf16 v[156:159], a[224:227], a[168:171], v[156:159]
 v_add_f32 v120, v120, v12
 v_mfma_f32_16x16x32_bf16 v[156:159], a[228:231], a[172:175], v[156:159]
 v_add_f32 v121, v121, v13
 v_mfma_f32_16x16x32_bf16 v[152:155], a[228:231], a[164:167], v[152:155]
 v_add_f32 v122, v122, v14
 v_mfma_f32_16x16x32_bf16 v[152:155], a[224:227], a[160:163], v[152:155]
 v_add_f32 v123, v123, v15
 s_waitcnt lgkmcnt(0)
 v_mfma_f32_16x16x32_bf16 v[148:151], a[224:227], a[152:155], v[148:151]
 v_add_f32 v124, v124, v12
 v_mfma_f32_16x16x32_bf16 v[148:151], a[228:231], a[156:159], v[148:151]
 v_add_f32 v125, v125, v13
 v_mfma_f32_16x16x32_bf16 v[144:147], a[228:231], a[148:151], v[144:147]
 v_add_f32 v126, v126, v14
 v_mfma_f32_16x16x32_bf16 v[144:147], a[224:227], a[144:147], v[144:147]
 v_add_f32 v127, v127, v15
 v_mfma_f32_16x16x32_bf16 v[140:143], a[224:227], a[136:139], v[140:143]
 v_add_f32 v128, v128, v12
 v_add_f32 v129, v129, v13
 v_mfma_f32_16x16x32_bf16 v[140:143], a[228:231], a[140:143], v[140:143]
 v_add_f32 v130, v130, v14
 v_mfma_f32_16x16x32_bf16 v[136:139], a[228:231], a[132:135], v[136:139]
 v_add_f32 v131, v131, v15
 v_mfma_f32_16x16x32_bf16 v[136:139], a[224:227], a[128:131], v[136:139]
 v_add_f32 v132, v132, v12
 s_waitcnt vmcnt(8)
 v_mfma_f32_16x16x32_bf16 v[168:171], a[232:235], a[128:131], v[168:171]
 v_add_f32 v133, v133, v13
 v_mfma_f32_16x16x32_bf16 v[168:171], a[236:239], a[132:135], v[168:171]
 global_load_dwordx4 a[228:231], v0, s[70:71] offset:1024 sc1
 v_add_f32 v134, v134, v14
 v_mfma_f32_16x16x32_bf16 v[172:175], a[236:239], a[140:143], v[172:175]
 v_add_f32 v135, v135, v15
 v_mfma_f32_16x16x32_bf16 v[172:175], a[232:235], a[136:139], v[172:175]
 global_load_dwordx4 a[224:227], v0, s[70:71] offset:0 sc1
 v_accvgpr_read_b32 v5, a240
 v_mfma_f32_16x16x32_bf16 v[176:179], a[232:235], a[144:147], v[176:179]
 v_add_f32 v5, v5, v12
 v_mfma_f32_16x16x32_bf16 v[176:179], a[236:239], a[148:151], v[176:179]
 v_accvgpr_write_b32 a240, v5
 v_mfma_f32_16x16x32_bf16 v[180:183], a[236:239], a[156:159], v[180:183]
 v_accvgpr_read_b32 v6, a241
 v_mfma_f32_16x16x32_bf16 v[180:183], a[232:235], a[152:155], v[180:183]
 v_add_f32 v6, v6, v13
 v_mfma_f32_16x16x32_bf16 v[184:187], a[232:235], a[160:163], v[184:187]
 v_accvgpr_write_b32 a241, v6
 v_mfma_f32_16x16x32_bf16 v[184:187], a[236:239], a[164:167], v[184:187]
 v_accvgpr_read_b32 v5, a242
 v_mfma_f32_16x16x32_bf16 v[188:191], a[236:239], a[172:175], v[188:191]
 v_add_f32 v5, v5, v14
 v_mfma_f32_16x16x32_bf16 v[188:191], a[232:235], a[168:171], v[188:191]
 v_accvgpr_write_b32 a242, v5
 v_mfma_f32_16x16x32_bf16 v[192:195], a[232:235], a[176:179], v[192:195]
 v_accvgpr_read_b32 v6, a243
 v_mfma_f32_16x16x32_bf16 v[192:195], a[236:239], a[180:183], v[192:195]
 v_add_f32 v6, v6, v15
 v_mfma_f32_16x16x32_bf16 v[196:199], a[236:239], a[188:191], v[196:199]
 v_accvgpr_write_b32 a243, v6
 v_mfma_f32_16x16x32_bf16 v[196:199], a[232:235], a[184:187], v[196:199]
 v_accvgpr_read_b32 v5, a244
 s_waitcnt vmcnt(8)
 v_mfma_f32_16x16x32_bf16 v[228:231], a[192:195], a[184:187], v[228:231]
 v_add_f32 v5, v5, v12
 v_accvgpr_write_b32 a244, v5
 v_mfma_f32_16x16x32_bf16 v[228:231], a[196:199], a[188:191], v[228:231]
 global_load_dwordx4 a[236:239], v0, s[70:71] offset:3072 sc1
 v_accvgpr_read_b32 v6, a245
 v_mfma_f32_16x16x32_bf16 v[224:227], a[196:199], a[180:183], v[224:227]
 v_add_f32 v6, v6, v13
 v_mfma_f32_16x16x32_bf16 v[224:227], a[192:195], a[176:179], v[224:227]
 global_load_dwordx4 a[232:235], v0, s[70:71] offset:2048 sc1
 v_accvgpr_write_b32 a245, v6
 v_mfma_f32_16x16x32_bf16 v[220:223], a[192:195], a[168:171], v[220:223]
 v_accvgpr_read_b32 v5, a246
 s_add_u32 s70, s70, 8192
 s_addc_u32 s71, s71, 0
 v_mfma_f32_16x16x32_bf16 v[220:223], a[196:199], a[172:175], v[220:223]
 v_add_f32 v5, v5, v14
 v_mfma_f32_16x16x32_bf16 v[216:219], a[196:199], a[164:167], v[216:219]
 v_accvgpr_write_b32 a246, v5
 v_mfma_f32_16x16x32_bf16 v[216:219], a[192:195], a[160:163], v[216:219]
 v_accvgpr_read_b32 v6, a247
 v_mfma_f32_16x16x32_bf16 v[212:215], a[192:195], a[152:155], v[212:215]
 v_add_f32 v6, v6, v15
 v_mfma_f32_16x16x32_bf16 v[212:215], a[196:199], a[156:159], v[212:215]
 v_accvgpr_write_b32 a247, v6
 v_mfma_f32_16x16x32_bf16 v[208:211], a[196:199], a[148:151], v[208:211]
 s_add_u32 s55, s55, 1
 s_waitcnt lgkmcnt(0)
 s_barrier
 v_mfma_f32_16x16x32_bf16 v[208:211], a[192:195], a[144:147], v[208:211]
 v_mfma_f32_16x16x32_bf16 v[204:207], a[192:195], a[136:139], v[204:207]
 v_mfma_f32_16x16x32_bf16 v[204:207], a[196:199], a[140:143], v[204:207]
 v_mfma_f32_16x16x32_bf16 v[200:203], a[196:199], a[132:135], v[200:203]
 v_mfma_f32_16x16x32_bf16 v[200:203], a[192:195], a[128:131], v[200:203]
 s_waitcnt vmcnt(8)
 v_mfma_f32_16x16x32_bf16 v[232:235], a[200:203], a[128:131], v[232:235]
 ds_read_b128 a[128:131], v1 offset:2048
 v_mfma_f32_16x16x32_bf16 v[232:235], a[204:207], a[132:135], v[232:235]
 global_load_dwordx4 a[196:199], v0, s[70:71] offset:-3072 sc1
 ds_read_b128 a[132:135], v1 offset:3072
 v_mfma_f32_16x16x32_bf16 v[236:239], a[204:207], a[140:143], v[236:239]
 ds_read_b128 a[140:143], v1 offset:7168
 v_mfma_f32_16x16x32_bf16 v[236:239], a[200:203], a[136:139], v[236:239]
 global_load_dwordx4 a[192:195], v0, s[70:71] offset:-4096 sc1
 ds_read_b128 a[136:139], v1 offset:6144
 v_mfma_f32_16x16x32_bf16 v[240:243], a[200:203], a[144:147], v[240:243]
 ds_read_b128 a[144:147], v1 offset:10240
 v_mfma_f32_16x16x32_bf16 v[240:243], a[204:207], a[148:151], v[240:243]
 ds_read_b128 a[148:151], v1 offset:11264
 v_mfma_f32_16x16x32_bf16 v[244:247], a[204:207], a[156:159], v[244:247]
 ds_read_b128 a[156:159], v1 offset:15360
 v_mfma_f32_16x16x32_bf16 v[244:247], a[200:203], a[152:155], v[244:247]
 ds_read_b128 a[152:155], v1 offset:14336
 v_mfma_f32_16x16x32_bf16 v[248:251], a[200:203], a[160:163], v[248:251]
 ds_read_b128 a[160:163], v1 offset:18432
 v_mfma_f32_16x16x32_bf16 v[248:251], a[204:207], a[164:167], v[248:251]
 ds_read_b128 a[164:167], v1 offset:19456
 v_mfma_f32_16x16x32_bf16 v[252:255], a[204:207], a[172:175], v[252:255]
 ds_read_b128 a[172:175], v1 offset:23552
 v_mfma_f32_16x16x32_bf16 v[252:255], a[200:203], a[168:171], v[252:255]
 ds_read_b128 a[168:171], v1 offset:22528
 v_mfma_f32_16x16x32_bf16 a[248:251], a[200:203], a[176:179], a[248:251]
 ds_read_b128 a[176:179], v1 offset:26624
 v_mfma_f32_16x16x32_bf16 a[248:251], a[204:207], a[180:183], a[248:251]
 ds_read_b128 a[180:183], v1 offset:27648
 v_mfma_f32_16x16x32_bf16 a[252:255], a[204:207], a[188:191], a[252:255]
 global_load_dwordx4 a[204:207], v0, s[70:71] offset:-1024 sc1
 ds_read_b128 a[188:191], v1 offset:31744
 v_mfma_f32_16x16x32_bf16 a[252:255], a[200:203], a[184:187], a[252:255]
 global_load_dwordx4 a[200:203], v0, s[70:71] offset:-2048 sc1
 ds_read_b128 a[184:187], v1 offset:30720
 s_waitcnt vmcnt(10) lgkmcnt(8)
Lloop:
 v_mfma_f32_16x16x32_bf16 v[16:19], a[208:211], a[128:131], v[16:19]
 v_mfma_f32_16x16x32_bf16 v[16:19], a[212:215], a[132:135], v[16:19]
 v_mov_b32 v6, v3
 s_cmp_eq_u32 s25, 0
 s_cbranch_scc1 Lgat0
Lgatr0:
 s_add_u32 s29, s29, 0x2000000
 v_mfma_f32_16x16x32_bf16 v[20:23], a[212:215], a[140:143], v[20:23]
 v_mfma_f32_16x16x32_bf16 v[20:23], a[208:211], a[136:139], v[20:23]
 v_mfma_f32_16x16x32_bf16 v[24:27], a[208:211], a[144:147], v[24:27]
 s_add_u32 m0, s50, 0
 v_mfma_f32_16x16x32_bf16 v[24:27], a[212:215], a[148:151], v[24:27]
 v_mfma_f32_16x16x32_bf16 v[28:31], a[212:215], a[156:159], v[28:31]
 v_mfma_f32_16x16x32_bf16 v[28:31], a[208:211], a[152:155], v[28:31]
 s_waitcnt lgkmcnt(0)
 v_mfma_f32_16x16x32_bf16 v[32:35], a[208:211], a[160:163], v[32:35]
 v_mfma_f32_16x16x32_bf16 v[32:35], a[212:215], a[164:167], v[32:35]
 v_mfma_f32_16x16x32_bf16 v[36:39], a[212:215], a[172:175], v[36:39]
 v_mfma_f32_16x16x32_bf16 v[36:39], a[208:211], a[168:171], v[36:39]
 buffer_load_dwordx4 v6, s[8:11], s30 offen lds
 v_mfma_f32_16x16x32_bf16 v[40:43], a[208:211], a[176:179], v[40:43]
 v_mfma_f32_16x16x32_bf16 v[40:43], a[212:215], a[180:183], v[40:43]
 v_mfma_f32_16x16x32_bf16 v[44:47], a[212:215], a[188:191], v[44:47]
 s_add_u32 m0, m0, 1024
 v_mfma_f32_16x16x32_bf16 v[44:47], a[208:211], a[184:187], v[44:47]
 s_waitcnt vmcnt(9)
 v_mfma_f32_16x16x32_bf16 v[76:79], a[216:219], a[184:187], v[76:79]
 v_mfma_f32_16x16x32_bf16 v[76:79], a[220:223], a[188:191], v[76:79]
 global_load_dwordx4 a[212:215], v0, s[70:71] offset:1024 sc1
 s_add_u32 s30, s30, s20
 v_mfma_f32_16x16x32_bf16 v[72:75], a[220:223], a[180:183], v[72:75]
 v_mfma_f32_16x16x32_bf16 v[72:75], a[216:219], a[176:179], v[72:75]
 global_load_dwordx4 a[208:211], v0, s[70:71] offset:0 sc1
 v_mfma_f32_16x16x32_bf16 v[68:71], a[216:219], a[168:171], v[68:71]
 buffer_load_dwordx4 v6, s[8:11], s30 offen lds
 v_mfma_f32_16x16x32_bf16 v[68:71], a[220:223], a[172:175], v[68:71]
 v_mfma_f32_16x16x32_bf16 v[64:67], a[220:223], a[164:167], v[64:67]
 v_mfma_f32_16x16x32_bf16 v[64:67], a[216:219], a[160:163], v[64:67]
 v_mfma_f32_16x16x32_bf16 v[60:63], a[216:219], a[152:155], v[60:63]
 s_add_u32 m0, m0, 3072
 v_mfma_f32_16x16x32_bf16 v[60:63], a[220:223], a[156:159], v[60:63]
 v_mfma_f32_16x16x32_bf16 v[56:59], a[220:223], a[148:151], v[56:59]
 v_mfma_f32_16x16x32_bf16 v[56:59], a[216:219], a[144:147], v[56:59]
 s_add_u32 s30, s30, s21
 v_mfma_f32_16x16x32_bf16 v[52:55], a[216:219], a[136:139], v[52:55]
 v_mfma_f32_16x16x32_bf16 v[52:55], a[220:223], a[140:143], v[52:55]
 v_mfma_f32_16x16x32_bf16 v[48:51], a[220:223], a[132:135], v[48:51]
 v_mfma_f32_16x16x32_bf16 v[48:51], a[216:219], a[128:131], v[48:51]
 s_waitcnt vmcnt(10)
 v_mfma_f32_16x16x32_bf16 v[80:83], a[224:227], a[128:131], v[80:83]
 v_mfma_f32_16x16x32_bf16 v[80:83], a[228:231], a[132:135], v[80:83]
 global_load_dwordx4 a[220:223], v0, s[70:71] offset:3072 sc1
 v_mfma_f32_16x16x32_bf16 v[84:87], a[228:231], a[140:143], v[84:87]
 v_mfma_f32_16x16x32_bf16 v[84:87], a[224:227], a[136:139], v[84:87]
 global_load_dwordx4 a[216:219], v0, s[70:71] offset:2048 sc1
 v_mfma_f32_16x16x32_bf16 v[88:91], a[224:227], a[144:147], v[88:91]
 s_add_u32 s70, s70, 8192
 s_addc_u32 s71, s71, 0
 v_mfma_f32_16x16x32_bf16 v[88:91], a[228:231], a[148:151], v[88:91]
 v_mfma_f32_16x16x32_bf16 v[92:95], a[228:231], a[156:159], v[92:95]
 v_mfma_f32_16x16x32_bf16 v[92:95], a[224:227], a[152:155], v[92:95]
 v_mfma_f32_16x16x32_bf16 v[96:99], a[224:227], a[160:163], v[96:99]
 v_mfma_f32_16x16x32_bf16 v[96:99], a[228:231], a[164:167], v[96:99]
 v_mfma_f32_16x16x32_bf16 v[100:103], a[228:231], a[172:175], v[100:103]
 v_mfma_f32_16x16x32_bf16 v[100:103], a[224:227], a[168:171], v[100:103]
 v_mfma_f32_16x16x32_bf16 v[104:107], a[224:227], a[176:179], v[104:107]
 v_mfma_f32_16x16x32_bf16 v[104:107], a[228:231], a[180:183], v[104:107]
 v_mfma_f32_16x16x32_bf16 v[108:111], a[228:231], a[188:191], v[108:111]
 v_mfma_f32_16x16x32_bf16 v[108:111], a[224:227], a[184:187], v[108:111]
 s_waitcnt vmcnt(10)
 v_mfma_f32_16x16x32_bf16 a[244:247], a[232:235], a[184:187], a[244:247]
 v_mfma_f32_16x16x32_bf16 a[244:247], a[236:239], a[188:191], a[244:247]
 global_load_dwordx4 a[228:231], v0, s[70:71] offset:-3072 sc1
 v_mfma_f32_16x16x32_bf16 a[240:243], a[236:239], a[180:183], a[240:243]
 v_mfma_f32_16x16x32_bf16 a[240:243], a[232:235], a[176:179], a[240:243]
 global_load_dwordx4 a[224:227], v0, s[70:71] offset:-4096 sc1
 v_mfma_f32_16x16x32_bf16 v[132:135], a[232:235], a[168:171], v[132:135]
 v_mfma_f32_16x16x32_bf16 v[132:135], a[236:239], a[172:175], v[132:135]
 v_mfma_f32_16x16x32_bf16 v[128:131], a[236:239], a[164:167], v[128:131]
 v_mfma_f32_16x16x32_bf16 v[128:131], a[232:235], a[160:163], v[128:131]
 v_mfma_f32_16x16x32_bf16 v[124:127], a[232:235], a[152:155], v[124:127]
 v_mfma_f32_16x16x32_bf16 v[124:127], a[236:239], a[156:159], v[124:127]
 v_mfma_f32_16x16x32_bf16 v[120:123], a[236:239], a[148:151], v[120:123]
 v_mfma_f32_16x16x32_bf16 v[120:123], a[232:235], a[144:147], v[120:123]
 v_mfma_f32_16x16x32_bf16 v[116:119], a[232:235], a[136:139], v[116:119]
 v_mfma_f32_16x16x32_bf16 v[116:119], a[236:239], a[140:143], v[116:119]
 v_mfma_f32_16x16x32_bf16 v[112:115], a[236:239], a[132:135], v[112:115]
 buffer_load_dwordx4 v6, s[8:11], s30 offen lds
 v_mfma_f32_16x16x32_bf16 v[112:115], a[232:235], a[128:131], v[112:115]
 s_waitcnt vmcnt(11)
 v_mfma_f32_16x16x32_bf16 v[136:139], a[192:195], a[128:131], v[136:139]
 v_mfma_f32_16x16x32_bf16 v[136:139], a[196:199], a[132:135], v[136:139]
 global_load_dwordx4 a[236:239], v0, s[70:71] offset:-1024 sc1
 v_mfma_f32_16x16x32_bf16 v[140:143], a[196:199], a[140:143], v[140:143]
 s_add_u32 m0, m0, 1024
 v_mfma_f32_16x16x32_bf16 v[140:143], a[192:195], a[136:139], v[140:143]
 global_load_dwordx4 a[232:235], v0, s[70:71] offset:-2048 sc1
 v_mfma_f32_16x16x32_bf16 v[144:147], a[192:195], a[144:147], v[144:147]
 v_mfma_f32_16x16x32_bf16 v[144:147], a[196:199], a[148:151], v[144:147]
 s_add_u32 s30, s30, s20
 v_mfma_f32_16x16x32_bf16 v[148:151], a[196:199], a[156:159], v[148:151]
 v_mfma_f32_16x16x32_bf16 v[148:151], a[192:195], a[152:155], v[148:151]
 v_mfma_f32_16x16x32_bf16 v[152:155], a[192:195], a[160:163], v[152:155]
 buffer_load_dwordx4 v6, s[8:11], s30 offen lds
 v_mfma_f32_16x16x32_bf16 v[152:155], a[196:199], a[164:167], v[152:155]
 v_mfma_f32_16x16x32_bf16 v[156:159], a[196:199], a[172:175], v[156:159]
 v_mfma_f32_16x16x32_bf16 v[156:159], a[192:195], a[168:171], v[156:159]
 s_add_u32 m0, m0, 3072
 v_mfma_f32_16x16x32_bf16 v[160:163], a[192:195], a[176:179], v[160:163]
 v_mfma_f32_16x16x32_bf16 v[160:163], a[196:199], a[180:183], v[160:163]
 v_mfma_f32_16x16x32_bf16 v[164:167], a[196:199], a[188:191], v[164:167]
 s_add_u32 s30, s30, s21
 v_mfma_f32_16x16x32_bf16 v[164:167], a[192:195], a[184:187], v[164:167]
 s_waitcnt vmcnt(12)
 v_mfma_f32_16x16x32_bf16 v[196:199], a[200:203], a[184:187], v[196:199]
 v_mfma_f32_16x16x32_bf16 v[196:199], a[204:207], a[188:191], v[196:199]
 global_load_dwordx4 a[196:199], v0, s[70:71] offset:1024 sc1
 v_mfma_f32_16x16x32_bf16 v[192:195], a[204:207], a[180:183], v[192:195]
 s_add_u32 s31, s31, 1
 v_mov_b32 v7, s31
 buffer_store_dword v7, v1, s[60:63], 0 offen sc1
 v_mfma_f32_16x16x32_bf16 v[192:195], a[200:203], a[176:179], v[192:195]
 global_load_dwordx4 a[192:195], v0, s[70:71] offset:0 sc1
 v_mfma_f32_16x16x32_bf16 v[188:191], a[200:203], a[168:171], v[188:191]
 v_mfma_f32_16x16x32_bf16 v[188:191], a[204:207], a[172:175], v[188:191]
 v_mfma_f32_16x16x32_bf16 v[184:187], a[204:207], a[164:167], v[184:187]
 v_mfma_f32_16x16x32_bf16 v[184:187], a[200:203], a[160:163], v[184:187]
 v_mfma_f32_16x16x32_bf16 v[180:183], a[200:203], a[152:155], v[180:183]
 v_mfma_f32_16x16x32_bf16 v[180:183], a[204:207], a[156:159], v[180:183]
 v_mfma_f32_16x16x32_bf16 v[176:179], a[204:207], a[148:151], v[176:179]
 v_mfma_f32_16x16x32_bf16 v[176:179], a[200:203], a[144:147], v[176:179]
 v_mfma_f32_16x16x32_bf16 v[172:175], a[200:203], a[136:139], v[172:175]
 v_mfma_f32_16x16x32_bf16 v[172:175], a[204:207], a[140:143], v[172:175]
 v_mfma_f32_16x16x32_bf16 v[168:171], a[204:207], a[132:135], v[168:171]
 v_mfma_f32_16x16x32_bf16 v[168:171], a[200:203], a[128:131], v[168:171]
 s_waitcnt vmcnt(12)
 v_mfma_f32_16x16x32_bf16 v[200:203], a[208:211], a[128:131], v[200:203]
 v_mfma_f32_16x16x32_bf16 v[200:203], a[212:215], a[132:135], v[200:203]
 global_load_dwordx4 a[204:207], v0, s[70:71] offset:3072 sc1
 v_mfma_f32_16x16x32_bf16 v[204:207], a[212:215], a[140:143], v[204:207]
 v_mfma_f32_16x16x32_bf16 v[204:207], a[208:211], a[136:139], v[204:207]
 global_load_dwordx4 a[200:203], v0, s[70:71] offset:2048 sc1
 v_mfma_f32_16x16x32_bf16 v[208:211], a[208:211], a[144:147], v[208:211]
 s_add_u32 s70, s70, 8192
 s_addc_u32 s71, s71, 0
 v_mfma_f32_16x16x32_bf16 v[208:211], a[212:215], a[148:151], v[208:211]
 v_mfma_f32_16x16x32_bf16 v[212:215], a[212:215], a[156:159], v[212:215]
 v_mfma_f32_16x16x32_bf16 v[212:215], a[208:211], a[152:155], v[212:215]
 v_mfma_f32_16x16x32_bf16 v[216:219], a[208:211], a[160:163], v[216:219]
 v_mfma_f32_16x16x32_bf16 v[216:219], a[212:215], a[164:167], v[216:219]
 v_mfma_f32_16x16x32_bf16 v[220:223], a[212:215], a[172:175], v[220:223]
 v_mfma_f32_16x16x32_bf16 v[220:223], a[208:211], a[168:171], v[220:223]
 v_mfma_f32_16x16x32_bf16 v[224:227], a[208:211], a[176:179], v[224:227]
 v_mfma_f32_16x16x32_bf16 v[224:227], a[212:215], a[180:183], v[224:227]
 v_mfma_f32_16x16x32_bf16 v[228:231], a[212:215], a[188:191], v[228:231]
 v_mfma_f32_16x16x32_bf16 v[228:231], a[208:211], a[184:187], v[228:231]
 buffer_load_dwordx4 v6, s[8:11], s30 offen lds
 s_waitcnt vmcnt(12)
 v_mfma_f32_16x16x32_bf16 a[252:255], a[216:219], a[184:187], a[252:255]
 ds_read_b128 a[184:187], v1 offset:63488
 v_mfma_f32_16x16x32_bf16 a[252:255], a[220:223], a[188:191], a[252:255]
 global_load_dwordx4 a[212:215], v0, s[70:71] offset:-3072 sc1
 ds_read_b128 a[188:191], v1 offset:64512
 v_mfma_f32_16x16x32_bf16 a[248:251], a[220:223], a[180:183], a[248:251]
 ds_read_b128 a[180:183], v1 offset:60416
 v_mfma_f32_16x16x32_bf16 a[248:251], a[216:219], a[176:179], a[248:251]
 global_load_dwordx4 a[208:211], v0, s[70:71] offset:-4096 sc1
 ds_read_b128 a[176:179], v1 offset:59392
 v_mfma_f32_16x16x32_bf16 v[252:255], a[216:219], a[168:171], v[252:255]
 ds_read_b128 a[168:171], v1 offset:55296
 v_mfma_f32_16x16x32_bf16 v[252:255], a[220:223], a[172:175], v[252:255]
 ds_read_b128 a[172:175], v1 offset:56320
 s_add_u32 m0, m0, 1024
 v_mfma_f32_16x16x32_bf16 v[248:251], a[220:223], a[164:167], v[248:251]
 ds_read_b128 a[164:167], v1 offset:52224
 v_mfma_f32_16x16x32_bf16 v[248:251], a[216:219], a[160:163], v[248:251]
 ds_read_b128 a[160:163], v1 offset:51200
 v_mfma_f32_16x16x32_bf16 v[244:247], a[216:219], a[152:155], v[244:247]
 ds_read_b128 a[152:155], v1 offset:47104
 s_add_u32 s30, s30, s20
 v_mfma_f32_16x16x32_bf16 v[244:247], a[220:223], a[156:159], v[244:247]
 ds_read_b128 a[156:159], v1 offset:48128
 v_mfma_f32_16x16x32_bf16 v[240:243], a[220:223], a[148:151], v[240:243]
 ds_read_b128 a[148:151], v1 offset:44032
 v_mfma_f32_16x16x32_bf16 v[240:243], a[216:219], a[144:147], v[240:243]
 ds_read_b128 a[144:147], v1 offset:43008
 v_mfma_f32_16x16x32_bf16 v[236:239], a[216:219], a[136:139], v[236:239]
 ds_read_b128 a[136:139], v1 offset:38912
 v_mfma_f32_16x16x32_bf16 v[236:239], a[220:223], a[140:143], v[236:239]
 ds_read_b128 a[140:143], v1 offset:39936
 v_mfma_f32_16x16x32_bf16 v[232:235], a[220:223], a[132:135], v[232:235]
 ds_read_b128 a[132:135], v1 offset:35840
 v_mfma_f32_16x16x32_bf16 v[232:235], a[216:219], a[128:131], v[232:235]
 ds_read_b128 a[128:131], v1 offset:34816
 s_waitcnt vmcnt(12) lgkmcnt(8)
 v_mfma_f32_16x16x32_bf16 v[44:47], a[224:227], a[184:187], v[44:47]
 buffer_load_dwordx4 v6, s[8:11], s30 offen lds
 s_add_u32 m0, m0, 3072
 v_mfma_f32_16x16x32_bf16 v[44:47], a[228:231], a[188:191], v[44:47]
 global_load_dwordx4 a[220:223], v0, s[70:71] offset:-1024 sc1
 v_mfma_f32_16x16x32_bf16 v[40:43], a[228:231], a[180:183], v[40:43]
 s_add_u32 s30, s30, s21
 v_mfma_f32_16x16x32_bf16 v[40:43], a[224:227], a[176:179], v[40:43]
 global_load_dwordx4 a[216:219], v0, s[70:71] offset:-2048 sc1
 v_mfma_f32_16x16x32_bf16 v[36:39], a[224:227], a[168:171], v[36:39]
 v_mfma_f32_16x16x32_bf16 v[36:39], a[228:231], a[172:175], v[36:39]
 v_mfma_f32_16x16x32_bf16 v[32:35], a[228:231], a[164:167], v[32:35]
 v_mfma_f32_16x16x32_bf16 v[32:35], a[224:227], a[160:163], v[32:35]
 s_waitcnt lgkmcnt(0)
 v_mfma_f32_16x16x32_bf16 v[28:31], a[224:227], a[152:155], v[28:31]
 v_mfma_f32_16x16x32_bf16 v[28:31], a[228:231], a[156:159], v[28:31]
 v_mfma_f32_16x16x32_bf16 v[24:27], a[228:231], a[148:151], v[24:27]
 v_mfma_f32_16x16x32_bf16 v[24:27], a[224:227], a[144:147], v[24:27]
 v_mfma_f32_16x16x32_bf16 v[20:23], a[224:227], a[136:139], v[20:23]
 v_mfma_f32_16x16x32_bf16 v[20:23], a[228:231], a[140:143], v[20:23]
 v_mfma_f32_16x16x32_bf16 v[16:19], a[228:231], a[132:135], v[16:19]
 v_mfma_f32_16x16x32_bf16 v[16:19], a[224:227], a[128:131], v[16:19]
 s_waitcnt vmcnt(12)
 v_mfma_f32_16x16x32_bf16 v[48:51], a[232:235], a[128:131], v[48:51]
 v_mfma_f32_16x16x32_bf16 v[48:51], a[236:239], a[132:135], v[48:51]
 global_load_dwordx4 a[228:231], v0, s[70:71] offset:1024 sc1
 v_mfma_f32_16x16x32_bf16 v[52:55], a[236:239], a[140:143], v[52:55]
 v_mfma_f32_16x16x32_bf16 v[52:55], a[232:235], a[136:139], v[52:55]
 global_load_dwordx4 a[224:227], v0, s[70:71] offset:0 sc1
 v_mfma_f32_16x16x32_bf16 v[56:59], a[232:235], a[144:147], v[56:59]
 v_mfma_f32_16x16x32_bf16 v[56:59], a[236:239], a[148:151], v[56:59]
 v_mfma_f32_16x16x32_bf16 v[60:63], a[236:239], a[156:159], v[60:63]
 v_mfma_f32_16x16x32_bf16 v[60:63], a[232:235], a[152:155], v[60:63]
 v_mfma_f32_16x16x32_bf16 v[64:67], a[232:235], a[160:163], v[64:67]
 v_mfma_f32_16x16x32_bf16 v[64:67], a[236:239], a[164:167], v[64:67]
 v_mfma_f32_16x16x32_bf16 v[68:71], a[236:239], a[172:175], v[68:71]
 v_mfma_f32_16x16x32_bf16 v[68:71], a[232:235], a[168:171], v[68:71]
 v_mfma_f32_16x16x32_bf16 v[72:75], a[232:235], a[176:179], v[72:75]
 v_mfma_f32_16x16x32_bf16 v[72:75], a[236:239], a[180:183], v[72:75]
 v_mfma_f32_16x16x32_bf16 v[76:79], a[236:239], a[188:191], v[76:79]
 v_mfma_f32_16x16x32_bf16 v[76:79], a[232:235], a[184:187], v[76:79]
 s_waitcnt vmcnt(10)
 v_mfma_f32_16x16x32_bf16 v[108:111], a[192:195], a[184:187], v[108:111]
 v_mfma_f32_16x16x32_bf16 v[108:111], a[196:199], a[188:191], v[108:111]
 global_load_dwordx4 a[236:239], v0, s[70:71] offset:3072 sc1
 v_mfma_f32_16x16x32_bf16 v[104:107], a[196:199], a[180:183], v[104:107]
 v_mfma_f32_16x16x32_bf16 v[104:107], a[192:195], a[176:179], v[104:107]
 global_load_dwordx4 a[232:235], v0, s[70:71] offset:2048 sc1
 v_mfma_f32_16x16x32_bf16 v[100:103], a[192:195], a[168:171], v[100:103]
 s_add_u32 s70, s70, 8192
 s_addc_u32 s71, s71, 0
 v_mfma_f32_16x16x32_bf16 v[100:103], a[196:199], a[172:175], v[100:103]
 buffer_load_dwordx4 v6, s[8:11], s30 offen lds
 v_mfma_f32_16x16x32_bf16 v[96:99], a[196:199], a[164:167], v[96:99]
 v_mfma_f32_16x16x32_bf16 v[96:99], a[192:195], a[160:163], v[96:99]
 v_mfma_f32_16x16x32_bf16 v[92:95], a[192:195], a[152:155], v[92:95]
 v_mfma_f32_16x16x32_bf16 v[92:95], a[196:199], a[156:159], v[92:95]
 s_add_u32 m0, m0, 1024
 v_mfma_f32_16x16x32_bf16 v[88:91], a[196:199], a[148:151], v[88:91]
 v_mfma_f32_16x16x32_bf16 v[88:91], a[192:195], a[144:147], v[88:91]
 v_mfma_f32_16x16x32_bf16 v[84:87], a[192:195], a[136:139], v[84:87]
 s_add_u32 s30, s30, s20
 v_mfma_f32_16x16x32_bf16 v[84:87], a[196:199], a[140:143], v[84:87]
 v_mfma_f32_16x16x32_bf16 v[80:83], a[196:199], a[132:135], v[80:83]
 v_mfma_f32_16x16x32_bf16 v[80:83], a[192:195], a[128:131], v[80:83]
 buffer_load_dwordx4 v6, s[8:11], s30 offen lds
 s_waitcnt vmcnt(12)
 v_mfma_f32_16x16x32_bf16 v[112:115], a[200:203], a[128:131], v[112:115]
 v_mfma_f32_16x16x32_bf16 v[112:115], a[204:207], a[132:135], v[112:115]
 global_load_dwordx4 a[196:199], v0, s[70:71] offset:-3072 sc1
 v_mfma_f32_16x16x32_bf16 v[116:119], a[204:207], a[140:143], v[116:119]
 s_add_u32 m0, m0, 3072
 v_mfma_f32_16x16x32_bf16 v[116:119], a[200:203], a[136:139], v[116:119]
 global_load_dwordx4 a[192:195], v0, s[70:71] offset:-4096 sc1
 v_mfma_f32_16x16x32_bf16 v[120:123], a[200:203], a[144:147], v[120:123]
 v_mfma_f32_16x16x32_bf16 v[120:123], a[204:207], a[148:151], v[120:123]
 v_mfma_f32_16x16x32_bf16 v[124:127], a[204:207], a[156:159], v[124:127]
 s_add_u32 s30, s30, s21
 v_mfma_f32_16x16x32_bf16 v[124:127], a[200:203], a[152:155], v[124:127]
 v_mfma_f32_16x16x32_bf16 v[128:131], a[200:203], a[160:163], v[128:131]
 v_mfma_f32_16x16x32_bf16 v[128:131], a[204:207], a[164:167], v[128:131]
 v_mfma_f32_16x16x32_bf16 v[132:135], a[204:207], a[172:175], v[132:135]
 v_mfma_f32_16x16x32_bf16 v[132:135], a[200:203], a[168:171], v[132:135]
 v_mfma_f32_16x16x32_bf16 a[240:243], a[200:203], a[176:179], a[240:243]
 v_mfma_f32_16x16x32_bf16 a[240:243], a[204:207], a[180:183], a[240:243]
 v_mfma_f32_16x16x32_bf16 a[244:247], a[204:207], a[188:191], a[244:247]
 v_mfma_f32_16x16x32_bf16 a[244:247], a[200:203], a[184:187], a[244:247]
 s_waitcnt vmcnt(11)
 v_mfma_f32_16x16x32_bf16 v[164:167], a[208:211], a[184:187], v[164:167]
 v_mfma_f32_16x16x32_bf16 v[164:167], a[212:215], a[188:191], v[164:167]
 global_load_dwordx4 a[204:207], v0, s[70:71] offset:-1024 sc1
 v_mfma_f32_16x16x32_bf16 v[160:163], a[212:215], a[180:183], v[160:163]
 v_mfma_f32_16x16x32_bf16 v[160:163], a[208:211], a[176:179], v[160:163]
 global_load_dwordx4 a[200:203], v0, s[70:71] offset:-2048 sc1
 v_mfma_f32_16x16x32_bf16 v[156:159], a[208:211], a[168:171], v[156:159]
 v_mfma_f32_16x16x32_bf16 v[156:159], a[212:215], a[172:175], v[156:159]
 v_mfma_f32_16x16x32_bf16 v[152:155], a[212:215], a[164:167], v[152:155]
 v_mfma_f32_16x16x32_bf16 v[152:155], a[208:211], a[160:163], v[152:155]
 v_mfma_f32_16x16x32_bf16 v[148:151], a[208:211], a[152:155], v[148:151]
 v_mfma_f32_16x16x32_bf16 v[148:151], a[212:215], a[156:159], v[148:151]
 v_mfma_f32_16x16x32_bf16 v[144:147], a[212:215], a[148:151], v[144:147]
 v_mfma_f32_16x16x32_bf16 v[144:147], a[208:211], a[144:147], v[144:147]
 v_mfma_f32_16x16x32_bf16 v[140:143], a[208:211], a[136:139], v[140:143]
 v_mfma_f32_16x16x32_bf16 v[140:143], a[212:215], a[140:143], v[140:143]
 v_mfma_f32_16x16x32_bf16 v[136:139], a[212:215], a[132:135], v[136:139]
 v_mfma_f32_16x16x32_bf16 v[136:139], a[208:211], a[128:131], v[136:139]
 s_waitcnt vmcnt(10)
 v_mfma_f32_16x16x32_bf16 v[168:171], a[216:219], a[128:131], v[168:171]
 v_mfma_f32_16x16x32_bf16 v[168:171], a[220:223], a[132:135], v[168:171]
 global_load_dwordx4 a[212:215], v0, s[70:71] offset:1024 sc1
 v_mfma_f32_16x16x32_bf16 v[172:175], a[220:223], a[140:143], v[172:175]
 v_mfma_f32_16x16x32_bf16 v[172:175], a[216:219], a[136:139], v[172:175]
 global_load_dwordx4 a[208:211], v0, s[70:71] offset:0 sc1
 v_mfma_f32_16x16x32_bf16 v[176:179], a[216:219], a[144:147], v[176:179]
 v_mfma_f32_16x16x32_bf16 v[176:179], a[220:223], a[148:151], v[176:179]
 v_mfma_f32_16x16x32_bf16 v[180:183], a[220:223], a[156:159], v[180:183]
 v_mfma_f32_16x16x32_bf16 v[180:183], a[216:219], a[152:155], v[180:183]
 v_mfma_f32_16x16x32_bf16 v[184:187], a[216:219], a[160:163], v[184:187]
 v_mfma_f32_16x16x32_bf16 v[184:187], a[220:223], a[164:167], v[184:187]
 buffer_load_dwordx4 v6, s[8:11], s30 offen lds
 v_mfma_f32_16x16x32_bf16 v[188:191], a[220:223], a[172:175], v[188:191]
 v_mfma_f32_16x16x32_bf16 v[188:191], a[216:219], a[168:171], v[188:191]
 v_mfma_f32_16x16x32_bf16 v[192:195], a[216:219], a[176:179], v[192:195]
 s_add_u32 m0, m0, 1024
 v_mfma_f32_16x16x32_bf16 v[192:195], a[220:223], a[180:183], v[192:195]
 v_mfma_f32_16x16x32_bf16 v[196:199], a[220:223], a[188:191], v[196:199]
 v_mfma_f32_16x16x32_bf16 v[196:199], a[216:219], a[184:187], v[196:199]
 s_waitcnt vmcnt(11)
 v_mfma_f32_16x16x32_bf16 v[228:231], a[224:227], a[184:187], v[228:231]
 s_add_u32 s30, s30, s20
 v_mfma_f32_16x16x32_bf16 v[228:231], a[228:231], a[188:191], v[228:231]
 global_load_dwordx4 a[220:223], v0, s[70:71] offset:3072 sc1
 v_mfma_f32_16x16x32_bf16 v[224:227], a[228:231], a[180:183], v[224:227]
 buffer_load_dwordx4 v6, s[8:11], s30 offen lds
 v_mfma_f32_16x16x32_bf16 v[224:227], a[224:227], a[176:179], v[224:227]
 global_load_dwordx4 a[216:219], v0, s[70:71] offset:2048 sc1
 v_mfma_f32_16x16x32_bf16 v[220:223], a[224:227], a[168:171], v[220:223]
 s_add_u32 s70, s70, 8192
 s_addc_u32 s71, s71, 0
 v_mfma_f32_16x16x32_bf16 v[220:223], a[228:231], a[172:175], v[220:223]
 v_mfma_f32_16x16x32_bf16 v[216:219], a[228:231], a[164:167], v[216:219]
 s_add_u32 m0, m0, 3072
 v_mfma_f32_16x16x32_bf16 v[216:219], a[224:227], a[160:163], v[216:219]
 v_mfma_f32_16x16x32_bf16 v[212:215], a[224:227], a[152:155], v[212:215]
 v_mfma_f32_16x16x32_bf16 v[212:215], a[228:231], a[156:159], v[212:215]
 s_add_u32 s30, s30, s21
 v_mfma_f32_16x16x32_bf16 v[208:211], a[228:231], a[148:151], v[208:211]
 v_mfma_f32_16x16x32_bf16 v[208:211], a[224:227], a[144:147], v[208:211]
 v_mfma_f32_16x16x32_bf16 v[204:207], a[224:227], a[136:139], v[204:207]
 v_mfma_f32_16x16x32_bf16 v[204:207], a[228:231], a[140:143], v[204:207]
 v_mfma_f32_16x16x32_bf16 v[200:203], a[228:231], a[132:135], v[200:203]
 v_mfma_f32_16x16x32_bf16 v[200:203], a[224:227], a[128:131], v[200:203]
 s_waitcnt vmcnt(12)
 v_mfma_f32_16x16x32_bf16 v[232:235], a[232:235], a[128:131], v[232:235]
 ds_read_b128 a[128:131], v2 offset:2048
 v_mfma_f32_16x16x32_bf16 v[232:235], a[236:239], a[132:135], v[232:235]
 global_load_dwordx4 a[228:231], v0, s[70:71] offset:-3072 sc1
 ds_read_b128 a[132:135], v2 offset:3072
 v_mfma_f32_16x16x32_bf16 v[236:239], a[236:239], a[140:143], v[236:239]
 ds_read_b128 a[140:143], v2 offset:7168
 v_mfma_f32_16x16x32_bf16 v[236:239], a[232:235], a[136:139], v[236:239]
 global_load_dwordx4 a[224:227], v0, s[70:71] offset:-4096 sc1
 ds_read_b128 a[136:139], v2 offset:6144
 v_mfma_f32_16x16x32_bf16 v[240:243], a[232:235], a[144:147], v[240:243]
 ds_read_b128 a[144:147], v2 offset:10240
 v_mfma_f32_16x16x32_bf16 v[240:243], a[236:239], a[148:151], v[240:243]
 ds_read_b128 a[148:151], v2 offset:11264
 v_mfma_f32_16x16x32_bf16 v[244:247], a[236:239], a[156:159], v[244:247]
 ds_read_b128 a[156:159], v2 offset:15360
 v_mfma_f32_16x16x32_bf16 v[244:247], a[232:235], a[152:155], v[244:247]
 ds_read_b128 a[152:155], v2 offset:14336
 v_mfma_f32_16x16x32_bf16 v[248:251], a[232:235], a[160:163], v[248:251]
 ds_read_b128 a[160:163], v2 offset:18432
 v_mfma_f32_16x16x32_bf16 v[248:251], a[236:239], a[164:167], v[248:251]
 ds_read_b128 a[164:167], v2 offset:19456
 v_mfma_f32_16x16x32_bf16 v[252:255], a[236:239], a[172:175], v[252:255]
 ds_read_b128 a[172:175], v2 offset:23552
 v_mfma_f32_16x16x32_bf16 v[252:255], a[232:235], a[168:171], v[252:255]
 ds_read_b128 a[168:171], v2 offset:22528
 v_mfma_f32_16x16x32_bf16 a[248:251], a[232:235], a[176:179], a[248:251]
 ds_read_b128 a[176:179], v2 offset:26624
 v_mfma_f32_16x16x32_bf16 a[248:251], a[236:239], a[180:183], a[248:251]
 ds_read_b128 a[180:183], v2 offset:27648
 v_mfma_f32_16x16x32_bf16 a[252:255], a[236:239], a[188:191], a[252:255]
 ds_read_b128 a[188:191], v2 offset:31744
 v_mfma_f32_16x16x32_bf16 a[252:255], a[232:235], a[184:187], a[252:255]
 ds_read_b128 a[184:187], v2 offset:30720
 s_waitcnt vmcnt(10) lgkmcnt(8)
 v_mfma_f32_16x16x32_bf16 v[16:19], a[192:195], a[128:131], v[16:19]
 v_mfma_f32_16x16x32_bf16 v[16:19], a[196:199], a[132:135], v[16:19]
 global_load_dwordx4 a[236:239], v0, s[70:71] offset:-1024 sc1
 v_mfma_f32_16x16x32_bf16 v[20:23], a[196:199], a[140:143], v[20:23]
 v_mfma_f32_16x16x32_bf16 v[20:23], a[192:195], a[136:139], v[20:23]
 global_load_dwordx4 a[232:235], v0, s[70:71] offset:-2048 sc1
 v_mfma_f32_16x16x32_bf16 v[24:27], a[192:195], a[144:147], v[24:27]
 v_mfma_f32_16x16x32_bf16 v[24:27], a[196:199], a[148:151], v[24:27]
 v_mfma_f32_16x16x32_bf16 v[28:31], a[196:199], a[156:159], v[28:31]
 v_mfma_f32_16x16x32_bf16 v[28:31], a[192:195], a[152:155], v[28:31]
 s_waitcnt lgkmcnt(0)
 v_mfma_f32_16x16x32_bf16 v[32:35], a[192:195], a[160:163], v[32:35]
 v_mfma_f32_16x16x32_bf16 v[32:35], a[196:199], a[164:167], v[32:35]
 v_mfma_f32_16x16x32_bf16 v[36:39], a[196:199], a[172:175], v[36:39]
 v_mfma_f32_16x16x32_bf16 v[36:39], a[192:195], a[168:171], v[36:39]
 v_mfma_f32_16x16x32_bf16 v[40:43], a[192:195], a[176:179], v[40:43]
 v_mfma_f32_16x16x32_bf16 v[40:43], a[196:199], a[180:183], v[40:43]
 buffer_load_dwordx4 v6, s[8:11], s30 offen lds
 v_mfma_f32_16x16x32_bf16 v[44:47], a[196:199], a[188:191], v[44:47]
 v_mfma_f32_16x16x32_bf16 v[44:47], a[192:195], a[184:187], v[44:47]
 s_waitcnt vmcnt(11)
 v_mfma_f32_16x16x32_bf16 v[76:79], a[200:203], a[184:187], v[76:79]
 s_add_u32 m0, m0, 1024
 v_mfma_f32_16x16x32_bf16 v[76:79], a[204:207], a[188:191], v[76:79]
 global_load_dwordx4 a[196:199], v0, s[70:71] offset:1024 sc1
 v_mfma_f32_16x16x32_bf16 v[72:75], a[204:207], a[180:183], v[72:75]
 v_mfma_f32_16x16x32_bf16 v[72:75], a[200:203], a[176:179], v[72:75]
 global_load_dwordx4 a[192:195], v0, s[70:71] offset:0 sc1
 s_add_u32 s30, s30, s20
 v_mfma_f32_16x16x32_bf16 v[68:71], a[200:203], a[168:171], v[68:71]
 v_mfma_f32_16x16x32_bf16 v[68:71], a[204:207], a[172:175], v[68:71]
 v_mfma_f32_16x16x32_bf16 v[64:67], a[204:207], a[164:167], v[64:67]
 buffer_load_dwordx4 v6, s[8:11], s30 offen lds
 v_mfma_f32_16x16x32_bf16 v[64:67], a[200:203], a[160:163], v[64:67]
 v_mfma_f32_16x16x32_bf16 v[60:63], a[200:203], a[152:155], v[60:63]
 v_mfma_f32_16x16x32_bf16 v[60:63], a[204:207], a[156:159], v[60:63]
 v_mfma_f32_16x16x32_bf16 v[56:59], a[204:207], a[148:151], v[56:59]
 s_add_u32 m0, m0, 3072
 v_mfma_f32_16x16x32_bf16 v[56:59], a[200:203], a[144:147], v[56:59]
 v_mfma_f32_16x16x32_bf16 v[52:55], a[200:203], a[136:139], v[52:55]
 v_mfma_f32_16x16x32_bf16 v[52:55], a[204:207], a[140:143], v[52:55]
 s_add_u32 s30, s30, s21
 v_mfma_f32_16x16x32_bf16 v[48:51], a[204:207], a[132:135], v[48:51]
 v_mfma_f32_16x16x32_bf16 v[48:51], a[200:203], a[128:131], v[48:51]
 s_waitcnt vmcnt(12)
 v_mfma_f32_16x16x32_bf16 v[80:83], a[208:211], a[128:131], v[80:83]
 v_mfma_f32_16x16x32_bf16 v[80:83], a[212:215], a[132:135], v[80:83]
 global_load_dwordx4 a[204:207], v0, s[70:71] offset:3072 sc1
 v_mfma_f32_16x16x32_bf16 v[84:87], a[212:215], a[140:143], v[84:87]
 v_mfma_f32_16x16x32_bf16 v[84:87], a[208:211], a[136:139], v[84:87]
 global_load_dwordx4 a[200:203], v0, s[70:71] offset:2048 sc1
 v_mfma_f32_16x16x32_bf16 v[88:91], a[208:211], a[144:147], v[88:91]
 s_add_u32 s70, s70, 8192
 s_addc_u32 s71, s71, 0
 v_mfma_f32_16x16x32_bf16 v[88:91], a[212:215], a[148:151], v[88:91]
 v_mfma_f32_16x16x32_bf16 v[92:95], a[212:215], a[156:159], v[92:95]
 v_mfma_f32_16x16x32_bf16 v[92:95], a[208:211], a[152:155], v[92:95]
 v_mfma_f32_16x16x32_bf16 v[96:99], a[208:211], a[160:163], v[96:99]
 v_mfma_f32_16x16x32_bf16 v[96:99], a[212:215], a[164:167], v[96:99]
 v_mfma_f32_16x16x32_bf16 v[100:103], a[212:215], a[172:175], v[100:103]
 v_mfma_f32_16x16x32_bf16 v[100:103], a[208:211], a[168:171], v[100:103]
 v_mfma_f32_16x16x32_bf16 v[104:107], a[208:211], a[176:179], v[104:107]
 v_mfma_f32_16x16x32_bf16 v[104:107], a[212:215], a[180:183], v[104:107]
 v_mfma_f32_16x16x32_bf16 v[108:111], a[212:215], a[188:191], v[108:111]
 v_mfma_f32_16x16x32_bf16 v[108:111], a[208:211], a[184:187], v[108:111]
 s_waitcnt vmcnt(10)
 v_mfma_f32_16x16x32_bf16 a[244:247], a[216:219], a[184:187], a[244:247]
 v_mfma_f32_16x16x32_bf16 a[244:247], a[220:223], a[188:191], a[244:247]
 global_load_dwordx4 a[212:215], v0, s[70:71] offset:-3072 sc1
 v_mfma_f32_16x16x32_bf16 a[240:243], a[220:223], a[180:183], a[240:243]
 v_mfma_f32_16x16x32_bf16 a[240:243], a[216:219], a[176:179], a[240:243]
 global_load_dwordx4 a[208:211], v0, s[70:71] offset:-4096 sc1
 v_mfma_f32_16x16x32_bf16 v[132:135], a[216:219], a[168:171], v[132:135]
 v_mfma_f32_16x16x32_bf16 v[132:135], a[220:223], a[172:175], v[132:135]
 v_mfma_f32_16x16x32_bf16 v[128:131], a[220:223], a[164:167], v[128:131]
 v_mfma_f32_16x16x32_bf16 v[128:131], a[216:219], a[160:163], v[128:131]
 v_mfma_f32_16x16x32_bf16 v[124:127], a[216:219], a[152:155], v[124:127]
 v_mfma_f32_16x16x32_bf16 v[124:127], a[220:223], a[156:159], v[124:127]
 v_mfma_f32_16x16x32_bf16 v[120:123], a[220:223], a[148:151], v[120:123]
 v_mfma_f32_16x16x32_bf16 v[120:123], a[216:219], a[144:147], v[120:123]
 v_mfma_f32_16x16x32_bf16 v[116:119], a[216:219], a[136:139], v[116:119]
 v_mfma_f32_16x16x32_bf16 v[116:119], a[220:223], a[140:143], v[116:119]
 v_mfma_f32_16x16x32_bf16 v[112:115], a[220:223], a[132:135], v[112:115]
 v_mfma_f32_16x16x32_bf16 v[112:115], a[216:219], a[128:131], v[112:115]
 s_waitcnt vmcnt(10)
 v_mfma_f32_16x16x32_bf16 v[136:139], a[224:227], a[128:131], v[136:139]
 buffer_load_dwordx4 v6, s[8:11], s30 offen lds
 v_mfma_f32_16x16x32_bf16 v[136:139], a[228:231], a[132:135], v[136:139]
 global_load_dwordx4 a[220:223], v0, s[70:71] offset:-1024 sc1
 v_mfma_f32_16x16x32_bf16 v[140:143], a[228:231], a[140:143], v[140:143]
 v_mfma_f32_16x16x32_bf16 v[140:143], a[224:227], a[136:139], v[140:143]
 global_load_dwordx4 a[216:219], v0, s[70:71] offset:-2048 sc1
 s_add_u32 m0, m0, 1024
 v_mfma_f32_16x16x32_bf16 v[144:147], a[224:227], a[144:147], v[144:147]
 v_mfma_f32_16x16x32_bf16 v[144:147], a[228:231], a[148:151], v[144:147]
 v_mfma_f32_16x16x32_bf16 v[148:151], a[228:231], a[156:159], v[148:151]
 v_mfma_f32_16x16x32_bf16 v[148:151], a[224:227], a[152:155], v[148:151]
 s_add_u32 s30, s30, s20
 v_mfma_f32_16x16x32_bf16 v[152:155], a[224:227], a[160:163], v[152:155]
 v_mfma_f32_16x16x32_bf16 v[152:155], a[228:231], a[164:167], v[152:155]
 v_mfma_f32_16x16x32_bf16 v[156:159], a[228:231], a[172:175], v[156:159]
 buffer_load_dwordx4 v6, s[8:11], s30 offen lds
 v_mfma_f32_16x16x32_bf16 v[156:159], a[224:227], a[168:171], v[156:159]
 v_mfma_f32_16x16x32_bf16 v[160:163], a[224:227], a[176:179], v[160:163]
 v_mfma_f32_16x16x32_bf16 v[160:163], a[228:231], a[180:183], v[160:163]
 s_add_u32 m0, m0, 3072
 v_mfma_f32_16x16x32_bf16 v[164:167], a[228:231], a[188:191], v[164:167]
 v_mfma_f32_16x16x32_bf16 v[164:167], a[224:227], a[184:187], v[164:167]
 s_waitcnt vmcnt(12)
 v_mfma_f32_16x16x32_bf16 v[196:199], a[232:235], a[184:187], v[196:199]
 s_add_u32 s30, s30, s21
 v_mfma_f32_16x16x32_bf16 v[196:199], a[236:239], a[188:191], v[196:199]
 global_load_dwordx4 a[228:231], v0, s[70:71] offset:1024 sc1
 v_mfma_f32_16x16x32_bf16 v[192:195], a[236:239], a[180:183], v[192:195]
 v_mfma_f32_16x16x32_bf16 v[192:195], a[232:235], a[176:179], v[192:195]
 global_load_dwordx4 a[224:227], v0, s[70:71] offset:0 sc1
 v_mfma_f32_16x16x32_bf16 v[188:191], a[232:235], a[168:171], v[188:191]
 v_mfma_f32_16x16x32_bf16 v[188:191], a[236:239], a[172:175], v[188:191]
 v_mfma_f32_16x16x32_bf16 v[184:187], a[236:239], a[164:167], v[184:187]
 v_mfma_f32_16x16x32_bf16 v[184:187], a[232:235], a[160:163], v[184:187]
 v_mfma_f32_16x16x32_bf16 v[180:183], a[232:235], a[152:155], v[180:183]
 v_mfma_f32_16x16x32_bf16 v[180:183], a[236:239], a[156:159], v[180:183]
 v_mfma_f32_16x16x32_bf16 v[176:179], a[236:239], a[148:151], v[176:179]
 v_mfma_f32_16x16x32_bf16 v[176:179], a[232:235], a[144:147], v[176:179]
 v_mfma_f32_16x16x32_bf16 v[172:175], a[232:235], a[136:139], v[172:175]
 v_mfma_f32_16x16x32_bf16 v[172:175], a[236:239], a[140:143], v[172:175]
 v_mfma_f32_16x16x32_bf16 v[168:171], a[236:239], a[132:135], v[168:171]
 v_mfma_f32_16x16x32_bf16 v[168:171], a[232:235], a[128:131], v[168:171]
 s_waitcnt vmcnt(11)
 v_mfma_f32_16x16x32_bf16 v[200:203], a[192:195], a[128:131], v[200:203]
 v_mfma_f32_16x16x32_bf16 v[200:203], a[196:199], a[132:135], v[200:203]
 global_load_dwordx4 a[236:239], v0, s[70:71] offset:3072 sc1
 v_mfma_f32_16x16x32_bf16 v[204:207], a[196:199], a[140:143], v[204:207]
 v_mfma_f32_16x16x32_bf16 v[204:207], a[192:195], a[136:139], v[204:207]
 global_load_dwordx4 a[232:235], v0, s[70:71] offset:2048 sc1
 v_mfma_f32_16x16x32_bf16 v[208:211], a[192:195], a[144:147], v[208:211]
 s_add_u32 s70, s70, 8192
 s_addc_u32 s71, s71, 0
 v_mfma_f32_16x16x32_bf16 v[208:211], a[196:199], a[148:151], v[208:211]
 v_mfma_f32_16x16x32_bf16 v[212:215], a[196:199], a[156:159], v[212:215]
 v_mfma_f32_16x16x32_bf16 v[212:215], a[192:195], a[152:155], v[212:215]
 v_mfma_f32_16x16x32_bf16 v[216:219], a[192:195], a[160:163], v[216:219]
 v_mfma_f32_16x16x32_bf16 v[216:219], a[196:199], a[164:167], v[216:219]
 v_mfma_f32_16x16x32_bf16 v[220:223], a[196:199], a[172:175], v[220:223]
 v_mfma_f32_16x16x32_bf16 v[220:223], a[192:195], a[168:171], v[220:223]
 v_mfma_f32_16x16x32_bf16 v[224:227], a[192:195], a[176:179], v[224:227]
 v_mfma_f32_16x16x32_bf16 v[224:227], a[196:199], a[180:183], v[224:227]
 v_mfma_f32_16x16x32_bf16 v[228:231], a[196:199], a[188:191], v[228:231]
 v_mfma_f32_16x16x32_bf16 v[228:231], a[192:195], a[184:187], v[228:231]
 buffer_load_dwordx4 v6, s[8:11], s30 offen lds
 s_waitcnt vmcnt(11)
 v_mfma_f32_16x16x32_bf16 a[252:255], a[200:203], a[184:187], a[252:255]
 ds_read_b128 a[184:187], v2 offset:63488
 v_mfma_f32_16x16x32_bf16 a[252:255], a[204:207], a[188:191], a[252:255]
 global_load_dwordx4 a[196:199], v0, s[70:71] offset:-3072 sc1
 ds_read_b128 a[188:191], v2 offset:64512
 v_mfma_f32_16x16x32_bf16 a[248:251], a[204:207], a[180:183], a[248:251]
 ds_read_b128 a[180:183], v2 offset:60416
 v_mfma_f32_16x16x32_bf16 a[248:251], a[200:203], a[176:179], a[248:251]
 global_load_dwordx4 a[192:195], v0, s[70:71] offset:-4096 sc1
 ds_read_b128 a[176:179], v2 offset:59392
 v_mfma_f32_16x16x32_bf16 v[252:255], a[200:203], a[168:171], v[252:255]
 ds_read_b128 a[168:171], v2 offset:55296
 v_mfma_f32_16x16x32_bf16 v[252:255], a[204:207], a[172:175], v[252:255]
 ds_read_b128 a[172:175], v2 offset:56320
 v_mfma_f32_16x16x32_bf16 v[248:251], a[204:207], a[164:167], v[248:251]
 ds_read_b128 a[164:167], v2 offset:52224
 v_mfma_f32_16x16x32_bf16 v[248:251], a[200:203], a[160:163], v[248:251]
 ds_read_b128 a[160:163], v2 offset:51200
 s_add_u32 m0, m0, 1024
 v_mfma_f32_16x16x32_bf16 v[244:247], a[200:203], a[152:155], v[244:247]
 ds_read_b128 a[152:155], v2 offset:47104
 v_mfma_f32_16x16x32_bf16 v[244:247], a[204:207], a[156:159], v[244:247]
 ds_read_b128 a[156:159], v2 offset:48128
 v_mfma_f32_16x16x32_bf16 v[240:243], a[204:207], a[148:151], v[240:243]
 ds_read_b128 a[148:151], v2 offset:44032
 s_add_u32 s30, s30, s20
 v_mfma_f32_16x16x32_bf16 v[240:243], a[200:203], a[144:147], v[240:243]
 ds_read_b128 a[144:147], v2 offset:43008
 v_mfma_f32_16x16x32_bf16 v[236:239], a[200:203], a[136:139], v[236:239]
 ds_read_b128 a[136:139], v2 offset:38912
 v_mfma_f32_16x16x32_bf16 v[236:239], a[204:207], a[140:143], v[236:239]
 ds_read_b128 a[140:143], v2 offset:39936
 v_mfma_f32_16x16x32_bf16 v[232:235], a[204:207], a[132:135], v[232:235]
 ds_read_b128 a[132:135], v2 offset:35840
 v_mfma_f32_16x16x32_bf16 v[232:235], a[200:203], a[128:131], v[232:235]
 ds_read_b128 a[128:131], v2 offset:34816
 s_waitcnt vmcnt(11) lgkmcnt(8)
 v_mfma_f32_16x16x32_bf16 v[44:47], a[208:211], a[184:187], v[44:47]
 buffer_load_dwordx4 v6, s[8:11], s30 offen lds
 v_mfma_f32_16x16x32_bf16 v[44:47], a[212:215], a[188:191], v[44:47]
 global_load_dwordx4 a[204:207], v0, s[70:71] offset:-1024 sc1
 s_add_u32 m0, m0, 3072
 v_mfma_f32_16x16x32_bf16 v[40:43], a[212:215], a[180:183], v[40:43]
 buffer_load_dword v4, off, s[64:67], 0 sc1
 v_mfma_f32_16x16x32_bf16 v[40:43], a[208:211], a[176:179], v[40:43]
 global_load_dwordx4 a[200:203], v0, s[70:71] offset:-2048 sc1
 v_mfma_f32_16x16x32_bf16 v[36:39], a[208:211], a[168:171], v[36:39]
 s_add_u32 s30, s30, s22
 v_mfma_f32_16x16x32_bf16 v[36:39], a[212:215], a[172:175], v[36:39]
 v_mfma_f32_16x16x32_bf16 v[32:35], a[212:215], a[164:167], v[32:35]
 v_mfma_f32_16x16x32_bf16 v[32:35], a[208:211], a[160:163], v[32:35]
 s_waitcnt lgkmcnt(0)
 v_mfma_f32_16x16x32_bf16 v[28:31], a[208:211], a[152:155], v[28:31]
 v_mfma_f32_16x16x32_bf16 v[28:31], a[212:215], a[156:159], v[28:31]
 v_mfma_f32_16x16x32_bf16 v[24:27], a[212:215], a[148:151], v[24:27]
 v_mfma_f32_16x16x32_bf16 v[24:27], a[208:211], a[144:147], v[24:27]
 v_mfma_f32_16x16x32_bf16 v[20:23], a[208:211], a[136:139], v[20:23]
 v_mfma_f32_16x16x32_bf16 v[20:23], a[212:215], a[140:143], v[20:23]
 v_mfma_f32_16x16x32_bf16 v[16:19], a[212:215], a[132:135], v[16:19]
 v_mfma_f32_16x16x32_bf16 v[16:19], a[208:211], a[128:131], v[16:19]
 s_waitcnt vmcnt(12)
 v_mfma_f32_16x16x32_bf16 v[48:51], a[216:219], a[128:131], v[48:51]
 v_lshrrev_b32 v5, 6, v1
 v_mfma_f32_16x16x32_bf16 v[48:51], a[220:223], a[132:135], v[48:51]
 global_load_dwordx4 a[212:215], v0, s[70:71] offset:1024 sc1
 v_mfma_f32_16x16x32_bf16 v[52:55], a[220:223], a[140:143], v[52:55]
 v_and_b32 v6, 48, v1
 v_mfma_f32_16x16x32_bf16 v[52:55], a[216:219], a[136:139], v[52:55]
 global_load_dwordx4 a[208:211], v0, s[70:71] offset:0 sc1
 v_lshl_add_u32 v5, v5, 11, v6
 v_mfma_f32_16x16x32_bf16 v[56:59], a[216:219], a[144:147], v[56:59]
 v_mfma_f32_16x16x32_bf16 v[56:59], a[220:223], a[148:151], v[56:59]
 s_mov_b32 m0, s52
 v_mfma_f32_16x16x32_bf16 v[60:63], a[220:223], a[156:159], v[60:63]
 s_add_u32 s3, s48, 31744
 v_mfma_f32_16x16x32_bf16 v[60:63], a[216:219], a[152:155], v[60:63]
 v_mfma_f32_16x16x32_bf16 v[64:67], a[216:219], a[160:163], v[64:67]
 buffer_load_dwordx4 v5, s[40:43], s48 offen lds
 v_mfma_f32_16x16x32_bf16 v[64:67], a[220:223], a[164:167], v[64:67]
 buffer_load_dwordx4 v5, s[40:43], s3 offen offset:1024 lds
 v_mfma_f32_16x16x32_bf16 v[68:71], a[220:223], a[172:175], v[68:71]
 v_mfma_f32_16x16x32_bf16 v[68:71], a[216:219], a[168:171], v[68:71]
 s_add_u32 s48, s48, 2097152
 v_mfma_f32_16x16x32_bf16 v[72:75], a[216:219], a[176:179], v[72:75]
 v_mfma_f32_16x16x32_bf16 v[72:75], a[220:223], a[180:183], v[72:75]
 v_mfma_f32_16x16x32_bf16 v[76:79], a[220:223], a[188:191], v[76:79]
 v_mfma_f32_16x16x32_bf16 v[76:79], a[216:219], a[184:187], v[76:79]
 s_waitcnt vmcnt(13)
 v_mfma_f32_16x16x32_bf16 v[108:111], a[224:227], a[184:187], v[108:111]
 v_mfma_f32_16x16x32_bf16 v[108:111], a[228:231], a[188:191], v[108:111]
 global_load_dwordx4 a[220:223], v0, s[70:71] offset:3072 sc1
 v_mfma_f32_16x16x32_bf16 v[104:107], a[228:231], a[180:183], v[104:107]
 v_mfma_f32_16x16x32_bf16 v[104:107], a[224:227], a[176:179], v[104:107]
 global_load_dwordx4 a[216:219], v0, s[70:71] offset:2048 sc1
 v_mfma_f32_16x16x32_bf16 v[100:103], a[224:227], a[168:171], v[100:103]
 s_add_u32 s70, s70, 8192
 s_addc_u32 s71, s71, 0
 v_mfma_f32_16x16x32_bf16 v[100:103], a[228:231], a[172:175], v[100:103]
 v_mfma_f32_16x16x32_bf16 v[96:99], a[228:231], a[164:167], v[96:99]
 v_mfma_f32_16x16x32_bf16 v[96:99], a[224:227], a[160:163], v[96:99]
 v_mfma_f32_16x16x32_bf16 v[92:95], a[224:227], a[152:155], v[92:95]
 v_mfma_f32_16x16x32_bf16 v[92:95], a[228:231], a[156:159], v[92:95]
 v_mfma_f32_16x16x32_bf16 v[88:91], a[228:231], a[148:151], v[88:91]
 v_mfma_f32_16x16x32_bf16 v[88:91], a[224:227], a[144:147], v[88:91]
 v_mfma_f32_16x16x32_bf16 v[84:87], a[224:227], a[136:139], v[84:87]
 v_mfma_f32_16x16x32_bf16 v[84:87], a[228:231], a[140:143], v[84:87]
 v_mfma_f32_16x16x32_bf16 v[80:83], a[228:231], a[132:135], v[80:83]
 v_mfma_f32_16x16x32_bf16 v[80:83], a[224:227], a[128:131], v[80:83]
 s_waitcnt vmcnt(13)
 v_mfma_f32_16x16x32_bf16 v[112:115], a[232:235], a[128:131], v[112:115]
 v_mfma_f32_16x16x32_bf16 v[112:115], a[236:239], a[132:135], v[112:115]
 global_load_dwordx4 a[228:231], v0, s[70:71] offset:-3072 sc1
 v_mfma_f32_16x16x32_bf16 v[116:119], a[236:239], a[140:143], v[116:119]
 v_mfma_f32_16x16x32_bf16 v[116:119], a[232:235], a[136:139], v[116:119]
 global_load_dwordx4 a[224:227], v0, s[70:71] offset:-4096 sc1
 v_mfma_f32_16x16x32_bf16 v[120:123], a[232:235], a[144:147], v[120:123]
 v_mfma_f32_16x16x32_bf16 v[120:123], a[236:239], a[148:151], v[120:123]
 v_mfma_f32_16x16x32_bf16 v[124:127], a[236:239], a[156:159], v[124:127]
 v_mfma_f32_16x16x32_bf16 v[124:127], a[232:235], a[152:155], v[124:127]
 v_mfma_f32_16x16x32_bf16 v[128:131], a[232:235], a[160:163], v[128:131]
 v_mfma_f32_16x16x32_bf16 v[128:131], a[236:239], a[164:167], v[128:131]
 v_mfma_f32_16x16x32_bf16 v[132:135], a[236:239], a[172:175], v[132:135]
 v_mfma_f32_16x16x32_bf16 v[132:135], a[232:235], a[168:171], v[132:135]
 v_mfma_f32_16x16x32_bf16 a[240:243], a[232:235], a[176:179], a[240:243]
 v_mfma_f32_16x16x32_bf16 a[240:243], a[236:239], a[180:183], a[240:243]
 v_mfma_f32_16x16x32_bf16 a[244:247], a[236:239], a[188:191], a[244:247]
 v_mfma_f32_16x16x32_bf16 a[244:247], a[232:235], a[184:187], a[244:247]
 s_waitcnt vmcnt(12)
 v_mfma_f32_16x16x32_bf16 v[164:167], a[192:195], a[184:187], v[164:167]
 v_mfma_f32_16x16x32_bf16 v[164:167], a[196:199], a[188:191], v[164:167]
 global_load_dwordx4 a[236:239], v0, s[70:71] offset:-1024 sc1
 v_mfma_f32_16x16x32_bf16 v[160:163], a[196:199], a[180:183], v[160:163]
 v_mfma_f32_16x16x32_bf16 v[160:163], a[192:195], a[176:179], v[160:163]
 global_load_dwordx4 a[232:235], v0, s[70:71] offset:-2048 sc1
 v_mfma_f32_16x16x32_bf16 v[156:159], a[192:195], a[168:171], v[156:159]
 v_mfma_f32_16x16x32_bf16 v[156:159], a[196:199], a[172:175], v[156:159]
 v_mfma_f32_16x16x32_bf16 v[152:155], a[196:199], a[164:167], v[152:155]
 v_mfma_f32_16x16x32_bf16 v[152:155], a[192:195], a[160:163], v[152:155]
 v_mfma_f32_16x16x32_bf16 v[148:151], a[192:195], a[152:155], v[148:151]
 v_mfma_f32_16x16x32_bf16 v[148:151], a[196:199], a[156:159], v[148:151]
 v_mfma_f32_16x16x32_bf16 v[144:147], a[196:199], a[148:151], v[144:147]
 v_mfma_f32_16x16x32_bf16 v[144:147], a[192:195], a[144:147], v[144:147]
 v_mfma_f32_16x16x32_bf16 v[140:143], a[192:195], a[136:139], v[140:143]
 v_mfma_f32_16x16x32_bf16 v[140:143], a[196:199], a[140:143], v[140:143]
 v_mfma_f32_16x16x32_bf16 v[136:139], a[196:199], a[132:135], v[136:139]
 v_mfma_f32_16x16x32_bf16 v[136:139], a[192:195], a[128:131], v[136:139]
 s_waitcnt vmcnt(10)
 v_mfma_f32_16x16x32_bf16 v[168:171], a[200:203], a[128:131], v[168:171]
 v_mfma_f32_16x16x32_bf16 v[168:171], a[204:207], a[132:135], v[168:171]
 global_load_dwordx4 a[196:199], v0, s[70:71] offset:1024 sc1
 v_mfma_f32_16x16x32_bf16 v[172:175], a[204:207], a[140:143], v[172:175]
 v_mfma_f32_16x16x32_bf16 v[172:175], a[200:203], a[136:139], v[172:175]
 global_load_dwordx4 a[192:195], v0, s[70:71] offset:0 sc1
 v_mfma_f32_16x16x32_bf16 v[176:179], a[200:203], a[144:147], v[176:179]
 v_mfma_f32_16x16x32_bf16 v[176:179], a[204:207], a[148:151], v[176:179]
 v_mfma_f32_16x16x32_bf16 v[180:183], a[204:207], a[156:159], v[180:183]
 v_mfma_f32_16x16x32_bf16 v[180:183], a[200:203], a[152:155], v[180:183]
 v_mfma_f32_16x16x32_bf16 v[184:187], a[200:203], a[160:163], v[184:187]
 v_mfma_f32_16x16x32_bf16 v[184:187], a[204:207], a[164:167], v[184:187]
 v_mfma_f32_16x16x32_bf16 v[188:191], a[204:207], a[172:175], v[188:191]
 v_mfma_f32_16x16x32_bf16 v[188:191], a[200:203], a[168:171], v[188:191]
 v_mfma_f32_16x16x32_bf16 v[192:195], a[200:203], a[176:179], v[192:195]
 v_mfma_f32_16x16x32_bf16 v[192:195], a[204:207], a[180:183], v[192:195]
 v_mfma_f32_16x16x32_bf16 v[196:199], a[204:207], a[188:191], v[196:199]
 v_mfma_f32_16x16x32_bf16 v[196:199], a[200:203], a[184:187], v[196:199]
 s_waitcnt vmcnt(10)
 v_mfma_f32_16x16x32_bf16 v[228:231], a[208:211], a[184:187], v[228:231]
 v_mfma_f32_16x16x32_bf16 v[228:231], a[212:215], a[188:191], v[228:231]
 global_load_dwordx4 a[204:207], v0, s[70:71] offset:3072 sc1
 v_mfma_f32_16x16x32_bf16 v[224:227], a[212:215], a[180:183], v[224:227]
 v_mfma_f32_16x16x32_bf16 v[224:227], a[208:211], a[176:179], v[224:227]
 global_load_dwordx4 a[200:203], v0, s[70:71] offset:2048 sc1
 v_mfma_f32_16x16x32_bf16 v[220:223], a[208:211], a[168:171], v[220:223]
 s_add_u32 s70, s70, 8192
 s_addc_u32 s71, s71, 0
 v_mfma_f32_16x16x32_bf16 v[220:223], a[212:215], a[172:175], v[220:223]
 v_mfma_f32_16x16x32_bf16 v[216:219], a[212:215], a[164:167], v[216:219]
 v_mfma_f32_16x16x32_bf16 v[216:219], a[208:211], a[160:163], v[216:219]
 v_mfma_f32_16x16x32_bf16 v[212:215], a[208:211], a[152:155], v[212:215]
 v_mfma_f32_16x16x32_bf16 v[212:215], a[212:215], a[156:159], v[212:215]
 v_mfma_f32_16x16x32_bf16 v[208:211], a[212:215], a[148:151], v[208:211]
 v_cmp_gt_i32 vcc, s55, v4
 s_and_b64 vcc, exec, vcc
 s_cbranch_vccnz Lspin_pb
Lok_pb:
 s_add_u32 s55, s55, 1
 s_waitcnt lgkmcnt(0)
 s_barrier
 v_mfma_f32_16x16x32_bf16 v[208:211], a[208:211], a[144:147], v[208:211]
 s_cmp_eq_u32 s25, 0
 s_cbranch_scc1 Lxrg
Lxrgr:
 v_mfma_f32_16x16x32_bf16 v[204:207], a[208:211], a[136:139], v[204:207]
 v_mfma_f32_16x16x32_bf16 v[204:207], a[212:215], a[140:143], v[204:207]
 v_mfma_f32_16x16x32_bf16 v[200:203], a[212:215], a[132:135], v[200:203]
 v_mfma_f32_16x16x32_bf16 v[200:203], a[208:211], a[128:131], v[200:203]
 s_waitcnt vmcnt(8)
 v_mfma_f32_16x16x32_bf16 v[232:235], a[216:219], a[128:131], v[232:235]
 ds_read_b128 a[128:131], v1
 v_mfma_f32_16x16x32_bf16 v[232:235], a[220:223], a[132:135], v[232:235]
 global_load_dwordx4 a[212:215], v0, s[70:71] offset:-3072 sc1
 ds_read_b128 a[132:135], v1 offset:1024
 v_mfma_f32_16x16x32_bf16 v[236:239], a[220:223], a[140:143], v[236:239]
 ds_read_b128 a[140:143], v1 offset:5120
 v_mfma_f32_16x16x32_bf16 v[236:239], a[216:219], a[136:139], v[236:239]
 global_load_dwordx4 a[208:211], v0, s[70:71] offset:-4096 sc1
 ds_read_b128 a[136:139], v1 offset:4096
 v_mfma_f32_16x16x32_bf16 v[240:243], a[216:219], a[144:147], v[240:243]
 ds_read_b128 a[144:147], v1 offset:8192
 v_mfma_f32_16x16x32_bf16 v[240:243], a[220:223], a[148:151], v[240:243]
 ds_read_b128 a[148:151], v1 offset:9216
 v_mfma_f32_16x16x32_bf16 v[244:247], a[220:223], a[156:159], v[244:247]
 ds_read_b128 a[156:159], v1 offset:13312
 v_mfma_f32_16x16x32_bf16 v[244:247], a[216:219], a[152:155], v[244:247]
 ds_read_b128 a[152:155], v1 offset:12288
 v_mfma_f32_16x16x32_bf16 v[248:251], a[216:219], a[160:163], v[248:251]
 ds_read_b128 a[160:163], v1 offset:16384
 v_mfma_f32_16x16x32_bf16 v[248:251], a[220:223], a[164:167], v[248:251]
 ds_read_b128 a[164:167], v1 offset:17408
 v_mfma_f32_16x16x32_bf16 v[252:255], a[220:223], a[172:175], v[252:255]
 ds_read_b128 a[172:175], v1 offset:21504
 v_mfma_f32_16x16x32_bf16 v[252:255], a[216:219], a[168:171], v[252:255]
 ds_read_b128 a[168:171], v1 offset:20480
 v_mfma_f32_16x16x32_bf16 a[248:251], a[216:219], a[176:179], a[248:251]
 ds_read_b128 a[176:179], v1 offset:24576
 v_mfma_f32_16x16x32_bf16 a[248:251], a[220:223], a[180:183], a[248:251]
 ds_read_b128 a[180:183], v1 offset:25600
 v_mfma_f32_16x16x32_bf16 a[252:255], a[220:223], a[188:191], a[252:255]
 global_load_dwordx4 a[220:223], v0, s[70:71] offset:-1024 sc1
 ds_read_b128 a[188:191], v1 offset:29696
 v_mfma_f32_16x16x32_bf16 a[252:255], a[216:219], a[184:187], a[252:255]
 global_load_dwordx4 a[216:219], v0, s[70:71] offset:-2048 sc1
 ds_read_b128 a[184:187], v1 offset:28672
 s_waitcnt vmcnt(10) lgkmcnt(8)
 v_mfma_f32_16x16x32_bf16 v[16:19], a[224:227], a[128:131], v[16:19]
 v_mfma_f32_16x16x32_bf16 v[16:19], a[228:231], a[132:135], v[16:19]
 v_mov_b32 v6, v3
 s_cmp_eq_u32 s25, 0
 s_cbranch_scc1 Lgat1
Lgatr1:
 v_mfma_f32_16x16x32_bf16 v[20:23], a[228:231], a[140:143], v[20:23]
 v_mfma_f32_16x16x32_bf16 v[20:23], a[224:227], a[136:139], v[20:23]
 v_mfma_f32_16x16x32_bf16 v[24:27], a[224:227], a[144:147], v[24:27]
 v_mfma_f32_16x16x32_bf16 v[24:27], a[228:231], a[148:151], v[24:27]
 s_add_u32 m0, s50, 2048
 v_mfma_f32_16x16x32_bf16 v[28:31], a[228:231], a[156:159], v[28:31]
 v_mfma_f32_16x16x32_bf16 v[28:31], a[224:227], a[152:155], v[28:31]
 s_waitcnt lgkmcnt(0)
 v_mfma_f32_16x16x32_bf16 v[32:35], a[224:227], a[160:163], v[32:35]
 v_mfma_f32_16x16x32_bf16 v[32:35], a[228:231], a[164:167], v[32:35]
 v_mfma_f32_16x16x32_bf16 v[36:39], a[228:231], a[172:175], v[36:39]
 v_mfma_f32_16x16x32_bf16 v[36:39], a[224:227], a[168:171], v[36:39]
 v_mfma_f32_16x16x32_bf16 v[40:43], a[224:227], a[176:179], v[40:43]
 buffer_load_dwordx4 v6, s[8:11], s30 offen lds
 v_mfma_f32_16x16x32_bf16 v[40:43], a[228:231], a[180:183], v[40:43]
 v_mfma_f32_16x16x32_bf16 v[44:47], a[228:231], a[188:191], v[44:47]
 v_mfma_f32_16x16x32_bf16 v[44:47], a[224:227], a[184:187], v[44:47]
 s_waitcnt vmcnt(9)
 v_mfma_f32_16x16x32_bf16 v[76:79], a[232:235], a[184:187], v[76:79]
 s_add_u32 m0, m0, 1024
 v_mfma_f32_16x16x32_bf16 v[76:79], a[236:239], a[188:191], v[76:79]
 global_load_dwordx4 a[228:231], v0, s[70:71] offset:1024 sc1
 v_mfma_f32_16x16x32_bf16 v[72:75], a[236:239], a[180:183], v[72:75]
 v_mfma_f32_16x16x32_bf16 v[72:75], a[232:235], a[176:179], v[72:75]
 global_load_dwordx4 a[224:227], v0, s[70:71] offset:0 sc1
 s_add_u32 s30, s30, s20
 v_mfma_f32_16x16x32_bf16 v[68:71], a[232:235], a[168:171], v[68:71]
 v_mfma_f32_16x16x32_bf16 v[68:71], a[236:239], a[172:175], v[68:71]
 v_mfma_f32_16x16x32_bf16 v[64:67], a[236:239], a[164:167], v[64:67]
 v_mfma_f32_16x16x32_bf16 v[64:67], a[232:235], a[160:163], v[64:67]
 buffer_load_dwordx4 v6, s[8:11], s30 offen lds
 v_mfma_f32_16x16x32_bf16 v[60:63], a[232:235], a[152:155], v[60:63]
 v_mfma_f32_16x16x32_bf16 v[60:63], a[236:239], a[156:159], v[60:63]
 v_mfma_f32_16x16x32_bf16 v[56:59], a[236:239], a[148:151], v[56:59]
 v_mfma_f32_16x16x32_bf16 v[56:59], a[232:235], a[144:147], v[56:59]
 s_add_u32 m0, m0, 3072
 v_mfma_f32_16x16x32_bf16 v[52:55], a[232:235], a[136:139], v[52:55]
 v_mfma_f32_16x16x32_bf16 v[52:55], a[236:239], a[140:143], v[52:55]
 v_mfma_f32_16x16x32_bf16 v[48:51], a[236:239], a[132:135], v[48:51]
 s_add_u32 s30, s30, s21
 v_mfma_f32_16x16x32_bf16 v[48:51], a[232:235], a[128:131], v[48:51]
 s_waitcnt vmcnt(10)
 v_mfma_f32_16x16x32_bf16 v[80:83], a[192:195], a[128:131], v[80:83]
 v_mfma_f32_16x16x32_bf16 v[80:83], a[196:199], a[132:135], v[80:83]
 global_load_dwordx4 a[236:239], v0, s[70:71] offset:3072 sc1
 v_mfma_f32_16x16x32_bf16 v[84:87], a[196:199], a[140:143], v[84:87]
 v_mfma_f32_16x16x32_bf16 v[84:87], a[192:195], a[136:139], v[84:87]
 global_load_dwordx4 a[232:235], v0, s[70:71] offset:2048 sc1
 v_mfma_f32_16x16x32_bf16 v[88:91], a[192:195], a[144:147], v[88:91]
 s_add_u32 s70, s70, 8192
 s_addc_u32 s71, s71, 0
 v_mfma_f32_16x16x32_bf16 v[88:91], a[196:199], a[148:151], v[88:91]
 v_mfma_f32_16x16x32_bf16 v[92:95], a[196:199], a[156:159], v[92:95]
 v_mfma_f32_16x16x32_bf16 v[92:95], a[192:195], a[152:155], v[92:95]
 v_mfma_f32_16x16x32_bf16 v[96:99], a[192:195], a[160:163], v[96:99]
 v_mfma_f32_16x16x32_bf16 v[96:99], a[196:199], a[164:167], v[96:99]
 v_mfma_f32_16x16x32_bf16 v[100:103], a[196:199], a[172:175], v[100:103]
 v_mfma_f32_16x16x32_bf16 v[100:103], a[192:195], a[168:171], v[100:103]
 v_mfma_f32_16x16x32_bf16 v[104:107], a[192:195], a[176:179], v[104:107]
 v_mfma_f32_16x16x32_bf16 v[104:107], a[196:199], a[180:183], v[104:107]
 v_mfma_f32_16x16x32_bf16 v[108:111], a[196:199], a[188:191], v[108:111]
 v_mfma_f32_16x16x32_bf16 v[108:111], a[192:195], a[184:187], v[108:111]
 s_waitcnt vmcnt(10)
 v_mfma_f32_16x16x32_bf16 a[244:247], a[200:203], a[184:187], a[244:247]
 v_mfma_f32_16x16x32_bf16 a[244:247], a[204:207], a[188:191], a[244:247]
 global_load_dwordx4 a[196:199], v0, s[70:71] offset:-3072 sc1
 v_mfma_f32_16x16x32_bf16 a[240:243], a[204:207], a[180:183], a[240:243]
 v_mfma_f32_16x16x32_bf16 a[240:243], a[200:203], a[176:179], a[240:243]
 global_load_dwordx4 a[192:195], v0, s[70:71] offset:-4096 sc1
 v_mfma_f32_16x16x32_bf16 v[132:135], a[200:203], a[168:171], v[132:135]
 v_mfma_f32_16x16x32_bf16 v[132:135], a[204:207], a[172:175], v[132:135]
 v_mfma_f32_16x16x32_bf16 v[128:131], a[204:207], a[164:167], v[128:131]
 v_mfma_f32_16x16x32_bf16 v[128:131], a[200:203], a[160:163], v[128:131]
 v_mfma_f32_16x16x32_bf16 v[124:127], a[200:203], a[152:155], v[124:127]
 v_mfma_f32_16x16x32_bf16 v[124:127], a[204:207], a[156:159], v[124:127]
 v_mfma_f32_16x16x32_bf16 v[120:123], a[204:207], a[148:151], v[120:123]
 v_mfma_f32_16x16x32_bf16 v[120:123], a[200:203], a[144:147], v[120:123]
 v_mfma_f32_16x16x32_bf16 v[116:119], a[200:203], a[136:139], v[116:119]
 v_mfma_f32_16x16x32_bf16 v[116:119], a[204:207], a[140:143], v[116:119]
 v_mfma_f32_16x16x32_bf16 v[112:115], a[204:207], a[132:135], v[112:115]
 v_mfma_f32_16x16x32_bf16 v[112:115], a[200:203], a[128:131], v[112:115]
 s_waitcnt vmcnt(10)
 v_mfma_f32_16x16x32_bf16 v[136:139], a[208:211], a[128:131], v[136:139]
 v_mfma_f32_16x16x32_bf16 v[136:139], a[212:215], a[132:135], v[136:139]
 global_load_dwordx4 a[204:207], v0, s[70:71] offset:-1024 sc1
 v_mfma_f32_16x16x32_bf16 v[140:143], a[212:215], a[140:143], v[140:143]
 v_mfma_f32_16x16x32_bf16 v[140:143], a[208:211], a[136:139], v[140:143]
 global_load_dwordx4 a[200:203], v0, s[70:71] offset:-2048 sc1
 v_mfma_f32_16x16x32_bf16 v[144:147], a[208:211], a[144:147], v[144:147]
 v_mfma_f32_16x16x32_bf16 v[144:147], a[212:215], a[148:151], v[144:147]
 v_mfma_f32_16x16x32_bf16 v[148:151], a[212:215], a[156:159], v[148:151]
 buffer_load_dwordx4 v6, s[8:11], s30 offen lds
 v_mfma_f32_16x16x32_bf16 v[148:151], a[208:211], a[152:155], v[148:151]
 v_mfma_f32_16x16x32_bf16 v[152:155], a[208:211], a[160:163], v[152:155]
 v_mfma_f32_16x16x32_bf16 v[152:155], a[212:215], a[164:167], v[152:155]
 v_mfma_f32_16x16x32_bf16 v[156:159], a[212:215], a[172:175], v[156:159]
 s_add_u32 m0, m0, 1024
 v_mfma_f32_16x16x32_bf16 v[156:159], a[208:211], a[168:171], v[156:159]
 v_mfma_f32_16x16x32_bf16 v[160:163], a[208:211], a[176:179], v[160:163]
 v_mfma_f32_16x16x32_bf16 v[160:163], a[212:215], a[180:183], v[160:163]
 v_mfma_f32_16x16x32_bf16 v[164:167], a[212:215], a[188:191], v[164:167]
 s_add_u32 s30, s30, s20
 v_mfma_f32_16x16x32_bf16 v[164:167], a[208:211], a[184:187], v[164:167]
 s_waitcnt vmcnt(11)
 v_mfma_f32_16x16x32_bf16 v[196:199], a[216:219], a[184:187], v[196:199]
 v_mfma_f32_16x16x32_bf16 v[196:199], a[220:223], a[188:191], v[196:199]
 global_load_dwordx4 a[212:215], v0, s[70:71] offset:1024 sc1
 v_mfma_f32_16x16x32_bf16 v[192:195], a[220:223], a[180:183], v[192:195]
 buffer_load_dwordx4 v6, s[8:11], s30 offen lds
 v_mfma_f32_16x16x32_bf16 v[192:195], a[216:219], a[176:179], v[192:195]
 global_load_dwordx4 a[208:211], v0, s[70:71] offset:0 sc1
 v_mfma_f32_16x16x32_bf16 v[188:191], a[216:219], a[168:171], v[188:191]
 v_mfma_f32_16x16x32_bf16 v[188:191], a[220:223], a[172:175], v[188:191]
 s_add_u32 m0, m0, 3072
 v_mfma_f32_16x16x32_bf16 v[184:187], a[220:223], a[164:167], v[184:187]
 v_mfma_f32_16x16x32_bf16 v[184:187], a[216:219], a[160:163], v[184:187]
 v_mfma_f32_16x16x32_bf16 v[180:183], a[216:219], a[152:155], v[180:183]
 v_mfma_f32_16x16x32_bf16 v[180:183], a[220:223], a[156:159], v[180:183]
 s_add_u32 s30, s30, s21
 v_mfma_f32_16x16x32_bf16 v[176:179], a[220:223], a[148:151], v[176:179]
 v_mfma_f32_16x16x32_bf16 v[176:179], a[216:219], a[144:147], v[176:179]
 v_mfma_f32_16x16x32_bf16 v[172:175], a[216:219], a[136:139], v[172:175]
 v_mfma_f32_16x16x32_bf16 v[172:175], a[220:223], a[140:143], v[172:175]
 v_mfma_f32_16x16x32_bf16 v[168:171], a[220:223], a[132:135], v[168:171]
 v_mfma_f32_16x16x32_bf16 v[168:171], a[216:219], a[128:131], v[168:171]
 s_waitcnt vmcnt(11)
 v_mfma_f32_16x16x32_bf16 v[200:203], a[224:227], a[128:131], v[200:203]
 v_mfma_f32_16x16x32_bf16 v[200:203], a[228:231], a[132:135], v[200:203]
 global_load_dwordx4 a[220:223], v0, s[70:71] offset:3072 sc1
 v_mfma_f32_16x16x32_bf16 v[204:207], a[228:231], a[140:143], v[204:207]
 v_mfma_f32_16x16x32_bf16 v[204:207], a[224:227], a[136:139], v[204:207]
 global_load_dwordx4 a[216:219], v0, s[70:71] offset:2048 sc1
 v_mfma_f32_16x16x32_bf16 v[208:211], a[224:227], a[144:147], v[208:211]
 s_add_u32 s70, s70, 8192
 s_addc_u32 s71, s71, 0
 v_mfma_f32_16x16x32_bf16 v[208:211], a[228:231], a[148:151], v[208:211]
 v_mfma_f32_16x16x32_bf16 v[212:215], a[228:231], a[156:159], v[212:215]
 v_mfma_f32_16x16x32_bf16 v[212:215], a[224:227], a[152:155], v[212:215]
 v_mfma_f32_16x16x32_bf16 v[216:219], a[224:227], a[160:163], v[216:219]
 v_mfma_f32_16x16x32_bf16 v[216:219], a[228:231], a[164:167], v[216:219]
 v_mfma_f32_16x16x32_bf16 v[220:223], a[228:231], a[172:175], v[220:223]
 v_mfma_f32_16x16x32_bf16 v[220:223], a[224:227], a[168:171], v[220:223]
 v_mfma_f32_16x16x32_bf16 v[224:227], a[224:227], a[176:179], v[224:227]
 v_mfma_f32_16x16x32_bf16 v[224:227], a[228:231], a[180:183], v[224:227]
 v_mfma_f32_16x16x32_bf16 v[228:231], a[228:231], a[188:191], v[228:231]
 v_mfma_f32_16x16x32_bf16 v[228:231], a[224:227], a[184:187], v[228:231]
 s_waitcnt vmcnt(10)
 v_mfma_f32_16x16x32_bf16 a[252:255], a[232:235], a[184:187], a[252:255]
 ds_read_b128 a[184:187], v1 offset:61440
 v_mfma_f32_16x16x32_bf16 a[252:255], a[236:239], a[188:191], a[252:255]
 global_load_dwordx4 a[228:231], v0, s[70:71] offset:-3072 sc1
 ds_read_b128 a[188:191], v1 offset:62464
 v_mfma_f32_16x16x32_bf16 a[248:251], a[236:239], a[180:183], a[248:251]
 ds_read_b128 a[180:183], v1 offset:58368
 v_mfma_f32_16x16x32_bf16 a[248:251], a[232:235], a[176:179], a[248:251]
 global_load_dwordx4 a[224:227], v0, s[70:71] offset:-4096 sc1
 ds_read_b128 a[176:179], v1 offset:57344
 v_mfma_f32_16x16x32_bf16 v[252:255], a[232:235], a[168:171], v[252:255]
 ds_read_b128 a[168:171], v1 offset:53248
 v_mfma_f32_16x16x32_bf16 v[252:255], a[236:239], a[172:175], v[252:255]
 ds_read_b128 a[172:175], v1 offset:54272
 v_mfma_f32_16x16x32_bf16 v[248:251], a[236:239], a[164:167], v[248:251]
 ds_read_b128 a[164:167], v1 offset:50176
 v_mfma_f32_16x16x32_bf16 v[248:251], a[232:235], a[160:163], v[248:251]
 ds_read_b128 a[160:163], v1 offset:49152
 v_mfma_f32_16x16x32_bf16 v[244:247], a[232:235], a[152:155], v[244:247]
 ds_read_b128 a[152:155], v1 offset:45056
 v_mfma_f32_16x16x32_bf16 v[244:247], a[236:239], a[156:159], v[244:247]
 ds_read_b128 a[156:159], v1 offset:46080
 v_mfma_f32_16x16x32_bf16 v[240:243], a[236:239], a[148:151], v[240:243]
 ds_read_b128 a[148:151], v1 offset:41984
 v_mfma_f32_16x16x32_bf16 v[240:243], a[232:235], a[144:147], v[240:243]
 ds_read_b128 a[144:147], v1 offset:40960
 v_mfma_f32_16x16x32_bf16 v[236:239], a[232:235], a[136:139], v[236:239]
 ds_read_b128 a[136:139], v1 offset:36864
 v_mfma_f32_16x16x32_bf16 v[236:239], a[236:239], a[140:143], v[236:239]
 ds_read_b128 a[140:143], v1 offset:37888
 v_mfma_f32_16x16x32_bf16 v[232:235], a[236:239], a[132:135], v[232:235]
 ds_read_b128 a[132:135], v1 offset:33792
 v_mfma_f32_16x16x32_bf16 v[232:235], a[232:235], a[128:131], v[232:235]
 ds_read_b128 a[128:131], v1 offset:32768
 s_waitcnt vmcnt(10) lgkmcnt(8)
 v_mfma_f32_16x16x32_bf16 v[44:47], a[192:195], a[184:187], v[44:47]
 v_mfma_f32_16x16x32_bf16 v[44:47], a[196:199], a[188:191], v[44:47]
 buffer_load_dwordx4 v6, s[8:11], s30 offen lds
 v_mfma_f32_16x16x32_bf16 v[40:43], a[196:199], a[180:183], v[40:43]
 v_mfma_f32_16x16x32_bf16 v[40:43], a[192:195], a[176:179], v[40:43]
 v_mfma_f32_16x16x32_bf16 v[36:39], a[192:195], a[168:171], v[36:39]
 s_add_u32 m0, m0, 1024
 v_mfma_f32_16x16x32_bf16 v[36:39], a[196:199], a[172:175], v[36:39]
 v_mfma_f32_16x16x32_bf16 v[32:35], a[196:199], a[164:167], v[32:35]
 v_mfma_f32_16x16x32_bf16 v[32:35], a[192:195], a[160:163], v[32:35]
 s_waitcnt lgkmcnt(0)
 v_mfma_f32_16x16x32_bf16 v[28:31], a[192:195], a[152:155], v[28:31]
 s_add_u32 s30, s30, s20
 v_mfma_f32_16x16x32_bf16 v[28:31], a[196:199], a[156:159], v[28:31]
 v_mfma_f32_16x16x32_bf16 v[24:27], a[196:199], a[148:151], v[24:27]
 v_mfma_f32_16x16x32_bf16 v[24:27], a[192:195], a[144:147], v[24:27]
 v_mfma_f32_16x16x32_bf16 v[20:23], a[192:195], a[136:139], v[20:23]
 buffer_load_dwordx4 v6, s[8:11], s30 offen lds
 v_mfma_f32_16x16x32_bf16 v[20:23], a[196:199], a[140:143], v[20:23]
 v_mfma_f32_16x16x32_bf16 v[16:19], a[196:199], a[132:135], v[16:19]
 v_mfma_f32_16x16x32_bf16 v[16:19], a[192:195], a[128:131], v[16:19]
 s_add_u32 m0, m0, 3072
 s_waitcnt vmcnt(10)
 v_mfma_f32_16x16x32_bf16 v[48:51], a[200:203], a[128:131], v[48:51]
 v_mfma_f32_16x16x32_bf16 v[48:51], a[204:207], a[132:135], v[48:51]
 global_load_dwordx4 a[196:199], v0, s[70:71] offset:-1024 sc1
 v_mfma_f32_16x16x32_bf16 v[52:55], a[204:207], a[140:143], v[52:55]
 v_mfma_f32_16x16x32_bf16 v[52:55], a[200:203], a[136:139], v[52:55]
 global_load_dwordx4 a[192:195], v0, s[70:71] offset:-2048 sc1
 s_add_u32 s30, s30, s21
 v_mfma_f32_16x16x32_bf16 v[56:59], a[200:203], a[144:147], v[56:59]
 v_mfma_f32_16x16x32_bf16 v[56:59], a[204:207], a[148:151], v[56:59]
 v_mfma_f32_16x16x32_bf16 v[60:63], a[204:207], a[156:159], v[60:63]
 v_mfma_f32_16x16x32_bf16 v[60:63], a[200:203], a[152:155], v[60:63]
 v_mfma_f32_16x16x32_bf16 v[64:67], a[200:203], a[160:163], v[64:67]
 v_mfma_f32_16x16x32_bf16 v[64:67], a[204:207], a[164:167], v[64:67]
 v_mfma_f32_16x16x32_bf16 v[68:71], a[204:207], a[172:175], v[68:71]
 v_mfma_f32_16x16x32_bf16 v[68:71], a[200:203], a[168:171], v[68:71]
 v_mfma_f32_16x16x32_bf16 v[72:75], a[200:203], a[176:179], v[72:75]
 v_mfma_f32_16x16x32_bf16 v[72:75], a[204:207], a[180:183], v[72:75]
 v_mfma_f32_16x16x32_bf16 v[76:79], a[204:207], a[188:191], v[76:79]
 v_mfma_f32_16x16x32_bf16 v[76:79], a[200:203], a[184:187], v[76:79]
 s_waitcnt vmcnt(8)
 v_mfma_f32_16x16x32_bf16 v[108:111], a[208:211], a[184:187], v[108:111]
 v_mfma_f32_16x16x32_bf16 v[108:111], a[212:215], a[188:191], v[108:111]
 global_load_dwordx4 a[204:207], v0, s[70:71] offset:1024 sc1
 v_mfma_f32_16x16x32_bf16 v[104:107], a[212:215], a[180:183], v[104:107]
 v_mfma_f32_16x16x32_bf16 v[104:107], a[208:211], a[176:179], v[104:107]
 global_load_dwordx4 a[200:203], v0, s[70:71] offset:0 sc1
 v_mfma_f32_16x16x32_bf16 v[100:103], a[208:211], a[168:171], v[100:103]
 v_mfma_f32_16x16x32_bf16 v[100:103], a[212:215], a[172:175], v[100:103]
 v_mfma_f32_16x16x32_bf16 v[96:99], a[212:215], a[164:167], v[96:99]
 v_mfma_f32_16x16x32_bf16 v[96:99], a[208:211], a[160:163], v[96:99]
 v_mfma_f32_16x16x32_bf16 v[92:95], a[208:211], a[152:155], v[92:95]
 v_mfma_f32_16x16x32_bf16 v[92:95], a[212:215], a[156:159], v[92:95]
 v_mfma_f32_16x16x32_bf16 v[88:91], a[212:215], a[148:151], v[88:91]
 v_mfma_f32_16x16x32_bf16 v[88:91], a[208:211], a[144:147], v[88:91]
 v_mfma_f32_16x16x32_bf16 v[84:87], a[208:211], a[136:139], v[84:87]
 v_mfma_f32_16x16x32_bf16 v[84:87], a[212:215], a[140:143], v[84:87]
 v_mfma_f32_16x16x32_bf16 v[80:83], a[212:215], a[132:135], v[80:83]
 v_mfma_f32_16x16x32_bf16 v[80:83], a[208:211], a[128:131], v[80:83]
 s_waitcnt vmcnt(8)
 v_mfma_f32_16x16x32_bf16 v[112:115], a[216:219], a[128:131], v[112:115]
 v_mfma_f32_16x16x32_bf16 v[112:115], a[220:223], a[132:135], v[112:115]
 global_load_dwordx4 a[212:215], v0, s[70:71] offset:3072 sc1
 v_mfma_f32_16x16x32_bf16 v[116:119], a[220:223], a[140:143], v[116:119]
 v_mfma_f32_16x16x32_bf16 v[116:119], a[216:219], a[136:139], v[116:119]
 global_load_dwordx4 a[208:211], v0, s[70:71] offset:2048 sc1
 v_mfma_f32_16x16x32_bf16 v[120:123], a[216:219], a[144:147], v[120:123]
 s_add_u32 s70, s70, 8192
 s_addc_u32 s71, s71, 0
 v_mfma_f32_16x16x32_bf16 v[120:123], a[220:223], a[148:151], v[120:123]
 v_mfma_f32_16x16x32_bf16 v[124:127], a[220:223], a[156:159], v[124:127]
 v_mfma_f32_16x16x32_bf16 v[124:127], a[216:219], a[152:155], v[124:127]
 v_mfma_f32_16x16x32_bf16 v[128:131], a[216:219], a[160:163], v[128:131]
 v_mfma_f32_16x16x32_bf16 v[128:131], a[220:223], a[164:167], v[128:131]
 v_mfma_f32_16x16x32_bf16 v[132:135], a[220:223], a[172:175], v[132:135]
 v_mfma_f32_16x16x32_bf16 v[132:135], a[216:219], a[168:171], v[132:135]
 buffer_load_dwordx4 v6, s[8:11], s30 offen lds
 v_mfma_f32_16x16x32_bf16 a[240:243], a[216:219], a[176:179], a[240:243]
 v_mfma_f32_16x16x32_bf16 a[240:243], a[220:223], a[180:183], a[240:243]
 v_mfma_f32_16x16x32_bf16 a[244:247], a[220:223], a[188:191], a[244:247]
 s_add_u32 m0, m0, 1024
 v_mfma_f32_16x16x32_bf16 a[244:247], a[216:219], a[184:187], a[244:247]
 s_waitcnt vmcnt(9)
 v_mfma_f32_16x16x32_bf16 v[164:167], a[224:227], a[184:187], v[164:167]
 v_mfma_f32_16x16x32_bf16 v[164:167], a[228:231], a[188:191], v[164:167]
 global_load_dwordx4 a[220:223], v0, s[70:71] offset:-3072 sc1
 v_mfma_f32_16x16x32_bf16 v[160:163], a[228:231], a[180:183], v[160:163]
 s_add_u32 s30, s30, s20
 v_mfma_f32_16x16x32_bf16 v[160:163], a[224:227], a[176:179], v[160:163]
 global_load_dwordx4 a[216:219], v0, s[70:71] offset:-4096 sc1
 v_mfma_f32_16x16x32_bf16 v[156:159], a[224:227], a[168:171], v[156:159]
 v_mfma_f32_16x16x32_bf16 v[156:159], a[228:231], a[172:175], v[156:159]
 v_mfma_f32_16x16x32_bf16 v[152:155], a[228:231], a[164:167], v[152:155]
 buffer_load_dwordx4 v6, s[8:11], s30 offen lds
 v_mfma_f32_16x16x32_bf16 v[152:155], a[224:227], a[160:163], v[152:155]
 v_mfma_f32_16x16x32_bf16 v[148:151], a[224:227], a[152:155], v[148:151]
 v_mfma_f32_16x16x32_bf16 v[148:151], a[228:231], a[156:159], v[148:151]
 s_add_u32 m0, m0, 3072
 v_mfma_f32_16x16x32_bf16 v[144:147], a[228:231], a[148:151], v[144:147]
 v_mfma_f32_16x16x32_bf16 v[144:147], a[224:227], a[144:147], v[144:147]
 v_mfma_f32_16x16x32_bf16 v[140:143], a[224:227], a[136:139], v[140:143]
 v_mfma_f32_16x16x32_bf16 v[140:143], a[228:231], a[140:143], v[140:143]
 s_add_u32 s30, s30, s21
 v_mfma_f32_16x16x32_bf16 v[136:139], a[228:231], a[132:135], v[136:139]
 v_mfma_f32_16x16x32_bf16 v[136:139], a[224:227], a[128:131], v[136:139]
 s_waitcnt vmcnt(8)
 v_mfma_f32_16x16x32_bf16 v[168:171], a[192:195], a[128:131], v[168:171]
 v_mfma_f32_16x16x32_bf16 v[168:171], a[196:199], a[132:135], v[168:171]
 global_load_dwordx4 a[228:231], v0, s[70:71] offset:-1024 sc1
 v_mfma_f32_16x16x32_bf16 v[172:175], a[196:199], a[140:143], v[172:175]
 v_mfma_f32_16x16x32_bf16 v[172:175], a[192:195], a[136:139], v[172:175]
 global_load_dwordx4 a[224:227], v0, s[70:71] offset:-2048 sc1
 v_mfma_f32_16x16x32_bf16 v[176:179], a[192:195], a[144:147], v[176:179]
 v_mfma_f32_16x16x32_bf16 v[176:179], a[196:199], a[148:151], v[176:179]
 v_mfma_f32_16x16x32_bf16 v[180:183], a[196:199], a[156:159], v[180:183]
 v_mfma_f32_16x16x32_bf16 v[180:183], a[192:195], a[152:155], v[180:183]
 v_mfma_f32_16x16x32_bf16 v[184:187], a[192:195], a[160:163], v[184:187]
 v_mfma_f32_16x16x32_bf16 v[184:187], a[196:199], a[164:167], v[184:187]
 v_mfma_f32_16x16x32_bf16 v[188:191], a[196:199], a[172:175], v[188:191]
 v_mfma_f32_16x16x32_bf16 v[188:191], a[192:195], a[168:171], v[188:191]
 v_mfma_f32_16x16x32_bf16 v[192:195], a[192:195], a[176:179], v[192:195]
 v_mfma_f32_16x16x32_bf16 v[192:195], a[196:199], a[180:183], v[192:195]
 v_mfma_f32_16x16x32_bf16 v[196:199], a[196:199], a[188:191], v[196:199]
 v_mfma_f32_16x16x32_bf16 v[196:199], a[192:195], a[184:187], v[196:199]
 s_waitcnt vmcnt(8)
 v_mfma_f32_16x16x32_bf16 v[228:231], a[200:203], a[184:187], v[228:231]
 v_mfma_f32_16x16x32_bf16 v[228:231], a[204:207], a[188:191], v[228:231]
 global_load_dwordx4 a[196:199], v0, s[70:71] offset:1024 sc1
 v_mfma_f32_16x16x32_bf16 v[224:227], a[204:207], a[180:183], v[224:227]
 v_mfma_f32_16x16x32_bf16 v[224:227], a[200:203], a[176:179], v[224:227]
 global_load_dwordx4 a[192:195], v0, s[70:71] offset:0 sc1
 v_mfma_f32_16x16x32_bf16 v[220:223], a[200:203], a[168:171], v[220:223]
 v_mfma_f32_16x16x32_bf16 v[220:223], a[204:207], a[172:175], v[220:223]
 v_mfma_f32_16x16x32_bf16 v[216:219], a[204:207], a[164:167], v[216:219]
 v_mfma_f32_16x16x32_bf16 v[216:219], a[200:203], a[160:163], v[216:219]
 v_mfma_f32_16x16x32_bf16 v[212:215], a[200:203], a[152:155], v[212:215]
 v_mfma_f32_16x16x32_bf16 v[212:215], a[204:207], a[156:159], v[212:215]
 v_mfma_f32_16x16x32_bf16 v[208:211], a[204:207], a[148:151], v[208:211]
 v_mfma_f32_16x16x32_bf16 v[208:211], a[200:203], a[144:147], v[208:211]
 v_mfma_f32_16x16x32_bf16 v[204:207], a[200:203], a[136:139], v[204:207]
 v_mfma_f32_16x16x32_bf16 v[204:207], a[204:207], a[140:143], v[204:207]
 v_mfma_f32_16x16x32_bf16 v[200:203], a[204:207], a[132:135], v[200:203]
 v_mfma_f32_16x16x32_bf16 v[200:203], a[200:203], a[128:131], v[200:203]
 buffer_load_dwordx4 v6, s[8:11], s30 offen lds
 s_waitcnt vmcnt(9)
 v_mfma_f32_16x16x32_bf16 v[232:235], a[208:211], a[128:131], v[232:235]
 ds_read_b128 a[128:131], v2
 v_mfma_f32_16x16x32_bf16 v[232:235], a[212:215], a[132:135], v[232:235]
 global_load_dwordx4 a[204:207], v0, s[70:71] offset:3072 sc1
 ds_read_b128 a[132:135], v2 offset:1024
 v_mfma_f32_16x16x32_bf16 v[236:239], a[212:215], a[140:143], v[236:239]
 ds_read_b128 a[140:143], v2 offset:5120
 v_mfma_f32_16x16x32_bf16 v[236:239], a[208:211], a[136:139], v[236:239]
 global_load_dwordx4 a[200:203], v0, s[70:71] offset:2048 sc1
 ds_read_b128 a[136:139], v2 offset:4096
 v_mfma_f32_16x16x32_bf16 v[240:243], a[208:211], a[144:147], v[240:243]
 s_add_u32 s70, s70, 8192
 s_addc_u32 s71, s71, 0
 ds_read_b128 a[144:147], v2 offset:8192
 v_mfma_f32_16x16x32_bf16 v[240:243], a[212:215], a[148:151], v[240:243]
 ds_read_b128 a[148:151], v2 offset:9216
 v_mfma_f32_16x16x32_bf16 v[244:247], a[212:215], a[156:159], v[244:247]
 ds_read_b128 a[156:159], v2 offset:13312
 v_mfma_f32_16x16x32_bf16 v[244:247], a[208:211], a[152:155], v[244:247]
 ds_read_b128 a[152:155], v2 offset:12288
 v_mfma_f32_16x16x32_bf16 v[248:251], a[208:211], a[160:163], v[248:251]
 ds_read_b128 a[160:163], v2 offset:16384
 v_mfma_f32_16x16x32_bf16 v[248:251], a[212:215], a[164:167], v[248:251]
 ds_read_b128 a[164:167], v2 offset:17408
 s_add_u32 m0, m0, 1024
 v_mfma_f32_16x16x32_bf16 v[252:255], a[212:215], a[172:175], v[252:255]
 ds_read_b128 a[172:175], v2 offset:21504
 v_mfma_f32_16x16x32_bf16 v[252:255], a[208:211], a[168:171], v[252:255]
 ds_read_b128 a[168:171], v2 offset:20480
 v_mfma_f32_16x16x32_bf16 a[248:251], a[208:211], a[176:179], a[248:251]
 ds_read_b128 a[176:179], v2 offset:24576
 s_add_u32 s30, s30, s20
 v_mfma_f32_16x16x32_bf16 a[248:251], a[212:215], a[180:183], a[248:251]
 ds_read_b128 a[180:183], v2 offset:25600
 v_mfma_f32_16x16x32_bf16 a[252:255], a[212:215], a[188:191], a[252:255]
 ds_read_b128 a[188:191], v2 offset:29696
 v_mfma_f32_16x16x32_bf16 a[252:255], a[208:211], a[184:187], a[252:255]
 ds_read_b128 a[184:187], v2 offset:28672
 s_waitcnt vmcnt(8) lgkmcnt(8)
 v_mfma_f32_16x16x32_bf16 v[16:19], a[216:219], a[128:131], v[16:19]
 buffer_load_dwordx4 v6, s[8:11], s30 offen lds
 v_mfma_f32_16x16x32_bf16 v[16:19], a[220:223], a[132:135], v[16:19]
 global_load_dwordx4 a[212:215], v0, s[70:71] offset:-3072 sc1
 v_mfma_f32_16x16x32_bf16 v[20:23], a[220:223], a[140:143], v[20:23]
 v_mfma_f32_16x16x32_bf16 v[20:23], a[216:219], a[136:139], v[20:23]
 global_load_dwordx4 a[208:211], v0, s[70:71] offset:-4096 sc1
 s_add_u32 m0, m0, 3072
 v_mfma_f32_16x16x32_bf16 v[24:27], a[216:219], a[144:147], v[24:27]
 v_mfma_f32_16x16x32_bf16 v[24:27], a[220:223], a[148:151], v[24:27]
 v_mfma_f32_16x16x32_bf16 v[28:31], a[220:223], a[156:159], v[28:31]
 v_mfma_f32_16x16x32_bf16 v[28:31], a[216:219], a[152:155], v[28:31]
 s_add_u32 s30, s30, s21
 s_waitcnt lgkmcnt(0)
 v_mfma_f32_16x16x32_bf16 v[32:35], a[216:219], a[160:163], v[32:35]
 v_mfma_f32_16x16x32_bf16 v[32:35], a[220:223], a[164:167], v[32:35]
 v_mfma_f32_16x16x32_bf16 v[36:39], a[220:223], a[172:175], v[36:39]
 v_mfma_f32_16x16x32_bf16 v[36:39], a[216:219], a[168:171], v[36:39]
 v_mfma_f32_16x16x32_bf16 v[40:43], a[216:219], a[176:179], v[40:43]
 v_mfma_f32_16x16x32_bf16 v[40:43], a[220:223], a[180:183], v[40:43]
 v_mfma_f32_16x16x32_bf16 v[44:47], a[220:223], a[188:191], v[44:47]
 v_mfma_f32_16x16x32_bf16 v[44:47], a[216:219], a[184:187], v[44:47]
 s_waitcnt vmcnt(8)
 v_mfma_f32_16x16x32_bf16 v[76:79], a[224:227], a[184:187], v[76:79]
 v_mfma_f32_16x16x32_bf16 v[76:79], a[228:231], a[188:191], v[76:79]
 global_load_dwordx4 a[220:223], v0, s[70:71] offset:-1024 sc1
 v_mfma_f32_16x16x32_bf16 v[72:75], a[228:231], a[180:183], v[72:75]
 v_mfma_f32_16x16x32_bf16 v[72:75], a[224:227], a[176:179], v[72:75]
 global_load_dwordx4 a[216:219], v0, s[70:71] offset:-2048 sc1
 v_mfma_f32_16x16x32_bf16 v[68:71], a[224:227], a[168:171], v[68:71]
 v_mfma_f32_16x16x32_bf16 v[68:71], a[228:231], a[172:175], v[68:71]
 v_mfma_f32_16x16x32_bf16 v[64:67], a[228:231], a[164:167], v[64:67]
 v_mfma_f32_16x16x32_bf16 v[64:67], a[224:227], a[160:163], v[64:67]
 v_mfma_f32_16x16x32_bf16 v[60:63], a[224:227], a[152:155], v[60:63]
 v_mfma_f32_16x16x32_bf16 v[60:63], a[228:231], a[156:159], v[60:63]
 v_mfma_f32_16x16x32_bf16 v[56:59], a[228:231], a[148:151], v[56:59]
 v_mfma_f32_16x16x32_bf16 v[56:59], a[224:227], a[144:147], v[56:59]
 v_mfma_f32_16x16x32_bf16 v[52:55], a[224:227], a[136:139], v[52:55]
 v_mfma_f32_16x16x32_bf16 v[52:55], a[228:231], a[140:143], v[52:55]
 v_mfma_f32_16x16x32_bf16 v[48:51], a[228:231], a[132:135], v[48:51]
 v_mfma_f32_16x16x32_bf16 v[48:51], a[224:227], a[128:131], v[48:51]
 s_waitcnt vmcnt(8)
 v_mfma_f32_16x16x32_bf16 v[80:83], a[192:195], a[128:131], v[80:83]
 v_mfma_f32_16x16x32_bf16 v[80:83], a[196:199], a[132:135], v[80:83]
 global_load_dwordx4 a[228:231], v0, s[70:71] offset:1024 sc1
 v_mfma_f32_16x16x32_bf16 v[84:87], a[196:199], a[140:143], v[84:87]
 v_mfma_f32_16x16x32_bf16 v[84:87], a[192:195], a[136:139], v[84:87]
 global_load_dwordx4 a[224:227], v0, s[70:71] offset:0 sc1
 v_mfma_f32_16x16x32_bf16 v[88:91], a[192:195], a[144:147], v[88:91]
 v_mfma_f32_16x16x32_bf16 v[88:91], a[196:199], a[148:151], v[88:91]
 v_mfma_f32_16x16x32_bf16 v[92:95], a[196:199], a[156:159], v[92:95]
 v_mfma_f32_16x16x32_bf16 v[92:95], a[192:195], a[152:155], v[92:95]
 v_mfma_f32_16x16x32_bf16 v[96:99], a[192:195], a[160:163], v[96:99]
 v_mfma_f32_16x16x32_bf16 v[96:99], a[196:199], a[164:167], v[96:99]
 v_mfma_f32_16x16x32_bf16 v[100:103], a[196:199], a[172:175], v[100:103]
 v_mfma_f32_16x16x32_bf16 v[100:103], a[192:195], a[168:171], v[100:103]
 v_mfma_f32_16x16x32_bf16 v[104:107], a[192:195], a[176:179], v[104:107]
 v_mfma_f32_16x16x32_bf16 v[104:107], a[196:199], a[180:183], v[104:107]
 v_mfma_f32_16x16x32_bf16 v[108:111], a[196:199], a[188:191], v[108:111]
 v_mfma_f32_16x16x32_bf16 v[108:111], a[192:195], a[184:187], v[108:111]
 buffer_load_dwordx4 v6, s[8:11], s30 offen lds
 s_waitcnt vmcnt(8)
 v_mfma_f32_16x16x32_bf16 a[244:247], a[200:203], a[184:187], a[244:247]
 v_mfma_f32_16x16x32_bf16 a[244:247], a[204:207], a[188:191], a[244:247]
 global_load_dwordx4 a[196:199], v0, s[70:71] offset:3072 sc1
 v_mfma_f32_16x16x32_bf16 a[240:243], a[204:207], a[180:183], a[240:243]
 v_mfma_f32_16x16x32_bf16 a[240:243], a[200:203], a[176:179], a[240:243]
 global_load_dwordx4 a[192:195], v0, s[70:71] offset:2048 sc1
 s_add_u32 m0, m0, 1024
 v_mfma_f32_16x16x32_bf16 v[132:135], a[200:203], a[168:171], v[132:135]
 s_add_u32 s70, s70, 8192
 s_addc_u32 s71, s71, 0
 v_mfma_f32_16x16x32_bf16 v[132:135], a[204:207], a[172:175], v[132:135]
 v_mfma_f32_16x16x32_bf16 v[128:131], a[204:207], a[164:167], v[128:131]
 s_add_u32 s30, s30, s20
 v_mfma_f32_16x16x32_bf16 v[128:131], a[200:203], a[160:163], v[128:131]
 v_mfma_f32_16x16x32_bf16 v[124:127], a[200:203], a[152:155], v[124:127]
 v_mfma_f32_16x16x32_bf16 v[124:127], a[204:207], a[156:159], v[124:127]
 v_mfma_f32_16x16x32_bf16 v[120:123], a[204:207], a[148:151], v[120:123]
 buffer_load_dwordx4 v6, s[8:11], s30 offen lds
 v_mfma_f32_16x16x32_bf16 v[120:123], a[200:203], a[144:147], v[120:123]
 v_mfma_f32_16x16x32_bf16 v[116:119], a[200:203], a[136:139], v[116:119]
 v_mfma_f32_16x16x32_bf16 v[116:119], a[204:207], a[140:143], v[116:119]
 v_mfma_f32_16x16x32_bf16 v[112:115], a[204:207], a[132:135], v[112:115]
 s_add_u32 m0, m0, 3072
 v_mfma_f32_16x16x32_bf16 v[112:115], a[200:203], a[128:131], v[112:115]
 s_waitcnt vmcnt(8)
 v_mfma_f32_16x16x32_bf16 v[136:139], a[208:211], a[128:131], v[136:139]
 v_mfma_f32_16x16x32_bf16 v[136:139], a[212:215], a[132:135], v[136:139]
 global_load_dwordx4 a[204:207], v0, s[70:71] offset:-3072 sc1
 s_add_u32 s30, s30, s21
 v_mfma_f32_16x16x32_bf16 v[140:143], a[212:215], a[140:143], v[140:143]
 v_mfma_f32_16x16x32_bf16 v[140:143], a[208:211], a[136:139], v[140:143]
 global_load_dwordx4 a[200:203], v0, s[70:71] offset:-4096 sc1
 v_mfma_f32_16x16x32_bf16 v[144:147], a[208:211], a[144:147], v[144:147]
 v_mfma_f32_16x16x32_bf16 v[144:147], a[212:215], a[148:151], v[144:147]
 v_mfma_f32_16x16x32_bf16 v[148:151], a[212:215], a[156:159], v[148:151]
 v_mfma_f32_16x16x32_bf16 v[148:151], a[208:211], a[152:155], v[148:151]
 v_mfma_f32_16x16x32_bf16 v[152:155], a[208:211], a[160:163], v[152:155]
 v_mfma_f32_16x16x32_bf16 v[152:155], a[212:215], a[164:167], v[152:155]
 v_mfma_f32_16x16x32_bf16 v[156:159], a[212:215], a[172:175], v[156:159]
 v_and_b32 v5, 768, v3
 v_mfma_f32_16x16x32_bf16 v[156:159], a[208:211], a[168:171], v[156:159]
 v_and_b32 v7, 1023, v3
 v_mfma_f32_16x16x32_bf16 v[160:163], a[208:211], a[176:179], v[160:163]
 v_mfma_f32_16x16x32_bf16 v[160:163], a[212:215], a[180:183], v[160:163]
 v_add3_u32 v5, v5, v7, s52
 v_mfma_f32_16x16x32_bf16 v[164:167], a[212:215], a[188:191], v[164:167]
 v_mfma_f32_16x16x32_bf16 v[164:167], a[208:211], a[184:187], v[164:167]
 ds_read_b64_tr_b16 v[8:9], v5 offset:0
 s_waitcnt vmcnt(8)
 v_mfma_f32_16x16x32_bf16 v[196:199], a[216:219], a[184:187], v[196:199]
 v_mfma_f32_16x16x32_bf16 v[196:199], a[220:223], a[188:191], v[196:199]
 global_load_dwordx4 a[212:215], v0, s[70:71] offset:-1024 sc1
 ds_read_b64_tr_b16 v[10:11], v5 offset:256
 v_mfma_f32_16x16x32_bf16 v[192:195], a[220:223], a[180:183], v[192:195]
 ds_read_b64_tr_b16 v[12:13], v5 offset:8
 v_mfma_f32_16x16x32_bf16 v[192:195], a[216:219], a[176:179], v[192:195]
 global_load_dwordx4 a[208:211], v0, s[70:71] offset:-2048 sc1
 ds_read_b64_tr_b16 v[14:15], v5 offset:264
 v_mfma_f32_16x16x32_bf16 v[188:191], a[216:219], a[168:171], v[188:191]
 v_mfma_f32_16x16x32_bf16 v[188:191], a[220:223], a[172:175], v[188:191]
 v_mfma_f32_16x16x32_bf16 v[184:187], a[220:223], a[164:167], v[184:187]
 v_mfma_f32_16x16x32_bf16 v[184:187], a[216:219], a[160:163], v[184:187]
 v_mfma_f32_16x16x32_bf16 v[180:183], a[216:219], a[152:155], v[180:183]
 v_mfma_f32_16x16x32_bf16 v[180:183], a[220:223], a[156:159], v[180:183]
 v_mfma_f32_16x16x32_bf16 v[176:179], a[220:223], a[148:151], v[176:179]
 v_mfma_f32_16x16x32_bf16 v[176:179], a[216:219], a[144:147], v[176:179]
 v_mfma_f32_16x16x32_bf16 v[172:175], a[216:219], a[136:139], v[172:175]
 v_mfma_f32_16x16x32_bf16 v[172:175], a[220:223], a[140:143], v[172:175]
 v_mfma_f32_16x16x32_bf16 v[168:171], a[220:223], a[132:135], v[168:171]
 v_mfma_f32_16x16x32_bf16 v[168:171], a[216:219], a[128:131], v[168:171]
 s_waitcnt vmcnt(8)
 v_mfma_f32_16x16x32_bf16 v[200:203], a[224:227], a[128:131], v[200:203]
 v_mfma_f32_16x16x32_bf16 v[200:203], a[228:231], a[132:135], v[200:203]
 global_load_dwordx4 a[220:223], v0, s[70:71] offset:1024 sc1
 v_mfma_f32_16x16x32_bf16 v[204:207], a[228:231], a[140:143], v[204:207]
 s_waitcnt lgkmcnt(2)
 v_mfma_f32_16x16x32_bf16 v[204:207], a[224:227], a[136:139], v[204:207]
 global_load_dwordx4 a[216:219], v0, s[70:71] offset:0 sc1
 v_mfma_f32_16x16x32_bf16 v[208:211], a[224:227], a[144:147], v[208:211]
 buffer_store_dwordx4 v[8:11], v7, s[12:15], s49 offen sc1
 v_mfma_f32_16x16x32_bf16 v[208:211], a[228:231], a[148:151], v[208:211]
 s_waitcnt lgkmcnt(0)
 v_mfma_f32_16x16x32_bf16 v[212:215], a[228:231], a[156:159], v[212:215]
 buffer_store_dwordx4 v[12:15], v7, s[12:15], s49 offen offset:2048 sc1
 v_mfma_f32_16x16x32_bf16 v[212:215], a[224:227], a[152:155], v[212:215]
 s_add_u32 s49, s49, 2097152
 v_mfma_f32_16x16x32_bf16 v[216:219], a[224:227], a[160:163], v[216:219]
 v_mfma_f32_16x16x32_bf16 v[216:219], a[228:231], a[164:167], v[216:219]
 buffer_load_dwordx4 v6, s[8:11], s30 offen lds
 v_mfma_f32_16x16x32_bf16 v[220:223], a[228:231], a[172:175], v[220:223]
 v_mfma_f32_16x16x32_bf16 v[220:223], a[224:227], a[168:171], v[220:223]
 v_mfma_f32_16x16x32_bf16 v[224:227], a[224:227], a[176:179], v[224:227]
 v_mfma_f32_16x16x32_bf16 v[224:227], a[228:231], a[180:183], v[224:227]
 s_add_u32 m0, m0, 1024
 v_mfma_f32_16x16x32_bf16 v[228:231], a[228:231], a[188:191], v[228:231]
 v_mfma_f32_16x16x32_bf16 v[228:231], a[224:227], a[184:187], v[228:231]
 s_add_u32 s30, s30, s20
 buffer_load_dwordx4 v6, s[8:11], s30 offen lds
 s_waitcnt vmcnt(11)
 v_mfma_f32_16x16x32_bf16 a[252:255], a[192:195], a[184:187], a[252:255]
 ds_read_b128 a[184:187], v2 offset:61440
 v_mfma_f32_16x16x32_bf16 a[252:255], a[196:199], a[188:191], a[252:255]
 global_load_dwordx4 a[228:231], v0, s[70:71] offset:3072 sc1
 ds_read_b128 a[188:191], v2 offset:62464
 v_mfma_f32_16x16x32_bf16 a[248:251], a[196:199], a[180:183], a[248:251]
 ds_read_b128 a[180:183], v2 offset:58368
 v_mfma_f32_16x16x32_bf16 a[248:251], a[192:195], a[176:179], a[248:251]
 global_load_dwordx4 a[224:227], v0, s[70:71] offset:2048 sc1
 ds_read_b128 a[176:179], v2 offset:57344
 v_mfma_f32_16x16x32_bf16 v[252:255], a[192:195], a[168:171], v[252:255]
 s_add_u32 s70, s70, 8192
 s_addc_u32 s71, s71, 0
 ds_read_b128 a[168:171], v2 offset:53248
 v_mfma_f32_16x16x32_bf16 v[252:255], a[196:199], a[172:175], v[252:255]
 ds_read_b128 a[172:175], v2 offset:54272
 v_mfma_f32_16x16x32_bf16 v[248:251], a[196:199], a[164:167], v[248:251]
 ds_read_b128 a[164:167], v2 offset:50176
 v_mfma_f32_16x16x32_bf16 v[248:251], a[192:195], a[160:163], v[248:251]
 ds_read_b128 a[160:163], v2 offset:49152
 v_mfma_f32_16x16x32_bf16 v[244:247], a[192:195], a[152:155], v[244:247]
 ds_read_b128 a[152:155], v2 offset:45056
 s_add_u32 m0, m0, 3072
 v_mfma_f32_16x16x32_bf16 v[244:247], a[196:199], a[156:159], v[244:247]
 ds_read_b128 a[156:159], v2 offset:46080
 v_mfma_f32_16x16x32_bf16 v[240:243], a[196:199], a[148:151], v[240:243]
 ds_read_b128 a[148:151], v2 offset:41984
 v_mfma_f32_16x16x32_bf16 v[240:243], a[192:195], a[144:147], v[240:243]
 ds_read_b128 a[144:147], v2 offset:40960
 s_add_u32 s30, s30, s21
 v_mfma_f32_16x16x32_bf16 v[236:239], a[192:195], a[136:139], v[236:239]
 ds_read_b128 a[136:139], v2 offset:36864
 v_mfma_f32_16x16x32_bf16 v[236:239], a[196:199], a[140:143], v[236:239]
 ds_read_b128 a[140:143], v2 offset:37888
 v_mfma_f32_16x16x32_bf16 v[232:235], a[196:199], a[132:135], v[232:235]
 ds_read_b128 a[132:135], v2 offset:33792
 v_mfma_f32_16x16x32_bf16 v[232:235], a[192:195], a[128:131], v[232:235]
 ds_read_b128 a[128:131], v2 offset:32768
 s_waitcnt vmcnt(10) lgkmcnt(8)
 v_mfma_f32_16x16x32_bf16 v[44:47], a[200:203], a[184:187], v[44:47]
 v_mfma_f32_16x16x32_bf16 v[44:47], a[204:207], a[188:191], v[44:47]
 global_load_dwordx4 a[196:199], v0, s[70:71] offset:-3072 sc1
 v_mfma_f32_16x16x32_bf16 v[40:43], a[204:207], a[180:183], v[40:43]
 v_mfma_f32_16x16x32_bf16 v[40:43], a[200:203], a[176:179], v[40:43]
 global_load_dwordx4 a[192:195], v0, s[70:71] offset:-4096 sc1
 v_mfma_f32_16x16x32_bf16 v[36:39], a[200:203], a[168:171], v[36:39]
 v_mfma_f32_16x16x32_bf16 v[36:39], a[204:207], a[172:175], v[36:39]
 v_mfma_f32_16x16x32_bf16 v[32:35], a[204:207], a[164:167], v[32:35]
 v_mfma_f32_16x16x32_bf16 v[32:35], a[200:203], a[160:163], v[32:35]
 s_waitcnt lgkmcnt(0)
 v_mfma_f32_16x16x32_bf16 v[28:31], a[200:203], a[152:155], v[28:31]
 v_mfma_f32_16x16x32_bf16 v[28:31], a[204:207], a[156:159], v[28:31]
 v_mfma_f32_16x16x32_bf16 v[24:27], a[204:207], a[148:151], v[24:27]
 v_mfma_f32_16x16x32_bf16 v[24:27], a[200:203], a[144:147], v[24:27]
 v_mfma_f32_16x16x32_bf16 v[20:23], a[200:203], a[136:139], v[20:23]
 v_mfma_f32_16x16x32_bf16 v[20:23], a[204:207], a[140:143], v[20:23]
 v_mfma_f32_16x16x32_bf16 v[16:19], a[204:207], a[132:135], v[16:19]
 v_mfma_f32_16x16x32_bf16 v[16:19], a[200:203], a[128:131], v[16:19]
 s_waitcnt vmcnt(10)
 v_mfma_f32_16x16x32_bf16 v[48:51], a[208:211], a[128:131], v[48:51]
 v_mfma_f32_16x16x32_bf16 v[48:51], a[212:215], a[132:135], v[48:51]
 global_load_dwordx4 a[204:207], v0, s[70:71] offset:-1024 sc1
 v_mfma_f32_16x16x32_bf16 v[52:55], a[212:215], a[140:143], v[52:55]
 v_mfma_f32_16x16x32_bf16 v[52:55], a[208:211], a[136:139], v[52:55]
 global_load_dwordx4 a[200:203], v0, s[70:71] offset:-2048 sc1
 v_mfma_f32_16x16x32_bf16 v[56:59], a[208:211], a[144:147], v[56:59]
 v_mfma_f32_16x16x32_bf16 v[56:59], a[212:215], a[148:151], v[56:59]
 v_mfma_f32_16x16x32_bf16 v[60:63], a[212:215], a[156:159], v[60:63]
 v_mfma_f32_16x16x32_bf16 v[60:63], a[208:211], a[152:155], v[60:63]
 v_mfma_f32_16x16x32_bf16 v[64:67], a[208:211], a[160:163], v[64:67]
 v_mfma_f32_16x16x32_bf16 v[64:67], a[212:215], a[164:167], v[64:67]
 v_mfma_f32_16x16x32_bf16 v[68:71], a[212:215], a[172:175], v[68:71]
 v_mfma_f32_16x16x32_bf16 v[68:71], a[208:211], a[168:171], v[68:71]
 v_mfma_f32_16x16x32_bf16 v[72:75], a[208:211], a[176:179], v[72:75]
 v_mfma_f32_16x16x32_bf16 v[72:75], a[212:215], a[180:183], v[72:75]
 v_mfma_f32_16x16x32_bf16 v[76:79], a[212:215], a[188:191], v[76:79]
 v_mfma_f32_16x16x32_bf16 v[76:79], a[208:211], a[184:187], v[76:79]
 s_waitcnt vmcnt(10)
 v_mfma_f32_16x16x32_bf16 v[108:111], a[216:219], a[184:187], v[108:111]
 v_mfma_f32_16x16x32_bf16 v[108:111], a[220:223], a[188:191], v[108:111]
 global_load_dwordx4 a[212:215], v0, s[70:71] offset:1024 sc1
 v_mfma_f32_16x16x32_bf16 v[104:107], a[220:223], a[180:183], v[104:107]
 v_mfma_f32_16x16x32_bf16 v[104:107], a[216:219], a[176:179], v[104:107]
 global_load_dwordx4 a[208:211], v0, s[70:71] offset:0 sc1
 v_mfma_f32_16x16x32_bf16 v[100:103], a[216:219], a[168:171], v[100:103]
 buffer_load_dwordx4 v6, s[8:11], s30 offen lds
 v_mfma_f32_16x16x32_bf16 v[100:103], a[220:223], a[172:175], v[100:103]
 v_mfma_f32_16x16x32_bf16 v[96:99], a[220:223], a[164:167], v[96:99]
 v_mfma_f32_16x16x32_bf16 v[96:99], a[216:219], a[160:163], v[96:99]
 s_add_u32 m0, m0, 1024
 v_mfma_f32_16x16x32_bf16 v[92:95], a[216:219], a[152:155], v[92:95]
 v_mfma_f32_16x16x32_bf16 v[92:95], a[220:223], a[156:159], v[92:95]
 v_mfma_f32_16x16x32_bf16 v[88:91], a[220:223], a[148:151], v[88:91]
 v_mfma_f32_16x16x32_bf16 v[88:91], a[216:219], a[144:147], v[88:91]
 s_add_u32 s30, s30, s20
 v_mfma_f32_16x16x32_bf16 v[84:87], a[216:219], a[136:139], v[84:87]
 v_mfma_f32_16x16x32_bf16 v[84:87], a[220:223], a[140:143], v[84:87]
 v_mfma_f32_16x16x32_bf16 v[80:83], a[220:223], a[132:135], v[80:83]
 buffer_load_dwordx4 v6, s[8:11], s30 offen lds
 v_mfma_f32_16x16x32_bf16 v[80:83], a[216:219], a[128:131], v[80:83]
 s_waitcnt vmcnt(8)
 v_mfma_f32_16x16x32_bf16 v[112:115], a[224:227], a[128:131], v[112:115]
 v_mfma_f32_16x16x32_bf16 v[112:115], a[228:231], a[132:135], v[112:115]
 global_load_dwordx4 a[220:223], v0, s[70:71] offset:3072 sc1
 v_mfma_f32_16x16x32_bf16 v[116:119], a[228:231], a[140:143], v[116:119]
 s_add_u32 m0, m0, 3072
 v_mfma_f32_16x16x32_bf16 v[116:119], a[224:227], a[136:139], v[116:119]
 global_load_dwordx4 a[216:219], v0, s[70:71] offset:2048 sc1
 v_mfma_f32_16x16x32_bf16 v[120:123], a[224:227], a[144:147], v[120:123]
 s_add_u32 s70, s70, 8192
 s_addc_u32 s71, s71, 0
 v_mfma_f32_16x16x32_bf16 v[120:123], a[228:231], a[148:151], v[120:123]
 v_mfma_f32_16x16x32_bf16 v[124:127], a[228:231], a[156:159], v[124:127]
 s_add_u32 s30, s30, s22
 v_mfma_f32_16x16x32_bf16 v[124:127], a[224:227], a[152:155], v[124:127]
 v_mfma_f32_16x16x32_bf16 v[128:131], a[224:227], a[160:163], v[128:131]
 v_mfma_f32_16x16x32_bf16 v[128:131], a[228:231], a[164:167], v[128:131]
 v_mfma_f32_16x16x32_bf16 v[132:135], a[228:231], a[172:175], v[132:135]
 v_mfma_f32_16x16x32_bf16 v[132:135], a[224:227], a[168:171], v[132:135]
 v_mfma_f32_16x16x32_bf16 a[240:243], a[224:227], a[176:179], a[240:243]
 v_mfma_f32_16x16x32_bf16 a[240:243], a[228:231], a[180:183], a[240:243]
 v_mfma_f32_16x16x32_bf16 a[244:247], a[228:231], a[188:191], a[244:247]
 v_mfma_f32_16x16x32_bf16 a[244:247], a[224:227], a[184:187], a[244:247]
 s_waitcnt vmcnt(8)
 v_mfma_f32_16x16x32_bf16 v[164:167], a[192:195], a[184:187], v[164:167]
 v_mfma_f32_16x16x32_bf16 v[164:167], a[196:199], a[188:191], v[164:167]
 global_load_dwordx4 a[228:231], v0, s[70:71] offset:-3072 sc1
 v_mfma_f32_16x16x32_bf16 v[160:163], a[196:199], a[180:183], v[160:163]
 v_mfma_f32_16x16x32_bf16 v[160:163], a[192:195], a[176:179], v[160:163]
 global_load_dwordx4 a[224:227], v0, s[70:71] offset:-4096 sc1
 v_mfma_f32_16x16x32_bf16 v[156:159], a[192:195], a[168:171], v[156:159]
 v_mfma_f32_16x16x32_bf16 v[156:159], a[196:199], a[172:175], v[156:159]
 global_load_dwordx4 a[236:239], v0, s[70:71] offset:-1024 sc1
 v_mfma_f32_16x16x32_bf16 v[152:155], a[196:199], a[164:167], v[152:155]
 v_mfma_f32_16x16x32_bf16 v[152:155], a[192:195], a[160:163], v[152:155]
 global_load_dwordx4 a[232:235], v0, s[70:71] offset:-2048 sc1
 v_mfma_f32_16x16x32_bf16 v[148:151], a[192:195], a[152:155], v[148:151]
 v_mfma_f32_16x16x32_bf16 v[148:151], a[196:199], a[156:159], v[148:151]
 v_mfma_f32_16x16x32_bf16 v[144:147], a[196:199], a[148:151], v[144:147]
 v_mfma_f32_16x16x32_bf16 v[144:147], a[192:195], a[144:147], v[144:147]
 v_mfma_f32_16x16x32_bf16 v[140:143], a[192:195], a[136:139], v[140:143]
 v_mfma_f32_16x16x32_bf16 v[140:143], a[196:199], a[140:143], v[140:143]
 v_mfma_f32_16x16x32_bf16 v[136:139], a[196:199], a[132:135], v[136:139]
 v_mfma_f32_16x16x32_bf16 v[136:139], a[192:195], a[128:131], v[136:139]
 s_waitcnt vmcnt(10)
 v_mfma_f32_16x16x32_bf16 v[168:171], a[200:203], a[128:131], v[168:171]
 v_mfma_f32_16x16x32_bf16 v[168:171], a[204:207], a[132:135], v[168:171]
 global_load_dwordx4 a[196:199], v0, s[70:71] offset:1024 sc1
 v_mfma_f32_16x16x32_bf16 v[172:175], a[204:207], a[140:143], v[172:175]
 v_mfma_f32_16x16x32_bf16 v[172:175], a[200:203], a[136:139], v[172:175]
 global_load_dwordx4 a[192:195], v0, s[70:71] offset:0 sc1
 v_mfma_f32_16x16x32_bf16 v[176:179], a[200:203], a[144:147], v[176:179]
 v_mfma_f32_16x16x32_bf16 v[176:179], a[204:207], a[148:151], v[176:179]
 v_mfma_f32_16x16x32_bf16 v[180:183], a[204:207], a[156:159], v[180:183]
 v_mfma_f32_16x16x32_bf16 v[180:183], a[200:203], a[152:155], v[180:183]
 v_mfma_f32_16x16x32_bf16 v[184:187], a[200:203], a[160:163], v[184:187]
 v_mfma_f32_16x16x32_bf16 v[184:187], a[204:207], a[164:167], v[184:187]
 v_mfma_f32_16x16x32_bf16 v[188:191], a[204:207], a[172:175], v[188:191]
 v_mfma_f32_16x16x32_bf16 v[188:191], a[200:203], a[168:171], v[188:191]
 v_mfma_f32_16x16x32_bf16 v[192:195], a[200:203], a[176:179], v[192:195]
 v_mfma_f32_16x16x32_bf16 v[192:195], a[204:207], a[180:183], v[192:195]
 v_mfma_f32_16x16x32_bf16 v[196:199], a[204:207], a[188:191], v[196:199]
 v_mfma_f32_16x16x32_bf16 v[196:199], a[200:203], a[184:187], v[196:199]
 s_waitcnt vmcnt(10)
 v_mfma_f32_16x16x32_bf16 v[228:231], a[208:211], a[184:187], v[228:231]
 v_mfma_f32_16x16x32_bf16 v[228:231], a[212:215], a[188:191], v[228:231]
 global_load_dwordx4 a[204:207], v0, s[70:71] offset:3072 sc1
 v_mfma_f32_16x16x32_bf16 v[224:227], a[212:215], a[180:183], v[224:227]
 v_mfma_f32_16x16x32_bf16 v[224:227], a[208:211], a[176:179], v[224:227]
 global_load_dwordx4 a[200:203], v0, s[70:71] offset:2048 sc1
 v_mfma_f32_16x16x32_bf16 v[220:223], a[208:211], a[168:171], v[220:223]
 s_add_u32 s70, s70, 8192
 s_addc_u32 s71, s71, 0
 v_mfma_f32_16x16x32_bf16 v[220:223], a[212:215], a[172:175], v[220:223]
 v_mfma_f32_16x16x32_bf16 v[216:219], a[212:215], a[164:167], v[216:219]
 v_mfma_f32_16x16x32_bf16 v[216:219], a[208:211], a[160:163], v[216:219]
 v_mfma_f32_16x16x32_bf16 v[212:215], a[208:211], a[152:155], v[212:215]
 v_mfma_f32_16x16x32_bf16 v[212:215], a[212:215], a[156:159], v[212:215]
 v_mfma_f32_16x16x32_bf16 v[208:211], a[212:215], a[148:151], v[208:211]
 s_waitcnt vmcnt(10)
 s_waitcnt lgkmcnt(0)
 s_barrier
 v_mfma_f32_16x16x32_bf16 v[208:211], a[208:211], a[144:147], v[208:211]
 v_mfma_f32_16x16x32_bf16 v[204:207], a[208:211], a[136:139], v[204:207]
 v_mfma_f32_16x16x32_bf16 v[204:207], a[212:215], a[140:143], v[204:207]
 v_mfma_f32_16x16x32_bf16 v[200:203], a[212:215], a[132:135], v[200:203]
 v_mfma_f32_16x16x32_bf16 v[200:203], a[208:211], a[128:131], v[200:203]
 s_waitcnt vmcnt(8)
 v_mfma_f32_16x16x32_bf16 v[232:235], a[216:219], a[128:131], v[232:235]
 ds_read_b128 a[128:131], v1 offset:2048
 v_mfma_f32_16x16x32_bf16 v[232:235], a[220:223], a[132:135], v[232:235]
 global_load_dwordx4 a[212:215], v0, s[70:71] offset:-3072 sc1
 ds_read_b128 a[132:135], v1 offset:3072
 v_mfma_f32_16x16x32_bf16 v[236:239], a[220:223], a[140:143], v[236:239]
 ds_read_b128 a[140:143], v1 offset:7168
 v_mfma_f32_16x16x32_bf16 v[236:239], a[216:219], a[136:139], v[236:239]
 global_load_dwordx4 a[208:211], v0, s[70:71] offset:-4096 sc1
 ds_read_b128 a[136:139], v1 offset:6144
 v_mfma_f32_16x16x32_bf16 v[240:243], a[216:219], a[144:147], v[240:243]
 ds_read_b128 a[144:147], v1 offset:10240
 v_mfma_f32_16x16x32_bf16 v[240:243], a[220:223], a[148:151], v[240:243]
 ds_read_b128 a[148:151], v1 offset:11264
 v_mfma_f32_16x16x32_bf16 v[244:247], a[220:223], a[156:159], v[244:247]
 ds_read_b128 a[156:159], v1 offset:15360
 v_mfma_f32_16x16x32_bf16 v[244:247], a[216:219], a[152:155], v[244:247]
 ds_read_b128 a[152:155], v1 offset:14336
 v_mfma_f32_16x16x32_bf16 v[248:251], a[216:219], a[160:163], v[248:251]
 ds_read_b128 a[160:163], v1 offset:18432
 v_mfma_f32_16x16x32_bf16 v[248:251], a[220:223], a[164:167], v[248:251]
 ds_read_b128 a[164:167], v1 offset:19456
 v_mfma_f32_16x16x32_bf16 v[252:255], a[220:223], a[172:175], v[252:255]
 ds_read_b128 a[172:175], v1 offset:23552
 v_mfma_f32_16x16x32_bf16 v[252:255], a[216:219], a[168:171], v[252:255]
 ds_read_b128 a[168:171], v1 offset:22528
 v_mfma_f32_16x16x32_bf16 a[248:251], a[216:219], a[176:179], a[248:251]
 ds_read_b128 a[176:179], v1 offset:26624
 v_mfma_f32_16x16x32_bf16 a[248:251], a[220:223], a[180:183], a[248:251]
 ds_read_b128 a[180:183], v1 offset:27648
 v_mfma_f32_16x16x32_bf16 a[252:255], a[220:223], a[188:191], a[252:255]
 global_load_dwordx4 a[220:223], v0, s[70:71] offset:-1024 sc1
 ds_read_b128 a[188:191], v1 offset:31744
 v_mfma_f32_16x16x32_bf16 a[252:255], a[216:219], a[184:187], a[252:255]
 global_load_dwordx4 a[216:219], v0, s[70:71] offset:-2048 sc1
 ds_read_b128 a[184:187], v1 offset:30720
 s_waitcnt vmcnt(10) lgkmcnt(8)
 v_mfma_f32_16x16x32_bf16 v[16:19], a[224:227], a[128:131], v[16:19]
 v_mov_b32 v7, 1
 v_mfma_f32_16x16x32_bf16 v[16:19], a[228:231], a[132:135], v[16:19]
 v_mfma_f32_16x16x32_bf16 v[20:23], a[228:231], a[140:143], v[20:23]
 buffer_atomic_add v7, v0, s[56:59], 0 offen sc1
 v_mfma_f32_16x16x32_bf16 v[20:23], a[224:227], a[136:139], v[20:23]
 v_bfe_u32 v4, v3, 8, 2
 v_mfma_f32_16x16x32_bf16 v[24:27], a[224:227], a[144:147], v[24:27]
 v_mfma_f32_16x16x32_bf16 v[24:27], a[228:231], a[148:151], v[24:27]
 v_lshl_add_u32 v4, v4, 5, s51
 v_mfma_f32_16x16x32_bf16 v[28:31], a[228:231], a[156:159], v[28:31]
 ds_read_b128 v[8:11], v4 offset:256
 v_mfma_f32_16x16x32_bf16 v[28:31], a[224:227], a[152:155], v[28:31]
 s_waitcnt lgkmcnt(1)
 v_mfma_f32_16x16x32_bf16 v[32:35], a[224:227], a[160:163], v[32:35]
 v_mfma_f32_16x16x32_bf16 v[32:35], a[228:231], a[164:167], v[32:35]
 v_mfma_f32_16x16x32_bf16 v[36:39], a[228:231], a[172:175], v[36:39]
 v_mfma_f32_16x16x32_bf16 v[36:39], a[224:227], a[168:171], v[36:39]
 v_mfma_f32_16x16x32_bf16 v[40:43], a[224:227], a[176:179], v[40:43]
 v_mfma_f32_16x16x32_bf16 v[40:43], a[228:231], a[180:183], v[40:43]
 v_mfma_f32_16x16x32_bf16 v[44:47], a[228:231], a[188:191], v[44:47]
 v_mfma_f32_16x16x32_bf16 v[44:47], a[224:227], a[184:187], v[44:47]
 s_waitcnt vmcnt(9)
 v_mfma_f32_16x16x32_bf16 v[76:79], a[232:235], a[184:187], v[76:79]
 v_mfma_f32_16x16x32_bf16 v[76:79], a[236:239], a[188:191], v[76:79]
 global_load_dwordx4 a[228:231], v0, s[70:71] offset:1024 sc1
 v_mfma_f32_16x16x32_bf16 v[72:75], a[236:239], a[180:183], v[72:75]
 v_mfma_f32_16x16x32_bf16 v[72:75], a[232:235], a[176:179], v[72:75]
 global_load_dwordx4 a[224:227], v0, s[70:71] offset:0 sc1
 v_mfma_f32_16x16x32_bf16 v[68:71], a[232:235], a[168:171], v[68:71]
 s_waitcnt lgkmcnt(0)
 v_mfma_f32_16x16x32_bf16 v[68:71], a[236:239], a[172:175], v[68:71]
 v_mfma_f32_16x16x32_bf16 v[64:67], a[236:239], a[164:167], v[64:67]
 v_add_f32 v136, v136, v8
 v_mfma_f32_16x16x32_bf16 v[64:67], a[232:235], a[160:163], v[64:67]
 v_mfma_f32_16x16x32_bf16 v[60:63], a[232:235], a[152:155], v[60:63]
 ds_read_b128 v[12:15], v4 offset:272
 v_mfma_f32_16x16x32_bf16 v[60:63], a[236:239], a[156:159], v[60:63]
 v_add_f32 v137, v137, v9
 v_mfma_f32_16x16x32_bf16 v[56:59], a[236:239], a[148:151], v[56:59]
 v_mfma_f32_16x16x32_bf16 v[56:59], a[232:235], a[144:147], v[56:59]
 v_add_f32 v138, v138, v10
 v_mfma_f32_16x16x32_bf16 v[52:55], a[232:235], a[136:139], v[52:55]
 v_add_f32 v139, v139, v11
 v_mfma_f32_16x16x32_bf16 v[52:55], a[236:239], a[140:143], v[52:55]
 v_mfma_f32_16x16x32_bf16 v[48:51], a[236:239], a[132:135], v[48:51]
 v_add_f32 v140, v140, v8
 v_mfma_f32_16x16x32_bf16 v[48:51], a[232:235], a[128:131], v[48:51]
 v_add_f32 v141, v141, v9
 s_waitcnt vmcnt(9)
 v_mfma_f32_16x16x32_bf16 v[80:83], a[192:195], a[128:131], v[80:83]
 v_mfma_f32_16x16x32_bf16 v[80:83], a[196:199], a[132:135], v[80:83]
 global_load_dwordx4 a[236:239], v0, s[70:71] offset:3072 sc1
 v_add_f32 v142, v142, v10
 v_mfma_f32_16x16x32_bf16 v[84:87], a[196:199], a[140:143], v[84:87]
 v_add_f32 v143, v143, v11
 v_mfma_f32_16x16x32_bf16 v[84:87], a[192:195], a[136:139], v[84:87]
 global_load_dwordx4 a[232:235], v0, s[70:71] offset:2048 sc1
 v_mfma_f32_16x16x32_bf16 v[88:91], a[192:195], a[144:147], v[88:91]
 v_add_f32 v144, v144, v8
 s_add_u32 s70, s70, 8192
 s_addc_u32 s71, s71, 0
 v_mfma_f32_16x16x32_bf16 v[88:91], a[196:199], a[148:151], v[88:91]
 v_mfma_f32_16x16x32_bf16 v[92:95], a[196:199], a[156:159], v[92:95]
 v_add_f32 v145, v145, v9
 v_mfma_f32_16x16x32_bf16 v[92:95], a[192:195], a[152:155], v[92:95]
 v_add_f32 v146, v146, v10
 v_mfma_f32_16x16x32_bf16 v[96:99], a[192:195], a[160:163], v[96:99]
 v_mfma_f32_16x16x32_bf16 v[96:99], a[196:199], a[164:167], v[96:99]
 v_add_f32 v147, v147, v11
 v_mfma_f32_16x16x32_bf16 v[100:103], a[196:199], a[172:175], v[100:103]
 v_add_f32 v148, v148, v8
 v_mfma_f32_16x16x32_bf16 v[100:103], a[192:195], a[168:171], v[100:103]
 v_mfma_f32_16x16x32_bf16 v[104:107], a[192:195], a[176:179], v[104:107]
 v_add_f32 v149, v149, v9
 v_mfma_f32_16x16x32_bf16 v[104:107], a[196:199], a[180:183], v[104:107]
 v_add_f32 v150, v150, v10
 v_mfma_f32_16x16x32_bf16 v[108:111], a[196:199], a[188:191], v[108:111]
 v_mfma_f32_16x16x32_bf16 v[108:111], a[192:195], a[184:187], v[108:111]
 v_add_f32 v151, v151, v11
 s_waitcnt vmcnt(9)
 v_mfma_f32_16x16x32_bf16 a[244:247], a[200:203], a[184:187], a[244:247]
 ds_read_b128 a[184:187], v1 offset:63488
 v_add_f32 v152, v152, v8
 v_mfma_f32_16x16x32_bf16 a[244:247], a[204:207], a[188:191], a[244:247]
 global_load_dwordx4 a[196:199], v0, s[70:71] offset:-3072 sc1
 ds_read_b128 a[188:191], v1 offset:64512
 v_mfma_f32_16x16x32_bf16 a[240:243], a[204:207], a[180:183], a[240:243]
 ds_read_b128 a[180:183], v1 offset:60416
 v_add_f32 v153, v153, v9
 v_mfma_f32_16x16x32_bf16 a[240:243], a[200:203], a[176:179], a[240:243]
 global_load_dwordx4 a[192:195], v0, s[70:71] offset:-4096 sc1
 ds_read_b128 a[176:179], v1 offset:59392
 v_mfma_f32_16x16x32_bf16 v[132:135], a[200:203], a[168:171], v[132:135]
 ds_read_b128 a[168:171], v1 offset:55296
 v_add_f32 v154, v154, v10
 v_mfma_f32_16x16x32_bf16 v[132:135], a[204:207], a[172:175], v[132:135]
 ds_read_b128 a[172:175], v1 offset:56320
 v_add_f32 v155, v155, v11
 v_mfma_f32_16x16x32_bf16 v[128:131], a[204:207], a[164:167], v[128:131]
 ds_read_b128 a[164:167], v1 offset:52224
 v_mfma_f32_16x16x32_bf16 v[128:131], a[200:203], a[160:163], v[128:131]
 ds_read_b128 a[160:163], v1 offset:51200
 v_add_f32 v156, v156, v8
 v_mfma_f32_16x16x32_bf16 v[124:127], a[200:203], a[152:155], v[124:127]
 ds_read_b128 a[152:155], v1 offset:47104
 v_add_f32 v157, v157, v9
 v_mfma_f32_16x16x32_bf16 v[124:127], a[204:207], a[156:159], v[124:127]
 ds_read_b128 a[156:159], v1 offset:48128
 v_mfma_f32_16x16x32_bf16 v[120:123], a[204:207], a[148:151], v[120:123]
 ds_read_b128 a[148:151], v1 offset:44032
 v_add_f32 v158, v158, v10
 v_mfma_f32_16x16x32_bf16 v[120:123], a[200:203], a[144:147], v[120:123]
 ds_read_b128 a[144:147], v1 offset:43008
 v_add_f32 v159, v159, v11
 v_mfma_f32_16x16x32_bf16 v[116:119], a[200:203], a[136:139], v[116:119]
 ds_read_b128 a[136:139], v1 offset:38912
 v_mfma_f32_16x16x32_bf16 v[116:119], a[204:207], a[140:143], v[116:119]
 ds_read_b128 a[140:143], v1 offset:39936
 v_add_f32 v160, v160, v8
 v_mfma_f32_16x16x32_bf16 v[112:115], a[204:207], a[132:135], v[112:115]
 ds_read_b128 a[132:135], v1 offset:35840
 v_add_f32 v161, v161, v9
 v_mfma_f32_16x16x32_bf16 v[112:115], a[200:203], a[128:131], v[112:115]
 ds_read_b128 a[128:131], v1 offset:34816
 s_waitcnt vmcnt(9) lgkmcnt(8)
 v_mfma_f32_16x16x32_bf16 v[44:47], a[208:211], a[184:187], v[44:47]
 v_add_f32 v162, v162, v10
 v_mfma_f32_16x16x32_bf16 v[44:47], a[212:215], a[188:191], v[44:47]
 global_load_dwordx4 a[204:207], v0, s[70:71] offset:-1024 sc1
 v_mfma_f32_16x16x32_bf16 v[40:43], a[212:215], a[180:183], v[40:43]
 v_add_f32 v163, v163, v11
 v_mfma_f32_16x16x32_bf16 v[40:43], a[208:211], a[176:179], v[40:43]
 global_load_dwordx4 a[200:203], v0, s[70:71] offset:-2048 sc1
 v_add_f32 v164, v164, v8
 v_mfma_f32_16x16x32_bf16 v[36:39], a[208:211], a[168:171], v[36:39]
 v_mfma_f32_16x16x32_bf16 v[36:39], a[212:215], a[172:175], v[36:39]
 v_add_f32 v165, v165, v9
 v_mfma_f32_16x16x32_bf16 v[32:35], a[212:215], a[164:167], v[32:35]
 v_add_f32 v166, v166, v10
 v_mfma_f32_16x16x32_bf16 v[32:35], a[208:211], a[160:163], v[32:35]
 s_waitcnt lgkmcnt(0)
 v_mfma_f32_16x16x32_bf16 v[28:31], a[208:211], a[152:155], v[28:31]
 v_add_f32 v167, v167, v11
 v_mfma_f32_16x16x32_bf16 v[28:31], a[212:215], a[156:159], v[28:31]
 v_mfma_f32_16x16x32_bf16 v[24:27], a[212:215], a[148:151], v[24:27]
 v_mfma_f32_16x16x32_bf16 v[24:27], a[208:211], a[144:147], v[24:27]
 v_add_f32 v168, v168, v12
 v_mfma_f32_16x16x32_bf16 v[20:23], a[208:211], a[136:139], v[20:23]
 ds_read_b128 v[8:11], v4 offset:384
 v_mfma_f32_16x16x32_bf16 v[20:23], a[212:215], a[140:143], v[20:23]
 v_mfma_f32_16x16x32_bf16 v[16:19], a[212:215], a[132:135], v[16:19]
 v_add_f32 v169, v169, v13
 v_mfma_f32_16x16x32_bf16 v[16:19], a[208:211], a[128:131], v[16:19]
 s_waitcnt vmcnt(9)
 v_mfma_f32_16x16x32_bf16 v[48:51], a[216:219], a[128:131], v[48:51]
 v_add_f32 v170, v170, v14
 v_mfma_f32_16x16x32_bf16 v[48:51], a[220:223], a[132:135], v[48:51]
 global_load_dwordx4 a[212:215], v0, s[70:71] offset:1024 sc1
 v_add_f32 v171, v171, v15
 v_mfma_f32_16x16x32_bf16 v[52:55], a[220:223], a[140:143], v[52:55]
 v_mfma_f32_16x16x32_bf16 v[52:55], a[216:219], a[136:139], v[52:55]
 global_load_dwordx4 a[208:211], v0, s[70:71] offset:0 sc1
 v_add_f32 v172, v172, v12
 v_mfma_f32_16x16x32_bf16 v[56:59], a[216:219], a[144:147], v[56:59]
 v_add_f32 v173, v173, v13
 v_mfma_f32_16x16x32_bf16 v[56:59], a[220:223], a[148:151], v[56:59]
 v_mfma_f32_16x16x32_bf16 v[60:63], a[220:223], a[156:159], v[60:63]
 v_add_f32 v174, v174, v14
 v_mfma_f32_16x16x32_bf16 v[60:63], a[216:219], a[152:155], v[60:63]
 v_add_f32 v175, v175, v15
 v_mfma_f32_16x16x32_bf16 v[64:67], a[216:219], a[160:163], v[64:67]
 v_mfma_f32_16x16x32_bf16 v[64:67], a[220:223], a[164:167], v[64:67]
 v_add_f32 v176, v176, v12
 v_mfma_f32_16x16x32_bf16 v[68:71], a[220:223], a[172:175], v[68:71]
 v_add_f32 v177, v177, v13
 v_mfma_f32_16x16x32_bf16 v[68:71], a[216:219], a[168:171], v[68:71]
 v_mfma_f32_16x16x32_bf16 v[72:75], a[216:219], a[176:179], v[72:75]
 v_add_f32 v178, v178, v14
 v_mfma_f32_16x16x32_bf16 v[72:75], a[220:223], a[180:183], v[72:75]
 v_mfma_f32_16x16x32_bf16 v[76:79], a[220:223], a[188:191], v[76:79]
 v_add_f32 v179, v179, v15
 v_mfma_f32_16x16x32_bf16 v[76:79], a[216:219], a[184:187], v[76:79]
 v_add_f32 v180, v180, v12
 s_waitcnt vmcnt(8)
 v_mfma_f32_16x16x32_bf16 v[108:111], a[224:227], a[184:187], v[108:111]
 v_mfma_f32_16x16x32_bf16 v[108:111], a[228:231], a[188:191], v[108:111]
 global_load_dwordx4 a[220:223], v0, s[70:71] offset:3072 sc1
 v_add_f32 v181, v181, v13
 v_mfma_f32_16x16x32_bf16 v[104:107], a[228:231], a[180:183], v[104:107]
 v_add_f32 v182, v182, v14
 v_mfma_f32_16x16x32_bf16 v[104:107], a[224:227], a[176:179], v[104:107]
 global_load_dwordx4 a[216:219], v0, s[70:71] offset:2048 sc1
 v_mfma_f32_16x16x32_bf16 v[100:103], a[224:227], a[168:171], v[100:103]
 v_add_f32 v183, v183, v15
 s_add_u32 s70, s70, 8192
 s_addc_u32 s71, s71, 0
 v_mfma_f32_16x16x32_bf16 v[100:103], a[228:231], a[172:175], v[100:103]
 v_add_f32 v184, v184, v12
 v_mfma_f32_16x16x32_bf16 v[96:99], a[228:231], a[164:167], v[96:99]
 v_mfma_f32_16x16x32_bf16 v[96:99], a[224:227], a[160:163], v[96:99]
 v_add_f32 v185, v185, v13
 v_mfma_f32_16x16x32_bf16 v[92:95], a[224:227], a[152:155], v[92:95]
 v_add_f32 v186, v186, v14
 v_mfma_f32_16x16x32_bf16 v[92:95], a[228:231], a[156:159], v[92:95]
 v_mfma_f32_16x16x32_bf16 v[88:91], a[228:231], a[148:151], v[88:91]
 v_add_f32 v187, v187, v15
 v_mfma_f32_16x16x32_bf16 v[88:91], a[224:227], a[144:147], v[88:91]
 v_mfma_f32_16x16x32_bf16 v[84:87], a[224:227], a[136:139], v[84:87]
 v_add_f32 v188, v188, v12
 v_mfma_f32_16x16x32_bf16 v[84:87], a[228:231], a[140:143], v[84:87]
 v_add_f32 v189, v189, v13
 v_mfma_f32_16x16x32_bf16 v[80:83], a[228:231], a[132:135], v[80:83]
 v_mfma_f32_16x16x32_bf16 v[80:83], a[224:227], a[128:131], v[80:83]
 v_add_f32 v190, v190, v14
 s_waitcnt vmcnt(8)
 v_mfma_f32_16x16x32_bf16 v[112:115], a[232:235], a[128:131], v[112:115]
 ds_read_b128 a[128:131], v2 offset:2048
 v_add_f32 v191, v191, v15
 v_mfma_f32_16x16x32_bf16 v[112:115], a[236:239], a[132:135], v[112:115]
 global_load_dwordx4 a[228:231], v0, s[70:71] offset:-3072 sc1
 ds_read_b128 a[132:135], v2 offset:3072
 v_mfma_f32_16x16x32_bf16 v[116:119], a[236:239], a[140:143], v[116:119]
 ds_read_b128 a[140:143], v2 offset:7168
 v_add_f32 v192, v192, v12
 v_mfma_f32_16x16x32_bf16 v[116:119], a[232:235], a[136:139], v[116:119]
 global_load_dwordx4 a[224:227], v0, s[70:71] offset:-4096 sc1
 ds_read_b128 a[136:139], v2 offset:6144
 v_mfma_f32_16x16x32_bf16 v[120:123], a[232:235], a[144:147], v[120:123]
 ds_read_b128 a[144:147], v2 offset:10240
 v_add_f32 v193, v193, v13
 v_mfma_f32_16x16x32_bf16 v[120:123], a[236:239], a[148:151], v[120:123]
 ds_read_b128 a[148:151], v2 offset:11264
 v_add_f32 v194, v194, v14
 v_mfma_f32_16x16x32_bf16 v[124:127], a[236:239], a[156:159], v[124:127]
 ds_read_b128 a[156:159], v2 offset:15360
 v_add_f32 v195, v195, v15
 v_mfma_f32_16x16x32_bf16 v[124:127], a[232:235], a[152:155], v[124:127]
 ds_read_b128 a[152:155], v2 offset:14336
 v_mfma_f32_16x16x32_bf16 v[128:131], a[232:235], a[160:163], v[128:131]
 ds_read_b128 a[160:163], v2 offset:18432
 v_add_f32 v196, v196, v12
 v_mfma_f32_16x16x32_bf16 v[128:131], a[236:239], a[164:167], v[128:131]
 ds_read_b128 a[164:167], v2 offset:19456
 v_mfma_f32_16x16x32_bf16 v[132:135], a[236:239], a[172:175], v[132:135]
 ds_read_b128 a[172:175], v2 offset:23552
 v_add_f32 v197, v197, v13
 v_mfma_f32_16x16x32_bf16 v[132:135], a[232:235], a[168:171], v[132:135]
 ds_read_b128 a[168:171], v2 offset:22528
 v_add_f32 v198, v198, v14
 v_mfma_f32_16x16x32_bf16 a[240:243], a[232:235], a[176:179], a[240:243]
 ds_read_b128 a[176:179], v2 offset:26624
 v_mfma_f32_16x16x32_bf16 a[240:243], a[236:239], a[180:183], a[240:243]
 ds_read_b128 a[180:183], v2 offset:27648
 v_add_f32 v199, v199, v15
 v_mfma_f32_16x16x32_bf16 a[244:247], a[236:239], a[188:191], a[244:247]
 ds_read_b128 a[188:191], v2 offset:31744
 s_waitcnt lgkmcnt(15)
 v_mfma_f32_16x16x32_bf16 a[244:247], a[232:235], a[184:187], a[244:247]
 ds_read_b128 a[184:187], v2 offset:30720
 s_waitcnt vmcnt(8) lgkmcnt(8)
 v_mfma_f32_16x16x32_bf16 v[16:19], a[192:195], a[128:131], v[16:19]
 v_add_f32 v200, v200, v8
 v_mfma_f32_16x16x32_bf16 v[16:19], a[196:199], a[132:135], v[16:19]
 global_load_dwordx4 a[236:239], v0, s[70:71] offset:-1024 sc1
 ds_read_b128 v[12:15], v4 offset:400
 v_mfma_f32_16x16x32_bf16 v[20:23], a[196:199], a[140:143], v[20:23]
 v_mfma_f32_16x16x32_bf16 v[20:23], a[192:195], a[136:139], v[20:23]
 global_load_dwordx4 a[232:235], v0, s[70:71] offset:-2048 sc1
 v_add_f32 v201, v201, v9
 v_mfma_f32_16x16x32_bf16 v[24:27], a[192:195], a[144:147], v[24:27]
 v_add_f32 v202, v202, v10
 v_mfma_f32_16x16x32_bf16 v[24:27], a[196:199], a[148:151], v[24:27]
 v_mfma_f32_16x16x32_bf16 v[28:31], a[196:199], a[156:159], v[28:31]
 v_add_f32 v203, v203, v11
 v_mfma_f32_16x16x32_bf16 v[28:31], a[192:195], a[152:155], v[28:31]
 s_waitcnt lgkmcnt(1)
 v_mfma_f32_16x16x32_bf16 v[32:35], a[192:195], a[160:163], v[32:35]
 v_add_f32 v204, v204, v8
 v_mfma_f32_16x16x32_bf16 v[32:35], a[196:199], a[164:167], v[32:35]
 v_add_f32 v205, v205, v9
 v_mfma_f32_16x16x32_bf16 v[36:39], a[196:199], a[172:175], v[36:39]
 v_mfma_f32_16x16x32_bf16 v[36:39], a[192:195], a[168:171], v[36:39]
 v_add_f32 v206, v206, v10
 v_mfma_f32_16x16x32_bf16 v[40:43], a[192:195], a[176:179], v[40:43]
 v_add_f32 v207, v207, v11
 v_mfma_f32_16x16x32_bf16 v[40:43], a[196:199], a[180:183], v[40:43]
 v_mfma_f32_16x16x32_bf16 v[44:47], a[196:199], a[188:191], v[44:47]
 v_add_f32 v208, v208, v8
 v_mfma_f32_16x16x32_bf16 v[44:47], a[192:195], a[184:187], v[44:47]
 v_add_f32 v209, v209, v9
 s_waitcnt vmcnt(8)
 v_mfma_f32_16x16x32_bf16 v[76:79], a[200:203], a[184:187], v[76:79]
 v_mfma_f32_16x16x32_bf16 v[76:79], a[204:207], a[188:191], v[76:79]
 global_load_dwordx4 a[196:199], v0, s[70:71] offset:1024 sc1
 v_add_f32 v210, v210, v10
 v_mfma_f32_16x16x32_bf16 v[72:75], a[204:207], a[180:183], v[72:75]
 v_add_f32 v211, v211, v11
 v_mfma_f32_16x16x32_bf16 v[72:75], a[200:203], a[176:179], v[72:75]
 global_load_dwordx4 a[192:195], v0, s[70:71] offset:0 sc1
 v_mfma_f32_16x16x32_bf16 v[68:71], a[200:203], a[168:171], v[68:71]
 v_add_f32 v212, v212, v8
 v_mfma_f32_16x16x32_bf16 v[68:71], a[204:207], a[172:175], v[68:71]
 v_mfma_f32_16x16x32_bf16 v[64:67], a[204:207], a[164:167], v[64:67]
 v_add_f32 v213, v213, v9
 v_mfma_f32_16x16x32_bf16 v[64:67], a[200:203], a[160:163], v[64:67]
 v_add_f32 v214, v214, v10
 v_mfma_f32_16x16x32_bf16 v[60:63], a[200:203], a[152:155], v[60:63]
 v_mfma_f32_16x16x32_bf16 v[60:63], a[204:207], a[156:159], v[60:63]
 v_add_f32 v215, v215, v11
 v_mfma_f32_16x16x32_bf16 v[56:59], a[204:207], a[148:151], v[56:59]
 v_add_f32 v216, v216, v8
 v_mfma_f32_16x16x32_bf16 v[56:59], a[200:203], a[144:147], v[56:59]
 v_mfma_f32_16x16x32_bf16 v[52:55], a[200:203], a[136:139], v[52:55]
 v_add_f32 v217, v217, v9
 v_mfma_f32_16x16x32_bf16 v[52:55], a[204:207], a[140:143], v[52:55]
 v_add_f32 v218, v218, v10
 v_mfma_f32_16x16x32_bf16 v[48:51], a[204:207], a[132:135], v[48:51]
 v_mfma_f32_16x16x32_bf16 v[48:51], a[200:203], a[128:131], v[48:51]
 v_add_f32 v219, v219, v11
 s_waitcnt vmcnt(8)
 v_mfma_f32_16x16x32_bf16 v[80:83], a[208:211], a[128:131], v[80:83]
 v_add_f32 v220, v220, v8
 v_mfma_f32_16x16x32_bf16 v[80:83], a[212:215], a[132:135], v[80:83]
 global_load_dwordx4 a[204:207], v0, s[70:71] offset:3072 sc1
 v_mfma_f32_16x16x32_bf16 v[84:87], a[212:215], a[140:143], v[84:87]
 v_add_f32 v221, v221, v9
 v_mfma_f32_16x16x32_bf16 v[84:87], a[208:211], a[136:139], v[84:87]
 global_load_dwordx4 a[200:203], v0, s[70:71] offset:2048 sc1
 v_mfma_f32_16x16x32_bf16 v[88:91], a[208:211], a[144:147], v[88:91]
 v_add_f32 v222, v222, v10
 s_add_u32 s70, s70, 8192
 s_addc_u32 s71, s71, 0
 v_mfma_f32_16x16x32_bf16 v[88:91], a[212:215], a[148:151], v[88:91]
 v_add_f32 v223, v223, v11
 v_mfma_f32_16x16x32_bf16 v[92:95], a[212:215], a[156:159], v[92:95]
 v_mfma_f32_16x16x32_bf16 v[92:95], a[208:211], a[152:155], v[92:95]
 v_add_f32 v224, v224, v8
 v_mfma_f32_16x16x32_bf16 v[96:99], a[208:211], a[160:163], v[96:99]
 v_add_f32 v225, v225, v9
 v_mfma_f32_16x16x32_bf16 v[96:99], a[212:215], a[164:167], v[96:99]
 v_mfma_f32_16x16x32_bf16 v[100:103], a[212:215], a[172:175], v[100:103]
 v_add_f32 v226, v226, v10
 v_mfma_f32_16x16x32_bf16 v[100:103], a[208:211], a[168:171], v[100:103]
 v_add_f32 v227, v227, v11
 v_mfma_f32_16x16x32_bf16 v[104:107], a[208:211], a[176:179], v[104:107]
 v_mfma_f32_16x16x32_bf16 v[104:107], a[212:215], a[180:183], v[104:107]
 v_add_f32 v228, v228, v8
 v_mfma_f32_16x16x32_bf16 v[108:111], a[212:215], a[188:191], v[108:111]
 v_add_f32 v229, v229, v9
 v_mfma_f32_16x16x32_bf16 v[108:111], a[208:211], a[184:187], v[108:111]
 s_waitcnt vmcnt(8)
 v_mfma_f32_16x16x32_bf16 a[244:247], a[216:219], a[184:187], a[244:247]
 ds_read_b128 a[184:187], v2 offset:63488
 v_add_f32 v230, v230, v10
 v_mfma_f32_16x16x32_bf16 a[244:247], a[220:223], a[188:191], a[244:247]
 global_load_dwordx4 a[212:215], v0, s[70:71] offset:-3072 sc1
 ds_read_b128 a[188:191], v2 offset:64512
 v_mfma_f32_16x16x32_bf16 a[240:243], a[220:223], a[180:183], a[240:243]
 ds_read_b128 a[180:183], v2 offset:60416
 v_add_f32 v231, v231, v11
 v_mfma_f32_16x16x32_bf16 a[240:243], a[216:219], a[176:179], a[240:243]
 global_load_dwordx4 a[208:211], v0, s[70:71] offset:-4096 sc1
 ds_read_b128 a[176:179], v2 offset:59392
 s_waitcnt lgkmcnt(4)
 v_mfma_f32_16x16x32_bf16 v[132:135], a[216:219], a[168:171], v[132:135]
 ds_read_b128 a[168:171], v2 offset:55296
 v_mfma_f32_16x16x32_bf16 v[132:135], a[220:223], a[172:175], v[132:135]
 ds_read_b128 a[172:175], v2 offset:56320
 v_add_f32 v232, v232, v12
 v_mfma_f32_16x16x32_bf16 v[128:131], a[220:223], a[164:167], v[128:131]
 ds_read_b128 a[164:167], v2 offset:52224
 v_add_f32 v233, v233, v13
 v_mfma_f32_16x16x32_bf16 v[128:131], a[216:219], a[160:163], v[128:131]
 ds_read_b128 a[160:163], v2 offset:51200
 v_mfma_f32_16x16x32_bf16 v[124:127], a[216:219], a[152:155], v[124:127]
 ds_read_b128 a[152:155], v2 offset:47104
 v_add_f32 v234, v234, v14
 v_mfma_f32_16x16x32_bf16 v[124:127], a[220:223], a[156:159], v[124:127]
 ds_read_b128 a[156:159], v2 offset:48128
 v_add_f32 v235, v235, v15
 v_mfma_f32_16x16x32_bf16 v[120:123], a[220:223], a[148:151], v[120:123]
 ds_read_b128 a[148:151], v2 offset:44032
 v_mfma_f32_16x16x32_bf16 v[120:123], a[216:219], a[144:147], v[120:123]
 ds_read_b128 a[144:147], v2 offset:43008
 v_add_f32 v236, v236, v12
 v_mfma_f32_16x16x32_bf16 v[116:119], a[216:219], a[136:139], v[116:119]
 ds_read_b128 a[136:139], v2 offset:38912
 v_add_f32 v237, v237, v13
 v_mfma_f32_16x16x32_bf16 v[116:119], a[220:223], a[140:143], v[116:119]
 ds_read_b128 a[140:143], v2 offset:39936
 v_mfma_f32_16x16x32_bf16 v[112:115], a[220:223], a[132:135], v[112:115]
 ds_read_b128 a[132:135], v2 offset:35840
 v_add_f32 v238, v238, v14
 v_mfma_f32_16x16x32_bf16 v[112:115], a[216:219], a[128:131], v[112:115]
 ds_read_b128 a[128:131], v2 offset:34816
 s_waitcnt vmcnt(8) lgkmcnt(8)
 v_mfma_f32_16x16x32_bf16 v[44:47], a[224:227], a[184:187], v[44:47]
 v_add_f32 v239, v239, v15
 v_mfma_f32_16x16x32_bf16 v[44:47], a[228:231], a[188:191], v[44:47]
 global_load_dwordx4 a[220:223], v0, s[70:71] offset:-1024 sc1
 v_add_f32 v240, v240, v12
 v_mfma_f32_16x16x32_bf16 v[40:43], a[228:231], a[180:183], v[40:43]
 v_mfma_f32_16x16x32_bf16 v[40:43], a[224:227], a[176:179], v[40:43]
 global_load_dwordx4 a[216:219], v0, s[70:71] offset:-2048 sc1
 v_add_f32 v241, v241, v13
 v_mfma_f32_16x16x32_bf16 v[36:39], a[224:227], a[168:171], v[36:39]
 v_add_f32 v242, v242, v14
 v_mfma_f32_16x16x32_bf16 v[36:39], a[228:231], a[172:175], v[36:39]
 v_mfma_f32_16x16x32_bf16 v[32:35], a[228:231], a[164:167], v[32:35]
 v_add_f32 v243, v243, v15
 v_mfma_f32_16x16x32_bf16 v[32:35], a[224:227], a[160:163], v[32:35]
 v_add_f32 v244, v244, v12
 s_waitcnt lgkmcnt(0)
 v_mfma_f32_16x16x32_bf16 v[28:31], a[224:227], a[152:155], v[28:31]
 v_mfma_f32_16x16x32_bf16 v[28:31], a[228:231], a[156:159], v[28:31]
 v_add_f32 v245, v245, v13
 v_mfma_f32_16x16x32_bf16 v[24:27], a[228:231], a[148:151], v[24:27]
 v_add_f32 v246, v246, v14
 v_mfma_f32_16x16x32_bf16 v[24:27], a[224:227], a[144:147], v[24:27]
 v_mfma_f32_16x16x32_bf16 v[20:23], a[224:227], a[136:139], v[20:23]
 v_add_f32 v247, v247, v15
 v_mfma_f32_16x16x32_bf16 v[20:23], a[228:231], a[140:143], v[20:23]
 v_mfma_f32_16x16x32_bf16 v[16:19], a[228:231], a[132:135], v[16:19]
 v_add_f32 v248, v248, v12
 v_mfma_f32_16x16x32_bf16 v[16:19], a[224:227], a[128:131], v[16:19]
 v_add_f32 v249, v249, v13
 s_waitcnt vmcnt(8)
 v_mfma_f32_16x16x32_bf16 v[48:51], a[232:235], a[128:131], v[48:51]
 v_mfma_f32_16x16x32_bf16 v[48:51], a[236:239], a[132:135], v[48:51]
 global_load_dwordx4 a[228:231], v0, s[70:71] offset:1024 sc1
 v_add_f32 v250, v250, v14
 v_mfma_f32_16x16x32_bf16 v[52:55], a[236:239], a[140:143], v[52:55]
 v_add_f32 v251, v251, v15
 v_mfma_f32_16x16x32_bf16 v[52:55], a[232:235], a[136:139], v[52:55]
 global_load_dwordx4 a[224:227], v0, s[70:71] offset:0 sc1
 v_mfma_f32_16x16x32_bf16 v[56:59], a[232:235], a[144:147], v[56:59]
 v_add_f32 v252, v252, v12
 v_mfma_f32_16x16x32_bf16 v[56:59], a[236:239], a[148:151], v[56:59]
 v_add_f32 v253, v253, v13
 v_mfma_f32_16x16x32_bf16 v[60:63], a[236:239], a[156:159], v[60:63]
 v_mfma_f32_16x16x32_bf16 v[60:63], a[232:235], a[152:155], v[60:63]
 v_add_f32 v254, v254, v14
 v_mfma_f32_16x16x32_bf16 v[64:67], a[232:235], a[160:163], v[64:67]
 v_add_f32 v255, v255, v15
 v_mfma_f32_16x16x32_bf16 v[64:67], a[236:239], a[164:167], v[64:67]
 v_mfma_f32_16x16x32_bf16 v[68:71], a[236:239], a[172:175], v[68:71]
 v_accvgpr_read_b32 v5, a248
 v_mfma_f32_16x16x32_bf16 v[68:71], a[232:235], a[168:171], v[68:71]
 v_mfma_f32_16x16x32_bf16 v[72:75], a[232:235], a[176:179], v[72:75]
 v_add_f32 v5, v5, v12
 v_mfma_f32_16x16x32_bf16 v[72:75], a[236:239], a[180:183], v[72:75]
 v_accvgpr_write_b32 a248, v5
 v_mfma_f32_16x16x32_bf16 v[76:79], a[236:239], a[188:191], v[76:79]
 v_mfma_f32_16x16x32_bf16 v[76:79], a[232:235], a[184:187], v[76:79]
 v_accvgpr_read_b32 v6, a249
 s_waitcnt vmcnt(8)
 v_mfma_f32_16x16x32_bf16 v[108:111], a[192:195], a[184:187], v[108:111]
 v_add_f32 v6, v6, v13
 v_mfma_f32_16x16x32_bf16 v[108:111], a[196:199], a[188:191], v[108:111]
 global_load_dwordx4 a[236:239], v0, s[70:71] offset:3072 sc1
 v_mfma_f32_16x16x32_bf16 v[104:107], a[196:199], a[180:183], v[104:107]
 v_accvgpr_write_b32 a249, v6
 v_mfma_f32_16x16x32_bf16 v[104:107], a[192:195], a[176:179], v[104:107]
 global_load_dwordx4 a[232:235], v0, s[70:71] offset:2048 sc1
 v_accvgpr_read_b32 v5, a250
 v_mfma_f32_16x16x32_bf16 v[100:103], a[192:195], a[168:171], v[100:103]
 s_add_u32 s70, s70, 8192
 s_addc_u32 s71, s71, 0
 v_mfma_f32_16x16x32_bf16 v[100:103], a[196:199], a[172:175], v[100:103]
 v_add_f32 v5, v5, v14
 v_mfma_f32_16x16x32_bf16 v[96:99], a[196:199], a[164:167], v[96:99]
 v_accvgpr_write_b32 a250, v5
 v_mfma_f32_16x16x32_bf16 v[96:99], a[192:195], a[160:163], v[96:99]
 v_mfma_f32_16x16x32_bf16 v[92:95], a[192:195], a[152:155], v[92:95]
 v_accvgpr_read_b32 v6, a251
 v_mfma_f32_16x16x32_bf16 v[92:95], a[196:199], a[156:159], v[92:95]
 v_mfma_f32_16x16x32_bf16 v[88:91], a[196:199], a[148:151], v[88:91]
 v_add_f32 v6, v6, v15
 v_mfma_f32_16x16x32_bf16 v[88:91], a[192:195], a[144:147], v[88:91]
 v_accvgpr_write_b32 a251, v6
 v_mfma_f32_16x16x32_bf16 v[84:87], a[192:195], a[136:139], v[84:87]
 v_mfma_f32_16x16x32_bf16 v[84:87], a[196:199], a[140:143], v[84:87]
 v_accvgpr_read_b32 v5, a252
 v_mfma_f32_16x16x32_bf16 v[80:83], a[196:199], a[132:135], v[80:83]
 v_add_f32 v5, v5, v12
 v_mfma_f32_16x16x32_bf16 v[80:83], a[192:195], a[128:131], v[80:83]
 s_waitcnt vmcnt(8)
 v_mfma_f32_16x16x32_bf16 v[112:115], a[200:203], a[128:131], v[112:115]
 ds_read_b128 a[128:131], v1 offset:2048
 v_accvgpr_write_b32 a252, v5
 v_mfma_f32_16x16x32_bf16 v[112:115], a[204:207], a[132:135], v[112:115]
 global_load_dwordx4 a[196:199], v0, s[70:71] offset:-3072 sc1
 ds_read_b128 a[132:135], v1 offset:3072
 v_mfma_f32_16x16x32_bf16 v[116:119], a[204:207], a[140:143], v[116:119]
 ds_read_b128 a[140:143], v1 offset:7168
 v_accvgpr_read_b32 v6, a253
 v_mfma_f32_16x16x32_bf16 v[116:119], a[200:203], a[136:139], v[116:119]
 global_load_dwordx4 a[192:195], v0, s[70:71] offset:-4096 sc1
 ds_read_b128 a[136:139], v1 offset:6144
 v_mfma_f32_16x16x32_bf16 v[120:123], a[200:203], a[144:147], v[120:123]
 ds_read_b128 a[144:147], v1 offset:10240
 v_add_f32 v6, v6, v13
 v_mfma_f32_16x16x32_bf16 v[120:123], a[204:207], a[148:151], v[120:123]
 ds_read_b128 a[148:151], v1 offset:11264
 v_accvgpr_write_b32 a253, v6
 v_mfma_f32_16x16x32_bf16 v[124:127], a[204:207], a[156:159], v[124:127]
 ds_read_b128 a[156:159], v1 offset:15360
 v_accvgpr_read_b32 v5, a254
 v_mfma_f32_16x16x32_bf16 v[124:127], a[200:203], a[152:155], v[124:127]
 ds_read_b128 a[152:155], v1 offset:14336
 v_mfma_f32_16x16x32_bf16 v[128:131], a[200:203], a[160:163], v[128:131]
 ds_read_b128 a[160:163], v1 offset:18432
 v_add_f32 v5, v5, v14
 v_mfma_f32_16x16x32_bf16 v[128:131], a[204:207], a[164:167], v[128:131]
 ds_read_b128 a[164:167], v1 offset:19456
 v_accvgpr_write_b32 a254, v5
 v_mfma_f32_16x16x32_bf16 v[132:135], a[204:207], a[172:175], v[132:135]
 ds_read_b128 a[172:175], v1 offset:23552
 v_mfma_f32_16x16x32_bf16 v[132:135], a[200:203], a[168:171], v[132:135]
 ds_read_b128 a[168:171], v1 offset:22528
 v_accvgpr_read_b32 v6, a255
 v_mfma_f32_16x16x32_bf16 a[240:243], a[200:203], a[176:179], a[240:243]
 ds_read_b128 a[176:179], v1 offset:26624
 v_add_f32 v6, v6, v15
 v_mfma_f32_16x16x32_bf16 a[240:243], a[204:207], a[180:183], a[240:243]
 ds_read_b128 a[180:183], v1 offset:27648
 v_accvgpr_write_b32 a255, v6
 v_mfma_f32_16x16x32_bf16 a[244:247], a[204:207], a[188:191], a[244:247]
 global_load_dwordx4 a[204:207], v0, s[70:71] offset:-1024 sc1
 ds_read_b128 a[188:191], v1 offset:31744
 v_mfma_f32_16x16x32_bf16 a[244:247], a[200:203], a[184:187], a[244:247]
 global_load_dwordx4 a[200:203], v0, s[70:71] offset:-2048 sc1
 ds_read_b128 a[184:187], v1 offset:30720
 s_waitcnt vmcnt(10) lgkmcnt(8)
 s_mov_b32 s8, s32
 s_mov_b32 s9, s33
 s_mov_b32 s10, s34
 s_mov_b32 s20, 1024
 s_mov_b32 s21, 1024
 s_mov_b32 s22, 1024
 s_xor_b32 s30, s29, 131072
 s_add_u32 s51, s51, 2048
 s_add_u32 s25, s25, 1
 s_cmp_eq_u32 s25, 6
 s_cbranch_scc1 Llast
 v_mfma_f32_16x16x32_bf16 v[136:139], a[208:211], a[128:131], v[136:139]
 v_accvgpr_read_b32 v5, a0
 v_lshlrev_b32 v6, 16, v5
 v_mfma_f32_16x16x32_bf16 v[136:139], a[212:215], a[132:135], v[136:139]
 v_and_b32 v5, s26, v5
 v_mul_f32 v6, v6, v16
 v_mfma_f32_16x16x32_bf16 v[140:143], a[212:215], a[140:143], v[140:143]
 v_mul_f32 v5, v5, v17
 v_cvt_pk_bf16_f32 v8, v6, v5
 v_mfma_f32_16x16x32_bf16 v[140:143], a[208:211], a[136:139], v[140:143]
 v_accvgpr_read_b32 v5, a1
 v_mfma_f32_16x16x32_bf16 v[144:147], a[208:211], a[144:147], v[144:147]
 v_lshlrev_b32 v6, 16, v5
 v_and_b32 v5, s26, v5
 v_mfma_f32_16x16x32_bf16 v[144:147], a[212:215], a[148:151], v[144:147]
 v_mul_f32 v6, v6, v18
 v_mul_f32 v5, v5, v19
 v_mfma_f32_16x16x32_bf16 v[148:151], a[212:215], a[156:159], v[148:151]
 v_cvt_pk_bf16_f32 v9, v6, v5
 v_accvgpr_read_b32 v5, a2
 v_mfma_f32_16x16x32_bf16 v[148:151], a[208:211], a[152:155], v[148:151]
 v_lshlrev_b32 v6, 16, v5
 v_and_b32 v5, s26, v5
 s_waitcnt lgkmcnt(0)
 v_mfma_f32_16x16x32_bf16 v[152:155], a[208:211], a[160:163], v[152:155]
 v_mul_f32 v6, v6, v48
 v_mul_f32 v5, v5, v49
 v_mfma_f32_16x16x32_bf16 v[152:155], a[212:215], a[164:167], v[152:155]
 v_cvt_pk_bf16_f32 v10, v6, v5
 v_mfma_f32_16x16x32_bf16 v[156:159], a[212:215], a[172:175], v[156:159]
 v_accvgpr_read_b32 v5, a3
 v_lshlrev_b32 v6, 16, v5
 v_mfma_f32_16x16x32_bf16 v[156:159], a[208:211], a[168:171], v[156:159]
 v_and_b32 v5, s26, v5
 v_mul_f32 v6, v6, v50
 v_mfma_f32_16x16x32_bf16 v[160:163], a[208:211], a[176:179], v[160:163]
 v_mul_f32 v5, v5, v51
 v_cvt_pk_bf16_f32 v11, v6, v5
 v_mfma_f32_16x16x32_bf16 v[160:163], a[212:215], a[180:183], v[160:163]
 ds_write_b128 v3, v[8:11]
 s_add_u32 s68, s29, 0
 v_mfma_f32_16x16x32_bf16 v[164:167], a[212:215], a[188:191], v[164:167]
 buffer_store_dwordx4 v[8:11], v3, s[32:35], s68 offen sc1
 v_accvgpr_read_b32 v5, a32
 v_mfma_f32_16x16x32_bf16 v[164:167], a[208:211], a[184:187], v[164:167]
 v_lshlrev_b32 v6, 16, v5
 v_and_b32 v5, s26, v5
 s_waitcnt vmcnt(9)
 v_mfma_f32_16x16x32_bf16 v[196:199], a[216:219], a[184:187], v[196:199]
 v_mul_f32 v6, v6, v80
 v_mul_f32 v5, v5, v81
 v_mfma_f32_16x16x32_bf16 v[196:199], a[220:223], a[188:191], v[196:199]
 global_load_dwordx4 a[212:215], v0, s[70:71] offset:1024 sc1
 v_cvt_pk_bf16_f32 v12, v6, v5
 v_mfma_f32_16x16x32_bf16 v[192:195], a[220:223], a[180:183], v[192:195]
 v_accvgpr_read_b32 v5, a33
 v_lshlrev_b32 v6, 16, v5
 v_mfma_f32_16x16x32_bf16 v[192:195], a[216:219], a[176:179], v[192:195]
 global_load_dwordx4 a[208:211], v0, s[70:71] offset:0 sc1
 v_and_b32 v5, s26, v5
 v_mfma_f32_16x16x32_bf16 v[188:191], a[216:219], a[168:171], v[188:191]
 v_mul_f32 v6, v6, v82
 v_mul_f32 v5, v5, v83
 v_mfma_f32_16x16x32_bf16 v[188:191], a[220:223], a[172:175], v[188:191]
 v_cvt_pk_bf16_f32 v13, v6, v5
 v_accvgpr_read_b32 v5, a34
 v_mfma_f32_16x16x32_bf16 v[184:187], a[220:223], a[164:167], v[184:187]
 v_lshlrev_b32 v6, 16, v5
 v_and_b32 v5, s26, v5
 v_mfma_f32_16x16x32_bf16 v[184:187], a[216:219], a[160:163], v[184:187]
 v_mul_f32 v6, v6, v112
 v_mul_f32 v5, v5, v113
 v_mfma_f32_16x16x32_bf16 v[180:183], a[216:219], a[152:155], v[180:183]
 v_cvt_pk_bf16_f32 v14, v6, v5
 v_accvgpr_read_b32 v5, a35
 v_mfma_f32_16x16x32_bf16 v[180:183], a[220:223], a[156:159], v[180:183]
 v_lshlrev_b32 v6, 16, v5
 v_and_b32 v5, s26, v5
 v_mfma_f32_16x16x32_bf16 v[176:179], a[220:223], a[148:151], v[176:179]
 v_mul_f32 v6, v6, v114
 v_mul_f32 v5, v5, v115
 v_mfma_f32_16x16x32_bf16 v[176:179], a[216:219], a[144:147], v[176:179]
 v_cvt_pk_bf16_f32 v15, v6, v5
 v_mfma_f32_16x16x32_bf16 v[172:175], a[216:219], a[136:139], v[172:175]
 ds_write_b128 v3, v[12:15] offset:1024
 v_mfma_f32_16x16x32_bf16 v[172:175], a[220:223], a[140:143], v[172:175]
 buffer_store_dwordx4 v[12:15], v3, s[32:35], s68 offen offset:1024 sc1
 v_accvgpr_read_b32 v5, a4
 v_lshlrev_b32 v6, 16, v5
 v_and_b32 v5, s26, v5
 v_mul_f32 v6, v6, v20
 v_mfma_f32_16x16x32_bf16 v[168:171], a[220:223], a[132:135], v[168:171]
 v_mul_f32 v5, v5, v21
 v_cvt_pk_bf16_f32 v8, v6, v5
 v_mfma_f32_16x16x32_bf16 v[168:171], a[216:219], a[128:131], v[168:171]
 v_accvgpr_read_b32 v5, a5
 v_lshlrev_b32 v6, 16, v5
 s_waitcnt vmcnt(10)
 v_mfma_f32_16x16x32_bf16 v[200:203], a[224:227], a[128:131], v[200:203]
 v_and_b32 v5, s26, v5
 v_mul_f32 v6, v6, v22
 v_mfma_f32_16x16x32_bf16 v[200:203], a[228:231], a[132:135], v[200:203]
 global_load_dwordx4 a[220:223], v0, s[70:71] offset:3072 sc1
 v_mul_f32 v5, v5, v23
 v_mfma_f32_16x16x32_bf16 v[204:207], a[228:231], a[140:143], v[204:207]
 v_cvt_pk_bf16_f32 v9, v6, v5
 v_accvgpr_read_b32 v5, a6
 v_mfma_f32_16x16x32_bf16 v[204:207], a[224:227], a[136:139], v[204:207]
 global_load_dwordx4 a[216:219], v0, s[70:71] offset:2048 sc1
 v_lshlrev_b32 v6, 16, v5
 v_mfma_f32_16x16x32_bf16 v[208:211], a[224:227], a[144:147], v[208:211]
 v_and_b32 v5, s26, v5
 v_mul_f32 v6, v6, v52
 s_add_u32 s70, s70, 8192
 s_addc_u32 s71, s71, 0
 v_mfma_f32_16x16x32_bf16 v[208:211], a[228:231], a[148:151], v[208:211]
 v_mul_f32 v5, v5, v53
 v_cvt_pk_bf16_f32 v10, v6, v5
 v_mfma_f32_16x16x32_bf16 v[212:215], a[228:231], a[156:159], v[212:215]
 v_accvgpr_read_b32 v5, a7
 v_lshlrev_b32 v6, 16, v5
 v_mfma_f32_16x16x32_bf16 v[212:215], a[224:227], a[152:155], v[212:215]
 v_and_b32 v5, s26, v5
 v_mul_f32 v6, v6, v54
 v_mfma_f32_16x16x32_bf16 v[216:219], a[224:227], a[160:163], v[216:219]
 v_mul_f32 v5, v5, v55
 v_cvt_pk_bf16_f32 v11, v6, v5
 v_mfma_f32_16x16x32_bf16 v[216:219], a[228:231], a[164:167], v[216:219]
 ds_write_b128 v3, v[8:11] offset:4096
 v_mfma_f32_16x16x32_bf16 v[220:223], a[228:231], a[172:175], v[220:223]
 buffer_store_dwordx4 v[8:11], v3, s[32:35], s68 offen offset:2048 sc1
 v_accvgpr_read_b32 v5, a36
 v_lshlrev_b32 v6, 16, v5
 v_and_b32 v5, s26, v5
 v_mul_f32 v6, v6, v84
 v_mfma_f32_16x16x32_bf16 v[220:223], a[224:227], a[168:171], v[220:223]
 v_mul_f32 v5, v5, v85
 v_cvt_pk_bf16_f32 v12, v6, v5
 v_mfma_f32_16x16x32_bf16 v[224:227], a[224:227], a[176:179], v[224:227]
 v_accvgpr_read_b32 v5, a37
 v_lshlrev_b32 v6, 16, v5
 v_mfma_f32_16x16x32_bf16 v[224:227], a[228:231], a[180:183], v[224:227]
 v_and_b32 v5, s26, v5
 v_mul_f32 v6, v6, v86
 v_mfma_f32_16x16x32_bf16 v[228:231], a[228:231], a[188:191], v[228:231]
 v_mul_f32 v5, v5, v87
 v_cvt_pk_bf16_f32 v13, v6, v5
 v_mfma_f32_16x16x32_bf16 v[228:231], a[224:227], a[184:187], v[228:231]
 v_accvgpr_read_b32 v5, a38
 v_lshlrev_b32 v6, 16, v5
 s_waitcnt vmcnt(11)
 v_mfma_f32_16x16x32_bf16 a[252:255], a[232:235], a[184:187], a[252:255]
 ds_read_b128 a[184:187], v1 offset:63488
 v_and_b32 v5, s26, v5
 v_mfma_f32_16x16x32_bf16 a[252:255], a[236:239], a[188:191], a[252:255]
 global_load_dwordx4 a[228:231], v0, s[70:71] offset:-3072 sc1
 ds_read_b128 a[188:191], v1 offset:64512
 v_mfma_f32_16x16x32_bf16 a[248:251], a[236:239], a[180:183], a[248:251]
 ds_read_b128 a[180:183], v1 offset:60416
 v_mul_f32 v6, v6, v116
 v_mfma_f32_16x16x32_bf16 a[248:251], a[232:235], a[176:179], a[248:251]
 global_load_dwordx4 a[224:227], v0, s[70:71] offset:-4096 sc1
 ds_read_b128 a[176:179], v1 offset:59392
 v_mul_f32 v5, v5, v117
 v_mfma_f32_16x16x32_bf16 v[252:255], a[232:235], a[168:171], v[252:255]
 ds_read_b128 a[168:171], v1 offset:55296
 v_cvt_pk_bf16_f32 v14, v6, v5
 v_accvgpr_read_b32 v5, a39
 v_mfma_f32_16x16x32_bf16 v[252:255], a[236:239], a[172:175], v[252:255]
 ds_read_b128 a[172:175], v1 offset:56320
 v_lshlrev_b32 v6, 16, v5
 v_mfma_f32_16x16x32_bf16 v[248:251], a[236:239], a[164:167], v[248:251]
 ds_read_b128 a[164:167], v1 offset:52224
 v_and_b32 v5, s26, v5
 v_mul_f32 v6, v6, v118
 v_mfma_f32_16x16x32_bf16 v[248:251], a[232:235], a[160:163], v[248:251]
 ds_read_b128 a[160:163], v1 offset:51200
 v_mul_f32 v5, v5, v119
 v_cvt_pk_bf16_f32 v15, v6, v5
 v_mfma_f32_16x16x32_bf16 v[244:247], a[232:235], a[152:155], v[244:247]
 ds_read_b128 a[152:155], v1 offset:47104
 ds_write_b128 v3, v[12:15] offset:5120
 v_mfma_f32_16x16x32_bf16 v[244:247], a[236:239], a[156:159], v[244:247]
 buffer_store_dwordx4 v[12:15], v3, s[32:35], s68 offen offset:3072 sc1
 ds_read_b128 a[156:159], v1 offset:48128
 v_accvgpr_read_b32 v5, a8
 v_lshlrev_b32 v6, 16, v5
 v_and_b32 v5, s26, v5
 v_mfma_f32_16x16x32_bf16 v[240:243], a[236:239], a[148:151], v[240:243]
 ds_read_b128 a[148:151], v1 offset:44032
 v_mul_f32 v6, v6, v24
 v_mfma_f32_16x16x32_bf16 v[240:243], a[232:235], a[144:147], v[240:243]
 ds_read_b128 a[144:147], v1 offset:43008
 v_mul_f32 v5, v5, v25
 v_cvt_pk_bf16_f32 v8, v6, v5
 v_mfma_f32_16x16x32_bf16 v[236:239], a[232:235], a[136:139], v[236:239]
 ds_read_b128 a[136:139], v1 offset:38912
 v_accvgpr_read_b32 v5, a9
 v_mfma_f32_16x16x32_bf16 v[236:239], a[236:239], a[140:143], v[236:239]
 ds_read_b128 a[140:143], v1 offset:39936
 v_lshlrev_b32 v6, 16, v5
 v_mfma_f32_16x16x32_bf16 v[232:235], a[236:239], a[132:135], v[232:235]
 ds_read_b128 a[132:135], v1 offset:35840
 v_and_b32 v5, s26, v5
 v_mfma_f32_16x16x32_bf16 v[232:235], a[232:235], a[128:131], v[232:235]
 ds_read_b128 a[128:131], v1 offset:34816
 v_mul_f32 v6, v6, v26
 s_waitcnt vmcnt(12) lgkmcnt(9)
 v_mfma_f32_16x16x32_bf16 v[164:167], a[192:195], a[184:187], v[164:167]
 v_mul_f32 v5, v5, v27
 v_cvt_pk_bf16_f32 v9, v6, v5
 v_mfma_f32_16x16x32_bf16 v[164:167], a[196:199], a[188:191], v[164:167]
 global_load_dwordx4 a[236:239], v0, s[70:71] offset:-1024 sc1
 v_accvgpr_read_b32 v5, a10
 v_mfma_f32_16x16x32_bf16 v[160:163], a[196:199], a[180:183], v[160:163]
 v_lshlrev_b32 v6, 16, v5
 v_and_b32 v5, s26, v5
 v_mfma_f32_16x16x32_bf16 v[160:163], a[192:195], a[176:179], v[160:163]
 global_load_dwordx4 a[232:235], v0, s[70:71] offset:-2048 sc1
 v_mul_f32 v6, v6, v56
 v_mfma_f32_16x16x32_bf16 v[156:159], a[192:195], a[168:171], v[156:159]
 v_mul_f32 v5, v5, v57
 v_cvt_pk_bf16_f32 v10, v6, v5
 v_mfma_f32_16x16x32_bf16 v[156:159], a[196:199], a[172:175], v[156:159]
 v_accvgpr_read_b32 v5, a11
 v_lshlrev_b32 v6, 16, v5
 v_mfma_f32_16x16x32_bf16 v[152:155], a[196:199], a[164:167], v[152:155]
 v_and_b32 v5, s26, v5
 v_mul_f32 v6, v6, v58
 v_mfma_f32_16x16x32_bf16 v[152:155], a[192:195], a[160:163], v[152:155]
 v_mul_f32 v5, v5, v59
 v_cvt_pk_bf16_f32 v11, v6, v5
 s_waitcnt lgkmcnt(0)
 v_mfma_f32_16x16x32_bf16 v[148:151], a[192:195], a[152:155], v[148:151]
 ds_write_b128 v3, v[8:11] offset:8192
 s_add_u32 s68, s29, 4096
 v_mfma_f32_16x16x32_bf16 v[148:151], a[196:199], a[156:159], v[148:151]
 buffer_store_dwordx4 v[8:11], v3, s[32:35], s68 offen sc1
 v_accvgpr_read_b32 v5, a40
 v_lshlrev_b32 v6, 16, v5
 v_and_b32 v5, s26, v5
 v_mul_f32 v6, v6, v88
 v_mfma_f32_16x16x32_bf16 v[144:147], a[196:199], a[148:151], v[144:147]
 v_mul_f32 v5, v5, v89
 v_cvt_pk_bf16_f32 v12, v6, v5
 v_mfma_f32_16x16x32_bf16 v[144:147], a[192:195], a[144:147], v[144:147]
 v_accvgpr_read_b32 v5, a41
 v_lshlrev_b32 v6, 16, v5
 v_mfma_f32_16x16x32_bf16 v[140:143], a[192:195], a[136:139], v[140:143]
 v_and_b32 v5, s26, v5
 v_mul_f32 v6, v6, v90
 v_mfma_f32_16x16x32_bf16 v[140:143], a[196:199], a[140:143], v[140:143]
 v_mul_f32 v5, v5, v91
 v_cvt_pk_bf16_f32 v13, v6, v5
 v_mfma_f32_16x16x32_bf16 v[136:139], a[196:199], a[132:135], v[136:139]
 v_accvgpr_read_b32 v5, a42
 v_lshlrev_b32 v6, 16, v5
 v_mfma_f32_16x16x32_bf16 v[136:139], a[192:195], a[128:131], v[136:139]
 v_and_b32 v5, s26, v5
 v_mul_f32 v6, v6, v120
 s_waitcnt vmcnt(13)
 v_mfma_f32_16x16x32_bf16 v[168:171], a[200:203], a[128:131], v[168:171]
 v_mul_f32 v5, v5, v121
 v_cvt_pk_bf16_f32 v14, v6, v5
 v_mfma_f32_16x16x32_bf16 v[168:171], a[204:207], a[132:135], v[168:171]
 global_load_dwordx4 a[196:199], v0, s[70:71] offset:1024 sc1
 v_accvgpr_read_b32 v5, a43
 v_mfma_f32_16x16x32_bf16 v[172:175], a[204:207], a[140:143], v[172:175]
 v_lshlrev_b32 v6, 16, v5
 v_and_b32 v5, s26, v5
 v_mfma_f32_16x16x32_bf16 v[172:175], a[200:203], a[136:139], v[172:175]
 global_load_dwordx4 a[192:195], v0, s[70:71] offset:0 sc1
 v_mul_f32 v6, v6, v122
 v_mfma_f32_16x16x32_bf16 v[176:179], a[200:203], a[144:147], v[176:179]
 v_mul_f32 v5, v5, v123
 v_cvt_pk_bf16_f32 v15, v6, v5
 v_mfma_f32_16x16x32_bf16 v[176:179], a[204:207], a[148:151], v[176:179]
 ds_write_b128 v3, v[12:15] offset:9216
 v_mfma_f32_16x16x32_bf16 v[180:183], a[204:207], a[156:159], v[180:183]
 v_lshlrev_b32 v4, 2, v3
 v_and_b32 v4, 192, v4
 v_mfma_f32_16x16x32_bf16 v[180:183], a[200:203], a[152:155], v[180:183]
 buffer_load_dword v4, v4, s[44:47], 0 offen sc1
 v_mfma_f32_16x16x32_bf16 v[184:187], a[200:203], a[160:163], v[184:187]
 buffer_store_dwordx4 v[12:15], v3, s[32:35], s68 offen offset:1024 sc1
 v_accvgpr_read_b32 v5, a12
 v_lshlrev_b32 v6, 16, v5
 v_and_b32 v5, s26, v5
 v_mul_f32 v6, v6, v28
 v_mfma_f32_16x16x32_bf16 v[184:187], a[204:207], a[164:167], v[184:187]
 v_mul_f32 v5, v5, v29
 v_cvt_pk_bf16_f32 v8, v6, v5
 v_mfma_f32_16x16x32_bf16 v[188:191], a[204:207], a[172:175], v[188:191]
 v_accvgpr_read_b32 v5, a13
 v_lshlrev_b32 v6, 16, v5
 v_mfma_f32_16x16x32_bf16 v[188:191], a[200:203], a[168:171], v[188:191]
 v_and_b32 v5, s26, v5
 v_mul_f32 v6, v6, v30
 v_mfma_f32_16x16x32_bf16 v[192:195], a[200:203], a[176:179], v[192:195]
 v_mul_f32 v5, v5, v31
 v_cvt_pk_bf16_f32 v9, v6, v5
 v_mfma_f32_16x16x32_bf16 v[192:195], a[204:207], a[180:183], v[192:195]
 v_accvgpr_read_b32 v5, a14
 v_lshlrev_b32 v6, 16, v5
 v_mfma_f32_16x16x32_bf16 v[196:199], a[204:207], a[188:191], v[196:199]
 v_and_b32 v5, s26, v5
 v_mul_f32 v6, v6, v60
 v_mfma_f32_16x16x32_bf16 v[196:199], a[200:203], a[184:187], v[196:199]
 v_mul_f32 v5, v5, v61
 v_cvt_pk_bf16_f32 v10, v6, v5
 s_waitcnt vmcnt(14)
 v_mfma_f32_16x16x32_bf16 v[228:231], a[208:211], a[184:187], v[228:231]
 v_accvgpr_read_b32 v5, a15
 v_lshlrev_b32 v6, 16, v5
 v_mfma_f32_16x16x32_bf16 v[228:231], a[212:215], a[188:191], v[228:231]
 global_load_dwordx4 a[204:207], v0, s[70:71] offset:3072 sc1
 v_and_b32 v5, s26, v5
 v_mfma_f32_16x16x32_bf16 v[224:227], a[212:215], a[180:183], v[224:227]
 v_mul_f32 v6, v6, v62
 v_mul_f32 v5, v5, v63
 v_mfma_f32_16x16x32_bf16 v[224:227], a[208:211], a[176:179], v[224:227]
 global_load_dwordx4 a[200:203], v0, s[70:71] offset:2048 sc1
 v_cvt_pk_bf16_f32 v11, v6, v5
 v_mfma_f32_16x16x32_bf16 v[220:223], a[208:211], a[168:171], v[220:223]
 ds_write_b128 v3, v[8:11] offset:12288
 s_add_u32 s70, s70, 8192
 s_addc_u32 s71, s71, 0
 v_mfma_f32_16x16x32_bf16 v[220:223], a[212:215], a[172:175], v[220:223]
 buffer_store_dwordx4 v[8:11], v3, s[32:35], s68 offen offset:2048 sc1
 v_accvgpr_read_b32 v5, a44
 v_lshlrev_b32 v6, 16, v5
 v_and_b32 v5, s26, v5
 v_mfma_f32_16x16x32_bf16 v[216:219], a[212:215], a[164:167], v[216:219]
 v_mul_f32 v6, v6, v92
 v_mul_f32 v5, v5, v93
 v_mfma_f32_16x16x32_bf16 v[216:219], a[208:211], a[160:163], v[216:219]
 v_cvt_pk_bf16_f32 v12, v6, v5
 v_accvgpr_read_b32 v5, a45
 v_mfma_f32_16x16x32_bf16 v[212:215], a[208:211], a[152:155], v[212:215]
 v_lshlrev_b32 v6, 16, v5
 v_and_b32 v5, s26, v5
 v_mfma_f32_16x16x32_bf16 v[212:215], a[212:215], a[156:159], v[212:215]
 v_mul_f32 v6, v6, v94
 v_mul_f32 v5, v5, v95
 v_mfma_f32_16x16x32_bf16 v[208:211], a[212:215], a[148:151], v[208:211]
 v_cvt_pk_bf16_f32 v13, v6, v5
 v_accvgpr_read_b32 v5, a46
 v_mfma_f32_16x16x32_bf16 v[208:211], a[208:211], a[144:147], v[208:211]
 v_lshlrev_b32 v6, 16, v5
 v_and_b32 v5, s26, v5
 v_mfma_f32_16x16x32_bf16 v[204:207], a[208:211], a[136:139], v[204:207]
 v_mul_f32 v6, v6, v124
 v_mul_f32 v5, v5, v125
 v_mfma_f32_16x16x32_bf16 v[204:207], a[212:215], a[140:143], v[204:207]
 v_cvt_pk_bf16_f32 v14, v6, v5
 v_accvgpr_read_b32 v5, a47
 v_mfma_f32_16x16x32_bf16 v[200:203], a[212:215], a[132:135], v[200:203]
 v_lshlrev_b32 v6, 16, v5
 v_and_b32 v5, s26, v5
 v_mfma_f32_16x16x32_bf16 v[200:203], a[208:211], a[128:131], v[200:203]
 v_mul_f32 v6, v6, v126
 v_mul_f32 v5, v5, v127
 s_waitcnt vmcnt(14)
 v_mfma_f32_16x16x32_bf16 v[232:235], a[216:219], a[128:131], v[232:235]
 ds_read_b128 a[128:131], v2 offset:2048
 v_cvt_pk_bf16_f32 v15, v6, v5
 v_mfma_f32_16x16x32_bf16 v[232:235], a[220:223], a[132:135], v[232:235]
 global_load_dwordx4 a[212:215], v0, s[70:71] offset:-3072 sc1
 ds_read_b128 a[132:135], v2 offset:3072
 v_mfma_f32_16x16x32_bf16 v[236:239], a[220:223], a[140:143], v[236:239]
 ds_read_b128 a[140:143], v2 offset:7168
 ds_write_b128 v3, v[12:15] offset:13312
 v_mfma_f32_16x16x32_bf16 v[236:239], a[216:219], a[136:139], v[236:239]
 global_load_dwordx4 a[208:211], v0, s[70:71] offset:-4096 sc1
 ds_read_b128 a[136:139], v2 offset:6144
 v_mfma_f32_16x16x32_bf16 v[240:243], a[216:219], a[144:147], v[240:243]
 buffer_store_dwordx4 v[12:15], v3, s[32:35], s68 offen offset:3072 sc1
 ds_read_b128 a[144:147], v2 offset:10240
 v_accvgpr_read_b32 v5, a16
 v_lshlrev_b32 v6, 16, v5
 v_and_b32 v5, s26, v5
 v_mfma_f32_16x16x32_bf16 v[240:243], a[220:223], a[148:151], v[240:243]
 ds_read_b128 a[148:151], v2 offset:11264
 v_mul_f32 v6, v6, v32
 v_mfma_f32_16x16x32_bf16 v[244:247], a[220:223], a[156:159], v[244:247]
 ds_read_b128 a[156:159], v2 offset:15360
 v_mul_f32 v5, v5, v33
 v_cvt_pk_bf16_f32 v8, v6, v5
 v_mfma_f32_16x16x32_bf16 v[244:247], a[216:219], a[152:155], v[244:247]
 ds_read_b128 a[152:155], v2 offset:14336
 v_accvgpr_read_b32 v5, a17
 v_lshlrev_b32 v6, 16, v5
 v_mfma_f32_16x16x32_bf16 v[248:251], a[216:219], a[160:163], v[248:251]
 ds_read_b128 a[160:163], v2 offset:18432
 v_and_b32 v5, s26, v5
 v_mul_f32 v6, v6, v34
 v_mfma_f32_16x16x32_bf16 v[248:251], a[220:223], a[164:167], v[248:251]
 ds_read_b128 a[164:167], v2 offset:19456
 v_mul_f32 v5, v5, v35
 v_cvt_pk_bf16_f32 v9, v6, v5
 v_mfma_f32_16x16x32_bf16 v[252:255], a[220:223], a[172:175], v[252:255]
 ds_read_b128 a[172:175], v2 offset:23552
 v_accvgpr_read_b32 v5, a18
 v_mfma_f32_16x16x32_bf16 v[252:255], a[216:219], a[168:171], v[252:255]
 ds_read_b128 a[168:171], v2 offset:22528
 v_lshlrev_b32 v6, 16, v5
 v_mfma_f32_16x16x32_bf16 a[248:251], a[216:219], a[176:179], a[248:251]
 ds_read_b128 a[176:179], v2 offset:26624
 v_and_b32 v5, s26, v5
 v_mfma_f32_16x16x32_bf16 a[248:251], a[220:223], a[180:183], a[248:251]
 ds_read_b128 a[180:183], v2 offset:27648
 v_mul_f32 v6, v6, v64
 v_mfma_f32_16x16x32_bf16 a[252:255], a[220:223], a[188:191], a[252:255]
 ds_read_b128 a[188:191], v2 offset:31744
 v_mul_f32 v5, v5, v65
 v_mfma_f32_16x16x32_bf16 a[252:255], a[216:219], a[184:187], a[252:255]
 ds_read_b128 a[184:187], v2 offset:30720
 v_cvt_pk_bf16_f32 v10, v6, v5
 s_waitcnt vmcnt(14) lgkmcnt(8)
 v_mfma_f32_16x16x32_bf16 v[136:139], a[224:227], a[128:131], v[136:139]
 v_accvgpr_read_b32 v5, a19
 v_lshlrev_b32 v6, 16, v5
 v_mfma_f32_16x16x32_bf16 v[136:139], a[228:231], a[132:135], v[136:139]
 global_load_dwordx4 a[220:223], v0, s[70:71] offset:-1024 sc1
 v_and_b32 v5, s26, v5
 v_mfma_f32_16x16x32_bf16 v[140:143], a[228:231], a[140:143], v[140:143]
 v_mul_f32 v6, v6, v66
 v_mul_f32 v5, v5, v67
 v_mfma_f32_16x16x32_bf16 v[140:143], a[224:227], a[136:139], v[140:143]
 global_load_dwordx4 a[216:219], v0, s[70:71] offset:-2048 sc1
 v_cvt_pk_bf16_f32 v11, v6, v5
 v_mfma_f32_16x16x32_bf16 v[144:147], a[224:227], a[144:147], v[144:147]
 ds_write_b128 v3, v[8:11] offset:16384
 s_add_u32 s68, s29, 8192
 v_mfma_f32_16x16x32_bf16 v[144:147], a[228:231], a[148:151], v[144:147]
 buffer_store_dwordx4 v[8:11], v3, s[32:35], s68 offen sc1
 v_accvgpr_read_b32 v5, a48
 v_lshlrev_b32 v6, 16, v5
 v_and_b32 v5, s26, v5
 v_mul_f32 v6, v6, v96
 v_mfma_f32_16x16x32_bf16 v[148:151], a[228:231], a[156:159], v[148:151]
 v_mul_f32 v5, v5, v97
 v_cvt_pk_bf16_f32 v12, v6, v5
 v_mfma_f32_16x16x32_bf16 v[148:151], a[224:227], a[152:155], v[148:151]
 v_accvgpr_read_b32 v5, a49
 v_lshlrev_b32 v6, 16, v5
 s_waitcnt lgkmcnt(1)
 v_mfma_f32_16x16x32_bf16 v[152:155], a[224:227], a[160:163], v[152:155]
 v_and_b32 v5, s26, v5
 v_mul_f32 v6, v6, v98
 v_mfma_f32_16x16x32_bf16 v[152:155], a[228:231], a[164:167], v[152:155]
 v_mul_f32 v5, v5, v99
 v_cvt_pk_bf16_f32 v13, v6, v5
 v_mfma_f32_16x16x32_bf16 v[156:159], a[228:231], a[172:175], v[156:159]
 v_accvgpr_read_b32 v5, a50
 v_lshlrev_b32 v6, 16, v5
 v_mfma_f32_16x16x32_bf16 v[156:159], a[224:227], a[168:171], v[156:159]
 v_and_b32 v5, s26, v5
 v_mul_f32 v6, v6, v128
 v_mfma_f32_16x16x32_bf16 v[160:163], a[224:227], a[176:179], v[160:163]
 v_mul_f32 v5, v5, v129
 v_cvt_pk_bf16_f32 v14, v6, v5
 v_mfma_f32_16x16x32_bf16 v[160:163], a[228:231], a[180:183], v[160:163]
 v_accvgpr_read_b32 v5, a51
 v_lshlrev_b32 v6, 16, v5
 v_mfma_f32_16x16x32_bf16 v[164:167], a[228:231], a[188:191], v[164:167]
 v_and_b32 v5, s26, v5
 v_mul_f32 v6, v6, v130
 v_mfma_f32_16x16x32_bf16 v[164:167], a[224:227], a[184:187], v[164:167]
 v_mul_f32 v5, v5, v131
 v_cvt_pk_bf16_f32 v15, v6, v5
 s_waitcnt vmcnt(14)
 v_mfma_f32_16x16x32_bf16 v[196:199], a[232:235], a[184:187], v[196:199]
 ds_write_b128 v3, v[12:15] offset:17408
 v_mfma_f32_16x16x32_bf16 v[196:199], a[236:239], a[188:191], v[196:199]
 buffer_store_dwordx4 v[12:15], v3, s[32:35], s68 offen offset:1024 sc1
 global_load_dwordx4 a[228:231], v0, s[70:71] offset:1024 sc1
 v_accvgpr_read_b32 v5, a20
 v_lshlrev_b32 v6, 16, v5
 v_and_b32 v5, s26, v5
 v_mfma_f32_16x16x32_bf16 v[192:195], a[236:239], a[180:183], v[192:195]
 v_mul_f32 v6, v6, v36
 v_mul_f32 v5, v5, v37
 v_mfma_f32_16x16x32_bf16 v[192:195], a[232:235], a[176:179], v[192:195]
 global_load_dwordx4 a[224:227], v0, s[70:71] offset:0 sc1
 v_cvt_pk_bf16_f32 v8, v6, v5
 v_mfma_f32_16x16x32_bf16 v[188:191], a[232:235], a[168:171], v[188:191]
 v_accvgpr_read_b32 v5, a21
 v_lshlrev_b32 v6, 16, v5
 v_mfma_f32_16x16x32_bf16 v[188:191], a[236:239], a[172:175], v[188:191]
 v_and_b32 v5, s26, v5
 v_mul_f32 v6, v6, v38
 v_mfma_f32_16x16x32_bf16 v[184:187], a[236:239], a[164:167], v[184:187]
 v_mul_f32 v5, v5, v39
 v_cvt_pk_bf16_f32 v9, v6, v5
 v_mfma_f32_16x16x32_bf16 v[184:187], a[232:235], a[160:163], v[184:187]
 v_accvgpr_read_b32 v5, a22
 v_lshlrev_b32 v6, 16, v5
 v_mfma_f32_16x16x32_bf16 v[180:183], a[232:235], a[152:155], v[180:183]
 v_and_b32 v5, s26, v5
 v_mul_f32 v6, v6, v68
 v_mfma_f32_16x16x32_bf16 v[180:183], a[236:239], a[156:159], v[180:183]
 v_mul_f32 v5, v5, v69
 v_cvt_pk_bf16_f32 v10, v6, v5
 v_mfma_f32_16x16x32_bf16 v[176:179], a[236:239], a[148:151], v[176:179]
 v_accvgpr_read_b32 v5, a23
 v_lshlrev_b32 v6, 16, v5
 v_mfma_f32_16x16x32_bf16 v[176:179], a[232:235], a[144:147], v[176:179]
 v_and_b32 v5, s26, v5
 v_mul_f32 v6, v6, v70
 v_mfma_f32_16x16x32_bf16 v[172:175], a[232:235], a[136:139], v[172:175]
 v_mul_f32 v5, v5, v71
 v_cvt_pk_bf16_f32 v11, v6, v5
 v_mfma_f32_16x16x32_bf16 v[172:175], a[236:239], a[140:143], v[172:175]
 ds_write_b128 v3, v[8:11] offset:20480
 v_mfma_f32_16x16x32_bf16 v[168:171], a[236:239], a[132:135], v[168:171]
 buffer_store_dwordx4 v[8:11], v3, s[32:35], s68 offen offset:2048 sc1
 v_accvgpr_read_b32 v5, a52
 v_lshlrev_b32 v6, 16, v5
 v_and_b32 v5, s26, v5
 v_mfma_f32_16x16x32_bf16 v[168:171], a[232:235], a[128:131], v[168:171]
 v_mul_f32 v6, v6, v100
 v_mul_f32 v5, v5, v101
 s_waitcnt vmcnt(15)
 v_mfma_f32_16x16x32_bf16 v[200:203], a[192:195], a[128:131], v[200:203]
 v_cvt_pk_bf16_f32 v12, v6, v5
 v_accvgpr_read_b32 v5, a53
 v_mfma_f32_16x16x32_bf16 v[200:203], a[196:199], a[132:135], v[200:203]
 global_load_dwordx4 a[236:239], v0, s[70:71] offset:3072 sc1
 v_lshlrev_b32 v6, 16, v5
 v_mfma_f32_16x16x32_bf16 v[204:207], a[196:199], a[140:143], v[204:207]
 v_and_b32 v5, s26, v5
 s_waitcnt vmcnt(15)
 v_cmp_gt_i32 vcc, s27, v4
 s_and_b64 vcc, exec, vcc
 s_cbranch_vccnz Lspin_w
Lok_w:
 s_add_u32 s27, s27, 64
 v_mfma_f32_16x16x32_bf16 v[204:207], a[192:195], a[136:139], v[204:207]
 global_load_dwordx4 a[232:235], v0, s[70:71] offset:2048 sc1
 v_mul_f32 v6, v6, v102
 v_mfma_f32_16x16x32_bf16 v[208:211], a[192:195], a[144:147], v[208:211]
 v_mul_f32 v5, v5, v103
 v_cvt_pk_bf16_f32 v13, v6, v5
 s_add_u32 s70, s70, 1843200
 s_addc_u32 s71, s71, 0
 v_mfma_f32_16x16x32_bf16 v[208:211], a[196:199], a[148:151], v[208:211]
 v_accvgpr_read_b32 v5, a54
 v_lshlrev_b32 v6, 16, v5
 v_mfma_f32_16x16x32_bf16 v[212:215], a[196:199], a[156:159], v[212:215]
 v_and_b32 v5, s26, v5
 v_mul_f32 v6, v6, v132
 v_mfma_f32_16x16x32_bf16 v[212:215], a[192:195], a[152:155], v[212:215]
 v_mul_f32 v5, v5, v133
 v_cvt_pk_bf16_f32 v14, v6, v5
 v_mfma_f32_16x16x32_bf16 v[216:219], a[192:195], a[160:163], v[216:219]
 v_accvgpr_read_b32 v5, a55
 v_lshlrev_b32 v6, 16, v5
 v_mfma_f32_16x16x32_bf16 v[216:219], a[196:199], a[164:167], v[216:219]
 v_and_b32 v5, s26, v5
 v_mul_f32 v6, v6, v134
 v_mfma_f32_16x16x32_bf16 v[220:223], a[196:199], a[172:175], v[220:223]
 v_mul_f32 v5, v5, v135
 v_cvt_pk_bf16_f32 v15, v6, v5
 v_mfma_f32_16x16x32_bf16 v[220:223], a[192:195], a[168:171], v[220:223]
 ds_write_b128 v3, v[12:15] offset:21504
 v_mfma_f32_16x16x32_bf16 v[224:227], a[192:195], a[176:179], v[224:227]
 buffer_store_dwordx4 v[12:15], v3, s[32:35], s68 offen offset:3072 sc1
 v_accvgpr_read_b32 v5, a24
 v_lshlrev_b32 v6, 16, v5
 v_and_b32 v5, s26, v5
 v_mul_f32 v6, v6, v40
 v_mfma_f32_16x16x32_bf16 v[224:227], a[196:199], a[180:183], v[224:227]
 v_mul_f32 v5, v5, v41
 v_cvt_pk_bf16_f32 v8, v6, v5
 v_mfma_f32_16x16x32_bf16 v[228:231], a[196:199], a[188:191], v[228:231]
 v_accvgpr_read_b32 v5, a25
 v_lshlrev_b32 v6, 16, v5
 v_mfma_f32_16x16x32_bf16 v[228:231], a[192:195], a[184:187], v[228:231]
 v_and_b32 v5, s26, v5
 v_mul_f32 v6, v6, v42
 s_waitcnt vmcnt(14)
 v_mfma_f32_16x16x32_bf16 a[252:255], a[200:203], a[184:187], a[252:255]
 ds_read_b128 a[184:187], v2 offset:63488
 v_mul_f32 v5, v5, v43
 v_mfma_f32_16x16x32_bf16 a[252:255], a[204:207], a[188:191], a[252:255]
 global_load_dwordx4 a[196:199], v0, s[70:71] offset:-3072 sc1
 ds_read_b128 a[188:191], v2 offset:64512
 v_mfma_f32_16x16x32_bf16 a[248:251], a[204:207], a[180:183], a[248:251]
 ds_read_b128 a[180:183], v2 offset:60416
 v_cvt_pk_bf16_f32 v9, v6, v5
 v_mfma_f32_16x16x32_bf16 a[248:251], a[200:203], a[176:179], a[248:251]
 global_load_dwordx4 a[192:195], v0, s[70:71] offset:-4096 sc1
 ds_read_b128 a[176:179], v2 offset:59392
 v_accvgpr_read_b32 v5, a26
 v_lshlrev_b32 v6, 16, v5
 v_mfma_f32_16x16x32_bf16 v[252:255], a[200:203], a[168:171], v[252:255]
 ds_read_b128 a[168:171], v2 offset:55296
 v_and_b32 v5, s26, v5
 v_mfma_f32_16x16x32_bf16 v[252:255], a[204:207], a[172:175], v[252:255]
 ds_read_b128 a[172:175], v2 offset:56320
 v_mul_f32 v6, v6, v72
 v_mfma_f32_16x16x32_bf16 v[248:251], a[204:207], a[164:167], v[248:251]
 ds_read_b128 a[164:167], v2 offset:52224
 v_mul_f32 v5, v5, v73
 v_mfma_f32_16x16x32_bf16 v[248:251], a[200:203], a[160:163], v[248:251]
 ds_read_b128 a[160:163], v2 offset:51200
 v_cvt_pk_bf16_f32 v10, v6, v5
 v_mfma_f32_16x16x32_bf16 v[244:247], a[200:203], a[152:155], v[244:247]
 ds_read_b128 a[152:155], v2 offset:47104
 v_accvgpr_read_b32 v5, a27
 v_mfma_f32_16x16x32_bf16 v[244:247], a[204:207], a[156:159], v[244:247]
 ds_read_b128 a[156:159], v2 offset:48128
 v_lshlrev_b32 v6, 16, v5
 v_mfma_f32_16x16x32_bf16 v[240:243], a[204:207], a[148:151], v[240:243]
 ds_read_b128 a[148:151], v2 offset:44032
 v_and_b32 v5, s26, v5
 v_mfma_f32_16x16x32_bf16 v[240:243], a[200:203], a[144:147], v[240:243]
 ds_read_b128 a[144:147], v2 offset:43008
 v_mul_f32 v6, v6, v74
 v_mfma_f32_16x16x32_bf16 v[236:239], a[200:203], a[136:139], v[236:239]
 ds_read_b128 a[136:139], v2 offset:38912
 v_mul_f32 v5, v5, v75
 v_mfma_f32_16x16x32_bf16 v[236:239], a[204:207], a[140:143], v[236:239]
 ds_read_b128 a[140:143], v2 offset:39936
 v_cvt_pk_bf16_f32 v11, v6, v5
 v_mfma_f32_16x16x32_bf16 v[232:235], a[204:207], a[132:135], v[232:235]
 ds_read_b128 a[132:135], v2 offset:35840
 ds_write_b128 v3, v[8:11] offset:24576
 s_add_u32 s68, s29, 12288
 buffer_store_dwordx4 v[8:11], v3, s[32:35], s68 offen sc1
 v_accvgpr_read_b32 v5, a56
 v_lshlrev_b32 v6, 16, v5
 v_and_b32 v5, s26, v5
 v_mul_f32 v6, v6, v104
 v_mfma_f32_16x16x32_bf16 v[232:235], a[200:203], a[128:131], v[232:235]
 ds_read_b128 a[128:131], v2 offset:34816
 v_mul_f32 v5, v5, v105
 v_cvt_pk_bf16_f32 v12, v6, v5
 s_waitcnt vmcnt(14) lgkmcnt(9)
 v_mfma_f32_16x16x32_bf16 v[164:167], a[208:211], a[184:187], v[164:167]
 v_accvgpr_read_b32 v5, a57
 v_lshlrev_b32 v6, 16, v5
 v_mfma_f32_16x16x32_bf16 v[164:167], a[212:215], a[188:191], v[164:167]
 global_load_dwordx4 a[204:207], v0, s[70:71] offset:-1024 sc1
 v_and_b32 v5, s26, v5
 v_mfma_f32_16x16x32_bf16 v[160:163], a[212:215], a[180:183], v[160:163]
 v_mul_f32 v6, v6, v106
 v_mul_f32 v5, v5, v107
 v_mfma_f32_16x16x32_bf16 v[160:163], a[208:211], a[176:179], v[160:163]
 global_load_dwordx4 a[200:203], v0, s[70:71] offset:-2048 sc1
 v_cvt_pk_bf16_f32 v13, v6, v5
 v_mfma_f32_16x16x32_bf16 v[156:159], a[208:211], a[168:171], v[156:159]
 v_accvgpr_read_b32 v5, a58
 v_accvgpr_read_b32 v7, a240
 v_mfma_f32_16x16x32_bf16 v[156:159], a[212:215], a[172:175], v[156:159]
 v_lshlrev_b32 v6, 16, v5
 v_and_b32 v5, s26, v5
 v_mfma_f32_16x16x32_bf16 v[152:155], a[212:215], a[164:167], v[152:155]
 v_mul_f32 v6, v6, v7
 v_accvgpr_read_b32 v7, a241
 v_mfma_f32_16x16x32_bf16 v[152:155], a[208:211], a[160:163], v[152:155]
 v_mul_f32 v5, v5, v7
 v_cvt_pk_bf16_f32 v14, v6, v5
 s_waitcnt lgkmcnt(0)
 v_mfma_f32_16x16x32_bf16 v[148:151], a[208:211], a[152:155], v[148:151]
 v_accvgpr_read_b32 v5, a59
 v_accvgpr_read_b32 v7, a242
 v_mfma_f32_16x16x32_bf16 v[148:151], a[212:215], a[156:159], v[148:151]
 v_lshlrev_b32 v6, 16, v5
 v_and_b32 v5, s26, v5
 v_mfma_f32_16x16x32_bf16 v[144:147], a[212:215], a[148:151], v[144:147]
 v_mul_f32 v6, v6, v7
 v_accvgpr_read_b32 v7, a243
 v_mfma_f32_16x16x32_bf16 v[144:147], a[208:211], a[144:147], v[144:147]
 v_mul_f32 v5, v5, v7
 v_cvt_pk_bf16_f32 v15, v6, v5
 v_mfma_f32_16x16x32_bf16 v[140:143], a[208:211], a[136:139], v[140:143]
 ds_write_b128 v3, v[12:15] offset:25600
 v_mfma_f32_16x16x32_bf16 v[140:143], a[212:215], a[140:143], v[140:143]
 buffer_store_dwordx4 v[12:15], v3, s[32:35], s68 offen offset:1024 sc1
 v_accvgpr_read_b32 v5, a28
 v_lshlrev_b32 v6, 16, v5
 v_and_b32 v5, s26, v5
 v_mul_f32 v6, v6, v44
 v_mfma_f32_16x16x32_bf16 v[136:139], a[212:215], a[132:135], v[136:139]
 v_mul_f32 v5, v5, v45
 v_cvt_pk_bf16_f32 v8, v6, v5
 v_mfma_f32_16x16x32_bf16 v[136:139], a[208:211], a[128:131], v[136:139]
 v_accvgpr_read_b32 v5, a29
 v_lshlrev_b32 v6, 16, v5
 s_waitcnt vmcnt(14)
 v_mfma_f32_16x16x32_bf16 v[168:171], a[216:219], a[128:131], v[168:171]
 v_and_b32 v5, s26, v5
 v_mul_f32 v6, v6, v46
 v_mfma_f32_16x16x32_bf16 v[168:171], a[220:223], a[132:135], v[168:171]
 global_load_dwordx4 a[212:215], v0, s[70:71] offset:1024 sc1
 v_mul_f32 v5, v5, v47
 v_mfma_f32_16x16x32_bf16 v[172:175], a[220:223], a[140:143], v[172:175]
 v_cvt_pk_bf16_f32 v9, v6, v5
 v_accvgpr_read_b32 v5, a30
 v_mfma_f32_16x16x32_bf16 v[172:175], a[216:219], a[136:139], v[172:175]
 global_load_dwordx4 a[208:211], v0, s[70:71] offset:0 sc1
 v_lshlrev_b32 v6, 16, v5
 v_mfma_f32_16x16x32_bf16 v[176:179], a[216:219], a[144:147], v[176:179]
 v_and_b32 v5, s26, v5
 v_mul_f32 v6, v6, v76
 v_mfma_f32_16x16x32_bf16 v[176:179], a[220:223], a[148:151], v[176:179]
 v_mul_f32 v5, v5, v77
 v_cvt_pk_bf16_f32 v10, v6, v5
 v_mfma_f32_16x16x32_bf16 v[180:183], a[220:223], a[156:159], v[180:183]
 v_accvgpr_read_b32 v5, a31
 v_lshlrev_b32 v6, 16, v5
 v_mfma_f32_16x16x32_bf16 v[180:183], a[216:219], a[152:155], v[180:183]
 v_and_b32 v5, s26, v5
 v_mul_f32 v6, v6, v78
 v_mfma_f32_16x16x32_bf16 v[184:187], a[216:219], a[160:163], v[184:187]
 v_mul_f32 v5, v5, v79
 v_cvt_pk_bf16_f32 v11, v6, v5
 v_mfma_f32_16x16x32_bf16 v[184:187], a[220:223], a[164:167], v[184:187]
 ds_write_b128 v3, v[8:11] offset:28672
 v_mfma_f32_16x16x32_bf16 v[188:191], a[220:223], a[172:175], v[188:191]
 buffer_store_dwordx4 v[8:11], v3, s[32:35], s68 offen offset:2048 sc1
 v_accvgpr_read_b32 v5, a60
 v_lshlrev_b32 v6, 16, v5
 v_and_b32 v5, s26, v5
 v_mul_f32 v6, v6, v108
 v_mfma_f32_16x16x32_bf16 v[188:191], a[216:219], a[168:171], v[188:191]
 v_mul_f32 v5, v5, v109
 v_cvt_pk_bf16_f32 v12, v6, v5
 v_mfma_f32_16x16x32_bf16 v[192:195], a[216:219], a[176:179], v[192:195]
 v_accvgpr_read_b32 v5, a61
 v_lshlrev_b32 v6, 16, v5
 v_mfma_f32_16x16x32_bf16 v[192:195], a[220:223], a[180:183], v[192:195]
 v_and_b32 v5, s26, v5
 v_mul_f32 v6, v6, v110
 v_mfma_f32_16x16x32_bf16 v[196:199], a[220:223], a[188:191], v[196:199]
 v_mul_f32 v5, v5, v111
 v_cvt_pk_bf16_f32 v13, v6, v5
 v_mfma_f32_16x16x32_bf16 v[196:199], a[216:219], a[184:187], v[196:199]
 v_accvgpr_read_b32 v5, a62
 v_accvgpr_read_b32 v7, a244
 s_waitcnt vmcnt(13)
 v_mfma_f32_16x16x32_bf16 v[228:231], a[224:227], a[184:187], v[228:231]
 v_lshlrev_b32 v6, 16, v5
 v_and_b32 v5, s26, v5
 v_mfma_f32_16x16x32_bf16 v[228:231], a[228:231], a[188:191], v[228:231]
 global_load_dwordx4 a[220:223], v0, s[70:71] offset:3072 sc1
 v_mul_f32 v6, v6, v7
 v_mfma_f32_16x16x32_bf16 v[224:227], a[228:231], a[180:183], v[224:227]
 v_accvgpr_read_b32 v7, a245
 v_mul_f32 v5, v5, v7
 v_mfma_f32_16x16x32_bf16 v[224:227], a[224:227], a[176:179], v[224:227]
 global_load_dwordx4 a[216:219], v0, s[70:71] offset:2048 sc1
 v_cvt_pk_bf16_f32 v14, v6, v5
 v_mfma_f32_16x16x32_bf16 v[220:223], a[224:227], a[168:171], v[220:223]
 v_accvgpr_read_b32 v5, a63
 v_accvgpr_read_b32 v7, a246
 s_add_u32 s70, s70, 8192
 s_addc_u32 s71, s71, 0
 v_mfma_f32_16x16x32_bf16 v[220:223], a[228:231], a[172:175], v[220:223]
 v_lshlrev_b32 v6, 16, v5
 v_and_b32 v5, s26, v5
 v_mfma_f32_16x16x32_bf16 v[216:219], a[228:231], a[164:167], v[216:219]
 v_mul_f32 v6, v6, v7
 v_accvgpr_read_b32 v7, a247
 v_mfma_f32_16x16x32_bf16 v[216:219], a[224:227], a[160:163], v[216:219]
 v_mul_f32 v5, v5, v7
 v_cvt_pk_bf16_f32 v15, v6, v5
 v_mfma_f32_16x16x32_bf16 v[212:215], a[224:227], a[152:155], v[212:215]
 ds_write_b128 v3, v[12:15] offset:29696
 v_mfma_f32_16x16x32_bf16 v[212:215], a[228:231], a[156:159], v[212:215]
 buffer_store_dwordx4 v[12:15], v3, s[32:35], s68 offen offset:3072 sc1
 v_mfma_f32_16x16x32_bf16 v[208:211], a[228:231], a[148:151], v[208:211]
 s_waitcnt lgkmcnt(0)
 s_barrier
 v_mfma_f32_16x16x32_bf16 v[208:211], a[224:227], a[144:147], v[208:211]
 v_and_b32 v1, 1023, v3
 v_add_u32 v2, 65536, v1
 v_mfma_f32_16x16x32_bf16 v[204:207], a[224:227], a[136:139], v[204:207]
 v_mfma_f32_16x16x32_bf16 v[204:207], a[228:231], a[140:143], v[204:207]
 v_mfma_f32_16x16x32_bf16 v[200:203], a[228:231], a[132:135], v[200:203]
 v_mfma_f32_16x16x32_bf16 v[200:203], a[224:227], a[128:131], v[200:203]
 s_waitcnt vmcnt(13)
 v_mfma_f32_16x16x32_bf16 v[232:235], a[232:235], a[128:131], v[232:235]
 ds_read_b128 a[128:131], v1
 v_mfma_f32_16x16x32_bf16 v[232:235], a[236:239], a[132:135], v[232:235]
 global_load_dwordx4 a[228:231], v0, s[70:71] offset:-3072 sc1
 ds_read_b128 a[132:135], v1 offset:1024
 v_mfma_f32_16x16x32_bf16 v[236:239], a[236:239], a[140:143], v[236:239]
 ds_read_b128 a[140:143], v1 offset:5120
 v_mfma_f32_16x16x32_bf16 v[236:239], a[232:235], a[136:139], v[236:239]
 global_load_dwordx4 a[224:227], v0, s[70:71] offset:-4096 sc1
 ds_read_b128 a[136:139], v1 offset:4096
 v_mfma_f32_16x16x32_bf16 v[240:243], a[232:235], a[144:147], v[240:243]
 ds_read_b128 a[144:147], v1 offset:8192
 v_mfma_f32_16x16x32_bf16 v[240:243], a[236:239], a[148:151], v[240:243]
 ds_read_b128 a[148:151], v1 offset:9216
 v_mfma_f32_16x16x32_bf16 v[244:247], a[236:239], a[156:159], v[244:247]
 ds_read_b128 a[156:159], v1 offset:13312
 v_mfma_f32_16x16x32_bf16 v[244:247], a[232:235], a[152:155], v[244:247]
 ds_read_b128 a[152:155], v1 offset:12288
 v_mfma_f32_16x16x32_bf16 v[248:251], a[232:235], a[160:163], v[248:251]
 ds_read_b128 a[160:163], v1 offset:16384
 v_mfma_f32_16x16x32_bf16 v[248:251], a[236:239], a[164:167], v[248:251]
 ds_read_b128 a[164:167], v1 offset:17408
 v_mfma_f32_16x16x32_bf16 v[252:255], a[236:239], a[172:175], v[252:255]
 ds_read_b128 a[172:175], v1 offset:21504
 v_mfma_f32_16x16x32_bf16 v[252:255], a[232:235], a[168:171], v[252:255]
 ds_read_b128 a[168:171], v1 offset:20480
 v_mfma_f32_16x16x32_bf16 a[248:251], a[232:235], a[176:179], a[248:251]
 ds_read_b128 a[176:179], v1 offset:24576
 v_mfma_f32_16x16x32_bf16 a[248:251], a[236:239], a[180:183], a[248:251]
 ds_read_b128 a[180:183], v1 offset:25600
 v_mfma_f32_16x16x32_bf16 a[252:255], a[236:239], a[188:191], a[252:255]
 global_load_dwordx4 a[236:239], v0, s[70:71] offset:-1024 sc1
 ds_read_b128 a[188:191], v1 offset:29696
 v_mfma_f32_16x16x32_bf16 a[252:255], a[232:235], a[184:187], a[252:255]
 global_load_dwordx4 a[232:235], v0, s[70:71] offset:-2048 sc1
 ds_read_b128 a[184:187], v1 offset:28672
 s_waitcnt vmcnt(14) lgkmcnt(8)
 v_mfma_f32_16x16x32_bf16 v[16:19], a[192:195], a[128:131], v[16:19]
 v_accvgpr_read_b32 v5, a64
 v_lshlrev_b32 v6, 16, v5
 v_mfma_f32_16x16x32_bf16 v[16:19], a[196:199], a[132:135], v[16:19]
 v_and_b32 v5, s26, v5
 v_mfma_f32_16x16x32_bf16 v[20:23], a[196:199], a[140:143], v[20:23]
 v_mul_f32 v6, v6, v136
 v_mul_f32 v5, v5, v137
 v_mfma_f32_16x16x32_bf16 v[20:23], a[192:195], a[136:139], v[20:23]
 v_cvt_pk_bf16_f32 v8, v6, v5
 v_accvgpr_read_b32 v5, a65
 v_mfma_f32_16x16x32_bf16 v[24:27], a[192:195], a[144:147], v[24:27]
 v_lshlrev_b32 v6, 16, v5
 v_mfma_f32_16x16x32_bf16 v[24:27], a[196:199], a[148:151], v[24:27]
 v_and_b32 v5, s26, v5
 v_mul_f32 v6, v6, v138
 v_mfma_f32_16x16x32_bf16 v[28:31], a[196:199], a[156:159], v[28:31]
 v_mul_f32 v5, v5, v139
 v_cvt_pk_bf16_f32 v9, v6, v5
 v_mfma_f32_16x16x32_bf16 v[28:31], a[192:195], a[152:155], v[28:31]
 v_accvgpr_read_b32 v5, a66
 v_lshlrev_b32 v6, 16, v5
 s_waitcnt lgkmcnt(0)
 v_mfma_f32_16x16x32_bf16 v[32:35], a[192:195], a[160:163], v[32:35]
 v_and_b32 v5, s26, v5
 v_mul_f32 v6, v6, v168
 v_mfma_f32_16x16x32_bf16 v[32:35], a[196:199], a[164:167], v[32:35]
 v_mul_f32 v5, v5, v169
 v_cvt_pk_bf16_f32 v10, v6, v5
 v_mfma_f32_16x16x32_bf16 v[36:39], a[196:199], a[172:175], v[36:39]
 v_accvgpr_read_b32 v5, a67
 v_lshlrev_b32 v6, 16, v5
 v_mfma_f32_16x16x32_bf16 v[36:39], a[192:195], a[168:171], v[36:39]
 v_and_b32 v5, s26, v5
 v_mul_f32 v6, v6, v170
 v_mfma_f32_16x16x32_bf16 v[40:43], a[192:195], a[176:179], v[40:43]
 v_mul_f32 v5, v5, v171
 v_cvt_pk_bf16_f32 v11, v6, v5
 v_mfma_f32_16x16x32_bf16 v[40:43], a[196:199], a[180:183], v[40:43]
 ds_write_b128 v3, v[8:11] offset:2048
 v_mfma_f32_16x16x32_bf16 v[44:47], a[196:199], a[188:191], v[44:47]
 s_add_u32 s68, s29, 16384
 buffer_store_dwordx4 v[8:11], v3, s[32:35], s68 offen sc1
 v_mfma_f32_16x16x32_bf16 v[44:47], a[192:195], a[184:187], v[44:47]
 v_accvgpr_read_b32 v5, a96
 s_waitcnt vmcnt(12)
 v_mfma_f32_16x16x32_bf16 v[76:79], a[200:203], a[184:187], v[76:79]
 v_lshlrev_b32 v6, 16, v5
 v_mfma_f32_16x16x32_bf16 v[76:79], a[204:207], a[188:191], v[76:79]
 global_load_dwordx4 a[196:199], v0, s[70:71] offset:1024 sc1
 v_and_b32 v5, s26, v5
 v_mfma_f32_16x16x32_bf16 v[72:75], a[204:207], a[180:183], v[72:75]
 v_mul_f32 v6, v6, v200
 v_mul_f32 v5, v5, v201
 v_mfma_f32_16x16x32_bf16 v[72:75], a[200:203], a[176:179], v[72:75]
 global_load_dwordx4 a[192:195], v0, s[70:71] offset:0 sc1
 v_cvt_pk_bf16_f32 v12, v6, v5
 v_mfma_f32_16x16x32_bf16 v[68:71], a[200:203], a[168:171], v[68:71]
 v_accvgpr_read_b32 v5, a97
 v_lshlrev_b32 v6, 16, v5
 v_mfma_f32_16x16x32_bf16 v[68:71], a[204:207], a[172:175], v[68:71]
 v_and_b32 v5, s26, v5
 v_mul_f32 v6, v6, v202
 v_mfma_f32_16x16x32_bf16 v[64:67], a[204:207], a[164:167], v[64:67]
 v_mul_f32 v5, v5, v203
 v_cvt_pk_bf16_f32 v13, v6, v5
 v_mfma_f32_16x16x32_bf16 v[64:67], a[200:203], a[160:163], v[64:67]
 v_accvgpr_read_b32 v5, a98
 v_lshlrev_b32 v6, 16, v5
 v_mfma_f32_16x16x32_bf16 v[60:63], a[200:203], a[152:155], v[60:63]
 v_and_b32 v5, s26, v5
 v_mul_f32 v6, v6, v232
 v_mfma_f32_16x16x32_bf16 v[60:63], a[204:207], a[156:159], v[60:63]
 v_mul_f32 v5, v5, v233
 v_cvt_pk_bf16_f32 v14, v6, v5
 v_mfma_f32_16x16x32_bf16 v[56:59], a[204:207], a[148:151], v[56:59]
 v_accvgpr_read_b32 v5, a99
 v_lshlrev_b32 v6, 16, v5
 v_mfma_f32_16x16x32_bf16 v[56:59], a[200:203], a[144:147], v[56:59]
 v_and_b32 v5, s26, v5
 v_mul_f32 v6, v6, v234
 v_mfma_f32_16x16x32_bf16 v[52:55], a[200:203], a[136:139], v[52:55]
 v_mul_f32 v5, v5, v235
 v_cvt_pk_bf16_f32 v15, v6, v5
 v_mfma_f32_16x16x32_bf16 v[52:55], a[204:207], a[140:143], v[52:55]
 ds_write_b128 v3, v[12:15] offset:3072
 v_mfma_f32_16x16x32_bf16 v[48:51], a[204:207], a[132:135], v[48:51]
 buffer_store_dwordx4 v[12:15], v3, s[32:35], s68 offen offset:1024 sc1
 v_mfma_f32_16x16x32_bf16 v[48:51], a[200:203], a[128:131], v[48:51]
 v_accvgpr_read_b32 v5, a68
 v_lshlrev_b32 v6, 16, v5
 s_waitcnt vmcnt(12)
 v_mfma_f32_16x16x32_bf16 v[80:83], a[208:211], a[128:131], v[80:83]
 v_and_b32 v5, s26, v5
 v_mul_f32 v6, v6, v140
 v_mfma_f32_16x16x32_bf16 v[80:83], a[212:215], a[132:135], v[80:83]
 global_load_dwordx4 a[204:207], v0, s[70:71] offset:3072 sc1
 v_mul_f32 v5, v5, v141
 v_mfma_f32_16x16x32_bf16 v[84:87], a[212:215], a[140:143], v[84:87]
 v_cvt_pk_bf16_f32 v8, v6, v5
 v_accvgpr_read_b32 v5, a69
 v_mfma_f32_16x16x32_bf16 v[84:87], a[208:211], a[136:139], v[84:87]
 global_load_dwordx4 a[200:203], v0, s[70:71] offset:2048 sc1
 v_lshlrev_b32 v6, 16, v5
 v_mfma_f32_16x16x32_bf16 v[88:91], a[208:211], a[144:147], v[88:91]
 v_and_b32 v5, s26, v5
 v_mul_f32 v6, v6, v142
 s_add_u32 s70, s70, 8192
 s_addc_u32 s71, s71, 0
 v_mfma_f32_16x16x32_bf16 v[88:91], a[212:215], a[148:151], v[88:91]
 v_mul_f32 v5, v5, v143
 v_cvt_pk_bf16_f32 v9, v6, v5
 v_mfma_f32_16x16x32_bf16 v[92:95], a[212:215], a[156:159], v[92:95]
 v_accvgpr_read_b32 v5, a70
 v_lshlrev_b32 v6, 16, v5
 v_mfma_f32_16x16x32_bf16 v[92:95], a[208:211], a[152:155], v[92:95]
 v_and_b32 v5, s26, v5
 v_mul_f32 v6, v6, v172
 v_mfma_f32_16x16x32_bf16 v[96:99], a[208:211], a[160:163], v[96:99]
 v_mul_f32 v5, v5, v173
 v_cvt_pk_bf16_f32 v10, v6, v5
 v_mfma_f32_16x16x32_bf16 v[96:99], a[212:215], a[164:167], v[96:99]
 v_accvgpr_read_b32 v5, a71
 v_lshlrev_b32 v6, 16, v5
 v_mfma_f32_16x16x32_bf16 v[100:103], a[212:215], a[172:175], v[100:103]
 v_and_b32 v5, s26, v5
 v_mul_f32 v6, v6, v174
 v_mfma_f32_16x16x32_bf16 v[100:103], a[208:211], a[168:171], v[100:103]
 v_mul_f32 v5, v5, v175
 v_cvt_pk_bf16_f32 v11, v6, v5
 v_mfma_f32_16x16x32_bf16 v[104:107], a[208:211], a[176:179], v[104:107]
 ds_write_b128 v3, v[8:11] offset:6144
 v_mfma_f32_16x16x32_bf16 v[104:107], a[212:215], a[180:183], v[104:107]
 buffer_store_dwordx4 v[8:11], v3, s[32:35], s68 offen offset:2048 sc1
 v_accvgpr_read_b32 v5, a100
 v_lshlrev_b32 v6, 16, v5
 v_and_b32 v5, s26, v5
 v_mul_f32 v6, v6, v204
 v_mfma_f32_16x16x32_bf16 v[108:111], a[212:215], a[188:191], v[108:111]
 v_mul_f32 v5, v5, v205
 v_cvt_pk_bf16_f32 v12, v6, v5
 v_mfma_f32_16x16x32_bf16 v[108:111], a[208:211], a[184:187], v[108:111]
 v_accvgpr_read_b32 v5, a101
 v_lshlrev_b32 v6, 16, v5
 s_waitcnt vmcnt(12)
 v_mfma_f32_16x16x32_bf16 a[244:247], a[216:219], a[184:187], a[244:247]
 ds_read_b128 a[184:187], v1 offset:61440
 v_and_b32 v5, s26, v5
 v_mfma_f32_16x16x32_bf16 a[244:247], a[220:223], a[188:191], a[244:247]
 global_load_dwordx4 a[212:215], v0, s[70:71] offset:-3072 sc1
 ds_read_b128 a[188:191], v1 offset:62464
 v_mfma_f32_16x16x32_bf16 a[240:243], a[220:223], a[180:183], a[240:243]
 ds_read_b128 a[180:183], v1 offset:58368
 v_mul_f32 v6, v6, v206
 v_mfma_f32_16x16x32_bf16 a[240:243], a[216:219], a[176:179], a[240:243]
 global_load_dwordx4 a[208:211], v0, s[70:71] offset:-4096 sc1
 ds_read_b128 a[176:179], v1 offset:57344
 v_mfma_f32_16x16x32_bf16 v[132:135], a[216:219], a[168:171], v[132:135]
 ds_read_b128 a[168:171], v1 offset:53248
 v_mul_f32 v5, v5, v207
 v_mfma_f32_16x16x32_bf16 v[132:135], a[220:223], a[172:175], v[132:135]
 ds_read_b128 a[172:175], v1 offset:54272
 v_cvt_pk_bf16_f32 v13, v6, v5
 v_mfma_f32_16x16x32_bf16 v[128:131], a[220:223], a[164:167], v[128:131]
 ds_read_b128 a[164:167], v1 offset:50176
 v_accvgpr_read_b32 v5, a102
 v_lshlrev_b32 v6, 16, v5
 v_mfma_f32_16x16x32_bf16 v[128:131], a[216:219], a[160:163], v[128:131]
 ds_read_b128 a[160:163], v1 offset:49152
 v_and_b32 v5, s26, v5
 v_mul_f32 v6, v6, v236
 v_mfma_f32_16x16x32_bf16 v[124:127], a[216:219], a[152:155], v[124:127]
 ds_read_b128 a[152:155], v1 offset:45056
 v_mul_f32 v5, v5, v237
 v_mfma_f32_16x16x32_bf16 v[124:127], a[220:223], a[156:159], v[124:127]
 ds_read_b128 a[156:159], v1 offset:46080
 v_cvt_pk_bf16_f32 v14, v6, v5
 v_mfma_f32_16x16x32_bf16 v[120:123], a[220:223], a[148:151], v[120:123]
 ds_read_b128 a[148:151], v1 offset:41984
 v_accvgpr_read_b32 v5, a103
 v_mfma_f32_16x16x32_bf16 v[120:123], a[216:219], a[144:147], v[120:123]
 ds_read_b128 a[144:147], v1 offset:40960
 v_lshlrev_b32 v6, 16, v5
 v_mfma_f32_16x16x32_bf16 v[116:119], a[216:219], a[136:139], v[116:119]
 ds_read_b128 a[136:139], v1 offset:36864
 v_and_b32 v5, s26, v5
 v_mfma_f32_16x16x32_bf16 v[116:119], a[220:223], a[140:143], v[116:119]
 ds_read_b128 a[140:143], v1 offset:37888
 v_mul_f32 v6, v6, v238
 v_mfma_f32_16x16x32_bf16 v[112:115], a[220:223], a[132:135], v[112:115]
 ds_read_b128 a[132:135], v1 offset:33792
 v_mul_f32 v5, v5, v239
 v_mfma_f32_16x16x32_bf16 v[112:115], a[216:219], a[128:131], v[112:115]
 ds_read_b128 a[128:131], v1 offset:32768
 v_cvt_pk_bf16_f32 v15, v6, v5
 s_waitcnt vmcnt(11) lgkmcnt(8)
 v_mfma_f32_16x16x32_bf16 v[44:47], a[224:227], a[184:187], v[44:47]
 ds_write_b128 v3, v[12:15] offset:7168
 v_mfma_f32_16x16x32_bf16 v[44:47], a[228:231], a[188:191], v[44:47]
 buffer_store_dwordx4 v[12:15], v3, s[32:35], s68 offen offset:3072 sc1
 global_load_dwordx4 a[220:223], v0, s[70:71] offset:-1024 sc1
 v_accvgpr_read_b32 v5, a72
 v_lshlrev_b32 v6, 16, v5
 v_and_b32 v5, s26, v5
 v_mfma_f32_16x16x32_bf16 v[40:43], a[228:231], a[180:183], v[40:43]
 v_mul_f32 v6, v6, v144
 v_mul_f32 v5, v5, v145
 v_mfma_f32_16x16x32_bf16 v[40:43], a[224:227], a[176:179], v[40:43]
 global_load_dwordx4 a[216:219], v0, s[70:71] offset:-2048 sc1
 v_cvt_pk_bf16_f32 v8, v6, v5
 v_mfma_f32_16x16x32_bf16 v[36:39], a[224:227], a[168:171], v[36:39]
 v_accvgpr_read_b32 v5, a73
 v_lshlrev_b32 v6, 16, v5
 v_mfma_f32_16x16x32_bf16 v[36:39], a[228:231], a[172:175], v[36:39]
 v_and_b32 v5, s26, v5
 v_mul_f32 v6, v6, v146
 v_mfma_f32_16x16x32_bf16 v[32:35], a[228:231], a[164:167], v[32:35]
 v_mul_f32 v5, v5, v147
 v_cvt_pk_bf16_f32 v9, v6, v5
 v_mfma_f32_16x16x32_bf16 v[32:35], a[224:227], a[160:163], v[32:35]
 v_accvgpr_read_b32 v5, a74
 v_lshlrev_b32 v6, 16, v5
 s_waitcnt lgkmcnt(1)
 v_mfma_f32_16x16x32_bf16 v[28:31], a[224:227], a[152:155], v[28:31]
 v_and_b32 v5, s26, v5
 v_mul_f32 v6, v6, v176
 v_mfma_f32_16x16x32_bf16 v[28:31], a[228:231], a[156:159], v[28:31]
 v_mul_f32 v5, v5, v177
 v_cvt_pk_bf16_f32 v10, v6, v5
 v_mfma_f32_16x16x32_bf16 v[24:27], a[228:231], a[148:151], v[24:27]
 v_accvgpr_read_b32 v5, a75
 v_lshlrev_b32 v6, 16, v5
 v_mfma_f32_16x16x32_bf16 v[24:27], a[224:227], a[144:147], v[24:27]
 v_and_b32 v5, s26, v5
 v_mul_f32 v6, v6, v178
 v_mfma_f32_16x16x32_bf16 v[20:23], a[224:227], a[136:139], v[20:23]
 v_mul_f32 v5, v5, v179
 v_cvt_pk_bf16_f32 v11, v6, v5
 v_mfma_f32_16x16x32_bf16 v[20:23], a[228:231], a[140:143], v[20:23]
 ds_write_b128 v3, v[8:11] offset:10240
 s_add_u32 s68, s29, 20480
 v_mfma_f32_16x16x32_bf16 v[16:19], a[228:231], a[132:135], v[16:19]
 buffer_store_dwordx4 v[8:11], v3, s[32:35], s68 offen sc1
 v_accvgpr_read_b32 v5, a104
 v_lshlrev_b32 v6, 16, v5
 v_mfma_f32_16x16x32_bf16 v[16:19], a[224:227], a[128:131], v[16:19]
 v_and_b32 v5, s26, v5
 v_mul_f32 v6, v6, v208
 s_waitcnt vmcnt(13)
 v_mfma_f32_16x16x32_bf16 v[48:51], a[232:235], a[128:131], v[48:51]
 v_mul_f32 v5, v5, v209
 v_cvt_pk_bf16_f32 v12, v6, v5
 v_mfma_f32_16x16x32_bf16 v[48:51], a[236:239], a[132:135], v[48:51]
 global_load_dwordx4 a[228:231], v0, s[70:71] offset:1024 sc1
 v_accvgpr_read_b32 v5, a105
 v_mfma_f32_16x16x32_bf16 v[52:55], a[236:239], a[140:143], v[52:55]
 v_lshlrev_b32 v6, 16, v5
 v_and_b32 v5, s26, v5
 v_mfma_f32_16x16x32_bf16 v[52:55], a[232:235], a[136:139], v[52:55]
 global_load_dwordx4 a[224:227], v0, s[70:71] offset:0 sc1
 v_mul_f32 v6, v6, v210
 v_mfma_f32_16x16x32_bf16 v[56:59], a[232:235], a[144:147], v[56:59]
 v_mul_f32 v5, v5, v211
 v_cvt_pk_bf16_f32 v13, v6, v5
 v_mfma_f32_16x16x32_bf16 v[56:59], a[236:239], a[148:151], v[56:59]
 v_accvgpr_read_b32 v5, a106
 v_lshlrev_b32 v6, 16, v5
 v_mfma_f32_16x16x32_bf16 v[60:63], a[236:239], a[156:159], v[60:63]
 v_and_b32 v5, s26, v5
 v_mfma_f32_16x16x32_bf16 v[60:63], a[232:235], a[152:155], v[60:63]
 v_mul_f32 v6, v6, v240
 v_mul_f32 v5, v5, v241
 v_mfma_f32_16x16x32_bf16 v[64:67], a[232:235], a[160:163], v[64:67]
 v_cvt_pk_bf16_f32 v14, v6, v5
 v_accvgpr_read_b32 v5, a107
 v_mfma_f32_16x16x32_bf16 v[64:67], a[236:239], a[164:167], v[64:67]
 v_lshlrev_b32 v6, 16, v5
 v_mfma_f32_16x16x32_bf16 v[68:71], a[236:239], a[172:175], v[68:71]
 v_and_b32 v5, s26, v5
 v_mul_f32 v6, v6, v242
 v_mfma_f32_16x16x32_bf16 v[68:71], a[232:235], a[168:171], v[68:71]
 v_mul_f32 v5, v5, v243
 v_cvt_pk_bf16_f32 v15, v6, v5
 v_mfma_f32_16x16x32_bf16 v[72:75], a[232:235], a[176:179], v[72:75]
 ds_write_b128 v3, v[12:15] offset:11264
 v_mfma_f32_16x16x32_bf16 v[72:75], a[236:239], a[180:183], v[72:75]
 buffer_store_dwordx4 v[12:15], v3, s[32:35], s68 offen offset:1024 sc1
 v_accvgpr_read_b32 v5, a76
 v_lshlrev_b32 v6, 16, v5
 v_mfma_f32_16x16x32_bf16 v[76:79], a[236:239], a[188:191], v[76:79]
 v_and_b32 v5, s26, v5
 v_mul_f32 v6, v6, v148
 v_mfma_f32_16x16x32_bf16 v[76:79], a[232:235], a[184:187], v[76:79]
 v_mul_f32 v5, v5, v149
 v_cvt_pk_bf16_f32 v8, v6, v5
 s_waitcnt vmcnt(13)
 v_mfma_f32_16x16x32_bf16 v[108:111], a[192:195], a[184:187], v[108:111]
 v_accvgpr_read_b32 v5, a77
 v_lshlrev_b32 v6, 16, v5
 v_mfma_f32_16x16x32_bf16 v[108:111], a[196:199], a[188:191], v[108:111]
 global_load_dwordx4 a[236:239], v0, s[70:71] offset:3072 sc1
 v_and_b32 v5, s26, v5
 v_mfma_f32_16x16x32_bf16 v[104:107], a[196:199], a[180:183], v[104:107]
 v_mul_f32 v6, v6, v150
 v_mul_f32 v5, v5, v151
 v_mfma_f32_16x16x32_bf16 v[104:107], a[192:195], a[176:179], v[104:107]
 global_load_dwordx4 a[232:235], v0, s[70:71] offset:2048 sc1
 v_cvt_pk_bf16_f32 v9, v6, v5
 v_mfma_f32_16x16x32_bf16 v[100:103], a[192:195], a[168:171], v[100:103]
 v_accvgpr_read_b32 v5, a78
 v_lshlrev_b32 v6, 16, v5
 s_add_u32 s70, s70, 8192
 s_addc_u32 s71, s71, 0
 v_mfma_f32_16x16x32_bf16 v[100:103], a[196:199], a[172:175], v[100:103]
 v_and_b32 v5, s26, v5
 v_mul_f32 v6, v6, v180
 v_mfma_f32_16x16x32_bf16 v[96:99], a[196:199], a[164:167], v[96:99]
 v_mul_f32 v5, v5, v181
 v_cvt_pk_bf16_f32 v10, v6, v5
 v_mfma_f32_16x16x32_bf16 v[96:99], a[192:195], a[160:163], v[96:99]
 v_accvgpr_read_b32 v5, a79
 v_lshlrev_b32 v6, 16, v5
 v_mfma_f32_16x16x32_bf16 v[92:95], a[192:195], a[152:155], v[92:95]
 v_and_b32 v5, s26, v5
 v_mul_f32 v6, v6, v182
 v_mfma_f32_16x16x32_bf16 v[92:95], a[196:199], a[156:159], v[92:95]
 v_mul_f32 v5, v5, v183
 v_cvt_pk_bf16_f32 v11, v6, v5
 v_mfma_f32_16x16x32_bf16 v[88:91], a[196:199], a[148:151], v[88:91]
 ds_write_b128 v3, v[8:11] offset:14336
 v_mfma_f32_16x16x32_bf16 v[88:91], a[192:195], a[144:147], v[88:91]
 buffer_store_dwordx4 v[8:11], v3, s[32:35], s68 offen offset:2048 sc1
 v_accvgpr_read_b32 v5, a108
 v_lshlrev_b32 v6, 16, v5
 v_and_b32 v5, s26, v5
 v_mul_f32 v6, v6, v212
 v_mfma_f32_16x16x32_bf16 v[84:87], a[192:195], a[136:139], v[84:87]
 v_mul_f32 v5, v5, v213
 v_cvt_pk_bf16_f32 v12, v6, v5
 v_mfma_f32_16x16x32_bf16 v[84:87], a[196:199], a[140:143], v[84:87]
 v_accvgpr_read_b32 v5, a109
 v_lshlrev_b32 v6, 16, v5
 v_mfma_f32_16x16x32_bf16 v[80:83], a[196:199], a[132:135], v[80:83]
 v_and_b32 v5, s26, v5
 v_mul_f32 v6, v6, v214
 v_mfma_f32_16x16x32_bf16 v[80:83], a[192:195], a[128:131], v[80:83]
 v_mul_f32 v5, v5, v215
 v_cvt_pk_bf16_f32 v13, v6, v5
 s_waitcnt vmcnt(13)
 v_mfma_f32_16x16x32_bf16 v[112:115], a[200:203], a[128:131], v[112:115]
 ds_read_b128 a[128:131], v2
 v_accvgpr_read_b32 v5, a110
 v_mfma_f32_16x16x32_bf16 v[112:115], a[204:207], a[132:135], v[112:115]
 global_load_dwordx4 a[196:199], v0, s[70:71] offset:-3072 sc1
 ds_read_b128 a[132:135], v2 offset:1024
 v_mfma_f32_16x16x32_bf16 v[116:119], a[204:207], a[140:143], v[116:119]
 ds_read_b128 a[140:143], v2 offset:5120
 v_lshlrev_b32 v6, 16, v5
 v_mfma_f32_16x16x32_bf16 v[116:119], a[200:203], a[136:139], v[116:119]
 global_load_dwordx4 a[192:195], v0, s[70:71] offset:-4096 sc1
 ds_read_b128 a[136:139], v2 offset:4096
 v_mfma_f32_16x16x32_bf16 v[120:123], a[200:203], a[144:147], v[120:123]
 ds_read_b128 a[144:147], v2 offset:8192
 v_and_b32 v5, s26, v5
 v_mfma_f32_16x16x32_bf16 v[120:123], a[204:207], a[148:151], v[120:123]
 ds_read_b128 a[148:151], v2 offset:9216
 v_mul_f32 v6, v6, v244
 v_mfma_f32_16x16x32_bf16 v[124:127], a[204:207], a[156:159], v[124:127]
 ds_read_b128 a[156:159], v2 offset:13312
 v_mul_f32 v5, v5, v245
 v_cvt_pk_bf16_f32 v14, v6, v5
 v_mfma_f32_16x16x32_bf16 v[124:127], a[200:203], a[152:155], v[124:127]
 ds_read_b128 a[152:155], v2 offset:12288
 v_accvgpr_read_b32 v5, a111
 v_mfma_f32_16x16x32_bf16 v[128:131], a[200:203], a[160:163], v[128:131]
 ds_read_b128 a[160:163], v2 offset:16384
 v_lshlrev_b32 v6, 16, v5
 v_mfma_f32_16x16x32_bf16 v[128:131], a[204:207], a[164:167], v[128:131]
 ds_read_b128 a[164:167], v2 offset:17408
 v_and_b32 v5, s26, v5
 v_mfma_f32_16x16x32_bf16 v[132:135], a[204:207], a[172:175], v[132:135]
 ds_read_b128 a[172:175], v2 offset:21504
 v_mul_f32 v6, v6, v246
 v_mfma_f32_16x16x32_bf16 v[132:135], a[200:203], a[168:171], v[132:135]
 ds_read_b128 a[168:171], v2 offset:20480
 v_mul_f32 v5, v5, v247
 v_mfma_f32_16x16x32_bf16 a[240:243], a[200:203], a[176:179], a[240:243]
 ds_read_b128 a[176:179], v2 offset:24576
 v_cvt_pk_bf16_f32 v15, v6, v5
 v_mfma_f32_16x16x32_bf16 a[240:243], a[204:207], a[180:183], a[240:243]
 ds_read_b128 a[180:183], v2 offset:25600
 ds_write_b128 v3, v[12:15] offset:15360
 s_add_u32 s31, s31, 1
 v_mov_b32 v7, s31
 v_mfma_f32_16x16x32_bf16 a[244:247], a[204:207], a[188:191], a[244:247]
 buffer_store_dword v7, v1, s[60:63], 0 offen sc1
 ds_read_b128 a[188:191], v2 offset:29696
 v_mfma_f32_16x16x32_bf16 a[244:247], a[200:203], a[184:187], a[244:247]
 buffer_store_dwordx4 v[12:15], v3, s[32:35], s68 offen offset:3072 sc1
 ds_read_b128 a[184:187], v2 offset:28672
 v_accvgpr_read_b32 v5, a80
 v_lshlrev_b32 v6, 16, v5
 v_and_b32 v5, s26, v5
 s_waitcnt vmcnt(14) lgkmcnt(9)
 v_mfma_f32_16x16x32_bf16 v[16:19], a[208:211], a[128:131], v[16:19]
 v_mul_f32 v6, v6, v152
 v_mul_f32 v5, v5, v153
 v_mfma_f32_16x16x32_bf16 v[16:19], a[212:215], a[132:135], v[16:19]
 global_load_dwordx4 a[204:207], v0, s[70:71] offset:-1024 sc1
 v_cvt_pk_bf16_f32 v8, v6, v5
 v_mfma_f32_16x16x32_bf16 v[20:23], a[212:215], a[140:143], v[20:23]
 v_accvgpr_read_b32 v5, a81
 v_lshlrev_b32 v6, 16, v5
 v_mfma_f32_16x16x32_bf16 v[20:23], a[208:211], a[136:139], v[20:23]
 global_load_dwordx4 a[200:203], v0, s[70:71] offset:-2048 sc1
 v_and_b32 v5, s26, v5
 v_mfma_f32_16x16x32_bf16 v[24:27], a[208:211], a[144:147], v[24:27]
 v_mul_f32 v6, v6, v154
 v_mul_f32 v5, v5, v155
 v_mfma_f32_16x16x32_bf16 v[24:27], a[212:215], a[148:151], v[24:27]
 v_cvt_pk_bf16_f32 v9, v6, v5
 v_accvgpr_read_b32 v5, a82
 v_mfma_f32_16x16x32_bf16 v[28:31], a[212:215], a[156:159], v[28:31]
 v_lshlrev_b32 v6, 16, v5
 v_and_b32 v5, s26, v5
 v_mfma_f32_16x16x32_bf16 v[28:31], a[208:211], a[152:155], v[28:31]
 v_mul_f32 v6, v6, v184
 s_waitcnt lgkmcnt(0)
 v_mfma_f32_16x16x32_bf16 v[32:35], a[208:211], a[160:163], v[32:35]
 v_mul_f32 v5, v5, v185
 v_cvt_pk_bf16_f32 v10, v6, v5
 v_mfma_f32_16x16x32_bf16 v[32:35], a[212:215], a[164:167], v[32:35]
 v_accvgpr_read_b32 v5, a83
 v_lshlrev_b32 v6, 16, v5
 v_mfma_f32_16x16x32_bf16 v[36:39], a[212:215], a[172:175], v[36:39]
 v_and_b32 v5, s26, v5
 v_mul_f32 v6, v6, v186
 v_mfma_f32_16x16x32_bf16 v[36:39], a[208:211], a[168:171], v[36:39]
 v_mul_f32 v5, v5, v187
 v_cvt_pk_bf16_f32 v11, v6, v5
 v_mfma_f32_16x16x32_bf16 v[40:43], a[208:211], a[176:179], v[40:43]
 ds_write_b128 v3, v[8:11] offset:18432
 v_mfma_f32_16x16x32_bf16 v[40:43], a[212:215], a[180:183], v[40:43]
 s_add_u32 s68, s29, 24576
 buffer_store_dwordx4 v[8:11], v3, s[32:35], s68 offen sc1
 v_mfma_f32_16x16x32_bf16 v[44:47], a[212:215], a[188:191], v[44:47]
 v_accvgpr_read_b32 v5, a112
 v_mfma_f32_16x16x32_bf16 v[44:47], a[208:211], a[184:187], v[44:47]
 v_lshlrev_b32 v6, 16, v5
 v_and_b32 v5, s26, v5
 s_waitcnt vmcnt(14)
 v_mfma_f32_16x16x32_bf16 v[76:79], a[216:219], a[184:187], v[76:79]
 v_mul_f32 v6, v6, v216
 v_mul_f32 v5, v5, v217
 v_mfma_f32_16x16x32_bf16 v[76:79], a[220:223], a[188:191], v[76:79]
 global_load_dwordx4 a[212:215], v0, s[70:71] offset:1024 sc1
 v_cvt_pk_bf16_f32 v12, v6, v5
 v_mfma_f32_16x16x32_bf16 v[72:75], a[220:223], a[180:183], v[72:75]
 v_accvgpr_read_b32 v5, a113
 v_lshlrev_b32 v6, 16, v5
 v_mfma_f32_16x16x32_bf16 v[72:75], a[216:219], a[176:179], v[72:75]
 global_load_dwordx4 a[208:211], v0, s[70:71] offset:0 sc1
 v_and_b32 v5, s26, v5
 v_mfma_f32_16x16x32_bf16 v[68:71], a[216:219], a[168:171], v[68:71]
 v_mul_f32 v6, v6, v218
 v_mul_f32 v5, v5, v219
 v_mfma_f32_16x16x32_bf16 v[68:71], a[220:223], a[172:175], v[68:71]
 v_cvt_pk_bf16_f32 v13, v6, v5
 v_accvgpr_read_b32 v5, a114
 v_mfma_f32_16x16x32_bf16 v[64:67], a[220:223], a[164:167], v[64:67]
 v_lshlrev_b32 v6, 16, v5
 v_and_b32 v5, s26, v5
 v_mfma_f32_16x16x32_bf16 v[64:67], a[216:219], a[160:163], v[64:67]
 v_mul_f32 v6, v6, v248
 v_mul_f32 v5, v5, v249
 v_mfma_f32_16x16x32_bf16 v[60:63], a[216:219], a[152:155], v[60:63]
 v_cvt_pk_bf16_f32 v14, v6, v5
 v_mfma_f32_16x16x32_bf16 v[60:63], a[220:223], a[156:159], v[60:63]
 v_accvgpr_read_b32 v5, a115
 v_lshlrev_b32 v6, 16, v5
 v_mfma_f32_16x16x32_bf16 v[56:59], a[220:223], a[148:151], v[56:59]
 v_and_b32 v5, s26, v5
 v_mul_f32 v6, v6, v250
 v_mfma_f32_16x16x32_bf16 v[56:59], a[216:219], a[144:147], v[56:59]
 v_mul_f32 v5, v5, v251
 v_cvt_pk_bf16_f32 v15, v6, v5
 v_mfma_f32_16x16x32_bf16 v[52:55], a[216:219], a[136:139], v[52:55]
 ds_write_b128 v3, v[12:15] offset:19456
 v_mfma_f32_16x16x32_bf16 v[52:55], a[220:223], a[140:143], v[52:55]
 buffer_store_dwordx4 v[12:15], v3, s[32:35], s68 offen offset:1024 sc1
 v_accvgpr_read_b32 v5, a84
 v_mfma_f32_16x16x32_bf16 v[48:51], a[220:223], a[132:135], v[48:51]
 v_lshlrev_b32 v6, 16, v5
 v_mfma_f32_16x16x32_bf16 v[48:51], a[216:219], a[128:131], v[48:51]
 v_and_b32 v5, s26, v5
 v_mul_f32 v6, v6, v156
 s_waitcnt vmcnt(14)
 v_mfma_f32_16x16x32_bf16 v[80:83], a[224:227], a[128:131], v[80:83]
 v_mul_f32 v5, v5, v157
 v_cvt_pk_bf16_f32 v8, v6, v5
 v_mfma_f32_16x16x32_bf16 v[80:83], a[228:231], a[132:135], v[80:83]
 global_load_dwordx4 a[220:223], v0, s[70:71] offset:3072 sc1
 v_accvgpr_read_b32 v5, a85
 v_mfma_f32_16x16x32_bf16 v[84:87], a[228:231], a[140:143], v[84:87]
 v_lshlrev_b32 v6, 16, v5
 v_and_b32 v5, s26, v5
 v_mfma_f32_16x16x32_bf16 v[84:87], a[224:227], a[136:139], v[84:87]
 global_load_dwordx4 a[216:219], v0, s[70:71] offset:2048 sc1
 v_mul_f32 v6, v6, v158
 v_mfma_f32_16x16x32_bf16 v[88:91], a[224:227], a[144:147], v[88:91]
 v_mul_f32 v5, v5, v159
 v_cvt_pk_bf16_f32 v9, v6, v5
 s_add_u32 s70, s70, 8192
 s_addc_u32 s71, s71, 0
 v_mfma_f32_16x16x32_bf16 v[88:91], a[228:231], a[148:151], v[88:91]
 v_accvgpr_read_b32 v5, a86
 v_lshlrev_b32 v6, 16, v5
 v_mfma_f32_16x16x32_bf16 v[92:95], a[228:231], a[156:159], v[92:95]
 v_and_b32 v5, s26, v5
 v_mul_f32 v6, v6, v188
 v_mfma_f32_16x16x32_bf16 v[92:95], a[224:227], a[152:155], v[92:95]
 v_mul_f32 v5, v5, v189
 v_cvt_pk_bf16_f32 v10, v6, v5
 v_mfma_f32_16x16x32_bf16 v[96:99], a[224:227], a[160:163], v[96:99]
 v_accvgpr_read_b32 v5, a87
 v_lshlrev_b32 v6, 16, v5
 v_mfma_f32_16x16x32_bf16 v[96:99], a[228:231], a[164:167], v[96:99]
 v_and_b32 v5, s26, v5
 v_mul_f32 v6, v6, v190
 v_mfma_f32_16x16x32_bf16 v[100:103], a[228:231], a[172:175], v[100:103]
 v_mul_f32 v5, v5, v191
 v_cvt_pk_bf16_f32 v11, v6, v5
 v_mfma_f32_16x16x32_bf16 v[100:103], a[224:227], a[168:171], v[100:103]
 ds_write_b128 v3, v[8:11] offset:22528
 v_mfma_f32_16x16x32_bf16 v[104:107], a[224:227], a[176:179], v[104:107]
 buffer_store_dwordx4 v[8:11], v3, s[32:35], s68 offen offset:2048 sc1
 v_accvgpr_read_b32 v5, a116
 v_lshlrev_b32 v6, 16, v5
 v_and_b32 v5, s26, v5
 v_mul_f32 v6, v6, v220
 v_mfma_f32_16x16x32_bf16 v[104:107], a[228:231], a[180:183], v[104:107]
 v_mul_f32 v5, v5, v221
 v_cvt_pk_bf16_f32 v12, v6, v5
 v_mfma_f32_16x16x32_bf16 v[108:111], a[228:231], a[188:191], v[108:111]
 v_accvgpr_read_b32 v5, a117
 v_lshlrev_b32 v6, 16, v5
 v_mfma_f32_16x16x32_bf16 v[108:111], a[224:227], a[184:187], v[108:111]
 v_and_b32 v5, s26, v5
 v_mul_f32 v6, v6, v222
 s_waitcnt vmcnt(14)
 v_mfma_f32_16x16x32_bf16 a[244:247], a[232:235], a[184:187], a[244:247]
 ds_read_b128 a[184:187], v2 offset:61440
 v_mul_f32 v5, v5, v223
 v_mfma_f32_16x16x32_bf16 a[244:247], a[236:239], a[188:191], a[244:247]
 global_load_dwordx4 a[228:231], v0, s[70:71] offset:-3072 sc1
 ds_read_b128 a[188:191], v2 offset:62464
 v_mfma_f32_16x16x32_bf16 a[240:243], a[236:239], a[180:183], a[240:243]
 ds_read_b128 a[180:183], v2 offset:58368
 v_cvt_pk_bf16_f32 v13, v6, v5
 v_mfma_f32_16x16x32_bf16 a[240:243], a[232:235], a[176:179], a[240:243]
 global_load_dwordx4 a[224:227], v0, s[70:71] offset:-4096 sc1
 ds_read_b128 a[176:179], v2 offset:57344
 v_accvgpr_read_b32 v5, a118
 v_mfma_f32_16x16x32_bf16 v[132:135], a[232:235], a[168:171], v[132:135]
 ds_read_b128 a[168:171], v2 offset:53248
 v_lshlrev_b32 v6, 16, v5
 v_mfma_f32_16x16x32_bf16 v[132:135], a[236:239], a[172:175], v[132:135]
 ds_read_b128 a[172:175], v2 offset:54272
 v_and_b32 v5, s26, v5
 v_mfma_f32_16x16x32_bf16 v[128:131], a[236:239], a[164:167], v[128:131]
 ds_read_b128 a[164:167], v2 offset:50176
 v_mul_f32 v6, v6, v252
 v_mfma_f32_16x16x32_bf16 v[128:131], a[232:235], a[160:163], v[128:131]
 ds_read_b128 a[160:163], v2 offset:49152
 v_mul_f32 v5, v5, v253
 v_mfma_f32_16x16x32_bf16 v[124:127], a[232:235], a[152:155], v[124:127]
 ds_read_b128 a[152:155], v2 offset:45056
 v_cvt_pk_bf16_f32 v14, v6, v5
 v_mfma_f32_16x16x32_bf16 v[124:127], a[236:239], a[156:159], v[124:127]
 ds_read_b128 a[156:159], v2 offset:46080
 v_accvgpr_read_b32 v5, a119
 v_mfma_f32_16x16x32_bf16 v[120:123], a[236:239], a[148:151], v[120:123]
 ds_read_b128 a[148:151], v2 offset:41984
 v_lshlrev_b32 v6, 16, v5
 v_mfma_f32_16x16x32_bf16 v[120:123], a[232:235], a[144:147], v[120:123]
 ds_read_b128 a[144:147], v2 offset:40960
 v_and_b32 v5, s26, v5
 v_mfma_f32_16x16x32_bf16 v[116:119], a[232:235], a[136:139], v[116:119]
 ds_read_b128 a[136:139], v2 offset:36864
 v_mul_f32 v6, v6, v254
 v_mfma_f32_16x16x32_bf16 v[116:119], a[236:239], a[140:143], v[116:119]
 ds_read_b128 a[140:143], v2 offset:37888
 v_mul_f32 v5, v5, v255
 v_mfma_f32_16x16x32_bf16 v[112:115], a[236:239], a[132:135], v[112:115]
 ds_read_b128 a[132:135], v2 offset:33792
 v_cvt_pk_bf16_f32 v15, v6, v5
 v_mfma_f32_16x16x32_bf16 v[112:115], a[232:235], a[128:131], v[112:115]
 ds_read_b128 a[128:131], v2 offset:32768
 ds_write_b128 v3, v[12:15] offset:23552
 buffer_store_dwordx4 v[12:15], v3, s[32:35], s68 offen offset:3072 sc1
 v_accvgpr_read_b32 v5, a88
 v_lshlrev_b32 v6, 16, v5
 v_and_b32 v5, s26, v5
 s_waitcnt vmcnt(14) lgkmcnt(9)
 v_mfma_f32_16x16x32_bf16 v[44:47], a[192:195], a[184:187], v[44:47]
 v_mul_f32 v6, v6, v160
 v_mul_f32 v5, v5, v161
 v_mfma_f32_16x16x32_bf16 v[44:47], a[196:199], a[188:191], v[44:47]
 global_load_dwordx4 a[236:239], v0, s[70:71] offset:-1024 sc1
 v_cvt_pk_bf16_f32 v8, v6, v5
 v_mfma_f32_16x16x32_bf16 v[40:43], a[196:199], a[180:183], v[40:43]
 v_accvgpr_read_b32 v5, a89
 v_lshlrev_b32 v6, 16, v5
 v_mfma_f32_16x16x32_bf16 v[40:43], a[192:195], a[176:179], v[40:43]
 global_load_dwordx4 a[232:235], v0, s[70:71] offset:-2048 sc1
 v_and_b32 v5, s26, v5
 v_mfma_f32_16x16x32_bf16 v[36:39], a[192:195], a[168:171], v[36:39]
 v_mul_f32 v6, v6, v162
 v_mul_f32 v5, v5, v163
 v_mfma_f32_16x16x32_bf16 v[36:39], a[196:199], a[172:175], v[36:39]
 v_cvt_pk_bf16_f32 v9, v6, v5
 v_accvgpr_read_b32 v5, a90
 v_mfma_f32_16x16x32_bf16 v[32:35], a[196:199], a[164:167], v[32:35]
 v_lshlrev_b32 v6, 16, v5
 v_and_b32 v5, s26, v5
 v_mfma_f32_16x16x32_bf16 v[32:35], a[192:195], a[160:163], v[32:35]
 v_mul_f32 v6, v6, v192
 v_mul_f32 v5, v5, v193
 s_waitcnt lgkmcnt(1)
 v_mfma_f32_16x16x32_bf16 v[28:31], a[192:195], a[152:155], v[28:31]
 v_cvt_pk_bf16_f32 v10, v6, v5
 v_accvgpr_read_b32 v5, a91
 v_mfma_f32_16x16x32_bf16 v[28:31], a[196:199], a[156:159], v[28:31]
 v_lshlrev_b32 v6, 16, v5
 v_and_b32 v5, s26, v5
 v_mfma_f32_16x16x32_bf16 v[24:27], a[196:199], a[148:151], v[24:27]
 v_mul_f32 v6, v6, v194
 v_mul_f32 v5, v5, v195
 v_mfma_f32_16x16x32_bf16 v[24:27], a[192:195], a[144:147], v[24:27]
 v_cvt_pk_bf16_f32 v11, v6, v5
 v_mfma_f32_16x16x32_bf16 v[20:23], a[192:195], a[136:139], v[20:23]
 ds_write_b128 v3, v[8:11] offset:26624
 s_add_u32 s68, s29, 28672
 v_mfma_f32_16x16x32_bf16 v[20:23], a[196:199], a[140:143], v[20:23]
 buffer_store_dwordx4 v[8:11], v3, s[32:35], s68 offen sc1
 v_accvgpr_read_b32 v5, a120
 v_lshlrev_b32 v6, 16, v5
 v_and_b32 v5, s26, v5
 v_mfma_f32_16x16x32_bf16 v[16:19], a[196:199], a[132:135], v[16:19]
 v_mul_f32 v6, v6, v224
 v_mul_f32 v5, v5, v225
 v_mfma_f32_16x16x32_bf16 v[16:19], a[192:195], a[128:131], v[16:19]
 v_cvt_pk_bf16_f32 v12, v6, v5
 v_accvgpr_read_b32 v5, a121
 s_waitcnt vmcnt(13)
 v_mfma_f32_16x16x32_bf16 v[48:51], a[200:203], a[128:131], v[48:51]
 v_lshlrev_b32 v6, 16, v5
 v_and_b32 v5, s26, v5
 v_mfma_f32_16x16x32_bf16 v[48:51], a[204:207], a[132:135], v[48:51]
 global_load_dwordx4 a[196:199], v0, s[70:71] offset:1024 sc1
 v_mul_f32 v6, v6, v226
 v_mfma_f32_16x16x32_bf16 v[52:55], a[204:207], a[140:143], v[52:55]
 v_mul_f32 v5, v5, v227
 v_cvt_pk_bf16_f32 v13, v6, v5
 v_mfma_f32_16x16x32_bf16 v[52:55], a[200:203], a[136:139], v[52:55]
 global_load_dwordx4 a[192:195], v0, s[70:71] offset:0 sc1
 v_accvgpr_read_b32 v5, a122
 v_mfma_f32_16x16x32_bf16 v[56:59], a[200:203], a[144:147], v[56:59]
 v_accvgpr_read_b32 v7, a248
 v_lshlrev_b32 v6, 16, v5
 v_mfma_f32_16x16x32_bf16 v[56:59], a[204:207], a[148:151], v[56:59]
 v_and_b32 v5, s26, v5
 v_mul_f32 v6, v6, v7
 v_mfma_f32_16x16x32_bf16 v[60:63], a[204:207], a[156:159], v[60:63]
 v_accvgpr_read_b32 v7, a249
 v_mfma_f32_16x16x32_bf16 v[60:63], a[200:203], a[152:155], v[60:63]
 v_mul_f32 v5, v5, v7
 v_cvt_pk_bf16_f32 v14, v6, v5
 v_mfma_f32_16x16x32_bf16 v[64:67], a[200:203], a[160:163], v[64:67]
 v_accvgpr_read_b32 v5, a123
 v_accvgpr_read_b32 v7, a250
 v_mfma_f32_16x16x32_bf16 v[64:67], a[204:207], a[164:167], v[64:67]
 v_lshlrev_b32 v6, 16, v5
 v_mfma_f32_16x16x32_bf16 v[68:71], a[204:207], a[172:175], v[68:71]
 v_and_b32 v5, s26, v5
 v_mul_f32 v6, v6, v7
 v_mfma_f32_16x16x32_bf16 v[68:71], a[200:203], a[168:171], v[68:71]
 v_accvgpr_read_b32 v7, a251
 v_mul_f32 v5, v5, v7
 v_mfma_f32_16x16x32_bf16 v[72:75], a[200:203], a[176:179], v[72:75]
 v_cvt_pk_bf16_f32 v15, v6, v5
 v_mfma_f32_16x16x32_bf16 v[72:75], a[204:207], a[180:183], v[72:75]
 ds_write_b128 v3, v[12:15] offset:27648
 v_mfma_f32_16x16x32_bf16 v[76:79], a[204:207], a[188:191], v[76:79]
 buffer_store_dwordx4 v[12:15], v3, s[32:35], s68 offen offset:1024 sc1
 v_accvgpr_read_b32 v5, a92
 v_lshlrev_b32 v6, 16, v5
 v_mfma_f32_16x16x32_bf16 v[76:79], a[200:203], a[184:187], v[76:79]
 v_and_b32 v5, s26, v5
 v_mul_f32 v6, v6, v164
 s_waitcnt vmcnt(13)
 v_mfma_f32_16x16x32_bf16 v[108:111], a[208:211], a[184:187], v[108:111]
 v_mul_f32 v5, v5, v165
 v_cvt_pk_bf16_f32 v8, v6, v5
 v_mfma_f32_16x16x32_bf16 v[108:111], a[212:215], a[188:191], v[108:111]
 global_load_dwordx4 a[204:207], v0, s[70:71] offset:3072 sc1
 v_accvgpr_read_b32 v5, a93
 v_mfma_f32_16x16x32_bf16 v[104:107], a[212:215], a[180:183], v[104:107]
 v_lshlrev_b32 v6, 16, v5
 v_and_b32 v5, s26, v5
 v_mfma_f32_16x16x32_bf16 v[104:107], a[208:211], a[176:179], v[104:107]
 global_load_dwordx4 a[200:203], v0, s[70:71] offset:2048 sc1
 v_mul_f32 v6, v6, v166
 v_mfma_f32_16x16x32_bf16 v[100:103], a[208:211], a[168:171], v[100:103]
 v_mul_f32 v5, v5, v167
 v_cvt_pk_bf16_f32 v9, v6, v5
 s_add_u32 s70, s70, 8192
 s_addc_u32 s71, s71, 0
 v_mfma_f32_16x16x32_bf16 v[100:103], a[212:215], a[172:175], v[100:103]
 v_accvgpr_read_b32 v5, a94
 v_lshlrev_b32 v6, 16, v5
 v_mfma_f32_16x16x32_bf16 v[96:99], a[212:215], a[164:167], v[96:99]
 v_and_b32 v5, s26, v5
 v_mul_f32 v6, v6, v196
 v_mfma_f32_16x16x32_bf16 v[96:99], a[208:211], a[160:163], v[96:99]
 v_mul_f32 v5, v5, v197
 v_cvt_pk_bf16_f32 v10, v6, v5
 v_mfma_f32_16x16x32_bf16 v[92:95], a[208:211], a[152:155], v[92:95]
 v_accvgpr_read_b32 v5, a95
 v_lshlrev_b32 v6, 16, v5
 v_mfma_f32_16x16x32_bf16 v[92:95], a[212:215], a[156:159], v[92:95]
 v_and_b32 v5, s26, v5
 v_mul_f32 v6, v6, v198
 v_mfma_f32_16x16x32_bf16 v[88:91], a[212:215], a[148:151], v[88:91]
 v_mul_f32 v5, v5, v199
 v_cvt_pk_bf16_f32 v11, v6, v5
 v_mfma_f32_16x16x32_bf16 v[88:91], a[208:211], a[144:147], v[88:91]
 ds_write_b128 v3, v[8:11] offset:30720
 v_mfma_f32_16x16x32_bf16 v[84:87], a[208:211], a[136:139], v[84:87]
 buffer_store_dwordx4 v[8:11], v3, s[32:35], s68 offen offset:2048 sc1
 v_accvgpr_read_b32 v5, a124
 v_lshlrev_b32 v6, 16, v5
 v_and_b32 v5, s26, v5
 v_mul_f32 v6, v6, v228
 v_mfma_f32_16x16x32_bf16 v[84:87], a[212:215], a[140:143], v[84:87]
 v_mul_f32 v5, v5, v229
 v_cvt_pk_bf16_f32 v12, v6, v5
 v_mfma_f32_16x16x32_bf16 v[80:83], a[212:215], a[132:135], v[80:83]
 v_accvgpr_read_b32 v5, a125
 v_lshlrev_b32 v6, 16, v5
 v_mfma_f32_16x16x32_bf16 v[80:83], a[208:211], a[128:131], v[80:83]
 v_and_b32 v5, s26, v5
 v_mul_f32 v6, v6, v230
 s_waitcnt vmcnt(13)
 v_mfma_f32_16x16x32_bf16 v[112:115], a[216:219], a[128:131], v[112:115]
 ds_read_b128 a[128:131], v1
 v_mul_f32 v5, v5, v231
 v_mfma_f32_16x16x32_bf16 v[112:115], a[220:223], a[132:135], v[112:115]
 global_load_dwordx4 a[212:215], v0, s[70:71] offset:-3072 sc1
 ds_read_b128 a[132:135], v1 offset:1024
 v_mfma_f32_16x16x32_bf16 v[116:119], a[220:223], a[140:143], v[116:119]
 ds_read_b128 a[140:143], v1 offset:5120
 v_cvt_pk_bf16_f32 v13, v6, v5
 v_mfma_f32_16x16x32_bf16 v[116:119], a[216:219], a[136:139], v[116:119]
 global_load_dwordx4 a[208:211], v0, s[70:71] offset:-4096 sc1
 ds_read_b128 a[136:139], v1 offset:4096
 v_mfma_f32_16x16x32_bf16 v[120:123], a[216:219], a[144:147], v[120:123]
 ds_read_b128 a[144:147], v1 offset:8192
 v_accvgpr_read_b32 v5, a126
 v_mfma_f32_16x16x32_bf16 v[120:123], a[220:223], a[148:151], v[120:123]
 ds_read_b128 a[148:151], v1 offset:9216
 v_accvgpr_read_b32 v7, a252
 v_lshlrev_b32 v6, 16, v5
 v_mfma_f32_16x16x32_bf16 v[124:127], a[220:223], a[156:159], v[124:127]
 ds_read_b128 a[156:159], v1 offset:13312
 v_and_b32 v5, s26, v5
 v_mfma_f32_16x16x32_bf16 v[124:127], a[216:219], a[152:155], v[124:127]
 ds_read_b128 a[152:155], v1 offset:12288
 v_mul_f32 v6, v6, v7
 v_accvgpr_read_b32 v7, a253
 v_mfma_f32_16x16x32_bf16 v[128:131], a[216:219], a[160:163], v[128:131]
 ds_read_b128 a[160:163], v1 offset:16384
 v_mul_f32 v5, v5, v7
 v_cvt_pk_bf16_f32 v14, v6, v5
 v_mfma_f32_16x16x32_bf16 v[128:131], a[220:223], a[164:167], v[128:131]
 ds_read_b128 a[164:167], v1 offset:17408
 v_accvgpr_read_b32 v5, a127
 v_accvgpr_read_b32 v7, a254
 v_mfma_f32_16x16x32_bf16 v[132:135], a[220:223], a[172:175], v[132:135]
 ds_read_b128 a[172:175], v1 offset:21504
 v_lshlrev_b32 v6, 16, v5
 v_mfma_f32_16x16x32_bf16 v[132:135], a[216:219], a[168:171], v[132:135]
 ds_read_b128 a[168:171], v1 offset:20480
 v_and_b32 v5, s26, v5
 v_mul_f32 v6, v6, v7
 v_mfma_f32_16x16x32_bf16 a[240:243], a[216:219], a[176:179], a[240:243]
 ds_read_b128 a[176:179], v1 offset:24576
 v_accvgpr_read_b32 v7, a255
 v_mul_f32 v5, v5, v7
 v_cvt_pk_bf16_f32 v15, v6, v5
 v_mfma_f32_16x16x32_bf16 a[240:243], a[220:223], a[180:183], a[240:243]
 ds_read_b128 a[180:183], v1 offset:25600
 ds_write_b128 v3, v[12:15] offset:31744
 v_mfma_f32_16x16x32_bf16 a[244:247], a[220:223], a[188:191], a[244:247]
 buffer_store_dwordx4 v[12:15], v3, s[32:35], s68 offen offset:3072 sc1
 global_load_dwordx4 a[220:223], v0, s[70:71] offset:-1024 sc1
 ds_read_b128 a[188:191], v1 offset:29696
 v_mfma_f32_16x16x32_bf16 a[244:247], a[216:219], a[184:187], a[244:247]
 global_load_dwordx4 a[216:219], v0, s[70:71] offset:-2048 sc1
 ds_read_b128 a[184:187], v1 offset:28672
 s_waitcnt vmcnt(15) lgkmcnt(9)
Ls1b:
 v_mfma_f32_16x16x32_bf16 v[136:139], a[224:227], a[128:131], v[136:139]
 v_bfe_u32 v4, v3, 8, 2
 v_mfma_f32_16x16x32_bf16 v[136:139], a[228:231], a[132:135], v[136:139]
 v_mfma_f32_16x16x32_bf16 v[140:143], a[228:231], a[140:143], v[140:143]
 v_lshl_add_u32 v4, v4, 5, s51
 v_mfma_f32_16x16x32_bf16 v[140:143], a[224:227], a[136:139], v[140:143]
 ds_read_b128 v[8:11], v4
 v_mfma_f32_16x16x32_bf16 v[144:147], a[224:227], a[144:147], v[144:147]
 v_mfma_f32_16x16x32_bf16 v[144:147], a[228:231], a[148:151], v[144:147]
 v_mfma_f32_16x16x32_bf16 v[148:151], a[228:231], a[156:159], v[148:151]
 v_mfma_f32_16x16x32_bf16 v[148:151], a[224:227], a[152:155], v[148:151]
 s_waitcnt lgkmcnt(1)
 v_mfma_f32_16x16x32_bf16 v[152:155], a[224:227], a[160:163], v[152:155]
 v_mfma_f32_16x16x32_bf16 v[152:155], a[228:231], a[164:167], v[152:155]
 v_mfma_f32_16x16x32_bf16 v[156:159], a[228:231], a[172:175], v[156:159]
 v_mfma_f32_16x16x32_bf16 v[156:159], a[224:227], a[168:171], v[156:159]
 v_mfma_f32_16x16x32_bf16 v[160:163], a[224:227], a[176:179], v[160:163]
 v_mfma_f32_16x16x32_bf16 v[160:163], a[228:231], a[180:183], v[160:163]
 v_mfma_f32_16x16x32_bf16 v[164:167], a[228:231], a[188:191], v[164:167]
 v_mfma_f32_16x16x32_bf16 v[164:167], a[224:227], a[184:187], v[164:167]
 s_waitcnt vmcnt(12)
 v_mfma_f32_16x16x32_bf16 v[196:199], a[232:235], a[184:187], v[196:199]
 s_waitcnt lgkmcnt(0)
 v_mfma_f32_16x16x32_bf16 v[196:199], a[236:239], a[188:191], v[196:199]
 global_load_dwordx4 a[228:231], v0, s[70:71] offset:1024 sc1
 v_add_f32 v16, v16, v8
 v_mfma_f32_16x16x32_bf16 v[192:195], a[236:239], a[180:183], v[192:195]
 v_mfma_f32_16x16x32_bf16 v[192:195], a[232:235], a[176:179], v[192:195]
 global_load_dwordx4 a[224:227], v0, s[70:71] offset:0 sc1
 ds_read_b128 v[12:15], v4 offset:16
 v_mfma_f32_16x16x32_bf16 v[188:191], a[232:235], a[168:171], v[188:191]
 v_add_f32 v17, v17, v9
 v_mfma_f32_16x16x32_bf16 v[188:191], a[236:239], a[172:175], v[188:191]
 v_mfma_f32_16x16x32_bf16 v[184:187], a[236:239], a[164:167], v[184:187]
 v_add_f32 v18, v18, v10
 v_mfma_f32_16x16x32_bf16 v[184:187], a[232:235], a[160:163], v[184:187]
 v_add_f32 v19, v19, v11
 v_mfma_f32_16x16x32_bf16 v[180:183], a[232:235], a[152:155], v[180:183]
 v_mfma_f32_16x16x32_bf16 v[180:183], a[236:239], a[156:159], v[180:183]
 v_add_f32 v20, v20, v8
 v_mfma_f32_16x16x32_bf16 v[176:179], a[236:239], a[148:151], v[176:179]
 v_add_f32 v21, v21, v9
 v_mfma_f32_16x16x32_bf16 v[176:179], a[232:235], a[144:147], v[176:179]
 v_add_f32 v22, v22, v10
 v_mfma_f32_16x16x32_bf16 v[172:175], a[232:235], a[136:139], v[172:175]
 v_mfma_f32_16x16x32_bf16 v[172:175], a[236:239], a[140:143], v[172:175]
 v_add_f32 v23, v23, v11
 v_mfma_f32_16x16x32_bf16 v[168:171], a[236:239], a[132:135], v[168:171]
 v_add_f32 v24, v24, v8
 v_mfma_f32_16x16x32_bf16 v[168:171], a[232:235], a[128:131], v[168:171]
 s_waitcnt vmcnt(11)
 v_mfma_f32_16x16x32_bf16 v[200:203], a[192:195], a[128:131], v[200:203]
 v_add_f32 v25, v25, v9
 v_mfma_f32_16x16x32_bf16 v[200:203], a[196:199], a[132:135], v[200:203]
 global_load_dwordx4 a[236:239], v0, s[70:71] offset:3072 sc1
 v_add_f32 v26, v26, v10
 v_mfma_f32_16x16x32_bf16 v[204:207], a[196:199], a[140:143], v[204:207]
 v_mfma_f32_16x16x32_bf16 v[204:207], a[192:195], a[136:139], v[204:207]
 global_load_dwordx4 a[232:235], v0, s[70:71] offset:2048 sc1
 v_add_f32 v27, v27, v11
 v_mfma_f32_16x16x32_bf16 v[208:211], a[192:195], a[144:147], v[208:211]
 v_add_f32 v28, v28, v8
 s_add_u32 s70, s70, 8192
 s_addc_u32 s71, s71, 0
 v_mfma_f32_16x16x32_bf16 v[208:211], a[196:199], a[148:151], v[208:211]
 v_mfma_f32_16x16x32_bf16 v[212:215], a[196:199], a[156:159], v[212:215]
 v_add_f32 v29, v29, v9
 v_mfma_f32_16x16x32_bf16 v[212:215], a[192:195], a[152:155], v[212:215]
 v_add_f32 v30, v30, v10
 v_mfma_f32_16x16x32_bf16 v[216:219], a[192:195], a[160:163], v[216:219]
 v_add_f32 v31, v31, v11
 v_mfma_f32_16x16x32_bf16 v[216:219], a[196:199], a[164:167], v[216:219]
 v_mfma_f32_16x16x32_bf16 v[220:223], a[196:199], a[172:175], v[220:223]
 v_add_f32 v32, v32, v8
 v_mfma_f32_16x16x32_bf16 v[220:223], a[192:195], a[168:171], v[220:223]
 v_add_f32 v33, v33, v9
 v_mfma_f32_16x16x32_bf16 v[224:227], a[192:195], a[176:179], v[224:227]
 v_mfma_f32_16x16x32_bf16 v[224:227], a[196:199], a[180:183], v[224:227]
 v_add_f32 v34, v34, v10
 v_mfma_f32_16x16x32_bf16 v[228:231], a[196:199], a[188:191], v[228:231]
 v_add_f32 v35, v35, v11
 v_mfma_f32_16x16x32_bf16 v[228:231], a[192:195], a[184:187], v[228:231]
 v_add_f32 v36, v36, v8
 s_waitcnt vmcnt(10)
 v_mfma_f32_16x16x32_bf16 a[252:255], a[200:203], a[184:187], a[252:255]
 ds_read_b128 a[184:187], v1 offset:61440
 v_add_f32 v37, v37, v9
 v_mfma_f32_16x16x32_bf16 a[252:255], a[204:207], a[188:191], a[252:255]
 global_load_dwordx4 a[196:199], v0, s[70:71] offset:-3072 sc1
 ds_read_b128 a[188:191], v1 offset:62464
 v_mfma_f32_16x16x32_bf16 a[248:251], a[204:207], a[180:183], a[248:251]
 ds_read_b128 a[180:183], v1 offset:58368
 v_add_f32 v38, v38, v10
 v_mfma_f32_16x16x32_bf16 a[248:251], a[200:203], a[176:179], a[248:251]
 global_load_dwordx4 a[192:195], v0, s[70:71] offset:-4096 sc1
 ds_read_b128 a[176:179], v1 offset:57344
 v_mfma_f32_16x16x32_bf16 v[252:255], a[200:203], a[168:171], v[252:255]
 ds_read_b128 a[168:171], v1 offset:53248
 v_add_f32 v39, v39, v11
 v_mfma_f32_16x16x32_bf16 v[252:255], a[204:207], a[172:175], v[252:255]
 ds_read_b128 a[172:175], v1 offset:54272
 v_add_f32 v40, v40, v8
 v_mfma_f32_16x16x32_bf16 v[248:251], a[204:207], a[164:167], v[248:251]
 ds_read_b128 a[164:167], v1 offset:50176
 v_mfma_f32_16x16x32_bf16 v[248:251], a[200:203], a[160:163], v[248:251]
 ds_read_b128 a[160:163], v1 offset:49152
 v_add_f32 v41, v41, v9
 v_mfma_f32_16x16x32_bf16 v[244:247], a[200:203], a[152:155], v[244:247]
 ds_read_b128 a[152:155], v1 offset:45056
 v_add_f32 v42, v42, v10
 v_mfma_f32_16x16x32_bf16 v[244:247], a[204:207], a[156:159], v[244:247]
 ds_read_b128 a[156:159], v1 offset:46080
 v_mfma_f32_16x16x32_bf16 v[240:243], a[204:207], a[148:151], v[240:243]
 ds_read_b128 a[148:151], v1 offset:41984
 v_add_f32 v43, v43, v11
 v_mfma_f32_16x16x32_bf16 v[240:243], a[200:203], a[144:147], v[240:243]
 ds_read_b128 a[144:147], v1 offset:40960
 v_add_f32 v44, v44, v8
 v_mfma_f32_16x16x32_bf16 v[236:239], a[200:203], a[136:139], v[236:239]
 ds_read_b128 a[136:139], v1 offset:36864
 v_mfma_f32_16x16x32_bf16 v[236:239], a[204:207], a[140:143], v[236:239]
 ds_read_b128 a[140:143], v1 offset:37888
 v_add_f32 v45, v45, v9
 v_mfma_f32_16x16x32_bf16 v[232:235], a[204:207], a[132:135], v[232:235]
 ds_read_b128 a[132:135], v1 offset:33792
 v_add_f32 v46, v46, v10
 v_mfma_f32_16x16x32_bf16 v[232:235], a[200:203], a[128:131], v[232:235]
 ds_read_b128 a[128:131], v1 offset:32768
 v_add_f32 v47, v47, v11
 s_waitcnt vmcnt(9) lgkmcnt(8)
 v_mfma_f32_16x16x32_bf16 v[164:167], a[208:211], a[184:187], v[164:167]
 v_mfma_f32_16x16x32_bf16 v[164:167], a[212:215], a[188:191], v[164:167]
 global_load_dwordx4 a[204:207], v0, s[70:71] offset:-1024 sc1
 v_mfma_f32_16x16x32_bf16 v[160:163], a[212:215], a[180:183], v[160:163]
 v_add_f32 v48, v48, v12
 v_mfma_f32_16x16x32_bf16 v[160:163], a[208:211], a[176:179], v[160:163]
 global_load_dwordx4 a[200:203], v0, s[70:71] offset:-2048 sc1
 v_mfma_f32_16x16x32_bf16 v[156:159], a[208:211], a[168:171], v[156:159]
 ds_read_b128 v[8:11], v4 offset:128
 v_mfma_f32_16x16x32_bf16 v[156:159], a[212:215], a[172:175], v[156:159]
 v_add_f32 v49, v49, v13
 v_mfma_f32_16x16x32_bf16 v[152:155], a[212:215], a[164:167], v[152:155]
 v_mfma_f32_16x16x32_bf16 v[152:155], a[208:211], a[160:163], v[152:155]
 v_add_f32 v50, v50, v14
 s_waitcnt lgkmcnt(1)
 v_mfma_f32_16x16x32_bf16 v[148:151], a[208:211], a[152:155], v[148:151]
 v_add_f32 v51, v51, v15
 v_mfma_f32_16x16x32_bf16 v[148:151], a[212:215], a[156:159], v[148:151]
 v_add_f32 v52, v52, v12
 v_mfma_f32_16x16x32_bf16 v[144:147], a[212:215], a[148:151], v[144:147]
 v_mfma_f32_16x16x32_bf16 v[144:147], a[208:211], a[144:147], v[144:147]
 v_add_f32 v53, v53, v13
 v_mfma_f32_16x16x32_bf16 v[140:143], a[208:211], a[136:139], v[140:143]
 v_add_f32 v54, v54, v14
 v_mfma_f32_16x16x32_bf16 v[140:143], a[212:215], a[140:143], v[140:143]
 v_mfma_f32_16x16x32_bf16 v[136:139], a[212:215], a[132:135], v[136:139]
 v_add_f32 v55, v55, v15
 v_mfma_f32_16x16x32_bf16 v[136:139], a[208:211], a[128:131], v[136:139]
 v_add_f32 v56, v56, v12
 s_waitcnt vmcnt(8)
 v_mfma_f32_16x16x32_bf16 v[168:171], a[216:219], a[128:131], v[168:171]
 v_mfma_f32_16x16x32_bf16 v[168:171], a[220:223], a[132:135], v[168:171]
 global_load_dwordx4 a[212:215], v0, s[70:71] offset:1024 sc1
 v_add_f32 v57, v57, v13
 v_mfma_f32_16x16x32_bf16 v[172:175], a[220:223], a[140:143], v[172:175]
 v_add_f32 v58, v58, v14
 v_mfma_f32_16x16x32_bf16 v[172:175], a[216:219], a[136:139], v[172:175]
 global_load_dwordx4 a[208:211], v0, s[70:71] offset:0 sc1
 v_add_f32 v59, v59, v15
 v_mfma_f32_16x16x32_bf16 v[176:179], a[216:219], a[144:147], v[176:179]
 v_mfma_f32_16x16x32_bf16 v[176:179], a[220:223], a[148:151], v[176:179]
 v_add_f32 v60, v60, v12
 v_mfma_f32_16x16x32_bf16 v[180:183], a[220:223], a[156:159], v[180:183]
 v_add_f32 v61, v61, v13
 v_mfma_f32_16x16x32_bf16 v[180:183], a[216:219], a[152:155], v[180:183]
 v_mfma_f32_16x16x32_bf16 v[184:187], a[216:219], a[160:163], v[184:187]
 v_add_f32 v62, v62, v14
 v_mfma_f32_16x16x32_bf16 v[184:187], a[220:223], a[164:167], v[184:187]
 v_add_f32 v63, v63, v15
 v_mfma_f32_16x16x32_bf16 v[188:191], a[220:223], a[172:175], v[188:191]
 v_mfma_f32_16x16x32_bf16 v[188:191], a[216:219], a[168:171], v[188:191]
 v_add_f32 v64, v64, v12
 v_mfma_f32_16x16x32_bf16 v[192:195], a[216:219], a[176:179], v[192:195]
 v_add_f32 v65, v65, v13
 v_mfma_f32_16x16x32_bf16 v[192:195], a[220:223], a[180:183], v[192:195]
 v_mfma_f32_16x16x32_bf16 v[196:199], a[220:223], a[188:191], v[196:199]
 v_add_f32 v66, v66, v14
 v_mfma_f32_16x16x32_bf16 v[196:199], a[216:219], a[184:187], v[196:199]
 v_add_f32 v67, v67, v15
 s_waitcnt vmcnt(8)
 v_mfma_f32_16x16x32_bf16 v[228:231], a[224:227], a[184:187], v[228:231]
 v_add_f32 v68, v68, v12
 v_mfma_f32_16x16x32_bf16 v[228:231], a[228:231], a[188:191], v[228:231]
 global_load_dwordx4 a[220:223], v0, s[70:71] offset:3072 sc1
 v_mfma_f32_16x16x32_bf16 v[224:227], a[228:231], a[180:183], v[224:227]
 v_add_f32 v69, v69, v13
 v_mfma_f32_16x16x32_bf16 v[224:227], a[224:227], a[176:179], v[224:227]
 global_load_dwordx4 a[216:219], v0, s[70:71] offset:2048 sc1
 v_add_f32 v70, v70, v14
 v_mfma_f32_16x16x32_bf16 v[220:223], a[224:227], a[168:171], v[220:223]
 s_add_u32 s70, s70, 8192
 s_addc_u32 s71, s71, 0
 v_mfma_f32_16x16x32_bf16 v[220:223], a[228:231], a[172:175], v[220:223]
 v_add_f32 v71, v71, v15
 v_mfma_f32_16x16x32_bf16 v[216:219], a[228:231], a[164:167], v[216:219]
 v_add_f32 v72, v72, v12
 v_mfma_f32_16x16x32_bf16 v[216:219], a[224:227], a[160:163], v[216:219]
 v_mfma_f32_16x16x32_bf16 v[212:215], a[224:227], a[152:155], v[212:215]
 v_add_f32 v73, v73, v13
 v_mfma_f32_16x16x32_bf16 v[212:215], a[228:231], a[156:159], v[212:215]
 v_add_f32 v74, v74, v14
 v_mfma_f32_16x16x32_bf16 v[208:211], a[228:231], a[148:151], v[208:211]
 v_add_f32 v75, v75, v15
 v_mfma_f32_16x16x32_bf16 v[208:211], a[224:227], a[144:147], v[208:211]
 v_mfma_f32_16x16x32_bf16 v[204:207], a[224:227], a[136:139], v[204:207]
 v_add_f32 v76, v76, v12
 v_mfma_f32_16x16x32_bf16 v[204:207], a[228:231], a[140:143], v[204:207]
 v_add_f32 v77, v77, v13
 v_mfma_f32_16x16x32_bf16 v[200:203], a[228:231], a[132:135], v[200:203]
 v_mfma_f32_16x16x32_bf16 v[200:203], a[224:227], a[128:131], v[200:203]
 v_add_f32 v78, v78, v14
 s_waitcnt vmcnt(8)
 v_mfma_f32_16x16x32_bf16 v[232:235], a[232:235], a[128:131], v[232:235]
 ds_read_b128 a[128:131], v2
 v_add_f32 v79, v79, v15
 v_mfma_f32_16x16x32_bf16 v[232:235], a[236:239], a[132:135], v[232:235]
 global_load_dwordx4 a[228:231], v0, s[70:71] offset:-3072 sc1
 ds_read_b128 a[132:135], v2 offset:1024
 v_mfma_f32_16x16x32_bf16 v[236:239], a[236:239], a[140:143], v[236:239]
 ds_read_b128 a[140:143], v2 offset:5120
 s_waitcnt lgkmcnt(3)
 v_mfma_f32_16x16x32_bf16 v[236:239], a[232:235], a[136:139], v[236:239]
 global_load_dwordx4 a[224:227], v0, s[70:71] offset:-4096 sc1
 ds_read_b128 a[136:139], v2 offset:4096
 v_mfma_f32_16x16x32_bf16 v[240:243], a[232:235], a[144:147], v[240:243]
 ds_read_b128 a[144:147], v2 offset:8192
 v_add_f32 v80, v80, v8
 v_mfma_f32_16x16x32_bf16 v[240:243], a[236:239], a[148:151], v[240:243]
 ds_read_b128 a[148:151], v2 offset:9216
 ds_read_b128 v[12:15], v4 offset:144
 v_mfma_f32_16x16x32_bf16 v[244:247], a[236:239], a[156:159], v[244:247]
 ds_read_b128 a[156:159], v2 offset:13312
 v_add_f32 v81, v81, v9
 v_mfma_f32_16x16x32_bf16 v[244:247], a[232:235], a[152:155], v[244:247]
 ds_read_b128 a[152:155], v2 offset:12288
 v_add_f32 v82, v82, v10
 v_mfma_f32_16x16x32_bf16 v[248:251], a[232:235], a[160:163], v[248:251]
 ds_read_b128 a[160:163], v2 offset:16384
 v_mfma_f32_16x16x32_bf16 v[248:251], a[236:239], a[164:167], v[248:251]
 ds_read_b128 a[164:167], v2 offset:17408
 v_add_f32 v83, v83, v11
 v_mfma_f32_16x16x32_bf16 v[252:255], a[236:239], a[172:175], v[252:255]
 ds_read_b128 a[172:175], v2 offset:21504
 v_add_f32 v84, v84, v8
 v_mfma_f32_16x16x32_bf16 v[252:255], a[232:235], a[168:171], v[252:255]
 ds_read_b128 a[168:171], v2 offset:20480
 v_mfma_f32_16x16x32_bf16 a[248:251], a[232:235], a[176:179], a[248:251]
 ds_read_b128 a[176:179], v2 offset:24576
 v_add_f32 v85, v85, v9
 v_mfma_f32_16x16x32_bf16 a[248:251], a[236:239], a[180:183], a[248:251]
 ds_read_b128 a[180:183], v2 offset:25600
 v_add_f32 v86, v86, v10
 v_mfma_f32_16x16x32_bf16 a[252:255], a[236:239], a[188:191], a[252:255]
 ds_read_b128 a[188:191], v2 offset:29696
 v_mfma_f32_16x16x32_bf16 a[252:255], a[232:235], a[184:187], a[252:255]
 ds_read_b128 a[184:187], v2 offset:28672
 v_add_f32 v87, v87, v11
 s_waitcnt vmcnt(8) lgkmcnt(8)
 v_mfma_f32_16x16x32_bf16 v[136:139], a[192:195], a[128:131], v[136:139]
 v_add_f32 v88, v88, v8
 v_mfma_f32_16x16x32_bf16 v[136:139], a[196:199], a[132:135], v[136:139]
 global_load_dwordx4 a[236:239], v0, s[70:71] offset:-1024 sc1
 v_add_f32 v89, v89, v9
 v_mfma_f32_16x16x32_bf16 v[140:143], a[196:199], a[140:143], v[140:143]
 v_mfma_f32_16x16x32_bf16 v[140:143], a[192:195], a[136:139], v[140:143]
 global_load_dwordx4 a[232:235], v0, s[70:71] offset:-2048 sc1
 v_add_f32 v90, v90, v10
 v_mfma_f32_16x16x32_bf16 v[144:147], a[192:195], a[144:147], v[144:147]
 v_add_f32 v91, v91, v11
 v_mfma_f32_16x16x32_bf16 v[144:147], a[196:199], a[148:151], v[144:147]
 v_mfma_f32_16x16x32_bf16 v[148:151], a[196:199], a[156:159], v[148:151]
 v_add_f32 v92, v92, v8
 v_mfma_f32_16x16x32_bf16 v[148:151], a[192:195], a[152:155], v[148:151]
 v_add_f32 v93, v93, v9
 s_waitcnt lgkmcnt(0)
 v_mfma_f32_16x16x32_bf16 v[152:155], a[192:195], a[160:163], v[152:155]
 v_mfma_f32_16x16x32_bf16 v[152:155], a[196:199], a[164:167], v[152:155]
 v_add_f32 v94, v94, v10
 v_mfma_f32_16x16x32_bf16 v[156:159], a[196:199], a[172:175], v[156:159]
 v_add_f32 v95, v95, v11
 v_mfma_f32_16x16x32_bf16 v[156:159], a[192:195], a[168:171], v[156:159]
 buffer_load_dword v4, off, s[64:67], 0 sc1
 v_mfma_f32_16x16x32_bf16 v[160:163], a[192:195], a[176:179], v[160:163]
 v_mfma_f32_16x16x32_bf16 v[160:163], a[196:199], a[180:183], v[160:163]
 v_add_f32 v96, v96, v8
 v_mfma_f32_16x16x32_bf16 v[164:167], a[196:199], a[188:191], v[164:167]
 v_add_f32 v97, v97, v9
 v_mfma_f32_16x16x32_bf16 v[164:167], a[192:195], a[184:187], v[164:167]
 s_waitcnt vmcnt(9)
 v_mfma_f32_16x16x32_bf16 v[196:199], a[200:203], a[184:187], v[196:199]
 v_add_f32 v98, v98, v10
 v_mfma_f32_16x16x32_bf16 v[196:199], a[204:207], a[188:191], v[196:199]
 global_load_dwordx4 a[196:199], v0, s[70:71] offset:1024 sc1
 v_add_f32 v99, v99, v11
 v_mfma_f32_16x16x32_bf16 v[192:195], a[204:207], a[180:183], v[192:195]
 v_mfma_f32_16x16x32_bf16 v[192:195], a[200:203], a[176:179], v[192:195]
 global_load_dwordx4 a[192:195], v0, s[70:71] offset:0 sc1
 v_add_f32 v100, v100, v8
 v_mfma_f32_16x16x32_bf16 v[188:191], a[200:203], a[168:171], v[188:191]
 v_add_f32 v101, v101, v9
 v_mfma_f32_16x16x32_bf16 v[188:191], a[204:207], a[172:175], v[188:191]
 v_mfma_f32_16x16x32_bf16 v[184:187], a[204:207], a[164:167], v[184:187]
 v_add_f32 v102, v102, v10
 v_mfma_f32_16x16x32_bf16 v[184:187], a[200:203], a[160:163], v[184:187]
 v_add_f32 v103, v103, v11
 v_mfma_f32_16x16x32_bf16 v[180:183], a[200:203], a[152:155], v[180:183]
 v_add_f32 v104, v104, v8
 v_mfma_f32_16x16x32_bf16 v[180:183], a[204:207], a[156:159], v[180:183]
 v_mfma_f32_16x16x32_bf16 v[176:179], a[204:207], a[148:151], v[176:179]
 v_add_f32 v105, v105, v9
 v_mfma_f32_16x16x32_bf16 v[176:179], a[200:203], a[144:147], v[176:179]
 v_add_f32 v106, v106, v10
 v_mfma_f32_16x16x32_bf16 v[172:175], a[200:203], a[136:139], v[172:175]
 v_mfma_f32_16x16x32_bf16 v[172:175], a[204:207], a[140:143], v[172:175]
 v_add_f32 v107, v107, v11
 v_mfma_f32_16x16x32_bf16 v[168:171], a[204:207], a[132:135], v[168:171]
 v_add_f32 v108, v108, v8
 v_mfma_f32_16x16x32_bf16 v[168:171], a[200:203], a[128:131], v[168:171]
 s_waitcnt vmcnt(9)
 v_mfma_f32_16x16x32_bf16 v[200:203], a[208:211], a[128:131], v[200:203]
 v_add_f32 v109, v109, v9
 v_mfma_f32_16x16x32_bf16 v[200:203], a[212:215], a[132:135], v[200:203]
 global_load_dwordx4 a[204:207], v0, s[70:71] offset:3072 sc1
 v_add_f32 v110, v110, v10
 v_mfma_f32_16x16x32_bf16 v[204:207], a[212:215], a[140:143], v[204:207]
 v_add_f32 v111, v111, v11
 v_mfma_f32_16x16x32_bf16 v[204:207], a[208:211], a[136:139], v[204:207]
 global_load_dwordx4 a[200:203], v0, s[70:71] offset:2048 sc1
 v_mfma_f32_16x16x32_bf16 v[208:211], a[208:211], a[144:147], v[208:211]
 s_add_u32 s70, s70, 8192
 s_addc_u32 s71, s71, 0
 v_mfma_f32_16x16x32_bf16 v[208:211], a[212:215], a[148:151], v[208:211]
 v_add_f32 v112, v112, v12
 v_mfma_f32_16x16x32_bf16 v[212:215], a[212:215], a[156:159], v[212:215]
 v_mfma_f32_16x16x32_bf16 v[212:215], a[208:211], a[152:155], v[212:215]
 v_add_f32 v113, v113, v13
 v_mfma_f32_16x16x32_bf16 v[216:219], a[208:211], a[160:163], v[216:219]
 v_add_f32 v114, v114, v14
 v_mfma_f32_16x16x32_bf16 v[216:219], a[212:215], a[164:167], v[216:219]
 v_mfma_f32_16x16x32_bf16 v[220:223], a[212:215], a[172:175], v[220:223]
 v_add_f32 v115, v115, v15
 v_mfma_f32_16x16x32_bf16 v[220:223], a[208:211], a[168:171], v[220:223]
 v_add_f32 v116, v116, v12
 v_mfma_f32_16x16x32_bf16 v[224:227], a[208:211], a[176:179], v[224:227]
 v_add_f32 v117, v117, v13
 v_mfma_f32_16x16x32_bf16 v[224:227], a[212:215], a[180:183], v[224:227]
 v_mfma_f32_16x16x32_bf16 v[228:231], a[212:215], a[188:191], v[228:231]
 v_add_f32 v118, v118, v14
 v_mfma_f32_16x16x32_bf16 v[228:231], a[208:211], a[184:187], v[228:231]
 v_add_f32 v119, v119, v15
 s_waitcnt vmcnt(9)
 v_mfma_f32_16x16x32_bf16 a[252:255], a[216:219], a[184:187], a[252:255]
 ds_read_b128 a[184:187], v2 offset:61440
 v_add_f32 v120, v120, v12
 v_mfma_f32_16x16x32_bf16 a[252:255], a[220:223], a[188:191], a[252:255]
 global_load_dwordx4 a[212:215], v0, s[70:71] offset:-3072 sc1
 ds_read_b128 a[188:191], v2 offset:62464
 v_mfma_f32_16x16x32_bf16 a[248:251], a[220:223], a[180:183], a[248:251]
 ds_read_b128 a[180:183], v2 offset:58368
 v_add_f32 v121, v121, v13
 v_mfma_f32_16x16x32_bf16 a[248:251], a[216:219], a[176:179], a[248:251]
 global_load_dwordx4 a[208:211], v0, s[70:71] offset:-4096 sc1
 ds_read_b128 a[176:179], v2 offset:57344
 v_mfma_f32_16x16x32_bf16 v[252:255], a[216:219], a[168:171], v[252:255]
 ds_read_b128 a[168:171], v2 offset:53248
 v_add_f32 v122, v122, v14
 v_mfma_f32_16x16x32_bf16 v[252:255], a[220:223], a[172:175], v[252:255]
 ds_read_b128 a[172:175], v2 offset:54272
 v_add_f32 v123, v123, v15
 v_mfma_f32_16x16x32_bf16 v[248:251], a[220:223], a[164:167], v[248:251]
 ds_read_b128 a[164:167], v2 offset:50176
 v_mfma_f32_16x16x32_bf16 v[248:251], a[216:219], a[160:163], v[248:251]
 ds_read_b128 a[160:163], v2 offset:49152
 v_add_f32 v124, v124, v12
 v_mfma_f32_16x16x32_bf16 v[244:247], a[216:219], a[152:155], v[244:247]
 ds_read_b128 a[152:155], v2 offset:45056
 v_add_f32 v125, v125, v13
 v_mfma_f32_16x16x32_bf16 v[244:247], a[220:223], a[156:159], v[244:247]
 ds_read_b128 a[156:159], v2 offset:46080
 v_add_f32 v126, v126, v14
 v_mfma_f32_16x16x32_bf16 v[240:243], a[220:223], a[148:151], v[240:243]
 ds_read_b128 a[148:151], v2 offset:41984
 v_mfma_f32_16x16x32_bf16 v[240:243], a[216:219], a[144:147], v[240:243]
 ds_read_b128 a[144:147], v2 offset:40960
 v_add_f32 v127, v127, v15
 v_mfma_f32_16x16x32_bf16 v[236:239], a[216:219], a[136:139], v[236:239]
 ds_read_b128 a[136:139], v2 offset:36864
 v_add_f32 v128, v128, v12
 v_mfma_f32_16x16x32_bf16 v[236:239], a[220:223], a[140:143], v[236:239]
 ds_read_b128 a[140:143], v2 offset:37888
 v_mfma_f32_16x16x32_bf16 v[232:235], a[220:223], a[132:135], v[232:235]
 ds_read_b128 a[132:135], v2 offset:33792
 v_add_f32 v129, v129, v13
 v_mfma_f32_16x16x32_bf16 v[232:235], a[216:219], a[128:131], v[232:235]
 ds_read_b128 a[128:131], v2 offset:32768
 v_add_f32 v130, v130, v14
 s_waitcnt vmcnt(9) lgkmcnt(8)
 v_mfma_f32_16x16x32_bf16 v[164:167], a[224:227], a[184:187], v[164:167]
 v_mfma_f32_16x16x32_bf16 v[164:167], a[228:231], a[188:191], v[164:167]
 global_load_dwordx4 a[220:223], v0, s[70:71] offset:-1024 sc1
 v_add_f32 v131, v131, v15
 v_mfma_f32_16x16x32_bf16 v[160:163], a[228:231], a[180:183], v[160:163]
 v_add_f32 v132, v132, v12
 v_mfma_f32_16x16x32_bf16 v[160:163], a[224:227], a[176:179], v[160:163]
 global_load_dwordx4 a[216:219], v0, s[70:71] offset:-2048 sc1
 v_add_f32 v133, v133, v13
 v_mfma_f32_16x16x32_bf16 v[156:159], a[224:227], a[168:171], v[156:159]
 v_mfma_f32_16x16x32_bf16 v[156:159], a[228:231], a[172:175], v[156:159]
 v_add_f32 v134, v134, v14
 v_mfma_f32_16x16x32_bf16 v[152:155], a[228:231], a[164:167], v[152:155]
 v_add_f32 v135, v135, v15
 v_mfma_f32_16x16x32_bf16 v[152:155], a[224:227], a[160:163], v[152:155]
 s_waitcnt lgkmcnt(0)
 v_mfma_f32_16x16x32_bf16 v[148:151], a[224:227], a[152:155], v[148:151]
 v_accvgpr_read_b32 v5, a240
 v_mfma_f32_16x16x32_bf16 v[148:151], a[228:231], a[156:159], v[148:151]
 v_add_f32 v5, v5, v12
 v_mfma_f32_16x16x32_bf16 v[144:147], a[228:231], a[148:151], v[144:147]
 v_mfma_f32_16x16x32_bf16 v[144:147], a[224:227], a[144:147], v[144:147]
 v_accvgpr_write_b32 a240, v5
 v_mfma_f32_16x16x32_bf16 v[140:143], a[224:227], a[136:139], v[140:143]
 v_accvgpr_read_b32 v6, a241
 v_mfma_f32_16x16x32_bf16 v[140:143], a[228:231], a[140:143], v[140:143]
 v_mfma_f32_16x16x32_bf16 v[136:139], a[228:231], a[132:135], v[136:139]
 v_add_f32 v6, v6, v13
 v_mfma_f32_16x16x32_bf16 v[136:139], a[224:227], a[128:131], v[136:139]
 v_accvgpr_write_b32 a241, v6
 s_waitcnt vmcnt(9)
 v_mfma_f32_16x16x32_bf16 v[168:171], a[232:235], a[128:131], v[168:171]
 v_accvgpr_read_b32 v5, a242
 v_mfma_f32_16x16x32_bf16 v[168:171], a[236:239], a[132:135], v[168:171]
 global_load_dwordx4 a[228:231], v0, s[70:71] offset:1024 sc1
 v_mfma_f32_16x16x32_bf16 v[172:175], a[236:239], a[140:143], v[172:175]
 v_add_f32 v5, v5, v14
 v_mfma_f32_16x16x32_bf16 v[172:175], a[232:235], a[136:139], v[172:175]
 global_load_dwordx4 a[224:227], v0, s[70:71] offset:0 sc1
 v_accvgpr_write_b32 a242, v5
 v_mfma_f32_16x16x32_bf16 v[176:179], a[232:235], a[144:147], v[176:179]
 v_mfma_f32_16x16x32_bf16 v[176:179], a[236:239], a[148:151], v[176:179]
 v_accvgpr_read_b32 v6, a243
 v_mfma_f32_16x16x32_bf16 v[180:183], a[236:239], a[156:159], v[180:183]
 v_add_f32 v6, v6, v15
 v_mfma_f32_16x16x32_bf16 v[180:183], a[232:235], a[152:155], v[180:183]
 v_mfma_f32_16x16x32_bf16 v[184:187], a[232:235], a[160:163], v[184:187]
 v_accvgpr_write_b32 a243, v6
 v_mfma_f32_16x16x32_bf16 v[184:187], a[236:239], a[164:167], v[184:187]
 v_accvgpr_read_b32 v5, a244
 v_mfma_f32_16x16x32_bf16 v[188:191], a[236:239], a[172:175], v[188:191]
 v_add_f32 v5, v5, v12
 v_mfma_f32_16x16x32_bf16 v[188:191], a[232:235], a[168:171], v[188:191]
 v_mfma_f32_16x16x32_bf16 v[192:195], a[232:235], a[176:179], v[192:195]
 v_accvgpr_write_b32 a244, v5
 v_mfma_f32_16x16x32_bf16 v[192:195], a[236:239], a[180:183], v[192:195]
 v_accvgpr_read_b32 v6, a245
 v_mfma_f32_16x16x32_bf16 v[196:199], a[236:239], a[188:191], v[196:199]
 v_mfma_f32_16x16x32_bf16 v[196:199], a[232:235], a[184:187], v[196:199]
 v_add_f32 v6, v6, v13
 s_waitcnt vmcnt(8)
 v_mfma_f32_16x16x32_bf16 v[228:231], a[192:195], a[184:187], v[228:231]
 v_accvgpr_write_b32 a245, v6
 v_mfma_f32_16x16x32_bf16 v[228:231], a[196:199], a[188:191], v[228:231]
 global_load_dwordx4 a[236:239], v0, s[70:71] offset:3072 sc1
 v_mfma_f32_16x16x32_bf16 v[224:227], a[196:199], a[180:183], v[224:227]
 v_accvgpr_read_b32 v5, a246
 v_mfma_f32_16x16x32_bf16 v[224:227], a[192:195], a[176:179], v[224:227]
 global_load_dwordx4 a[232:235], v0, s[70:71] offset:2048 sc1
 v_add_f32 v5, v5, v14
 v_mfma_f32_16x16x32_bf16 v[220:223], a[192:195], a[168:171], v[220:223]
 v_accvgpr_write_b32 a246, v5
 s_add_u32 s70, s70, 8192
 s_addc_u32 s71, s71, 0
 v_mfma_f32_16x16x32_bf16 v[220:223], a[196:199], a[172:175], v[220:223]
 v_mfma_f32_16x16x32_bf16 v[216:219], a[196:199], a[164:167], v[216:219]
 v_accvgpr_read_b32 v6, a247
 v_mfma_f32_16x16x32_bf16 v[216:219], a[192:195], a[160:163], v[216:219]
 v_add_f32 v6, v6, v15
 v_mfma_f32_16x16x32_bf16 v[212:215], a[192:195], a[152:155], v[212:215]
 v_mfma_f32_16x16x32_bf16 v[212:215], a[196:199], a[156:159], v[212:215]
 v_accvgpr_write_b32 a247, v6
 v_mfma_f32_16x16x32_bf16 v[208:211], a[196:199], a[148:151], v[208:211]
 v_cmp_gt_i32 vcc, s55, v4
 s_and_b64 vcc, exec, vcc
 s_cbranch_vccnz Lspin_pa
Lok_pa:
 s_add_u32 s55, s55, 1
 s_waitcnt lgkmcnt(0)
 s_barrier
 v_mfma_f32_16x16x32_bf16 v[208:211], a[192:195], a[144:147], v[208:211]
 v_mfma_f32_16x16x32_bf16 v[204:207], a[192:195], a[136:139], v[204:207]
 v_mfma_f32_16x16x32_bf16 v[204:207], a[196:199], a[140:143], v[204:207]
 v_mfma_f32_16x16x32_bf16 v[200:203], a[196:199], a[132:135], v[200:203]
 v_mfma_f32_16x16x32_bf16 v[200:203], a[192:195], a[128:131], v[200:203]
 s_waitcnt vmcnt(8)
 v_mfma_f32_16x16x32_bf16 v[232:235], a[200:203], a[128:131], v[232:235]
 ds_read_b128 a[128:131], v1 offset:2048
 v_mfma_f32_16x16x32_bf16 v[232:235], a[204:207], a[132:135], v[232:235]
 global_load_dwordx4 a[196:199], v0, s[70:71] offset:-3072 sc1
 ds_read_b128 a[132:135], v1 offset:3072
 v_mfma_f32_16x16x32_bf16 v[236:239], a[204:207], a[140:143], v[236:239]
 ds_read_b128 a[140:143], v1 offset:7168
 v_mfma_f32_16x16x32_bf16 v[236:239], a[200:203], a[136:139], v[236:239]
 global_load_dwordx4 a[192:195], v0, s[70:71] offset:-4096 sc1
 ds_read_b128 a[136:139], v1 offset:6144
 v_mfma_f32_16x16x32_bf16 v[240:243], a[200:203], a[144:147], v[240:243]
 ds_read_b128 a[144:147], v1 offset:10240
 v_mfma_f32_16x16x32_bf16 v[240:243], a[204:207], a[148:151], v[240:243]
 ds_read_b128 a[148:151], v1 offset:11264
 v_mfma_f32_16x16x32_bf16 v[244:247], a[204:207], a[156:159], v[244:247]
 ds_read_b128 a[156:159], v1 offset:15360
 v_mfma_f32_16x16x32_bf16 v[244:247], a[200:203], a[152:155], v[244:247]
 ds_read_b128 a[152:155], v1 offset:14336
 v_mfma_f32_16x16x32_bf16 v[248:251], a[200:203], a[160:163], v[248:251]
 ds_read_b128 a[160:163], v1 offset:18432
 v_mfma_f32_16x16x32_bf16 v[248:251], a[204:207], a[164:167], v[248:251]
 ds_read_b128 a[164:167], v1 offset:19456
 v_mfma_f32_16x16x32_bf16 v[252:255], a[204:207], a[172:175], v[252:255]
 ds_read_b128 a[172:175], v1 offset:23552
 v_mfma_f32_16x16x32_bf16 v[252:255], a[200:203], a[168:171], v[252:255]
 ds_read_b128 a[168:171], v1 offset:22528
 v_mfma_f32_16x16x32_bf16 a[248:251], a[200:203], a[176:179], a[248:251]
 ds_read_b128 a[176:179], v1 offset:26624
 v_mfma_f32_16x16x32_bf16 a[248:251], a[204:207], a[180:183], a[248:251]
 ds_read_b128 a[180:183], v1 offset:27648
 v_mfma_f32_16x16x32_bf16 a[252:255], a[204:207], a[188:191], a[252:255]
 global_load_dwordx4 a[204:207], v0, s[70:71] offset:-1024 sc1
 ds_read_b128 a[188:191], v1 offset:31744
 v_mfma_f32_16x16x32_bf16 a[252:255], a[200:203], a[184:187], a[252:255]
 global_load_dwordx4 a[200:203], v0, s[70:71] offset:-2048 sc1
 ds_read_b128 a[184:187], v1 offset:30720
 s_waitcnt vmcnt(10) lgkmcnt(8)
 s_branch Lloop
Llast:
 v_mfma_f32_16x16x32_bf16 v[136:139], a[208:211], a[128:131], v[136:139]
 v_accvgpr_read_b32 v5, a0
 v_lshlrev_b32 v6, 16, v5
 v_mfma_f32_16x16x32_bf16 v[136:139], a[212:215], a[132:135], v[136:139]
 v_and_b32 v5, s26, v5
 v_mul_f32 v6, v6, v16
 v_mfma_f32_16x16x32_bf16 v[140:143], a[212:215], a[140:143], v[140:143]
 v_mul_f32 v5, v5, v17
 v_cvt_pk_bf16_f32 v8, v6, v5
 v_mfma_f32_16x16x32_bf16 v[140:143], a[208:211], a[136:139], v[140:143]
 v_accvgpr_read_b32 v5, a1
 v_lshlrev_b32 v6, 16, v5
 v_mfma_f32_16x16x32_bf16 v[144:147], a[208:211], a[144:147], v[144:147]
 v_and_b32 v5, s26, v5
 v_mul_f32 v6, v6, v18
 v_mfma_f32_16x16x32_bf16 v[144:147], a[212:215], a[148:151], v[144:147]
 v_mul_f32 v5, v5, v19
 v_cvt_pk_bf16_f32 v9, v6, v5
 v_mfma_f32_16x16x32_bf16 v[148:151], a[212:215], a[156:159], v[148:151]
 v_accvgpr_read_b32 v5, a2
 v_lshlrev_b32 v6, 16, v5
 v_mfma_f32_16x16x32_bf16 v[148:151], a[208:211], a[152:155], v[148:151]
 v_and_b32 v5, s26, v5
 v_mul_f32 v6, v6, v48
 s_waitcnt lgkmcnt(0)
 v_mfma_f32_16x16x32_bf16 v[152:155], a[208:211], a[160:163], v[152:155]
 v_mul_f32 v5, v5, v49
 v_cvt_pk_bf16_f32 v10, v6, v5
 v_mfma_f32_16x16x32_bf16 v[152:155], a[212:215], a[164:167], v[152:155]
 v_accvgpr_read_b32 v5, a3
 v_lshlrev_b32 v6, 16, v5
 v_mfma_f32_16x16x32_bf16 v[156:159], a[212:215], a[172:175], v[156:159]
 v_and_b32 v5, s26, v5
 v_mul_f32 v6, v6, v50
 v_mfma_f32_16x16x32_bf16 v[156:159], a[208:211], a[168:171], v[156:159]
 v_mul_f32 v5, v5, v51
 v_cvt_pk_bf16_f32 v11, v6, v5
 v_mfma_f32_16x16x32_bf16 v[160:163], a[208:211], a[176:179], v[160:163]
 v_lshrrev_b32 v5, 7, v1
 v_lshlrev_b32 v6, 4, v5
 v_mfma_f32_16x16x32_bf16 v[160:163], a[212:215], a[180:183], v[160:163]
 v_xor_b32 v6, v6, v1
 v_and_b32 v6, 112, v6
 v_mfma_f32_16x16x32_bf16 v[164:167], a[212:215], a[188:191], v[164:167]
 v_lshl_add_u32 v16, v5, 11, v6
 v_lshrrev_b32 v5, 4, v1
 v_mfma_f32_16x16x32_bf16 v[164:167], a[208:211], a[184:187], v[164:167]
 v_and_b32 v5, 48, v5
 v_xor_b32 v5, v5, v1
 s_waitcnt vmcnt(8)
 v_mfma_f32_16x16x32_bf16 v[196:199], a[216:219], a[184:187], v[196:199]
 v_and_b32 v5, 112, v5
 v_and_b32 v6, 240, v1
 v_mfma_f32_16x16x32_bf16 v[196:199], a[220:223], a[188:191], v[196:199]
 global_load_dwordx4 a[212:215], v0, s[70:71] offset:1024 sc1
 v_lshl_add_u32 v5, v6, 3, v5
 v_mfma_f32_16x16x32_bf16 v[192:195], a[220:223], a[180:183], v[192:195]
 v_add_u32 v17, s50, v5
 v_xor_b32 v18, 64, v17
 v_mfma_f32_16x16x32_bf16 v[192:195], a[216:219], a[176:179], v[192:195]
 global_load_dwordx4 a[208:211], v0, s[70:71] offset:0 sc1
 ds_write_b128 v17, v[8:11]
 v_mfma_f32_16x16x32_bf16 v[188:191], a[216:219], a[168:171], v[188:191]
 v_accvgpr_read_b32 v5, a32
 v_lshlrev_b32 v6, 16, v5
 v_mfma_f32_16x16x32_bf16 v[188:191], a[220:223], a[172:175], v[188:191]
 v_and_b32 v5, s26, v5
 v_mul_f32 v6, v6, v80
 v_mfma_f32_16x16x32_bf16 v[184:187], a[220:223], a[164:167], v[184:187]
 v_mul_f32 v5, v5, v81
 v_cvt_pk_bf16_f32 v12, v6, v5
 v_mfma_f32_16x16x32_bf16 v[184:187], a[216:219], a[160:163], v[184:187]
 v_accvgpr_read_b32 v5, a33
 v_lshlrev_b32 v6, 16, v5
 v_mfma_f32_16x16x32_bf16 v[180:183], a[216:219], a[152:155], v[180:183]
 v_and_b32 v5, s26, v5
 v_mul_f32 v6, v6, v82
 v_mfma_f32_16x16x32_bf16 v[180:183], a[220:223], a[156:159], v[180:183]
 v_mul_f32 v5, v5, v83
 v_cvt_pk_bf16_f32 v13, v6, v5
 v_mfma_f32_16x16x32_bf16 v[176:179], a[220:223], a[148:151], v[176:179]
 v_accvgpr_read_b32 v5, a34
 v_lshlrev_b32 v6, 16, v5
 v_mfma_f32_16x16x32_bf16 v[176:179], a[216:219], a[144:147], v[176:179]
 v_and_b32 v5, s26, v5
 v_mul_f32 v6, v6, v112
 v_mfma_f32_16x16x32_bf16 v[172:175], a[216:219], a[136:139], v[172:175]
 v_mul_f32 v5, v5, v113
 v_cvt_pk_bf16_f32 v14, v6, v5
 v_mfma_f32_16x16x32_bf16 v[172:175], a[220:223], a[140:143], v[172:175]
 v_accvgpr_read_b32 v5, a35
 v_lshlrev_b32 v6, 16, v5
 v_mfma_f32_16x16x32_bf16 v[168:171], a[220:223], a[132:135], v[168:171]
 v_and_b32 v5, s26, v5
 v_mul_f32 v6, v6, v114
 v_mfma_f32_16x16x32_bf16 v[168:171], a[216:219], a[128:131], v[168:171]
 v_mul_f32 v5, v5, v115
 v_cvt_pk_bf16_f32 v15, v6, v5
 s_waitcnt vmcnt(8)
 v_mfma_f32_16x16x32_bf16 v[200:203], a[224:227], a[128:131], v[200:203]
 ds_write_b128 v18, v[12:15]
 v_mfma_f32_16x16x32_bf16 v[200:203], a[228:231], a[132:135], v[200:203]
 global_load_dwordx4 a[220:223], v0, s[70:71] offset:3072 sc1
 ds_read_b128 v[48:51], v3
 v_mfma_f32_16x16x32_bf16 v[204:207], a[228:231], a[140:143], v[204:207]
 ds_read_b128 v[80:83], v3 offset:1024
 v_accvgpr_read_b32 v5, a4
 v_mfma_f32_16x16x32_bf16 v[204:207], a[224:227], a[136:139], v[204:207]
 global_load_dwordx4 a[216:219], v0, s[70:71] offset:2048 sc1
 v_lshlrev_b32 v6, 16, v5
 v_mfma_f32_16x16x32_bf16 v[208:211], a[224:227], a[144:147], v[208:211]
 v_and_b32 v5, s26, v5
 v_mul_f32 v6, v6, v20
 s_add_u32 s70, s70, 8192
 s_addc_u32 s71, s71, 0
 v_mfma_f32_16x16x32_bf16 v[208:211], a[228:231], a[148:151], v[208:211]
 v_mul_f32 v5, v5, v21
 v_cvt_pk_bf16_f32 v8, v6, v5
 v_mfma_f32_16x16x32_bf16 v[212:215], a[228:231], a[156:159], v[212:215]
 v_accvgpr_read_b32 v5, a5
 v_lshlrev_b32 v6, 16, v5
 v_mfma_f32_16x16x32_bf16 v[212:215], a[224:227], a[152:155], v[212:215]
 v_and_b32 v5, s26, v5
 v_mul_f32 v6, v6, v22
 v_mfma_f32_16x16x32_bf16 v[216:219], a[224:227], a[160:163], v[216:219]
 v_mul_f32 v5, v5, v23
 v_cvt_pk_bf16_f32 v9, v6, v5
 s_waitcnt lgkmcnt(1)
 s_add_u32 s3, s28, 0
 v_mfma_f32_16x16x32_bf16 v[216:219], a[228:231], a[164:167], v[216:219]
 buffer_store_dwordx4 v[48:51], v16, s[16:19], s3 offen nt
 s_waitcnt lgkmcnt(0)
 s_add_u32 s3, s28, 16384
 buffer_store_dwordx4 v[80:83], v16, s[16:19], s3 offen nt
 v_accvgpr_read_b32 v5, a6
 v_lshlrev_b32 v6, 16, v5
 v_and_b32 v5, s26, v5
 v_mul_f32 v6, v6, v52
 v_mfma_f32_16x16x32_bf16 v[220:223], a[228:231], a[172:175], v[220:223]
 v_mul_f32 v5, v5, v53
 v_cvt_pk_bf16_f32 v10, v6, v5
 v_mfma_f32_16x16x32_bf16 v[220:223], a[224:227], a[168:171], v[220:223]
 v_accvgpr_read_b32 v5, a7
 v_lshlrev_b32 v6, 16, v5
 v_mfma_f32_16x16x32_bf16 v[224:227], a[224:227], a[176:179], v[224:227]
 v_and_b32 v5, s26, v5
 v_mul_f32 v6, v6, v54
 v_mul_f32 v5, v5, v55
 v_cvt_pk_bf16_f32 v11, v6, v5
 v_mfma_f32_16x16x32_bf16 v[224:227], a[228:231], a[180:183], v[224:227]
 ds_write_b128 v17, v[8:11] offset:4096
 v_mfma_f32_16x16x32_bf16 v[228:231], a[228:231], a[188:191], v[228:231]
 v_accvgpr_read_b32 v5, a36
 v_lshlrev_b32 v6, 16, v5
 v_mfma_f32_16x16x32_bf16 v[228:231], a[224:227], a[184:187], v[228:231]
 v_and_b32 v5, s26, v5
 v_mul_f32 v6, v6, v84
 s_waitcnt vmcnt(10)
 v_mfma_f32_16x16x32_bf16 a[252:255], a[232:235], a[184:187], a[252:255]
 ds_read_b128 a[184:187], v1 offset:63488
 v_mul_f32 v5, v5, v85
 v_mfma_f32_16x16x32_bf16 a[252:255], a[236:239], a[188:191], a[252:255]
 global_load_dwordx4 a[228:231], v0, s[70:71] offset:-3072 sc1
 ds_read_b128 a[188:191], v1 offset:64512
 v_mfma_f32_16x16x32_bf16 a[248:251], a[236:239], a[180:183], a[248:251]
 ds_read_b128 a[180:183], v1 offset:60416
 v_cvt_pk_bf16_f32 v12, v6, v5
 v_mfma_f32_16x16x32_bf16 a[248:251], a[232:235], a[176:179], a[248:251]
 global_load_dwordx4 a[224:227], v0, s[70:71] offset:-4096 sc1
 ds_read_b128 a[176:179], v1 offset:59392
 v_mfma_f32_16x16x32_bf16 v[252:255], a[232:235], a[168:171], v[252:255]
 ds_read_b128 a[168:171], v1 offset:55296
 v_accvgpr_read_b32 v5, a37
 v_mfma_f32_16x16x32_bf16 v[252:255], a[236:239], a[172:175], v[252:255]
 ds_read_b128 a[172:175], v1 offset:56320
 v_lshlrev_b32 v6, 16, v5
 v_mfma_f32_16x16x32_bf16 v[248:251], a[236:239], a[164:167], v[248:251]
 ds_read_b128 a[164:167], v1 offset:52224
 v_and_b32 v5, s26, v5
 v_mfma_f32_16x16x32_bf16 v[248:251], a[232:235], a[160:163], v[248:251]
 ds_read_b128 a[160:163], v1 offset:51200
 v_mul_f32 v6, v6, v86
 v_mul_f32 v5, v5, v87
 v_mfma_f32_16x16x32_bf16 v[244:247], a[232:235], a[152:155], v[244:247]
 ds_read_b128 a[152:155], v1 offset:47104
 v_cvt_pk_bf16_f32 v13, v6, v5
 v_mfma_f32_16x16x32_bf16 v[244:247], a[236:239], a[156:159], v[244:247]
 ds_read_b128 a[156:159], v1 offset:48128
 v_accvgpr_read_b32 v5, a38
 v_lshlrev_b32 v6, 16, v5
 v_mfma_f32_16x16x32_bf16 v[240:243], a[236:239], a[148:151], v[240:243]
 ds_read_b128 a[148:151], v1 offset:44032
 v_and_b32 v5, s26, v5
 v_mul_f32 v6, v6, v116
 v_mfma_f32_16x16x32_bf16 v[240:243], a[232:235], a[144:147], v[240:243]
 ds_read_b128 a[144:147], v1 offset:43008
 v_mul_f32 v5, v5, v117
 v_mfma_f32_16x16x32_bf16 v[236:239], a[232:235], a[136:139], v[236:239]
 ds_read_b128 a[136:139], v1 offset:38912
 v_cvt_pk_bf16_f32 v14, v6, v5
 v_mfma_f32_16x16x32_bf16 v[236:239], a[236:239], a[140:143], v[236:239]
 ds_read_b128 a[140:143], v1 offset:39936
 v_accvgpr_read_b32 v5, a39
 v_mfma_f32_16x16x32_bf16 v[232:235], a[236:239], a[132:135], v[232:235]
 ds_read_b128 a[132:135], v1 offset:35840
 v_lshlrev_b32 v6, 16, v5
 v_mfma_f32_16x16x32_bf16 v[232:235], a[232:235], a[128:131], v[232:235]
 ds_read_b128 a[128:131], v1 offset:34816
 v_and_b32 v5, s26, v5
 s_waitcnt vmcnt(10) lgkmcnt(8)
 v_mfma_f32_16x16x32_bf16 v[164:167], a[192:195], a[184:187], v[164:167]
 v_mul_f32 v6, v6, v118
 v_mul_f32 v5, v5, v119
 v_mfma_f32_16x16x32_bf16 v[164:167], a[196:199], a[188:191], v[164:167]
 global_load_dwordx4 a[236:239], v0, s[70:71] offset:-1024 sc1
 v_cvt_pk_bf16_f32 v15, v6, v5
 v_mfma_f32_16x16x32_bf16 v[160:163], a[196:199], a[180:183], v[160:163]
 ds_write_b128 v18, v[12:15] offset:4096
 ds_read_b128 v[48:51], v3 offset:4096
 v_mfma_f32_16x16x32_bf16 v[160:163], a[192:195], a[176:179], v[160:163]
 global_load_dwordx4 a[232:235], v0, s[70:71] offset:-2048 sc1
 ds_read_b128 v[80:83], v3 offset:5120
 v_mfma_f32_16x16x32_bf16 v[156:159], a[192:195], a[168:171], v[156:159]
 v_accvgpr_read_b32 v5, a8
 v_lshlrev_b32 v6, 16, v5
 v_mfma_f32_16x16x32_bf16 v[156:159], a[196:199], a[172:175], v[156:159]
 v_and_b32 v5, s26, v5
 v_mul_f32 v6, v6, v24
 v_mfma_f32_16x16x32_bf16 v[152:155], a[196:199], a[164:167], v[152:155]
 v_mul_f32 v5, v5, v25
 v_cvt_pk_bf16_f32 v8, v6, v5
 v_mfma_f32_16x16x32_bf16 v[152:155], a[192:195], a[160:163], v[152:155]
 v_accvgpr_read_b32 v5, a9
 v_lshlrev_b32 v6, 16, v5
 s_waitcnt lgkmcnt(3)
 v_mfma_f32_16x16x32_bf16 v[148:151], a[192:195], a[152:155], v[148:151]
 v_and_b32 v5, s26, v5
 v_mul_f32 v6, v6, v26
 v_mfma_f32_16x16x32_bf16 v[148:151], a[196:199], a[156:159], v[148:151]
 v_mul_f32 v5, v5, v27
 v_cvt_pk_bf16_f32 v9, v6, v5
 s_waitcnt lgkmcnt(1)
 s_add_u32 s3, s28, 32768
 v_mfma_f32_16x16x32_bf16 v[144:147], a[196:199], a[148:151], v[144:147]
 buffer_store_dwordx4 v[48:51], v16, s[16:19], s3 offen nt
 s_waitcnt lgkmcnt(0)
 s_add_u32 s3, s28, 49152
 buffer_store_dwordx4 v[80:83], v16, s[16:19], s3 offen nt
 v_accvgpr_read_b32 v5, a10
 v_lshlrev_b32 v6, 16, v5
 v_and_b32 v5, s26, v5
 v_mul_f32 v6, v6, v56
 v_mfma_f32_16x16x32_bf16 v[144:147], a[192:195], a[144:147], v[144:147]
 v_mul_f32 v5, v5, v57
 v_cvt_pk_bf16_f32 v10, v6, v5
 v_mfma_f32_16x16x32_bf16 v[140:143], a[192:195], a[136:139], v[140:143]
 v_accvgpr_read_b32 v5, a11
 v_lshlrev_b32 v6, 16, v5
 v_mfma_f32_16x16x32_bf16 v[140:143], a[196:199], a[140:143], v[140:143]
 v_and_b32 v5, s26, v5
 v_mul_f32 v6, v6, v58
 v_mfma_f32_16x16x32_bf16 v[136:139], a[196:199], a[132:135], v[136:139]
 v_mul_f32 v5, v5, v59
 v_cvt_pk_bf16_f32 v11, v6, v5
 v_mfma_f32_16x16x32_bf16 v[136:139], a[192:195], a[128:131], v[136:139]
 ds_write_b128 v17, v[8:11] offset:8192
 s_waitcnt vmcnt(12)
 v_mfma_f32_16x16x32_bf16 v[168:171], a[200:203], a[128:131], v[168:171]
 v_accvgpr_read_b32 v5, a40
 v_lshlrev_b32 v6, 16, v5
 v_mfma_f32_16x16x32_bf16 v[168:171], a[204:207], a[132:135], v[168:171]
 global_load_dwordx4 a[196:199], v0, s[70:71] offset:1024 sc1
 v_and_b32 v5, s26, v5
 v_mfma_f32_16x16x32_bf16 v[172:175], a[204:207], a[140:143], v[172:175]
 v_mul_f32 v6, v6, v88
 v_mul_f32 v5, v5, v89
 v_mfma_f32_16x16x32_bf16 v[172:175], a[200:203], a[136:139], v[172:175]
 global_load_dwordx4 a[192:195], v0, s[70:71] offset:0 sc1
 v_cvt_pk_bf16_f32 v12, v6, v5
 v_mfma_f32_16x16x32_bf16 v[176:179], a[200:203], a[144:147], v[176:179]
 v_accvgpr_read_b32 v5, a41
 v_lshlrev_b32 v6, 16, v5
 v_mfma_f32_16x16x32_bf16 v[176:179], a[204:207], a[148:151], v[176:179]
 v_and_b32 v5, s26, v5
 v_mul_f32 v6, v6, v90
 v_mfma_f32_16x16x32_bf16 v[180:183], a[204:207], a[156:159], v[180:183]
 v_mul_f32 v5, v5, v91
 v_cvt_pk_bf16_f32 v13, v6, v5
 v_mfma_f32_16x16x32_bf16 v[180:183], a[200:203], a[152:155], v[180:183]
 v_accvgpr_read_b32 v5, a42
 v_lshlrev_b32 v6, 16, v5
 v_mfma_f32_16x16x32_bf16 v[184:187], a[200:203], a[160:163], v[184:187]
 v_and_b32 v5, s26, v5
 v_mul_f32 v6, v6, v120
 v_mfma_f32_16x16x32_bf16 v[184:187], a[204:207], a[164:167], v[184:187]
 v_mul_f32 v5, v5, v121
 v_cvt_pk_bf16_f32 v14, v6, v5
 v_mfma_f32_16x16x32_bf16 v[188:191], a[204:207], a[172:175], v[188:191]
 v_accvgpr_read_b32 v5, a43
 v_lshlrev_b32 v6, 16, v5
 v_mfma_f32_16x16x32_bf16 v[188:191], a[200:203], a[168:171], v[188:191]
 v_and_b32 v5, s26, v5
 v_mul_f32 v6, v6, v122
 v_mfma_f32_16x16x32_bf16 v[192:195], a[200:203], a[176:179], v[192:195]
 v_mul_f32 v5, v5, v123
 v_cvt_pk_bf16_f32 v15, v6, v5
 v_mfma_f32_16x16x32_bf16 v[192:195], a[204:207], a[180:183], v[192:195]
 ds_write_b128 v18, v[12:15] offset:8192
 v_mfma_f32_16x16x32_bf16 v[196:199], a[204:207], a[188:191], v[196:199]
 ds_read_b128 v[48:51], v3 offset:8192
 ds_read_b128 v[80:83], v3 offset:9216
 v_mfma_f32_16x16x32_bf16 v[196:199], a[200:203], a[184:187], v[196:199]
 v_accvgpr_read_b32 v5, a12
 v_lshlrev_b32 v6, 16, v5
 s_waitcnt vmcnt(12)
 v_mfma_f32_16x16x32_bf16 v[228:231], a[208:211], a[184:187], v[228:231]
 v_and_b32 v5, s26, v5
 v_mul_f32 v6, v6, v28
 v_mfma_f32_16x16x32_bf16 v[228:231], a[212:215], a[188:191], v[228:231]
 global_load_dwordx4 a[204:207], v0, s[70:71] offset:3072 sc1
 v_mul_f32 v5, v5, v29
 v_mfma_f32_16x16x32_bf16 v[224:227], a[212:215], a[180:183], v[224:227]
 v_cvt_pk_bf16_f32 v8, v6, v5
 v_accvgpr_read_b32 v5, a13
 v_mfma_f32_16x16x32_bf16 v[224:227], a[208:211], a[176:179], v[224:227]
 global_load_dwordx4 a[200:203], v0, s[70:71] offset:2048 sc1
 v_lshlrev_b32 v6, 16, v5
 v_mfma_f32_16x16x32_bf16 v[220:223], a[208:211], a[168:171], v[220:223]
 v_and_b32 v5, s26, v5
 v_mul_f32 v6, v6, v30
 s_add_u32 s70, s70, 8192
 s_addc_u32 s71, s71, 0
 v_mfma_f32_16x16x32_bf16 v[220:223], a[212:215], a[172:175], v[220:223]
 v_mul_f32 v5, v5, v31
 v_cvt_pk_bf16_f32 v9, v6, v5
 s_waitcnt lgkmcnt(1)
 v_mfma_f32_16x16x32_bf16 v[216:219], a[212:215], a[164:167], v[216:219]
 s_add_u32 s3, s28, 65536
 buffer_store_dwordx4 v[48:51], v16, s[16:19], s3 offen nt
 s_waitcnt lgkmcnt(0)
 v_mfma_f32_16x16x32_bf16 v[216:219], a[208:211], a[160:163], v[216:219]
 s_add_u32 s3, s28, 81920
 buffer_store_dwordx4 v[80:83], v16, s[16:19], s3 offen nt
 v_accvgpr_read_b32 v5, a14
 v_lshlrev_b32 v6, 16, v5
 v_and_b32 v5, s26, v5
 v_mul_f32 v6, v6, v60
 v_mfma_f32_16x16x32_bf16 v[212:215], a[208:211], a[152:155], v[212:215]
 v_mul_f32 v5, v5, v61
 v_cvt_pk_bf16_f32 v10, v6, v5
 v_mfma_f32_16x16x32_bf16 v[212:215], a[212:215], a[156:159], v[212:215]
 v_accvgpr_read_b32 v5, a15
 v_lshlrev_b32 v6, 16, v5
 v_mfma_f32_16x16x32_bf16 v[208:211], a[212:215], a[148:151], v[208:211]
 v_and_b32 v5, s26, v5
 v_mul_f32 v6, v6, v62
 v_mfma_f32_16x16x32_bf16 v[208:211], a[208:211], a[144:147], v[208:211]
 v_mul_f32 v5, v5, v63
 v_cvt_pk_bf16_f32 v11, v6, v5
 v_mfma_f32_16x16x32_bf16 v[204:207], a[208:211], a[136:139], v[204:207]
 ds_write_b128 v17, v[8:11] offset:12288
 v_mfma_f32_16x16x32_bf16 v[204:207], a[212:215], a[140:143], v[204:207]
 v_accvgpr_read_b32 v5, a44
 v_lshlrev_b32 v6, 16, v5
 v_mfma_f32_16x16x32_bf16 v[200:203], a[212:215], a[132:135], v[200:203]
 v_and_b32 v5, s26, v5
 v_mul_f32 v6, v6, v92
 v_mfma_f32_16x16x32_bf16 v[200:203], a[208:211], a[128:131], v[200:203]
 v_mul_f32 v5, v5, v93
 v_cvt_pk_bf16_f32 v12, v6, v5
 s_waitcnt vmcnt(14)
 v_mfma_f32_16x16x32_bf16 v[232:235], a[216:219], a[128:131], v[232:235]
 ds_read_b128 a[128:131], v2 offset:2048
 v_accvgpr_read_b32 v5, a45
 v_mfma_f32_16x16x32_bf16 v[232:235], a[220:223], a[132:135], v[232:235]
 global_load_dwordx4 a[212:215], v0, s[70:71] offset:-3072 sc1
 ds_read_b128 a[132:135], v2 offset:3072
 v_mfma_f32_16x16x32_bf16 v[236:239], a[220:223], a[140:143], v[236:239]
 ds_read_b128 a[140:143], v2 offset:7168
 v_lshlrev_b32 v6, 16, v5
 v_mfma_f32_16x16x32_bf16 v[236:239], a[216:219], a[136:139], v[236:239]
 global_load_dwordx4 a[208:211], v0, s[70:71] offset:-4096 sc1
 ds_read_b128 a[136:139], v2 offset:6144
 v_and_b32 v5, s26, v5
 v_mfma_f32_16x16x32_bf16 v[240:243], a[216:219], a[144:147], v[240:243]
 ds_read_b128 a[144:147], v2 offset:10240
 v_mul_f32 v6, v6, v94
 v_mul_f32 v5, v5, v95
 v_mfma_f32_16x16x32_bf16 v[240:243], a[220:223], a[148:151], v[240:243]
 ds_read_b128 a[148:151], v2 offset:11264
 v_cvt_pk_bf16_f32 v13, v6, v5
 v_mfma_f32_16x16x32_bf16 v[244:247], a[220:223], a[156:159], v[244:247]
 ds_read_b128 a[156:159], v2 offset:15360
 v_accvgpr_read_b32 v5, a46
 v_lshlrev_b32 v6, 16, v5
 v_mfma_f32_16x16x32_bf16 v[244:247], a[216:219], a[152:155], v[244:247]
 ds_read_b128 a[152:155], v2 offset:14336
 v_and_b32 v5, s26, v5
 v_mul_f32 v6, v6, v124
 v_mfma_f32_16x16x32_bf16 v[248:251], a[216:219], a[160:163], v[248:251]
 ds_read_b128 a[160:163], v2 offset:18432
 v_mul_f32 v5, v5, v125
 v_mfma_f32_16x16x32_bf16 v[248:251], a[220:223], a[164:167], v[248:251]
 ds_read_b128 a[164:167], v2 offset:19456
 v_cvt_pk_bf16_f32 v14, v6, v5
 v_mfma_f32_16x16x32_bf16 v[252:255], a[220:223], a[172:175], v[252:255]
 ds_read_b128 a[172:175], v2 offset:23552
 v_accvgpr_read_b32 v5, a47
 v_mfma_f32_16x16x32_bf16 v[252:255], a[216:219], a[168:171], v[252:255]
 ds_read_b128 a[168:171], v2 offset:22528
 v_lshlrev_b32 v6, 16, v5
 v_mfma_f32_16x16x32_bf16 a[248:251], a[216:219], a[176:179], a[248:251]
 ds_read_b128 a[176:179], v2 offset:26624
 v_and_b32 v5, s26, v5
 v_mfma_f32_16x16x32_bf16 a[248:251], a[220:223], a[180:183], a[248:251]
 ds_read_b128 a[180:183], v2 offset:27648
 v_mul_f32 v6, v6, v126
 v_mfma_f32_16x16x32_bf16 a[252:255], a[220:223], a[188:191], a[252:255]
 ds_read_b128 a[188:191], v2 offset:31744
 v_mul_f32 v5, v5, v127
 v_mfma_f32_16x16x32_bf16 a[252:255], a[216:219], a[184:187], a[252:255]
 ds_read_b128 a[184:187], v2 offset:30720
 v_cvt_pk_bf16_f32 v15, v6, v5
 s_waitcnt vmcnt(12) lgkmcnt(8)
 v_mfma_f32_16x16x32_bf16 v[136:139], a[224:227], a[128:131], v[136:139]
 ds_write_b128 v18, v[12:15] offset:12288
 ds_read_b128 v[48:51], v3 offset:12288
 ds_read_b128 v[80:83], v3 offset:13312
 v_mfma_f32_16x16x32_bf16 v[136:139], a[228:231], a[132:135], v[136:139]
 global_load_dwordx4 a[220:223], v0, s[70:71] offset:-1024 sc1
 v_accvgpr_read_b32 v5, a16
 v_mfma_f32_16x16x32_bf16 v[140:143], a[228:231], a[140:143], v[140:143]
 v_lshlrev_b32 v6, 16, v5
 v_and_b32 v5, s26, v5
 v_mfma_f32_16x16x32_bf16 v[140:143], a[224:227], a[136:139], v[140:143]
 global_load_dwordx4 a[216:219], v0, s[70:71] offset:-2048 sc1
 v_mul_f32 v6, v6, v32
 v_mfma_f32_16x16x32_bf16 v[144:147], a[224:227], a[144:147], v[144:147]
 v_mul_f32 v5, v5, v33
 v_cvt_pk_bf16_f32 v8, v6, v5
 v_mfma_f32_16x16x32_bf16 v[144:147], a[228:231], a[148:151], v[144:147]
 v_accvgpr_read_b32 v5, a17
 v_lshlrev_b32 v6, 16, v5
 v_mfma_f32_16x16x32_bf16 v[148:151], a[228:231], a[156:159], v[148:151]
 v_and_b32 v5, s26, v5
 v_mul_f32 v6, v6, v34
 v_mfma_f32_16x16x32_bf16 v[148:151], a[224:227], a[152:155], v[148:151]
 v_mul_f32 v5, v5, v35
 v_cvt_pk_bf16_f32 v9, v6, v5
 s_waitcnt lgkmcnt(1)
 s_add_u32 s3, s28, 98304
 v_mfma_f32_16x16x32_bf16 v[152:155], a[224:227], a[160:163], v[152:155]
 buffer_store_dwordx4 v[48:51], v16, s[16:19], s3 offen nt
 s_waitcnt lgkmcnt(0)
 s_add_u32 s3, s28, 114688
 buffer_store_dwordx4 v[80:83], v16, s[16:19], s3 offen nt
 v_accvgpr_read_b32 v5, a18
 v_lshlrev_b32 v6, 16, v5
 v_and_b32 v5, s26, v5
 v_mul_f32 v6, v6, v64
 v_mfma_f32_16x16x32_bf16 v[152:155], a[228:231], a[164:167], v[152:155]
 v_mul_f32 v5, v5, v65
 v_cvt_pk_bf16_f32 v10, v6, v5
 v_mfma_f32_16x16x32_bf16 v[156:159], a[228:231], a[172:175], v[156:159]
 v_accvgpr_read_b32 v5, a19
 v_lshlrev_b32 v6, 16, v5
 v_mfma_f32_16x16x32_bf16 v[156:159], a[224:227], a[168:171], v[156:159]
 v_and_b32 v5, s26, v5
 v_mul_f32 v6, v6, v66
 v_mfma_f32_16x16x32_bf16 v[160:163], a[224:227], a[176:179], v[160:163]
 v_mul_f32 v5, v5, v67
 v_cvt_pk_bf16_f32 v11, v6, v5
 v_mfma_f32_16x16x32_bf16 v[160:163], a[228:231], a[180:183], v[160:163]
 ds_write_b128 v17, v[8:11] offset:16384
 v_mfma_f32_16x16x32_bf16 v[164:167], a[228:231], a[188:191], v[164:167]
 v_accvgpr_read_b32 v5, a48
 v_lshlrev_b32 v6, 16, v5
 v_mfma_f32_16x16x32_bf16 v[164:167], a[224:227], a[184:187], v[164:167]
 v_and_b32 v5, s26, v5
 v_mul_f32 v6, v6, v96
 s_waitcnt vmcnt(14)
 v_mfma_f32_16x16x32_bf16 v[196:199], a[232:235], a[184:187], v[196:199]
 v_mul_f32 v5, v5, v97
 v_cvt_pk_bf16_f32 v12, v6, v5
 v_mfma_f32_16x16x32_bf16 v[196:199], a[236:239], a[188:191], v[196:199]
 global_load_dwordx4 a[228:231], v0, s[70:71] offset:1024 sc1
 v_accvgpr_read_b32 v5, a49
 v_mfma_f32_16x16x32_bf16 v[192:195], a[236:239], a[180:183], v[192:195]
 v_lshlrev_b32 v6, 16, v5
 v_and_b32 v5, s26, v5
 v_mfma_f32_16x16x32_bf16 v[192:195], a[232:235], a[176:179], v[192:195]
 global_load_dwordx4 a[224:227], v0, s[70:71] offset:0 sc1
 v_mul_f32 v6, v6, v98
 v_mfma_f32_16x16x32_bf16 v[188:191], a[232:235], a[168:171], v[188:191]
 v_mul_f32 v5, v5, v99
 v_cvt_pk_bf16_f32 v13, v6, v5
 v_mfma_f32_16x16x32_bf16 v[188:191], a[236:239], a[172:175], v[188:191]
 v_accvgpr_read_b32 v5, a50
 v_lshlrev_b32 v6, 16, v5
 v_mfma_f32_16x16x32_bf16 v[184:187], a[236:239], a[164:167], v[184:187]
 v_and_b32 v5, s26, v5
 v_mul_f32 v6, v6, v128
 v_mfma_f32_16x16x32_bf16 v[184:187], a[232:235], a[160:163], v[184:187]
 v_mul_f32 v5, v5, v129
 v_cvt_pk_bf16_f32 v14, v6, v5
 v_mfma_f32_16x16x32_bf16 v[180:183], a[232:235], a[152:155], v[180:183]
 v_accvgpr_read_b32 v5, a51
 v_lshlrev_b32 v6, 16, v5
 v_mfma_f32_16x16x32_bf16 v[180:183], a[236:239], a[156:159], v[180:183]
 v_and_b32 v5, s26, v5
 v_mul_f32 v6, v6, v130
 v_mfma_f32_16x16x32_bf16 v[176:179], a[236:239], a[148:151], v[176:179]
 v_mul_f32 v5, v5, v131
 v_cvt_pk_bf16_f32 v15, v6, v5
 v_mfma_f32_16x16x32_bf16 v[176:179], a[232:235], a[144:147], v[176:179]
 ds_write_b128 v18, v[12:15] offset:16384
 v_mfma_f32_16x16x32_bf16 v[172:175], a[232:235], a[136:139], v[172:175]
 ds_read_b128 v[48:51], v3 offset:16384
 ds_read_b128 v[80:83], v3 offset:17408
 v_mfma_f32_16x16x32_bf16 v[172:175], a[236:239], a[140:143], v[172:175]
 v_accvgpr_read_b32 v5, a20
 v_lshlrev_b32 v6, 16, v5
 v_mfma_f32_16x16x32_bf16 v[168:171], a[236:239], a[132:135], v[168:171]
 v_and_b32 v5, s26, v5
 v_mul_f32 v6, v6, v36
 v_mfma_f32_16x16x32_bf16 v[168:171], a[232:235], a[128:131], v[168:171]
 v_mul_f32 v5, v5, v37
 v_cvt_pk_bf16_f32 v8, v6, v5
 s_waitcnt vmcnt(12)
 v_mfma_f32_16x16x32_bf16 v[200:203], a[192:195], a[128:131], v[200:203]
 v_accvgpr_read_b32 v5, a21
 v_lshlrev_b32 v6, 16, v5
 v_mfma_f32_16x16x32_bf16 v[200:203], a[196:199], a[132:135], v[200:203]
 global_load_dwordx4 a[236:239], v0, s[70:71] offset:3072 sc1
 v_and_b32 v5, s26, v5
 v_mfma_f32_16x16x32_bf16 v[204:207], a[196:199], a[140:143], v[204:207]
 v_mul_f32 v6, v6, v38
 v_mul_f32 v5, v5, v39
 v_mfma_f32_16x16x32_bf16 v[204:207], a[192:195], a[136:139], v[204:207]
 global_load_dwordx4 a[232:235], v0, s[70:71] offset:2048 sc1
 v_cvt_pk_bf16_f32 v9, v6, v5
 s_waitcnt lgkmcnt(1)
 s_add_u32 s3, s28, 131072
 v_mfma_f32_16x16x32_bf16 v[208:211], a[192:195], a[144:147], v[208:211]
 buffer_store_dwordx4 v[48:51], v16, s[16:19], s3 offen nt
 s_waitcnt lgkmcnt(0)
 s_add_u32 s3, s28, 147456
 s_add_u32 s70, s70, 1843200
 s_addc_u32 s71, s71, 0
 v_mfma_f32_16x16x32_bf16 v[208:211], a[196:199], a[148:151], v[208:211]
 buffer_store_dwordx4 v[80:83], v16, s[16:19], s3 offen nt
 v_accvgpr_read_b32 v5, a22
 v_lshlrev_b32 v6, 16, v5
 v_and_b32 v5, s26, v5
 v_mul_f32 v6, v6, v68
 v_mfma_f32_16x16x32_bf16 v[212:215], a[196:199], a[156:159], v[212:215]
 v_mul_f32 v5, v5, v69
 v_cvt_pk_bf16_f32 v10, v6, v5
 v_mfma_f32_16x16x32_bf16 v[212:215], a[192:195], a[152:155], v[212:215]
 v_accvgpr_read_b32 v5, a23
 v_lshlrev_b32 v6, 16, v5
 v_mfma_f32_16x16x32_bf16 v[216:219], a[192:195], a[160:163], v[216:219]
 v_and_b32 v5, s26, v5
 v_mul_f32 v6, v6, v70
 v_mfma_f32_16x16x32_bf16 v[216:219], a[196:199], a[164:167], v[216:219]
 v_mul_f32 v5, v5, v71
 v_cvt_pk_bf16_f32 v11, v6, v5
 v_mfma_f32_16x16x32_bf16 v[220:223], a[196:199], a[172:175], v[220:223]
 ds_write_b128 v17, v[8:11] offset:20480
 v_mfma_f32_16x16x32_bf16 v[220:223], a[192:195], a[168:171], v[220:223]
 v_accvgpr_read_b32 v5, a52
 v_lshlrev_b32 v6, 16, v5
 v_mfma_f32_16x16x32_bf16 v[224:227], a[192:195], a[176:179], v[224:227]
 v_and_b32 v5, s26, v5
 v_mul_f32 v6, v6, v100
 v_mfma_f32_16x16x32_bf16 v[224:227], a[196:199], a[180:183], v[224:227]
 v_mul_f32 v5, v5, v101
 v_cvt_pk_bf16_f32 v12, v6, v5
 v_mfma_f32_16x16x32_bf16 v[228:231], a[196:199], a[188:191], v[228:231]
 v_accvgpr_read_b32 v5, a53
 v_lshlrev_b32 v6, 16, v5
 v_mfma_f32_16x16x32_bf16 v[228:231], a[192:195], a[184:187], v[228:231]
 v_and_b32 v5, s26, v5
 v_mul_f32 v6, v6, v102
 s_waitcnt vmcnt(14)
 v_mfma_f32_16x16x32_bf16 a[252:255], a[200:203], a[184:187], a[252:255]
 ds_read_b128 a[184:187], v2 offset:63488
 v_mul_f32 v5, v5, v103
 v_mfma_f32_16x16x32_bf16 a[252:255], a[204:207], a[188:191], a[252:255]
 ds_read_b128 a[188:191], v2 offset:64512
 v_cvt_pk_bf16_f32 v13, v6, v5
 v_mfma_f32_16x16x32_bf16 a[248:251], a[204:207], a[180:183], a[248:251]
 ds_read_b128 a[180:183], v2 offset:60416
 v_accvgpr_read_b32 v5, a54
 v_mfma_f32_16x16x32_bf16 a[248:251], a[200:203], a[176:179], a[248:251]
 ds_read_b128 a[176:179], v2 offset:59392
 v_lshlrev_b32 v6, 16, v5
 v_mfma_f32_16x16x32_bf16 v[252:255], a[200:203], a[168:171], v[252:255]
 ds_read_b128 a[168:171], v2 offset:55296
 v_and_b32 v5, s26, v5
 v_mfma_f32_16x16x32_bf16 v[252:255], a[204:207], a[172:175], v[252:255]
 ds_read_b128 a[172:175], v2 offset:56320
 v_mul_f32 v6, v6, v132
 v_mfma_f32_16x16x32_bf16 v[248:251], a[204:207], a[164:167], v[248:251]
 ds_read_b128 a[164:167], v2 offset:52224
 v_mul_f32 v5, v5, v133
 v_mfma_f32_16x16x32_bf16 v[248:251], a[200:203], a[160:163], v[248:251]
 ds_read_b128 a[160:163], v2 offset:51200
 v_cvt_pk_bf16_f32 v14, v6, v5
 v_mfma_f32_16x16x32_bf16 v[244:247], a[200:203], a[152:155], v[244:247]
 ds_read_b128 a[152:155], v2 offset:47104
 v_accvgpr_read_b32 v5, a55
 v_mfma_f32_16x16x32_bf16 v[244:247], a[204:207], a[156:159], v[244:247]
 ds_read_b128 a[156:159], v2 offset:48128
 v_lshlrev_b32 v6, 16, v5
 v_mfma_f32_16x16x32_bf16 v[240:243], a[204:207], a[148:151], v[240:243]
 ds_read_b128 a[148:151], v2 offset:44032
 v_and_b32 v5, s26, v5
 v_mfma_f32_16x16x32_bf16 v[240:243], a[200:203], a[144:147], v[240:243]
 ds_read_b128 a[144:147], v2 offset:43008
 v_mul_f32 v6, v6, v134
 v_mfma_f32_16x16x32_bf16 v[236:239], a[200:203], a[136:139], v[236:239]
 ds_read_b128 a[136:139], v2 offset:38912
 v_mul_f32 v5, v5, v135
 v_mfma_f32_16x16x32_bf16 v[236:239], a[204:207], a[140:143], v[236:239]
 ds_read_b128 a[140:143], v2 offset:39936
 v_cvt_pk_bf16_f32 v15, v6, v5
 v_mfma_f32_16x16x32_bf16 v[232:235], a[204:207], a[132:135], v[232:235]
 ds_read_b128 a[132:135], v2 offset:35840
 v_mfma_f32_16x16x32_bf16 v[232:235], a[200:203], a[128:131], v[232:235]
 ds_read_b128 a[128:131], v2 offset:34816
 ds_write_b128 v18, v[12:15] offset:20480
 ds_read_b128 v[48:51], v3 offset:20480
 ds_read_b128 v[80:83], v3 offset:21504
 v_accvgpr_read_b32 v5, a24
 v_lshlrev_b32 v6, 16, v5
 s_waitcnt vmcnt(10) lgkmcnt(11)
 v_mfma_f32_16x16x32_bf16 v[164:167], a[208:211], a[184:187], v[164:167]
 v_and_b32 v5, s26, v5
 v_mul_f32 v6, v6, v40
 v_mfma_f32_16x16x32_bf16 v[164:167], a[212:215], a[188:191], v[164:167]
 v_mul_f32 v5, v5, v41
 v_cvt_pk_bf16_f32 v8, v6, v5
 v_mfma_f32_16x16x32_bf16 v[160:163], a[212:215], a[180:183], v[160:163]
 v_accvgpr_read_b32 v5, a25
 v_lshlrev_b32 v6, 16, v5
 v_mfma_f32_16x16x32_bf16 v[160:163], a[208:211], a[176:179], v[160:163]
 v_and_b32 v5, s26, v5
 v_mul_f32 v6, v6, v42
 v_mfma_f32_16x16x32_bf16 v[156:159], a[208:211], a[168:171], v[156:159]
 v_mul_f32 v5, v5, v43
 v_cvt_pk_bf16_f32 v9, v6, v5
 s_waitcnt lgkmcnt(1)
 s_add_u32 s3, s28, 163840
 v_mfma_f32_16x16x32_bf16 v[156:159], a[212:215], a[172:175], v[156:159]
 buffer_store_dwordx4 v[48:51], v16, s[16:19], s3 offen nt
 s_waitcnt lgkmcnt(0)
 s_add_u32 s3, s28, 180224
 buffer_store_dwordx4 v[80:83], v16, s[16:19], s3 offen nt
 v_accvgpr_read_b32 v5, a26
 v_lshlrev_b32 v6, 16, v5
 v_and_b32 v5, s26, v5
 v_mul_f32 v6, v6, v72
 v_mfma_f32_16x16x32_bf16 v[152:155], a[212:215], a[164:167], v[152:155]
 v_mul_f32 v5, v5, v73
 v_cvt_pk_bf16_f32 v10, v6, v5
 v_mfma_f32_16x16x32_bf16 v[152:155], a[208:211], a[160:163], v[152:155]
 v_accvgpr_read_b32 v5, a27
 v_lshlrev_b32 v6, 16, v5
 v_mfma_f32_16x16x32_bf16 v[148:151], a[208:211], a[152:155], v[148:151]
 v_and_b32 v5, s26, v5
 v_mul_f32 v6, v6, v74
 v_mfma_f32_16x16x32_bf16 v[148:151], a[212:215], a[156:159], v[148:151]
 v_mul_f32 v5, v5, v75
 v_cvt_pk_bf16_f32 v11, v6, v5
 v_mfma_f32_16x16x32_bf16 v[144:147], a[212:215], a[148:151], v[144:147]
 ds_write_b128 v17, v[8:11] offset:24576
 v_mfma_f32_16x16x32_bf16 v[144:147], a[208:211], a[144:147], v[144:147]
 v_accvgpr_read_b32 v5, a56
 v_lshlrev_b32 v6, 16, v5
 v_mfma_f32_16x16x32_bf16 v[140:143], a[208:211], a[136:139], v[140:143]
 v_and_b32 v5, s26, v5
 v_mul_f32 v6, v6, v104
 v_mfma_f32_16x16x32_bf16 v[140:143], a[212:215], a[140:143], v[140:143]
 v_mul_f32 v5, v5, v105
 v_cvt_pk_bf16_f32 v12, v6, v5
 v_mfma_f32_16x16x32_bf16 v[136:139], a[212:215], a[132:135], v[136:139]
 v_accvgpr_read_b32 v5, a57
 v_lshlrev_b32 v6, 16, v5
 v_mfma_f32_16x16x32_bf16 v[136:139], a[208:211], a[128:131], v[136:139]
 v_and_b32 v5, s26, v5
 v_mul_f32 v6, v6, v106
 s_waitcnt vmcnt(10)
 v_mfma_f32_16x16x32_bf16 v[168:171], a[216:219], a[128:131], v[168:171]
 v_mul_f32 v5, v5, v107
 v_cvt_pk_bf16_f32 v13, v6, v5
 v_mfma_f32_16x16x32_bf16 v[168:171], a[220:223], a[132:135], v[168:171]
 v_accvgpr_read_b32 v5, a58
 v_accvgpr_read_b32 v7, a240
 v_mfma_f32_16x16x32_bf16 v[172:175], a[220:223], a[140:143], v[172:175]
 v_lshlrev_b32 v6, 16, v5
 v_and_b32 v5, s26, v5
 v_mfma_f32_16x16x32_bf16 v[172:175], a[216:219], a[136:139], v[172:175]
 v_mul_f32 v6, v6, v7
 v_accvgpr_read_b32 v7, a241
 v_mfma_f32_16x16x32_bf16 v[176:179], a[216:219], a[144:147], v[176:179]
 v_mul_f32 v5, v5, v7
 v_cvt_pk_bf16_f32 v14, v6, v5
 v_mfma_f32_16x16x32_bf16 v[176:179], a[220:223], a[148:151], v[176:179]
 v_accvgpr_read_b32 v5, a59
 v_accvgpr_read_b32 v7, a242
 v_mfma_f32_16x16x32_bf16 v[180:183], a[220:223], a[156:159], v[180:183]
 v_lshlrev_b32 v6, 16, v5
 v_and_b32 v5, s26, v5
 v_mfma_f32_16x16x32_bf16 v[180:183], a[216:219], a[152:155], v[180:183]
 v_mul_f32 v6, v6, v7
 v_accvgpr_read_b32 v7, a243
 v_mfma_f32_16x16x32_bf16 v[184:187], a[216:219], a[160:163], v[184:187]
 v_mul_f32 v5, v5, v7
 v_cvt_pk_bf16_f32 v15, v6, v5
 v_mfma_f32_16x16x32_bf16 v[184:187], a[220:223], a[164:167], v[184:187]
 ds_write_b128 v18, v[12:15] offset:24576
 v_mfma_f32_16x16x32_bf16 v[188:191], a[220:223], a[172:175], v[188:191]
 ds_read_b128 v[48:51], v3 offset:24576
 ds_read_b128 v[80:83], v3 offset:25600
 v_mfma_f32_16x16x32_bf16 v[188:191], a[216:219], a[168:171], v[188:191]
 v_accvgpr_read_b32 v5, a28
 v_mfma_f32_16x16x32_bf16 v[192:195], a[216:219], a[176:179], v[192:195]
 v_lshlrev_b32 v6, 16, v5
 v_and_b32 v5, s26, v5
 v_mfma_f32_16x16x32_bf16 v[192:195], a[220:223], a[180:183], v[192:195]
 v_mul_f32 v6, v6, v44
 v_mul_f32 v5, v5, v45
 v_mfma_f32_16x16x32_bf16 v[196:199], a[220:223], a[188:191], v[196:199]
 v_cvt_pk_bf16_f32 v8, v6, v5
 v_accvgpr_read_b32 v5, a29
 v_mfma_f32_16x16x32_bf16 v[196:199], a[216:219], a[184:187], v[196:199]
 v_lshlrev_b32 v6, 16, v5
 v_and_b32 v5, s26, v5
 s_waitcnt vmcnt(6)
 v_mfma_f32_16x16x32_bf16 v[228:231], a[224:227], a[184:187], v[228:231]
 v_mul_f32 v6, v6, v46
 v_mul_f32 v5, v5, v47
 v_mfma_f32_16x16x32_bf16 v[228:231], a[228:231], a[188:191], v[228:231]
 v_cvt_pk_bf16_f32 v9, v6, v5
 s_waitcnt lgkmcnt(1)
 v_mfma_f32_16x16x32_bf16 v[224:227], a[228:231], a[180:183], v[224:227]
 s_add_u32 s3, s28, 196608
 buffer_store_dwordx4 v[48:51], v16, s[16:19], s3 offen nt
 v_mfma_f32_16x16x32_bf16 v[224:227], a[224:227], a[176:179], v[224:227]
 s_waitcnt lgkmcnt(0)
 s_add_u32 s3, s28, 212992
 v_mfma_f32_16x16x32_bf16 v[220:223], a[224:227], a[168:171], v[220:223]
 buffer_store_dwordx4 v[80:83], v16, s[16:19], s3 offen nt
 v_accvgpr_read_b32 v5, a30
 v_mfma_f32_16x16x32_bf16 v[220:223], a[228:231], a[172:175], v[220:223]
 v_lshlrev_b32 v6, 16, v5
 v_mfma_f32_16x16x32_bf16 v[216:219], a[228:231], a[164:167], v[216:219]
 v_and_b32 v5, s26, v5
 v_mul_f32 v6, v6, v76
 v_mfma_f32_16x16x32_bf16 v[216:219], a[224:227], a[160:163], v[216:219]
 v_mul_f32 v5, v5, v77
 v_cvt_pk_bf16_f32 v10, v6, v5
 v_mfma_f32_16x16x32_bf16 v[212:215], a[224:227], a[152:155], v[212:215]
 v_accvgpr_read_b32 v5, a31
 v_lshlrev_b32 v6, 16, v5
 v_mfma_f32_16x16x32_bf16 v[212:215], a[228:231], a[156:159], v[212:215]
 v_and_b32 v5, s26, v5
 v_mul_f32 v6, v6, v78
 v_mfma_f32_16x16x32_bf16 v[208:211], a[228:231], a[148:151], v[208:211]
 v_mul_f32 v5, v5, v79
 v_cvt_pk_bf16_f32 v11, v6, v5
 v_mfma_f32_16x16x32_bf16 v[208:211], a[224:227], a[144:147], v[208:211]
 ds_write_b128 v17, v[8:11] offset:28672
 v_mfma_f32_16x16x32_bf16 v[204:207], a[224:227], a[136:139], v[204:207]
 v_accvgpr_read_b32 v5, a60
 v_lshlrev_b32 v6, 16, v5
 v_mfma_f32_16x16x32_bf16 v[204:207], a[228:231], a[140:143], v[204:207]
 v_and_b32 v5, s26, v5
 v_mul_f32 v6, v6, v108
 v_mfma_f32_16x16x32_bf16 v[200:203], a[228:231], a[132:135], v[200:203]
 v_mul_f32 v5, v5, v109
 v_cvt_pk_bf16_f32 v12, v6, v5
 v_mfma_f32_16x16x32_bf16 v[200:203], a[224:227], a[128:131], v[200:203]
 v_accvgpr_read_b32 v5, a61
 v_lshlrev_b32 v6, 16, v5
 s_waitcnt vmcnt(6)
 v_mfma_f32_16x16x32_bf16 v[232:235], a[232:235], a[128:131], v[232:235]
 v_and_b32 v5, s26, v5
 v_mul_f32 v6, v6, v110
 v_mfma_f32_16x16x32_bf16 v[232:235], a[236:239], a[132:135], v[232:235]
 v_mul_f32 v5, v5, v111
 v_cvt_pk_bf16_f32 v13, v6, v5
 v_mfma_f32_16x16x32_bf16 v[236:239], a[236:239], a[140:143], v[236:239]
 v_accvgpr_read_b32 v5, a62
 v_accvgpr_read_b32 v7, a244
 v_mfma_f32_16x16x32_bf16 v[236:239], a[232:235], a[136:139], v[236:239]
 v_lshlrev_b32 v6, 16, v5
 v_and_b32 v5, s26, v5
 v_mfma_f32_16x16x32_bf16 v[240:243], a[232:235], a[144:147], v[240:243]
 v_mul_f32 v6, v6, v7
 v_accvgpr_read_b32 v7, a245
 v_mfma_f32_16x16x32_bf16 v[240:243], a[236:239], a[148:151], v[240:243]
 v_mul_f32 v5, v5, v7
 v_cvt_pk_bf16_f32 v14, v6, v5
 v_mfma_f32_16x16x32_bf16 v[244:247], a[236:239], a[156:159], v[244:247]
 v_accvgpr_read_b32 v5, a63
 v_accvgpr_read_b32 v7, a246
 v_mfma_f32_16x16x32_bf16 v[244:247], a[232:235], a[152:155], v[244:247]
 v_lshlrev_b32 v6, 16, v5
 v_and_b32 v5, s26, v5
 v_mfma_f32_16x16x32_bf16 v[248:251], a[232:235], a[160:163], v[248:251]
 v_mul_f32 v6, v6, v7
 v_accvgpr_read_b32 v7, a247
 v_mfma_f32_16x16x32_bf16 v[248:251], a[236:239], a[164:167], v[248:251]
 v_mul_f32 v5, v5, v7
 v_cvt_pk_bf16_f32 v15, v6, v5
 v_mfma_f32_16x16x32_bf16 v[252:255], a[236:239], a[172:175], v[252:255]
 ds_write_b128 v18, v[12:15] offset:28672
 v_mfma_f32_16x16x32_bf16 v[252:255], a[232:235], a[168:171], v[252:255]
 ds_read_b128 v[48:51], v3 offset:28672
 ds_read_b128 v[80:83], v3 offset:29696
 v_mfma_f32_16x16x32_bf16 a[248:251], a[232:235], a[176:179], a[248:251]
 s_waitcnt lgkmcnt(1)
 s_add_u32 s3, s28, 229376
 v_mfma_f32_16x16x32_bf16 a[248:251], a[236:239], a[180:183], a[248:251]
 buffer_store_dwordx4 v[48:51], v16, s[16:19], s3 offen nt
 s_waitcnt lgkmcnt(0)
 v_mfma_f32_16x16x32_bf16 a[252:255], a[236:239], a[188:191], a[252:255]
 s_add_u32 s3, s28, 245760
 buffer_store_dwordx4 v[80:83], v16, s[16:19], s3 offen nt
 v_mfma_f32_16x16x32_bf16 a[252:255], a[232:235], a[184:187], a[252:255]
 s_nop 7
 v_accvgpr_read_b32 v7, a64
 v_lshlrev_b32 v6, 16, v7
 v_and_b32 v7, s26, v7
 v_pk_mul_f32 v[6:7], v[6:7], v[136:137]
 v_cvt_pk_bf16_f32 v8, v6, v7
 v_accvgpr_read_b32 v7, a65
 v_lshlrev_b32 v6, 16, v7
 v_and_b32 v7, s26, v7
 v_pk_mul_f32 v[6:7], v[6:7], v[138:139]
 v_cvt_pk_bf16_f32 v9, v6, v7
 v_accvgpr_read_b32 v7, a66
 v_lshlrev_b32 v6, 16, v7
 v_and_b32 v7, s26, v7
 v_pk_mul_f32 v[6:7], v[6:7], v[168:169]
 v_cvt_pk_bf16_f32 v10, v6, v7
 v_accvgpr_read_b32 v7, a67
 v_lshlrev_b32 v6, 16, v7
 v_and_b32 v7, s26, v7
 v_pk_mul_f32 v[6:7], v[6:7], v[170:171]
 v_cvt_pk_bf16_f32 v11, v6, v7
 ds_write_b128 v17, v[8:11]
 v_accvgpr_read_b32 v7, a96
 v_lshlrev_b32 v6, 16, v7
 v_and_b32 v7, s26, v7
 v_pk_mul_f32 v[6:7], v[6:7], v[200:201]
 v_cvt_pk_bf16_f32 v12, v6, v7
 v_accvgpr_read_b32 v7, a97
 v_lshlrev_b32 v6, 16, v7
 v_and_b32 v7, s26, v7
 v_pk_mul_f32 v[6:7], v[6:7], v[202:203]
 v_cvt_pk_bf16_f32 v13, v6, v7
 v_accvgpr_read_b32 v7, a98
 v_lshlrev_b32 v6, 16, v7
 v_and_b32 v7, s26, v7
 v_pk_mul_f32 v[6:7], v[6:7], v[232:233]
 v_cvt_pk_bf16_f32 v14, v6, v7
 v_accvgpr_read_b32 v7, a99
 v_lshlrev_b32 v6, 16, v7
 v_and_b32 v7, s26, v7
 v_pk_mul_f32 v[6:7], v[6:7], v[234:235]
 v_cvt_pk_bf16_f32 v15, v6, v7
 ds_write_b128 v18, v[12:15]
 ds_read_b128 v[48:51], v3
 ds_read_b128 v[80:83], v3 offset:1024
 v_accvgpr_read_b32 v7, a68
 v_lshlrev_b32 v6, 16, v7
 v_and_b32 v7, s26, v7
 v_pk_mul_f32 v[6:7], v[6:7], v[140:141]
 v_cvt_pk_bf16_f32 v8, v6, v7
 v_accvgpr_read_b32 v7, a69
 v_lshlrev_b32 v6, 16, v7
 v_and_b32 v7, s26, v7
 v_pk_mul_f32 v[6:7], v[6:7], v[142:143]
 v_cvt_pk_bf16_f32 v9, v6, v7
 v_accvgpr_read_b32 v7, a70
 v_lshlrev_b32 v6, 16, v7
 s_waitcnt lgkmcnt(1)
 s_add_u32 s3, s28, 0
 buffer_store_dwordx4 v[48:51], v16, s[16:19], s3 offen offset:128 nt
 s_waitcnt lgkmcnt(0)
 s_add_u32 s3, s28, 16384
 buffer_store_dwordx4 v[80:83], v16, s[16:19], s3 offen offset:128 nt
 v_and_b32 v7, s26, v7
 v_pk_mul_f32 v[6:7], v[6:7], v[172:173]
 v_cvt_pk_bf16_f32 v10, v6, v7
 v_accvgpr_read_b32 v7, a71
 v_lshlrev_b32 v6, 16, v7
 v_and_b32 v7, s26, v7
 v_pk_mul_f32 v[6:7], v[6:7], v[174:175]
 v_cvt_pk_bf16_f32 v11, v6, v7
 ds_write_b128 v17, v[8:11] offset:4096
 v_accvgpr_read_b32 v7, a100
 v_lshlrev_b32 v6, 16, v7
 v_and_b32 v7, s26, v7
 v_pk_mul_f32 v[6:7], v[6:7], v[204:205]
 v_cvt_pk_bf16_f32 v12, v6, v7
 v_accvgpr_read_b32 v7, a101
 v_lshlrev_b32 v6, 16, v7
 v_and_b32 v7, s26, v7
 v_pk_mul_f32 v[6:7], v[6:7], v[206:207]
 v_cvt_pk_bf16_f32 v13, v6, v7
 v_accvgpr_read_b32 v7, a102
 v_lshlrev_b32 v6, 16, v7
 v_and_b32 v7, s26, v7
 v_pk_mul_f32 v[6:7], v[6:7], v[236:237]
 v_cvt_pk_bf16_f32 v14, v6, v7
 v_accvgpr_read_b32 v7, a103
 v_lshlrev_b32 v6, 16, v7
 v_and_b32 v7, s26, v7
 v_pk_mul_f32 v[6:7], v[6:7], v[238:239]
 v_cvt_pk_bf16_f32 v15, v6, v7
 ds_write_b128 v18, v[12:15] offset:4096
 ds_read_b128 v[48:51], v3 offset:4096
 ds_read_b128 v[80:83], v3 offset:5120
 v_accvgpr_read_b32 v7, a72
 v_lshlrev_b32 v6, 16, v7
 v_and_b32 v7, s26, v7
 v_pk_mul_f32 v[6:7], v[6:7], v[144:145]
 v_cvt_pk_bf16_f32 v8, v6, v7
 v_accvgpr_read_b32 v7, a73
 v_lshlrev_b32 v6, 16, v7
 v_and_b32 v7, s26, v7
 v_pk_mul_f32 v[6:7], v[6:7], v[146:147]
 v_cvt_pk_bf16_f32 v9, v6, v7
 v_accvgpr_read_b32 v7, a74
 v_lshlrev_b32 v6, 16, v7
 s_waitcnt lgkmcnt(1)
 s_add_u32 s3, s28, 32768
 buffer_store_dwordx4 v[48:51], v16, s[16:19], s3 offen offset:128 nt
 s_waitcnt lgkmcnt(0)
 s_add_u32 s3, s28, 49152
 buffer_store_dwordx4 v[80:83], v16, s[16:19], s3 offen offset:128 nt
 v_and_b32 v7, s26, v7
 v_pk_mul_f32 v[6:7], v[6:7], v[176:177]
 v_cvt_pk_bf16_f32 v10, v6, v7
 v_accvgpr_read_b32 v7, a75
 v_lshlrev_b32 v6, 16, v7
 v_and_b32 v7, s26, v7
 v_pk_mul_f32 v[6:7], v[6:7], v[178:179]
 v_cvt_pk_bf16_f32 v11, v6, v7
 ds_write_b128 v17, v[8:11] offset:8192
 v_accvgpr_read_b32 v7, a104
 v_lshlrev_b32 v6, 16, v7
 v_and_b32 v7, s26, v7
 v_pk_mul_f32 v[6:7], v[6:7], v[208:209]
 v_cvt_pk_bf16_f32 v12, v6, v7
 v_accvgpr_read_b32 v7, a105
 v_lshlrev_b32 v6, 16, v7
 v_and_b32 v7, s26, v7
 v_pk_mul_f32 v[6:7], v[6:7], v[210:211]
 v_cvt_pk_bf16_f32 v13, v6, v7
 v_accvgpr_read_b32 v7, a106
 v_lshlrev_b32 v6, 16, v7
 v_and_b32 v7, s26, v7
 v_pk_mul_f32 v[6:7], v[6:7], v[240:241]
 v_cvt_pk_bf16_f32 v14, v6, v7
 v_accvgpr_read_b32 v7, a107
 v_lshlrev_b32 v6, 16, v7
 v_and_b32 v7, s26, v7
 v_pk_mul_f32 v[6:7], v[6:7], v[242:243]
 v_cvt_pk_bf16_f32 v15, v6, v7
 ds_write_b128 v18, v[12:15] offset:8192
 ds_read_b128 v[48:51], v3 offset:8192
 ds_read_b128 v[80:83], v3 offset:9216
 v_accvgpr_read_b32 v7, a76
 v_lshlrev_b32 v6, 16, v7
 v_and_b32 v7, s26, v7
 v_pk_mul_f32 v[6:7], v[6:7], v[148:149]
 v_cvt_pk_bf16_f32 v8, v6, v7
 v_accvgpr_read_b32 v7, a77
 v_lshlrev_b32 v6, 16, v7
 v_and_b32 v7, s26, v7
 v_pk_mul_f32 v[6:7], v[6:7], v[150:151]
 v_cvt_pk_bf16_f32 v9, v6, v7
 v_accvgpr_read_b32 v7, a78
 v_lshlrev_b32 v6, 16, v7
 s_waitcnt lgkmcnt(1)
 s_add_u32 s3, s28, 65536
 buffer_store_dwordx4 v[48:51], v16, s[16:19], s3 offen offset:128 nt
 s_waitcnt lgkmcnt(0)
 s_add_u32 s3, s28, 81920
 buffer_store_dwordx4 v[80:83], v16, s[16:19], s3 offen offset:128 nt
 v_and_b32 v7, s26, v7
 v_pk_mul_f32 v[6:7], v[6:7], v[180:181]
 v_cvt_pk_bf16_f32 v10, v6, v7
 v_accvgpr_read_b32 v7, a79
 v_lshlrev_b32 v6, 16, v7
 v_and_b32 v7, s26, v7
 v_pk_mul_f32 v[6:7], v[6:7], v[182:183]
 v_cvt_pk_bf16_f32 v11, v6, v7
 ds_write_b128 v17, v[8:11] offset:12288
 v_accvgpr_read_b32 v7, a108
 v_lshlrev_b32 v6, 16, v7
 v_and_b32 v7, s26, v7
 v_pk_mul_f32 v[6:7], v[6:7], v[212:213]
 v_cvt_pk_bf16_f32 v12, v6, v7
 v_accvgpr_read_b32 v7, a109
 v_lshlrev_b32 v6, 16, v7
 v_and_b32 v7, s26, v7
 v_pk_mul_f32 v[6:7], v[6:7], v[214:215]
 v_cvt_pk_bf16_f32 v13, v6, v7
 v_accvgpr_read_b32 v7, a110
 v_lshlrev_b32 v6, 16, v7
 v_and_b32 v7, s26, v7
 v_pk_mul_f32 v[6:7], v[6:7], v[244:245]
 v_cvt_pk_bf16_f32 v14, v6, v7
 v_accvgpr_read_b32 v7, a111
 v_lshlrev_b32 v6, 16, v7
 v_and_b32 v7, s26, v7
 v_pk_mul_f32 v[6:7], v[6:7], v[246:247]
 v_cvt_pk_bf16_f32 v15, v6, v7
 ds_write_b128 v18, v[12:15] offset:12288
 ds_read_b128 v[48:51], v3 offset:12288
 ds_read_b128 v[80:83], v3 offset:13312
 v_accvgpr_read_b32 v7, a80
 v_lshlrev_b32 v6, 16, v7
 v_and_b32 v7, s26, v7
 v_pk_mul_f32 v[6:7], v[6:7], v[152:153]
 v_cvt_pk_bf16_f32 v8, v6, v7
 v_accvgpr_read_b32 v7, a81
 v_lshlrev_b32 v6, 16, v7
 v_and_b32 v7, s26, v7
 v_pk_mul_f32 v[6:7], v[6:7], v[154:155]
 v_cvt_pk_bf16_f32 v9, v6, v7
 v_accvgpr_read_b32 v7, a82
 v_lshlrev_b32 v6, 16, v7
 s_waitcnt lgkmcnt(1)
 s_add_u32 s3, s28, 98304
 buffer_store_dwordx4 v[48:51], v16, s[16:19], s3 offen offset:128 nt
 s_waitcnt lgkmcnt(0)
 s_add_u32 s3, s28, 114688
 buffer_store_dwordx4 v[80:83], v16, s[16:19], s3 offen offset:128 nt
 v_and_b32 v7, s26, v7
 v_pk_mul_f32 v[6:7], v[6:7], v[184:185]
 v_cvt_pk_bf16_f32 v10, v6, v7
 v_accvgpr_read_b32 v7, a83
 v_lshlrev_b32 v6, 16, v7
 v_and_b32 v7, s26, v7
 v_pk_mul_f32 v[6:7], v[6:7], v[186:187]
 v_cvt_pk_bf16_f32 v11, v6, v7
 ds_write_b128 v17, v[8:11] offset:16384
 v_accvgpr_read_b32 v7, a112
 v_lshlrev_b32 v6, 16, v7
 v_and_b32 v7, s26, v7
 v_pk_mul_f32 v[6:7], v[6:7], v[216:217]
 v_cvt_pk_bf16_f32 v12, v6, v7
 v_accvgpr_read_b32 v7, a113
 v_lshlrev_b32 v6, 16, v7
 v_and_b32 v7, s26, v7
 v_pk_mul_f32 v[6:7], v[6:7], v[218:219]
 v_cvt_pk_bf16_f32 v13, v6, v7
 v_accvgpr_read_b32 v7, a114
 v_lshlrev_b32 v6, 16, v7
 v_and_b32 v7, s26, v7
 v_pk_mul_f32 v[6:7], v[6:7], v[248:249]
 v_cvt_pk_bf16_f32 v14, v6, v7
 v_accvgpr_read_b32 v7, a115
 v_lshlrev_b32 v6, 16, v7
 v_and_b32 v7, s26, v7
 v_pk_mul_f32 v[6:7], v[6:7], v[250:251]
 v_cvt_pk_bf16_f32 v15, v6, v7
 ds_write_b128 v18, v[12:15] offset:16384
 ds_read_b128 v[48:51], v3 offset:16384
 ds_read_b128 v[80:83], v3 offset:17408
 v_accvgpr_read_b32 v7, a84
 v_lshlrev_b32 v6, 16, v7
 v_and_b32 v7, s26, v7
 v_pk_mul_f32 v[6:7], v[6:7], v[156:157]
 v_cvt_pk_bf16_f32 v8, v6, v7
 v_accvgpr_read_b32 v7, a85
 v_lshlrev_b32 v6, 16, v7
 v_and_b32 v7, s26, v7
 v_pk_mul_f32 v[6:7], v[6:7], v[158:159]
 v_cvt_pk_bf16_f32 v9, v6, v7
 v_accvgpr_read_b32 v7, a86
 v_lshlrev_b32 v6, 16, v7
 s_waitcnt lgkmcnt(1)
 s_add_u32 s3, s28, 131072
 buffer_store_dwordx4 v[48:51], v16, s[16:19], s3 offen offset:128 nt
 s_waitcnt lgkmcnt(0)
 s_add_u32 s3, s28, 147456
 buffer_store_dwordx4 v[80:83], v16, s[16:19], s3 offen offset:128 nt
 v_and_b32 v7, s26, v7
 v_pk_mul_f32 v[6:7], v[6:7], v[188:189]
 v_cvt_pk_bf16_f32 v10, v6, v7
 v_accvgpr_read_b32 v7, a87
 v_lshlrev_b32 v6, 16, v7
 v_and_b32 v7, s26, v7
 v_pk_mul_f32 v[6:7], v[6:7], v[190:191]
 v_cvt_pk_bf16_f32 v11, v6, v7
 ds_write_b128 v17, v[8:11] offset:20480
 v_accvgpr_read_b32 v7, a116
 v_lshlrev_b32 v6, 16, v7
 v_and_b32 v7, s26, v7
 v_pk_mul_f32 v[6:7], v[6:7], v[220:221]
 v_cvt_pk_bf16_f32 v12, v6, v7
 v_accvgpr_read_b32 v7, a117
 v_lshlrev_b32 v6, 16, v7
 v_and_b32 v7, s26, v7
 v_pk_mul_f32 v[6:7], v[6:7], v[222:223]
 v_cvt_pk_bf16_f32 v13, v6, v7
 v_accvgpr_read_b32 v7, a118
 v_lshlrev_b32 v6, 16, v7
 v_and_b32 v7, s26, v7
 v_pk_mul_f32 v[6:7], v[6:7], v[252:253]
 v_cvt_pk_bf16_f32 v14, v6, v7
 v_accvgpr_read_b32 v7, a119
 v_lshlrev_b32 v6, 16, v7
 v_and_b32 v7, s26, v7
 v_pk_mul_f32 v[6:7], v[6:7], v[254:255]
 v_cvt_pk_bf16_f32 v15, v6, v7
 ds_write_b128 v18, v[12:15] offset:20480
 ds_read_b128 v[48:51], v3 offset:20480
 ds_read_b128 v[80:83], v3 offset:21504
 v_accvgpr_read_b32 v7, a88
 v_lshlrev_b32 v6, 16, v7
 v_and_b32 v7, s26, v7
 v_pk_mul_f32 v[6:7], v[6:7], v[160:161]
 v_cvt_pk_bf16_f32 v8, v6, v7
 v_accvgpr_read_b32 v7, a89
 v_lshlrev_b32 v6, 16, v7
 v_and_b32 v7, s26, v7
 v_pk_mul_f32 v[6:7], v[6:7], v[162:163]
 v_cvt_pk_bf16_f32 v9, v6, v7
 v_accvgpr_read_b32 v7, a90
 v_lshlrev_b32 v6, 16, v7
 s_waitcnt lgkmcnt(1)
 s_add_u32 s3, s28, 163840
 buffer_store_dwordx4 v[48:51], v16, s[16:19], s3 offen offset:128 nt
 s_waitcnt lgkmcnt(0)
 s_add_u32 s3, s28, 180224
 buffer_store_dwordx4 v[80:83], v16, s[16:19], s3 offen offset:128 nt
 v_and_b32 v7, s26, v7
 v_pk_mul_f32 v[6:7], v[6:7], v[192:193]
 v_cvt_pk_bf16_f32 v10, v6, v7
 v_accvgpr_read_b32 v7, a91
 v_lshlrev_b32 v6, 16, v7
 v_and_b32 v7, s26, v7
 v_pk_mul_f32 v[6:7], v[6:7], v[194:195]
 v_cvt_pk_bf16_f32 v11, v6, v7
 ds_write_b128 v17, v[8:11] offset:24576
 v_accvgpr_read_b32 v7, a120
 v_lshlrev_b32 v6, 16, v7
 v_and_b32 v7, s26, v7
 v_pk_mul_f32 v[6:7], v[6:7], v[224:225]
 v_cvt_pk_bf16_f32 v12, v6, v7
 v_accvgpr_read_b32 v7, a121
 v_lshlrev_b32 v6, 16, v7
 v_and_b32 v7, s26, v7
 v_pk_mul_f32 v[6:7], v[6:7], v[226:227]
 v_cvt_pk_bf16_f32 v13, v6, v7
 v_accvgpr_read_b32 v7, a122
 v_accvgpr_read_b32 v112, a248
 v_accvgpr_read_b32 v113, a249
 v_lshlrev_b32 v6, 16, v7
 v_and_b32 v7, s26, v7
 v_pk_mul_f32 v[6:7], v[6:7], v[112:113]
 v_cvt_pk_bf16_f32 v14, v6, v7
 v_accvgpr_read_b32 v7, a123
 v_accvgpr_read_b32 v112, a250
 v_accvgpr_read_b32 v113, a251
 v_lshlrev_b32 v6, 16, v7
 v_and_b32 v7, s26, v7
 v_pk_mul_f32 v[6:7], v[6:7], v[112:113]
 v_cvt_pk_bf16_f32 v15, v6, v7
 ds_write_b128 v18, v[12:15] offset:24576
 ds_read_b128 v[48:51], v3 offset:24576
 ds_read_b128 v[80:83], v3 offset:25600
 v_accvgpr_read_b32 v7, a92
 v_lshlrev_b32 v6, 16, v7
 v_and_b32 v7, s26, v7
 v_pk_mul_f32 v[6:7], v[6:7], v[164:165]
 v_cvt_pk_bf16_f32 v8, v6, v7
 v_accvgpr_read_b32 v7, a93
 v_lshlrev_b32 v6, 16, v7
 v_and_b32 v7, s26, v7
 v_pk_mul_f32 v[6:7], v[6:7], v[166:167]
 v_cvt_pk_bf16_f32 v9, v6, v7
 v_accvgpr_read_b32 v7, a94
 v_lshlrev_b32 v6, 16, v7
 s_waitcnt lgkmcnt(1)
 s_add_u32 s3, s28, 196608
 buffer_store_dwordx4 v[48:51], v16, s[16:19], s3 offen offset:128 nt
 s_waitcnt lgkmcnt(0)
 s_add_u32 s3, s28, 212992
 buffer_store_dwordx4 v[80:83], v16, s[16:19], s3 offen offset:128 nt
 v_and_b32 v7, s26, v7
 v_pk_mul_f32 v[6:7], v[6:7], v[196:197]
 v_cvt_pk_bf16_f32 v10, v6, v7
 v_accvgpr_read_b32 v7, a95
 v_lshlrev_b32 v6, 16, v7
 v_and_b32 v7, s26, v7
 v_pk_mul_f32 v[6:7], v[6:7], v[198:199]
 v_cvt_pk_bf16_f32 v11, v6, v7
 ds_write_b128 v17, v[8:11] offset:28672
 v_accvgpr_read_b32 v7, a124
 v_lshlrev_b32 v6, 16, v7
 v_and_b32 v7, s26, v7
 v_pk_mul_f32 v[6:7], v[6:7], v[228:229]
 v_cvt_pk_bf16_f32 v12, v6, v7
 v_accvgpr_read_b32 v7, a125
 v_lshlrev_b32 v6, 16, v7
 v_and_b32 v7, s26, v7
 v_pk_mul_f32 v[6:7], v[6:7], v[230:231]
 v_cvt_pk_bf16_f32 v13, v6, v7
 v_accvgpr_read_b32 v7, a126
 v_accvgpr_read_b32 v112, a252
 v_accvgpr_read_b32 v113, a253
 v_lshlrev_b32 v6, 16, v7
 v_and_b32 v7, s26, v7
 v_pk_mul_f32 v[6:7], v[6:7], v[112:113]
 v_cvt_pk_bf16_f32 v14, v6, v7
 v_accvgpr_read_b32 v7, a127
 v_accvgpr_read_b32 v112, a254
 v_accvgpr_read_b32 v113, a255
 v_lshlrev_b32 v6, 16, v7
 v_and_b32 v7, s26, v7
 v_pk_mul_f32 v[6:7], v[6:7], v[112:113]
 v_cvt_pk_bf16_f32 v15, v6, v7
 ds_write_b128 v18, v[12:15] offset:28672
 ds_read_b128 v[48:51], v3 offset:28672
 ds_read_b128 v[80:83], v3 offset:29696
 s_waitcnt lgkmcnt(1)
 s_add_u32 s3, s28, 229376
 buffer_store_dwordx4 v[48:51], v16, s[16:19], s3 offen offset:128 nt
 s_waitcnt lgkmcnt(0)
 s_add_u32 s3, s28, 245760
 buffer_store_dwordx4 v[80:83], v16, s[16:19], s3 offen offset:128 nt
Lend:
 s_endpgm
Lspin_pro:
 s_add_u32 s53, s53, 1
 v_lshlrev_b32 v4, 2, v3
 v_and_b32 v4, 192, v4
 buffer_load_dword v4, v4, s[44:47], 0 offen sc1
 s_cmp_ge_u32 s53, 0x100000
 s_cbranch_scc1 Lgiveup_pro
 s_waitcnt vmcnt(0)
 v_cmp_gt_i32 vcc, s27, v4
 s_and_b64 vcc, exec, vcc
 s_cbranch_vccnz Lspin_pro
Lgiveup_pro:
 s_waitcnt vmcnt(0)
 s_branch Lok_pro
Lspin_pa:
 s_add_u32 s53, s53, 1
 buffer_load_dword v4, off, s[64:67], 0 sc1
 s_cmp_ge_u32 s53, 0x100000
 s_cbranch_scc1 Lgiveup_pa
 s_waitcnt vmcnt(0)
 v_cmp_gt_i32 vcc, s55, v4
 s_and_b64 vcc, exec, vcc
 s_cbranch_vccnz Lspin_pa
Lgiveup_pa:
 s_waitcnt vmcnt(0)
 s_branch Lok_pa
Lgat0:
 v_lshrrev_b32 v5, 4, v3
 v_and_b32 v5, 0x20, v5
 v_xor_b32 v5, v5, v3
 v_and_b32 v5, 0x30, v5
 v_bfe_u32 v6, v3, 6, 4
 v_lshl_add_u32 v6, v6, 11, v5
 s_branch Lgatr0
Lxrg:
 v_lshrrev_b32 v5, 2, v3
 v_and_b32 v5, 0x20, v5
 v_lshrrev_b32 v2, 4, v3
 v_xor_b32 v5, v5, v2
 v_and_b32 v5, 0x30, v5
 v_bfe_u32 v1, v3, 4, 4
 v_lshl_add_u32 v1, v1, 6, v5
 v_add_u32 v2, 0x10000, v1
 s_branch Lxrgr
Lspin_pb:
 s_add_u32 s53, s53, 1
 buffer_load_dword v4, off, s[64:67], 0 sc1
 s_cmp_ge_u32 s53, 0x100000
 s_cbranch_scc1 Lgiveup_pb
 s_waitcnt vmcnt(0)
 v_cmp_gt_i32 vcc, s55, v4
 s_and_b64 vcc, exec, vcc
 s_cbranch_vccnz Lspin_pb
Lgiveup_pb:
 s_waitcnt vmcnt(0)
 s_branch Lok_pb
Lgat1:
 v_lshrrev_b32 v5, 4, v3
 v_and_b32 v5, 0x20, v5
 v_xor_b32 v5, v5, v3
 v_and_b32 v5, 0x30, v5
 v_bfe_u32 v6, v3, 6, 4
 v_lshl_add_u32 v6, v6, 11, v5
 s_branch Lgatr1
Lspin_w:
 s_add_u32 s53, s53, 1
 v_lshlrev_b32 v4, 2, v3
 v_and_b32 v4, 192, v4
 buffer_load_dword v4, v4, s[44:47], 0 offen sc1
 s_cmp_ge_u32 s53, 0x100000
 s_cbranch_scc1 Lgiveup_w
 s_waitcnt vmcnt(0)
 v_cmp_gt_i32 vcc, s27, v4
 s_and_b64 vcc, exec, vcc
 s_cbranch_vccnz Lspin_w
Lgiveup_w:
 s_waitcnt vmcnt(0)
 s_branch Lok_w
.section .rodata,"a"
.p2align 6
.amdhsa_kernel standalone__cross_network_dcn__recsys_kernel
  .amdhsa_next_free_vgpr 512
  .amdhsa_next_free_sgpr 102
  .amdhsa_accum_offset 256
  .amdhsa_group_segment_fixed_size 0
  .amdhsa_kernarg_size 48
  .amdhsa_user_sgpr_count 2
  .amdhsa_user_sgpr_kernarg_segment_ptr 1
  .amdhsa_system_sgpr_workgroup_id_x 1
  .amdhsa_float_denorm_mode_32 3
.end_amdhsa_kernel
```

```asm
; @launch grid=(256,1,1) block=(256,1,1) lds=151552
.amdgcn_target "amdgcn-amd-amdhsa--gfx950"
.text
.globl standalone__cross_network_dcn__recsys_kernel
.p2align 8
.type standalone__cross_network_dcn__recsys_kernel,@function
standalone__cross_network_dcn__recsys_kernel:
 s_cmp_ge_u32 s2, 256
 s_cbranch_scc1 Lend
 s_load_dwordx4 s[56:59], s[0:1], 0
 s_load_dwordx4 s[60:63], s[0:1], 16
 s_load_dwordx4 s[64:67], s[0:1], 32
 v_lshrrev_b32 v9, 6, v0
 v_and_b32 v10, 63, v0
 v_readfirstlane_b32 s54, v9
 v_lshlrev_b32 v1, 4, v10
 s_getpc_b64 s[4:5]
Lpc:
 v_lshlrev_b32 v11, 6, v0
 s_bfe_u32 s3, s2, 0x20003
 s_lshl_b32 s3, s3, 14
 v_add_u32 v11, s3, v11
 v_min_u32 v12, Lend-Lpc, v11
 global_load_dword v60, v12, s[4:5]
 v_add_u32 v11, 16384, v11
 v_lshrrev_b32 v11, 7, v0
 v_and_b32 v12, 127, v0
 v_lshlrev_b32 v12, 3, v12
 v_lshl_add_u32 v30, v11, 11, v12
 v_lshlrev_b32 v31, 4, v0
 v_add_u32 v31, 131072, v31
 v_add_u32 v2, 65536, v1
 v_lshl_add_u32 v3, v9, 15, v1
 v_lshl_add_u32 v0, v9, 18, v1
 s_and_b32 s7, s2, 1
 s_lshr_b32 s28, s2, 1
 s_lshl_b32 s28, s28, 18
 s_lshl_b32 s6, s7, 10
 s_add_u32 s28, s28, s6
 s_lshl_b32 s6, s54, 8
 s_add_u32 s28, s28, s6
 s_mov_b32 s26, 0xffff0000
 s_lshl_b32 s24, s7, 20
 s_mov_b32 s25, 0
 s_mov_b32 s53, 0
 s_mov_b32 s31, -1
 s_mov_b32 s27, 64
 s_mov_b32 s55, -1
 s_lshl_b32 s50, s54, 15
 s_lshl_b32 s29, s2, 17
 s_add_u32 s29, s29, 33554432
 s_xor_b32 s30, s29, 131072
 s_lshr_b32 s4, s2, 3
 s_and_b32 s5, s2, 7
 s_lshl_b32 s48, s4, 16
 s_lshl_b32 s6, s5, 8
 s_add_u32 s48, s48, s6
 s_lshl_b32 s6, s54, 6
 s_add_u32 s48, s48, s6
 s_lshl_b32 s49, s5, 18
 s_and_b32 s6, s4, 1
 s_lshl_b32 s6, s6, 10
 s_add_u32 s49, s49, s6
 s_lshr_b32 s6, s4, 4
 s_lshr_b32 s5, s5, 2
 s_xor_b32 s5, s5, s6
 s_bfe_u32 s6, s4, 0x10001
 s_lshl_b32 s3, s5, 1
 s_add_u32 s3, s3, s6
 s_lshl_b32 s3, s3, 16
 s_add_u32 s49, s49, s3
 s_bfe_u32 s4, s4, 0x20002
 s_xor_b32 s5, s5, s6
 s_lshr_b32 s3, s54, 1
 s_lshl_b32 s3, s3, 4
 s_lshl_b32 s6, s4, 2
 s_add_u32 s3, s3, s6
 s_and_b32 s6, s54, 1
 s_lshl_b32 s6, s6, 1
 s_add_u32 s3, s3, s6
 s_lshl_b32 s4, s4, 3
 s_lshl_b32 s6, s54, 1
 s_add_u32 s4, s4, s6
 s_cmp_eq_u32 s5, 0
 s_cselect_b32 s3, s3, s4
 s_lshl_b32 s3, s3, 11
 s_add_u32 s49, s49, s3
 s_lshl_b32 s52, s54, 11
 s_add_u32 s52, s52, 143360
 s_lshl_b32 s51, s54, 9
 s_add_u32 s51, s51, 131072
 s_waitcnt lgkmcnt(0)
 s_mov_b32 s40, s58
 s_mov_b32 s41, s59
 s_mov_b32 s42, 0xc00000
 s_mov_b32 s43, 0x20000
 v_lshrrev_b32 v5, 6, v1
 v_and_b32 v6, 48, v1
 v_lshl_add_u32 v5, v5, 11, v6
 s_mov_b32 m0, s52
 s_add_u32 s3, s48, 31744
 buffer_load_dwordx4 v5, s[40:43], s48 offen lds
 buffer_load_dwordx4 v5, s[40:43], s3 offen offset:1024 lds
 s_add_u32 s48, s48, 2097152
 s_mov_b32 s20, s60
 s_mov_b32 s21, s61
 s_mov_b32 s22, 0x3000
 s_mov_b32 s23, 0x20000
 s_lshl_b32 s3, s7, 10
 buffer_load_dwordx2 v[32:33], v30, s[20:23], s3 offen
 s_add_u32 s3, s3, 4096
 buffer_load_dwordx2 v[34:35], v30, s[20:23], s3 offen
 s_add_u32 s3, s3, 4096
 buffer_load_dwordx2 v[36:37], v30, s[20:23], s3 offen
 s_add_u32 s3, s3, 4096
 s_mov_b32 s8, s56
 s_mov_b32 s9, s57
 s_mov_b32 s10, 0x2000000
 s_mov_b32 s11, 0x20000
 s_mov_b32 s16, s62
 s_mov_b32 s17, s63
 s_mov_b32 s18, 0x2000000
 s_mov_b32 s19, 0x20000
 s_mov_b32 s12, s66
 s_mov_b32 s13, s67
 s_mov_b32 s14, 0xc00000
 s_mov_b32 s15, 0x20000
 s_mov_b32 s32, s66
 s_mov_b32 s33, s67
 s_mov_b32 s34, 0x10000000
 s_mov_b32 s35, 0x20000
 s_mov_b32 s44, s64
 s_mov_b32 s45, s65
 s_mov_b32 s46, 0x100
 s_mov_b32 s47, 0x20000
 s_add_u32 s24, s24, 4096
 s_add_u32 s70, s66, s24
 s_addc_u32 s71, s67, 0
 s_sub_u32 s24, s24, 4096
 s_and_b32 s3, s2, 3
 s_lshl_b32 s3, s3, 6
 s_add_u32 s56, s44, s3
 s_addc_u32 s57, s45, 0
 s_mov_b32 s58, 0x4
 s_mov_b32 s59, 0x20000
 s_lshl_b32 s3, s2, 2
 s_add_u32 s3, s3, s54
 s_lshl_b32 s3, s3, 7
 s_add_u32 s3, s3, 15728640
 s_add_u32 s60, s32, s3
 s_addc_u32 s61, s33, 0
 s_mov_b32 s62, 0x4
 s_mov_b32 s63, 0x20000
 s_xor_b32 s3, s3, 512
 s_add_u32 s64, s32, s3
 s_addc_u32 s65, s33, 0
 s_mov_b32 s66, 0x4
 s_mov_b32 s67, 0x20000
 v_lshrrev_b32 v5, 2, v1
 v_and_b32 v5, 64, v5
 v_xor_b32 v5, v5, v1
 v_and_b32 v5, 112, v5
 v_lshrrev_b32 v6, 7, v1
 v_lshl_add_u32 v23, v6, 11, v5
 s_and_b32 s69, s28, 2047
 s_lshl_b32 s3, s7, 20
 s_add_u32 s69, s69, s3
 s_add_u32 m0, s50, 0
 s_add_u32 s3, s69, 0
 buffer_load_dwordx4 v23, s[40:43], s3 offen lds
 s_add_u32 m0, s50, 1024
 s_add_u32 s3, s69, 16384
 buffer_load_dwordx4 v23, s[40:43], s3 offen lds
 s_add_u32 m0, s50, 4096
 s_add_u32 s3, s69, 32768
 buffer_load_dwordx4 v23, s[40:43], s3 offen lds
 s_add_u32 m0, s50, 5120
 s_add_u32 s3, s69, 49152
 buffer_load_dwordx4 v23, s[40:43], s3 offen lds
 s_add_u32 m0, s50, 8192
 s_add_u32 s3, s69, 65536
 buffer_load_dwordx4 v23, s[40:43], s3 offen lds
 s_add_u32 m0, s50, 9216
 s_add_u32 s3, s69, 81920
 buffer_load_dwordx4 v23, s[40:43], s3 offen lds
 s_add_u32 m0, s50, 12288
 s_add_u32 s3, s69, 98304
 buffer_load_dwordx4 v23, s[40:43], s3 offen lds
 s_add_u32 m0, s50, 13312
 s_add_u32 s3, s69, 114688
 buffer_load_dwordx4 v23, s[40:43], s3 offen lds
 s_add_u32 m0, s50, 16384
 s_add_u32 s3, s69, 262144
 buffer_load_dwordx4 v23, s[40:43], s3 offen lds
 s_add_u32 m0, s50, 17408
 s_add_u32 s3, s69, 278528
 buffer_load_dwordx4 v23, s[40:43], s3 offen lds
 s_add_u32 m0, s50, 20480
 s_add_u32 s3, s69, 294912
 buffer_load_dwordx4 v23, s[40:43], s3 offen lds
 s_add_u32 m0, s50, 21504
 s_add_u32 s3, s69, 311296
 buffer_load_dwordx4 v23, s[40:43], s3 offen lds
 s_add_u32 m0, s50, 24576
 s_add_u32 s3, s69, 327680
 buffer_load_dwordx4 v23, s[40:43], s3 offen lds
 s_add_u32 m0, s50, 25600
 s_add_u32 s3, s69, 344064
 buffer_load_dwordx4 v23, s[40:43], s3 offen lds
 s_add_u32 m0, s50, 28672
 s_add_u32 s3, s69, 360448
 buffer_load_dwordx4 v23, s[40:43], s3 offen lds
 s_add_u32 m0, s50, 29696
 s_add_u32 s3, s69, 376832
 buffer_load_dwordx4 v23, s[40:43], s3 offen lds
 v_mov_b32 v7, 0
 buffer_store_dword v7, v1, s[60:63], 0 offen sc1
 v_lshrrev_b32 v5, 7, v1
 v_lshlrev_b32 v6, 4, v5
 v_xor_b32 v6, v6, v1
 v_and_b32 v6, 112, v6
 v_lshl_add_u32 v20, v5, 11, v6
 v_lshrrev_b32 v5, 4, v1
 v_and_b32 v5, 48, v5
 v_xor_b32 v5, v5, v1
 v_and_b32 v5, 112, v5
 v_and_b32 v6, 240, v1
 v_lshl_add_u32 v5, v6, 3, v5
 v_add_u32 v21, s50, v5
 v_xor_b32 v22, 64, v21
 v_lshrrev_b32 v5, 1, v1
 v_and_b32 v5, 64, v5
 v_and_b32 v6, 48, v1
 v_or_b32 v5, v5, v6
 v_and_b32 v6, 192, v1
 v_lshl_add_u32 v5, v6, 1, v5
 v_and_b32 v6, 256, v1
 v_lshl_add_u32 v5, v6, 2, v5
 v_and_b32 v6, 512, v1
 v_lshl_add_u32 v5, v6, 3, v5
 v_add_u32 v24, s50, v5
 v_xor_b32 v25, 64, v24
 v_mov_b32 v64, 1.0
 v_mov_b32 v65, 1.0
 v_mov_b32 v66, 1.0
 v_mov_b32 v67, 1.0
 v_mov_b32 v68, 1.0
 v_mov_b32 v69, 1.0
 v_mov_b32 v70, 1.0
 v_mov_b32 v71, 1.0
 v_mov_b32 v72, 1.0
 v_mov_b32 v73, 1.0
 v_mov_b32 v74, 1.0
 v_mov_b32 v75, 1.0
 v_mov_b32 v76, 1.0
 v_mov_b32 v77, 1.0
 v_mov_b32 v78, 1.0
 v_mov_b32 v79, 1.0
 v_mov_b32 v80, 1.0
 v_mov_b32 v81, 1.0
 v_mov_b32 v82, 1.0
 v_mov_b32 v83, 1.0
 v_mov_b32 v84, 1.0
 v_mov_b32 v85, 1.0
 v_mov_b32 v86, 1.0
 v_mov_b32 v87, 1.0
 v_mov_b32 v88, 1.0
 v_mov_b32 v89, 1.0
 v_mov_b32 v90, 1.0
 v_mov_b32 v91, 1.0
 v_mov_b32 v92, 1.0
 v_mov_b32 v93, 1.0
 v_mov_b32 v94, 1.0
 v_mov_b32 v95, 1.0
 v_mov_b32 v96, 1.0
 v_mov_b32 v97, 1.0
 v_mov_b32 v98, 1.0
 v_mov_b32 v99, 1.0
 v_mov_b32 v100, 1.0
 v_mov_b32 v101, 1.0
 v_mov_b32 v102, 1.0
 v_mov_b32 v103, 1.0
 v_mov_b32 v104, 1.0
 v_mov_b32 v105, 1.0
 v_mov_b32 v106, 1.0
 v_mov_b32 v107, 1.0
 v_mov_b32 v108, 1.0
 v_mov_b32 v109, 1.0
 v_mov_b32 v110, 1.0
 v_mov_b32 v111, 1.0
 v_mov_b32 v112, 1.0
 v_mov_b32 v113, 1.0
 v_mov_b32 v114, 1.0
 v_mov_b32 v115, 1.0
 v_mov_b32 v116, 1.0
 v_mov_b32 v117, 1.0
 v_mov_b32 v118, 1.0
 v_mov_b32 v119, 1.0
 v_mov_b32 v120, 1.0
 v_mov_b32 v121, 1.0
 v_mov_b32 v122, 1.0
 v_mov_b32 v123, 1.0
 v_mov_b32 v124, 1.0
 v_mov_b32 v125, 1.0
 v_mov_b32 v126, 1.0
 v_mov_b32 v127, 1.0
 v_mov_b32 v128, 1.0
 v_mov_b32 v129, 1.0
 v_mov_b32 v130, 1.0
 v_mov_b32 v131, 1.0
 v_mov_b32 v132, 1.0
 v_mov_b32 v133, 1.0
 v_mov_b32 v134, 1.0
 v_mov_b32 v135, 1.0
 v_accvgpr_write_b32 a240, 1.0
 v_accvgpr_write_b32 a241, 1.0
 v_accvgpr_write_b32 a242, 1.0
 v_accvgpr_write_b32 a243, 1.0
 v_accvgpr_write_b32 a244, 1.0
 v_accvgpr_write_b32 a245, 1.0
 v_accvgpr_write_b32 a246, 1.0
 v_accvgpr_write_b32 a247, 1.0
 v_mov_b32 v216, 1.0
 v_mov_b32 v217, 1.0
 v_mov_b32 v218, 1.0
 v_mov_b32 v219, 1.0
 v_mov_b32 v220, 1.0
 v_mov_b32 v221, 1.0
 v_mov_b32 v222, 1.0
 v_mov_b32 v223, 1.0
 v_mov_b32 v224, 1.0
 v_mov_b32 v225, 1.0
 v_mov_b32 v226, 1.0
 v_mov_b32 v227, 1.0
 v_mov_b32 v228, 1.0
 v_mov_b32 v229, 1.0
 v_mov_b32 v230, 1.0
 v_mov_b32 v231, 1.0
 v_mov_b32 v232, 1.0
 v_mov_b32 v233, 1.0
 v_mov_b32 v234, 1.0
 v_mov_b32 v235, 1.0
 v_mov_b32 v236, 1.0
 v_mov_b32 v237, 1.0
 v_mov_b32 v238, 1.0
 v_mov_b32 v239, 1.0
 v_mov_b32 v240, 1.0
 v_mov_b32 v241, 1.0
 v_mov_b32 v242, 1.0
 v_mov_b32 v243, 1.0
 v_mov_b32 v244, 1.0
 v_mov_b32 v245, 1.0
 v_mov_b32 v246, 1.0
 v_mov_b32 v247, 1.0
 v_mov_b32 v248, 1.0
 v_mov_b32 v249, 1.0
 v_mov_b32 v250, 1.0
 v_mov_b32 v251, 1.0
 v_mov_b32 v252, 1.0
 v_mov_b32 v253, 1.0
 v_mov_b32 v254, 1.0
 v_mov_b32 v255, 1.0
 v_accvgpr_write_b32 a248, 1.0
 v_accvgpr_write_b32 a249, 1.0
 v_accvgpr_write_b32 a250, 1.0
 v_accvgpr_write_b32 a251, 1.0
 v_accvgpr_write_b32 a252, 1.0
 v_accvgpr_write_b32 a253, 1.0
 v_accvgpr_write_b32 a254, 1.0
 v_accvgpr_write_b32 a255, 1.0
 v_and_b32 v5, 768, v3
 v_and_b32 v7, 1023, v3
 v_add3_u32 v5, v5, v7, s52
 s_waitcnt vmcnt(20)
 ds_read_b64_tr_b16 v[8:9], v5 offset:0
 ds_read_b64_tr_b16 v[10:11], v5 offset:256
 ds_read_b64_tr_b16 v[12:13], v5 offset:8
 ds_read_b64_tr_b16 v[14:15], v5 offset:264
 s_waitcnt lgkmcnt(2)
 buffer_store_dwordx4 v[8:11], v7, s[12:15], s49 offen sc1
 s_waitcnt lgkmcnt(0)
 buffer_store_dwordx4 v[12:15], v7, s[12:15], s49 offen offset:2048 sc1
 s_add_u32 s49, s49, 2097152
 s_add_u32 m0, s50, 2048
 s_add_u32 s3, s69, 524288
 buffer_load_dwordx4 v23, s[40:43], s3 offen lds
 s_add_u32 m0, s50, 3072
 s_add_u32 s3, s69, 540672
 buffer_load_dwordx4 v23, s[40:43], s3 offen lds
 s_add_u32 m0, s50, 6144
 s_add_u32 s3, s69, 557056
 buffer_load_dwordx4 v23, s[40:43], s3 offen lds
 s_add_u32 m0, s50, 7168
 s_add_u32 s3, s69, 573440
 buffer_load_dwordx4 v23, s[40:43], s3 offen lds
 s_add_u32 m0, s50, 10240
 s_add_u32 s3, s69, 589824
 buffer_load_dwordx4 v23, s[40:43], s3 offen lds
 s_add_u32 m0, s50, 11264
 s_add_u32 s3, s69, 606208
 buffer_load_dwordx4 v23, s[40:43], s3 offen lds
 s_add_u32 m0, s50, 14336
 s_add_u32 s3, s69, 622592
 buffer_load_dwordx4 v23, s[40:43], s3 offen lds
 s_add_u32 m0, s50, 15360
 s_add_u32 s3, s69, 638976
 buffer_load_dwordx4 v23, s[40:43], s3 offen lds
 s_waitcnt vmcnt(29)
 v_lshlrev_b32 v40, 16, v32
 v_and_b32 v41, s26, v32
 v_lshlrev_b32 v42, 16, v33
 v_and_b32 v43, s26, v33
 ds_write_b128 v31, v[40:43]
 s_waitcnt vmcnt(28)
 v_lshlrev_b32 v44, 16, v34
 v_and_b32 v45, s26, v34
 v_lshlrev_b32 v46, 16, v35
 v_and_b32 v47, s26, v35
 ds_write_b128 v31, v[44:47] offset:4096
 s_waitcnt vmcnt(27)
 v_lshlrev_b32 v48, 16, v36
 v_and_b32 v49, s26, v36
 v_lshlrev_b32 v50, 16, v37
 v_and_b32 v51, s26, v37
 ds_write_b128 v31, v[48:51] offset:8192
 s_waitcnt lgkmcnt(0)
 v_mov_b32 v32, 1.0
 v_mov_b32 v33, 1.0
 v_mov_b32 v34, 1.0
 v_mov_b32 v35, 1.0
 v_mov_b32 v36, 1.0
 v_mov_b32 v37, 1.0
 v_mov_b32 v38, 1.0
 v_mov_b32 v39, 1.0
 v_mov_b32 v40, 1.0
 v_mov_b32 v41, 1.0
 v_mov_b32 v42, 1.0
 v_mov_b32 v43, 1.0
 v_mov_b32 v44, 1.0
 v_mov_b32 v45, 1.0
 v_mov_b32 v46, 1.0
 v_mov_b32 v47, 1.0
 v_mov_b32 v48, 1.0
 v_mov_b32 v49, 1.0
 v_mov_b32 v50, 1.0
 v_mov_b32 v51, 1.0
 v_mov_b32 v52, 1.0
 v_mov_b32 v53, 1.0
 v_mov_b32 v54, 1.0
 v_mov_b32 v55, 1.0
 v_mov_b32 v56, 1.0
 v_mov_b32 v57, 1.0
 v_mov_b32 v58, 1.0
 v_mov_b32 v59, 1.0
 v_mov_b32 v60, 1.0
 v_mov_b32 v61, 1.0
 v_mov_b32 v62, 1.0
 v_mov_b32 v63, 1.0
 s_waitcnt vmcnt(23)
 ds_read_b64_tr_b16 v[136:137], v24 offset:0
 ds_read_b64_tr_b16 v[138:139], v24 offset:512
 ds_read_b64_tr_b16 v[144:145], v24 offset:8
 ds_read_b64_tr_b16 v[146:147], v24 offset:520
 ds_read_b64_tr_b16 v[152:153], v25 offset:0
 ds_read_b64_tr_b16 v[154:155], v25 offset:512
 ds_read_b64_tr_b16 v[160:161], v25 offset:8
 ds_read_b64_tr_b16 v[162:163], v25 offset:520
 s_waitcnt vmcnt(19)
 ds_read_b64_tr_b16 v[140:141], v24 offset:8192
 ds_read_b64_tr_b16 v[142:143], v24 offset:8704
 ds_read_b64_tr_b16 v[148:149], v24 offset:8200
 ds_read_b64_tr_b16 v[150:151], v24 offset:8712
 ds_read_b64_tr_b16 v[156:157], v25 offset:8192
 ds_read_b64_tr_b16 v[158:159], v25 offset:8704
 ds_read_b64_tr_b16 v[164:165], v25 offset:8200
 ds_read_b64_tr_b16 v[166:167], v25 offset:8712
 s_waitcnt lgkmcnt(8)
 s_add_u32 m0, s50, 0
 s_add_u32 s3, s28, 0
 buffer_load_dwordx4 v20, s[8:11], s3 offen lds
 s_add_u32 m0, s50, 1024
 s_add_u32 s3, s28, 16384
 buffer_load_dwordx4 v20, s[8:11], s3 offen lds
 s_add_u32 m0, s50, 4096
 s_add_u32 s3, s28, 32768
 buffer_load_dwordx4 v20, s[8:11], s3 offen lds
 s_add_u32 m0, s50, 5120
 s_add_u32 s3, s28, 49152
 buffer_load_dwordx4 v20, s[8:11], s3 offen lds
 s_waitcnt vmcnt(19)
 ds_read_b64_tr_b16 v[168:169], v24 offset:16384
 ds_read_b64_tr_b16 v[170:171], v24 offset:16896
 ds_read_b64_tr_b16 v[176:177], v24 offset:16392
 ds_read_b64_tr_b16 v[178:179], v24 offset:16904
 ds_read_b64_tr_b16 v[184:185], v25 offset:16384
 ds_read_b64_tr_b16 v[186:187], v25 offset:16896
 ds_read_b64_tr_b16 v[192:193], v25 offset:16392
 ds_read_b64_tr_b16 v[194:195], v25 offset:16904
 s_waitcnt vmcnt(15)
 ds_read_b64_tr_b16 v[172:173], v24 offset:24576
 ds_read_b64_tr_b16 v[174:175], v24 offset:25088
 ds_read_b64_tr_b16 v[180:181], v24 offset:24584
 ds_read_b64_tr_b16 v[182:183], v24 offset:25096
 ds_read_b64_tr_b16 v[188:189], v25 offset:24576
 ds_read_b64_tr_b16 v[190:191], v25 offset:25088
 ds_read_b64_tr_b16 v[196:197], v25 offset:24584
 ds_read_b64_tr_b16 v[198:199], v25 offset:25096
 s_waitcnt vmcnt(12)
 s_barrier
 v_mov_b32 v7, 1
 buffer_atomic_add v7, v0, s[56:59], 0 offen sc1
 s_add_u32 m0, s50, 18432
 s_add_u32 s3, s69, 786432
 buffer_load_dwordx4 v23, s[40:43], s3 offen lds
 s_add_u32 m0, s50, 19456
 s_add_u32 s3, s69, 802816
 buffer_load_dwordx4 v23, s[40:43], s3 offen lds
 s_add_u32 m0, s50, 22528
 s_add_u32 s3, s69, 819200
 buffer_load_dwordx4 v23, s[40:43], s3 offen lds
 s_add_u32 m0, s50, 23552
 s_add_u32 s3, s69, 835584
 buffer_load_dwordx4 v23, s[40:43], s3 offen lds
 s_add_u32 m0, s50, 26624
 s_add_u32 s3, s69, 851968
 buffer_load_dwordx4 v23, s[40:43], s3 offen lds
 s_add_u32 m0, s50, 27648
 s_add_u32 s3, s69, 868352
 buffer_load_dwordx4 v23, s[40:43], s3 offen lds
 s_add_u32 m0, s50, 30720
 s_add_u32 s3, s69, 884736
 buffer_load_dwordx4 v23, s[40:43], s3 offen lds
 s_add_u32 m0, s50, 31744
 s_add_u32 s3, s69, 901120
 buffer_load_dwordx4 v23, s[40:43], s3 offen lds
 s_waitcnt lgkmcnt(0)
 s_add_u32 m0, s50, 8192
 s_add_u32 s3, s28, 65536
 buffer_load_dwordx4 v20, s[8:11], s3 offen lds
 s_add_u32 m0, s50, 9216
 s_add_u32 s3, s28, 81920
 buffer_load_dwordx4 v20, s[8:11], s3 offen lds
 s_add_u32 m0, s50, 12288
 s_add_u32 s3, s28, 98304
 buffer_load_dwordx4 v20, s[8:11], s3 offen lds
 s_add_u32 m0, s50, 13312
 s_add_u32 s3, s28, 114688
 buffer_load_dwordx4 v20, s[8:11], s3 offen lds
 s_add_u32 m0, s50, 16384
 s_add_u32 s3, s28, 131072
 buffer_load_dwordx4 v20, s[8:11], s3 offen lds
 s_add_u32 m0, s50, 17408
 s_add_u32 s3, s28, 147456
 buffer_load_dwordx4 v20, s[8:11], s3 offen lds
 s_add_u32 m0, s50, 20480
 s_add_u32 s3, s28, 163840
 buffer_load_dwordx4 v20, s[8:11], s3 offen lds
 s_add_u32 m0, s50, 21504
 s_add_u32 s3, s28, 180224
 buffer_load_dwordx4 v20, s[8:11], s3 offen lds
 s_add_u32 m0, s50, 24576
 s_add_u32 s3, s28, 196608
 buffer_load_dwordx4 v20, s[8:11], s3 offen lds
 s_add_u32 m0, s50, 25600
 s_add_u32 s3, s28, 212992
 buffer_load_dwordx4 v20, s[8:11], s3 offen lds
 s_add_u32 m0, s50, 28672
 s_add_u32 s3, s28, 229376
 buffer_load_dwordx4 v20, s[8:11], s3 offen lds
 s_add_u32 m0, s50, 29696
 s_add_u32 s3, s28, 245760
 buffer_load_dwordx4 v20, s[8:11], s3 offen lds
 s_waitcnt vmcnt(29)
 ds_read_b64_tr_b16 v[200:201], v24 offset:2048
 ds_read_b64_tr_b16 v[202:203], v24 offset:2560
 ds_read_b64_tr_b16 v[208:209], v24 offset:2056
 ds_read_b64_tr_b16 v[210:211], v24 offset:2568
 ds_read_b64_tr_b16 a[224:225], v25 offset:2048
 ds_read_b64_tr_b16 a[226:227], v25 offset:2560
 ds_read_b64_tr_b16 a[232:233], v25 offset:2056
 ds_read_b64_tr_b16 a[234:235], v25 offset:2568
 s_waitcnt vmcnt(25)
 ds_read_b64_tr_b16 v[204:205], v24 offset:10240
 ds_read_b64_tr_b16 v[206:207], v24 offset:10752
 ds_read_b64_tr_b16 v[212:213], v24 offset:10248
 ds_read_b64_tr_b16 v[214:215], v24 offset:10760
 ds_read_b64_tr_b16 a[228:229], v25 offset:10240
 ds_read_b64_tr_b16 a[230:231], v25 offset:10752
 ds_read_b64_tr_b16 a[236:237], v25 offset:10248
 ds_read_b64_tr_b16 a[238:239], v25 offset:10760
 s_waitcnt vmcnt(16)
 ds_read_b64_tr_b16 a[192:193], v24 offset:18432
 ds_read_b64_tr_b16 a[194:195], v24 offset:18944
 ds_read_b64_tr_b16 a[200:201], v24 offset:18440
 ds_read_b64_tr_b16 a[202:203], v24 offset:18952
 ds_read_b64_tr_b16 a[208:209], v25 offset:18432
 ds_read_b64_tr_b16 a[210:211], v25 offset:18944
 ds_read_b64_tr_b16 a[216:217], v25 offset:18440
 ds_read_b64_tr_b16 a[218:219], v25 offset:18952
 s_waitcnt vmcnt(12)
 ds_read_b64_tr_b16 a[196:197], v24 offset:26624
 ds_read_b64_tr_b16 a[198:199], v24 offset:27136
 ds_read_b64_tr_b16 a[204:205], v24 offset:26632
 ds_read_b64_tr_b16 a[206:207], v24 offset:27144
 ds_read_b64_tr_b16 a[212:213], v25 offset:26624
 ds_read_b64_tr_b16 a[214:215], v25 offset:27136
 ds_read_b64_tr_b16 a[220:221], v25 offset:26632
 ds_read_b64_tr_b16 a[222:223], v25 offset:27144
 ds_read_b128 a[0:3], v21
 ds_read_b128 a[32:35], v22
 ds_read_b128 a[4:7], v21 offset:4096
 ds_read_b128 a[36:39], v22 offset:4096
 s_waitcnt lgkmcnt(2)
 ds_write_b128 v3, a[0:3]
 ds_write_b128 v3, a[32:35] offset:1024
 s_waitcnt vmcnt(10)
 ds_read_b128 a[8:11], v21 offset:8192
 ds_read_b128 a[40:43], v22 offset:8192
 s_waitcnt lgkmcnt(4)
 ds_write_b128 v3, a[4:7] offset:4096
 ds_write_b128 v3, a[36:39] offset:5120
 s_waitcnt vmcnt(8)
 ds_read_b128 a[12:15], v21 offset:12288
 ds_read_b128 a[44:47], v22 offset:12288
 s_waitcnt lgkmcnt(4)
 ds_write_b128 v3, a[8:11] offset:8192
 ds_write_b128 v3, a[40:43] offset:9216
 s_waitcnt vmcnt(6)
 ds_read_b128 a[16:19], v21 offset:16384
 ds_read_b128 a[48:51], v22 offset:16384
 s_waitcnt lgkmcnt(4)
 ds_write_b128 v3, a[12:15] offset:12288
 ds_write_b128 v3, a[44:47] offset:13312
 s_waitcnt vmcnt(4)
 ds_read_b128 a[20:23], v21 offset:20480
 ds_read_b128 a[52:55], v22 offset:20480
 s_waitcnt lgkmcnt(4)
 ds_write_b128 v3, a[16:19] offset:16384
 ds_write_b128 v3, a[48:51] offset:17408
 s_waitcnt vmcnt(2)
 ds_read_b128 a[24:27], v21 offset:24576
 ds_read_b128 a[56:59], v22 offset:24576
 s_waitcnt lgkmcnt(4)
 ds_write_b128 v3, a[20:23] offset:20480
 ds_write_b128 v3, a[52:55] offset:21504
 s_waitcnt lgkmcnt(0)
 v_lshlrev_b32 v4, 2, v3
 v_and_b32 v4, 192, v4
 buffer_load_dword v4, v4, s[44:47], 0 offen sc1
 s_add_u32 m0, s50, 2048
 s_add_u32 s3, s28, 128
 buffer_load_dwordx4 v20, s[8:11], s3 offen lds
 s_add_u32 m0, s50, 3072
 s_add_u32 s3, s28, 16512
 buffer_load_dwordx4 v20, s[8:11], s3 offen lds
 s_waitcnt vmcnt(3)
 ds_read_b128 a[28:31], v21 offset:28672
 ds_read_b128 a[60:63], v22 offset:28672
 ds_write_b128 v3, a[24:27] offset:24576
 ds_write_b128 v3, a[56:59] offset:25600
 s_waitcnt lgkmcnt(2)
 ds_write_b128 v3, a[28:31] offset:28672
 ds_write_b128 v3, a[60:63] offset:29696
 s_add_u32 m0, s50, 6144
 s_add_u32 s3, s28, 32896
 buffer_load_dwordx4 v20, s[8:11], s3 offen lds
 s_add_u32 m0, s50, 7168
 s_add_u32 s3, s28, 49280
 buffer_load_dwordx4 v20, s[8:11], s3 offen lds
 s_add_u32 m0, s50, 10240
 s_add_u32 s3, s28, 65664
 buffer_load_dwordx4 v20, s[8:11], s3 offen lds
 s_add_u32 m0, s50, 11264
 s_add_u32 s3, s28, 82048
 buffer_load_dwordx4 v20, s[8:11], s3 offen lds
 v_mov_b32 v8, v20
 v_mov_b32 v16, 1.0
 v_mov_b32 v17, 1.0
 v_mov_b32 v18, 1.0
 v_mov_b32 v19, 1.0
 v_mov_b32 v20, 1.0
 v_mov_b32 v21, 1.0
 v_mov_b32 v22, 1.0
 v_mov_b32 v23, 1.0
 v_mov_b32 v24, 1.0
 v_mov_b32 v25, 1.0
 v_mov_b32 v26, 1.0
 v_mov_b32 v27, 1.0
 v_mov_b32 v28, 1.0
 v_mov_b32 v29, 1.0
 v_mov_b32 v30, 1.0
 v_mov_b32 v31, 1.0
 s_add_u32 s70, s70, 32768
 s_addc_u32 s71, s71, 0
 s_xor_b32 s30, s28, 1024
 s_mov_b32 s20, 64
 s_mov_b32 s21, 32704
 s_mov_b32 s22, 0xfffc8040
 s_waitcnt lgkmcnt(0)
 s_barrier
 ds_read_b128 a[128:131], v1
 ds_read_b128 a[132:135], v1 offset:1024
 ds_read_b128 a[140:143], v1 offset:5120
 ds_read_b128 a[136:139], v1 offset:4096
 ds_read_b128 a[144:147], v1 offset:8192
 ds_read_b128 a[148:151], v1 offset:9216
 ds_read_b128 a[156:159], v1 offset:13312
 ds_read_b128 a[152:155], v1 offset:12288
 ds_read_b128 a[160:163], v1 offset:16384
 ds_read_b128 a[164:167], v1 offset:17408
 ds_read_b128 a[172:175], v1 offset:21504
 ds_read_b128 a[168:171], v1 offset:20480
 ds_read_b128 a[176:179], v1 offset:24576
 ds_read_b128 a[180:183], v1 offset:25600
 ds_read_b128 a[188:191], v1 offset:29696
 ds_read_b128 a[184:187], v1 offset:28672
 s_waitcnt lgkmcnt(8)
 v_mfma_f32_16x16x32_bf16 v[16:19], v[136:139], a[128:131], v[16:19]
 s_add_u32 m0, s50, 14336
 v_mfma_f32_16x16x32_bf16 v[16:19], v[140:143], a[132:135], v[16:19]
 v_mfma_f32_16x16x32_bf16 v[20:23], v[140:143], a[140:143], v[20:23]
 s_add_u32 s3, s28, 98432
 v_mfma_f32_16x16x32_bf16 v[20:23], v[136:139], a[136:139], v[20:23]
 buffer_load_dwordx4 v8, s[8:11], s3 offen lds
 v_mfma_f32_16x16x32_bf16 v[24:27], v[136:139], a[144:147], v[24:27]
 s_add_u32 m0, s50, 15360
 v_mfma_f32_16x16x32_bf16 v[24:27], v[140:143], a[148:151], v[24:27]
 v_mfma_f32_16x16x32_bf16 v[28:31], v[140:143], a[156:159], v[28:31]
 s_add_u32 s3, s28, 114816
 v_mfma_f32_16x16x32_bf16 v[28:31], v[136:139], a[152:155], v[28:31]
 buffer_load_dwordx4 v8, s[8:11], s3 offen lds
 s_waitcnt lgkmcnt(0)
 v_mfma_f32_16x16x32_bf16 v[32:35], v[136:139], a[160:163], v[32:35]
 s_add_u32 m0, s50, 18432
 v_mfma_f32_16x16x32_bf16 v[32:35], v[140:143], a[164:167], v[32:35]
 s_add_u32 s3, s28, 131200
 v_mfma_f32_16x16x32_bf16 v[36:39], v[140:143], a[172:175], v[36:39]
 v_mfma_f32_16x16x32_bf16 v[36:39], v[136:139], a[168:171], v[36:39]
 buffer_load_dwordx4 v8, s[8:11], s3 offen lds
 v_mfma_f32_16x16x32_bf16 v[40:43], v[136:139], a[176:179], v[40:43]
 s_add_u32 m0, s50, 19456
 v_mfma_f32_16x16x32_bf16 v[40:43], v[140:143], a[180:183], v[40:43]
 s_add_u32 s3, s28, 147584
 v_mfma_f32_16x16x32_bf16 v[44:47], v[140:143], a[188:191], v[44:47]
 v_mfma_f32_16x16x32_bf16 v[44:47], v[136:139], a[184:187], v[44:47]
 buffer_load_dwordx4 v8, s[8:11], s3 offen lds
 v_mfma_f32_16x16x32_bf16 v[76:79], v[144:147], a[184:187], v[76:79]
 s_add_u32 m0, s50, 22528
 v_mfma_f32_16x16x32_bf16 v[76:79], v[148:151], a[188:191], v[76:79]
 s_add_u32 s3, s28, 163968
 v_mfma_f32_16x16x32_bf16 v[72:75], v[148:151], a[180:183], v[72:75]
 v_mov_b32 v136, 1.0
 v_mfma_f32_16x16x32_bf16 v[72:75], v[144:147], a[176:179], v[72:75]
 buffer_load_dwordx4 v8, s[8:11], s3 offen lds
 v_mfma_f32_16x16x32_bf16 v[68:71], v[144:147], a[168:171], v[68:71]
 s_add_u32 m0, s50, 23552
 v_mov_b32 v137, 1.0
 v_mfma_f32_16x16x32_bf16 v[68:71], v[148:151], a[172:175], v[68:71]
 s_add_u32 s3, s28, 180352
 v_mov_b32 v138, 1.0
 v_mfma_f32_16x16x32_bf16 v[64:67], v[148:151], a[164:167], v[64:67]
 buffer_load_dwordx4 v8, s[8:11], s3 offen lds
 v_mfma_f32_16x16x32_bf16 v[64:67], v[144:147], a[160:163], v[64:67]
 v_mov_b32 v139, 1.0
 v_mfma_f32_16x16x32_bf16 v[60:63], v[144:147], a[152:155], v[60:63]
 s_add_u32 m0, s50, 26624
 v_mov_b32 v140, 1.0
 v_mfma_f32_16x16x32_bf16 v[60:63], v[148:151], a[156:159], v[60:63]
 v_mfma_f32_16x16x32_bf16 v[56:59], v[148:151], a[148:151], v[56:59]
 s_add_u32 s3, s28, 196736
 v_mov_b32 v141, 1.0
 v_mfma_f32_16x16x32_bf16 v[56:59], v[144:147], a[144:147], v[56:59]
 v_mov_b32 v142, 1.0
 v_mfma_f32_16x16x32_bf16 v[52:55], v[144:147], a[136:139], v[52:55]
 buffer_load_dwordx4 v8, s[8:11], s3 offen lds
 s_add_u32 m0, s50, 27648
 v_mfma_f32_16x16x32_bf16 v[52:55], v[148:151], a[140:143], v[52:55]
 v_mov_b32 v143, 1.0
 v_mfma_f32_16x16x32_bf16 v[48:51], v[148:151], a[132:135], v[48:51]
 s_add_u32 s3, s28, 213120
 v_mfma_f32_16x16x32_bf16 v[48:51], v[144:147], a[128:131], v[48:51]
 buffer_load_dwordx4 v8, s[8:11], s3 offen lds
 v_mfma_f32_16x16x32_bf16 v[80:83], v[152:155], a[128:131], v[80:83]
 s_add_u32 m0, s50, 30720
 v_mfma_f32_16x16x32_bf16 v[80:83], v[156:159], a[132:135], v[80:83]
 v_mfma_f32_16x16x32_bf16 v[84:87], v[156:159], a[140:143], v[84:87]
 s_add_u32 s3, s28, 229504
 v_mov_b32 v144, 1.0
 v_mfma_f32_16x16x32_bf16 v[84:87], v[152:155], a[136:139], v[84:87]
 buffer_load_dwordx4 v8, s[8:11], s3 offen lds
 v_mfma_f32_16x16x32_bf16 v[88:91], v[152:155], a[144:147], v[88:91]
 s_add_u32 m0, s50, 31744
 v_mov_b32 v145, 1.0
 v_mfma_f32_16x16x32_bf16 v[88:91], v[156:159], a[148:151], v[88:91]
 s_add_u32 s3, s28, 245888
 v_mov_b32 v146, 1.0
 v_mfma_f32_16x16x32_bf16 v[92:95], v[156:159], a[156:159], v[92:95]
 buffer_load_dwordx4 v8, s[8:11], s3 offen lds
 v_mfma_f32_16x16x32_bf16 v[92:95], v[152:155], a[152:155], v[92:95]
 v_mov_b32 v147, 1.0
 v_mfma_f32_16x16x32_bf16 v[96:99], v[152:155], a[160:163], v[96:99]
 v_mov_b32 v148, 1.0
 v_mfma_f32_16x16x32_bf16 v[96:99], v[156:159], a[164:167], v[96:99]
 v_mfma_f32_16x16x32_bf16 v[100:103], v[156:159], a[172:175], v[100:103]
 v_mov_b32 v149, 1.0
 v_mfma_f32_16x16x32_bf16 v[100:103], v[152:155], a[168:171], v[100:103]
 v_mov_b32 v150, 1.0
 v_mfma_f32_16x16x32_bf16 v[104:107], v[152:155], a[176:179], v[104:107]
 v_mfma_f32_16x16x32_bf16 v[104:107], v[156:159], a[180:183], v[104:107]
 v_mov_b32 v151, 1.0
 v_mfma_f32_16x16x32_bf16 v[108:111], v[156:159], a[188:191], v[108:111]
 v_mfma_f32_16x16x32_bf16 v[108:111], v[152:155], a[184:187], v[108:111]
 v_mfma_f32_16x16x32_bf16 a[244:247], v[160:163], a[184:187], a[244:247]
 ds_read_b128 a[184:187], v1 offset:61440
 v_mfma_f32_16x16x32_bf16 a[244:247], v[164:167], a[188:191], a[244:247]
 ds_read_b128 a[188:191], v1 offset:62464
 v_mfma_f32_16x16x32_bf16 a[240:243], v[164:167], a[180:183], a[240:243]
 ds_read_b128 a[180:183], v1 offset:58368
 v_mov_b32 v152, 1.0
 v_mfma_f32_16x16x32_bf16 a[240:243], v[160:163], a[176:179], a[240:243]
 ds_read_b128 a[176:179], v1 offset:57344
 v_mfma_f32_16x16x32_bf16 v[132:135], v[160:163], a[168:171], v[132:135]
 ds_read_b128 a[168:171], v1 offset:53248
 v_mov_b32 v153, 1.0
 v_mfma_f32_16x16x32_bf16 v[132:135], v[164:167], a[172:175], v[132:135]
 ds_read_b128 a[172:175], v1 offset:54272
 v_mov_b32 v154, 1.0
 v_mfma_f32_16x16x32_bf16 v[128:131], v[164:167], a[164:167], v[128:131]
 ds_read_b128 a[164:167], v1 offset:50176
 v_mfma_f32_16x16x32_bf16 v[128:131], v[160:163], a[160:163], v[128:131]
 ds_read_b128 a[160:163], v1 offset:49152
 v_mov_b32 v155, 1.0
 v_mfma_f32_16x16x32_bf16 v[124:127], v[160:163], a[152:155], v[124:127]
 ds_read_b128 a[152:155], v1 offset:45056
 v_mov_b32 v156, 1.0
 v_mfma_f32_16x16x32_bf16 v[124:127], v[164:167], a[156:159], v[124:127]
 ds_read_b128 a[156:159], v1 offset:46080
 v_mfma_f32_16x16x32_bf16 v[120:123], v[164:167], a[148:151], v[120:123]
 ds_read_b128 a[148:151], v1 offset:41984
 v_mov_b32 v157, 1.0
 v_mfma_f32_16x16x32_bf16 v[120:123], v[160:163], a[144:147], v[120:123]
 ds_read_b128 a[144:147], v1 offset:40960
 v_mov_b32 v158, 1.0
 v_mfma_f32_16x16x32_bf16 v[116:119], v[160:163], a[136:139], v[116:119]
 ds_read_b128 a[136:139], v1 offset:36864
 v_mfma_f32_16x16x32_bf16 v[116:119], v[164:167], a[140:143], v[116:119]
 ds_read_b128 a[140:143], v1 offset:37888
 v_mov_b32 v159, 1.0
 v_mfma_f32_16x16x32_bf16 v[112:115], v[164:167], a[132:135], v[112:115]
 ds_read_b128 a[132:135], v1 offset:33792
 v_mfma_f32_16x16x32_bf16 v[112:115], v[160:163], a[128:131], v[112:115]
 ds_read_b128 a[128:131], v1 offset:32768
 s_waitcnt lgkmcnt(8)
 v_mfma_f32_16x16x32_bf16 v[44:47], v[168:171], a[184:187], v[44:47]
 v_mfma_f32_16x16x32_bf16 v[44:47], v[172:175], a[188:191], v[44:47]
 v_mfma_f32_16x16x32_bf16 v[40:43], v[172:175], a[180:183], v[40:43]
 v_mov_b32 v160, 1.0
 v_mfma_f32_16x16x32_bf16 v[40:43], v[168:171], a[176:179], v[40:43]
 v_mfma_f32_16x16x32_bf16 v[36:39], v[168:171], a[168:171], v[36:39]
 v_mov_b32 v161, 1.0
 v_mfma_f32_16x16x32_bf16 v[36:39], v[172:175], a[172:175], v[36:39]
 v_mov_b32 v162, 1.0
 v_mfma_f32_16x16x32_bf16 v[32:35], v[172:175], a[164:167], v[32:35]
 v_mfma_f32_16x16x32_bf16 v[32:35], v[168:171], a[160:163], v[32:35]
 v_mov_b32 v163, 1.0
 s_waitcnt lgkmcnt(0)
 v_mfma_f32_16x16x32_bf16 v[28:31], v[168:171], a[152:155], v[28:31]
 v_mov_b32 v164, 1.0
 v_mfma_f32_16x16x32_bf16 v[28:31], v[172:175], a[156:159], v[28:31]
 v_mfma_f32_16x16x32_bf16 v[24:27], v[172:175], a[148:151], v[24:27]
 v_mov_b32 v165, 1.0
 v_mfma_f32_16x16x32_bf16 v[24:27], v[168:171], a[144:147], v[24:27]
 v_mov_b32 v166, 1.0
 v_mfma_f32_16x16x32_bf16 v[20:23], v[168:171], a[136:139], v[20:23]
 v_mfma_f32_16x16x32_bf16 v[20:23], v[172:175], a[140:143], v[20:23]
 v_mov_b32 v167, 1.0
 v_mfma_f32_16x16x32_bf16 v[16:19], v[172:175], a[132:135], v[16:19]
 v_mfma_f32_16x16x32_bf16 v[16:19], v[168:171], a[128:131], v[16:19]
 v_mfma_f32_16x16x32_bf16 v[48:51], v[176:179], a[128:131], v[48:51]
 v_mfma_f32_16x16x32_bf16 v[48:51], v[180:183], a[132:135], v[48:51]
 v_mfma_f32_16x16x32_bf16 v[52:55], v[180:183], a[140:143], v[52:55]
 v_mov_b32 v168, 1.0
 v_mfma_f32_16x16x32_bf16 v[52:55], v[176:179], a[136:139], v[52:55]
 v_mfma_f32_16x16x32_bf16 v[56:59], v[176:179], a[144:147], v[56:59]
 v_mov_b32 v169, 1.0
 v_mfma_f32_16x16x32_bf16 v[56:59], v[180:183], a[148:151], v[56:59]
 v_mov_b32 v170, 1.0
 v_mfma_f32_16x16x32_bf16 v[60:63], v[180:183], a[156:159], v[60:63]
 v_mfma_f32_16x16x32_bf16 v[60:63], v[176:179], a[152:155], v[60:63]
 v_mov_b32 v171, 1.0
 v_mfma_f32_16x16x32_bf16 v[64:67], v[176:179], a[160:163], v[64:67]
 v_mov_b32 v172, 1.0
 v_mfma_f32_16x16x32_bf16 v[64:67], v[180:183], a[164:167], v[64:67]
 v_mfma_f32_16x16x32_bf16 v[68:71], v[180:183], a[172:175], v[68:71]
 v_mov_b32 v173, 1.0
 v_mfma_f32_16x16x32_bf16 v[68:71], v[176:179], a[168:171], v[68:71]
 v_mov_b32 v174, 1.0
 v_mfma_f32_16x16x32_bf16 v[72:75], v[176:179], a[176:179], v[72:75]
 v_mfma_f32_16x16x32_bf16 v[72:75], v[180:183], a[180:183], v[72:75]
 v_mov_b32 v175, 1.0
 v_mfma_f32_16x16x32_bf16 v[76:79], v[180:183], a[188:191], v[76:79]
 v_mfma_f32_16x16x32_bf16 v[76:79], v[176:179], a[184:187], v[76:79]
 v_mfma_f32_16x16x32_bf16 v[108:111], v[184:187], a[184:187], v[108:111]
 v_mfma_f32_16x16x32_bf16 v[108:111], v[188:191], a[188:191], v[108:111]
 v_mfma_f32_16x16x32_bf16 v[104:107], v[188:191], a[180:183], v[104:107]
 v_mov_b32 v176, 1.0
 v_mfma_f32_16x16x32_bf16 v[104:107], v[184:187], a[176:179], v[104:107]
 v_mfma_f32_16x16x32_bf16 v[100:103], v[184:187], a[168:171], v[100:103]
 v_mov_b32 v177, 1.0
 v_mfma_f32_16x16x32_bf16 v[100:103], v[188:191], a[172:175], v[100:103]
 v_mov_b32 v178, 1.0
 v_mfma_f32_16x16x32_bf16 v[96:99], v[188:191], a[164:167], v[96:99]
 v_mfma_f32_16x16x32_bf16 v[96:99], v[184:187], a[160:163], v[96:99]
 v_mov_b32 v179, 1.0
 v_mfma_f32_16x16x32_bf16 v[92:95], v[184:187], a[152:155], v[92:95]
 v_mov_b32 v180, 1.0
 v_mfma_f32_16x16x32_bf16 v[92:95], v[188:191], a[156:159], v[92:95]
 v_mfma_f32_16x16x32_bf16 v[88:91], v[188:191], a[148:151], v[88:91]
 v_mov_b32 v181, 1.0
 v_mfma_f32_16x16x32_bf16 v[88:91], v[184:187], a[144:147], v[88:91]
 v_mov_b32 v182, 1.0
 v_mfma_f32_16x16x32_bf16 v[84:87], v[184:187], a[136:139], v[84:87]
 v_mfma_f32_16x16x32_bf16 v[84:87], v[188:191], a[140:143], v[84:87]
 v_mov_b32 v183, 1.0
 v_mfma_f32_16x16x32_bf16 v[80:83], v[188:191], a[132:135], v[80:83]
 v_mfma_f32_16x16x32_bf16 v[80:83], v[184:187], a[128:131], v[80:83]
 v_mfma_f32_16x16x32_bf16 v[112:115], v[192:195], a[128:131], v[112:115]
 ds_read_b128 a[128:131], v2
 v_mfma_f32_16x16x32_bf16 v[112:115], v[196:199], a[132:135], v[112:115]
 ds_read_b128 a[132:135], v2 offset:1024
 v_mfma_f32_16x16x32_bf16 v[116:119], v[196:199], a[140:143], v[116:119]
 ds_read_b128 a[140:143], v2 offset:5120
 v_mov_b32 v184, 1.0
 v_mfma_f32_16x16x32_bf16 v[116:119], v[192:195], a[136:139], v[116:119]
 ds_read_b128 a[136:139], v2 offset:4096
 v_mfma_f32_16x16x32_bf16 v[120:123], v[192:195], a[144:147], v[120:123]
 ds_read_b128 a[144:147], v2 offset:8192
 v_mov_b32 v185, 1.0
 v_mfma_f32_16x16x32_bf16 v[120:123], v[196:199], a[148:151], v[120:123]
 ds_read_b128 a[148:151], v2 offset:9216
 v_mov_b32 v186, 1.0
 v_mfma_f32_16x16x32_bf16 v[124:127], v[196:199], a[156:159], v[124:127]
 ds_read_b128 a[156:159], v2 offset:13312
 v_mfma_f32_16x16x32_bf16 v[124:127], v[192:195], a[152:155], v[124:127]
 ds_read_b128 a[152:155], v2 offset:12288
 v_mov_b32 v187, 1.0
 v_mfma_f32_16x16x32_bf16 v[128:131], v[192:195], a[160:163], v[128:131]
 ds_read_b128 a[160:163], v2 offset:16384
 v_mov_b32 v188, 1.0
 v_mfma_f32_16x16x32_bf16 v[128:131], v[196:199], a[164:167], v[128:131]
 ds_read_b128 a[164:167], v2 offset:17408
 v_mfma_f32_16x16x32_bf16 v[132:135], v[196:199], a[172:175], v[132:135]
 ds_read_b128 a[172:175], v2 offset:21504
 v_mov_b32 v189, 1.0
 v_mfma_f32_16x16x32_bf16 v[132:135], v[192:195], a[168:171], v[132:135]
 ds_read_b128 a[168:171], v2 offset:20480
 v_mov_b32 v190, 1.0
 v_mfma_f32_16x16x32_bf16 a[240:243], v[192:195], a[176:179], a[240:243]
 ds_read_b128 a[176:179], v2 offset:24576
 v_mfma_f32_16x16x32_bf16 a[240:243], v[196:199], a[180:183], a[240:243]
 ds_read_b128 a[180:183], v2 offset:25600
 v_mov_b32 v191, 1.0
 v_mfma_f32_16x16x32_bf16 a[244:247], v[196:199], a[188:191], a[244:247]
 ds_read_b128 a[188:191], v2 offset:29696
 v_mfma_f32_16x16x32_bf16 a[244:247], v[192:195], a[184:187], a[244:247]
 ds_read_b128 a[184:187], v2 offset:28672
 s_waitcnt lgkmcnt(8)
 v_mfma_f32_16x16x32_bf16 v[16:19], v[200:203], a[128:131], v[16:19]
 v_mfma_f32_16x16x32_bf16 v[16:19], v[204:207], a[132:135], v[16:19]
 v_mfma_f32_16x16x32_bf16 v[20:23], v[204:207], a[140:143], v[20:23]
 v_mov_b32 v192, 1.0
 v_mfma_f32_16x16x32_bf16 v[20:23], v[200:203], a[136:139], v[20:23]
 v_mfma_f32_16x16x32_bf16 v[24:27], v[200:203], a[144:147], v[24:27]
 v_mov_b32 v193, 1.0
 v_mfma_f32_16x16x32_bf16 v[24:27], v[204:207], a[148:151], v[24:27]
 v_mov_b32 v194, 1.0
 v_mfma_f32_16x16x32_bf16 v[28:31], v[204:207], a[156:159], v[28:31]
 v_mfma_f32_16x16x32_bf16 v[28:31], v[200:203], a[152:155], v[28:31]
 v_mov_b32 v195, 1.0
 s_waitcnt lgkmcnt(0)
 v_mfma_f32_16x16x32_bf16 v[32:35], v[200:203], a[160:163], v[32:35]
 v_mov_b32 v196, 1.0
 v_mfma_f32_16x16x32_bf16 v[32:35], v[204:207], a[164:167], v[32:35]
 v_mfma_f32_16x16x32_bf16 v[36:39], v[204:207], a[172:175], v[36:39]
 v_mov_b32 v197, 1.0
 v_mfma_f32_16x16x32_bf16 v[36:39], v[200:203], a[168:171], v[36:39]
 v_mov_b32 v198, 1.0
 v_mfma_f32_16x16x32_bf16 v[40:43], v[200:203], a[176:179], v[40:43]
 v_mfma_f32_16x16x32_bf16 v[40:43], v[204:207], a[180:183], v[40:43]
 v_mov_b32 v199, 1.0
 v_mfma_f32_16x16x32_bf16 v[44:47], v[204:207], a[188:191], v[44:47]
 v_mfma_f32_16x16x32_bf16 v[44:47], v[200:203], a[184:187], v[44:47]
 v_mfma_f32_16x16x32_bf16 v[76:79], v[208:211], a[184:187], v[76:79]
 v_mfma_f32_16x16x32_bf16 v[76:79], v[212:215], a[188:191], v[76:79]
 v_mfma_f32_16x16x32_bf16 v[72:75], v[212:215], a[180:183], v[72:75]
 v_mov_b32 v200, 1.0
 v_mfma_f32_16x16x32_bf16 v[72:75], v[208:211], a[176:179], v[72:75]
 v_mfma_f32_16x16x32_bf16 v[68:71], v[208:211], a[168:171], v[68:71]
 v_mov_b32 v201, 1.0
 v_mfma_f32_16x16x32_bf16 v[68:71], v[212:215], a[172:175], v[68:71]
 v_mov_b32 v202, 1.0
 v_mfma_f32_16x16x32_bf16 v[64:67], v[212:215], a[164:167], v[64:67]
 v_mfma_f32_16x16x32_bf16 v[64:67], v[208:211], a[160:163], v[64:67]
 v_mov_b32 v203, 1.0
 v_mfma_f32_16x16x32_bf16 v[60:63], v[208:211], a[152:155], v[60:63]
 v_mov_b32 v204, 1.0
 v_mfma_f32_16x16x32_bf16 v[60:63], v[212:215], a[156:159], v[60:63]
 v_mfma_f32_16x16x32_bf16 v[56:59], v[212:215], a[148:151], v[56:59]
 v_mov_b32 v205, 1.0
 v_mfma_f32_16x16x32_bf16 v[56:59], v[208:211], a[144:147], v[56:59]
 v_mov_b32 v206, 1.0
 v_mfma_f32_16x16x32_bf16 v[52:55], v[208:211], a[136:139], v[52:55]
 v_mfma_f32_16x16x32_bf16 v[52:55], v[212:215], a[140:143], v[52:55]
 v_mov_b32 v207, 1.0
 v_mfma_f32_16x16x32_bf16 v[48:51], v[212:215], a[132:135], v[48:51]
 v_mfma_f32_16x16x32_bf16 v[48:51], v[208:211], a[128:131], v[48:51]
 v_mfma_f32_16x16x32_bf16 v[80:83], a[224:227], a[128:131], v[80:83]
 v_mfma_f32_16x16x32_bf16 v[80:83], a[228:231], a[132:135], v[80:83]
 v_mfma_f32_16x16x32_bf16 v[84:87], a[228:231], a[140:143], v[84:87]
 v_mov_b32 v208, 1.0
 s_waitcnt vmcnt(16)
 v_cmp_gt_i32 vcc, s27, v4
 s_and_b64 vcc, exec, vcc
 s_cbranch_vccnz Lspin_pro
Lok_pro:
 s_add_u32 s27, s27, 64
 v_mfma_f32_16x16x32_bf16 v[84:87], a[224:227], a[136:139], v[84:87]
 v_mfma_f32_16x16x32_bf16 v[88:91], a[224:227], a[144:147], v[88:91]
 v_mov_b32 v209, 1.0
 v_mfma_f32_16x16x32_bf16 v[88:91], a[228:231], a[148:151], v[88:91]
 v_mov_b32 v210, 1.0
 v_mfma_f32_16x16x32_bf16 v[92:95], a[228:231], a[156:159], v[92:95]
 v_mfma_f32_16x16x32_bf16 v[92:95], a[224:227], a[152:155], v[92:95]
 v_mov_b32 v211, 1.0
 v_mfma_f32_16x16x32_bf16 v[96:99], a[224:227], a[160:163], v[96:99]
 v_mov_b32 v212, 1.0
 v_mfma_f32_16x16x32_bf16 v[96:99], a[228:231], a[164:167], v[96:99]
 v_mfma_f32_16x16x32_bf16 v[100:103], a[228:231], a[172:175], v[100:103]
 v_mov_b32 v213, 1.0
 v_mfma_f32_16x16x32_bf16 v[100:103], a[224:227], a[168:171], v[100:103]
 v_mov_b32 v214, 1.0
 v_mfma_f32_16x16x32_bf16 v[104:107], a[224:227], a[176:179], v[104:107]
 v_mfma_f32_16x16x32_bf16 v[104:107], a[228:231], a[180:183], v[104:107]
 v_mov_b32 v215, 1.0
 v_mfma_f32_16x16x32_bf16 v[108:111], a[228:231], a[188:191], v[108:111]
 v_mfma_f32_16x16x32_bf16 v[108:111], a[224:227], a[184:187], v[108:111]
 v_mfma_f32_16x16x32_bf16 a[244:247], a[232:235], a[184:187], a[244:247]
 ds_read_b128 a[184:187], v2 offset:61440
 v_mfma_f32_16x16x32_bf16 a[244:247], a[236:239], a[188:191], a[244:247]
 global_load_dwordx4 a[228:231], v0, s[70:71] offset:-3072 sc1
 ds_read_b128 a[188:191], v2 offset:62464
 v_mfma_f32_16x16x32_bf16 a[240:243], a[236:239], a[180:183], a[240:243]
 ds_read_b128 a[180:183], v2 offset:58368
 v_mfma_f32_16x16x32_bf16 a[240:243], a[232:235], a[176:179], a[240:243]
 global_load_dwordx4 a[224:227], v0, s[70:71] offset:-4096 sc1
 ds_read_b128 a[176:179], v2 offset:57344
 v_mfma_f32_16x16x32_bf16 v[132:135], a[232:235], a[168:171], v[132:135]
 ds_read_b128 a[168:171], v2 offset:53248
 v_mfma_f32_16x16x32_bf16 v[132:135], a[236:239], a[172:175], v[132:135]
 ds_read_b128 a[172:175], v2 offset:54272
 v_mfma_f32_16x16x32_bf16 v[128:131], a[236:239], a[164:167], v[128:131]
 ds_read_b128 a[164:167], v2 offset:50176
 v_mfma_f32_16x16x32_bf16 v[128:131], a[232:235], a[160:163], v[128:131]
 ds_read_b128 a[160:163], v2 offset:49152
 v_mfma_f32_16x16x32_bf16 v[124:127], a[232:235], a[152:155], v[124:127]
 ds_read_b128 a[152:155], v2 offset:45056
 v_mfma_f32_16x16x32_bf16 v[124:127], a[236:239], a[156:159], v[124:127]
 ds_read_b128 a[156:159], v2 offset:46080
 v_mfma_f32_16x16x32_bf16 v[120:123], a[236:239], a[148:151], v[120:123]
 ds_read_b128 a[148:151], v2 offset:41984
 v_mfma_f32_16x16x32_bf16 v[120:123], a[232:235], a[144:147], v[120:123]
 ds_read_b128 a[144:147], v2 offset:40960
 v_mfma_f32_16x16x32_bf16 v[116:119], a[232:235], a[136:139], v[116:119]
 ds_read_b128 a[136:139], v2 offset:36864
 v_mfma_f32_16x16x32_bf16 v[116:119], a[236:239], a[140:143], v[116:119]
 ds_read_b128 a[140:143], v2 offset:37888
 v_mfma_f32_16x16x32_bf16 v[112:115], a[236:239], a[132:135], v[112:115]
 ds_read_b128 a[132:135], v2 offset:33792
 v_mfma_f32_16x16x32_bf16 v[112:115], a[232:235], a[128:131], v[112:115]
 ds_read_b128 a[128:131], v2 offset:32768
 s_waitcnt lgkmcnt(8)
 v_mfma_f32_16x16x32_bf16 v[44:47], a[192:195], a[184:187], v[44:47]
 v_mfma_f32_16x16x32_bf16 v[44:47], a[196:199], a[188:191], v[44:47]
 global_load_dwordx4 a[236:239], v0, s[70:71] offset:-1024 sc1
 v_mfma_f32_16x16x32_bf16 v[40:43], a[196:199], a[180:183], v[40:43]
 v_mfma_f32_16x16x32_bf16 v[40:43], a[192:195], a[176:179], v[40:43]
 global_load_dwordx4 a[232:235], v0, s[70:71] offset:-2048 sc1
 v_mfma_f32_16x16x32_bf16 v[36:39], a[192:195], a[168:171], v[36:39]
 v_mfma_f32_16x16x32_bf16 v[36:39], a[196:199], a[172:175], v[36:39]
 v_mfma_f32_16x16x32_bf16 v[32:35], a[196:199], a[164:167], v[32:35]
 v_mfma_f32_16x16x32_bf16 v[32:35], a[192:195], a[160:163], v[32:35]
 s_waitcnt lgkmcnt(0)
 v_mfma_f32_16x16x32_bf16 v[28:31], a[192:195], a[152:155], v[28:31]
 v_mfma_f32_16x16x32_bf16 v[28:31], a[196:199], a[156:159], v[28:31]
 v_mfma_f32_16x16x32_bf16 v[24:27], a[196:199], a[148:151], v[24:27]
 v_mfma_f32_16x16x32_bf16 v[24:27], a[192:195], a[144:147], v[24:27]
 v_mfma_f32_16x16x32_bf16 v[20:23], a[192:195], a[136:139], v[20:23]
 v_mfma_f32_16x16x32_bf16 v[20:23], a[196:199], a[140:143], v[20:23]
 v_mfma_f32_16x16x32_bf16 v[16:19], a[196:199], a[132:135], v[16:19]
 v_mfma_f32_16x16x32_bf16 v[16:19], a[192:195], a[128:131], v[16:19]
 v_mfma_f32_16x16x32_bf16 v[48:51], a[200:203], a[128:131], v[48:51]
 v_mfma_f32_16x16x32_bf16 v[48:51], a[204:207], a[132:135], v[48:51]
 global_load_dwordx4 a[196:199], v0, s[70:71] offset:1024 sc1
 v_mfma_f32_16x16x32_bf16 v[52:55], a[204:207], a[140:143], v[52:55]
 v_mfma_f32_16x16x32_bf16 v[52:55], a[200:203], a[136:139], v[52:55]
 global_load_dwordx4 a[192:195], v0, s[70:71] offset:0 sc1
 v_mfma_f32_16x16x32_bf16 v[56:59], a[200:203], a[144:147], v[56:59]
 v_mfma_f32_16x16x32_bf16 v[56:59], a[204:207], a[148:151], v[56:59]
 v_mfma_f32_16x16x32_bf16 v[60:63], a[204:207], a[156:159], v[60:63]
 v_mfma_f32_16x16x32_bf16 v[60:63], a[200:203], a[152:155], v[60:63]
 v_mfma_f32_16x16x32_bf16 v[64:67], a[200:203], a[160:163], v[64:67]
 v_mfma_f32_16x16x32_bf16 v[64:67], a[204:207], a[164:167], v[64:67]
 v_mfma_f32_16x16x32_bf16 v[68:71], a[204:207], a[172:175], v[68:71]
 v_mfma_f32_16x16x32_bf16 v[68:71], a[200:203], a[168:171], v[68:71]
 v_mfma_f32_16x16x32_bf16 v[72:75], a[200:203], a[176:179], v[72:75]
 v_mfma_f32_16x16x32_bf16 v[72:75], a[204:207], a[180:183], v[72:75]
 v_mfma_f32_16x16x32_bf16 v[76:79], a[204:207], a[188:191], v[76:79]
 v_mfma_f32_16x16x32_bf16 v[76:79], a[200:203], a[184:187], v[76:79]
 v_mfma_f32_16x16x32_bf16 v[108:111], a[208:211], a[184:187], v[108:111]
 v_mfma_f32_16x16x32_bf16 v[108:111], a[212:215], a[188:191], v[108:111]
 global_load_dwordx4 a[204:207], v0, s[70:71] offset:3072 sc1
 v_mfma_f32_16x16x32_bf16 v[104:107], a[212:215], a[180:183], v[104:107]
 v_mfma_f32_16x16x32_bf16 v[104:107], a[208:211], a[176:179], v[104:107]
 global_load_dwordx4 a[200:203], v0, s[70:71] offset:2048 sc1
 v_mfma_f32_16x16x32_bf16 v[100:103], a[208:211], a[168:171], v[100:103]
 s_add_u32 s70, s70, 8192
 s_addc_u32 s71, s71, 0
 v_mfma_f32_16x16x32_bf16 v[100:103], a[212:215], a[172:175], v[100:103]
 v_mfma_f32_16x16x32_bf16 v[96:99], a[212:215], a[164:167], v[96:99]
 v_mfma_f32_16x16x32_bf16 v[96:99], a[208:211], a[160:163], v[96:99]
 v_mfma_f32_16x16x32_bf16 v[92:95], a[208:211], a[152:155], v[92:95]
 v_mfma_f32_16x16x32_bf16 v[92:95], a[212:215], a[156:159], v[92:95]
 v_mfma_f32_16x16x32_bf16 v[88:91], a[212:215], a[148:151], v[88:91]
 v_mfma_f32_16x16x32_bf16 v[88:91], a[208:211], a[144:147], v[88:91]
 v_mfma_f32_16x16x32_bf16 v[84:87], a[208:211], a[136:139], v[84:87]
 v_mfma_f32_16x16x32_bf16 v[84:87], a[212:215], a[140:143], v[84:87]
 v_mfma_f32_16x16x32_bf16 v[80:83], a[212:215], a[132:135], v[80:83]
 v_mfma_f32_16x16x32_bf16 v[80:83], a[208:211], a[128:131], v[80:83]
 v_mfma_f32_16x16x32_bf16 v[112:115], a[216:219], a[128:131], v[112:115]
 ds_read_b128 a[128:131], v1
 v_mfma_f32_16x16x32_bf16 v[112:115], a[220:223], a[132:135], v[112:115]
 global_load_dwordx4 a[212:215], v0, s[70:71] offset:-3072 sc1
 ds_read_b128 a[132:135], v1 offset:1024
 v_mfma_f32_16x16x32_bf16 v[116:119], a[220:223], a[140:143], v[116:119]
 ds_read_b128 a[140:143], v1 offset:5120
 v_mfma_f32_16x16x32_bf16 v[116:119], a[216:219], a[136:139], v[116:119]
 global_load_dwordx4 a[208:211], v0, s[70:71] offset:-4096 sc1
 ds_read_b128 a[136:139], v1 offset:4096
 v_mfma_f32_16x16x32_bf16 v[120:123], a[216:219], a[144:147], v[120:123]
 ds_read_b128 a[144:147], v1 offset:8192
 v_mfma_f32_16x16x32_bf16 v[120:123], a[220:223], a[148:151], v[120:123]
 ds_read_b128 a[148:151], v1 offset:9216
 v_mfma_f32_16x16x32_bf16 v[124:127], a[220:223], a[156:159], v[124:127]
 ds_read_b128 a[156:159], v1 offset:13312
 v_mfma_f32_16x16x32_bf16 v[124:127], a[216:219], a[152:155], v[124:127]
 ds_read_b128 a[152:155], v1 offset:12288
 v_mfma_f32_16x16x32_bf16 v[128:131], a[216:219], a[160:163], v[128:131]
 ds_read_b128 a[160:163], v1 offset:16384
 v_mfma_f32_16x16x32_bf16 v[128:131], a[220:223], a[164:167], v[128:131]
 ds_read_b128 a[164:167], v1 offset:17408
 v_mfma_f32_16x16x32_bf16 v[132:135], a[220:223], a[172:175], v[132:135]
 ds_read_b128 a[172:175], v1 offset:21504
 v_mfma_f32_16x16x32_bf16 v[132:135], a[216:219], a[168:171], v[132:135]
 ds_read_b128 a[168:171], v1 offset:20480
 v_mfma_f32_16x16x32_bf16 a[240:243], a[216:219], a[176:179], a[240:243]
 ds_read_b128 a[176:179], v1 offset:24576
 v_mfma_f32_16x16x32_bf16 a[240:243], a[220:223], a[180:183], a[240:243]
 ds_read_b128 a[180:183], v1 offset:25600
 v_mfma_f32_16x16x32_bf16 a[244:247], a[220:223], a[188:191], a[244:247]
 global_load_dwordx4 a[220:223], v0, s[70:71] offset:-1024 sc1
 ds_read_b128 a[188:191], v1 offset:29696
 v_mfma_f32_16x16x32_bf16 a[244:247], a[216:219], a[184:187], a[244:247]
 global_load_dwordx4 a[216:219], v0, s[70:71] offset:-2048 sc1
 ds_read_b128 a[184:187], v1 offset:28672
 s_waitcnt vmcnt(10) lgkmcnt(8)
 v_mfma_f32_16x16x32_bf16 v[136:139], a[224:227], a[128:131], v[136:139]
 v_lshrrev_b32 v5, 4, v1
 v_mfma_f32_16x16x32_bf16 v[136:139], a[228:231], a[132:135], v[136:139]
 v_and_b32 v5, 48, v5
 v_mfma_f32_16x16x32_bf16 v[140:143], a[228:231], a[140:143], v[140:143]
 v_xor_b32 v5, v5, v1
 v_mfma_f32_16x16x32_bf16 v[140:143], a[224:227], a[136:139], v[140:143]
 v_and_b32 v5, 112, v5
 v_mfma_f32_16x16x32_bf16 v[144:147], a[224:227], a[144:147], v[144:147]
 v_and_b32 v6, 240, v1
 v_mfma_f32_16x16x32_bf16 v[144:147], a[228:231], a[148:151], v[144:147]
 v_lshl_add_u32 v5, v6, 3, v5
 v_mfma_f32_16x16x32_bf16 v[148:151], a[228:231], a[156:159], v[148:151]
 v_add_u32 v8, s50, v5
 v_mfma_f32_16x16x32_bf16 v[148:151], a[224:227], a[152:155], v[148:151]
 v_xor_b32 v9, 64, v8
 s_waitcnt lgkmcnt(0)
 v_mfma_f32_16x16x32_bf16 v[152:155], a[224:227], a[160:163], v[152:155]
 v_mfma_f32_16x16x32_bf16 v[152:155], a[228:231], a[164:167], v[152:155]
 ds_read_b128 a[64:67], v8 offset:2048
 ds_read_b128 a[96:99], v9 offset:2048
 v_mfma_f32_16x16x32_bf16 v[156:159], a[228:231], a[172:175], v[156:159]
 v_mfma_f32_16x16x32_bf16 v[156:159], a[224:227], a[168:171], v[156:159]
 v_mfma_f32_16x16x32_bf16 v[160:163], a[224:227], a[176:179], v[160:163]
 v_mfma_f32_16x16x32_bf16 v[160:163], a[228:231], a[180:183], v[160:163]
 v_mfma_f32_16x16x32_bf16 v[164:167], a[228:231], a[188:191], v[164:167]
 ds_read_b128 a[68:71], v8 offset:6144
 v_mfma_f32_16x16x32_bf16 v[164:167], a[224:227], a[184:187], v[164:167]
 ds_read_b128 a[100:103], v9 offset:6144
 s_waitcnt vmcnt(8)
 v_mfma_f32_16x16x32_bf16 v[196:199], a[232:235], a[184:187], v[196:199]
 v_mfma_f32_16x16x32_bf16 v[196:199], a[236:239], a[188:191], v[196:199]
 global_load_dwordx4 a[228:231], v0, s[70:71] offset:1024 sc1
 v_mfma_f32_16x16x32_bf16 v[192:195], a[236:239], a[180:183], v[192:195]
 v_mfma_f32_16x16x32_bf16 v[192:195], a[232:235], a[176:179], v[192:195]
 global_load_dwordx4 a[224:227], v0, s[70:71] offset:0 sc1
 s_waitcnt lgkmcnt(2)
 v_mfma_f32_16x16x32_bf16 v[188:191], a[232:235], a[168:171], v[188:191]
 ds_write_b128 v3, a[64:67] offset:2048
 v_mfma_f32_16x16x32_bf16 v[188:191], a[236:239], a[172:175], v[188:191]
 ds_write_b128 v3, a[96:99] offset:3072
 v_mfma_f32_16x16x32_bf16 v[184:187], a[236:239], a[164:167], v[184:187]
 v_mfma_f32_16x16x32_bf16 v[184:187], a[232:235], a[160:163], v[184:187]
 ds_read_b128 a[72:75], v8 offset:10240
 v_mfma_f32_16x16x32_bf16 v[180:183], a[232:235], a[152:155], v[180:183]
 ds_read_b128 a[104:107], v9 offset:10240
 v_mfma_f32_16x16x32_bf16 v[180:183], a[236:239], a[156:159], v[180:183]
 v_mfma_f32_16x16x32_bf16 v[176:179], a[236:239], a[148:151], v[176:179]
 v_mfma_f32_16x16x32_bf16 v[176:179], a[232:235], a[144:147], v[176:179]
 v_mfma_f32_16x16x32_bf16 v[172:175], a[232:235], a[136:139], v[172:175]
 s_waitcnt lgkmcnt(4)
 v_mfma_f32_16x16x32_bf16 v[172:175], a[236:239], a[140:143], v[172:175]
 ds_write_b128 v3, a[68:71] offset:6144
 ds_write_b128 v3, a[100:103] offset:7168
 v_mfma_f32_16x16x32_bf16 v[168:171], a[236:239], a[132:135], v[168:171]
 v_mfma_f32_16x16x32_bf16 v[168:171], a[232:235], a[128:131], v[168:171]
 ds_read_b128 a[76:79], v8 offset:14336
 s_waitcnt vmcnt(8)
 v_mfma_f32_16x16x32_bf16 v[200:203], a[192:195], a[128:131], v[200:203]
 ds_read_b128 a[108:111], v9 offset:14336
 v_mfma_f32_16x16x32_bf16 v[200:203], a[196:199], a[132:135], v[200:203]
 global_load_dwordx4 a[236:239], v0, s[70:71] offset:3072 sc1
 v_mfma_f32_16x16x32_bf16 v[204:207], a[196:199], a[140:143], v[204:207]
 v_mfma_f32_16x16x32_bf16 v[204:207], a[192:195], a[136:139], v[204:207]
 global_load_dwordx4 a[232:235], v0, s[70:71] offset:2048 sc1
 v_mfma_f32_16x16x32_bf16 v[208:211], a[192:195], a[144:147], v[208:211]
 s_waitcnt lgkmcnt(4)
 s_add_u32 s70, s70, 8192
 s_addc_u32 s71, s71, 0
 v_mfma_f32_16x16x32_bf16 v[208:211], a[196:199], a[148:151], v[208:211]
 ds_write_b128 v3, a[72:75] offset:10240
 v_mfma_f32_16x16x32_bf16 v[212:215], a[196:199], a[156:159], v[212:215]
 ds_write_b128 v3, a[104:107] offset:11264
 v_mfma_f32_16x16x32_bf16 v[212:215], a[192:195], a[152:155], v[212:215]
 v_mfma_f32_16x16x32_bf16 v[216:219], a[192:195], a[160:163], v[216:219]
 ds_read_b128 a[80:83], v8 offset:18432
 v_mfma_f32_16x16x32_bf16 v[216:219], a[196:199], a[164:167], v[216:219]
 ds_read_b128 a[112:115], v9 offset:18432
 v_mfma_f32_16x16x32_bf16 v[220:223], a[196:199], a[172:175], v[220:223]
 v_mfma_f32_16x16x32_bf16 v[220:223], a[192:195], a[168:171], v[220:223]
 v_mfma_f32_16x16x32_bf16 v[224:227], a[192:195], a[176:179], v[224:227]
 s_waitcnt lgkmcnt(4)
 ds_write_b128 v3, a[76:79] offset:14336
 ds_write_b128 v3, a[108:111] offset:15360
 v_mfma_f32_16x16x32_bf16 v[224:227], a[196:199], a[180:183], v[224:227]
 v_mfma_f32_16x16x32_bf16 v[228:231], a[196:199], a[188:191], v[228:231]
 v_mfma_f32_16x16x32_bf16 v[228:231], a[192:195], a[184:187], v[228:231]
 s_waitcnt vmcnt(8)
 v_mfma_f32_16x16x32_bf16 a[252:255], a[200:203], a[184:187], a[252:255]
 ds_read_b128 a[184:187], v1 offset:61440
 ds_read_b128 a[84:87], v8 offset:22528
 v_mfma_f32_16x16x32_bf16 a[252:255], a[204:207], a[188:191], a[252:255]
 global_load_dwordx4 a[196:199], v0, s[70:71] offset:-3072 sc1
 ds_read_b128 a[188:191], v1 offset:62464
 v_mfma_f32_16x16x32_bf16 a[248:251], a[204:207], a[180:183], a[248:251]
 ds_read_b128 a[180:183], v1 offset:58368
 ds_read_b128 a[116:119], v9 offset:22528
 v_mfma_f32_16x16x32_bf16 a[248:251], a[200:203], a[176:179], a[248:251]
 global_load_dwordx4 a[192:195], v0, s[70:71] offset:-4096 sc1
 ds_read_b128 a[176:179], v1 offset:57344
 v_mfma_f32_16x16x32_bf16 v[252:255], a[200:203], a[168:171], v[252:255]
 ds_read_b128 a[168:171], v1 offset:53248
 v_mfma_f32_16x16x32_bf16 v[252:255], a[204:207], a[172:175], v[252:255]
 ds_read_b128 a[172:175], v1 offset:54272
 s_waitcnt lgkmcnt(10)
 v_mfma_f32_16x16x32_bf16 v[248:251], a[204:207], a[164:167], v[248:251]
 ds_read_b128 a[164:167], v1 offset:50176
 v_mfma_f32_16x16x32_bf16 v[248:251], a[200:203], a[160:163], v[248:251]
 ds_read_b128 a[160:163], v1 offset:49152
 v_mfma_f32_16x16x32_bf16 v[244:247], a[200:203], a[152:155], v[244:247]
 ds_read_b128 a[152:155], v1 offset:45056
 v_mfma_f32_16x16x32_bf16 v[244:247], a[204:207], a[156:159], v[244:247]
 ds_read_b128 a[156:159], v1 offset:46080
 v_mfma_f32_16x16x32_bf16 v[240:243], a[204:207], a[148:151], v[240:243]
 ds_read_b128 a[148:151], v1 offset:41984
 v_mfma_f32_16x16x32_bf16 v[240:243], a[200:203], a[144:147], v[240:243]
 ds_read_b128 a[144:147], v1 offset:40960
 v_mfma_f32_16x16x32_bf16 v[236:239], a[200:203], a[136:139], v[236:239]
 ds_read_b128 a[136:139], v1 offset:36864
 v_mfma_f32_16x16x32_bf16 v[236:239], a[204:207], a[140:143], v[236:239]
 ds_read_b128 a[140:143], v1 offset:37888
 v_mfma_f32_16x16x32_bf16 v[232:235], a[204:207], a[132:135], v[232:235]
 ds_read_b128 a[132:135], v1 offset:33792
 v_mfma_f32_16x16x32_bf16 v[232:235], a[200:203], a[128:131], v[232:235]
 ds_read_b128 a[128:131], v1 offset:32768
 ds_write_b128 v3, a[80:83] offset:18432
 ds_write_b128 v3, a[112:115] offset:19456
 ds_read_b128 a[88:91], v8 offset:26624
 ds_read_b128 a[120:123], v9 offset:26624
 s_waitcnt vmcnt(8) lgkmcnt(12)
 v_mfma_f32_16x16x32_bf16 v[164:167], a[208:211], a[184:187], v[164:167]
 v_mfma_f32_16x16x32_bf16 v[164:167], a[212:215], a[188:191], v[164:167]
 global_load_dwordx4 a[204:207], v0, s[70:71] offset:-1024 sc1
 v_mfma_f32_16x16x32_bf16 v[160:163], a[212:215], a[180:183], v[160:163]
 ds_write_b128 v3, a[84:87] offset:22528
 ds_write_b128 v3, a[116:119] offset:23552
 v_mfma_f32_16x16x32_bf16 v[160:163], a[208:211], a[176:179], v[160:163]
 global_load_dwordx4 a[200:203], v0, s[70:71] offset:-2048 sc1
 ds_read_b128 a[92:95], v8 offset:30720
 v_mfma_f32_16x16x32_bf16 v[156:159], a[208:211], a[168:171], v[156:159]
 ds_read_b128 a[124:127], v9 offset:30720
 v_mfma_f32_16x16x32_bf16 v[156:159], a[212:215], a[172:175], v[156:159]
 v_mfma_f32_16x16x32_bf16 v[152:155], a[212:215], a[164:167], v[152:155]
 v_mfma_f32_16x16x32_bf16 v[152:155], a[208:211], a[160:163], v[152:155]
 s_waitcnt lgkmcnt(4)
 ds_write_b128 v3, a[88:91] offset:26624
 v_mfma_f32_16x16x32_bf16 v[148:151], a[208:211], a[152:155], v[148:151]
 ds_write_b128 v3, a[120:123] offset:27648
 v_mfma_f32_16x16x32_bf16 v[148:151], a[212:215], a[156:159], v[148:151]
 v_mfma_f32_16x16x32_bf16 v[144:147], a[212:215], a[148:151], v[144:147]
 v_mfma_f32_16x16x32_bf16 v[144:147], a[208:211], a[144:147], v[144:147]
 v_mfma_f32_16x16x32_bf16 v[140:143], a[208:211], a[136:139], v[140:143]
 v_mfma_f32_16x16x32_bf16 v[140:143], a[212:215], a[140:143], v[140:143]
 s_waitcnt lgkmcnt(2)
 v_mfma_f32_16x16x32_bf16 v[136:139], a[212:215], a[132:135], v[136:139]
 ds_write_b128 v3, a[92:95] offset:30720
 v_mfma_f32_16x16x32_bf16 v[136:139], a[208:211], a[128:131], v[136:139]
 ds_write_b128 v3, a[124:127] offset:31744
 s_waitcnt vmcnt(8)
 v_mfma_f32_16x16x32_bf16 v[168:171], a[216:219], a[128:131], v[168:171]
 v_bfe_u32 v4, v3, 8, 2
 v_mfma_f32_16x16x32_bf16 v[168:171], a[220:223], a[132:135], v[168:171]
 global_load_dwordx4 a[212:215], v0, s[70:71] offset:1024 sc1
 v_lshl_add_u32 v4, v4, 5, s51
 v_mfma_f32_16x16x32_bf16 v[172:175], a[220:223], a[140:143], v[172:175]
 ds_read_b128 v[8:11], v4
 v_mfma_f32_16x16x32_bf16 v[172:175], a[216:219], a[136:139], v[172:175]
 global_load_dwordx4 a[208:211], v0, s[70:71] offset:0 sc1
 v_mfma_f32_16x16x32_bf16 v[176:179], a[216:219], a[144:147], v[176:179]
 v_mfma_f32_16x16x32_bf16 v[176:179], a[220:223], a[148:151], v[176:179]
 v_mfma_f32_16x16x32_bf16 v[180:183], a[220:223], a[156:159], v[180:183]
 v_mfma_f32_16x16x32_bf16 v[180:183], a[216:219], a[152:155], v[180:183]
 v_mfma_f32_16x16x32_bf16 v[184:187], a[216:219], a[160:163], v[184:187]
 v_mfma_f32_16x16x32_bf16 v[184:187], a[220:223], a[164:167], v[184:187]
 v_mfma_f32_16x16x32_bf16 v[188:191], a[220:223], a[172:175], v[188:191]
 v_mfma_f32_16x16x32_bf16 v[188:191], a[216:219], a[168:171], v[188:191]
 s_waitcnt lgkmcnt(0)
 v_add_f32 v16, v16, v8
 v_mfma_f32_16x16x32_bf16 v[192:195], a[216:219], a[176:179], v[192:195]
 ds_read_b128 v[12:15], v4 offset:16
 v_mfma_f32_16x16x32_bf16 v[192:195], a[220:223], a[180:183], v[192:195]
 v_add_f32 v17, v17, v9
 v_mfma_f32_16x16x32_bf16 v[196:199], a[220:223], a[188:191], v[196:199]
 v_add_f32 v18, v18, v10
 v_mfma_f32_16x16x32_bf16 v[196:199], a[216:219], a[184:187], v[196:199]
 v_add_f32 v19, v19, v11
 s_waitcnt vmcnt(8)
 v_mfma_f32_16x16x32_bf16 v[228:231], a[224:227], a[184:187], v[228:231]
 v_add_f32 v20, v20, v8
 v_mfma_f32_16x16x32_bf16 v[228:231], a[228:231], a[188:191], v[228:231]
 global_load_dwordx4 a[220:223], v0, s[70:71] offset:3072 sc1
 v_add_f32 v21, v21, v9
 v_mfma_f32_16x16x32_bf16 v[224:227], a[228:231], a[180:183], v[224:227]
 v_add_f32 v22, v22, v10
 v_mfma_f32_16x16x32_bf16 v[224:227], a[224:227], a[176:179], v[224:227]
 global_load_dwordx4 a[216:219], v0, s[70:71] offset:2048 sc1
 v_add_f32 v23, v23, v11
 v_mfma_f32_16x16x32_bf16 v[220:223], a[224:227], a[168:171], v[220:223]
 v_add_f32 v24, v24, v8
 s_add_u32 s70, s70, 8192
 s_addc_u32 s71, s71, 0
 v_mfma_f32_16x16x32_bf16 v[220:223], a[228:231], a[172:175], v[220:223]
 v_add_f32 v25, v25, v9
 v_mfma_f32_16x16x32_bf16 v[216:219], a[228:231], a[164:167], v[216:219]
 v_add_f32 v26, v26, v10
 v_mfma_f32_16x16x32_bf16 v[216:219], a[224:227], a[160:163], v[216:219]
 v_add_f32 v27, v27, v11
 v_mfma_f32_16x16x32_bf16 v[212:215], a[224:227], a[152:155], v[212:215]
 v_add_f32 v28, v28, v8
 v_mfma_f32_16x16x32_bf16 v[212:215], a[228:231], a[156:159], v[212:215]
 v_add_f32 v29, v29, v9
 v_mfma_f32_16x16x32_bf16 v[208:211], a[228:231], a[148:151], v[208:211]
 v_add_f32 v30, v30, v10
 v_mfma_f32_16x16x32_bf16 v[208:211], a[224:227], a[144:147], v[208:211]
 v_add_f32 v31, v31, v11
 v_add_f32 v32, v32, v8
 v_mfma_f32_16x16x32_bf16 v[204:207], a[224:227], a[136:139], v[204:207]
 v_add_f32 v33, v33, v9
 v_mfma_f32_16x16x32_bf16 v[204:207], a[228:231], a[140:143], v[204:207]
 v_add_f32 v34, v34, v10
 v_mfma_f32_16x16x32_bf16 v[200:203], a[228:231], a[132:135], v[200:203]
 v_add_f32 v35, v35, v11
 v_mfma_f32_16x16x32_bf16 v[200:203], a[224:227], a[128:131], v[200:203]
 v_add_f32 v36, v36, v8
 v_add_f32 v37, v37, v9
 s_waitcnt vmcnt(8)
 v_mfma_f32_16x16x32_bf16 v[232:235], a[232:235], a[128:131], v[232:235]
 ds_read_b128 a[128:131], v2
 v_add_f32 v38, v38, v10
 v_mfma_f32_16x16x32_bf16 v[232:235], a[236:239], a[132:135], v[232:235]
 global_load_dwordx4 a[228:231], v0, s[70:71] offset:-3072 sc1
 ds_read_b128 a[132:135], v2 offset:1024
 v_mfma_f32_16x16x32_bf16 v[236:239], a[236:239], a[140:143], v[236:239]
 ds_read_b128 a[140:143], v2 offset:5120
 v_add_f32 v39, v39, v11
 v_mfma_f32_16x16x32_bf16 v[236:239], a[232:235], a[136:139], v[236:239]
 global_load_dwordx4 a[224:227], v0, s[70:71] offset:-4096 sc1
 ds_read_b128 a[136:139], v2 offset:4096
 v_mfma_f32_16x16x32_bf16 v[240:243], a[232:235], a[144:147], v[240:243]
 ds_read_b128 a[144:147], v2 offset:8192
 v_add_f32 v40, v40, v8
 v_mfma_f32_16x16x32_bf16 v[240:243], a[236:239], a[148:151], v[240:243]
 ds_read_b128 a[148:151], v2 offset:9216
 v_add_f32 v41, v41, v9
 v_mfma_f32_16x16x32_bf16 v[244:247], a[236:239], a[156:159], v[244:247]
 ds_read_b128 a[156:159], v2 offset:13312
 v_add_f32 v42, v42, v10
 v_mfma_f32_16x16x32_bf16 v[244:247], a[232:235], a[152:155], v[244:247]
 ds_read_b128 a[152:155], v2 offset:12288
 v_add_f32 v43, v43, v11
 v_mfma_f32_16x16x32_bf16 v[248:251], a[232:235], a[160:163], v[248:251]
 ds_read_b128 a[160:163], v2 offset:16384
 v_add_f32 v44, v44, v8
 v_mfma_f32_16x16x32_bf16 v[248:251], a[236:239], a[164:167], v[248:251]
 ds_read_b128 a[164:167], v2 offset:17408
 v_add_f32 v45, v45, v9
 v_mfma_f32_16x16x32_bf16 v[252:255], a[236:239], a[172:175], v[252:255]
 ds_read_b128 a[172:175], v2 offset:21504
 v_add_f32 v46, v46, v10
 v_mfma_f32_16x16x32_bf16 v[252:255], a[232:235], a[168:171], v[252:255]
 ds_read_b128 a[168:171], v2 offset:20480
 v_add_f32 v47, v47, v11
 s_waitcnt lgkmcnt(12)
 v_mfma_f32_16x16x32_bf16 a[248:251], a[232:235], a[176:179], a[248:251]
 ds_read_b128 a[176:179], v2 offset:24576
 v_add_f32 v48, v48, v12
 v_mfma_f32_16x16x32_bf16 a[248:251], a[236:239], a[180:183], a[248:251]
 ds_read_b128 a[180:183], v2 offset:25600
 ds_read_b128 v[8:11], v4 offset:128
 v_mfma_f32_16x16x32_bf16 a[252:255], a[236:239], a[188:191], a[252:255]
 ds_read_b128 a[188:191], v2 offset:29696
 v_add_f32 v49, v49, v13
 v_mfma_f32_16x16x32_bf16 a[252:255], a[232:235], a[184:187], a[252:255]
 ds_read_b128 a[184:187], v2 offset:28672
 v_add_f32 v50, v50, v14
 s_waitcnt vmcnt(8) lgkmcnt(9)
 v_mfma_f32_16x16x32_bf16 v[136:139], a[192:195], a[128:131], v[136:139]
 v_add_f32 v51, v51, v15
 v_add_f32 v52, v52, v12
 v_mfma_f32_16x16x32_bf16 v[136:139], a[196:199], a[132:135], v[136:139]
 global_load_dwordx4 a[236:239], v0, s[70:71] offset:-1024 sc1
 v_add_f32 v53, v53, v13
 v_mfma_f32_16x16x32_bf16 v[140:143], a[196:199], a[140:143], v[140:143]
 v_add_f32 v54, v54, v14
 v_mfma_f32_16x16x32_bf16 v[140:143], a[192:195], a[136:139], v[140:143]
 global_load_dwordx4 a[232:235], v0, s[70:71] offset:-2048 sc1
 v_add_f32 v55, v55, v15
 v_mfma_f32_16x16x32_bf16 v[144:147], a[192:195], a[144:147], v[144:147]
 v_add_f32 v56, v56, v12
 v_mfma_f32_16x16x32_bf16 v[144:147], a[196:199], a[148:151], v[144:147]
 v_add_f32 v57, v57, v13
 v_mfma_f32_16x16x32_bf16 v[148:151], a[196:199], a[156:159], v[148:151]
 v_add_f32 v58, v58, v14
 v_mfma_f32_16x16x32_bf16 v[148:151], a[192:195], a[152:155], v[148:151]
 v_add_f32 v59, v59, v15
 s_waitcnt lgkmcnt(0)
 v_mfma_f32_16x16x32_bf16 v[152:155], a[192:195], a[160:163], v[152:155]
 v_add_f32 v60, v60, v12
 v_mfma_f32_16x16x32_bf16 v[152:155], a[196:199], a[164:167], v[152:155]
 v_add_f32 v61, v61, v13
 v_mfma_f32_16x16x32_bf16 v[156:159], a[196:199], a[172:175], v[156:159]
 v_add_f32 v62, v62, v14
 v_mfma_f32_16x16x32_bf16 v[156:159], a[192:195], a[168:171], v[156:159]
 v_add_f32 v63, v63, v15
 v_mfma_f32_16x16x32_bf16 v[160:163], a[192:195], a[176:179], v[160:163]
 v_add_f32 v64, v64, v12
 v_mfma_f32_16x16x32_bf16 v[160:163], a[196:199], a[180:183], v[160:163]
 v_add_f32 v65, v65, v13
 v_mfma_f32_16x16x32_bf16 v[164:167], a[196:199], a[188:191], v[164:167]
 v_add_f32 v66, v66, v14
 v_mfma_f32_16x16x32_bf16 v[164:167], a[192:195], a[184:187], v[164:167]
 v_add_f32 v67, v67, v15
 s_waitcnt vmcnt(8)
 v_mfma_f32_16x16x32_bf16 v[196:199], a[200:203], a[184:187], v[196:199]
 v_add_f32 v68, v68, v12
 v_mfma_f32_16x16x32_bf16 v[196:199], a[204:207], a[188:191], v[196:199]
 global_load_dwordx4 a[196:199], v0, s[70:71] offset:1024 sc1
 v_add_f32 v69, v69, v13
 v_mfma_f32_16x16x32_bf16 v[192:195], a[204:207], a[180:183], v[192:195]
 v_add_f32 v70, v70, v14
 v_add_f32 v71, v71, v15
 v_mfma_f32_16x16x32_bf16 v[192:195], a[200:203], a[176:179], v[192:195]
 global_load_dwordx4 a[192:195], v0, s[70:71] offset:0 sc1
 v_add_f32 v72, v72, v12
 v_mfma_f32_16x16x32_bf16 v[188:191], a[200:203], a[168:171], v[188:191]
 v_add_f32 v73, v73, v13
 v_mfma_f32_16x16x32_bf16 v[188:191], a[204:207], a[172:175], v[188:191]
 v_add_f32 v74, v74, v14
 v_mfma_f32_16x16x32_bf16 v[184:187], a[204:207], a[164:167], v[184:187]
 v_add_f32 v75, v75, v15
 v_mfma_f32_16x16x32_bf16 v[184:187], a[200:203], a[160:163], v[184:187]
 v_add_f32 v76, v76, v12
 v_mfma_f32_16x16x32_bf16 v[180:183], a[200:203], a[152:155], v[180:183]
 v_add_f32 v77, v77, v13
 v_mfma_f32_16x16x32_bf16 v[180:183], a[204:207], a[156:159], v[180:183]
 v_add_f32 v78, v78, v14
 v_mfma_f32_16x16x32_bf16 v[176:179], a[204:207], a[148:151], v[176:179]
 v_add_f32 v79, v79, v15
 v_mfma_f32_16x16x32_bf16 v[176:179], a[200:203], a[144:147], v[176:179]
 v_mfma_f32_16x16x32_bf16 v[172:175], a[200:203], a[136:139], v[172:175]
 v_add_f32 v80, v80, v8
 v_mfma_f32_16x16x32_bf16 v[172:175], a[204:207], a[140:143], v[172:175]
 ds_read_b128 v[12:15], v4 offset:144
 v_mfma_f32_16x16x32_bf16 v[168:171], a[204:207], a[132:135], v[168:171]
 v_add_f32 v81, v81, v9
 v_mfma_f32_16x16x32_bf16 v[168:171], a[200:203], a[128:131], v[168:171]
 v_add_f32 v82, v82, v10
 s_waitcnt vmcnt(8)
 v_mfma_f32_16x16x32_bf16 v[200:203], a[208:211], a[128:131], v[200:203]
 v_add_f32 v83, v83, v11
 v_mfma_f32_16x16x32_bf16 v[200:203], a[212:215], a[132:135], v[200:203]
 global_load_dwordx4 a[204:207], v0, s[70:71] offset:3072 sc1
 v_add_f32 v84, v84, v8
 v_mfma_f32_16x16x32_bf16 v[204:207], a[212:215], a[140:143], v[204:207]
 v_add_f32 v85, v85, v9
 v_mfma_f32_16x16x32_bf16 v[204:207], a[208:211], a[136:139], v[204:207]
 global_load_dwordx4 a[200:203], v0, s[70:71] offset:2048 sc1
 v_add_f32 v86, v86, v10
 v_mfma_f32_16x16x32_bf16 v[208:211], a[208:211], a[144:147], v[208:211]
 v_add_f32 v87, v87, v11
 s_add_u32 s70, s70, 8192
 s_addc_u32 s71, s71, 0
 v_mfma_f32_16x16x32_bf16 v[208:211], a[212:215], a[148:151], v[208:211]
 v_add_f32 v88, v88, v8
 v_add_f32 v89, v89, v9
 v_mfma_f32_16x16x32_bf16 v[212:215], a[212:215], a[156:159], v[212:215]
 v_add_f32 v90, v90, v10
 v_mfma_f32_16x16x32_bf16 v[212:215], a[208:211], a[152:155], v[212:215]
 v_add_f32 v91, v91, v11
 v_mfma_f32_16x16x32_bf16 v[216:219], a[208:211], a[160:163], v[216:219]
 v_add_f32 v92, v92, v8
 v_mfma_f32_16x16x32_bf16 v[216:219], a[212:215], a[164:167], v[216:219]
 v_add_f32 v93, v93, v9
 v_mfma_f32_16x16x32_bf16 v[220:223], a[212:215], a[172:175], v[220:223]
 v_add_f32 v94, v94, v10
 v_mfma_f32_16x16x32_bf16 v[220:223], a[208:211], a[168:171], v[220:223]
 v_add_f32 v95, v95, v11
 v_mfma_f32_16x16x32_bf16 v[224:227], a[208:211], a[176:179], v[224:227]
 v_add_f32 v96, v96, v8
 v_mfma_f32_16x16x32_bf16 v[224:227], a[212:215], a[180:183], v[224:227]
 v_add_f32 v97, v97, v9
 v_mfma_f32_16x16x32_bf16 v[228:231], a[212:215], a[188:191], v[228:231]
 v_add_f32 v98, v98, v10
 v_add_f32 v99, v99, v11
 v_mfma_f32_16x16x32_bf16 v[228:231], a[208:211], a[184:187], v[228:231]
 v_add_f32 v100, v100, v8
 v_add_f32 v101, v101, v9
 s_waitcnt vmcnt(8)
 v_mfma_f32_16x16x32_bf16 a[252:255], a[216:219], a[184:187], a[252:255]
 ds_read_b128 a[184:187], v2 offset:61440
 v_add_f32 v102, v102, v10
 v_mfma_f32_16x16x32_bf16 a[252:255], a[220:223], a[188:191], a[252:255]
 global_load_dwordx4 a[212:215], v0, s[70:71] offset:-3072 sc1
 ds_read_b128 a[188:191], v2 offset:62464
 v_mfma_f32_16x16x32_bf16 a[248:251], a[220:223], a[180:183], a[248:251]
 ds_read_b128 a[180:183], v2 offset:58368
 v_add_f32 v103, v103, v11
 v_mfma_f32_16x16x32_bf16 a[248:251], a[216:219], a[176:179], a[248:251]
 global_load_dwordx4 a[208:211], v0, s[70:71] offset:-4096 sc1
 ds_read_b128 a[176:179], v2 offset:57344
 v_mfma_f32_16x16x32_bf16 v[252:255], a[216:219], a[168:171], v[252:255]
 ds_read_b128 a[168:171], v2 offset:53248
 v_add_f32 v104, v104, v8
 v_mfma_f32_16x16x32_bf16 v[252:255], a[220:223], a[172:175], v[252:255]
 ds_read_b128 a[172:175], v2 offset:54272
 v_add_f32 v105, v105, v9
 v_mfma_f32_16x16x32_bf16 v[248:251], a[220:223], a[164:167], v[248:251]
 ds_read_b128 a[164:167], v2 offset:50176
 v_add_f32 v106, v106, v10
 v_mfma_f32_16x16x32_bf16 v[248:251], a[216:219], a[160:163], v[248:251]
 ds_read_b128 a[160:163], v2 offset:49152
 v_add_f32 v107, v107, v11
 v_mfma_f32_16x16x32_bf16 v[244:247], a[216:219], a[152:155], v[244:247]
 ds_read_b128 a[152:155], v2 offset:45056
 v_add_f32 v108, v108, v8
 v_mfma_f32_16x16x32_bf16 v[244:247], a[220:223], a[156:159], v[244:247]
 ds_read_b128 a[156:159], v2 offset:46080
 v_add_f32 v109, v109, v9
 v_mfma_f32_16x16x32_bf16 v[240:243], a[220:223], a[148:151], v[240:243]
 ds_read_b128 a[148:151], v2 offset:41984
 v_add_f32 v110, v110, v10
 v_mfma_f32_16x16x32_bf16 v[240:243], a[216:219], a[144:147], v[240:243]
 ds_read_b128 a[144:147], v2 offset:40960
 v_add_f32 v111, v111, v11
 s_waitcnt lgkmcnt(12)
 v_mfma_f32_16x16x32_bf16 v[236:239], a[216:219], a[136:139], v[236:239]
 ds_read_b128 a[136:139], v2 offset:36864
 v_add_f32 v112, v112, v12
 v_mfma_f32_16x16x32_bf16 v[236:239], a[220:223], a[140:143], v[236:239]
 ds_read_b128 a[140:143], v2 offset:37888
 v_add_f32 v113, v113, v13
 v_mfma_f32_16x16x32_bf16 v[232:235], a[220:223], a[132:135], v[232:235]
 ds_read_b128 a[132:135], v2 offset:33792
 v_add_f32 v114, v114, v14
 v_mfma_f32_16x16x32_bf16 v[232:235], a[216:219], a[128:131], v[232:235]
 ds_read_b128 a[128:131], v2 offset:32768
 v_add_f32 v115, v115, v15
 s_waitcnt vmcnt(8) lgkmcnt(8)
 v_mfma_f32_16x16x32_bf16 v[164:167], a[224:227], a[184:187], v[164:167]
 v_add_f32 v116, v116, v12
 v_mfma_f32_16x16x32_bf16 v[164:167], a[228:231], a[188:191], v[164:167]
 global_load_dwordx4 a[220:223], v0, s[70:71] offset:-1024 sc1
 v_add_f32 v117, v117, v13
 v_mfma_f32_16x16x32_bf16 v[160:163], a[228:231], a[180:183], v[160:163]
 v_add_f32 v118, v118, v14
 v_mfma_f32_16x16x32_bf16 v[160:163], a[224:227], a[176:179], v[160:163]
 global_load_dwordx4 a[216:219], v0, s[70:71] offset:-2048 sc1
 v_add_f32 v119, v119, v15
 v_mfma_f32_16x16x32_bf16 v[156:159], a[224:227], a[168:171], v[156:159]
 v_add_f32 v120, v120, v12
 v_mfma_f32_16x16x32_bf16 v[156:159], a[228:231], a[172:175], v[156:159]
 v_add_f32 v121, v121, v13
 v_mfma_f32_16x16x32_bf16 v[152:155], a[228:231], a[164:167], v[152:155]
 v_add_f32 v122, v122, v14
 v_mfma_f32_16x16x32_bf16 v[152:155], a[224:227], a[160:163], v[152:155]
 v_add_f32 v123, v123, v15
 s_waitcnt lgkmcnt(0)
 v_mfma_f32_16x16x32_bf16 v[148:151], a[224:227], a[152:155], v[148:151]
 v_add_f32 v124, v124, v12
 v_mfma_f32_16x16x32_bf16 v[148:151], a[228:231], a[156:159], v[148:151]
 v_add_f32 v125, v125, v13
 v_mfma_f32_16x16x32_bf16 v[144:147], a[228:231], a[148:151], v[144:147]
 v_add_f32 v126, v126, v14
 v_mfma_f32_16x16x32_bf16 v[144:147], a[224:227], a[144:147], v[144:147]
 v_add_f32 v127, v127, v15
 v_mfma_f32_16x16x32_bf16 v[140:143], a[224:227], a[136:139], v[140:143]
 v_add_f32 v128, v128, v12
 v_add_f32 v129, v129, v13
 v_mfma_f32_16x16x32_bf16 v[140:143], a[228:231], a[140:143], v[140:143]
 v_add_f32 v130, v130, v14
 v_mfma_f32_16x16x32_bf16 v[136:139], a[228:231], a[132:135], v[136:139]
 v_add_f32 v131, v131, v15
 v_mfma_f32_16x16x32_bf16 v[136:139], a[224:227], a[128:131], v[136:139]
 v_add_f32 v132, v132, v12
 s_waitcnt vmcnt(8)
 v_mfma_f32_16x16x32_bf16 v[168:171], a[232:235], a[128:131], v[168:171]
 v_add_f32 v133, v133, v13
 v_mfma_f32_16x16x32_bf16 v[168:171], a[236:239], a[132:135], v[168:171]
 global_load_dwordx4 a[228:231], v0, s[70:71] offset:1024 sc1
 v_add_f32 v134, v134, v14
 v_mfma_f32_16x16x32_bf16 v[172:175], a[236:239], a[140:143], v[172:175]
 v_add_f32 v135, v135, v15
 v_mfma_f32_16x16x32_bf16 v[172:175], a[232:235], a[136:139], v[172:175]
 global_load_dwordx4 a[224:227], v0, s[70:71] offset:0 sc1
 v_accvgpr_read_b32 v5, a240
 v_mfma_f32_16x16x32_bf16 v[176:179], a[232:235], a[144:147], v[176:179]
 v_add_f32 v5, v5, v12
 v_mfma_f32_16x16x32_bf16 v[176:179], a[236:239], a[148:151], v[176:179]
 v_accvgpr_write_b32 a240, v5
 v_mfma_f32_16x16x32_bf16 v[180:183], a[236:239], a[156:159], v[180:183]
 v_accvgpr_read_b32 v6, a241
 v_mfma_f32_16x16x32_bf16 v[180:183], a[232:235], a[152:155], v[180:183]
 v_add_f32 v6, v6, v13
 v_mfma_f32_16x16x32_bf16 v[184:187], a[232:235], a[160:163], v[184:187]
 v_accvgpr_write_b32 a241, v6
 v_mfma_f32_16x16x32_bf16 v[184:187], a[236:239], a[164:167], v[184:187]
 v_accvgpr_read_b32 v5, a242
 v_mfma_f32_16x16x32_bf16 v[188:191], a[236:239], a[172:175], v[188:191]
 v_add_f32 v5, v5, v14
 v_mfma_f32_16x16x32_bf16 v[188:191], a[232:235], a[168:171], v[188:191]
 v_accvgpr_write_b32 a242, v5
 v_mfma_f32_16x16x32_bf16 v[192:195], a[232:235], a[176:179], v[192:195]
 v_accvgpr_read_b32 v6, a243
 v_mfma_f32_16x16x32_bf16 v[192:195], a[236:239], a[180:183], v[192:195]
 v_add_f32 v6, v6, v15
 v_mfma_f32_16x16x32_bf16 v[196:199], a[236:239], a[188:191], v[196:199]
 v_accvgpr_write_b32 a243, v6
 v_mfma_f32_16x16x32_bf16 v[196:199], a[232:235], a[184:187], v[196:199]
 v_accvgpr_read_b32 v5, a244
 s_waitcnt vmcnt(8)
 v_mfma_f32_16x16x32_bf16 v[228:231], a[192:195], a[184:187], v[228:231]
 v_add_f32 v5, v5, v12
 v_accvgpr_write_b32 a244, v5
 v_mfma_f32_16x16x32_bf16 v[228:231], a[196:199], a[188:191], v[228:231]
 global_load_dwordx4 a[236:239], v0, s[70:71] offset:3072 sc1
 v_accvgpr_read_b32 v6, a245
 v_mfma_f32_16x16x32_bf16 v[224:227], a[196:199], a[180:183], v[224:227]
 v_add_f32 v6, v6, v13
 v_mfma_f32_16x16x32_bf16 v[224:227], a[192:195], a[176:179], v[224:227]
 global_load_dwordx4 a[232:235], v0, s[70:71] offset:2048 sc1
 v_accvgpr_write_b32 a245, v6
 v_mfma_f32_16x16x32_bf16 v[220:223], a[192:195], a[168:171], v[220:223]
 v_accvgpr_read_b32 v5, a246
 s_add_u32 s70, s70, 8192
 s_addc_u32 s71, s71, 0
 v_mfma_f32_16x16x32_bf16 v[220:223], a[196:199], a[172:175], v[220:223]
 v_add_f32 v5, v5, v14
 v_mfma_f32_16x16x32_bf16 v[216:219], a[196:199], a[164:167], v[216:219]
 v_accvgpr_write_b32 a246, v5
 v_mfma_f32_16x16x32_bf16 v[216:219], a[192:195], a[160:163], v[216:219]
 v_accvgpr_read_b32 v6, a247
 v_mfma_f32_16x16x32_bf16 v[212:215], a[192:195], a[152:155], v[212:215]
 v_add_f32 v6, v6, v15
 v_mfma_f32_16x16x32_bf16 v[212:215], a[196:199], a[156:159], v[212:215]
 v_accvgpr_write_b32 a247, v6
 v_mfma_f32_16x16x32_bf16 v[208:211], a[196:199], a[148:151], v[208:211]
 s_add_u32 s55, s55, 1
 s_waitcnt lgkmcnt(0)
 s_barrier
 v_mfma_f32_16x16x32_bf16 v[208:211], a[192:195], a[144:147], v[208:211]
 v_mfma_f32_16x16x32_bf16 v[204:207], a[192:195], a[136:139], v[204:207]
 v_mfma_f32_16x16x32_bf16 v[204:207], a[196:199], a[140:143], v[204:207]
 v_mfma_f32_16x16x32_bf16 v[200:203], a[196:199], a[132:135], v[200:203]
 v_mfma_f32_16x16x32_bf16 v[200:203], a[192:195], a[128:131], v[200:203]
 s_waitcnt vmcnt(8)
 v_mfma_f32_16x16x32_bf16 v[232:235], a[200:203], a[128:131], v[232:235]
 ds_read_b128 a[128:131], v1 offset:2048
 v_mfma_f32_16x16x32_bf16 v[232:235], a[204:207], a[132:135], v[232:235]
 global_load_dwordx4 a[196:199], v0, s[70:71] offset:-3072 sc1
 ds_read_b128 a[132:135], v1 offset:3072
 v_mfma_f32_16x16x32_bf16 v[236:239], a[204:207], a[140:143], v[236:239]
 ds_read_b128 a[140:143], v1 offset:7168
 v_mfma_f32_16x16x32_bf16 v[236:239], a[200:203], a[136:139], v[236:239]
 global_load_dwordx4 a[192:195], v0, s[70:71] offset:-4096 sc1
 ds_read_b128 a[136:139], v1 offset:6144
 v_mfma_f32_16x16x32_bf16 v[240:243], a[200:203], a[144:147], v[240:243]
 ds_read_b128 a[144:147], v1 offset:10240
 v_mfma_f32_16x16x32_bf16 v[240:243], a[204:207], a[148:151], v[240:243]
 ds_read_b128 a[148:151], v1 offset:11264
 v_mfma_f32_16x16x32_bf16 v[244:247], a[204:207], a[156:159], v[244:247]
 ds_read_b128 a[156:159], v1 offset:15360
 v_mfma_f32_16x16x32_bf16 v[244:247], a[200:203], a[152:155], v[244:247]
 ds_read_b128 a[152:155], v1 offset:14336
 v_mfma_f32_16x16x32_bf16 v[248:251], a[200:203], a[160:163], v[248:251]
 ds_read_b128 a[160:163], v1 offset:18432
 v_mfma_f32_16x16x32_bf16 v[248:251], a[204:207], a[164:167], v[248:251]
 ds_read_b128 a[164:167], v1 offset:19456
 v_mfma_f32_16x16x32_bf16 v[252:255], a[204:207], a[172:175], v[252:255]
 ds_read_b128 a[172:175], v1 offset:23552
 v_mfma_f32_16x16x32_bf16 v[252:255], a[200:203], a[168:171], v[252:255]
 ds_read_b128 a[168:171], v1 offset:22528
 v_mfma_f32_16x16x32_bf16 a[248:251], a[200:203], a[176:179], a[248:251]
 ds_read_b128 a[176:179], v1 offset:26624
 v_mfma_f32_16x16x32_bf16 a[248:251], a[204:207], a[180:183], a[248:251]
 ds_read_b128 a[180:183], v1 offset:27648
 v_mfma_f32_16x16x32_bf16 a[252:255], a[204:207], a[188:191], a[252:255]
 global_load_dwordx4 a[204:207], v0, s[70:71] offset:-1024 sc1
 ds_read_b128 a[188:191], v1 offset:31744
 v_mfma_f32_16x16x32_bf16 a[252:255], a[200:203], a[184:187], a[252:255]
 global_load_dwordx4 a[200:203], v0, s[70:71] offset:-2048 sc1
 ds_read_b128 a[184:187], v1 offset:30720
 s_waitcnt vmcnt(10) lgkmcnt(8)
Lloop:
 v_mfma_f32_16x16x32_bf16 v[16:19], a[208:211], a[128:131], v[16:19]
 v_mfma_f32_16x16x32_bf16 v[16:19], a[212:215], a[132:135], v[16:19]
 v_mov_b32 v6, v3
 s_cmp_eq_u32 s25, 0
 s_cbranch_scc1 Lgat0
Lgatr0:
 s_add_u32 s29, s29, 0x2000000
 v_mfma_f32_16x16x32_bf16 v[20:23], a[212:215], a[140:143], v[20:23]
 v_mfma_f32_16x16x32_bf16 v[20:23], a[208:211], a[136:139], v[20:23]
 v_mfma_f32_16x16x32_bf16 v[24:27], a[208:211], a[144:147], v[24:27]
 s_add_u32 m0, s50, 0
 v_mfma_f32_16x16x32_bf16 v[24:27], a[212:215], a[148:151], v[24:27]
 v_mfma_f32_16x16x32_bf16 v[28:31], a[212:215], a[156:159], v[28:31]
 v_mfma_f32_16x16x32_bf16 v[28:31], a[208:211], a[152:155], v[28:31]
 s_waitcnt lgkmcnt(0)
 v_mfma_f32_16x16x32_bf16 v[32:35], a[208:211], a[160:163], v[32:35]
 v_mfma_f32_16x16x32_bf16 v[32:35], a[212:215], a[164:167], v[32:35]
 v_mfma_f32_16x16x32_bf16 v[36:39], a[212:215], a[172:175], v[36:39]
 v_mfma_f32_16x16x32_bf16 v[36:39], a[208:211], a[168:171], v[36:39]
 buffer_load_dwordx4 v6, s[8:11], s30 offen lds
 v_mfma_f32_16x16x32_bf16 v[40:43], a[208:211], a[176:179], v[40:43]
 v_mfma_f32_16x16x32_bf16 v[40:43], a[212:215], a[180:183], v[40:43]
 v_mfma_f32_16x16x32_bf16 v[44:47], a[212:215], a[188:191], v[44:47]
 s_add_u32 m0, m0, 1024
 v_mfma_f32_16x16x32_bf16 v[44:47], a[208:211], a[184:187], v[44:47]
 s_waitcnt vmcnt(9)
 v_mfma_f32_16x16x32_bf16 v[76:79], a[216:219], a[184:187], v[76:79]
 v_mfma_f32_16x16x32_bf16 v[76:79], a[220:223], a[188:191], v[76:79]
 global_load_dwordx4 a[212:215], v0, s[70:71] offset:1024 sc1
 s_add_u32 s30, s30, s20
 v_mfma_f32_16x16x32_bf16 v[72:75], a[220:223], a[180:183], v[72:75]
 v_mfma_f32_16x16x32_bf16 v[72:75], a[216:219], a[176:179], v[72:75]
 global_load_dwordx4 a[208:211], v0, s[70:71] offset:0 sc1
 v_mfma_f32_16x16x32_bf16 v[68:71], a[216:219], a[168:171], v[68:71]
 buffer_load_dwordx4 v6, s[8:11], s30 offen lds
 v_mfma_f32_16x16x32_bf16 v[68:71], a[220:223], a[172:175], v[68:71]
 v_mfma_f32_16x16x32_bf16 v[64:67], a[220:223], a[164:167], v[64:67]
 v_mfma_f32_16x16x32_bf16 v[64:67], a[216:219], a[160:163], v[64:67]
 v_mfma_f32_16x16x32_bf16 v[60:63], a[216:219], a[152:155], v[60:63]
 s_add_u32 m0, m0, 3072
 v_mfma_f32_16x16x32_bf16 v[60:63], a[220:223], a[156:159], v[60:63]
 v_mfma_f32_16x16x32_bf16 v[56:59], a[220:223], a[148:151], v[56:59]
 v_mfma_f32_16x16x32_bf16 v[56:59], a[216:219], a[144:147], v[56:59]
 s_add_u32 s30, s30, s21
 v_mfma_f32_16x16x32_bf16 v[52:55], a[216:219], a[136:139], v[52:55]
 v_mfma_f32_16x16x32_bf16 v[52:55], a[220:223], a[140:143], v[52:55]
 v_mfma_f32_16x16x32_bf16 v[48:51], a[220:223], a[132:135], v[48:51]
 v_mfma_f32_16x16x32_bf16 v[48:51], a[216:219], a[128:131], v[48:51]
 s_waitcnt vmcnt(10)
 v_mfma_f32_16x16x32_bf16 v[80:83], a[224:227], a[128:131], v[80:83]
 v_mfma_f32_16x16x32_bf16 v[80:83], a[228:231], a[132:135], v[80:83]
 global_load_dwordx4 a[220:223], v0, s[70:71] offset:3072 sc1
 v_mfma_f32_16x16x32_bf16 v[84:87], a[228:231], a[140:143], v[84:87]
 v_mfma_f32_16x16x32_bf16 v[84:87], a[224:227], a[136:139], v[84:87]
 global_load_dwordx4 a[216:219], v0, s[70:71] offset:2048 sc1
 v_mfma_f32_16x16x32_bf16 v[88:91], a[224:227], a[144:147], v[88:91]
 s_add_u32 s70, s70, 8192
 s_addc_u32 s71, s71, 0
 v_mfma_f32_16x16x32_bf16 v[88:91], a[228:231], a[148:151], v[88:91]
 v_mfma_f32_16x16x32_bf16 v[92:95], a[228:231], a[156:159], v[92:95]
 v_mfma_f32_16x16x32_bf16 v[92:95], a[224:227], a[152:155], v[92:95]
 v_mfma_f32_16x16x32_bf16 v[96:99], a[224:227], a[160:163], v[96:99]
 v_mfma_f32_16x16x32_bf16 v[96:99], a[228:231], a[164:167], v[96:99]
 v_mfma_f32_16x16x32_bf16 v[100:103], a[228:231], a[172:175], v[100:103]
 v_mfma_f32_16x16x32_bf16 v[100:103], a[224:227], a[168:171], v[100:103]
 v_mfma_f32_16x16x32_bf16 v[104:107], a[224:227], a[176:179], v[104:107]
 v_mfma_f32_16x16x32_bf16 v[104:107], a[228:231], a[180:183], v[104:107]
 v_mfma_f32_16x16x32_bf16 v[108:111], a[228:231], a[188:191], v[108:111]
 v_mfma_f32_16x16x32_bf16 v[108:111], a[224:227], a[184:187], v[108:111]
 s_waitcnt vmcnt(10)
 v_mfma_f32_16x16x32_bf16 a[244:247], a[232:235], a[184:187], a[244:247]
 v_mfma_f32_16x16x32_bf16 a[244:247], a[236:239], a[188:191], a[244:247]
 global_load_dwordx4 a[228:231], v0, s[70:71] offset:-3072 sc1
 v_mfma_f32_16x16x32_bf16 a[240:243], a[236:239], a[180:183], a[240:243]
 v_mfma_f32_16x16x32_bf16 a[240:243], a[232:235], a[176:179], a[240:243]
 global_load_dwordx4 a[224:227], v0, s[70:71] offset:-4096 sc1
 v_mfma_f32_16x16x32_bf16 v[132:135], a[232:235], a[168:171], v[132:135]
 v_mfma_f32_16x16x32_bf16 v[132:135], a[236:239], a[172:175], v[132:135]
 v_mfma_f32_16x16x32_bf16 v[128:131], a[236:239], a[164:167], v[128:131]
 v_mfma_f32_16x16x32_bf16 v[128:131], a[232:235], a[160:163], v[128:131]
 v_mfma_f32_16x16x32_bf16 v[124:127], a[232:235], a[152:155], v[124:127]
 v_mfma_f32_16x16x32_bf16 v[124:127], a[236:239], a[156:159], v[124:127]
 v_mfma_f32_16x16x32_bf16 v[120:123], a[236:239], a[148:151], v[120:123]
 v_mfma_f32_16x16x32_bf16 v[120:123], a[232:235], a[144:147], v[120:123]
 v_mfma_f32_16x16x32_bf16 v[116:119], a[232:235], a[136:139], v[116:119]
 v_mfma_f32_16x16x32_bf16 v[116:119], a[236:239], a[140:143], v[116:119]
 v_mfma_f32_16x16x32_bf16 v[112:115], a[236:239], a[132:135], v[112:115]
 buffer_load_dwordx4 v6, s[8:11], s30 offen lds
 v_mfma_f32_16x16x32_bf16 v[112:115], a[232:235], a[128:131], v[112:115]
 s_waitcnt vmcnt(11)
 v_mfma_f32_16x16x32_bf16 v[136:139], a[192:195], a[128:131], v[136:139]
 v_mfma_f32_16x16x32_bf16 v[136:139], a[196:199], a[132:135], v[136:139]
 global_load_dwordx4 a[236:239], v0, s[70:71] offset:-1024 sc1
 v_mfma_f32_16x16x32_bf16 v[140:143], a[196:199], a[140:143], v[140:143]
 s_add_u32 m0, m0, 1024
 v_mfma_f32_16x16x32_bf16 v[140:143], a[192:195], a[136:139], v[140:143]
 global_load_dwordx4 a[232:235], v0, s[70:71] offset:-2048 sc1
 v_mfma_f32_16x16x32_bf16 v[144:147], a[192:195], a[144:147], v[144:147]
 v_mfma_f32_16x16x32_bf16 v[144:147], a[196:199], a[148:151], v[144:147]
 s_add_u32 s30, s30, s20
 v_mfma_f32_16x16x32_bf16 v[148:151], a[196:199], a[156:159], v[148:151]
 v_mfma_f32_16x16x32_bf16 v[148:151], a[192:195], a[152:155], v[148:151]
 v_mfma_f32_16x16x32_bf16 v[152:155], a[192:195], a[160:163], v[152:155]
 buffer_load_dwordx4 v6, s[8:11], s30 offen lds
 v_mfma_f32_16x16x32_bf16 v[152:155], a[196:199], a[164:167], v[152:155]
 v_mfma_f32_16x16x32_bf16 v[156:159], a[196:199], a[172:175], v[156:159]
 v_mfma_f32_16x16x32_bf16 v[156:159], a[192:195], a[168:171], v[156:159]
 s_add_u32 m0, m0, 3072
 v_mfma_f32_16x16x32_bf16 v[160:163], a[192:195], a[176:179], v[160:163]
 v_mfma_f32_16x16x32_bf16 v[160:163], a[196:199], a[180:183], v[160:163]
 v_mfma_f32_16x16x32_bf16 v[164:167], a[196:199], a[188:191], v[164:167]
 s_add_u32 s30, s30, s21
 v_mfma_f32_16x16x32_bf16 v[164:167], a[192:195], a[184:187], v[164:167]
 s_waitcnt vmcnt(12)
 v_mfma_f32_16x16x32_bf16 v[196:199], a[200:203], a[184:187], v[196:199]
 v_mfma_f32_16x16x32_bf16 v[196:199], a[204:207], a[188:191], v[196:199]
 global_load_dwordx4 a[196:199], v0, s[70:71] offset:1024 sc1
 v_mfma_f32_16x16x32_bf16 v[192:195], a[204:207], a[180:183], v[192:195]
 s_add_u32 s31, s31, 1
 v_mov_b32 v7, s31
 buffer_store_dword v7, v1, s[60:63], 0 offen sc1
 v_mfma_f32_16x16x32_bf16 v[192:195], a[200:203], a[176:179], v[192:195]
 global_load_dwordx4 a[192:195], v0, s[70:71] offset:0 sc1
 v_mfma_f32_16x16x32_bf16 v[188:191], a[200:203], a[168:171], v[188:191]
 v_mfma_f32_16x16x32_bf16 v[188:191], a[204:207], a[172:175], v[188:191]
 v_mfma_f32_16x16x32_bf16 v[184:187], a[204:207], a[164:167], v[184:187]
 v_mfma_f32_16x16x32_bf16 v[184:187], a[200:203], a[160:163], v[184:187]
 v_mfma_f32_16x16x32_bf16 v[180:183], a[200:203], a[152:155], v[180:183]
 v_mfma_f32_16x16x32_bf16 v[180:183], a[204:207], a[156:159], v[180:183]
 v_mfma_f32_16x16x32_bf16 v[176:179], a[204:207], a[148:151], v[176:179]
 v_mfma_f32_16x16x32_bf16 v[176:179], a[200:203], a[144:147], v[176:179]
 v_mfma_f32_16x16x32_bf16 v[172:175], a[200:203], a[136:139], v[172:175]
 v_mfma_f32_16x16x32_bf16 v[172:175], a[204:207], a[140:143], v[172:175]
 v_mfma_f32_16x16x32_bf16 v[168:171], a[204:207], a[132:135], v[168:171]
 v_mfma_f32_16x16x32_bf16 v[168:171], a[200:203], a[128:131], v[168:171]
 s_waitcnt vmcnt(12)
 v_mfma_f32_16x16x32_bf16 v[200:203], a[208:211], a[128:131], v[200:203]
 v_mfma_f32_16x16x32_bf16 v[200:203], a[212:215], a[132:135], v[200:203]
 global_load_dwordx4 a[204:207], v0, s[70:71] offset:3072 sc1
 v_mfma_f32_16x16x32_bf16 v[204:207], a[212:215], a[140:143], v[204:207]
 v_mfma_f32_16x16x32_bf16 v[204:207], a[208:211], a[136:139], v[204:207]
 global_load_dwordx4 a[200:203], v0, s[70:71] offset:2048 sc1
 v_mfma_f32_16x16x32_bf16 v[208:211], a[208:211], a[144:147], v[208:211]
 s_add_u32 s70, s70, 8192
 s_addc_u32 s71, s71, 0
 v_mfma_f32_16x16x32_bf16 v[208:211], a[212:215], a[148:151], v[208:211]
 v_mfma_f32_16x16x32_bf16 v[212:215], a[212:215], a[156:159], v[212:215]
 v_mfma_f32_16x16x32_bf16 v[212:215], a[208:211], a[152:155], v[212:215]
 v_mfma_f32_16x16x32_bf16 v[216:219], a[208:211], a[160:163], v[216:219]
 v_mfma_f32_16x16x32_bf16 v[216:219], a[212:215], a[164:167], v[216:219]
 v_mfma_f32_16x16x32_bf16 v[220:223], a[212:215], a[172:175], v[220:223]
 v_mfma_f32_16x16x32_bf16 v[220:223], a[208:211], a[168:171], v[220:223]
 v_mfma_f32_16x16x32_bf16 v[224:227], a[208:211], a[176:179], v[224:227]
 v_mfma_f32_16x16x32_bf16 v[224:227], a[212:215], a[180:183], v[224:227]
 v_mfma_f32_16x16x32_bf16 v[228:231], a[212:215], a[188:191], v[228:231]
 v_mfma_f32_16x16x32_bf16 v[228:231], a[208:211], a[184:187], v[228:231]
 buffer_load_dwordx4 v6, s[8:11], s30 offen lds
 s_waitcnt vmcnt(12)
 v_mfma_f32_16x16x32_bf16 a[252:255], a[216:219], a[184:187], a[252:255]
 ds_read_b128 a[184:187], v1 offset:63488
 v_mfma_f32_16x16x32_bf16 a[252:255], a[220:223], a[188:191], a[252:255]
 global_load_dwordx4 a[212:215], v0, s[70:71] offset:-3072 sc1
 ds_read_b128 a[188:191], v1 offset:64512
 v_mfma_f32_16x16x32_bf16 a[248:251], a[220:223], a[180:183], a[248:251]
 ds_read_b128 a[180:183], v1 offset:60416
 v_mfma_f32_16x16x32_bf16 a[248:251], a[216:219], a[176:179], a[248:251]
 global_load_dwordx4 a[208:211], v0, s[70:71] offset:-4096 sc1
 ds_read_b128 a[176:179], v1 offset:59392
 v_mfma_f32_16x16x32_bf16 v[252:255], a[216:219], a[168:171], v[252:255]
 ds_read_b128 a[168:171], v1 offset:55296
 v_mfma_f32_16x16x32_bf16 v[252:255], a[220:223], a[172:175], v[252:255]
 ds_read_b128 a[172:175], v1 offset:56320
 s_add_u32 m0, m0, 1024
 v_mfma_f32_16x16x32_bf16 v[248:251], a[220:223], a[164:167], v[248:251]
 ds_read_b128 a[164:167], v1 offset:52224
 v_mfma_f32_16x16x32_bf16 v[248:251], a[216:219], a[160:163], v[248:251]
 ds_read_b128 a[160:163], v1 offset:51200
 v_mfma_f32_16x16x32_bf16 v[244:247], a[216:219], a[152:155], v[244:247]
 ds_read_b128 a[152:155], v1 offset:47104
 s_add_u32 s30, s30, s20
 v_mfma_f32_16x16x32_bf16 v[244:247], a[220:223], a[156:159], v[244:247]
 ds_read_b128 a[156:159], v1 offset:48128
 v_mfma_f32_16x16x32_bf16 v[240:243], a[220:223], a[148:151], v[240:243]
 ds_read_b128 a[148:151], v1 offset:44032
 v_mfma_f32_16x16x32_bf16 v[240:243], a[216:219], a[144:147], v[240:243]
 ds_read_b128 a[144:147], v1 offset:43008
 v_mfma_f32_16x16x32_bf16 v[236:239], a[216:219], a[136:139], v[236:239]
 ds_read_b128 a[136:139], v1 offset:38912
 v_mfma_f32_16x16x32_bf16 v[236:239], a[220:223], a[140:143], v[236:239]
 ds_read_b128 a[140:143], v1 offset:39936
 v_mfma_f32_16x16x32_bf16 v[232:235], a[220:223], a[132:135], v[232:235]
 ds_read_b128 a[132:135], v1 offset:35840
 v_mfma_f32_16x16x32_bf16 v[232:235], a[216:219], a[128:131], v[232:235]
 ds_read_b128 a[128:131], v1 offset:34816
 s_waitcnt vmcnt(12) lgkmcnt(8)
 v_mfma_f32_16x16x32_bf16 v[44:47], a[224:227], a[184:187], v[44:47]
 buffer_load_dwordx4 v6, s[8:11], s30 offen lds
 s_add_u32 m0, m0, 3072
 v_mfma_f32_16x16x32_bf16 v[44:47], a[228:231], a[188:191], v[44:47]
 global_load_dwordx4 a[220:223], v0, s[70:71] offset:-1024 sc1
 v_mfma_f32_16x16x32_bf16 v[40:43], a[228:231], a[180:183], v[40:43]
 s_add_u32 s30, s30, s21
 v_mfma_f32_16x16x32_bf16 v[40:43], a[224:227], a[176:179], v[40:43]
 global_load_dwordx4 a[216:219], v0, s[70:71] offset:-2048 sc1
 v_mfma_f32_16x16x32_bf16 v[36:39], a[224:227], a[168:171], v[36:39]
 v_mfma_f32_16x16x32_bf16 v[36:39], a[228:231], a[172:175], v[36:39]
 v_mfma_f32_16x16x32_bf16 v[32:35], a[228:231], a[164:167], v[32:35]
 v_mfma_f32_16x16x32_bf16 v[32:35], a[224:227], a[160:163], v[32:35]
 s_waitcnt lgkmcnt(0)
 v_mfma_f32_16x16x32_bf16 v[28:31], a[224:227], a[152:155], v[28:31]
 v_mfma_f32_16x16x32_bf16 v[28:31], a[228:231], a[156:159], v[28:31]
 v_mfma_f32_16x16x32_bf16 v[24:27], a[228:231], a[148:151], v[24:27]
 v_mfma_f32_16x16x32_bf16 v[24:27], a[224:227], a[144:147], v[24:27]
 v_mfma_f32_16x16x32_bf16 v[20:23], a[224:227], a[136:139], v[20:23]
 v_mfma_f32_16x16x32_bf16 v[20:23], a[228:231], a[140:143], v[20:23]
 v_mfma_f32_16x16x32_bf16 v[16:19], a[228:231], a[132:135], v[16:19]
 v_mfma_f32_16x16x32_bf16 v[16:19], a[224:227], a[128:131], v[16:19]
 s_waitcnt vmcnt(12)
 v_mfma_f32_16x16x32_bf16 v[48:51], a[232:235], a[128:131], v[48:51]
 v_mfma_f32_16x16x32_bf16 v[48:51], a[236:239], a[132:135], v[48:51]
 global_load_dwordx4 a[228:231], v0, s[70:71] offset:1024 sc1
 v_mfma_f32_16x16x32_bf16 v[52:55], a[236:239], a[140:143], v[52:55]
 v_mfma_f32_16x16x32_bf16 v[52:55], a[232:235], a[136:139], v[52:55]
 global_load_dwordx4 a[224:227], v0, s[70:71] offset:0 sc1
 v_mfma_f32_16x16x32_bf16 v[56:59], a[232:235], a[144:147], v[56:59]
 v_mfma_f32_16x16x32_bf16 v[56:59], a[236:239], a[148:151], v[56:59]
 v_mfma_f32_16x16x32_bf16 v[60:63], a[236:239], a[156:159], v[60:63]
 v_mfma_f32_16x16x32_bf16 v[60:63], a[232:235], a[152:155], v[60:63]
 v_mfma_f32_16x16x32_bf16 v[64:67], a[232:235], a[160:163], v[64:67]
 v_mfma_f32_16x16x32_bf16 v[64:67], a[236:239], a[164:167], v[64:67]
 v_mfma_f32_16x16x32_bf16 v[68:71], a[236:239], a[172:175], v[68:71]
 v_mfma_f32_16x16x32_bf16 v[68:71], a[232:235], a[168:171], v[68:71]
 v_mfma_f32_16x16x32_bf16 v[72:75], a[232:235], a[176:179], v[72:75]
 v_mfma_f32_16x16x32_bf16 v[72:75], a[236:239], a[180:183], v[72:75]
 v_mfma_f32_16x16x32_bf16 v[76:79], a[236:239], a[188:191], v[76:79]
 v_mfma_f32_16x16x32_bf16 v[76:79], a[232:235], a[184:187], v[76:79]
 s_waitcnt vmcnt(10)
 v_mfma_f32_16x16x32_bf16 v[108:111], a[192:195], a[184:187], v[108:111]
 v_mfma_f32_16x16x32_bf16 v[108:111], a[196:199], a[188:191], v[108:111]
 global_load_dwordx4 a[236:239], v0, s[70:71] offset:3072 sc1
 v_mfma_f32_16x16x32_bf16 v[104:107], a[196:199], a[180:183], v[104:107]
 v_mfma_f32_16x16x32_bf16 v[104:107], a[192:195], a[176:179], v[104:107]
 global_load_dwordx4 a[232:235], v0, s[70:71] offset:2048 sc1
 v_mfma_f32_16x16x32_bf16 v[100:103], a[192:195], a[168:171], v[100:103]
 s_add_u32 s70, s70, 8192
 s_addc_u32 s71, s71, 0
 v_mfma_f32_16x16x32_bf16 v[100:103], a[196:199], a[172:175], v[100:103]
 buffer_load_dwordx4 v6, s[8:11], s30 offen lds
 v_mfma_f32_16x16x32_bf16 v[96:99], a[196:199], a[164:167], v[96:99]
 v_mfma_f32_16x16x32_bf16 v[96:99], a[192:195], a[160:163], v[96:99]
 v_mfma_f32_16x16x32_bf16 v[92:95], a[192:195], a[152:155], v[92:95]
 v_mfma_f32_16x16x32_bf16 v[92:95], a[196:199], a[156:159], v[92:95]
 s_add_u32 m0, m0, 1024
 v_mfma_f32_16x16x32_bf16 v[88:91], a[196:199], a[148:151], v[88:91]
 v_mfma_f32_16x16x32_bf16 v[88:91], a[192:195], a[144:147], v[88:91]
 v_mfma_f32_16x16x32_bf16 v[84:87], a[192:195], a[136:139], v[84:87]
 s_add_u32 s30, s30, s20
 v_mfma_f32_16x16x32_bf16 v[84:87], a[196:199], a[140:143], v[84:87]
 v_mfma_f32_16x16x32_bf16 v[80:83], a[196:199], a[132:135], v[80:83]
 v_mfma_f32_16x16x32_bf16 v[80:83], a[192:195], a[128:131], v[80:83]
 buffer_load_dwordx4 v6, s[8:11], s30 offen lds
 s_waitcnt vmcnt(12)
 v_mfma_f32_16x16x32_bf16 v[112:115], a[200:203], a[128:131], v[112:115]
 v_mfma_f32_16x16x32_bf16 v[112:115], a[204:207], a[132:135], v[112:115]
 global_load_dwordx4 a[196:199], v0, s[70:71] offset:-3072 sc1
 v_mfma_f32_16x16x32_bf16 v[116:119], a[204:207], a[140:143], v[116:119]
 s_add_u32 m0, m0, 3072
 v_mfma_f32_16x16x32_bf16 v[116:119], a[200:203], a[136:139], v[116:119]
 global_load_dwordx4 a[192:195], v0, s[70:71] offset:-4096 sc1
 v_mfma_f32_16x16x32_bf16 v[120:123], a[200:203], a[144:147], v[120:123]
 v_mfma_f32_16x16x32_bf16 v[120:123], a[204:207], a[148:151], v[120:123]
 v_mfma_f32_16x16x32_bf16 v[124:127], a[204:207], a[156:159], v[124:127]
 s_add_u32 s30, s30, s21
 v_mfma_f32_16x16x32_bf16 v[124:127], a[200:203], a[152:155], v[124:127]
 v_mfma_f32_16x16x32_bf16 v[128:131], a[200:203], a[160:163], v[128:131]
 v_mfma_f32_16x16x32_bf16 v[128:131], a[204:207], a[164:167], v[128:131]
 v_mfma_f32_16x16x32_bf16 v[132:135], a[204:207], a[172:175], v[132:135]
 v_mfma_f32_16x16x32_bf16 v[132:135], a[200:203], a[168:171], v[132:135]
 v_mfma_f32_16x16x32_bf16 a[240:243], a[200:203], a[176:179], a[240:243]
 v_mfma_f32_16x16x32_bf16 a[240:243], a[204:207], a[180:183], a[240:243]
 v_mfma_f32_16x16x32_bf16 a[244:247], a[204:207], a[188:191], a[244:247]
 v_mfma_f32_16x16x32_bf16 a[244:247], a[200:203], a[184:187], a[244:247]
 s_waitcnt vmcnt(11)
 v_mfma_f32_16x16x32_bf16 v[164:167], a[208:211], a[184:187], v[164:167]
 v_mfma_f32_16x16x32_bf16 v[164:167], a[212:215], a[188:191], v[164:167]
 global_load_dwordx4 a[204:207], v0, s[70:71] offset:-1024 sc1
 v_mfma_f32_16x16x32_bf16 v[160:163], a[212:215], a[180:183], v[160:163]
 v_mfma_f32_16x16x32_bf16 v[160:163], a[208:211], a[176:179], v[160:163]
 global_load_dwordx4 a[200:203], v0, s[70:71] offset:-2048 sc1
 v_mfma_f32_16x16x32_bf16 v[156:159], a[208:211], a[168:171], v[156:159]
 v_mfma_f32_16x16x32_bf16 v[156:159], a[212:215], a[172:175], v[156:159]
 v_mfma_f32_16x16x32_bf16 v[152:155], a[212:215], a[164:167], v[152:155]
 v_mfma_f32_16x16x32_bf16 v[152:155], a[208:211], a[160:163], v[152:155]
 v_mfma_f32_16x16x32_bf16 v[148:151], a[208:211], a[152:155], v[148:151]
 v_mfma_f32_16x16x32_bf16 v[148:151], a[212:215], a[156:159], v[148:151]
 v_mfma_f32_16x16x32_bf16 v[144:147], a[212:215], a[148:151], v[144:147]
 v_mfma_f32_16x16x32_bf16 v[144:147], a[208:211], a[144:147], v[144:147]
 v_mfma_f32_16x16x32_bf16 v[140:143], a[208:211], a[136:139], v[140:143]
 v_mfma_f32_16x16x32_bf16 v[140:143], a[212:215], a[140:143], v[140:143]
 v_mfma_f32_16x16x32_bf16 v[136:139], a[212:215], a[132:135], v[136:139]
 v_mfma_f32_16x16x32_bf16 v[136:139], a[208:211], a[128:131], v[136:139]
 s_waitcnt vmcnt(10)
 v_mfma_f32_16x16x32_bf16 v[168:171], a[216:219], a[128:131], v[168:171]
 v_mfma_f32_16x16x32_bf16 v[168:171], a[220:223], a[132:135], v[168:171]
 global_load_dwordx4 a[212:215], v0, s[70:71] offset:1024 sc1
 v_mfma_f32_16x16x32_bf16 v[172:175], a[220:223], a[140:143], v[172:175]
 v_mfma_f32_16x16x32_bf16 v[172:175], a[216:219], a[136:139], v[172:175]
 global_load_dwordx4 a[208:211], v0, s[70:71] offset:0 sc1
 v_mfma_f32_16x16x32_bf16 v[176:179], a[216:219], a[144:147], v[176:179]
 v_mfma_f32_16x16x32_bf16 v[176:179], a[220:223], a[148:151], v[176:179]
 v_mfma_f32_16x16x32_bf16 v[180:183], a[220:223], a[156:159], v[180:183]
 v_mfma_f32_16x16x32_bf16 v[180:183], a[216:219], a[152:155], v[180:183]
 v_mfma_f32_16x16x32_bf16 v[184:187], a[216:219], a[160:163], v[184:187]
 v_mfma_f32_16x16x32_bf16 v[184:187], a[220:223], a[164:167], v[184:187]
 buffer_load_dwordx4 v6, s[8:11], s30 offen lds
 v_mfma_f32_16x16x32_bf16 v[188:191], a[220:223], a[172:175], v[188:191]
 v_mfma_f32_16x16x32_bf16 v[188:191], a[216:219], a[168:171], v[188:191]
 v_mfma_f32_16x16x32_bf16 v[192:195], a[216:219], a[176:179], v[192:195]
 s_add_u32 m0, m0, 1024
 v_mfma_f32_16x16x32_bf16 v[192:195], a[220:223], a[180:183], v[192:195]
 v_mfma_f32_16x16x32_bf16 v[196:199], a[220:223], a[188:191], v[196:199]
 v_mfma_f32_16x16x32_bf16 v[196:199], a[216:219], a[184:187], v[196:199]
 s_waitcnt vmcnt(11)
 v_mfma_f32_16x16x32_bf16 v[228:231], a[224:227], a[184:187], v[228:231]
 s_add_u32 s30, s30, s20
 v_mfma_f32_16x16x32_bf16 v[228:231], a[228:231], a[188:191], v[228:231]
 global_load_dwordx4 a[220:223], v0, s[70:71] offset:3072 sc1
 v_mfma_f32_16x16x32_bf16 v[224:227], a[228:231], a[180:183], v[224:227]
 buffer_load_dwordx4 v6, s[8:11], s30 offen lds
 v_mfma_f32_16x16x32_bf16 v[224:227], a[224:227], a[176:179], v[224:227]
 global_load_dwordx4 a[216:219], v0, s[70:71] offset:2048 sc1
 v_mfma_f32_16x16x32_bf16 v[220:223], a[224:227], a[168:171], v[220:223]
 s_add_u32 s70, s70, 8192
 s_addc_u32 s71, s71, 0
 v_mfma_f32_16x16x32_bf16 v[220:223], a[228:231], a[172:175], v[220:223]
 v_mfma_f32_16x16x32_bf16 v[216:219], a[228:231], a[164:167], v[216:219]
 s_add_u32 m0, m0, 3072
 v_mfma_f32_16x16x32_bf16 v[216:219], a[224:227], a[160:163], v[216:219]
 v_mfma_f32_16x16x32_bf16 v[212:215], a[224:227], a[152:155], v[212:215]
 v_mfma_f32_16x16x32_bf16 v[212:215], a[228:231], a[156:159], v[212:215]
 s_add_u32 s30, s30, s21
 v_mfma_f32_16x16x32_bf16 v[208:211], a[228:231], a[148:151], v[208:211]
 v_mfma_f32_16x16x32_bf16 v[208:211], a[224:227], a[144:147], v[208:211]
 v_mfma_f32_16x16x32_bf16 v[204:207], a[224:227], a[136:139], v[204:207]
 v_mfma_f32_16x16x32_bf16 v[204:207], a[228:231], a[140:143], v[204:207]
 v_mfma_f32_16x16x32_bf16 v[200:203], a[228:231], a[132:135], v[200:203]
 v_mfma_f32_16x16x32_bf16 v[200:203], a[224:227], a[128:131], v[200:203]
 s_waitcnt vmcnt(12)
 v_mfma_f32_16x16x32_bf16 v[232:235], a[232:235], a[128:131], v[232:235]
 ds_read_b128 a[128:131], v2 offset:2048
 v_mfma_f32_16x16x32_bf16 v[232:235], a[236:239], a[132:135], v[232:235]
 global_load_dwordx4 a[228:231], v0, s[70:71] offset:-3072 sc1
 ds_read_b128 a[132:135], v2 offset:3072
 v_mfma_f32_16x16x32_bf16 v[236:239], a[236:239], a[140:143], v[236:239]
 ds_read_b128 a[140:143], v2 offset:7168
 v_mfma_f32_16x16x32_bf16 v[236:239], a[232:235], a[136:139], v[236:239]
 global_load_dwordx4 a[224:227], v0, s[70:71] offset:-4096 sc1
 ds_read_b128 a[136:139], v2 offset:6144
 v_mfma_f32_16x16x32_bf16 v[240:243], a[232:235], a[144:147], v[240:243]
 ds_read_b128 a[144:147], v2 offset:10240
 v_mfma_f32_16x16x32_bf16 v[240:243], a[236:239], a[148:151], v[240:243]
 ds_read_b128 a[148:151], v2 offset:11264
 v_mfma_f32_16x16x32_bf16 v[244:247], a[236:239], a[156:159], v[244:247]
 ds_read_b128 a[156:159], v2 offset:15360
 v_mfma_f32_16x16x32_bf16 v[244:247], a[232:235], a[152:155], v[244:247]
 ds_read_b128 a[152:155], v2 offset:14336
 v_mfma_f32_16x16x32_bf16 v[248:251], a[232:235], a[160:163], v[248:251]
 ds_read_b128 a[160:163], v2 offset:18432
 v_mfma_f32_16x16x32_bf16 v[248:251], a[236:239], a[164:167], v[248:251]
 ds_read_b128 a[164:167], v2 offset:19456
 v_mfma_f32_16x16x32_bf16 v[252:255], a[236:239], a[172:175], v[252:255]
 ds_read_b128 a[172:175], v2 offset:23552
 v_mfma_f32_16x16x32_bf16 v[252:255], a[232:235], a[168:171], v[252:255]
 ds_read_b128 a[168:171], v2 offset:22528
 v_mfma_f32_16x16x32_bf16 a[248:251], a[232:235], a[176:179], a[248:251]
 ds_read_b128 a[176:179], v2 offset:26624
 v_mfma_f32_16x16x32_bf16 a[248:251], a[236:239], a[180:183], a[248:251]
 ds_read_b128 a[180:183], v2 offset:27648
 v_mfma_f32_16x16x32_bf16 a[252:255], a[236:239], a[188:191], a[252:255]
 ds_read_b128 a[188:191], v2 offset:31744
 v_mfma_f32_16x16x32_bf16 a[252:255], a[232:235], a[184:187], a[252:255]
 ds_read_b128 a[184:187], v2 offset:30720
 s_waitcnt vmcnt(10) lgkmcnt(8)
 v_mfma_f32_16x16x32_bf16 v[16:19], a[192:195], a[128:131], v[16:19]
 v_mfma_f32_16x16x32_bf16 v[16:19], a[196:199], a[132:135], v[16:19]
 global_load_dwordx4 a[236:239], v0, s[70:71] offset:-1024 sc1
 v_mfma_f32_16x16x32_bf16 v[20:23], a[196:199], a[140:143], v[20:23]
 v_mfma_f32_16x16x32_bf16 v[20:23], a[192:195], a[136:139], v[20:23]
 global_load_dwordx4 a[232:235], v0, s[70:71] offset:-2048 sc1
 v_mfma_f32_16x16x32_bf16 v[24:27], a[192:195], a[144:147], v[24:27]
 v_mfma_f32_16x16x32_bf16 v[24:27], a[196:199], a[148:151], v[24:27]
 v_mfma_f32_16x16x32_bf16 v[28:31], a[196:199], a[156:159], v[28:31]
 v_mfma_f32_16x16x32_bf16 v[28:31], a[192:195], a[152:155], v[28:31]
 s_waitcnt lgkmcnt(0)
 v_mfma_f32_16x16x32_bf16 v[32:35], a[192:195], a[160:163], v[32:35]
 v_mfma_f32_16x16x32_bf16 v[32:35], a[196:199], a[164:167], v[32:35]
 v_mfma_f32_16x16x32_bf16 v[36:39], a[196:199], a[172:175], v[36:39]
 v_mfma_f32_16x16x32_bf16 v[36:39], a[192:195], a[168:171], v[36:39]
 v_mfma_f32_16x16x32_bf16 v[40:43], a[192:195], a[176:179], v[40:43]
 v_mfma_f32_16x16x32_bf16 v[40:43], a[196:199], a[180:183], v[40:43]
 buffer_load_dwordx4 v6, s[8:11], s30 offen lds
 v_mfma_f32_16x16x32_bf16 v[44:47], a[196:199], a[188:191], v[44:47]
 v_mfma_f32_16x16x32_bf16 v[44:47], a[192:195], a[184:187], v[44:47]
 s_waitcnt vmcnt(11)
 v_mfma_f32_16x16x32_bf16 v[76:79], a[200:203], a[184:187], v[76:79]
 s_add_u32 m0, m0, 1024
 v_mfma_f32_16x16x32_bf16 v[76:79], a[204:207], a[188:191], v[76:79]
 global_load_dwordx4 a[196:199], v0, s[70:71] offset:1024 sc1
 v_mfma_f32_16x16x32_bf16 v[72:75], a[204:207], a[180:183], v[72:75]
 v_mfma_f32_16x16x32_bf16 v[72:75], a[200:203], a[176:179], v[72:75]
 global_load_dwordx4 a[192:195], v0, s[70:71] offset:0 sc1
 s_add_u32 s30, s30, s20
 v_mfma_f32_16x16x32_bf16 v[68:71], a[200:203], a[168:171], v[68:71]
 v_mfma_f32_16x16x32_bf16 v[68:71], a[204:207], a[172:175], v[68:71]
 v_mfma_f32_16x16x32_bf16 v[64:67], a[204:207], a[164:167], v[64:67]
 buffer_load_dwordx4 v6, s[8:11], s30 offen lds
 v_mfma_f32_16x16x32_bf16 v[64:67], a[200:203], a[160:163], v[64:67]
 v_mfma_f32_16x16x32_bf16 v[60:63], a[200:203], a[152:155], v[60:63]
 v_mfma_f32_16x16x32_bf16 v[60:63], a[204:207], a[156:159], v[60:63]
 v_mfma_f32_16x16x32_bf16 v[56:59], a[204:207], a[148:151], v[56:59]
 s_add_u32 m0, m0, 3072
 v_mfma_f32_16x16x32_bf16 v[56:59], a[200:203], a[144:147], v[56:59]
 v_mfma_f32_16x16x32_bf16 v[52:55], a[200:203], a[136:139], v[52:55]
 v_mfma_f32_16x16x32_bf16 v[52:55], a[204:207], a[140:143], v[52:55]
 s_add_u32 s30, s30, s21
 v_mfma_f32_16x16x32_bf16 v[48:51], a[204:207], a[132:135], v[48:51]
 v_mfma_f32_16x16x32_bf16 v[48:51], a[200:203], a[128:131], v[48:51]
 s_waitcnt vmcnt(12)
 v_mfma_f32_16x16x32_bf16 v[80:83], a[208:211], a[128:131], v[80:83]
 v_mfma_f32_16x16x32_bf16 v[80:83], a[212:215], a[132:135], v[80:83]
 global_load_dwordx4 a[204:207], v0, s[70:71] offset:3072 sc1
 v_mfma_f32_16x16x32_bf16 v[84:87], a[212:215], a[140:143], v[84:87]
 v_mfma_f32_16x16x32_bf16 v[84:87], a[208:211], a[136:139], v[84:87]
 global_load_dwordx4 a[200:203], v0, s[70:71] offset:2048 sc1
 v_mfma_f32_16x16x32_bf16 v[88:91], a[208:211], a[144:147], v[88:91]
 s_add_u32 s70, s70, 8192
 s_addc_u32 s71, s71, 0
 v_mfma_f32_16x16x32_bf16 v[88:91], a[212:215], a[148:151], v[88:91]
 v_mfma_f32_16x16x32_bf16 v[92:95], a[212:215], a[156:159], v[92:95]
 v_mfma_f32_16x16x32_bf16 v[92:95], a[208:211], a[152:155], v[92:95]
 v_mfma_f32_16x16x32_bf16 v[96:99], a[208:211], a[160:163], v[96:99]
 v_mfma_f32_16x16x32_bf16 v[96:99], a[212:215], a[164:167], v[96:99]
 v_mfma_f32_16x16x32_bf16 v[100:103], a[212:215], a[172:175], v[100:103]
 v_mfma_f32_16x16x32_bf16 v[100:103], a[208:211], a[168:171], v[100:103]
 v_mfma_f32_16x16x32_bf16 v[104:107], a[208:211], a[176:179], v[104:107]
 v_mfma_f32_16x16x32_bf16 v[104:107], a[212:215], a[180:183], v[104:107]
 v_mfma_f32_16x16x32_bf16 v[108:111], a[212:215], a[188:191], v[108:111]
 v_mfma_f32_16x16x32_bf16 v[108:111], a[208:211], a[184:187], v[108:111]
 s_waitcnt vmcnt(10)
 v_mfma_f32_16x16x32_bf16 a[244:247], a[216:219], a[184:187], a[244:247]
 v_mfma_f32_16x16x32_bf16 a[244:247], a[220:223], a[188:191], a[244:247]
 global_load_dwordx4 a[212:215], v0, s[70:71] offset:-3072 sc1
 v_mfma_f32_16x16x32_bf16 a[240:243], a[220:223], a[180:183], a[240:243]
 v_mfma_f32_16x16x32_bf16 a[240:243], a[216:219], a[176:179], a[240:243]
 global_load_dwordx4 a[208:211], v0, s[70:71] offset:-4096 sc1
 v_mfma_f32_16x16x32_bf16 v[132:135], a[216:219], a[168:171], v[132:135]
 v_mfma_f32_16x16x32_bf16 v[132:135], a[220:223], a[172:175], v[132:135]
 v_mfma_f32_16x16x32_bf16 v[128:131], a[220:223], a[164:167], v[128:131]
 v_mfma_f32_16x16x32_bf16 v[128:131], a[216:219], a[160:163], v[128:131]
 v_mfma_f32_16x16x32_bf16 v[124:127], a[216:219], a[152:155], v[124:127]
 v_mfma_f32_16x16x32_bf16 v[124:127], a[220:223], a[156:159], v[124:127]
 v_mfma_f32_16x16x32_bf16 v[120:123], a[220:223], a[148:151], v[120:123]
 v_mfma_f32_16x16x32_bf16 v[120:123], a[216:219], a[144:147], v[120:123]
 v_mfma_f32_16x16x32_bf16 v[116:119], a[216:219], a[136:139], v[116:119]
 v_mfma_f32_16x16x32_bf16 v[116:119], a[220:223], a[140:143], v[116:119]
 v_mfma_f32_16x16x32_bf16 v[112:115], a[220:223], a[132:135], v[112:115]
 v_mfma_f32_16x16x32_bf16 v[112:115], a[216:219], a[128:131], v[112:115]
 s_waitcnt vmcnt(10)
 v_mfma_f32_16x16x32_bf16 v[136:139], a[224:227], a[128:131], v[136:139]
 buffer_load_dwordx4 v6, s[8:11], s30 offen lds
 v_mfma_f32_16x16x32_bf16 v[136:139], a[228:231], a[132:135], v[136:139]
 global_load_dwordx4 a[220:223], v0, s[70:71] offset:-1024 sc1
 v_mfma_f32_16x16x32_bf16 v[140:143], a[228:231], a[140:143], v[140:143]
 v_mfma_f32_16x16x32_bf16 v[140:143], a[224:227], a[136:139], v[140:143]
 global_load_dwordx4 a[216:219], v0, s[70:71] offset:-2048 sc1
 s_add_u32 m0, m0, 1024
 v_mfma_f32_16x16x32_bf16 v[144:147], a[224:227], a[144:147], v[144:147]
 v_mfma_f32_16x16x32_bf16 v[144:147], a[228:231], a[148:151], v[144:147]
 v_mfma_f32_16x16x32_bf16 v[148:151], a[228:231], a[156:159], v[148:151]
 v_mfma_f32_16x16x32_bf16 v[148:151], a[224:227], a[152:155], v[148:151]
 s_add_u32 s30, s30, s20
 v_mfma_f32_16x16x32_bf16 v[152:155], a[224:227], a[160:163], v[152:155]
 v_mfma_f32_16x16x32_bf16 v[152:155], a[228:231], a[164:167], v[152:155]
 v_mfma_f32_16x16x32_bf16 v[156:159], a[228:231], a[172:175], v[156:159]
 buffer_load_dwordx4 v6, s[8:11], s30 offen lds
 v_mfma_f32_16x16x32_bf16 v[156:159], a[224:227], a[168:171], v[156:159]
 v_mfma_f32_16x16x32_bf16 v[160:163], a[224:227], a[176:179], v[160:163]
 v_mfma_f32_16x16x32_bf16 v[160:163], a[228:231], a[180:183], v[160:163]
 s_add_u32 m0, m0, 3072
 v_mfma_f32_16x16x32_bf16 v[164:167], a[228:231], a[188:191], v[164:167]
 v_mfma_f32_16x16x32_bf16 v[164:167], a[224:227], a[184:187], v[164:167]
 s_waitcnt vmcnt(12)
 v_mfma_f32_16x16x32_bf16 v[196:199], a[232:235], a[184:187], v[196:199]
 s_add_u32 s30, s30, s21
 v_mfma_f32_16x16x32_bf16 v[196:199], a[236:239], a[188:191], v[196:199]
 global_load_dwordx4 a[228:231], v0, s[70:71] offset:1024 sc1
 v_mfma_f32_16x16x32_bf16 v[192:195], a[236:239], a[180:183], v[192:195]
 v_mfma_f32_16x16x32_bf16 v[192:195], a[232:235], a[176:179], v[192:195]
 global_load_dwordx4 a[224:227], v0, s[70:71] offset:0 sc1
 v_mfma_f32_16x16x32_bf16 v[188:191], a[232:235], a[168:171], v[188:191]
 v_mfma_f32_16x16x32_bf16 v[188:191], a[236:239], a[172:175], v[188:191]
 v_mfma_f32_16x16x32_bf16 v[184:187], a[236:239], a[164:167], v[184:187]
 v_mfma_f32_16x16x32_bf16 v[184:187], a[232:235], a[160:163], v[184:187]
 v_mfma_f32_16x16x32_bf16 v[180:183], a[232:235], a[152:155], v[180:183]
 v_mfma_f32_16x16x32_bf16 v[180:183], a[236:239], a[156:159], v[180:183]
 v_mfma_f32_16x16x32_bf16 v[176:179], a[236:239], a[148:151], v[176:179]
 v_mfma_f32_16x16x32_bf16 v[176:179], a[232:235], a[144:147], v[176:179]
 v_mfma_f32_16x16x32_bf16 v[172:175], a[232:235], a[136:139], v[172:175]
 v_mfma_f32_16x16x32_bf16 v[172:175], a[236:239], a[140:143], v[172:175]
 v_mfma_f32_16x16x32_bf16 v[168:171], a[236:239], a[132:135], v[168:171]
 v_mfma_f32_16x16x32_bf16 v[168:171], a[232:235], a[128:131], v[168:171]
 s_waitcnt vmcnt(11)
 v_mfma_f32_16x16x32_bf16 v[200:203], a[192:195], a[128:131], v[200:203]
 v_mfma_f32_16x16x32_bf16 v[200:203], a[196:199], a[132:135], v[200:203]
 global_load_dwordx4 a[236:239], v0, s[70:71] offset:3072 sc1
 v_mfma_f32_16x16x32_bf16 v[204:207], a[196:199], a[140:143], v[204:207]
 v_mfma_f32_16x16x32_bf16 v[204:207], a[192:195], a[136:139], v[204:207]
 global_load_dwordx4 a[232:235], v0, s[70:71] offset:2048 sc1
 v_mfma_f32_16x16x32_bf16 v[208:211], a[192:195], a[144:147], v[208:211]
 s_add_u32 s70, s70, 8192
 s_addc_u32 s71, s71, 0
 v_mfma_f32_16x16x32_bf16 v[208:211], a[196:199], a[148:151], v[208:211]
 v_mfma_f32_16x16x32_bf16 v[212:215], a[196:199], a[156:159], v[212:215]
 v_mfma_f32_16x16x32_bf16 v[212:215], a[192:195], a[152:155], v[212:215]
 v_mfma_f32_16x16x32_bf16 v[216:219], a[192:195], a[160:163], v[216:219]
 v_mfma_f32_16x16x32_bf16 v[216:219], a[196:199], a[164:167], v[216:219]
 v_mfma_f32_16x16x32_bf16 v[220:223], a[196:199], a[172:175], v[220:223]
 v_mfma_f32_16x16x32_bf16 v[220:223], a[192:195], a[168:171], v[220:223]
 v_mfma_f32_16x16x32_bf16 v[224:227], a[192:195], a[176:179], v[224:227]
 v_mfma_f32_16x16x32_bf16 v[224:227], a[196:199], a[180:183], v[224:227]
 v_mfma_f32_16x16x32_bf16 v[228:231], a[196:199], a[188:191], v[228:231]
 v_mfma_f32_16x16x32_bf16 v[228:231], a[192:195], a[184:187], v[228:231]
 buffer_load_dwordx4 v6, s[8:11], s30 offen lds
 s_waitcnt vmcnt(11)
 v_mfma_f32_16x16x32_bf16 a[252:255], a[200:203], a[184:187], a[252:255]
 ds_read_b128 a[184:187], v2 offset:63488
 v_mfma_f32_16x16x32_bf16 a[252:255], a[204:207], a[188:191], a[252:255]
 global_load_dwordx4 a[196:199], v0, s[70:71] offset:-3072 sc1
 ds_read_b128 a[188:191], v2 offset:64512
 v_mfma_f32_16x16x32_bf16 a[248:251], a[204:207], a[180:183], a[248:251]
 ds_read_b128 a[180:183], v2 offset:60416
 v_mfma_f32_16x16x32_bf16 a[248:251], a[200:203], a[176:179], a[248:251]
 global_load_dwordx4 a[192:195], v0, s[70:71] offset:-4096 sc1
 ds_read_b128 a[176:179], v2 offset:59392
 v_mfma_f32_16x16x32_bf16 v[252:255], a[200:203], a[168:171], v[252:255]
 ds_read_b128 a[168:171], v2 offset:55296
 v_mfma_f32_16x16x32_bf16 v[252:255], a[204:207], a[172:175], v[252:255]
 ds_read_b128 a[172:175], v2 offset:56320
 v_mfma_f32_16x16x32_bf16 v[248:251], a[204:207], a[164:167], v[248:251]
 ds_read_b128 a[164:167], v2 offset:52224
 v_mfma_f32_16x16x32_bf16 v[248:251], a[200:203], a[160:163], v[248:251]
 ds_read_b128 a[160:163], v2 offset:51200
 s_add_u32 m0, m0, 1024
 v_mfma_f32_16x16x32_bf16 v[244:247], a[200:203], a[152:155], v[244:247]
 ds_read_b128 a[152:155], v2 offset:47104
 v_mfma_f32_16x16x32_bf16 v[244:247], a[204:207], a[156:159], v[244:247]
 ds_read_b128 a[156:159], v2 offset:48128
 v_mfma_f32_16x16x32_bf16 v[240:243], a[204:207], a[148:151], v[240:243]
 ds_read_b128 a[148:151], v2 offset:44032
 s_add_u32 s30, s30, s20
 v_mfma_f32_16x16x32_bf16 v[240:243], a[200:203], a[144:147], v[240:243]
 ds_read_b128 a[144:147], v2 offset:43008
 v_mfma_f32_16x16x32_bf16 v[236:239], a[200:203], a[136:139], v[236:239]
 ds_read_b128 a[136:139], v2 offset:38912
 v_mfma_f32_16x16x32_bf16 v[236:239], a[204:207], a[140:143], v[236:239]
 ds_read_b128 a[140:143], v2 offset:39936
 v_mfma_f32_16x16x32_bf16 v[232:235], a[204:207], a[132:135], v[232:235]
 ds_read_b128 a[132:135], v2 offset:35840
 v_mfma_f32_16x16x32_bf16 v[232:235], a[200:203], a[128:131], v[232:235]
 ds_read_b128 a[128:131], v2 offset:34816
 s_waitcnt vmcnt(11) lgkmcnt(8)
 v_mfma_f32_16x16x32_bf16 v[44:47], a[208:211], a[184:187], v[44:47]
 buffer_load_dwordx4 v6, s[8:11], s30 offen lds
 v_mfma_f32_16x16x32_bf16 v[44:47], a[212:215], a[188:191], v[44:47]
 global_load_dwordx4 a[204:207], v0, s[70:71] offset:-1024 sc1
 s_add_u32 m0, m0, 3072
 v_mfma_f32_16x16x32_bf16 v[40:43], a[212:215], a[180:183], v[40:43]
 buffer_load_dword v4, off, s[64:67], 0 sc1
 v_mfma_f32_16x16x32_bf16 v[40:43], a[208:211], a[176:179], v[40:43]
 global_load_dwordx4 a[200:203], v0, s[70:71] offset:-2048 sc1
 v_mfma_f32_16x16x32_bf16 v[36:39], a[208:211], a[168:171], v[36:39]
 s_add_u32 s30, s30, s22
 v_mfma_f32_16x16x32_bf16 v[36:39], a[212:215], a[172:175], v[36:39]
 v_mfma_f32_16x16x32_bf16 v[32:35], a[212:215], a[164:167], v[32:35]
 v_mfma_f32_16x16x32_bf16 v[32:35], a[208:211], a[160:163], v[32:35]
 s_waitcnt lgkmcnt(0)
 v_mfma_f32_16x16x32_bf16 v[28:31], a[208:211], a[152:155], v[28:31]
 v_mfma_f32_16x16x32_bf16 v[28:31], a[212:215], a[156:159], v[28:31]
 v_mfma_f32_16x16x32_bf16 v[24:27], a[212:215], a[148:151], v[24:27]
 v_mfma_f32_16x16x32_bf16 v[24:27], a[208:211], a[144:147], v[24:27]
 v_mfma_f32_16x16x32_bf16 v[20:23], a[208:211], a[136:139], v[20:23]
 v_mfma_f32_16x16x32_bf16 v[20:23], a[212:215], a[140:143], v[20:23]
 v_mfma_f32_16x16x32_bf16 v[16:19], a[212:215], a[132:135], v[16:19]
 v_mfma_f32_16x16x32_bf16 v[16:19], a[208:211], a[128:131], v[16:19]
 s_waitcnt vmcnt(12)
 v_mfma_f32_16x16x32_bf16 v[48:51], a[216:219], a[128:131], v[48:51]
 v_lshrrev_b32 v5, 6, v1
 v_mfma_f32_16x16x32_bf16 v[48:51], a[220:223], a[132:135], v[48:51]
 global_load_dwordx4 a[212:215], v0, s[70:71] offset:1024 sc1
 v_mfma_f32_16x16x32_bf16 v[52:55], a[220:223], a[140:143], v[52:55]
 v_and_b32 v6, 48, v1
 v_mfma_f32_16x16x32_bf16 v[52:55], a[216:219], a[136:139], v[52:55]
 global_load_dwordx4 a[208:211], v0, s[70:71] offset:0 sc1
 v_lshl_add_u32 v5, v5, 11, v6
 v_mfma_f32_16x16x32_bf16 v[56:59], a[216:219], a[144:147], v[56:59]
 v_mfma_f32_16x16x32_bf16 v[56:59], a[220:223], a[148:151], v[56:59]
 s_mov_b32 m0, s52
 v_mfma_f32_16x16x32_bf16 v[60:63], a[220:223], a[156:159], v[60:63]
 s_add_u32 s3, s48, 31744
 v_mfma_f32_16x16x32_bf16 v[60:63], a[216:219], a[152:155], v[60:63]
 v_mfma_f32_16x16x32_bf16 v[64:67], a[216:219], a[160:163], v[64:67]
 buffer_load_dwordx4 v5, s[40:43], s48 offen lds
 v_mfma_f32_16x16x32_bf16 v[64:67], a[220:223], a[164:167], v[64:67]
 buffer_load_dwordx4 v5, s[40:43], s3 offen offset:1024 lds
 v_mfma_f32_16x16x32_bf16 v[68:71], a[220:223], a[172:175], v[68:71]
 v_mfma_f32_16x16x32_bf16 v[68:71], a[216:219], a[168:171], v[68:71]
 s_add_u32 s48, s48, 2097152
 v_mfma_f32_16x16x32_bf16 v[72:75], a[216:219], a[176:179], v[72:75]
 v_mfma_f32_16x16x32_bf16 v[72:75], a[220:223], a[180:183], v[72:75]
 v_mfma_f32_16x16x32_bf16 v[76:79], a[220:223], a[188:191], v[76:79]
 v_mfma_f32_16x16x32_bf16 v[76:79], a[216:219], a[184:187], v[76:79]
 s_waitcnt vmcnt(13)
 v_mfma_f32_16x16x32_bf16 v[108:111], a[224:227], a[184:187], v[108:111]
 v_mfma_f32_16x16x32_bf16 v[108:111], a[228:231], a[188:191], v[108:111]
 global_load_dwordx4 a[220:223], v0, s[70:71] offset:3072 sc1
 v_mfma_f32_16x16x32_bf16 v[104:107], a[228:231], a[180:183], v[104:107]
 v_mfma_f32_16x16x32_bf16 v[104:107], a[224:227], a[176:179], v[104:107]
 global_load_dwordx4 a[216:219], v0, s[70:71] offset:2048 sc1
 v_mfma_f32_16x16x32_bf16 v[100:103], a[224:227], a[168:171], v[100:103]
 s_add_u32 s70, s70, 8192
 s_addc_u32 s71, s71, 0
 v_mfma_f32_16x16x32_bf16 v[100:103], a[228:231], a[172:175], v[100:103]
 v_mfma_f32_16x16x32_bf16 v[96:99], a[228:231], a[164:167], v[96:99]
 v_mfma_f32_16x16x32_bf16 v[96:99], a[224:227], a[160:163], v[96:99]
 v_mfma_f32_16x16x32_bf16 v[92:95], a[224:227], a[152:155], v[92:95]
 v_mfma_f32_16x16x32_bf16 v[92:95], a[228:231], a[156:159], v[92:95]
 v_mfma_f32_16x16x32_bf16 v[88:91], a[228:231], a[148:151], v[88:91]
 v_mfma_f32_16x16x32_bf16 v[88:91], a[224:227], a[144:147], v[88:91]
 v_mfma_f32_16x16x32_bf16 v[84:87], a[224:227], a[136:139], v[84:87]
 v_mfma_f32_16x16x32_bf16 v[84:87], a[228:231], a[140:143], v[84:87]
 v_mfma_f32_16x16x32_bf16 v[80:83], a[228:231], a[132:135], v[80:83]
 v_mfma_f32_16x16x32_bf16 v[80:83], a[224:227], a[128:131], v[80:83]
 s_waitcnt vmcnt(13)
 v_mfma_f32_16x16x32_bf16 v[112:115], a[232:235], a[128:131], v[112:115]
 v_mfma_f32_16x16x32_bf16 v[112:115], a[236:239], a[132:135], v[112:115]
 global_load_dwordx4 a[228:231], v0, s[70:71] offset:-3072 sc1
 v_mfma_f32_16x16x32_bf16 v[116:119], a[236:239], a[140:143], v[116:119]
 v_mfma_f32_16x16x32_bf16 v[116:119], a[232:235], a[136:139], v[116:119]
 global_load_dwordx4 a[224:227], v0, s[70:71] offset:-4096 sc1
 v_mfma_f32_16x16x32_bf16 v[120:123], a[232:235], a[144:147], v[120:123]
 v_mfma_f32_16x16x32_bf16 v[120:123], a[236:239], a[148:151], v[120:123]
 v_mfma_f32_16x16x32_bf16 v[124:127], a[236:239], a[156:159], v[124:127]
 v_mfma_f32_16x16x32_bf16 v[124:127], a[232:235], a[152:155], v[124:127]
 v_mfma_f32_16x16x32_bf16 v[128:131], a[232:235], a[160:163], v[128:131]
 v_mfma_f32_16x16x32_bf16 v[128:131], a[236:239], a[164:167], v[128:131]
 v_mfma_f32_16x16x32_bf16 v[132:135], a[236:239], a[172:175], v[132:135]
 v_mfma_f32_16x16x32_bf16 v[132:135], a[232:235], a[168:171], v[132:135]
 v_mfma_f32_16x16x32_bf16 a[240:243], a[232:235], a[176:179], a[240:243]
 v_mfma_f32_16x16x32_bf16 a[240:243], a[236:239], a[180:183], a[240:243]
 v_mfma_f32_16x16x32_bf16 a[244:247], a[236:239], a[188:191], a[244:247]
 v_mfma_f32_16x16x32_bf16 a[244:247], a[232:235], a[184:187], a[244:247]
 s_waitcnt vmcnt(12)
 v_mfma_f32_16x16x32_bf16 v[164:167], a[192:195], a[184:187], v[164:167]
 v_mfma_f32_16x16x32_bf16 v[164:167], a[196:199], a[188:191], v[164:167]
 global_load_dwordx4 a[236:239], v0, s[70:71] offset:-1024 sc1
 v_mfma_f32_16x16x32_bf16 v[160:163], a[196:199], a[180:183], v[160:163]
 v_mfma_f32_16x16x32_bf16 v[160:163], a[192:195], a[176:179], v[160:163]
 global_load_dwordx4 a[232:235], v0, s[70:71] offset:-2048 sc1
 v_mfma_f32_16x16x32_bf16 v[156:159], a[192:195], a[168:171], v[156:159]
 v_mfma_f32_16x16x32_bf16 v[156:159], a[196:199], a[172:175], v[156:159]
 v_mfma_f32_16x16x32_bf16 v[152:155], a[196:199], a[164:167], v[152:155]
 v_mfma_f32_16x16x32_bf16 v[152:155], a[192:195], a[160:163], v[152:155]
 v_mfma_f32_16x16x32_bf16 v[148:151], a[192:195], a[152:155], v[148:151]
 v_mfma_f32_16x16x32_bf16 v[148:151], a[196:199], a[156:159], v[148:151]
 v_mfma_f32_16x16x32_bf16 v[144:147], a[196:199], a[148:151], v[144:147]
 v_mfma_f32_16x16x32_bf16 v[144:147], a[192:195], a[144:147], v[144:147]
 v_mfma_f32_16x16x32_bf16 v[140:143], a[192:195], a[136:139], v[140:143]
 v_mfma_f32_16x16x32_bf16 v[140:143], a[196:199], a[140:143], v[140:143]
 v_mfma_f32_16x16x32_bf16 v[136:139], a[196:199], a[132:135], v[136:139]
 v_mfma_f32_16x16x32_bf16 v[136:139], a[192:195], a[128:131], v[136:139]
 s_waitcnt vmcnt(10)
 v_mfma_f32_16x16x32_bf16 v[168:171], a[200:203], a[128:131], v[168:171]
 v_mfma_f32_16x16x32_bf16 v[168:171], a[204:207], a[132:135], v[168:171]
 global_load_dwordx4 a[196:199], v0, s[70:71] offset:1024 sc1
 v_mfma_f32_16x16x32_bf16 v[172:175], a[204:207], a[140:143], v[172:175]
 v_mfma_f32_16x16x32_bf16 v[172:175], a[200:203], a[136:139], v[172:175]
 global_load_dwordx4 a[192:195], v0, s[70:71] offset:0 sc1
 v_mfma_f32_16x16x32_bf16 v[176:179], a[200:203], a[144:147], v[176:179]
 v_mfma_f32_16x16x32_bf16 v[176:179], a[204:207], a[148:151], v[176:179]
 v_mfma_f32_16x16x32_bf16 v[180:183], a[204:207], a[156:159], v[180:183]
 v_mfma_f32_16x16x32_bf16 v[180:183], a[200:203], a[152:155], v[180:183]
 v_mfma_f32_16x16x32_bf16 v[184:187], a[200:203], a[160:163], v[184:187]
 v_mfma_f32_16x16x32_bf16 v[184:187], a[204:207], a[164:167], v[184:187]
 v_mfma_f32_16x16x32_bf16 v[188:191], a[204:207], a[172:175], v[188:191]
 v_mfma_f32_16x16x32_bf16 v[188:191], a[200:203], a[168:171], v[188:191]
 v_mfma_f32_16x16x32_bf16 v[192:195], a[200:203], a[176:179], v[192:195]
 v_mfma_f32_16x16x32_bf16 v[192:195], a[204:207], a[180:183], v[192:195]
 v_mfma_f32_16x16x32_bf16 v[196:199], a[204:207], a[188:191], v[196:199]
 v_mfma_f32_16x16x32_bf16 v[196:199], a[200:203], a[184:187], v[196:199]
 s_waitcnt vmcnt(10)
 v_mfma_f32_16x16x32_bf16 v[228:231], a[208:211], a[184:187], v[228:231]
 v_mfma_f32_16x16x32_bf16 v[228:231], a[212:215], a[188:191], v[228:231]
 global_load_dwordx4 a[204:207], v0, s[70:71] offset:3072 sc1
 v_mfma_f32_16x16x32_bf16 v[224:227], a[212:215], a[180:183], v[224:227]
 v_mfma_f32_16x16x32_bf16 v[224:227], a[208:211], a[176:179], v[224:227]
 global_load_dwordx4 a[200:203], v0, s[70:71] offset:2048 sc1
 v_mfma_f32_16x16x32_bf16 v[220:223], a[208:211], a[168:171], v[220:223]
 s_add_u32 s70, s70, 8192
 s_addc_u32 s71, s71, 0
 v_mfma_f32_16x16x32_bf16 v[220:223], a[212:215], a[172:175], v[220:223]
 v_mfma_f32_16x16x32_bf16 v[216:219], a[212:215], a[164:167], v[216:219]
 v_mfma_f32_16x16x32_bf16 v[216:219], a[208:211], a[160:163], v[216:219]
 v_mfma_f32_16x16x32_bf16 v[212:215], a[208:211], a[152:155], v[212:215]
 v_mfma_f32_16x16x32_bf16 v[212:215], a[212:215], a[156:159], v[212:215]
 v_mfma_f32_16x16x32_bf16 v[208:211], a[212:215], a[148:151], v[208:211]
 v_cmp_gt_i32 vcc, s55, v4
 s_and_b64 vcc, exec, vcc
 s_cbranch_vccnz Lspin_pb
Lok_pb:
 s_add_u32 s55, s55, 1
 s_waitcnt lgkmcnt(0)
 s_barrier
 v_mfma_f32_16x16x32_bf16 v[208:211], a[208:211], a[144:147], v[208:211]
 s_cmp_eq_u32 s25, 0
 s_cbranch_scc1 Lxrg
Lxrgr:
 v_mfma_f32_16x16x32_bf16 v[204:207], a[208:211], a[136:139], v[204:207]
 v_mfma_f32_16x16x32_bf16 v[204:207], a[212:215], a[140:143], v[204:207]
 v_mfma_f32_16x16x32_bf16 v[200:203], a[212:215], a[132:135], v[200:203]
 v_mfma_f32_16x16x32_bf16 v[200:203], a[208:211], a[128:131], v[200:203]
 s_waitcnt vmcnt(8)
 v_mfma_f32_16x16x32_bf16 v[232:235], a[216:219], a[128:131], v[232:235]
 ds_read_b128 a[128:131], v1
 v_mfma_f32_16x16x32_bf16 v[232:235], a[220:223], a[132:135], v[232:235]
 global_load_dwordx4 a[212:215], v0, s[70:71] offset:-3072 sc1
 ds_read_b128 a[132:135], v1 offset:1024
 v_mfma_f32_16x16x32_bf16 v[236:239], a[220:223], a[140:143], v[236:239]
 ds_read_b128 a[140:143], v1 offset:5120
 v_mfma_f32_16x16x32_bf16 v[236:239], a[216:219], a[136:139], v[236:239]
 global_load_dwordx4 a[208:211], v0, s[70:71] offset:-4096 sc1
 ds_read_b128 a[136:139], v1 offset:4096
 v_mfma_f32_16x16x32_bf16 v[240:243], a[216:219], a[144:147], v[240:243]
 ds_read_b128 a[144:147], v1 offset:8192
 v_mfma_f32_16x16x32_bf16 v[240:243], a[220:223], a[148:151], v[240:243]
 ds_read_b128 a[148:151], v1 offset:9216
 v_mfma_f32_16x16x32_bf16 v[244:247], a[220:223], a[156:159], v[244:247]
 ds_read_b128 a[156:159], v1 offset:13312
 v_mfma_f32_16x16x32_bf16 v[244:247], a[216:219], a[152:155], v[244:247]
 ds_read_b128 a[152:155], v1 offset:12288
 v_mfma_f32_16x16x32_bf16 v[248:251], a[216:219], a[160:163], v[248:251]
 ds_read_b128 a[160:163], v1 offset:16384
 v_mfma_f32_16x16x32_bf16 v[248:251], a[220:223], a[164:167], v[248:251]
 ds_read_b128 a[164:167], v1 offset:17408
 v_mfma_f32_16x16x32_bf16 v[252:255], a[220:223], a[172:175], v[252:255]
 ds_read_b128 a[172:175], v1 offset:21504
 v_mfma_f32_16x16x32_bf16 v[252:255], a[216:219], a[168:171], v[252:255]
 ds_read_b128 a[168:171], v1 offset:20480
 v_mfma_f32_16x16x32_bf16 a[248:251], a[216:219], a[176:179], a[248:251]
 ds_read_b128 a[176:179], v1 offset:24576
 v_mfma_f32_16x16x32_bf16 a[248:251], a[220:223], a[180:183], a[248:251]
 ds_read_b128 a[180:183], v1 offset:25600
 v_mfma_f32_16x16x32_bf16 a[252:255], a[220:223], a[188:191], a[252:255]
 global_load_dwordx4 a[220:223], v0, s[70:71] offset:-1024 sc1
 ds_read_b128 a[188:191], v1 offset:29696
 v_mfma_f32_16x16x32_bf16 a[252:255], a[216:219], a[184:187], a[252:255]
 global_load_dwordx4 a[216:219], v0, s[70:71] offset:-2048 sc1
 ds_read_b128 a[184:187], v1 offset:28672
 s_waitcnt vmcnt(10) lgkmcnt(8)
 v_mfma_f32_16x16x32_bf16 v[16:19], a[224:227], a[128:131], v[16:19]
 v_mfma_f32_16x16x32_bf16 v[16:19], a[228:231], a[132:135], v[16:19]
 v_mov_b32 v6, v3
 s_cmp_eq_u32 s25, 0
 s_cbranch_scc1 Lgat1
Lgatr1:
 v_mfma_f32_16x16x32_bf16 v[20:23], a[228:231], a[140:143], v[20:23]
 v_mfma_f32_16x16x32_bf16 v[20:23], a[224:227], a[136:139], v[20:23]
 v_mfma_f32_16x16x32_bf16 v[24:27], a[224:227], a[144:147], v[24:27]
 v_mfma_f32_16x16x32_bf16 v[24:27], a[228:231], a[148:151], v[24:27]
 s_add_u32 m0, s50, 2048
 v_mfma_f32_16x16x32_bf16 v[28:31], a[228:231], a[156:159], v[28:31]
 v_mfma_f32_16x16x32_bf16 v[28:31], a[224:227], a[152:155], v[28:31]
 s_waitcnt lgkmcnt(0)
 v_mfma_f32_16x16x32_bf16 v[32:35], a[224:227], a[160:163], v[32:35]
 v_mfma_f32_16x16x32_bf16 v[32:35], a[228:231], a[164:167], v[32:35]
 v_mfma_f32_16x16x32_bf16 v[36:39], a[228:231], a[172:175], v[36:39]
 v_mfma_f32_16x16x32_bf16 v[36:39], a[224:227], a[168:171], v[36:39]
 v_mfma_f32_16x16x32_bf16 v[40:43], a[224:227], a[176:179], v[40:43]
 buffer_load_dwordx4 v6, s[8:11], s30 offen lds
 v_mfma_f32_16x16x32_bf16 v[40:43], a[228:231], a[180:183], v[40:43]
 v_mfma_f32_16x16x32_bf16 v[44:47], a[228:231], a[188:191], v[44:47]
 v_mfma_f32_16x16x32_bf16 v[44:47], a[224:227], a[184:187], v[44:47]
 s_waitcnt vmcnt(9)
 v_mfma_f32_16x16x32_bf16 v[76:79], a[232:235], a[184:187], v[76:79]
 s_add_u32 m0, m0, 1024
 v_mfma_f32_16x16x32_bf16 v[76:79], a[236:239], a[188:191], v[76:79]
 global_load_dwordx4 a[228:231], v0, s[70:71] offset:1024 sc1
 v_mfma_f32_16x16x32_bf16 v[72:75], a[236:239], a[180:183], v[72:75]
 v_mfma_f32_16x16x32_bf16 v[72:75], a[232:235], a[176:179], v[72:75]
 global_load_dwordx4 a[224:227], v0, s[70:71] offset:0 sc1
 s_add_u32 s30, s30, s20
 v_mfma_f32_16x16x32_bf16 v[68:71], a[232:235], a[168:171], v[68:71]
 v_mfma_f32_16x16x32_bf16 v[68:71], a[236:239], a[172:175], v[68:71]
 v_mfma_f32_16x16x32_bf16 v[64:67], a[236:239], a[164:167], v[64:67]
 v_mfma_f32_16x16x32_bf16 v[64:67], a[232:235], a[160:163], v[64:67]
 buffer_load_dwordx4 v6, s[8:11], s30 offen lds
 v_mfma_f32_16x16x32_bf16 v[60:63], a[232:235], a[152:155], v[60:63]
 v_mfma_f32_16x16x32_bf16 v[60:63], a[236:239], a[156:159], v[60:63]
 v_mfma_f32_16x16x32_bf16 v[56:59], a[236:239], a[148:151], v[56:59]
 v_mfma_f32_16x16x32_bf16 v[56:59], a[232:235], a[144:147], v[56:59]
 s_add_u32 m0, m0, 3072
 v_mfma_f32_16x16x32_bf16 v[52:55], a[232:235], a[136:139], v[52:55]
 v_mfma_f32_16x16x32_bf16 v[52:55], a[236:239], a[140:143], v[52:55]
 v_mfma_f32_16x16x32_bf16 v[48:51], a[236:239], a[132:135], v[48:51]
 s_add_u32 s30, s30, s21
 v_mfma_f32_16x16x32_bf16 v[48:51], a[232:235], a[128:131], v[48:51]
 s_waitcnt vmcnt(10)
 v_mfma_f32_16x16x32_bf16 v[80:83], a[192:195], a[128:131], v[80:83]
 v_mfma_f32_16x16x32_bf16 v[80:83], a[196:199], a[132:135], v[80:83]
 global_load_dwordx4 a[236:239], v0, s[70:71] offset:3072 sc1
 v_mfma_f32_16x16x32_bf16 v[84:87], a[196:199], a[140:143], v[84:87]
 v_mfma_f32_16x16x32_bf16 v[84:87], a[192:195], a[136:139], v[84:87]
 global_load_dwordx4 a[232:235], v0, s[70:71] offset:2048 sc1
 v_mfma_f32_16x16x32_bf16 v[88:91], a[192:195], a[144:147], v[88:91]
 s_add_u32 s70, s70, 8192
 s_addc_u32 s71, s71, 0
 v_mfma_f32_16x16x32_bf16 v[88:91], a[196:199], a[148:151], v[88:91]
 v_mfma_f32_16x16x32_bf16 v[92:95], a[196:199], a[156:159], v[92:95]
 v_mfma_f32_16x16x32_bf16 v[92:95], a[192:195], a[152:155], v[92:95]
 v_mfma_f32_16x16x32_bf16 v[96:99], a[192:195], a[160:163], v[96:99]
 v_mfma_f32_16x16x32_bf16 v[96:99], a[196:199], a[164:167], v[96:99]
 v_mfma_f32_16x16x32_bf16 v[100:103], a[196:199], a[172:175], v[100:103]
 v_mfma_f32_16x16x32_bf16 v[100:103], a[192:195], a[168:171], v[100:103]
 v_mfma_f32_16x16x32_bf16 v[104:107], a[192:195], a[176:179], v[104:107]
 v_mfma_f32_16x16x32_bf16 v[104:107], a[196:199], a[180:183], v[104:107]
 v_mfma_f32_16x16x32_bf16 v[108:111], a[196:199], a[188:191], v[108:111]
 v_mfma_f32_16x16x32_bf16 v[108:111], a[192:195], a[184:187], v[108:111]
 s_waitcnt vmcnt(10)
 v_mfma_f32_16x16x32_bf16 a[244:247], a[200:203], a[184:187], a[244:247]
 v_mfma_f32_16x16x32_bf16 a[244:247], a[204:207], a[188:191], a[244:247]
 global_load_dwordx4 a[196:199], v0, s[70:71] offset:-3072 sc1
 v_mfma_f32_16x16x32_bf16 a[240:243], a[204:207], a[180:183], a[240:243]
 v_mfma_f32_16x16x32_bf16 a[240:243], a[200:203], a[176:179], a[240:243]
 global_load_dwordx4 a[192:195], v0, s[70:71] offset:-4096 sc1
 v_mfma_f32_16x16x32_bf16 v[132:135], a[200:203], a[168:171], v[132:135]
 v_mfma_f32_16x16x32_bf16 v[132:135], a[204:207], a[172:175], v[132:135]
 v_mfma_f32_16x16x32_bf16 v[128:131], a[204:207], a[164:167], v[128:131]
 v_mfma_f32_16x16x32_bf16 v[128:131], a[200:203], a[160:163], v[128:131]
 v_mfma_f32_16x16x32_bf16 v[124:127], a[200:203], a[152:155], v[124:127]
 v_mfma_f32_16x16x32_bf16 v[124:127], a[204:207], a[156:159], v[124:127]
 v_mfma_f32_16x16x32_bf16 v[120:123], a[204:207], a[148:151], v[120:123]
 v_mfma_f32_16x16x32_bf16 v[120:123], a[200:203], a[144:147], v[120:123]
 v_mfma_f32_16x16x32_bf16 v[116:119], a[200:203], a[136:139], v[116:119]
 v_mfma_f32_16x16x32_bf16 v[116:119], a[204:207], a[140:143], v[116:119]
 v_mfma_f32_16x16x32_bf16 v[112:115], a[204:207], a[132:135], v[112:115]
 v_mfma_f32_16x16x32_bf16 v[112:115], a[200:203], a[128:131], v[112:115]
 s_waitcnt vmcnt(10)
 v_mfma_f32_16x16x32_bf16 v[136:139], a[208:211], a[128:131], v[136:139]
 v_mfma_f32_16x16x32_bf16 v[136:139], a[212:215], a[132:135], v[136:139]
 global_load_dwordx4 a[204:207], v0, s[70:71] offset:-1024 sc1
 v_mfma_f32_16x16x32_bf16 v[140:143], a[212:215], a[140:143], v[140:143]
 v_mfma_f32_16x16x32_bf16 v[140:143], a[208:211], a[136:139], v[140:143]
 global_load_dwordx4 a[200:203], v0, s[70:71] offset:-2048 sc1
 v_mfma_f32_16x16x32_bf16 v[144:147], a[208:211], a[144:147], v[144:147]
 v_mfma_f32_16x16x32_bf16 v[144:147], a[212:215], a[148:151], v[144:147]
 v_mfma_f32_16x16x32_bf16 v[148:151], a[212:215], a[156:159], v[148:151]
 buffer_load_dwordx4 v6, s[8:11], s30 offen lds
 v_mfma_f32_16x16x32_bf16 v[148:151], a[208:211], a[152:155], v[148:151]
 v_mfma_f32_16x16x32_bf16 v[152:155], a[208:211], a[160:163], v[152:155]
 v_mfma_f32_16x16x32_bf16 v[152:155], a[212:215], a[164:167], v[152:155]
 v_mfma_f32_16x16x32_bf16 v[156:159], a[212:215], a[172:175], v[156:159]
 s_add_u32 m0, m0, 1024
 v_mfma_f32_16x16x32_bf16 v[156:159], a[208:211], a[168:171], v[156:159]
 v_mfma_f32_16x16x32_bf16 v[160:163], a[208:211], a[176:179], v[160:163]
 v_mfma_f32_16x16x32_bf16 v[160:163], a[212:215], a[180:183], v[160:163]
 v_mfma_f32_16x16x32_bf16 v[164:167], a[212:215], a[188:191], v[164:167]
 s_add_u32 s30, s30, s20
 v_mfma_f32_16x16x32_bf16 v[164:167], a[208:211], a[184:187], v[164:167]
 s_waitcnt vmcnt(11)
 v_mfma_f32_16x16x32_bf16 v[196:199], a[216:219], a[184:187], v[196:199]
 v_mfma_f32_16x16x32_bf16 v[196:199], a[220:223], a[188:191], v[196:199]
 global_load_dwordx4 a[212:215], v0, s[70:71] offset:1024 sc1
 v_mfma_f32_16x16x32_bf16 v[192:195], a[220:223], a[180:183], v[192:195]
 buffer_load_dwordx4 v6, s[8:11], s30 offen lds
 v_mfma_f32_16x16x32_bf16 v[192:195], a[216:219], a[176:179], v[192:195]
 global_load_dwordx4 a[208:211], v0, s[70:71] offset:0 sc1
 v_mfma_f32_16x16x32_bf16 v[188:191], a[216:219], a[168:171], v[188:191]
 v_mfma_f32_16x16x32_bf16 v[188:191], a[220:223], a[172:175], v[188:191]
 s_add_u32 m0, m0, 3072
 v_mfma_f32_16x16x32_bf16 v[184:187], a[220:223], a[164:167], v[184:187]
 v_mfma_f32_16x16x32_bf16 v[184:187], a[216:219], a[160:163], v[184:187]
 v_mfma_f32_16x16x32_bf16 v[180:183], a[216:219], a[152:155], v[180:183]
 v_mfma_f32_16x16x32_bf16 v[180:183], a[220:223], a[156:159], v[180:183]
 s_add_u32 s30, s30, s21
 v_mfma_f32_16x16x32_bf16 v[176:179], a[220:223], a[148:151], v[176:179]
 v_mfma_f32_16x16x32_bf16 v[176:179], a[216:219], a[144:147], v[176:179]
 v_mfma_f32_16x16x32_bf16 v[172:175], a[216:219], a[136:139], v[172:175]
 v_mfma_f32_16x16x32_bf16 v[172:175], a[220:223], a[140:143], v[172:175]
 v_mfma_f32_16x16x32_bf16 v[168:171], a[220:223], a[132:135], v[168:171]
 v_mfma_f32_16x16x32_bf16 v[168:171], a[216:219], a[128:131], v[168:171]
 s_waitcnt vmcnt(11)
 v_mfma_f32_16x16x32_bf16 v[200:203], a[224:227], a[128:131], v[200:203]
 v_mfma_f32_16x16x32_bf16 v[200:203], a[228:231], a[132:135], v[200:203]
 global_load_dwordx4 a[220:223], v0, s[70:71] offset:3072 sc1
 v_mfma_f32_16x16x32_bf16 v[204:207], a[228:231], a[140:143], v[204:207]
 v_mfma_f32_16x16x32_bf16 v[204:207], a[224:227], a[136:139], v[204:207]
 global_load_dwordx4 a[216:219], v0, s[70:71] offset:2048 sc1
 v_mfma_f32_16x16x32_bf16 v[208:211], a[224:227], a[144:147], v[208:211]
 s_add_u32 s70, s70, 8192
 s_addc_u32 s71, s71, 0
 v_mfma_f32_16x16x32_bf16 v[208:211], a[228:231], a[148:151], v[208:211]
 v_mfma_f32_16x16x32_bf16 v[212:215], a[228:231], a[156:159], v[212:215]
 v_mfma_f32_16x16x32_bf16 v[212:215], a[224:227], a[152:155], v[212:215]
 v_mfma_f32_16x16x32_bf16 v[216:219], a[224:227], a[160:163], v[216:219]
 v_mfma_f32_16x16x32_bf16 v[216:219], a[228:231], a[164:167], v[216:219]
 v_mfma_f32_16x16x32_bf16 v[220:223], a[228:231], a[172:175], v[220:223]
 v_mfma_f32_16x16x32_bf16 v[220:223], a[224:227], a[168:171], v[220:223]
 v_mfma_f32_16x16x32_bf16 v[224:227], a[224:227], a[176:179], v[224:227]
 v_mfma_f32_16x16x32_bf16 v[224:227], a[228:231], a[180:183], v[224:227]
 v_mfma_f32_16x16x32_bf16 v[228:231], a[228:231], a[188:191], v[228:231]
 v_mfma_f32_16x16x32_bf16 v[228:231], a[224:227], a[184:187], v[228:231]
 s_waitcnt vmcnt(10)
 v_mfma_f32_16x16x32_bf16 a[252:255], a[232:235], a[184:187], a[252:255]
 ds_read_b128 a[184:187], v1 offset:61440
 v_mfma_f32_16x16x32_bf16 a[252:255], a[236:239], a[188:191], a[252:255]
 global_load_dwordx4 a[228:231], v0, s[70:71] offset:-3072 sc1
 ds_read_b128 a[188:191], v1 offset:62464
 v_mfma_f32_16x16x32_bf16 a[248:251], a[236:239], a[180:183], a[248:251]
 ds_read_b128 a[180:183], v1 offset:58368
 v_mfma_f32_16x16x32_bf16 a[248:251], a[232:235], a[176:179], a[248:251]
 global_load_dwordx4 a[224:227], v0, s[70:71] offset:-4096 sc1
 ds_read_b128 a[176:179], v1 offset:57344
 v_mfma_f32_16x16x32_bf16 v[252:255], a[232:235], a[168:171], v[252:255]
 ds_read_b128 a[168:171], v1 offset:53248
 v_mfma_f32_16x16x32_bf16 v[252:255], a[236:239], a[172:175], v[252:255]
 ds_read_b128 a[172:175], v1 offset:54272
 v_mfma_f32_16x16x32_bf16 v[248:251], a[236:239], a[164:167], v[248:251]
 ds_read_b128 a[164:167], v1 offset:50176
 v_mfma_f32_16x16x32_bf16 v[248:251], a[232:235], a[160:163], v[248:251]
 ds_read_b128 a[160:163], v1 offset:49152
 v_mfma_f32_16x16x32_bf16 v[244:247], a[232:235], a[152:155], v[244:247]
 ds_read_b128 a[152:155], v1 offset:45056
 v_mfma_f32_16x16x32_bf16 v[244:247], a[236:239], a[156:159], v[244:247]
 ds_read_b128 a[156:159], v1 offset:46080
 v_mfma_f32_16x16x32_bf16 v[240:243], a[236:239], a[148:151], v[240:243]
 ds_read_b128 a[148:151], v1 offset:41984
 v_mfma_f32_16x16x32_bf16 v[240:243], a[232:235], a[144:147], v[240:243]
 ds_read_b128 a[144:147], v1 offset:40960
 v_mfma_f32_16x16x32_bf16 v[236:239], a[232:235], a[136:139], v[236:239]
 ds_read_b128 a[136:139], v1 offset:36864
 v_mfma_f32_16x16x32_bf16 v[236:239], a[236:239], a[140:143], v[236:239]
 ds_read_b128 a[140:143], v1 offset:37888
 v_mfma_f32_16x16x32_bf16 v[232:235], a[236:239], a[132:135], v[232:235]
 ds_read_b128 a[132:135], v1 offset:33792
 v_mfma_f32_16x16x32_bf16 v[232:235], a[232:235], a[128:131], v[232:235]
 ds_read_b128 a[128:131], v1 offset:32768
 s_waitcnt vmcnt(10) lgkmcnt(8)
 v_mfma_f32_16x16x32_bf16 v[44:47], a[192:195], a[184:187], v[44:47]
 v_mfma_f32_16x16x32_bf16 v[44:47], a[196:199], a[188:191], v[44:47]
 buffer_load_dwordx4 v6, s[8:11], s30 offen lds
 v_mfma_f32_16x16x32_bf16 v[40:43], a[196:199], a[180:183], v[40:43]
 v_mfma_f32_16x16x32_bf16 v[40:43], a[192:195], a[176:179], v[40:43]
 v_mfma_f32_16x16x32_bf16 v[36:39], a[192:195], a[168:171], v[36:39]
 s_add_u32 m0, m0, 1024
 v_mfma_f32_16x16x32_bf16 v[36:39], a[196:199], a[172:175], v[36:39]
 v_mfma_f32_16x16x32_bf16 v[32:35], a[196:199], a[164:167], v[32:35]
 v_mfma_f32_16x16x32_bf16 v[32:35], a[192:195], a[160:163], v[32:35]
 s_waitcnt lgkmcnt(0)
 v_mfma_f32_16x16x32_bf16 v[28:31], a[192:195], a[152:155], v[28:31]
 s_add_u32 s30, s30, s20
 v_mfma_f32_16x16x32_bf16 v[28:31], a[196:199], a[156:159], v[28:31]
 v_mfma_f32_16x16x32_bf16 v[24:27], a[196:199], a[148:151], v[24:27]
 v_mfma_f32_16x16x32_bf16 v[24:27], a[192:195], a[144:147], v[24:27]
 v_mfma_f32_16x16x32_bf16 v[20:23], a[192:195], a[136:139], v[20:23]
 buffer_load_dwordx4 v6, s[8:11], s30 offen lds
 v_mfma_f32_16x16x32_bf16 v[20:23], a[196:199], a[140:143], v[20:23]
 v_mfma_f32_16x16x32_bf16 v[16:19], a[196:199], a[132:135], v[16:19]
 v_mfma_f32_16x16x32_bf16 v[16:19], a[192:195], a[128:131], v[16:19]
 s_add_u32 m0, m0, 3072
 s_waitcnt vmcnt(10)
 v_mfma_f32_16x16x32_bf16 v[48:51], a[200:203], a[128:131], v[48:51]
 v_mfma_f32_16x16x32_bf16 v[48:51], a[204:207], a[132:135], v[48:51]
 global_load_dwordx4 a[196:199], v0, s[70:71] offset:-1024 sc1
 v_mfma_f32_16x16x32_bf16 v[52:55], a[204:207], a[140:143], v[52:55]
 v_mfma_f32_16x16x32_bf16 v[52:55], a[200:203], a[136:139], v[52:55]
 global_load_dwordx4 a[192:195], v0, s[70:71] offset:-2048 sc1
 s_add_u32 s30, s30, s21
 v_mfma_f32_16x16x32_bf16 v[56:59], a[200:203], a[144:147], v[56:59]
 v_mfma_f32_16x16x32_bf16 v[56:59], a[204:207], a[148:151], v[56:59]
 v_mfma_f32_16x16x32_bf16 v[60:63], a[204:207], a[156:159], v[60:63]
 v_mfma_f32_16x16x32_bf16 v[60:63], a[200:203], a[152:155], v[60:63]
 v_mfma_f32_16x16x32_bf16 v[64:67], a[200:203], a[160:163], v[64:67]
 v_mfma_f32_16x16x32_bf16 v[64:67], a[204:207], a[164:167], v[64:67]
 v_mfma_f32_16x16x32_bf16 v[68:71], a[204:207], a[172:175], v[68:71]
 v_mfma_f32_16x16x32_bf16 v[68:71], a[200:203], a[168:171], v[68:71]
 v_mfma_f32_16x16x32_bf16 v[72:75], a[200:203], a[176:179], v[72:75]
 v_mfma_f32_16x16x32_bf16 v[72:75], a[204:207], a[180:183], v[72:75]
 v_mfma_f32_16x16x32_bf16 v[76:79], a[204:207], a[188:191], v[76:79]
 v_mfma_f32_16x16x32_bf16 v[76:79], a[200:203], a[184:187], v[76:79]
 s_waitcnt vmcnt(8)
 v_mfma_f32_16x16x32_bf16 v[108:111], a[208:211], a[184:187], v[108:111]
 v_mfma_f32_16x16x32_bf16 v[108:111], a[212:215], a[188:191], v[108:111]
 global_load_dwordx4 a[204:207], v0, s[70:71] offset:1024 sc1
 v_mfma_f32_16x16x32_bf16 v[104:107], a[212:215], a[180:183], v[104:107]
 v_mfma_f32_16x16x32_bf16 v[104:107], a[208:211], a[176:179], v[104:107]
 global_load_dwordx4 a[200:203], v0, s[70:71] offset:0 sc1
 v_mfma_f32_16x16x32_bf16 v[100:103], a[208:211], a[168:171], v[100:103]
 v_mfma_f32_16x16x32_bf16 v[100:103], a[212:215], a[172:175], v[100:103]
 v_mfma_f32_16x16x32_bf16 v[96:99], a[212:215], a[164:167], v[96:99]
 v_mfma_f32_16x16x32_bf16 v[96:99], a[208:211], a[160:163], v[96:99]
 v_mfma_f32_16x16x32_bf16 v[92:95], a[208:211], a[152:155], v[92:95]
 v_mfma_f32_16x16x32_bf16 v[92:95], a[212:215], a[156:159], v[92:95]
 v_mfma_f32_16x16x32_bf16 v[88:91], a[212:215], a[148:151], v[88:91]
 v_mfma_f32_16x16x32_bf16 v[88:91], a[208:211], a[144:147], v[88:91]
 v_mfma_f32_16x16x32_bf16 v[84:87], a[208:211], a[136:139], v[84:87]
 v_mfma_f32_16x16x32_bf16 v[84:87], a[212:215], a[140:143], v[84:87]
 v_mfma_f32_16x16x32_bf16 v[80:83], a[212:215], a[132:135], v[80:83]
 v_mfma_f32_16x16x32_bf16 v[80:83], a[208:211], a[128:131], v[80:83]
 s_waitcnt vmcnt(8)
 v_mfma_f32_16x16x32_bf16 v[112:115], a[216:219], a[128:131], v[112:115]
 v_mfma_f32_16x16x32_bf16 v[112:115], a[220:223], a[132:135], v[112:115]
 global_load_dwordx4 a[212:215], v0, s[70:71] offset:3072 sc1
 v_mfma_f32_16x16x32_bf16 v[116:119], a[220:223], a[140:143], v[116:119]
 v_mfma_f32_16x16x32_bf16 v[116:119], a[216:219], a[136:139], v[116:119]
 global_load_dwordx4 a[208:211], v0, s[70:71] offset:2048 sc1
 v_mfma_f32_16x16x32_bf16 v[120:123], a[216:219], a[144:147], v[120:123]
 s_add_u32 s70, s70, 8192
 s_addc_u32 s71, s71, 0
 v_mfma_f32_16x16x32_bf16 v[120:123], a[220:223], a[148:151], v[120:123]
 v_mfma_f32_16x16x32_bf16 v[124:127], a[220:223], a[156:159], v[124:127]
 v_mfma_f32_16x16x32_bf16 v[124:127], a[216:219], a[152:155], v[124:127]
 v_mfma_f32_16x16x32_bf16 v[128:131], a[216:219], a[160:163], v[128:131]
 v_mfma_f32_16x16x32_bf16 v[128:131], a[220:223], a[164:167], v[128:131]
 v_mfma_f32_16x16x32_bf16 v[132:135], a[220:223], a[172:175], v[132:135]
 v_mfma_f32_16x16x32_bf16 v[132:135], a[216:219], a[168:171], v[132:135]
 buffer_load_dwordx4 v6, s[8:11], s30 offen lds
 v_mfma_f32_16x16x32_bf16 a[240:243], a[216:219], a[176:179], a[240:243]
 v_mfma_f32_16x16x32_bf16 a[240:243], a[220:223], a[180:183], a[240:243]
 v_mfma_f32_16x16x32_bf16 a[244:247], a[220:223], a[188:191], a[244:247]
 s_add_u32 m0, m0, 1024
 v_mfma_f32_16x16x32_bf16 a[244:247], a[216:219], a[184:187], a[244:247]
 s_waitcnt vmcnt(9)
 v_mfma_f32_16x16x32_bf16 v[164:167], a[224:227], a[184:187], v[164:167]
 v_mfma_f32_16x16x32_bf16 v[164:167], a[228:231], a[188:191], v[164:167]
 global_load_dwordx4 a[220:223], v0, s[70:71] offset:-3072 sc1
 v_mfma_f32_16x16x32_bf16 v[160:163], a[228:231], a[180:183], v[160:163]
 s_add_u32 s30, s30, s20
 v_mfma_f32_16x16x32_bf16 v[160:163], a[224:227], a[176:179], v[160:163]
 global_load_dwordx4 a[216:219], v0, s[70:71] offset:-4096 sc1
 v_mfma_f32_16x16x32_bf16 v[156:159], a[224:227], a[168:171], v[156:159]
 v_mfma_f32_16x16x32_bf16 v[156:159], a[228:231], a[172:175], v[156:159]
 v_mfma_f32_16x16x32_bf16 v[152:155], a[228:231], a[164:167], v[152:155]
 buffer_load_dwordx4 v6, s[8:11], s30 offen lds
 v_mfma_f32_16x16x32_bf16 v[152:155], a[224:227], a[160:163], v[152:155]
 v_mfma_f32_16x16x32_bf16 v[148:151], a[224:227], a[152:155], v[148:151]
 v_mfma_f32_16x16x32_bf16 v[148:151], a[228:231], a[156:159], v[148:151]
 s_add_u32 m0, m0, 3072
 v_mfma_f32_16x16x32_bf16 v[144:147], a[228:231], a[148:151], v[144:147]
 v_mfma_f32_16x16x32_bf16 v[144:147], a[224:227], a[144:147], v[144:147]
 v_mfma_f32_16x16x32_bf16 v[140:143], a[224:227], a[136:139], v[140:143]
 v_mfma_f32_16x16x32_bf16 v[140:143], a[228:231], a[140:143], v[140:143]
 s_add_u32 s30, s30, s21
 v_mfma_f32_16x16x32_bf16 v[136:139], a[228:231], a[132:135], v[136:139]
 v_mfma_f32_16x16x32_bf16 v[136:139], a[224:227], a[128:131], v[136:139]
 s_waitcnt vmcnt(8)
 v_mfma_f32_16x16x32_bf16 v[168:171], a[192:195], a[128:131], v[168:171]
 v_mfma_f32_16x16x32_bf16 v[168:171], a[196:199], a[132:135], v[168:171]
 global_load_dwordx4 a[228:231], v0, s[70:71] offset:-1024 sc1
 v_mfma_f32_16x16x32_bf16 v[172:175], a[196:199], a[140:143], v[172:175]
 v_mfma_f32_16x16x32_bf16 v[172:175], a[192:195], a[136:139], v[172:175]
 global_load_dwordx4 a[224:227], v0, s[70:71] offset:-2048 sc1
 v_mfma_f32_16x16x32_bf16 v[176:179], a[192:195], a[144:147], v[176:179]
 v_mfma_f32_16x16x32_bf16 v[176:179], a[196:199], a[148:151], v[176:179]
 v_mfma_f32_16x16x32_bf16 v[180:183], a[196:199], a[156:159], v[180:183]
 v_mfma_f32_16x16x32_bf16 v[180:183], a[192:195], a[152:155], v[180:183]
 v_mfma_f32_16x16x32_bf16 v[184:187], a[192:195], a[160:163], v[184:187]
 v_mfma_f32_16x16x32_bf16 v[184:187], a[196:199], a[164:167], v[184:187]
 v_mfma_f32_16x16x32_bf16 v[188:191], a[196:199], a[172:175], v[188:191]
 v_mfma_f32_16x16x32_bf16 v[188:191], a[192:195], a[168:171], v[188:191]
 v_mfma_f32_16x16x32_bf16 v[192:195], a[192:195], a[176:179], v[192:195]
 v_mfma_f32_16x16x32_bf16 v[192:195], a[196:199], a[180:183], v[192:195]
 v_mfma_f32_16x16x32_bf16 v[196:199], a[196:199], a[188:191], v[196:199]
 v_mfma_f32_16x16x32_bf16 v[196:199], a[192:195], a[184:187], v[196:199]
 s_waitcnt vmcnt(8)
 v_mfma_f32_16x16x32_bf16 v[228:231], a[200:203], a[184:187], v[228:231]
 v_mfma_f32_16x16x32_bf16 v[228:231], a[204:207], a[188:191], v[228:231]
 global_load_dwordx4 a[196:199], v0, s[70:71] offset:1024 sc1
 v_mfma_f32_16x16x32_bf16 v[224:227], a[204:207], a[180:183], v[224:227]
 v_mfma_f32_16x16x32_bf16 v[224:227], a[200:203], a[176:179], v[224:227]
 global_load_dwordx4 a[192:195], v0, s[70:71] offset:0 sc1
 v_mfma_f32_16x16x32_bf16 v[220:223], a[200:203], a[168:171], v[220:223]
 v_mfma_f32_16x16x32_bf16 v[220:223], a[204:207], a[172:175], v[220:223]
 v_mfma_f32_16x16x32_bf16 v[216:219], a[204:207], a[164:167], v[216:219]
 v_mfma_f32_16x16x32_bf16 v[216:219], a[200:203], a[160:163], v[216:219]
 v_mfma_f32_16x16x32_bf16 v[212:215], a[200:203], a[152:155], v[212:215]
 v_mfma_f32_16x16x32_bf16 v[212:215], a[204:207], a[156:159], v[212:215]
 v_mfma_f32_16x16x32_bf16 v[208:211], a[204:207], a[148:151], v[208:211]
 v_mfma_f32_16x16x32_bf16 v[208:211], a[200:203], a[144:147], v[208:211]
 v_mfma_f32_16x16x32_bf16 v[204:207], a[200:203], a[136:139], v[204:207]
 v_mfma_f32_16x16x32_bf16 v[204:207], a[204:207], a[140:143], v[204:207]
 v_mfma_f32_16x16x32_bf16 v[200:203], a[204:207], a[132:135], v[200:203]
 v_mfma_f32_16x16x32_bf16 v[200:203], a[200:203], a[128:131], v[200:203]
 buffer_load_dwordx4 v6, s[8:11], s30 offen lds
 s_waitcnt vmcnt(9)
 v_mfma_f32_16x16x32_bf16 v[232:235], a[208:211], a[128:131], v[232:235]
 ds_read_b128 a[128:131], v2
 v_mfma_f32_16x16x32_bf16 v[232:235], a[212:215], a[132:135], v[232:235]
 global_load_dwordx4 a[204:207], v0, s[70:71] offset:3072 sc1
 ds_read_b128 a[132:135], v2 offset:1024
 v_mfma_f32_16x16x32_bf16 v[236:239], a[212:215], a[140:143], v[236:239]
 ds_read_b128 a[140:143], v2 offset:5120
 v_mfma_f32_16x16x32_bf16 v[236:239], a[208:211], a[136:139], v[236:239]
 global_load_dwordx4 a[200:203], v0, s[70:71] offset:2048 sc1
 ds_read_b128 a[136:139], v2 offset:4096
 v_mfma_f32_16x16x32_bf16 v[240:243], a[208:211], a[144:147], v[240:243]
 s_add_u32 s70, s70, 8192
 s_addc_u32 s71, s71, 0
 ds_read_b128 a[144:147], v2 offset:8192
 v_mfma_f32_16x16x32_bf16 v[240:243], a[212:215], a[148:151], v[240:243]
 ds_read_b128 a[148:151], v2 offset:9216
 v_mfma_f32_16x16x32_bf16 v[244:247], a[212:215], a[156:159], v[244:247]
 ds_read_b128 a[156:159], v2 offset:13312
 v_mfma_f32_16x16x32_bf16 v[244:247], a[208:211], a[152:155], v[244:247]
 ds_read_b128 a[152:155], v2 offset:12288
 v_mfma_f32_16x16x32_bf16 v[248:251], a[208:211], a[160:163], v[248:251]
 ds_read_b128 a[160:163], v2 offset:16384
 v_mfma_f32_16x16x32_bf16 v[248:251], a[212:215], a[164:167], v[248:251]
 ds_read_b128 a[164:167], v2 offset:17408
 s_add_u32 m0, m0, 1024
 v_mfma_f32_16x16x32_bf16 v[252:255], a[212:215], a[172:175], v[252:255]
 ds_read_b128 a[172:175], v2 offset:21504
 v_mfma_f32_16x16x32_bf16 v[252:255], a[208:211], a[168:171], v[252:255]
 ds_read_b128 a[168:171], v2 offset:20480
 v_mfma_f32_16x16x32_bf16 a[248:251], a[208:211], a[176:179], a[248:251]
 ds_read_b128 a[176:179], v2 offset:24576
 s_add_u32 s30, s30, s20
 v_mfma_f32_16x16x32_bf16 a[248:251], a[212:215], a[180:183], a[248:251]
 ds_read_b128 a[180:183], v2 offset:25600
 v_mfma_f32_16x16x32_bf16 a[252:255], a[212:215], a[188:191], a[252:255]
 ds_read_b128 a[188:191], v2 offset:29696
 v_mfma_f32_16x16x32_bf16 a[252:255], a[208:211], a[184:187], a[252:255]
 ds_read_b128 a[184:187], v2 offset:28672
 s_waitcnt vmcnt(8) lgkmcnt(8)
 v_mfma_f32_16x16x32_bf16 v[16:19], a[216:219], a[128:131], v[16:19]
 buffer_load_dwordx4 v6, s[8:11], s30 offen lds
 v_mfma_f32_16x16x32_bf16 v[16:19], a[220:223], a[132:135], v[16:19]
 global_load_dwordx4 a[212:215], v0, s[70:71] offset:-3072 sc1
 v_mfma_f32_16x16x32_bf16 v[20:23], a[220:223], a[140:143], v[20:23]
 v_mfma_f32_16x16x32_bf16 v[20:23], a[216:219], a[136:139], v[20:23]
 global_load_dwordx4 a[208:211], v0, s[70:71] offset:-4096 sc1
 s_add_u32 m0, m0, 3072
 v_mfma_f32_16x16x32_bf16 v[24:27], a[216:219], a[144:147], v[24:27]
 v_mfma_f32_16x16x32_bf16 v[24:27], a[220:223], a[148:151], v[24:27]
 v_mfma_f32_16x16x32_bf16 v[28:31], a[220:223], a[156:159], v[28:31]
 v_mfma_f32_16x16x32_bf16 v[28:31], a[216:219], a[152:155], v[28:31]
 s_add_u32 s30, s30, s21
 s_waitcnt lgkmcnt(0)
 v_mfma_f32_16x16x32_bf16 v[32:35], a[216:219], a[160:163], v[32:35]
 v_mfma_f32_16x16x32_bf16 v[32:35], a[220:223], a[164:167], v[32:35]
 v_mfma_f32_16x16x32_bf16 v[36:39], a[220:223], a[172:175], v[36:39]
 v_mfma_f32_16x16x32_bf16 v[36:39], a[216:219], a[168:171], v[36:39]
 v_mfma_f32_16x16x32_bf16 v[40:43], a[216:219], a[176:179], v[40:43]
 v_mfma_f32_16x16x32_bf16 v[40:43], a[220:223], a[180:183], v[40:43]
 v_mfma_f32_16x16x32_bf16 v[44:47], a[220:223], a[188:191], v[44:47]
 v_mfma_f32_16x16x32_bf16 v[44:47], a[216:219], a[184:187], v[44:47]
 s_waitcnt vmcnt(8)
 v_mfma_f32_16x16x32_bf16 v[76:79], a[224:227], a[184:187], v[76:79]
 v_mfma_f32_16x16x32_bf16 v[76:79], a[228:231], a[188:191], v[76:79]
 global_load_dwordx4 a[220:223], v0, s[70:71] offset:-1024 sc1
 v_mfma_f32_16x16x32_bf16 v[72:75], a[228:231], a[180:183], v[72:75]
 v_mfma_f32_16x16x32_bf16 v[72:75], a[224:227], a[176:179], v[72:75]
 global_load_dwordx4 a[216:219], v0, s[70:71] offset:-2048 sc1
 v_mfma_f32_16x16x32_bf16 v[68:71], a[224:227], a[168:171], v[68:71]
 v_mfma_f32_16x16x32_bf16 v[68:71], a[228:231], a[172:175], v[68:71]
 v_mfma_f32_16x16x32_bf16 v[64:67], a[228:231], a[164:167], v[64:67]
 v_mfma_f32_16x16x32_bf16 v[64:67], a[224:227], a[160:163], v[64:67]
 v_mfma_f32_16x16x32_bf16 v[60:63], a[224:227], a[152:155], v[60:63]
 v_mfma_f32_16x16x32_bf16 v[60:63], a[228:231], a[156:159], v[60:63]
 v_mfma_f32_16x16x32_bf16 v[56:59], a[228:231], a[148:151], v[56:59]
 v_mfma_f32_16x16x32_bf16 v[56:59], a[224:227], a[144:147], v[56:59]
 v_mfma_f32_16x16x32_bf16 v[52:55], a[224:227], a[136:139], v[52:55]
 v_mfma_f32_16x16x32_bf16 v[52:55], a[228:231], a[140:143], v[52:55]
 v_mfma_f32_16x16x32_bf16 v[48:51], a[228:231], a[132:135], v[48:51]
 v_mfma_f32_16x16x32_bf16 v[48:51], a[224:227], a[128:131], v[48:51]
 s_waitcnt vmcnt(8)
 v_mfma_f32_16x16x32_bf16 v[80:83], a[192:195], a[128:131], v[80:83]
 v_mfma_f32_16x16x32_bf16 v[80:83], a[196:199], a[132:135], v[80:83]
 global_load_dwordx4 a[228:231], v0, s[70:71] offset:1024 sc1
 v_mfma_f32_16x16x32_bf16 v[84:87], a[196:199], a[140:143], v[84:87]
 v_mfma_f32_16x16x32_bf16 v[84:87], a[192:195], a[136:139], v[84:87]
 global_load_dwordx4 a[224:227], v0, s[70:71] offset:0 sc1
 v_mfma_f32_16x16x32_bf16 v[88:91], a[192:195], a[144:147], v[88:91]
 v_mfma_f32_16x16x32_bf16 v[88:91], a[196:199], a[148:151], v[88:91]
 v_mfma_f32_16x16x32_bf16 v[92:95], a[196:199], a[156:159], v[92:95]
 v_mfma_f32_16x16x32_bf16 v[92:95], a[192:195], a[152:155], v[92:95]
 v_mfma_f32_16x16x32_bf16 v[96:99], a[192:195], a[160:163], v[96:99]
 v_mfma_f32_16x16x32_bf16 v[96:99], a[196:199], a[164:167], v[96:99]
 v_mfma_f32_16x16x32_bf16 v[100:103], a[196:199], a[172:175], v[100:103]
 v_mfma_f32_16x16x32_bf16 v[100:103], a[192:195], a[168:171], v[100:103]
 v_mfma_f32_16x16x32_bf16 v[104:107], a[192:195], a[176:179], v[104:107]
 v_mfma_f32_16x16x32_bf16 v[104:107], a[196:199], a[180:183], v[104:107]
 v_mfma_f32_16x16x32_bf16 v[108:111], a[196:199], a[188:191], v[108:111]
 v_mfma_f32_16x16x32_bf16 v[108:111], a[192:195], a[184:187], v[108:111]
 buffer_load_dwordx4 v6, s[8:11], s30 offen lds
 s_waitcnt vmcnt(8)
 v_mfma_f32_16x16x32_bf16 a[244:247], a[200:203], a[184:187], a[244:247]
 v_mfma_f32_16x16x32_bf16 a[244:247], a[204:207], a[188:191], a[244:247]
 global_load_dwordx4 a[196:199], v0, s[70:71] offset:3072 sc1
 v_mfma_f32_16x16x32_bf16 a[240:243], a[204:207], a[180:183], a[240:243]
 v_mfma_f32_16x16x32_bf16 a[240:243], a[200:203], a[176:179], a[240:243]
 global_load_dwordx4 a[192:195], v0, s[70:71] offset:2048 sc1
 s_add_u32 m0, m0, 1024
 v_mfma_f32_16x16x32_bf16 v[132:135], a[200:203], a[168:171], v[132:135]
 s_add_u32 s70, s70, 8192
 s_addc_u32 s71, s71, 0
 v_mfma_f32_16x16x32_bf16 v[132:135], a[204:207], a[172:175], v[132:135]
 v_mfma_f32_16x16x32_bf16 v[128:131], a[204:207], a[164:167], v[128:131]
 s_add_u32 s30, s30, s20
 v_mfma_f32_16x16x32_bf16 v[128:131], a[200:203], a[160:163], v[128:131]
 v_mfma_f32_16x16x32_bf16 v[124:127], a[200:203], a[152:155], v[124:127]
 v_mfma_f32_16x16x32_bf16 v[124:127], a[204:207], a[156:159], v[124:127]
 v_mfma_f32_16x16x32_bf16 v[120:123], a[204:207], a[148:151], v[120:123]
 buffer_load_dwordx4 v6, s[8:11], s30 offen lds
 v_mfma_f32_16x16x32_bf16 v[120:123], a[200:203], a[144:147], v[120:123]
 v_mfma_f32_16x16x32_bf16 v[116:119], a[200:203], a[136:139], v[116:119]
 v_mfma_f32_16x16x32_bf16 v[116:119], a[204:207], a[140:143], v[116:119]
 v_mfma_f32_16x16x32_bf16 v[112:115], a[204:207], a[132:135], v[112:115]
 s_add_u32 m0, m0, 3072
 v_mfma_f32_16x16x32_bf16 v[112:115], a[200:203], a[128:131], v[112:115]
 s_waitcnt vmcnt(8)
 v_mfma_f32_16x16x32_bf16 v[136:139], a[208:211], a[128:131], v[136:139]
 v_mfma_f32_16x16x32_bf16 v[136:139], a[212:215], a[132:135], v[136:139]
 global_load_dwordx4 a[204:207], v0, s[70:71] offset:-3072 sc1
 s_add_u32 s30, s30, s21
 v_mfma_f32_16x16x32_bf16 v[140:143], a[212:215], a[140:143], v[140:143]
 v_mfma_f32_16x16x32_bf16 v[140:143], a[208:211], a[136:139], v[140:143]
 global_load_dwordx4 a[200:203], v0, s[70:71] offset:-4096 sc1
 v_mfma_f32_16x16x32_bf16 v[144:147], a[208:211], a[144:147], v[144:147]
 v_mfma_f32_16x16x32_bf16 v[144:147], a[212:215], a[148:151], v[144:147]
 v_mfma_f32_16x16x32_bf16 v[148:151], a[212:215], a[156:159], v[148:151]
 v_mfma_f32_16x16x32_bf16 v[148:151], a[208:211], a[152:155], v[148:151]
 v_mfma_f32_16x16x32_bf16 v[152:155], a[208:211], a[160:163], v[152:155]
 v_mfma_f32_16x16x32_bf16 v[152:155], a[212:215], a[164:167], v[152:155]
 v_mfma_f32_16x16x32_bf16 v[156:159], a[212:215], a[172:175], v[156:159]
 v_and_b32 v5, 768, v3
 v_mfma_f32_16x16x32_bf16 v[156:159], a[208:211], a[168:171], v[156:159]
 v_and_b32 v7, 1023, v3
 v_mfma_f32_16x16x32_bf16 v[160:163], a[208:211], a[176:179], v[160:163]
 v_mfma_f32_16x16x32_bf16 v[160:163], a[212:215], a[180:183], v[160:163]
 v_add3_u32 v5, v5, v7, s52
 v_mfma_f32_16x16x32_bf16 v[164:167], a[212:215], a[188:191], v[164:167]
 v_mfma_f32_16x16x32_bf16 v[164:167], a[208:211], a[184:187], v[164:167]
 ds_read_b64_tr_b16 v[8:9], v5 offset:0
 s_waitcnt vmcnt(8)
 v_mfma_f32_16x16x32_bf16 v[196:199], a[216:219], a[184:187], v[196:199]
 v_mfma_f32_16x16x32_bf16 v[196:199], a[220:223], a[188:191], v[196:199]
 global_load_dwordx4 a[212:215], v0, s[70:71] offset:-1024 sc1
 ds_read_b64_tr_b16 v[10:11], v5 offset:256
 v_mfma_f32_16x16x32_bf16 v[192:195], a[220:223], a[180:183], v[192:195]
 ds_read_b64_tr_b16 v[12:13], v5 offset:8
 v_mfma_f32_16x16x32_bf16 v[192:195], a[216:219], a[176:179], v[192:195]
 global_load_dwordx4 a[208:211], v0, s[70:71] offset:-2048 sc1
 ds_read_b64_tr_b16 v[14:15], v5 offset:264
 v_mfma_f32_16x16x32_bf16 v[188:191], a[216:219], a[168:171], v[188:191]
 v_mfma_f32_16x16x32_bf16 v[188:191], a[220:223], a[172:175], v[188:191]
 v_mfma_f32_16x16x32_bf16 v[184:187], a[220:223], a[164:167], v[184:187]
 v_mfma_f32_16x16x32_bf16 v[184:187], a[216:219], a[160:163], v[184:187]
 v_mfma_f32_16x16x32_bf16 v[180:183], a[216:219], a[152:155], v[180:183]
 v_mfma_f32_16x16x32_bf16 v[180:183], a[220:223], a[156:159], v[180:183]
 v_mfma_f32_16x16x32_bf16 v[176:179], a[220:223], a[148:151], v[176:179]
 v_mfma_f32_16x16x32_bf16 v[176:179], a[216:219], a[144:147], v[176:179]
 v_mfma_f32_16x16x32_bf16 v[172:175], a[216:219], a[136:139], v[172:175]
 v_mfma_f32_16x16x32_bf16 v[172:175], a[220:223], a[140:143], v[172:175]
 v_mfma_f32_16x16x32_bf16 v[168:171], a[220:223], a[132:135], v[168:171]
 v_mfma_f32_16x16x32_bf16 v[168:171], a[216:219], a[128:131], v[168:171]
 s_waitcnt vmcnt(8)
 v_mfma_f32_16x16x32_bf16 v[200:203], a[224:227], a[128:131], v[200:203]
 v_mfma_f32_16x16x32_bf16 v[200:203], a[228:231], a[132:135], v[200:203]
 global_load_dwordx4 a[220:223], v0, s[70:71] offset:1024 sc1
 v_mfma_f32_16x16x32_bf16 v[204:207], a[228:231], a[140:143], v[204:207]
 s_waitcnt lgkmcnt(2)
 v_mfma_f32_16x16x32_bf16 v[204:207], a[224:227], a[136:139], v[204:207]
 global_load_dwordx4 a[216:219], v0, s[70:71] offset:0 sc1
 v_mfma_f32_16x16x32_bf16 v[208:211], a[224:227], a[144:147], v[208:211]
 buffer_store_dwordx4 v[8:11], v7, s[12:15], s49 offen sc1
 v_mfma_f32_16x16x32_bf16 v[208:211], a[228:231], a[148:151], v[208:211]
 s_waitcnt lgkmcnt(0)
 v_mfma_f32_16x16x32_bf16 v[212:215], a[228:231], a[156:159], v[212:215]
 buffer_store_dwordx4 v[12:15], v7, s[12:15], s49 offen offset:2048 sc1
 v_mfma_f32_16x16x32_bf16 v[212:215], a[224:227], a[152:155], v[212:215]
 s_add_u32 s49, s49, 2097152
 v_mfma_f32_16x16x32_bf16 v[216:219], a[224:227], a[160:163], v[216:219]
 v_mfma_f32_16x16x32_bf16 v[216:219], a[228:231], a[164:167], v[216:219]
 buffer_load_dwordx4 v6, s[8:11], s30 offen lds
 v_mfma_f32_16x16x32_bf16 v[220:223], a[228:231], a[172:175], v[220:223]
 v_mfma_f32_16x16x32_bf16 v[220:223], a[224:227], a[168:171], v[220:223]
 v_mfma_f32_16x16x32_bf16 v[224:227], a[224:227], a[176:179], v[224:227]
 v_mfma_f32_16x16x32_bf16 v[224:227], a[228:231], a[180:183], v[224:227]
 s_add_u32 m0, m0, 1024
 v_mfma_f32_16x16x32_bf16 v[228:231], a[228:231], a[188:191], v[228:231]
 v_mfma_f32_16x16x32_bf16 v[228:231], a[224:227], a[184:187], v[228:231]
 s_add_u32 s30, s30, s20
 buffer_load_dwordx4 v6, s[8:11], s30 offen lds
 s_waitcnt vmcnt(11)
 v_mfma_f32_16x16x32_bf16 a[252:255], a[192:195], a[184:187], a[252:255]
 ds_read_b128 a[184:187], v2 offset:61440
 v_mfma_f32_16x16x32_bf16 a[252:255], a[196:199], a[188:191], a[252:255]
 global_load_dwordx4 a[228:231], v0, s[70:71] offset:3072 sc1
 ds_read_b128 a[188:191], v2 offset:62464
 v_mfma_f32_16x16x32_bf16 a[248:251], a[196:199], a[180:183], a[248:251]
 ds_read_b128 a[180:183], v2 offset:58368
 v_mfma_f32_16x16x32_bf16 a[248:251], a[192:195], a[176:179], a[248:251]
 global_load_dwordx4 a[224:227], v0, s[70:71] offset:2048 sc1
 ds_read_b128 a[176:179], v2 offset:57344
 v_mfma_f32_16x16x32_bf16 v[252:255], a[192:195], a[168:171], v[252:255]
 s_add_u32 s70, s70, 8192
 s_addc_u32 s71, s71, 0
 ds_read_b128 a[168:171], v2 offset:53248
 v_mfma_f32_16x16x32_bf16 v[252:255], a[196:199], a[172:175], v[252:255]
 ds_read_b128 a[172:175], v2 offset:54272
 v_mfma_f32_16x16x32_bf16 v[248:251], a[196:199], a[164:167], v[248:251]
 ds_read_b128 a[164:167], v2 offset:50176
 v_mfma_f32_16x16x32_bf16 v[248:251], a[192:195], a[160:163], v[248:251]
 ds_read_b128 a[160:163], v2 offset:49152
 v_mfma_f32_16x16x32_bf16 v[244:247], a[192:195], a[152:155], v[244:247]
 ds_read_b128 a[152:155], v2 offset:45056
 s_add_u32 m0, m0, 3072
 v_mfma_f32_16x16x32_bf16 v[244:247], a[196:199], a[156:159], v[244:247]
 ds_read_b128 a[156:159], v2 offset:46080
 v_mfma_f32_16x16x32_bf16 v[240:243], a[196:199], a[148:151], v[240:243]
 ds_read_b128 a[148:151], v2 offset:41984
 v_mfma_f32_16x16x32_bf16 v[240:243], a[192:195], a[144:147], v[240:243]
 ds_read_b128 a[144:147], v2 offset:40960
 s_add_u32 s30, s30, s21
 v_mfma_f32_16x16x32_bf16 v[236:239], a[192:195], a[136:139], v[236:239]
 ds_read_b128 a[136:139], v2 offset:36864
 v_mfma_f32_16x16x32_bf16 v[236:239], a[196:199], a[140:143], v[236:239]
 ds_read_b128 a[140:143], v2 offset:37888
 v_mfma_f32_16x16x32_bf16 v[232:235], a[196:199], a[132:135], v[232:235]
 ds_read_b128 a[132:135], v2 offset:33792
 v_mfma_f32_16x16x32_bf16 v[232:235], a[192:195], a[128:131], v[232:235]
 ds_read_b128 a[128:131], v2 offset:32768
 s_waitcnt vmcnt(10) lgkmcnt(8)
 v_mfma_f32_16x16x32_bf16 v[44:47], a[200:203], a[184:187], v[44:47]
 v_mfma_f32_16x16x32_bf16 v[44:47], a[204:207], a[188:191], v[44:47]
 global_load_dwordx4 a[196:199], v0, s[70:71] offset:-3072 sc1
 v_mfma_f32_16x16x32_bf16 v[40:43], a[204:207], a[180:183], v[40:43]
 v_mfma_f32_16x16x32_bf16 v[40:43], a[200:203], a[176:179], v[40:43]
 global_load_dwordx4 a[192:195], v0, s[70:71] offset:-4096 sc1
 v_mfma_f32_16x16x32_bf16 v[36:39], a[200:203], a[168:171], v[36:39]
 v_mfma_f32_16x16x32_bf16 v[36:39], a[204:207], a[172:175], v[36:39]
 v_mfma_f32_16x16x32_bf16 v[32:35], a[204:207], a[164:167], v[32:35]
 v_mfma_f32_16x16x32_bf16 v[32:35], a[200:203], a[160:163], v[32:35]
 s_waitcnt lgkmcnt(0)
 v_mfma_f32_16x16x32_bf16 v[28:31], a[200:203], a[152:155], v[28:31]
 v_mfma_f32_16x16x32_bf16 v[28:31], a[204:207], a[156:159], v[28:31]
 v_mfma_f32_16x16x32_bf16 v[24:27], a[204:207], a[148:151], v[24:27]
 v_mfma_f32_16x16x32_bf16 v[24:27], a[200:203], a[144:147], v[24:27]
 v_mfma_f32_16x16x32_bf16 v[20:23], a[200:203], a[136:139], v[20:23]
 v_mfma_f32_16x16x32_bf16 v[20:23], a[204:207], a[140:143], v[20:23]
 v_mfma_f32_16x16x32_bf16 v[16:19], a[204:207], a[132:135], v[16:19]
 v_mfma_f32_16x16x32_bf16 v[16:19], a[200:203], a[128:131], v[16:19]
 s_waitcnt vmcnt(10)
 v_mfma_f32_16x16x32_bf16 v[48:51], a[208:211], a[128:131], v[48:51]
 v_mfma_f32_16x16x32_bf16 v[48:51], a[212:215], a[132:135], v[48:51]
 global_load_dwordx4 a[204:207], v0, s[70:71] offset:-1024 sc1
 v_mfma_f32_16x16x32_bf16 v[52:55], a[212:215], a[140:143], v[52:55]
 v_mfma_f32_16x16x32_bf16 v[52:55], a[208:211], a[136:139], v[52:55]
 global_load_dwordx4 a[200:203], v0, s[70:71] offset:-2048 sc1
 v_mfma_f32_16x16x32_bf16 v[56:59], a[208:211], a[144:147], v[56:59]
 v_mfma_f32_16x16x32_bf16 v[56:59], a[212:215], a[148:151], v[56:59]
 v_mfma_f32_16x16x32_bf16 v[60:63], a[212:215], a[156:159], v[60:63]
 v_mfma_f32_16x16x32_bf16 v[60:63], a[208:211], a[152:155], v[60:63]
 v_mfma_f32_16x16x32_bf16 v[64:67], a[208:211], a[160:163], v[64:67]
 v_mfma_f32_16x16x32_bf16 v[64:67], a[212:215], a[164:167], v[64:67]
 v_mfma_f32_16x16x32_bf16 v[68:71], a[212:215], a[172:175], v[68:71]
 v_mfma_f32_16x16x32_bf16 v[68:71], a[208:211], a[168:171], v[68:71]
 v_mfma_f32_16x16x32_bf16 v[72:75], a[208:211], a[176:179], v[72:75]
 v_mfma_f32_16x16x32_bf16 v[72:75], a[212:215], a[180:183], v[72:75]
 v_mfma_f32_16x16x32_bf16 v[76:79], a[212:215], a[188:191], v[76:79]
 v_mfma_f32_16x16x32_bf16 v[76:79], a[208:211], a[184:187], v[76:79]
 s_waitcnt vmcnt(10)
 v_mfma_f32_16x16x32_bf16 v[108:111], a[216:219], a[184:187], v[108:111]
 v_mfma_f32_16x16x32_bf16 v[108:111], a[220:223], a[188:191], v[108:111]
 global_load_dwordx4 a[212:215], v0, s[70:71] offset:1024 sc1
 v_mfma_f32_16x16x32_bf16 v[104:107], a[220:223], a[180:183], v[104:107]
 v_mfma_f32_16x16x32_bf16 v[104:107], a[216:219], a[176:179], v[104:107]
 global_load_dwordx4 a[208:211], v0, s[70:71] offset:0 sc1
 v_mfma_f32_16x16x32_bf16 v[100:103], a[216:219], a[168:171], v[100:103]
 buffer_load_dwordx4 v6, s[8:11], s30 offen lds
 v_mfma_f32_16x16x32_bf16 v[100:103], a[220:223], a[172:175], v[100:103]
 v_mfma_f32_16x16x32_bf16 v[96:99], a[220:223], a[164:167], v[96:99]
 v_mfma_f32_16x16x32_bf16 v[96:99], a[216:219], a[160:163], v[96:99]
 s_add_u32 m0, m0, 1024
 v_mfma_f32_16x16x32_bf16 v[92:95], a[216:219], a[152:155], v[92:95]
 v_mfma_f32_16x16x32_bf16 v[92:95], a[220:223], a[156:159], v[92:95]
 v_mfma_f32_16x16x32_bf16 v[88:91], a[220:223], a[148:151], v[88:91]
 v_mfma_f32_16x16x32_bf16 v[88:91], a[216:219], a[144:147], v[88:91]
 s_add_u32 s30, s30, s20
 v_mfma_f32_16x16x32_bf16 v[84:87], a[216:219], a[136:139], v[84:87]
 v_mfma_f32_16x16x32_bf16 v[84:87], a[220:223], a[140:143], v[84:87]
 v_mfma_f32_16x16x32_bf16 v[80:83], a[220:223], a[132:135], v[80:83]
 buffer_load_dwordx4 v6, s[8:11], s30 offen lds
 v_mfma_f32_16x16x32_bf16 v[80:83], a[216:219], a[128:131], v[80:83]
 s_waitcnt vmcnt(8)
 v_mfma_f32_16x16x32_bf16 v[112:115], a[224:227], a[128:131], v[112:115]
 v_mfma_f32_16x16x32_bf16 v[112:115], a[228:231], a[132:135], v[112:115]
 global_load_dwordx4 a[220:223], v0, s[70:71] offset:3072 sc1
 v_mfma_f32_16x16x32_bf16 v[116:119], a[228:231], a[140:143], v[116:119]
 s_add_u32 m0, m0, 3072
 v_mfma_f32_16x16x32_bf16 v[116:119], a[224:227], a[136:139], v[116:119]
 global_load_dwordx4 a[216:219], v0, s[70:71] offset:2048 sc1
 v_mfma_f32_16x16x32_bf16 v[120:123], a[224:227], a[144:147], v[120:123]
 s_add_u32 s70, s70, 8192
 s_addc_u32 s71, s71, 0
 v_mfma_f32_16x16x32_bf16 v[120:123], a[228:231], a[148:151], v[120:123]
 v_mfma_f32_16x16x32_bf16 v[124:127], a[228:231], a[156:159], v[124:127]
 s_add_u32 s30, s30, s22
 v_mfma_f32_16x16x32_bf16 v[124:127], a[224:227], a[152:155], v[124:127]
 v_mfma_f32_16x16x32_bf16 v[128:131], a[224:227], a[160:163], v[128:131]
 v_mfma_f32_16x16x32_bf16 v[128:131], a[228:231], a[164:167], v[128:131]
 v_mfma_f32_16x16x32_bf16 v[132:135], a[228:231], a[172:175], v[132:135]
 v_mfma_f32_16x16x32_bf16 v[132:135], a[224:227], a[168:171], v[132:135]
 v_mfma_f32_16x16x32_bf16 a[240:243], a[224:227], a[176:179], a[240:243]
 v_mfma_f32_16x16x32_bf16 a[240:243], a[228:231], a[180:183], a[240:243]
 v_mfma_f32_16x16x32_bf16 a[244:247], a[228:231], a[188:191], a[244:247]
 v_mfma_f32_16x16x32_bf16 a[244:247], a[224:227], a[184:187], a[244:247]
 s_waitcnt vmcnt(8)
 v_mfma_f32_16x16x32_bf16 v[164:167], a[192:195], a[184:187], v[164:167]
 v_mfma_f32_16x16x32_bf16 v[164:167], a[196:199], a[188:191], v[164:167]
 global_load_dwordx4 a[228:231], v0, s[70:71] offset:-3072 sc1
 v_mfma_f32_16x16x32_bf16 v[160:163], a[196:199], a[180:183], v[160:163]
 v_mfma_f32_16x16x32_bf16 v[160:163], a[192:195], a[176:179], v[160:163]
 global_load_dwordx4 a[224:227], v0, s[70:71] offset:-4096 sc1
 v_mfma_f32_16x16x32_bf16 v[156:159], a[192:195], a[168:171], v[156:159]
 v_mfma_f32_16x16x32_bf16 v[156:159], a[196:199], a[172:175], v[156:159]
 global_load_dwordx4 a[236:239], v0, s[70:71] offset:-1024 sc1
 v_mfma_f32_16x16x32_bf16 v[152:155], a[196:199], a[164:167], v[152:155]
 v_mfma_f32_16x16x32_bf16 v[152:155], a[192:195], a[160:163], v[152:155]
 global_load_dwordx4 a[232:235], v0, s[70:71] offset:-2048 sc1
 v_mfma_f32_16x16x32_bf16 v[148:151], a[192:195], a[152:155], v[148:151]
 v_mfma_f32_16x16x32_bf16 v[148:151], a[196:199], a[156:159], v[148:151]
 v_mfma_f32_16x16x32_bf16 v[144:147], a[196:199], a[148:151], v[144:147]
 v_mfma_f32_16x16x32_bf16 v[144:147], a[192:195], a[144:147], v[144:147]
 v_mfma_f32_16x16x32_bf16 v[140:143], a[192:195], a[136:139], v[140:143]
 v_mfma_f32_16x16x32_bf16 v[140:143], a[196:199], a[140:143], v[140:143]
 v_mfma_f32_16x16x32_bf16 v[136:139], a[196:199], a[132:135], v[136:139]
 v_mfma_f32_16x16x32_bf16 v[136:139], a[192:195], a[128:131], v[136:139]
 s_waitcnt vmcnt(10)
 v_mfma_f32_16x16x32_bf16 v[168:171], a[200:203], a[128:131], v[168:171]
 v_mfma_f32_16x16x32_bf16 v[168:171], a[204:207], a[132:135], v[168:171]
 global_load_dwordx4 a[196:199], v0, s[70:71] offset:1024 sc1
 v_mfma_f32_16x16x32_bf16 v[172:175], a[204:207], a[140:143], v[172:175]
 v_mfma_f32_16x16x32_bf16 v[172:175], a[200:203], a[136:139], v[172:175]
 global_load_dwordx4 a[192:195], v0, s[70:71] offset:0 sc1
 v_mfma_f32_16x16x32_bf16 v[176:179], a[200:203], a[144:147], v[176:179]
 v_mfma_f32_16x16x32_bf16 v[176:179], a[204:207], a[148:151], v[176:179]
 v_mfma_f32_16x16x32_bf16 v[180:183], a[204:207], a[156:159], v[180:183]
 v_mfma_f32_16x16x32_bf16 v[180:183], a[200:203], a[152:155], v[180:183]
 v_mfma_f32_16x16x32_bf16 v[184:187], a[200:203], a[160:163], v[184:187]
 v_mfma_f32_16x16x32_bf16 v[184:187], a[204:207], a[164:167], v[184:187]
 v_mfma_f32_16x16x32_bf16 v[188:191], a[204:207], a[172:175], v[188:191]
 v_mfma_f32_16x16x32_bf16 v[188:191], a[200:203], a[168:171], v[188:191]
 v_mfma_f32_16x16x32_bf16 v[192:195], a[200:203], a[176:179], v[192:195]
 v_mfma_f32_16x16x32_bf16 v[192:195], a[204:207], a[180:183], v[192:195]
 v_mfma_f32_16x16x32_bf16 v[196:199], a[204:207], a[188:191], v[196:199]
 v_mfma_f32_16x16x32_bf16 v[196:199], a[200:203], a[184:187], v[196:199]
 s_waitcnt vmcnt(10)
 v_mfma_f32_16x16x32_bf16 v[228:231], a[208:211], a[184:187], v[228:231]
 v_mfma_f32_16x16x32_bf16 v[228:231], a[212:215], a[188:191], v[228:231]
 global_load_dwordx4 a[204:207], v0, s[70:71] offset:3072 sc1
 v_mfma_f32_16x16x32_bf16 v[224:227], a[212:215], a[180:183], v[224:227]
 v_mfma_f32_16x16x32_bf16 v[224:227], a[208:211], a[176:179], v[224:227]
 global_load_dwordx4 a[200:203], v0, s[70:71] offset:2048 sc1
 v_mfma_f32_16x16x32_bf16 v[220:223], a[208:211], a[168:171], v[220:223]
 s_add_u32 s70, s70, 8192
 s_addc_u32 s71, s71, 0
 v_mfma_f32_16x16x32_bf16 v[220:223], a[212:215], a[172:175], v[220:223]
 v_mfma_f32_16x16x32_bf16 v[216:219], a[212:215], a[164:167], v[216:219]
 v_mfma_f32_16x16x32_bf16 v[216:219], a[208:211], a[160:163], v[216:219]
 v_mfma_f32_16x16x32_bf16 v[212:215], a[208:211], a[152:155], v[212:215]
 v_mfma_f32_16x16x32_bf16 v[212:215], a[212:215], a[156:159], v[212:215]
 v_mfma_f32_16x16x32_bf16 v[208:211], a[212:215], a[148:151], v[208:211]
 s_waitcnt vmcnt(10)
 s_waitcnt lgkmcnt(0)
 s_barrier
 v_mfma_f32_16x16x32_bf16 v[208:211], a[208:211], a[144:147], v[208:211]
 v_mfma_f32_16x16x32_bf16 v[204:207], a[208:211], a[136:139], v[204:207]
 v_mfma_f32_16x16x32_bf16 v[204:207], a[212:215], a[140:143], v[204:207]
 v_mfma_f32_16x16x32_bf16 v[200:203], a[212:215], a[132:135], v[200:203]
 v_mfma_f32_16x16x32_bf16 v[200:203], a[208:211], a[128:131], v[200:203]
 s_waitcnt vmcnt(8)
 v_mfma_f32_16x16x32_bf16 v[232:235], a[216:219], a[128:131], v[232:235]
 ds_read_b128 a[128:131], v1 offset:2048
 v_mfma_f32_16x16x32_bf16 v[232:235], a[220:223], a[132:135], v[232:235]
 global_load_dwordx4 a[212:215], v0, s[70:71] offset:-3072 sc1
 ds_read_b128 a[132:135], v1 offset:3072
 v_mfma_f32_16x16x32_bf16 v[236:239], a[220:223], a[140:143], v[236:239]
 ds_read_b128 a[140:143], v1 offset:7168
 v_mfma_f32_16x16x32_bf16 v[236:239], a[216:219], a[136:139], v[236:239]
 global_load_dwordx4 a[208:211], v0, s[70:71] offset:-4096 sc1
 ds_read_b128 a[136:139], v1 offset:6144
 v_mfma_f32_16x16x32_bf16 v[240:243], a[216:219], a[144:147], v[240:243]
 ds_read_b128 a[144:147], v1 offset:10240
 v_mfma_f32_16x16x32_bf16 v[240:243], a[220:223], a[148:151], v[240:243]
 ds_read_b128 a[148:151], v1 offset:11264
 v_mfma_f32_16x16x32_bf16 v[244:247], a[220:223], a[156:159], v[244:247]
 ds_read_b128 a[156:159], v1 offset:15360
 v_mfma_f32_16x16x32_bf16 v[244:247], a[216:219], a[152:155], v[244:247]
 ds_read_b128 a[152:155], v1 offset:14336
 v_mfma_f32_16x16x32_bf16 v[248:251], a[216:219], a[160:163], v[248:251]
 ds_read_b128 a[160:163], v1 offset:18432
 v_mfma_f32_16x16x32_bf16 v[248:251], a[220:223], a[164:167], v[248:251]
 ds_read_b128 a[164:167], v1 offset:19456
 v_mfma_f32_16x16x32_bf16 v[252:255], a[220:223], a[172:175], v[252:255]
 ds_read_b128 a[172:175], v1 offset:23552
 v_mfma_f32_16x16x32_bf16 v[252:255], a[216:219], a[168:171], v[252:255]
 ds_read_b128 a[168:171], v1 offset:22528
 v_mfma_f32_16x16x32_bf16 a[248:251], a[216:219], a[176:179], a[248:251]
 ds_read_b128 a[176:179], v1 offset:26624
 v_mfma_f32_16x16x32_bf16 a[248:251], a[220:223], a[180:183], a[248:251]
 ds_read_b128 a[180:183], v1 offset:27648
 v_mfma_f32_16x16x32_bf16 a[252:255], a[220:223], a[188:191], a[252:255]
 global_load_dwordx4 a[220:223], v0, s[70:71] offset:-1024 sc1
 ds_read_b128 a[188:191], v1 offset:31744
 v_mfma_f32_16x16x32_bf16 a[252:255], a[216:219], a[184:187], a[252:255]
 global_load_dwordx4 a[216:219], v0, s[70:71] offset:-2048 sc1
 ds_read_b128 a[184:187], v1 offset:30720
 s_waitcnt vmcnt(10) lgkmcnt(8)
 v_mfma_f32_16x16x32_bf16 v[16:19], a[224:227], a[128:131], v[16:19]
 v_mov_b32 v7, 1
 v_mfma_f32_16x16x32_bf16 v[16:19], a[228:231], a[132:135], v[16:19]
 v_mfma_f32_16x16x32_bf16 v[20:23], a[228:231], a[140:143], v[20:23]
 buffer_atomic_add v7, v0, s[56:59], 0 offen sc1
 v_mfma_f32_16x16x32_bf16 v[20:23], a[224:227], a[136:139], v[20:23]
 v_bfe_u32 v4, v3, 8, 2
 v_mfma_f32_16x16x32_bf16 v[24:27], a[224:227], a[144:147], v[24:27]
 v_mfma_f32_16x16x32_bf16 v[24:27], a[228:231], a[148:151], v[24:27]
 v_lshl_add_u32 v4, v4, 5, s51
 v_mfma_f32_16x16x32_bf16 v[28:31], a[228:231], a[156:159], v[28:31]
 ds_read_b128 v[8:11], v4 offset:256
 v_mfma_f32_16x16x32_bf16 v[28:31], a[224:227], a[152:155], v[28:31]
 s_waitcnt lgkmcnt(1)
 v_mfma_f32_16x16x32_bf16 v[32:35], a[224:227], a[160:163], v[32:35]
 v_mfma_f32_16x16x32_bf16 v[32:35], a[228:231], a[164:167], v[32:35]
 v_mfma_f32_16x16x32_bf16 v[36:39], a[228:231], a[172:175], v[36:39]
 v_mfma_f32_16x16x32_bf16 v[36:39], a[224:227], a[168:171], v[36:39]
 v_mfma_f32_16x16x32_bf16 v[40:43], a[224:227], a[176:179], v[40:43]
 v_mfma_f32_16x16x32_bf16 v[40:43], a[228:231], a[180:183], v[40:43]
 v_mfma_f32_16x16x32_bf16 v[44:47], a[228:231], a[188:191], v[44:47]
 v_mfma_f32_16x16x32_bf16 v[44:47], a[224:227], a[184:187], v[44:47]
 s_waitcnt vmcnt(9)
 v_mfma_f32_16x16x32_bf16 v[76:79], a[232:235], a[184:187], v[76:79]
 v_mfma_f32_16x16x32_bf16 v[76:79], a[236:239], a[188:191], v[76:79]
 global_load_dwordx4 a[228:231], v0, s[70:71] offset:1024 sc1
 v_mfma_f32_16x16x32_bf16 v[72:75], a[236:239], a[180:183], v[72:75]
 v_mfma_f32_16x16x32_bf16 v[72:75], a[232:235], a[176:179], v[72:75]
 global_load_dwordx4 a[224:227], v0, s[70:71] offset:0 sc1
 v_mfma_f32_16x16x32_bf16 v[68:71], a[232:235], a[168:171], v[68:71]
 s_waitcnt lgkmcnt(0)
 v_mfma_f32_16x16x32_bf16 v[68:71], a[236:239], a[172:175], v[68:71]
 v_mfma_f32_16x16x32_bf16 v[64:67], a[236:239], a[164:167], v[64:67]
 v_add_f32 v136, v136, v8
 v_mfma_f32_16x16x32_bf16 v[64:67], a[232:235], a[160:163], v[64:67]
 v_mfma_f32_16x16x32_bf16 v[60:63], a[232:235], a[152:155], v[60:63]
 ds_read_b128 v[12:15], v4 offset:272
 v_mfma_f32_16x16x32_bf16 v[60:63], a[236:239], a[156:159], v[60:63]
 v_add_f32 v137, v137, v9
 v_mfma_f32_16x16x32_bf16 v[56:59], a[236:239], a[148:151], v[56:59]
 v_mfma_f32_16x16x32_bf16 v[56:59], a[232:235], a[144:147], v[56:59]
 v_add_f32 v138, v138, v10
 v_mfma_f32_16x16x32_bf16 v[52:55], a[232:235], a[136:139], v[52:55]
 v_add_f32 v139, v139, v11
 v_mfma_f32_16x16x32_bf16 v[52:55], a[236:239], a[140:143], v[52:55]
 v_mfma_f32_16x16x32_bf16 v[48:51], a[236:239], a[132:135], v[48:51]
 v_add_f32 v140, v140, v8
 v_mfma_f32_16x16x32_bf16 v[48:51], a[232:235], a[128:131], v[48:51]
 v_add_f32 v141, v141, v9
 s_waitcnt vmcnt(9)
 v_mfma_f32_16x16x32_bf16 v[80:83], a[192:195], a[128:131], v[80:83]
 v_mfma_f32_16x16x32_bf16 v[80:83], a[196:199], a[132:135], v[80:83]
 global_load_dwordx4 a[236:239], v0, s[70:71] offset:3072 sc1
 v_add_f32 v142, v142, v10
 v_mfma_f32_16x16x32_bf16 v[84:87], a[196:199], a[140:143], v[84:87]
 v_add_f32 v143, v143, v11
 v_mfma_f32_16x16x32_bf16 v[84:87], a[192:195], a[136:139], v[84:87]
 global_load_dwordx4 a[232:235], v0, s[70:71] offset:2048 sc1
 v_mfma_f32_16x16x32_bf16 v[88:91], a[192:195], a[144:147], v[88:91]
 v_add_f32 v144, v144, v8
 s_add_u32 s70, s70, 8192
 s_addc_u32 s71, s71, 0
 v_mfma_f32_16x16x32_bf16 v[88:91], a[196:199], a[148:151], v[88:91]
 v_mfma_f32_16x16x32_bf16 v[92:95], a[196:199], a[156:159], v[92:95]
 v_add_f32 v145, v145, v9
 v_mfma_f32_16x16x32_bf16 v[92:95], a[192:195], a[152:155], v[92:95]
 v_add_f32 v146, v146, v10
 v_mfma_f32_16x16x32_bf16 v[96:99], a[192:195], a[160:163], v[96:99]
 v_mfma_f32_16x16x32_bf16 v[96:99], a[196:199], a[164:167], v[96:99]
 v_add_f32 v147, v147, v11
 v_mfma_f32_16x16x32_bf16 v[100:103], a[196:199], a[172:175], v[100:103]
 v_add_f32 v148, v148, v8
 v_mfma_f32_16x16x32_bf16 v[100:103], a[192:195], a[168:171], v[100:103]
 v_mfma_f32_16x16x32_bf16 v[104:107], a[192:195], a[176:179], v[104:107]
 v_add_f32 v149, v149, v9
 v_mfma_f32_16x16x32_bf16 v[104:107], a[196:199], a[180:183], v[104:107]
 v_add_f32 v150, v150, v10
 v_mfma_f32_16x16x32_bf16 v[108:111], a[196:199], a[188:191], v[108:111]
 v_mfma_f32_16x16x32_bf16 v[108:111], a[192:195], a[184:187], v[108:111]
 v_add_f32 v151, v151, v11
 s_waitcnt vmcnt(9)
 v_mfma_f32_16x16x32_bf16 a[244:247], a[200:203], a[184:187], a[244:247]
 ds_read_b128 a[184:187], v1 offset:63488
 v_add_f32 v152, v152, v8
 v_mfma_f32_16x16x32_bf16 a[244:247], a[204:207], a[188:191], a[244:247]
 global_load_dwordx4 a[196:199], v0, s[70:71] offset:-3072 sc1
 ds_read_b128 a[188:191], v1 offset:64512
 v_mfma_f32_16x16x32_bf16 a[240:243], a[204:207], a[180:183], a[240:243]
 ds_read_b128 a[180:183], v1 offset:60416
 v_add_f32 v153, v153, v9
 v_mfma_f32_16x16x32_bf16 a[240:243], a[200:203], a[176:179], a[240:243]
 global_load_dwordx4 a[192:195], v0, s[70:71] offset:-4096 sc1
 ds_read_b128 a[176:179], v1 offset:59392
 v_mfma_f32_16x16x32_bf16 v[132:135], a[200:203], a[168:171], v[132:135]
 ds_read_b128 a[168:171], v1 offset:55296
 v_add_f32 v154, v154, v10
 v_mfma_f32_16x16x32_bf16 v[132:135], a[204:207], a[172:175], v[132:135]
 ds_read_b128 a[172:175], v1 offset:56320
 v_add_f32 v155, v155, v11
 v_mfma_f32_16x16x32_bf16 v[128:131], a[204:207], a[164:167], v[128:131]
 ds_read_b128 a[164:167], v1 offset:52224
 v_mfma_f32_16x16x32_bf16 v[128:131], a[200:203], a[160:163], v[128:131]
 ds_read_b128 a[160:163], v1 offset:51200
 v_add_f32 v156, v156, v8
 v_mfma_f32_16x16x32_bf16 v[124:127], a[200:203], a[152:155], v[124:127]
 ds_read_b128 a[152:155], v1 offset:47104
 v_add_f32 v157, v157, v9
 v_mfma_f32_16x16x32_bf16 v[124:127], a[204:207], a[156:159], v[124:127]
 ds_read_b128 a[156:159], v1 offset:48128
 v_mfma_f32_16x16x32_bf16 v[120:123], a[204:207], a[148:151], v[120:123]
 ds_read_b128 a[148:151], v1 offset:44032
 v_add_f32 v158, v158, v10
 v_mfma_f32_16x16x32_bf16 v[120:123], a[200:203], a[144:147], v[120:123]
 ds_read_b128 a[144:147], v1 offset:43008
 v_add_f32 v159, v159, v11
 v_mfma_f32_16x16x32_bf16 v[116:119], a[200:203], a[136:139], v[116:119]
 ds_read_b128 a[136:139], v1 offset:38912
 v_mfma_f32_16x16x32_bf16 v[116:119], a[204:207], a[140:143], v[116:119]
 ds_read_b128 a[140:143], v1 offset:39936
 v_add_f32 v160, v160, v8
 v_mfma_f32_16x16x32_bf16 v[112:115], a[204:207], a[132:135], v[112:115]
 ds_read_b128 a[132:135], v1 offset:35840
 v_add_f32 v161, v161, v9
 v_mfma_f32_16x16x32_bf16 v[112:115], a[200:203], a[128:131], v[112:115]
 ds_read_b128 a[128:131], v1 offset:34816
 s_waitcnt vmcnt(9) lgkmcnt(8)
 v_mfma_f32_16x16x32_bf16 v[44:47], a[208:211], a[184:187], v[44:47]
 v_add_f32 v162, v162, v10
 v_mfma_f32_16x16x32_bf16 v[44:47], a[212:215], a[188:191], v[44:47]
 global_load_dwordx4 a[204:207], v0, s[70:71] offset:-1024 sc1
 v_mfma_f32_16x16x32_bf16 v[40:43], a[212:215], a[180:183], v[40:43]
 v_add_f32 v163, v163, v11
 v_mfma_f32_16x16x32_bf16 v[40:43], a[208:211], a[176:179], v[40:43]
 global_load_dwordx4 a[200:203], v0, s[70:71] offset:-2048 sc1
 v_add_f32 v164, v164, v8
 v_mfma_f32_16x16x32_bf16 v[36:39], a[208:211], a[168:171], v[36:39]
 v_mfma_f32_16x16x32_bf16 v[36:39], a[212:215], a[172:175], v[36:39]
 v_add_f32 v165, v165, v9
 v_mfma_f32_16x16x32_bf16 v[32:35], a[212:215], a[164:167], v[32:35]
 v_add_f32 v166, v166, v10
 v_mfma_f32_16x16x32_bf16 v[32:35], a[208:211], a[160:163], v[32:35]
 s_waitcnt lgkmcnt(0)
 v_mfma_f32_16x16x32_bf16 v[28:31], a[208:211], a[152:155], v[28:31]
 v_add_f32 v167, v167, v11
 v_mfma_f32_16x16x32_bf16 v[28:31], a[212:215], a[156:159], v[28:31]
 v_mfma_f32_16x16x32_bf16 v[24:27], a[212:215], a[148:151], v[24:27]
 v_mfma_f32_16x16x32_bf16 v[24:27], a[208:211], a[144:147], v[24:27]
 v_add_f32 v168, v168, v12
 v_mfma_f32_16x16x32_bf16 v[20:23], a[208:211], a[136:139], v[20:23]
 ds_read_b128 v[8:11], v4 offset:384
 v_mfma_f32_16x16x32_bf16 v[20:23], a[212:215], a[140:143], v[20:23]
 v_mfma_f32_16x16x32_bf16 v[16:19], a[212:215], a[132:135], v[16:19]
 v_add_f32 v169, v169, v13
 v_mfma_f32_16x16x32_bf16 v[16:19], a[208:211], a[128:131], v[16:19]
 s_waitcnt vmcnt(9)
 v_mfma_f32_16x16x32_bf16 v[48:51], a[216:219], a[128:131], v[48:51]
 v_add_f32 v170, v170, v14
 v_mfma_f32_16x16x32_bf16 v[48:51], a[220:223], a[132:135], v[48:51]
 global_load_dwordx4 a[212:215], v0, s[70:71] offset:1024 sc1
 v_add_f32 v171, v171, v15
 v_mfma_f32_16x16x32_bf16 v[52:55], a[220:223], a[140:143], v[52:55]
 v_mfma_f32_16x16x32_bf16 v[52:55], a[216:219], a[136:139], v[52:55]
 global_load_dwordx4 a[208:211], v0, s[70:71] offset:0 sc1
 v_add_f32 v172, v172, v12
 v_mfma_f32_16x16x32_bf16 v[56:59], a[216:219], a[144:147], v[56:59]
 v_add_f32 v173, v173, v13
 v_mfma_f32_16x16x32_bf16 v[56:59], a[220:223], a[148:151], v[56:59]
 v_mfma_f32_16x16x32_bf16 v[60:63], a[220:223], a[156:159], v[60:63]
 v_add_f32 v174, v174, v14
 v_mfma_f32_16x16x32_bf16 v[60:63], a[216:219], a[152:155], v[60:63]
 v_add_f32 v175, v175, v15
 v_mfma_f32_16x16x32_bf16 v[64:67], a[216:219], a[160:163], v[64:67]
 v_mfma_f32_16x16x32_bf16 v[64:67], a[220:223], a[164:167], v[64:67]
 v_add_f32 v176, v176, v12
 v_mfma_f32_16x16x32_bf16 v[68:71], a[220:223], a[172:175], v[68:71]
 v_add_f32 v177, v177, v13
 v_mfma_f32_16x16x32_bf16 v[68:71], a[216:219], a[168:171], v[68:71]
 v_mfma_f32_16x16x32_bf16 v[72:75], a[216:219], a[176:179], v[72:75]
 v_add_f32 v178, v178, v14
 v_mfma_f32_16x16x32_bf16 v[72:75], a[220:223], a[180:183], v[72:75]
 v_mfma_f32_16x16x32_bf16 v[76:79], a[220:223], a[188:191], v[76:79]
 v_add_f32 v179, v179, v15
 v_mfma_f32_16x16x32_bf16 v[76:79], a[216:219], a[184:187], v[76:79]
 v_add_f32 v180, v180, v12
 s_waitcnt vmcnt(8)
 v_mfma_f32_16x16x32_bf16 v[108:111], a[224:227], a[184:187], v[108:111]
 v_mfma_f32_16x16x32_bf16 v[108:111], a[228:231], a[188:191], v[108:111]
 global_load_dwordx4 a[220:223], v0, s[70:71] offset:3072 sc1
 v_add_f32 v181, v181, v13
 v_mfma_f32_16x16x32_bf16 v[104:107], a[228:231], a[180:183], v[104:107]
 v_add_f32 v182, v182, v14
 v_mfma_f32_16x16x32_bf16 v[104:107], a[224:227], a[176:179], v[104:107]
 global_load_dwordx4 a[216:219], v0, s[70:71] offset:2048 sc1
 v_mfma_f32_16x16x32_bf16 v[100:103], a[224:227], a[168:171], v[100:103]
 v_add_f32 v183, v183, v15
 s_add_u32 s70, s70, 8192
 s_addc_u32 s71, s71, 0
 v_mfma_f32_16x16x32_bf16 v[100:103], a[228:231], a[172:175], v[100:103]
 v_add_f32 v184, v184, v12
 v_mfma_f32_16x16x32_bf16 v[96:99], a[228:231], a[164:167], v[96:99]
 v_mfma_f32_16x16x32_bf16 v[96:99], a[224:227], a[160:163], v[96:99]
 v_add_f32 v185, v185, v13
 v_mfma_f32_16x16x32_bf16 v[92:95], a[224:227], a[152:155], v[92:95]
 v_add_f32 v186, v186, v14
 v_mfma_f32_16x16x32_bf16 v[92:95], a[228:231], a[156:159], v[92:95]
 v_mfma_f32_16x16x32_bf16 v[88:91], a[228:231], a[148:151], v[88:91]
 v_add_f32 v187, v187, v15
 v_mfma_f32_16x16x32_bf16 v[88:91], a[224:227], a[144:147], v[88:91]
 v_mfma_f32_16x16x32_bf16 v[84:87], a[224:227], a[136:139], v[84:87]
 v_add_f32 v188, v188, v12
 v_mfma_f32_16x16x32_bf16 v[84:87], a[228:231], a[140:143], v[84:87]
 v_add_f32 v189, v189, v13
 v_mfma_f32_16x16x32_bf16 v[80:83], a[228:231], a[132:135], v[80:83]
 v_mfma_f32_16x16x32_bf16 v[80:83], a[224:227], a[128:131], v[80:83]
 v_add_f32 v190, v190, v14
 s_waitcnt vmcnt(8)
 v_mfma_f32_16x16x32_bf16 v[112:115], a[232:235], a[128:131], v[112:115]
 ds_read_b128 a[128:131], v2 offset:2048
 v_add_f32 v191, v191, v15
 v_mfma_f32_16x16x32_bf16 v[112:115], a[236:239], a[132:135], v[112:115]
 global_load_dwordx4 a[228:231], v0, s[70:71] offset:-3072 sc1
 ds_read_b128 a[132:135], v2 offset:3072
 v_mfma_f32_16x16x32_bf16 v[116:119], a[236:239], a[140:143], v[116:119]
 ds_read_b128 a[140:143], v2 offset:7168
 v_add_f32 v192, v192, v12
 v_mfma_f32_16x16x32_bf16 v[116:119], a[232:235], a[136:139], v[116:119]
 global_load_dwordx4 a[224:227], v0, s[70:71] offset:-4096 sc1
 ds_read_b128 a[136:139], v2 offset:6144
 v_mfma_f32_16x16x32_bf16 v[120:123], a[232:235], a[144:147], v[120:123]
 ds_read_b128 a[144:147], v2 offset:10240
 v_add_f32 v193, v193, v13
 v_mfma_f32_16x16x32_bf16 v[120:123], a[236:239], a[148:151], v[120:123]
 ds_read_b128 a[148:151], v2 offset:11264
 v_add_f32 v194, v194, v14
 v_mfma_f32_16x16x32_bf16 v[124:127], a[236:239], a[156:159], v[124:127]
 ds_read_b128 a[156:159], v2 offset:15360
 v_add_f32 v195, v195, v15
 v_mfma_f32_16x16x32_bf16 v[124:127], a[232:235], a[152:155], v[124:127]
 ds_read_b128 a[152:155], v2 offset:14336
 v_mfma_f32_16x16x32_bf16 v[128:131], a[232:235], a[160:163], v[128:131]
 ds_read_b128 a[160:163], v2 offset:18432
 v_add_f32 v196, v196, v12
 v_mfma_f32_16x16x32_bf16 v[128:131], a[236:239], a[164:167], v[128:131]
 ds_read_b128 a[164:167], v2 offset:19456
 v_mfma_f32_16x16x32_bf16 v[132:135], a[236:239], a[172:175], v[132:135]
 ds_read_b128 a[172:175], v2 offset:23552
 v_add_f32 v197, v197, v13
 v_mfma_f32_16x16x32_bf16 v[132:135], a[232:235], a[168:171], v[132:135]
 ds_read_b128 a[168:171], v2 offset:22528
 v_add_f32 v198, v198, v14
 v_mfma_f32_16x16x32_bf16 a[240:243], a[232:235], a[176:179], a[240:243]
 ds_read_b128 a[176:179], v2 offset:26624
 v_mfma_f32_16x16x32_bf16 a[240:243], a[236:239], a[180:183], a[240:243]
 ds_read_b128 a[180:183], v2 offset:27648
 v_add_f32 v199, v199, v15
 v_mfma_f32_16x16x32_bf16 a[244:247], a[236:239], a[188:191], a[244:247]
 ds_read_b128 a[188:191], v2 offset:31744
 s_waitcnt lgkmcnt(15)
 v_mfma_f32_16x16x32_bf16 a[244:247], a[232:235], a[184:187], a[244:247]
 ds_read_b128 a[184:187], v2 offset:30720
 s_waitcnt vmcnt(8) lgkmcnt(8)
 v_mfma_f32_16x16x32_bf16 v[16:19], a[192:195], a[128:131], v[16:19]
 v_add_f32 v200, v200, v8
 v_mfma_f32_16x16x32_bf16 v[16:19], a[196:199], a[132:135], v[16:19]
 global_load_dwordx4 a[236:239], v0, s[70:71] offset:-1024 sc1
 ds_read_b128 v[12:15], v4 offset:400
 v_mfma_f32_16x16x32_bf16 v[20:23], a[196:199], a[140:143], v[20:23]
 v_mfma_f32_16x16x32_bf16 v[20:23], a[192:195], a[136:139], v[20:23]
 global_load_dwordx4 a[232:235], v0, s[70:71] offset:-2048 sc1
 v_add_f32 v201, v201, v9
 v_mfma_f32_16x16x32_bf16 v[24:27], a[192:195], a[144:147], v[24:27]
 v_add_f32 v202, v202, v10
 v_mfma_f32_16x16x32_bf16 v[24:27], a[196:199], a[148:151], v[24:27]
 v_mfma_f32_16x16x32_bf16 v[28:31], a[196:199], a[156:159], v[28:31]
 v_add_f32 v203, v203, v11
 v_mfma_f32_16x16x32_bf16 v[28:31], a[192:195], a[152:155], v[28:31]
 s_waitcnt lgkmcnt(1)
 v_mfma_f32_16x16x32_bf16 v[32:35], a[192:195], a[160:163], v[32:35]
 v_add_f32 v204, v204, v8
 v_mfma_f32_16x16x32_bf16 v[32:35], a[196:199], a[164:167], v[32:35]
 v_add_f32 v205, v205, v9
 v_mfma_f32_16x16x32_bf16 v[36:39], a[196:199], a[172:175], v[36:39]
 v_mfma_f32_16x16x32_bf16 v[36:39], a[192:195], a[168:171], v[36:39]
 v_add_f32 v206, v206, v10
 v_mfma_f32_16x16x32_bf16 v[40:43], a[192:195], a[176:179], v[40:43]
 v_add_f32 v207, v207, v11
 v_mfma_f32_16x16x32_bf16 v[40:43], a[196:199], a[180:183], v[40:43]
 v_mfma_f32_16x16x32_bf16 v[44:47], a[196:199], a[188:191], v[44:47]
 v_add_f32 v208, v208, v8
 v_mfma_f32_16x16x32_bf16 v[44:47], a[192:195], a[184:187], v[44:47]
 v_add_f32 v209, v209, v9
 s_waitcnt vmcnt(8)
 v_mfma_f32_16x16x32_bf16 v[76:79], a[200:203], a[184:187], v[76:79]
 v_mfma_f32_16x16x32_bf16 v[76:79], a[204:207], a[188:191], v[76:79]
 global_load_dwordx4 a[196:199], v0, s[70:71] offset:1024 sc1
 v_add_f32 v210, v210, v10
 v_mfma_f32_16x16x32_bf16 v[72:75], a[204:207], a[180:183], v[72:75]
 v_add_f32 v211, v211, v11
 v_mfma_f32_16x16x32_bf16 v[72:75], a[200:203], a[176:179], v[72:75]
 global_load_dwordx4 a[192:195], v0, s[70:71] offset:0 sc1
 v_mfma_f32_16x16x32_bf16 v[68:71], a[200:203], a[168:171], v[68:71]
 v_add_f32 v212, v212, v8
 v_mfma_f32_16x16x32_bf16 v[68:71], a[204:207], a[172:175], v[68:71]
 v_mfma_f32_16x16x32_bf16 v[64:67], a[204:207], a[164:167], v[64:67]
 v_add_f32 v213, v213, v9
 v_mfma_f32_16x16x32_bf16 v[64:67], a[200:203], a[160:163], v[64:67]
 v_add_f32 v214, v214, v10
 v_mfma_f32_16x16x32_bf16 v[60:63], a[200:203], a[152:155], v[60:63]
 v_mfma_f32_16x16x32_bf16 v[60:63], a[204:207], a[156:159], v[60:63]
 v_add_f32 v215, v215, v11
 v_mfma_f32_16x16x32_bf16 v[56:59], a[204:207], a[148:151], v[56:59]
 v_add_f32 v216, v216, v8
 v_mfma_f32_16x16x32_bf16 v[56:59], a[200:203], a[144:147], v[56:59]
 v_mfma_f32_16x16x32_bf16 v[52:55], a[200:203], a[136:139], v[52:55]
 v_add_f32 v217, v217, v9
 v_mfma_f32_16x16x32_bf16 v[52:55], a[204:207], a[140:143], v[52:55]
 v_add_f32 v218, v218, v10
 v_mfma_f32_16x16x32_bf16 v[48:51], a[204:207], a[132:135], v[48:51]
 v_mfma_f32_16x16x32_bf16 v[48:51], a[200:203], a[128:131], v[48:51]
 v_add_f32 v219, v219, v11
 s_waitcnt vmcnt(8)
 v_mfma_f32_16x16x32_bf16 v[80:83], a[208:211], a[128:131], v[80:83]
 v_add_f32 v220, v220, v8
 v_mfma_f32_16x16x32_bf16 v[80:83], a[212:215], a[132:135], v[80:83]
 global_load_dwordx4 a[204:207], v0, s[70:71] offset:3072 sc1
 v_mfma_f32_16x16x32_bf16 v[84:87], a[212:215], a[140:143], v[84:87]
 v_add_f32 v221, v221, v9
 v_mfma_f32_16x16x32_bf16 v[84:87], a[208:211], a[136:139], v[84:87]
 global_load_dwordx4 a[200:203], v0, s[70:71] offset:2048 sc1
 v_mfma_f32_16x16x32_bf16 v[88:91], a[208:211], a[144:147], v[88:91]
 v_add_f32 v222, v222, v10
 s_add_u32 s70, s70, 8192
 s_addc_u32 s71, s71, 0
 v_mfma_f32_16x16x32_bf16 v[88:91], a[212:215], a[148:151], v[88:91]
 v_add_f32 v223, v223, v11
 v_mfma_f32_16x16x32_bf16 v[92:95], a[212:215], a[156:159], v[92:95]
 v_mfma_f32_16x16x32_bf16 v[92:95], a[208:211], a[152:155], v[92:95]
 v_add_f32 v224, v224, v8
 v_mfma_f32_16x16x32_bf16 v[96:99], a[208:211], a[160:163], v[96:99]
 v_add_f32 v225, v225, v9
 v_mfma_f32_16x16x32_bf16 v[96:99], a[212:215], a[164:167], v[96:99]
 v_mfma_f32_16x16x32_bf16 v[100:103], a[212:215], a[172:175], v[100:103]
 v_add_f32 v226, v226, v10
 v_mfma_f32_16x16x32_bf16 v[100:103], a[208:211], a[168:171], v[100:103]
 v_add_f32 v227, v227, v11
 v_mfma_f32_16x16x32_bf16 v[104:107], a[208:211], a[176:179], v[104:107]
 v_mfma_f32_16x16x32_bf16 v[104:107], a[212:215], a[180:183], v[104:107]
 v_add_f32 v228, v228, v8
 v_mfma_f32_16x16x32_bf16 v[108:111], a[212:215], a[188:191], v[108:111]
 v_add_f32 v229, v229, v9
 v_mfma_f32_16x16x32_bf16 v[108:111], a[208:211], a[184:187], v[108:111]
 s_waitcnt vmcnt(8)
 v_mfma_f32_16x16x32_bf16 a[244:247], a[216:219], a[184:187], a[244:247]
 ds_read_b128 a[184:187], v2 offset:63488
 v_add_f32 v230, v230, v10
 v_mfma_f32_16x16x32_bf16 a[244:247], a[220:223], a[188:191], a[244:247]
 global_load_dwordx4 a[212:215], v0, s[70:71] offset:-3072 sc1
 ds_read_b128 a[188:191], v2 offset:64512
 v_mfma_f32_16x16x32_bf16 a[240:243], a[220:223], a[180:183], a[240:243]
 ds_read_b128 a[180:183], v2 offset:60416
 v_add_f32 v231, v231, v11
 v_mfma_f32_16x16x32_bf16 a[240:243], a[216:219], a[176:179], a[240:243]
 global_load_dwordx4 a[208:211], v0, s[70:71] offset:-4096 sc1
 ds_read_b128 a[176:179], v2 offset:59392
 s_waitcnt lgkmcnt(4)
 v_mfma_f32_16x16x32_bf16 v[132:135], a[216:219], a[168:171], v[132:135]
 ds_read_b128 a[168:171], v2 offset:55296
 v_mfma_f32_16x16x32_bf16 v[132:135], a[220:223], a[172:175], v[132:135]
 ds_read_b128 a[172:175], v2 offset:56320
 v_add_f32 v232, v232, v12
 v_mfma_f32_16x16x32_bf16 v[128:131], a[220:223], a[164:167], v[128:131]
 ds_read_b128 a[164:167], v2 offset:52224
 v_add_f32 v233, v233, v13
 v_mfma_f32_16x16x32_bf16 v[128:131], a[216:219], a[160:163], v[128:131]
 ds_read_b128 a[160:163], v2 offset:51200
 v_mfma_f32_16x16x32_bf16 v[124:127], a[216:219], a[152:155], v[124:127]
 ds_read_b128 a[152:155], v2 offset:47104
 v_add_f32 v234, v234, v14
 v_mfma_f32_16x16x32_bf16 v[124:127], a[220:223], a[156:159], v[124:127]
 ds_read_b128 a[156:159], v2 offset:48128
 v_add_f32 v235, v235, v15
 v_mfma_f32_16x16x32_bf16 v[120:123], a[220:223], a[148:151], v[120:123]
 ds_read_b128 a[148:151], v2 offset:44032
 v_mfma_f32_16x16x32_bf16 v[120:123], a[216:219], a[144:147], v[120:123]
 ds_read_b128 a[144:147], v2 offset:43008
 v_add_f32 v236, v236, v12
 v_mfma_f32_16x16x32_bf16 v[116:119], a[216:219], a[136:139], v[116:119]
 ds_read_b128 a[136:139], v2 offset:38912
 v_add_f32 v237, v237, v13
 v_mfma_f32_16x16x32_bf16 v[116:119], a[220:223], a[140:143], v[116:119]
 ds_read_b128 a[140:143], v2 offset:39936
 v_mfma_f32_16x16x32_bf16 v[112:115], a[220:223], a[132:135], v[112:115]
 ds_read_b128 a[132:135], v2 offset:35840
 v_add_f32 v238, v238, v14
 v_mfma_f32_16x16x32_bf16 v[112:115], a[216:219], a[128:131], v[112:115]
 ds_read_b128 a[128:131], v2 offset:34816
 s_waitcnt vmcnt(8) lgkmcnt(8)
 v_mfma_f32_16x16x32_bf16 v[44:47], a[224:227], a[184:187], v[44:47]
 v_add_f32 v239, v239, v15
 v_mfma_f32_16x16x32_bf16 v[44:47], a[228:231], a[188:191], v[44:47]
 global_load_dwordx4 a[220:223], v0, s[70:71] offset:-1024 sc1
 v_add_f32 v240, v240, v12
 v_mfma_f32_16x16x32_bf16 v[40:43], a[228:231], a[180:183], v[40:43]
 v_mfma_f32_16x16x32_bf16 v[40:43], a[224:227], a[176:179], v[40:43]
 global_load_dwordx4 a[216:219], v0, s[70:71] offset:-2048 sc1
 v_add_f32 v241, v241, v13
 v_mfma_f32_16x16x32_bf16 v[36:39], a[224:227], a[168:171], v[36:39]
 v_add_f32 v242, v242, v14
 v_mfma_f32_16x16x32_bf16 v[36:39], a[228:231], a[172:175], v[36:39]
 v_mfma_f32_16x16x32_bf16 v[32:35], a[228:231], a[164:167], v[32:35]
 v_add_f32 v243, v243, v15
 v_mfma_f32_16x16x32_bf16 v[32:35], a[224:227], a[160:163], v[32:35]
 v_add_f32 v244, v244, v12
 s_waitcnt lgkmcnt(0)
 v_mfma_f32_16x16x32_bf16 v[28:31], a[224:227], a[152:155], v[28:31]
 v_mfma_f32_16x16x32_bf16 v[28:31], a[228:231], a[156:159], v[28:31]
 v_add_f32 v245, v245, v13
 v_mfma_f32_16x16x32_bf16 v[24:27], a[228:231], a[148:151], v[24:27]
 v_add_f32 v246, v246, v14
 v_mfma_f32_16x16x32_bf16 v[24:27], a[224:227], a[144:147], v[24:27]
 v_mfma_f32_16x16x32_bf16 v[20:23], a[224:227], a[136:139], v[20:23]
 v_add_f32 v247, v247, v15
 v_mfma_f32_16x16x32_bf16 v[20:23], a[228:231], a[140:143], v[20:23]
 v_mfma_f32_16x16x32_bf16 v[16:19], a[228:231], a[132:135], v[16:19]
 v_add_f32 v248, v248, v12
 v_mfma_f32_16x16x32_bf16 v[16:19], a[224:227], a[128:131], v[16:19]
 v_add_f32 v249, v249, v13
 s_waitcnt vmcnt(8)
 v_mfma_f32_16x16x32_bf16 v[48:51], a[232:235], a[128:131], v[48:51]
 v_mfma_f32_16x16x32_bf16 v[48:51], a[236:239], a[132:135], v[48:51]
 global_load_dwordx4 a[228:231], v0, s[70:71] offset:1024 sc1
 v_add_f32 v250, v250, v14
 v_mfma_f32_16x16x32_bf16 v[52:55], a[236:239], a[140:143], v[52:55]
 v_add_f32 v251, v251, v15
 v_mfma_f32_16x16x32_bf16 v[52:55], a[232:235], a[136:139], v[52:55]
 global_load_dwordx4 a[224:227], v0, s[70:71] offset:0 sc1
 v_mfma_f32_16x16x32_bf16 v[56:59], a[232:235], a[144:147], v[56:59]
 v_add_f32 v252, v252, v12
 v_mfma_f32_16x16x32_bf16 v[56:59], a[236:239], a[148:151], v[56:59]
 v_add_f32 v253, v253, v13
 v_mfma_f32_16x16x32_bf16 v[60:63], a[236:239], a[156:159], v[60:63]
 v_mfma_f32_16x16x32_bf16 v[60:63], a[232:235], a[152:155], v[60:63]
 v_add_f32 v254, v254, v14
 v_mfma_f32_16x16x32_bf16 v[64:67], a[232:235], a[160:163], v[64:67]
 v_add_f32 v255, v255, v15
 v_mfma_f32_16x16x32_bf16 v[64:67], a[236:239], a[164:167], v[64:67]
 v_mfma_f32_16x16x32_bf16 v[68:71], a[236:239], a[172:175], v[68:71]
 v_accvgpr_read_b32 v5, a248
 v_mfma_f32_16x16x32_bf16 v[68:71], a[232:235], a[168:171], v[68:71]
 v_mfma_f32_16x16x32_bf16 v[72:75], a[232:235], a[176:179], v[72:75]
 v_add_f32 v5, v5, v12
 v_mfma_f32_16x16x32_bf16 v[72:75], a[236:239], a[180:183], v[72:75]
 v_accvgpr_write_b32 a248, v5
 v_mfma_f32_16x16x32_bf16 v[76:79], a[236:239], a[188:191], v[76:79]
 v_mfma_f32_16x16x32_bf16 v[76:79], a[232:235], a[184:187], v[76:79]
 v_accvgpr_read_b32 v6, a249
 s_waitcnt vmcnt(8)
 v_mfma_f32_16x16x32_bf16 v[108:111], a[192:195], a[184:187], v[108:111]
 v_add_f32 v6, v6, v13
 v_mfma_f32_16x16x32_bf16 v[108:111], a[196:199], a[188:191], v[108:111]
 global_load_dwordx4 a[236:239], v0, s[70:71] offset:3072 sc1
 v_mfma_f32_16x16x32_bf16 v[104:107], a[196:199], a[180:183], v[104:107]
 v_accvgpr_write_b32 a249, v6
 v_mfma_f32_16x16x32_bf16 v[104:107], a[192:195], a[176:179], v[104:107]
 global_load_dwordx4 a[232:235], v0, s[70:71] offset:2048 sc1
 v_accvgpr_read_b32 v5, a250
 v_mfma_f32_16x16x32_bf16 v[100:103], a[192:195], a[168:171], v[100:103]
 s_add_u32 s70, s70, 8192
 s_addc_u32 s71, s71, 0
 v_mfma_f32_16x16x32_bf16 v[100:103], a[196:199], a[172:175], v[100:103]
 v_add_f32 v5, v5, v14
 v_mfma_f32_16x16x32_bf16 v[96:99], a[196:199], a[164:167], v[96:99]
 v_accvgpr_write_b32 a250, v5
 v_mfma_f32_16x16x32_bf16 v[96:99], a[192:195], a[160:163], v[96:99]
 v_mfma_f32_16x16x32_bf16 v[92:95], a[192:195], a[152:155], v[92:95]
 v_accvgpr_read_b32 v6, a251
 v_mfma_f32_16x16x32_bf16 v[92:95], a[196:199], a[156:159], v[92:95]
 v_mfma_f32_16x16x32_bf16 v[88:91], a[196:199], a[148:151], v[88:91]
 v_add_f32 v6, v6, v15
 v_mfma_f32_16x16x32_bf16 v[88:91], a[192:195], a[144:147], v[88:91]
 v_accvgpr_write_b32 a251, v6
 v_mfma_f32_16x16x32_bf16 v[84:87], a[192:195], a[136:139], v[84:87]
 v_mfma_f32_16x16x32_bf16 v[84:87], a[196:199], a[140:143], v[84:87]
 v_accvgpr_read_b32 v5, a252
 v_mfma_f32_16x16x32_bf16 v[80:83], a[196:199], a[132:135], v[80:83]
 v_add_f32 v5, v5, v12
 v_mfma_f32_16x16x32_bf16 v[80:83], a[192:195], a[128:131], v[80:83]
 s_waitcnt vmcnt(8)
 v_mfma_f32_16x16x32_bf16 v[112:115], a[200:203], a[128:131], v[112:115]
 ds_read_b128 a[128:131], v1 offset:2048
 v_accvgpr_write_b32 a252, v5
 v_mfma_f32_16x16x32_bf16 v[112:115], a[204:207], a[132:135], v[112:115]
 global_load_dwordx4 a[196:199], v0, s[70:71] offset:-3072 sc1
 ds_read_b128 a[132:135], v1 offset:3072
 v_mfma_f32_16x16x32_bf16 v[116:119], a[204:207], a[140:143], v[116:119]
 ds_read_b128 a[140:143], v1 offset:7168
 v_accvgpr_read_b32 v6, a253
 v_mfma_f32_16x16x32_bf16 v[116:119], a[200:203], a[136:139], v[116:119]
 global_load_dwordx4 a[192:195], v0, s[70:71] offset:-4096 sc1
 ds_read_b128 a[136:139], v1 offset:6144
 v_mfma_f32_16x16x32_bf16 v[120:123], a[200:203], a[144:147], v[120:123]
 ds_read_b128 a[144:147], v1 offset:10240
 v_add_f32 v6, v6, v13
 v_mfma_f32_16x16x32_bf16 v[120:123], a[204:207], a[148:151], v[120:123]
 ds_read_b128 a[148:151], v1 offset:11264
 v_accvgpr_write_b32 a253, v6
 v_mfma_f32_16x16x32_bf16 v[124:127], a[204:207], a[156:159], v[124:127]
 ds_read_b128 a[156:159], v1 offset:15360
 v_accvgpr_read_b32 v5, a254
 v_mfma_f32_16x16x32_bf16 v[124:127], a[200:203], a[152:155], v[124:127]
 ds_read_b128 a[152:155], v1 offset:14336
 v_mfma_f32_16x16x32_bf16 v[128:131], a[200:203], a[160:163], v[128:131]
 ds_read_b128 a[160:163], v1 offset:18432
 v_add_f32 v5, v5, v14
 v_mfma_f32_16x16x32_bf16 v[128:131], a[204:207], a[164:167], v[128:131]
 ds_read_b128 a[164:167], v1 offset:19456
 v_accvgpr_write_b32 a254, v5
 v_mfma_f32_16x16x32_bf16 v[132:135], a[204:207], a[172:175], v[132:135]
 ds_read_b128 a[172:175], v1 offset:23552
 v_mfma_f32_16x16x32_bf16 v[132:135], a[200:203], a[168:171], v[132:135]
 ds_read_b128 a[168:171], v1 offset:22528
 v_accvgpr_read_b32 v6, a255
 v_mfma_f32_16x16x32_bf16 a[240:243], a[200:203], a[176:179], a[240:243]
 ds_read_b128 a[176:179], v1 offset:26624
 v_add_f32 v6, v6, v15
 v_mfma_f32_16x16x32_bf16 a[240:243], a[204:207], a[180:183], a[240:243]
 ds_read_b128 a[180:183], v1 offset:27648
 v_accvgpr_write_b32 a255, v6
 v_mfma_f32_16x16x32_bf16 a[244:247], a[204:207], a[188:191], a[244:247]
 global_load_dwordx4 a[204:207], v0, s[70:71] offset:-1024 sc1
 ds_read_b128 a[188:191], v1 offset:31744
 v_mfma_f32_16x16x32_bf16 a[244:247], a[200:203], a[184:187], a[244:247]
 global_load_dwordx4 a[200:203], v0, s[70:71] offset:-2048 sc1
 ds_read_b128 a[184:187], v1 offset:30720
 s_waitcnt vmcnt(10) lgkmcnt(8)
 s_mov_b32 s8, s32
 s_mov_b32 s9, s33
 s_mov_b32 s10, s34
 s_mov_b32 s20, 1024
 s_mov_b32 s21, 1024
 s_mov_b32 s22, 1024
 s_xor_b32 s30, s29, 131072
 s_add_u32 s51, s51, 2048
 s_add_u32 s25, s25, 1
 s_cmp_eq_u32 s25, 6
 s_cbranch_scc1 Llast
 v_mfma_f32_16x16x32_bf16 v[136:139], a[208:211], a[128:131], v[136:139]
 v_accvgpr_read_b32 v5, a0
 v_lshlrev_b32 v6, 16, v5
 v_mfma_f32_16x16x32_bf16 v[136:139], a[212:215], a[132:135], v[136:139]
 v_and_b32 v5, s26, v5
 v_mul_f32 v6, v6, v16
 v_mfma_f32_16x16x32_bf16 v[140:143], a[212:215], a[140:143], v[140:143]
 v_mul_f32 v5, v5, v17
 v_cvt_pk_bf16_f32 v8, v6, v5
 v_mfma_f32_16x16x32_bf16 v[140:143], a[208:211], a[136:139], v[140:143]
 v_accvgpr_read_b32 v5, a1
 v_mfma_f32_16x16x32_bf16 v[144:147], a[208:211], a[144:147], v[144:147]
 v_lshlrev_b32 v6, 16, v5
 v_and_b32 v5, s26, v5
 v_mfma_f32_16x16x32_bf16 v[144:147], a[212:215], a[148:151], v[144:147]
 v_mul_f32 v6, v6, v18
 v_mul_f32 v5, v5, v19
 v_mfma_f32_16x16x32_bf16 v[148:151], a[212:215], a[156:159], v[148:151]
 v_cvt_pk_bf16_f32 v9, v6, v5
 v_accvgpr_read_b32 v5, a2
 v_mfma_f32_16x16x32_bf16 v[148:151], a[208:211], a[152:155], v[148:151]
 v_lshlrev_b32 v6, 16, v5
 v_and_b32 v5, s26, v5
 s_waitcnt lgkmcnt(0)
 v_mfma_f32_16x16x32_bf16 v[152:155], a[208:211], a[160:163], v[152:155]
 v_mul_f32 v6, v6, v48
 v_mul_f32 v5, v5, v49
 v_mfma_f32_16x16x32_bf16 v[152:155], a[212:215], a[164:167], v[152:155]
 v_cvt_pk_bf16_f32 v10, v6, v5
 v_mfma_f32_16x16x32_bf16 v[156:159], a[212:215], a[172:175], v[156:159]
 v_accvgpr_read_b32 v5, a3
 v_lshlrev_b32 v6, 16, v5
 v_mfma_f32_16x16x32_bf16 v[156:159], a[208:211], a[168:171], v[156:159]
 v_and_b32 v5, s26, v5
 v_mul_f32 v6, v6, v50
 v_mfma_f32_16x16x32_bf16 v[160:163], a[208:211], a[176:179], v[160:163]
 v_mul_f32 v5, v5, v51
 v_cvt_pk_bf16_f32 v11, v6, v5
 v_mfma_f32_16x16x32_bf16 v[160:163], a[212:215], a[180:183], v[160:163]
 ds_write_b128 v3, v[8:11]
 s_add_u32 s68, s29, 0
 v_mfma_f32_16x16x32_bf16 v[164:167], a[212:215], a[188:191], v[164:167]
 buffer_store_dwordx4 v[8:11], v3, s[32:35], s68 offen sc1
 v_accvgpr_read_b32 v5, a32
 v_mfma_f32_16x16x32_bf16 v[164:167], a[208:211], a[184:187], v[164:167]
 v_lshlrev_b32 v6, 16, v5
 v_and_b32 v5, s26, v5
 s_waitcnt vmcnt(9)
 v_mfma_f32_16x16x32_bf16 v[196:199], a[216:219], a[184:187], v[196:199]
 v_mul_f32 v6, v6, v80
 v_mul_f32 v5, v5, v81
 v_mfma_f32_16x16x32_bf16 v[196:199], a[220:223], a[188:191], v[196:199]
 global_load_dwordx4 a[212:215], v0, s[70:71] offset:1024 sc1
 v_cvt_pk_bf16_f32 v12, v6, v5
 v_mfma_f32_16x16x32_bf16 v[192:195], a[220:223], a[180:183], v[192:195]
 v_accvgpr_read_b32 v5, a33
 v_lshlrev_b32 v6, 16, v5
 v_mfma_f32_16x16x32_bf16 v[192:195], a[216:219], a[176:179], v[192:195]
 global_load_dwordx4 a[208:211], v0, s[70:71] offset:0 sc1
 v_and_b32 v5, s26, v5
 v_mfma_f32_16x16x32_bf16 v[188:191], a[216:219], a[168:171], v[188:191]
 v_mul_f32 v6, v6, v82
 v_mul_f32 v5, v5, v83
 v_mfma_f32_16x16x32_bf16 v[188:191], a[220:223], a[172:175], v[188:191]
 v_cvt_pk_bf16_f32 v13, v6, v5
 v_accvgpr_read_b32 v5, a34
 v_mfma_f32_16x16x32_bf16 v[184:187], a[220:223], a[164:167], v[184:187]
 v_lshlrev_b32 v6, 16, v5
 v_and_b32 v5, s26, v5
 v_mfma_f32_16x16x32_bf16 v[184:187], a[216:219], a[160:163], v[184:187]
 v_mul_f32 v6, v6, v112
 v_mul_f32 v5, v5, v113
 v_mfma_f32_16x16x32_bf16 v[180:183], a[216:219], a[152:155], v[180:183]
 v_cvt_pk_bf16_f32 v14, v6, v5
 v_accvgpr_read_b32 v5, a35
 v_mfma_f32_16x16x32_bf16 v[180:183], a[220:223], a[156:159], v[180:183]
 v_lshlrev_b32 v6, 16, v5
 v_and_b32 v5, s26, v5
 v_mfma_f32_16x16x32_bf16 v[176:179], a[220:223], a[148:151], v[176:179]
 v_mul_f32 v6, v6, v114
 v_mul_f32 v5, v5, v115
 v_mfma_f32_16x16x32_bf16 v[176:179], a[216:219], a[144:147], v[176:179]
 v_cvt_pk_bf16_f32 v15, v6, v5
 v_mfma_f32_16x16x32_bf16 v[172:175], a[216:219], a[136:139], v[172:175]
 ds_write_b128 v3, v[12:15] offset:1024
 v_mfma_f32_16x16x32_bf16 v[172:175], a[220:223], a[140:143], v[172:175]
 buffer_store_dwordx4 v[12:15], v3, s[32:35], s68 offen offset:1024 sc1
 v_accvgpr_read_b32 v5, a4
 v_lshlrev_b32 v6, 16, v5
 v_and_b32 v5, s26, v5
 v_mul_f32 v6, v6, v20
 v_mfma_f32_16x16x32_bf16 v[168:171], a[220:223], a[132:135], v[168:171]
 v_mul_f32 v5, v5, v21
 v_cvt_pk_bf16_f32 v8, v6, v5
 v_mfma_f32_16x16x32_bf16 v[168:171], a[216:219], a[128:131], v[168:171]
 v_accvgpr_read_b32 v5, a5
 v_lshlrev_b32 v6, 16, v5
 s_waitcnt vmcnt(10)
 v_mfma_f32_16x16x32_bf16 v[200:203], a[224:227], a[128:131], v[200:203]
 v_and_b32 v5, s26, v5
 v_mul_f32 v6, v6, v22
 v_mfma_f32_16x16x32_bf16 v[200:203], a[228:231], a[132:135], v[200:203]
 global_load_dwordx4 a[220:223], v0, s[70:71] offset:3072 sc1
 v_mul_f32 v5, v5, v23
 v_mfma_f32_16x16x32_bf16 v[204:207], a[228:231], a[140:143], v[204:207]
 v_cvt_pk_bf16_f32 v9, v6, v5
 v_accvgpr_read_b32 v5, a6
 v_mfma_f32_16x16x32_bf16 v[204:207], a[224:227], a[136:139], v[204:207]
 global_load_dwordx4 a[216:219], v0, s[70:71] offset:2048 sc1
 v_lshlrev_b32 v6, 16, v5
 v_mfma_f32_16x16x32_bf16 v[208:211], a[224:227], a[144:147], v[208:211]
 v_and_b32 v5, s26, v5
 v_mul_f32 v6, v6, v52
 s_add_u32 s70, s70, 8192
 s_addc_u32 s71, s71, 0
 v_mfma_f32_16x16x32_bf16 v[208:211], a[228:231], a[148:151], v[208:211]
 v_mul_f32 v5, v5, v53
 v_cvt_pk_bf16_f32 v10, v6, v5
 v_mfma_f32_16x16x32_bf16 v[212:215], a[228:231], a[156:159], v[212:215]
 v_accvgpr_read_b32 v5, a7
 v_lshlrev_b32 v6, 16, v5
 v_mfma_f32_16x16x32_bf16 v[212:215], a[224:227], a[152:155], v[212:215]
 v_and_b32 v5, s26, v5
 v_mul_f32 v6, v6, v54
 v_mfma_f32_16x16x32_bf16 v[216:219], a[224:227], a[160:163], v[216:219]
 v_mul_f32 v5, v5, v55
 v_cvt_pk_bf16_f32 v11, v6, v5
 v_mfma_f32_16x16x32_bf16 v[216:219], a[228:231], a[164:167], v[216:219]
 ds_write_b128 v3, v[8:11] offset:4096
 v_mfma_f32_16x16x32_bf16 v[220:223], a[228:231], a[172:175], v[220:223]
 buffer_store_dwordx4 v[8:11], v3, s[32:35], s68 offen offset:2048 sc1
 v_accvgpr_read_b32 v5, a36
 v_lshlrev_b32 v6, 16, v5
 v_and_b32 v5, s26, v5
 v_mul_f32 v6, v6, v84
 v_mfma_f32_16x16x32_bf16 v[220:223], a[224:227], a[168:171], v[220:223]
 v_mul_f32 v5, v5, v85
 v_cvt_pk_bf16_f32 v12, v6, v5
 v_mfma_f32_16x16x32_bf16 v[224:227], a[224:227], a[176:179], v[224:227]
 v_accvgpr_read_b32 v5, a37
 v_lshlrev_b32 v6, 16, v5
 v_mfma_f32_16x16x32_bf16 v[224:227], a[228:231], a[180:183], v[224:227]
 v_and_b32 v5, s26, v5
 v_mul_f32 v6, v6, v86
 v_mfma_f32_16x16x32_bf16 v[228:231], a[228:231], a[188:191], v[228:231]
 v_mul_f32 v5, v5, v87
 v_cvt_pk_bf16_f32 v13, v6, v5
 v_mfma_f32_16x16x32_bf16 v[228:231], a[224:227], a[184:187], v[228:231]
 v_accvgpr_read_b32 v5, a38
 v_lshlrev_b32 v6, 16, v5
 s_waitcnt vmcnt(11)
 v_mfma_f32_16x16x32_bf16 a[252:255], a[232:235], a[184:187], a[252:255]
 ds_read_b128 a[184:187], v1 offset:63488
 v_and_b32 v5, s26, v5
 v_mfma_f32_16x16x32_bf16 a[252:255], a[236:239], a[188:191], a[252:255]
 global_load_dwordx4 a[228:231], v0, s[70:71] offset:-3072 sc1
 ds_read_b128 a[188:191], v1 offset:64512
 v_mfma_f32_16x16x32_bf16 a[248:251], a[236:239], a[180:183], a[248:251]
 ds_read_b128 a[180:183], v1 offset:60416
 v_mul_f32 v6, v6, v116
 v_mfma_f32_16x16x32_bf16 a[248:251], a[232:235], a[176:179], a[248:251]
 global_load_dwordx4 a[224:227], v0, s[70:71] offset:-4096 sc1
 ds_read_b128 a[176:179], v1 offset:59392
 v_mul_f32 v5, v5, v117
 v_mfma_f32_16x16x32_bf16 v[252:255], a[232:235], a[168:171], v[252:255]
 ds_read_b128 a[168:171], v1 offset:55296
 v_cvt_pk_bf16_f32 v14, v6, v5
 v_accvgpr_read_b32 v5, a39
 v_mfma_f32_16x16x32_bf16 v[252:255], a[236:239], a[172:175], v[252:255]
 ds_read_b128 a[172:175], v1 offset:56320
 v_lshlrev_b32 v6, 16, v5
 v_mfma_f32_16x16x32_bf16 v[248:251], a[236:239], a[164:167], v[248:251]
 ds_read_b128 a[164:167], v1 offset:52224
 v_and_b32 v5, s26, v5
 v_mul_f32 v6, v6, v118
 v_mfma_f32_16x16x32_bf16 v[248:251], a[232:235], a[160:163], v[248:251]
 ds_read_b128 a[160:163], v1 offset:51200
 v_mul_f32 v5, v5, v119
 v_cvt_pk_bf16_f32 v15, v6, v5
 v_mfma_f32_16x16x32_bf16 v[244:247], a[232:235], a[152:155], v[244:247]
 ds_read_b128 a[152:155], v1 offset:47104
 ds_write_b128 v3, v[12:15] offset:5120
 v_mfma_f32_16x16x32_bf16 v[244:247], a[236:239], a[156:159], v[244:247]
 buffer_store_dwordx4 v[12:15], v3, s[32:35], s68 offen offset:3072 sc1
 ds_read_b128 a[156:159], v1 offset:48128
 v_accvgpr_read_b32 v5, a8
 v_lshlrev_b32 v6, 16, v5
 v_and_b32 v5, s26, v5
 v_mfma_f32_16x16x32_bf16 v[240:243], a[236:239], a[148:151], v[240:243]
 ds_read_b128 a[148:151], v1 offset:44032
 v_mul_f32 v6, v6, v24
 v_mfma_f32_16x16x32_bf16 v[240:243], a[232:235], a[144:147], v[240:243]
 ds_read_b128 a[144:147], v1 offset:43008
 v_mul_f32 v5, v5, v25
 v_cvt_pk_bf16_f32 v8, v6, v5
 v_mfma_f32_16x16x32_bf16 v[236:239], a[232:235], a[136:139], v[236:239]
 ds_read_b128 a[136:139], v1 offset:38912
 v_accvgpr_read_b32 v5, a9
 v_mfma_f32_16x16x32_bf16 v[236:239], a[236:239], a[140:143], v[236:239]
 ds_read_b128 a[140:143], v1 offset:39936
 v_lshlrev_b32 v6, 16, v5
 v_mfma_f32_16x16x32_bf16 v[232:235], a[236:239], a[132:135], v[232:235]
 ds_read_b128 a[132:135], v1 offset:35840
 v_and_b32 v5, s26, v5
 v_mfma_f32_16x16x32_bf16 v[232:235], a[232:235], a[128:131], v[232:235]
 ds_read_b128 a[128:131], v1 offset:34816
 v_mul_f32 v6, v6, v26
 s_waitcnt vmcnt(12) lgkmcnt(9)
 v_mfma_f32_16x16x32_bf16 v[164:167], a[192:195], a[184:187], v[164:167]
 v_mul_f32 v5, v5, v27
 v_cvt_pk_bf16_f32 v9, v6, v5
 v_mfma_f32_16x16x32_bf16 v[164:167], a[196:199], a[188:191], v[164:167]
 global_load_dwordx4 a[236:239], v0, s[70:71] offset:-1024 sc1
 v_accvgpr_read_b32 v5, a10
 v_mfma_f32_16x16x32_bf16 v[160:163], a[196:199], a[180:183], v[160:163]
 v_lshlrev_b32 v6, 16, v5
 v_and_b32 v5, s26, v5
 v_mfma_f32_16x16x32_bf16 v[160:163], a[192:195], a[176:179], v[160:163]
 global_load_dwordx4 a[232:235], v0, s[70:71] offset:-2048 sc1
 v_mul_f32 v6, v6, v56
 v_mfma_f32_16x16x32_bf16 v[156:159], a[192:195], a[168:171], v[156:159]
 v_mul_f32 v5, v5, v57
 v_cvt_pk_bf16_f32 v10, v6, v5
 v_mfma_f32_16x16x32_bf16 v[156:159], a[196:199], a[172:175], v[156:159]
 v_accvgpr_read_b32 v5, a11
 v_lshlrev_b32 v6, 16, v5
 v_mfma_f32_16x16x32_bf16 v[152:155], a[196:199], a[164:167], v[152:155]
 v_and_b32 v5, s26, v5
 v_mul_f32 v6, v6, v58
 v_mfma_f32_16x16x32_bf16 v[152:155], a[192:195], a[160:163], v[152:155]
 v_mul_f32 v5, v5, v59
 v_cvt_pk_bf16_f32 v11, v6, v5
 s_waitcnt lgkmcnt(0)
 v_mfma_f32_16x16x32_bf16 v[148:151], a[192:195], a[152:155], v[148:151]
 ds_write_b128 v3, v[8:11] offset:8192
 s_add_u32 s68, s29, 4096
 v_mfma_f32_16x16x32_bf16 v[148:151], a[196:199], a[156:159], v[148:151]
 buffer_store_dwordx4 v[8:11], v3, s[32:35], s68 offen sc1
 v_accvgpr_read_b32 v5, a40
 v_lshlrev_b32 v6, 16, v5
 v_and_b32 v5, s26, v5
 v_mul_f32 v6, v6, v88
 v_mfma_f32_16x16x32_bf16 v[144:147], a[196:199], a[148:151], v[144:147]
 v_mul_f32 v5, v5, v89
 v_cvt_pk_bf16_f32 v12, v6, v5
 v_mfma_f32_16x16x32_bf16 v[144:147], a[192:195], a[144:147], v[144:147]
 v_accvgpr_read_b32 v5, a41
 v_lshlrev_b32 v6, 16, v5
 v_mfma_f32_16x16x32_bf16 v[140:143], a[192:195], a[136:139], v[140:143]
 v_and_b32 v5, s26, v5
 v_mul_f32 v6, v6, v90
 v_mfma_f32_16x16x32_bf16 v[140:143], a[196:199], a[140:143], v[140:143]
 v_mul_f32 v5, v5, v91
 v_cvt_pk_bf16_f32 v13, v6, v5
 v_mfma_f32_16x16x32_bf16 v[136:139], a[196:199], a[132:135], v[136:139]
 v_accvgpr_read_b32 v5, a42
 v_lshlrev_b32 v6, 16, v5
 v_mfma_f32_16x16x32_bf16 v[136:139], a[192:195], a[128:131], v[136:139]
 v_and_b32 v5, s26, v5
 v_mul_f32 v6, v6, v120
 s_waitcnt vmcnt(13)
 v_mfma_f32_16x16x32_bf16 v[168:171], a[200:203], a[128:131], v[168:171]
 v_mul_f32 v5, v5, v121
 v_cvt_pk_bf16_f32 v14, v6, v5
 v_mfma_f32_16x16x32_bf16 v[168:171], a[204:207], a[132:135], v[168:171]
 global_load_dwordx4 a[196:199], v0, s[70:71] offset:1024 sc1
 v_accvgpr_read_b32 v5, a43
 v_mfma_f32_16x16x32_bf16 v[172:175], a[204:207], a[140:143], v[172:175]
 v_lshlrev_b32 v6, 16, v5
 v_and_b32 v5, s26, v5
 v_mfma_f32_16x16x32_bf16 v[172:175], a[200:203], a[136:139], v[172:175]
 global_load_dwordx4 a[192:195], v0, s[70:71] offset:0 sc1
 v_mul_f32 v6, v6, v122
 v_mfma_f32_16x16x32_bf16 v[176:179], a[200:203], a[144:147], v[176:179]
 v_mul_f32 v5, v5, v123
 v_cvt_pk_bf16_f32 v15, v6, v5
 v_mfma_f32_16x16x32_bf16 v[176:179], a[204:207], a[148:151], v[176:179]
 ds_write_b128 v3, v[12:15] offset:9216
 v_mfma_f32_16x16x32_bf16 v[180:183], a[204:207], a[156:159], v[180:183]
 v_lshlrev_b32 v4, 2, v3
 v_and_b32 v4, 192, v4
 v_mfma_f32_16x16x32_bf16 v[180:183], a[200:203], a[152:155], v[180:183]
 buffer_load_dword v4, v4, s[44:47], 0 offen sc1
 v_mfma_f32_16x16x32_bf16 v[184:187], a[200:203], a[160:163], v[184:187]
 buffer_store_dwordx4 v[12:15], v3, s[32:35], s68 offen offset:1024 sc1
 v_accvgpr_read_b32 v5, a12
 v_lshlrev_b32 v6, 16, v5
 v_and_b32 v5, s26, v5
 v_mul_f32 v6, v6, v28
 v_mfma_f32_16x16x32_bf16 v[184:187], a[204:207], a[164:167], v[184:187]
 v_mul_f32 v5, v5, v29
 v_cvt_pk_bf16_f32 v8, v6, v5
 v_mfma_f32_16x16x32_bf16 v[188:191], a[204:207], a[172:175], v[188:191]
 v_accvgpr_read_b32 v5, a13
 v_lshlrev_b32 v6, 16, v5
 v_mfma_f32_16x16x32_bf16 v[188:191], a[200:203], a[168:171], v[188:191]
 v_and_b32 v5, s26, v5
 v_mul_f32 v6, v6, v30
 v_mfma_f32_16x16x32_bf16 v[192:195], a[200:203], a[176:179], v[192:195]
 v_mul_f32 v5, v5, v31
 v_cvt_pk_bf16_f32 v9, v6, v5
 v_mfma_f32_16x16x32_bf16 v[192:195], a[204:207], a[180:183], v[192:195]
 v_accvgpr_read_b32 v5, a14
 v_lshlrev_b32 v6, 16, v5
 v_mfma_f32_16x16x32_bf16 v[196:199], a[204:207], a[188:191], v[196:199]
 v_and_b32 v5, s26, v5
 v_mul_f32 v6, v6, v60
 v_mfma_f32_16x16x32_bf16 v[196:199], a[200:203], a[184:187], v[196:199]
 v_mul_f32 v5, v5, v61
 v_cvt_pk_bf16_f32 v10, v6, v5
 s_waitcnt vmcnt(14)
 v_mfma_f32_16x16x32_bf16 v[228:231], a[208:211], a[184:187], v[228:231]
 v_accvgpr_read_b32 v5, a15
 v_lshlrev_b32 v6, 16, v5
 v_mfma_f32_16x16x32_bf16 v[228:231], a[212:215], a[188:191], v[228:231]
 global_load_dwordx4 a[204:207], v0, s[70:71] offset:3072 sc1
 v_and_b32 v5, s26, v5
 v_mfma_f32_16x16x32_bf16 v[224:227], a[212:215], a[180:183], v[224:227]
 v_mul_f32 v6, v6, v62
 v_mul_f32 v5, v5, v63
 v_mfma_f32_16x16x32_bf16 v[224:227], a[208:211], a[176:179], v[224:227]
 global_load_dwordx4 a[200:203], v0, s[70:71] offset:2048 sc1
 v_cvt_pk_bf16_f32 v11, v6, v5
 v_mfma_f32_16x16x32_bf16 v[220:223], a[208:211], a[168:171], v[220:223]
 ds_write_b128 v3, v[8:11] offset:12288
 s_add_u32 s70, s70, 8192
 s_addc_u32 s71, s71, 0
 v_mfma_f32_16x16x32_bf16 v[220:223], a[212:215], a[172:175], v[220:223]
 buffer_store_dwordx4 v[8:11], v3, s[32:35], s68 offen offset:2048 sc1
 v_accvgpr_read_b32 v5, a44
 v_lshlrev_b32 v6, 16, v5
 v_and_b32 v5, s26, v5
 v_mfma_f32_16x16x32_bf16 v[216:219], a[212:215], a[164:167], v[216:219]
 v_mul_f32 v6, v6, v92
 v_mul_f32 v5, v5, v93
 v_mfma_f32_16x16x32_bf16 v[216:219], a[208:211], a[160:163], v[216:219]
 v_cvt_pk_bf16_f32 v12, v6, v5
 v_accvgpr_read_b32 v5, a45
 v_mfma_f32_16x16x32_bf16 v[212:215], a[208:211], a[152:155], v[212:215]
 v_lshlrev_b32 v6, 16, v5
 v_and_b32 v5, s26, v5
 v_mfma_f32_16x16x32_bf16 v[212:215], a[212:215], a[156:159], v[212:215]
 v_mul_f32 v6, v6, v94
 v_mul_f32 v5, v5, v95
 v_mfma_f32_16x16x32_bf16 v[208:211], a[212:215], a[148:151], v[208:211]
 v_cvt_pk_bf16_f32 v13, v6, v5
 v_accvgpr_read_b32 v5, a46
 v_mfma_f32_16x16x32_bf16 v[208:211], a[208:211], a[144:147], v[208:211]
 v_lshlrev_b32 v6, 16, v5
 v_and_b32 v5, s26, v5
 v_mfma_f32_16x16x32_bf16 v[204:207], a[208:211], a[136:139], v[204:207]
 v_mul_f32 v6, v6, v124
 v_mul_f32 v5, v5, v125
 v_mfma_f32_16x16x32_bf16 v[204:207], a[212:215], a[140:143], v[204:207]
 v_cvt_pk_bf16_f32 v14, v6, v5
 v_accvgpr_read_b32 v5, a47
 v_mfma_f32_16x16x32_bf16 v[200:203], a[212:215], a[132:135], v[200:203]
 v_lshlrev_b32 v6, 16, v5
 v_and_b32 v5, s26, v5
 v_mfma_f32_16x16x32_bf16 v[200:203], a[208:211], a[128:131], v[200:203]
 v_mul_f32 v6, v6, v126
 v_mul_f32 v5, v5, v127
 s_waitcnt vmcnt(14)
 v_mfma_f32_16x16x32_bf16 v[232:235], a[216:219], a[128:131], v[232:235]
 ds_read_b128 a[128:131], v2 offset:2048
 v_cvt_pk_bf16_f32 v15, v6, v5
 v_mfma_f32_16x16x32_bf16 v[232:235], a[220:223], a[132:135], v[232:235]
 global_load_dwordx4 a[212:215], v0, s[70:71] offset:-3072 sc1
 ds_read_b128 a[132:135], v2 offset:3072
 v_mfma_f32_16x16x32_bf16 v[236:239], a[220:223], a[140:143], v[236:239]
 ds_read_b128 a[140:143], v2 offset:7168
 ds_write_b128 v3, v[12:15] offset:13312
 v_mfma_f32_16x16x32_bf16 v[236:239], a[216:219], a[136:139], v[236:239]
 global_load_dwordx4 a[208:211], v0, s[70:71] offset:-4096 sc1
 ds_read_b128 a[136:139], v2 offset:6144
 v_mfma_f32_16x16x32_bf16 v[240:243], a[216:219], a[144:147], v[240:243]
 buffer_store_dwordx4 v[12:15], v3, s[32:35], s68 offen offset:3072 sc1
 ds_read_b128 a[144:147], v2 offset:10240
 v_accvgpr_read_b32 v5, a16
 v_lshlrev_b32 v6, 16, v5
 v_and_b32 v5, s26, v5
 v_mfma_f32_16x16x32_bf16 v[240:243], a[220:223], a[148:151], v[240:243]
 ds_read_b128 a[148:151], v2 offset:11264
 v_mul_f32 v6, v6, v32
 v_mfma_f32_16x16x32_bf16 v[244:247], a[220:223], a[156:159], v[244:247]
 ds_read_b128 a[156:159], v2 offset:15360
 v_mul_f32 v5, v5, v33
 v_cvt_pk_bf16_f32 v8, v6, v5
 v_mfma_f32_16x16x32_bf16 v[244:247], a[216:219], a[152:155], v[244:247]
 ds_read_b128 a[152:155], v2 offset:14336
 v_accvgpr_read_b32 v5, a17
 v_lshlrev_b32 v6, 16, v5
 v_mfma_f32_16x16x32_bf16 v[248:251], a[216:219], a[160:163], v[248:251]
 ds_read_b128 a[160:163], v2 offset:18432
 v_and_b32 v5, s26, v5
 v_mul_f32 v6, v6, v34
 v_mfma_f32_16x16x32_bf16 v[248:251], a[220:223], a[164:167], v[248:251]
 ds_read_b128 a[164:167], v2 offset:19456
 v_mul_f32 v5, v5, v35
 v_cvt_pk_bf16_f32 v9, v6, v5
 v_mfma_f32_16x16x32_bf16 v[252:255], a[220:223], a[172:175], v[252:255]
 ds_read_b128 a[172:175], v2 offset:23552
 v_accvgpr_read_b32 v5, a18
 v_mfma_f32_16x16x32_bf16 v[252:255], a[216:219], a[168:171], v[252:255]
 ds_read_b128 a[168:171], v2 offset:22528
 v_lshlrev_b32 v6, 16, v5
 v_mfma_f32_16x16x32_bf16 a[248:251], a[216:219], a[176:179], a[248:251]
 ds_read_b128 a[176:179], v2 offset:26624
 v_and_b32 v5, s26, v5
 v_mfma_f32_16x16x32_bf16 a[248:251], a[220:223], a[180:183], a[248:251]
 ds_read_b128 a[180:183], v2 offset:27648
 v_mul_f32 v6, v6, v64
 v_mfma_f32_16x16x32_bf16 a[252:255], a[220:223], a[188:191], a[252:255]
 ds_read_b128 a[188:191], v2 offset:31744
 v_mul_f32 v5, v5, v65
 v_mfma_f32_16x16x32_bf16 a[252:255], a[216:219], a[184:187], a[252:255]
 ds_read_b128 a[184:187], v2 offset:30720
 v_cvt_pk_bf16_f32 v10, v6, v5
 s_waitcnt vmcnt(14) lgkmcnt(8)
 v_mfma_f32_16x16x32_bf16 v[136:139], a[224:227], a[128:131], v[136:139]
 v_accvgpr_read_b32 v5, a19
 v_lshlrev_b32 v6, 16, v5
 v_mfma_f32_16x16x32_bf16 v[136:139], a[228:231], a[132:135], v[136:139]
 global_load_dwordx4 a[220:223], v0, s[70:71] offset:-1024 sc1
 v_and_b32 v5, s26, v5
 v_mfma_f32_16x16x32_bf16 v[140:143], a[228:231], a[140:143], v[140:143]
 v_mul_f32 v6, v6, v66
 v_mul_f32 v5, v5, v67
 v_mfma_f32_16x16x32_bf16 v[140:143], a[224:227], a[136:139], v[140:143]
 global_load_dwordx4 a[216:219], v0, s[70:71] offset:-2048 sc1
 v_cvt_pk_bf16_f32 v11, v6, v5
 v_mfma_f32_16x16x32_bf16 v[144:147], a[224:227], a[144:147], v[144:147]
 ds_write_b128 v3, v[8:11] offset:16384
 s_add_u32 s68, s29, 8192
 v_mfma_f32_16x16x32_bf16 v[144:147], a[228:231], a[148:151], v[144:147]
 buffer_store_dwordx4 v[8:11], v3, s[32:35], s68 offen sc1
 v_accvgpr_read_b32 v5, a48
 v_lshlrev_b32 v6, 16, v5
 v_and_b32 v5, s26, v5
 v_mul_f32 v6, v6, v96
 v_mfma_f32_16x16x32_bf16 v[148:151], a[228:231], a[156:159], v[148:151]
 v_mul_f32 v5, v5, v97
 v_cvt_pk_bf16_f32 v12, v6, v5
 v_mfma_f32_16x16x32_bf16 v[148:151], a[224:227], a[152:155], v[148:151]
 v_accvgpr_read_b32 v5, a49
 v_lshlrev_b32 v6, 16, v5
 s_waitcnt lgkmcnt(1)
 v_mfma_f32_16x16x32_bf16 v[152:155], a[224:227], a[160:163], v[152:155]
 v_and_b32 v5, s26, v5
 v_mul_f32 v6, v6, v98
 v_mfma_f32_16x16x32_bf16 v[152:155], a[228:231], a[164:167], v[152:155]
 v_mul_f32 v5, v5, v99
 v_cvt_pk_bf16_f32 v13, v6, v5
 v_mfma_f32_16x16x32_bf16 v[156:159], a[228:231], a[172:175], v[156:159]
 v_accvgpr_read_b32 v5, a50
 v_lshlrev_b32 v6, 16, v5
 v_mfma_f32_16x16x32_bf16 v[156:159], a[224:227], a[168:171], v[156:159]
 v_and_b32 v5, s26, v5
 v_mul_f32 v6, v6, v128
 v_mfma_f32_16x16x32_bf16 v[160:163], a[224:227], a[176:179], v[160:163]
 v_mul_f32 v5, v5, v129
 v_cvt_pk_bf16_f32 v14, v6, v5
 v_mfma_f32_16x16x32_bf16 v[160:163], a[228:231], a[180:183], v[160:163]
 v_accvgpr_read_b32 v5, a51
 v_lshlrev_b32 v6, 16, v5
 v_mfma_f32_16x16x32_bf16 v[164:167], a[228:231], a[188:191], v[164:167]
 v_and_b32 v5, s26, v5
 v_mul_f32 v6, v6, v130
 v_mfma_f32_16x16x32_bf16 v[164:167], a[224:227], a[184:187], v[164:167]
 v_mul_f32 v5, v5, v131
 v_cvt_pk_bf16_f32 v15, v6, v5
 s_waitcnt vmcnt(14)
 v_mfma_f32_16x16x32_bf16 v[196:199], a[232:235], a[184:187], v[196:199]
 ds_write_b128 v3, v[12:15] offset:17408
 v_mfma_f32_16x16x32_bf16 v[196:199], a[236:239], a[188:191], v[196:199]
 buffer_store_dwordx4 v[12:15], v3, s[32:35], s68 offen offset:1024 sc1
 global_load_dwordx4 a[228:231], v0, s[70:71] offset:1024 sc1
 v_accvgpr_read_b32 v5, a20
 v_lshlrev_b32 v6, 16, v5
 v_and_b32 v5, s26, v5
 v_mfma_f32_16x16x32_bf16 v[192:195], a[236:239], a[180:183], v[192:195]
 v_mul_f32 v6, v6, v36
 v_mul_f32 v5, v5, v37
 v_mfma_f32_16x16x32_bf16 v[192:195], a[232:235], a[176:179], v[192:195]
 global_load_dwordx4 a[224:227], v0, s[70:71] offset:0 sc1
 v_cvt_pk_bf16_f32 v8, v6, v5
 v_mfma_f32_16x16x32_bf16 v[188:191], a[232:235], a[168:171], v[188:191]
 v_accvgpr_read_b32 v5, a21
 v_lshlrev_b32 v6, 16, v5
 v_mfma_f32_16x16x32_bf16 v[188:191], a[236:239], a[172:175], v[188:191]
 v_and_b32 v5, s26, v5
 v_mul_f32 v6, v6, v38
 v_mfma_f32_16x16x32_bf16 v[184:187], a[236:239], a[164:167], v[184:187]
 v_mul_f32 v5, v5, v39
 v_cvt_pk_bf16_f32 v9, v6, v5
 v_mfma_f32_16x16x32_bf16 v[184:187], a[232:235], a[160:163], v[184:187]
 v_accvgpr_read_b32 v5, a22
 v_lshlrev_b32 v6, 16, v5
 v_mfma_f32_16x16x32_bf16 v[180:183], a[232:235], a[152:155], v[180:183]
 v_and_b32 v5, s26, v5
 v_mul_f32 v6, v6, v68
 v_mfma_f32_16x16x32_bf16 v[180:183], a[236:239], a[156:159], v[180:183]
 v_mul_f32 v5, v5, v69
 v_cvt_pk_bf16_f32 v10, v6, v5
 v_mfma_f32_16x16x32_bf16 v[176:179], a[236:239], a[148:151], v[176:179]
 v_accvgpr_read_b32 v5, a23
 v_lshlrev_b32 v6, 16, v5
 v_mfma_f32_16x16x32_bf16 v[176:179], a[232:235], a[144:147], v[176:179]
 v_and_b32 v5, s26, v5
 v_mul_f32 v6, v6, v70
 v_mfma_f32_16x16x32_bf16 v[172:175], a[232:235], a[136:139], v[172:175]
 v_mul_f32 v5, v5, v71
 v_cvt_pk_bf16_f32 v11, v6, v5
 v_mfma_f32_16x16x32_bf16 v[172:175], a[236:239], a[140:143], v[172:175]
 ds_write_b128 v3, v[8:11] offset:20480
 v_mfma_f32_16x16x32_bf16 v[168:171], a[236:239], a[132:135], v[168:171]
 buffer_store_dwordx4 v[8:11], v3, s[32:35], s68 offen offset:2048 sc1
 v_accvgpr_read_b32 v5, a52
 v_lshlrev_b32 v6, 16, v5
 v_and_b32 v5, s26, v5
 v_mfma_f32_16x16x32_bf16 v[168:171], a[232:235], a[128:131], v[168:171]
 v_mul_f32 v6, v6, v100
 v_mul_f32 v5, v5, v101
 s_waitcnt vmcnt(15)
 v_mfma_f32_16x16x32_bf16 v[200:203], a[192:195], a[128:131], v[200:203]
 v_cvt_pk_bf16_f32 v12, v6, v5
 v_accvgpr_read_b32 v5, a53
 v_mfma_f32_16x16x32_bf16 v[200:203], a[196:199], a[132:135], v[200:203]
 global_load_dwordx4 a[236:239], v0, s[70:71] offset:3072 sc1
 v_lshlrev_b32 v6, 16, v5
 v_mfma_f32_16x16x32_bf16 v[204:207], a[196:199], a[140:143], v[204:207]
 v_and_b32 v5, s26, v5
 s_waitcnt vmcnt(15)
 v_cmp_gt_i32 vcc, s27, v4
 s_and_b64 vcc, exec, vcc
 s_cbranch_vccnz Lspin_w
Lok_w:
 s_add_u32 s27, s27, 64
 v_mfma_f32_16x16x32_bf16 v[204:207], a[192:195], a[136:139], v[204:207]
 global_load_dwordx4 a[232:235], v0, s[70:71] offset:2048 sc1
 v_mul_f32 v6, v6, v102
 v_mfma_f32_16x16x32_bf16 v[208:211], a[192:195], a[144:147], v[208:211]
 v_mul_f32 v5, v5, v103
 v_cvt_pk_bf16_f32 v13, v6, v5
 s_add_u32 s70, s70, 1843200
 s_addc_u32 s71, s71, 0
 v_mfma_f32_16x16x32_bf16 v[208:211], a[196:199], a[148:151], v[208:211]
 v_accvgpr_read_b32 v5, a54
 v_lshlrev_b32 v6, 16, v5
 v_mfma_f32_16x16x32_bf16 v[212:215], a[196:199], a[156:159], v[212:215]
 v_and_b32 v5, s26, v5
 v_mul_f32 v6, v6, v132
 v_mfma_f32_16x16x32_bf16 v[212:215], a[192:195], a[152:155], v[212:215]
 v_mul_f32 v5, v5, v133
 v_cvt_pk_bf16_f32 v14, v6, v5
 v_mfma_f32_16x16x32_bf16 v[216:219], a[192:195], a[160:163], v[216:219]
 v_accvgpr_read_b32 v5, a55
 v_lshlrev_b32 v6, 16, v5
 v_mfma_f32_16x16x32_bf16 v[216:219], a[196:199], a[164:167], v[216:219]
 v_and_b32 v5, s26, v5
 v_mul_f32 v6, v6, v134
 v_mfma_f32_16x16x32_bf16 v[220:223], a[196:199], a[172:175], v[220:223]
 v_mul_f32 v5, v5, v135
 v_cvt_pk_bf16_f32 v15, v6, v5
 v_mfma_f32_16x16x32_bf16 v[220:223], a[192:195], a[168:171], v[220:223]
 ds_write_b128 v3, v[12:15] offset:21504
 v_mfma_f32_16x16x32_bf16 v[224:227], a[192:195], a[176:179], v[224:227]
 buffer_store_dwordx4 v[12:15], v3, s[32:35], s68 offen offset:3072 sc1
 v_accvgpr_read_b32 v5, a24
 v_lshlrev_b32 v6, 16, v5
 v_and_b32 v5, s26, v5
 v_mul_f32 v6, v6, v40
 v_mfma_f32_16x16x32_bf16 v[224:227], a[196:199], a[180:183], v[224:227]
 v_mul_f32 v5, v5, v41
 v_cvt_pk_bf16_f32 v8, v6, v5
 v_mfma_f32_16x16x32_bf16 v[228:231], a[196:199], a[188:191], v[228:231]
 v_accvgpr_read_b32 v5, a25
 v_lshlrev_b32 v6, 16, v5
 v_mfma_f32_16x16x32_bf16 v[228:231], a[192:195], a[184:187], v[228:231]
 v_and_b32 v5, s26, v5
 v_mul_f32 v6, v6, v42
 s_waitcnt vmcnt(14)
 v_mfma_f32_16x16x32_bf16 a[252:255], a[200:203], a[184:187], a[252:255]
 ds_read_b128 a[184:187], v2 offset:63488
 v_mul_f32 v5, v5, v43
 v_mfma_f32_16x16x32_bf16 a[252:255], a[204:207], a[188:191], a[252:255]
 global_load_dwordx4 a[196:199], v0, s[70:71] offset:-3072 sc1
 ds_read_b128 a[188:191], v2 offset:64512
 v_mfma_f32_16x16x32_bf16 a[248:251], a[204:207], a[180:183], a[248:251]
 ds_read_b128 a[180:183], v2 offset:60416
 v_cvt_pk_bf16_f32 v9, v6, v5
 v_mfma_f32_16x16x32_bf16 a[248:251], a[200:203], a[176:179], a[248:251]
 global_load_dwordx4 a[192:195], v0, s[70:71] offset:-4096 sc1
 ds_read_b128 a[176:179], v2 offset:59392
 v_accvgpr_read_b32 v5, a26
 v_lshlrev_b32 v6, 16, v5
 v_mfma_f32_16x16x32_bf16 v[252:255], a[200:203], a[168:171], v[252:255]
 ds_read_b128 a[168:171], v2 offset:55296
 v_and_b32 v5, s26, v5
 v_mfma_f32_16x16x32_bf16 v[252:255], a[204:207], a[172:175], v[252:255]
 ds_read_b128 a[172:175], v2 offset:56320
 v_mul_f32 v6, v6, v72
 v_mfma_f32_16x16x32_bf16 v[248:251], a[204:207], a[164:167], v[248:251]
 ds_read_b128 a[164:167], v2 offset:52224
 v_mul_f32 v5, v5, v73
 v_mfma_f32_16x16x32_bf16 v[248:251], a[200:203], a[160:163], v[248:251]
 ds_read_b128 a[160:163], v2 offset:51200
 v_cvt_pk_bf16_f32 v10, v6, v5
 v_mfma_f32_16x16x32_bf16 v[244:247], a[200:203], a[152:155], v[244:247]
 ds_read_b128 a[152:155], v2 offset:47104
 v_accvgpr_read_b32 v5, a27
 v_mfma_f32_16x16x32_bf16 v[244:247], a[204:207], a[156:159], v[244:247]
 ds_read_b128 a[156:159], v2 offset:48128
 v_lshlrev_b32 v6, 16, v5
 v_mfma_f32_16x16x32_bf16 v[240:243], a[204:207], a[148:151], v[240:243]
 ds_read_b128 a[148:151], v2 offset:44032
 v_and_b32 v5, s26, v5
 v_mfma_f32_16x16x32_bf16 v[240:243], a[200:203], a[144:147], v[240:243]
 ds_read_b128 a[144:147], v2 offset:43008
 v_mul_f32 v6, v6, v74
 v_mfma_f32_16x16x32_bf16 v[236:239], a[200:203], a[136:139], v[236:239]
 ds_read_b128 a[136:139], v2 offset:38912
 v_mul_f32 v5, v5, v75
 v_mfma_f32_16x16x32_bf16 v[236:239], a[204:207], a[140:143], v[236:239]
 ds_read_b128 a[140:143], v2 offset:39936
 v_cvt_pk_bf16_f32 v11, v6, v5
 v_mfma_f32_16x16x32_bf16 v[232:235], a[204:207], a[132:135], v[232:235]
 ds_read_b128 a[132:135], v2 offset:35840
 ds_write_b128 v3, v[8:11] offset:24576
 s_add_u32 s68, s29, 12288
 buffer_store_dwordx4 v[8:11], v3, s[32:35], s68 offen sc1
 v_accvgpr_read_b32 v5, a56
 v_lshlrev_b32 v6, 16, v5
 v_and_b32 v5, s26, v5
 v_mul_f32 v6, v6, v104
 v_mfma_f32_16x16x32_bf16 v[232:235], a[200:203], a[128:131], v[232:235]
 ds_read_b128 a[128:131], v2 offset:34816
 v_mul_f32 v5, v5, v105
 v_cvt_pk_bf16_f32 v12, v6, v5
 s_waitcnt vmcnt(14) lgkmcnt(9)
 v_mfma_f32_16x16x32_bf16 v[164:167], a[208:211], a[184:187], v[164:167]
 v_accvgpr_read_b32 v5, a57
 v_lshlrev_b32 v6, 16, v5
 v_mfma_f32_16x16x32_bf16 v[164:167], a[212:215], a[188:191], v[164:167]
 global_load_dwordx4 a[204:207], v0, s[70:71] offset:-1024 sc1
 v_and_b32 v5, s26, v5
 v_mfma_f32_16x16x32_bf16 v[160:163], a[212:215], a[180:183], v[160:163]
 v_mul_f32 v6, v6, v106
 v_mul_f32 v5, v5, v107
 v_mfma_f32_16x16x32_bf16 v[160:163], a[208:211], a[176:179], v[160:163]
 global_load_dwordx4 a[200:203], v0, s[70:71] offset:-2048 sc1
 v_cvt_pk_bf16_f32 v13, v6, v5
 v_mfma_f32_16x16x32_bf16 v[156:159], a[208:211], a[168:171], v[156:159]
 v_accvgpr_read_b32 v5, a58
 v_accvgpr_read_b32 v7, a240
 v_mfma_f32_16x16x32_bf16 v[156:159], a[212:215], a[172:175], v[156:159]
 v_lshlrev_b32 v6, 16, v5
 v_and_b32 v5, s26, v5
 v_mfma_f32_16x16x32_bf16 v[152:155], a[212:215], a[164:167], v[152:155]
 v_mul_f32 v6, v6, v7
 v_accvgpr_read_b32 v7, a241
 v_mfma_f32_16x16x32_bf16 v[152:155], a[208:211], a[160:163], v[152:155]
 v_mul_f32 v5, v5, v7
 v_cvt_pk_bf16_f32 v14, v6, v5
 s_waitcnt lgkmcnt(0)
 v_mfma_f32_16x16x32_bf16 v[148:151], a[208:211], a[152:155], v[148:151]
 v_accvgpr_read_b32 v5, a59
 v_accvgpr_read_b32 v7, a242
 v_mfma_f32_16x16x32_bf16 v[148:151], a[212:215], a[156:159], v[148:151]
 v_lshlrev_b32 v6, 16, v5
 v_and_b32 v5, s26, v5
 v_mfma_f32_16x16x32_bf16 v[144:147], a[212:215], a[148:151], v[144:147]
 v_mul_f32 v6, v6, v7
 v_accvgpr_read_b32 v7, a243
 v_mfma_f32_16x16x32_bf16 v[144:147], a[208:211], a[144:147], v[144:147]
 v_mul_f32 v5, v5, v7
 v_cvt_pk_bf16_f32 v15, v6, v5
 v_mfma_f32_16x16x32_bf16 v[140:143], a[208:211], a[136:139], v[140:143]
 ds_write_b128 v3, v[12:15] offset:25600
 v_mfma_f32_16x16x32_bf16 v[140:143], a[212:215], a[140:143], v[140:143]
 buffer_store_dwordx4 v[12:15], v3, s[32:35], s68 offen offset:1024 sc1
 v_accvgpr_read_b32 v5, a28
 v_lshlrev_b32 v6, 16, v5
 v_and_b32 v5, s26, v5
 v_mul_f32 v6, v6, v44
 v_mfma_f32_16x16x32_bf16 v[136:139], a[212:215], a[132:135], v[136:139]
 v_mul_f32 v5, v5, v45
 v_cvt_pk_bf16_f32 v8, v6, v5
 v_mfma_f32_16x16x32_bf16 v[136:139], a[208:211], a[128:131], v[136:139]
 v_accvgpr_read_b32 v5, a29
 v_lshlrev_b32 v6, 16, v5
 s_waitcnt vmcnt(14)
 v_mfma_f32_16x16x32_bf16 v[168:171], a[216:219], a[128:131], v[168:171]
 v_and_b32 v5, s26, v5
 v_mul_f32 v6, v6, v46
 v_mfma_f32_16x16x32_bf16 v[168:171], a[220:223], a[132:135], v[168:171]
 global_load_dwordx4 a[212:215], v0, s[70:71] offset:1024 sc1
 v_mul_f32 v5, v5, v47
 v_mfma_f32_16x16x32_bf16 v[172:175], a[220:223], a[140:143], v[172:175]
 v_cvt_pk_bf16_f32 v9, v6, v5
 v_accvgpr_read_b32 v5, a30
 v_mfma_f32_16x16x32_bf16 v[172:175], a[216:219], a[136:139], v[172:175]
 global_load_dwordx4 a[208:211], v0, s[70:71] offset:0 sc1
 v_lshlrev_b32 v6, 16, v5
 v_mfma_f32_16x16x32_bf16 v[176:179], a[216:219], a[144:147], v[176:179]
 v_and_b32 v5, s26, v5
 v_mul_f32 v6, v6, v76
 v_mfma_f32_16x16x32_bf16 v[176:179], a[220:223], a[148:151], v[176:179]
 v_mul_f32 v5, v5, v77
 v_cvt_pk_bf16_f32 v10, v6, v5
 v_mfma_f32_16x16x32_bf16 v[180:183], a[220:223], a[156:159], v[180:183]
 v_accvgpr_read_b32 v5, a31
 v_lshlrev_b32 v6, 16, v5
 v_mfma_f32_16x16x32_bf16 v[180:183], a[216:219], a[152:155], v[180:183]
 v_and_b32 v5, s26, v5
 v_mul_f32 v6, v6, v78
 v_mfma_f32_16x16x32_bf16 v[184:187], a[216:219], a[160:163], v[184:187]
 v_mul_f32 v5, v5, v79
 v_cvt_pk_bf16_f32 v11, v6, v5
 v_mfma_f32_16x16x32_bf16 v[184:187], a[220:223], a[164:167], v[184:187]
 ds_write_b128 v3, v[8:11] offset:28672
 v_mfma_f32_16x16x32_bf16 v[188:191], a[220:223], a[172:175], v[188:191]
 buffer_store_dwordx4 v[8:11], v3, s[32:35], s68 offen offset:2048 sc1
 v_accvgpr_read_b32 v5, a60
 v_lshlrev_b32 v6, 16, v5
 v_and_b32 v5, s26, v5
 v_mul_f32 v6, v6, v108
 v_mfma_f32_16x16x32_bf16 v[188:191], a[216:219], a[168:171], v[188:191]
 v_mul_f32 v5, v5, v109
 v_cvt_pk_bf16_f32 v12, v6, v5
 v_mfma_f32_16x16x32_bf16 v[192:195], a[216:219], a[176:179], v[192:195]
 v_accvgpr_read_b32 v5, a61
 v_lshlrev_b32 v6, 16, v5
 v_mfma_f32_16x16x32_bf16 v[192:195], a[220:223], a[180:183], v[192:195]
 v_and_b32 v5, s26, v5
 v_mul_f32 v6, v6, v110
 v_mfma_f32_16x16x32_bf16 v[196:199], a[220:223], a[188:191], v[196:199]
 v_mul_f32 v5, v5, v111
 v_cvt_pk_bf16_f32 v13, v6, v5
 v_mfma_f32_16x16x32_bf16 v[196:199], a[216:219], a[184:187], v[196:199]
 v_accvgpr_read_b32 v5, a62
 v_accvgpr_read_b32 v7, a244
 s_waitcnt vmcnt(13)
 v_mfma_f32_16x16x32_bf16 v[228:231], a[224:227], a[184:187], v[228:231]
 v_lshlrev_b32 v6, 16, v5
 v_and_b32 v5, s26, v5
 v_mfma_f32_16x16x32_bf16 v[228:231], a[228:231], a[188:191], v[228:231]
 global_load_dwordx4 a[220:223], v0, s[70:71] offset:3072 sc1
 v_mul_f32 v6, v6, v7
 v_mfma_f32_16x16x32_bf16 v[224:227], a[228:231], a[180:183], v[224:227]
 v_accvgpr_read_b32 v7, a245
 v_mul_f32 v5, v5, v7
 v_mfma_f32_16x16x32_bf16 v[224:227], a[224:227], a[176:179], v[224:227]
 global_load_dwordx4 a[216:219], v0, s[70:71] offset:2048 sc1
 v_cvt_pk_bf16_f32 v14, v6, v5
 v_mfma_f32_16x16x32_bf16 v[220:223], a[224:227], a[168:171], v[220:223]
 v_accvgpr_read_b32 v5, a63
 v_accvgpr_read_b32 v7, a246
 s_add_u32 s70, s70, 8192
 s_addc_u32 s71, s71, 0
 v_mfma_f32_16x16x32_bf16 v[220:223], a[228:231], a[172:175], v[220:223]
 v_lshlrev_b32 v6, 16, v5
 v_and_b32 v5, s26, v5
 v_mfma_f32_16x16x32_bf16 v[216:219], a[228:231], a[164:167], v[216:219]
 v_mul_f32 v6, v6, v7
 v_accvgpr_read_b32 v7, a247
 v_mfma_f32_16x16x32_bf16 v[216:219], a[224:227], a[160:163], v[216:219]
 v_mul_f32 v5, v5, v7
 v_cvt_pk_bf16_f32 v15, v6, v5
 v_mfma_f32_16x16x32_bf16 v[212:215], a[224:227], a[152:155], v[212:215]
 ds_write_b128 v3, v[12:15] offset:29696
 v_mfma_f32_16x16x32_bf16 v[212:215], a[228:231], a[156:159], v[212:215]
 buffer_store_dwordx4 v[12:15], v3, s[32:35], s68 offen offset:3072 sc1
 v_mfma_f32_16x16x32_bf16 v[208:211], a[228:231], a[148:151], v[208:211]
 s_waitcnt lgkmcnt(0)
 s_barrier
 v_mfma_f32_16x16x32_bf16 v[208:211], a[224:227], a[144:147], v[208:211]
 v_and_b32 v1, 1023, v3
 v_add_u32 v2, 65536, v1
 v_mfma_f32_16x16x32_bf16 v[204:207], a[224:227], a[136:139], v[204:207]
 v_mfma_f32_16x16x32_bf16 v[204:207], a[228:231], a[140:143], v[204:207]
 v_mfma_f32_16x16x32_bf16 v[200:203], a[228:231], a[132:135], v[200:203]
 v_mfma_f32_16x16x32_bf16 v[200:203], a[224:227], a[128:131], v[200:203]
 s_waitcnt vmcnt(13)
 v_mfma_f32_16x16x32_bf16 v[232:235], a[232:235], a[128:131], v[232:235]
 ds_read_b128 a[128:131], v1
 v_mfma_f32_16x16x32_bf16 v[232:235], a[236:239], a[132:135], v[232:235]
 global_load_dwordx4 a[228:231], v0, s[70:71] offset:-3072 sc1
 ds_read_b128 a[132:135], v1 offset:1024
 v_mfma_f32_16x16x32_bf16 v[236:239], a[236:239], a[140:143], v[236:239]
 ds_read_b128 a[140:143], v1 offset:5120
 v_mfma_f32_16x16x32_bf16 v[236:239], a[232:235], a[136:139], v[236:239]
 global_load_dwordx4 a[224:227], v0, s[70:71] offset:-4096 sc1
 ds_read_b128 a[136:139], v1 offset:4096
 v_mfma_f32_16x16x32_bf16 v[240:243], a[232:235], a[144:147], v[240:243]
 ds_read_b128 a[144:147], v1 offset:8192
 v_mfma_f32_16x16x32_bf16 v[240:243], a[236:239], a[148:151], v[240:243]
 ds_read_b128 a[148:151], v1 offset:9216
 v_mfma_f32_16x16x32_bf16 v[244:247], a[236:239], a[156:159], v[244:247]
 ds_read_b128 a[156:159], v1 offset:13312
 v_mfma_f32_16x16x32_bf16 v[244:247], a[232:235], a[152:155], v[244:247]
 ds_read_b128 a[152:155], v1 offset:12288
 v_mfma_f32_16x16x32_bf16 v[248:251], a[232:235], a[160:163], v[248:251]
 ds_read_b128 a[160:163], v1 offset:16384
 v_mfma_f32_16x16x32_bf16 v[248:251], a[236:239], a[164:167], v[248:251]
 ds_read_b128 a[164:167], v1 offset:17408
 v_mfma_f32_16x16x32_bf16 v[252:255], a[236:239], a[172:175], v[252:255]
 ds_read_b128 a[172:175], v1 offset:21504
 v_mfma_f32_16x16x32_bf16 v[252:255], a[232:235], a[168:171], v[252:255]
 ds_read_b128 a[168:171], v1 offset:20480
 v_mfma_f32_16x16x32_bf16 a[248:251], a[232:235], a[176:179], a[248:251]
 ds_read_b128 a[176:179], v1 offset:24576
 v_mfma_f32_16x16x32_bf16 a[248:251], a[236:239], a[180:183], a[248:251]
 ds_read_b128 a[180:183], v1 offset:25600
 v_mfma_f32_16x16x32_bf16 a[252:255], a[236:239], a[188:191], a[252:255]
 global_load_dwordx4 a[236:239], v0, s[70:71] offset:-1024 sc1
 ds_read_b128 a[188:191], v1 offset:29696
 v_mfma_f32_16x16x32_bf16 a[252:255], a[232:235], a[184:187], a[252:255]
 global_load_dwordx4 a[232:235], v0, s[70:71] offset:-2048 sc1
 ds_read_b128 a[184:187], v1 offset:28672
 s_waitcnt vmcnt(14) lgkmcnt(8)
 v_mfma_f32_16x16x32_bf16 v[16:19], a[192:195], a[128:131], v[16:19]
 v_accvgpr_read_b32 v5, a64
 v_lshlrev_b32 v6, 16, v5
 v_mfma_f32_16x16x32_bf16 v[16:19], a[196:199], a[132:135], v[16:19]
 v_and_b32 v5, s26, v5
 v_mfma_f32_16x16x32_bf16 v[20:23], a[196:199], a[140:143], v[20:23]
 v_mul_f32 v6, v6, v136
 v_mul_f32 v5, v5, v137
 v_mfma_f32_16x16x32_bf16 v[20:23], a[192:195], a[136:139], v[20:23]
 v_cvt_pk_bf16_f32 v8, v6, v5
 v_accvgpr_read_b32 v5, a65
 v_mfma_f32_16x16x32_bf16 v[24:27], a[192:195], a[144:147], v[24:27]
 v_lshlrev_b32 v6, 16, v5
 v_mfma_f32_16x16x32_bf16 v[24:27], a[196:199], a[148:151], v[24:27]
 v_and_b32 v5, s26, v5
 v_mul_f32 v6, v6, v138
 v_mfma_f32_16x16x32_bf16 v[28:31], a[196:199], a[156:159], v[28:31]
 v_mul_f32 v5, v5, v139
 v_cvt_pk_bf16_f32 v9, v6, v5
 v_mfma_f32_16x16x32_bf16 v[28:31], a[192:195], a[152:155], v[28:31]
 v_accvgpr_read_b32 v5, a66
 v_lshlrev_b32 v6, 16, v5
 s_waitcnt lgkmcnt(0)
 v_mfma_f32_16x16x32_bf16 v[32:35], a[192:195], a[160:163], v[32:35]
 v_and_b32 v5, s26, v5
 v_mul_f32 v6, v6, v168
 v_mfma_f32_16x16x32_bf16 v[32:35], a[196:199], a[164:167], v[32:35]
 v_mul_f32 v5, v5, v169
 v_cvt_pk_bf16_f32 v10, v6, v5
 v_mfma_f32_16x16x32_bf16 v[36:39], a[196:199], a[172:175], v[36:39]
 v_accvgpr_read_b32 v5, a67
 v_lshlrev_b32 v6, 16, v5
 v_mfma_f32_16x16x32_bf16 v[36:39], a[192:195], a[168:171], v[36:39]
 v_and_b32 v5, s26, v5
 v_mul_f32 v6, v6, v170
 v_mfma_f32_16x16x32_bf16 v[40:43], a[192:195], a[176:179], v[40:43]
 v_mul_f32 v5, v5, v171
 v_cvt_pk_bf16_f32 v11, v6, v5
 v_mfma_f32_16x16x32_bf16 v[40:43], a[196:199], a[180:183], v[40:43]
 ds_write_b128 v3, v[8:11] offset:2048
 v_mfma_f32_16x16x32_bf16 v[44:47], a[196:199], a[188:191], v[44:47]
 s_add_u32 s68, s29, 16384
 buffer_store_dwordx4 v[8:11], v3, s[32:35], s68 offen sc1
 v_mfma_f32_16x16x32_bf16 v[44:47], a[192:195], a[184:187], v[44:47]
 v_accvgpr_read_b32 v5, a96
 s_waitcnt vmcnt(12)
 v_mfma_f32_16x16x32_bf16 v[76:79], a[200:203], a[184:187], v[76:79]
 v_lshlrev_b32 v6, 16, v5
 v_mfma_f32_16x16x32_bf16 v[76:79], a[204:207], a[188:191], v[76:79]
 global_load_dwordx4 a[196:199], v0, s[70:71] offset:1024 sc1
 v_and_b32 v5, s26, v5
 v_mfma_f32_16x16x32_bf16 v[72:75], a[204:207], a[180:183], v[72:75]
 v_mul_f32 v6, v6, v200
 v_mul_f32 v5, v5, v201
 v_mfma_f32_16x16x32_bf16 v[72:75], a[200:203], a[176:179], v[72:75]
 global_load_dwordx4 a[192:195], v0, s[70:71] offset:0 sc1
 v_cvt_pk_bf16_f32 v12, v6, v5
 v_mfma_f32_16x16x32_bf16 v[68:71], a[200:203], a[168:171], v[68:71]
 v_accvgpr_read_b32 v5, a97
 v_lshlrev_b32 v6, 16, v5
 v_mfma_f32_16x16x32_bf16 v[68:71], a[204:207], a[172:175], v[68:71]
 v_and_b32 v5, s26, v5
 v_mul_f32 v6, v6, v202
 v_mfma_f32_16x16x32_bf16 v[64:67], a[204:207], a[164:167], v[64:67]
 v_mul_f32 v5, v5, v203
 v_cvt_pk_bf16_f32 v13, v6, v5
 v_mfma_f32_16x16x32_bf16 v[64:67], a[200:203], a[160:163], v[64:67]
 v_accvgpr_read_b32 v5, a98
 v_lshlrev_b32 v6, 16, v5
 v_mfma_f32_16x16x32_bf16 v[60:63], a[200:203], a[152:155], v[60:63]
 v_and_b32 v5, s26, v5
 v_mul_f32 v6, v6, v232
 v_mfma_f32_16x16x32_bf16 v[60:63], a[204:207], a[156:159], v[60:63]
 v_mul_f32 v5, v5, v233
 v_cvt_pk_bf16_f32 v14, v6, v5
 v_mfma_f32_16x16x32_bf16 v[56:59], a[204:207], a[148:151], v[56:59]
 v_accvgpr_read_b32 v5, a99
 v_lshlrev_b32 v6, 16, v5
 v_mfma_f32_16x16x32_bf16 v[56:59], a[200:203], a[144:147], v[56:59]
 v_and_b32 v5, s26, v5
 v_mul_f32 v6, v6, v234
 v_mfma_f32_16x16x32_bf16 v[52:55], a[200:203], a[136:139], v[52:55]
 v_mul_f32 v5, v5, v235
 v_cvt_pk_bf16_f32 v15, v6, v5
 v_mfma_f32_16x16x32_bf16 v[52:55], a[204:207], a[140:143], v[52:55]
 ds_write_b128 v3, v[12:15] offset:3072
 v_mfma_f32_16x16x32_bf16 v[48:51], a[204:207], a[132:135], v[48:51]
 buffer_store_dwordx4 v[12:15], v3, s[32:35], s68 offen offset:1024 sc1
 v_mfma_f32_16x16x32_bf16 v[48:51], a[200:203], a[128:131], v[48:51]
 v_accvgpr_read_b32 v5, a68
 v_lshlrev_b32 v6, 16, v5
 s_waitcnt vmcnt(12)
 v_mfma_f32_16x16x32_bf16 v[80:83], a[208:211], a[128:131], v[80:83]
 v_and_b32 v5, s26, v5
 v_mul_f32 v6, v6, v140
 v_mfma_f32_16x16x32_bf16 v[80:83], a[212:215], a[132:135], v[80:83]
 global_load_dwordx4 a[204:207], v0, s[70:71] offset:3072 sc1
 v_mul_f32 v5, v5, v141
 v_mfma_f32_16x16x32_bf16 v[84:87], a[212:215], a[140:143], v[84:87]
 v_cvt_pk_bf16_f32 v8, v6, v5
 v_accvgpr_read_b32 v5, a69
 v_mfma_f32_16x16x32_bf16 v[84:87], a[208:211], a[136:139], v[84:87]
 global_load_dwordx4 a[200:203], v0, s[70:71] offset:2048 sc1
 v_lshlrev_b32 v6, 16, v5
 v_mfma_f32_16x16x32_bf16 v[88:91], a[208:211], a[144:147], v[88:91]
 v_and_b32 v5, s26, v5
 v_mul_f32 v6, v6, v142
 s_add_u32 s70, s70, 8192
 s_addc_u32 s71, s71, 0
 v_mfma_f32_16x16x32_bf16 v[88:91], a[212:215], a[148:151], v[88:91]
 v_mul_f32 v5, v5, v143
 v_cvt_pk_bf16_f32 v9, v6, v5
 v_mfma_f32_16x16x32_bf16 v[92:95], a[212:215], a[156:159], v[92:95]
 v_accvgpr_read_b32 v5, a70
 v_lshlrev_b32 v6, 16, v5
 v_mfma_f32_16x16x32_bf16 v[92:95], a[208:211], a[152:155], v[92:95]
 v_and_b32 v5, s26, v5
 v_mul_f32 v6, v6, v172
 v_mfma_f32_16x16x32_bf16 v[96:99], a[208:211], a[160:163], v[96:99]
 v_mul_f32 v5, v5, v173
 v_cvt_pk_bf16_f32 v10, v6, v5
 v_mfma_f32_16x16x32_bf16 v[96:99], a[212:215], a[164:167], v[96:99]
 v_accvgpr_read_b32 v5, a71
 v_lshlrev_b32 v6, 16, v5
 v_mfma_f32_16x16x32_bf16 v[100:103], a[212:215], a[172:175], v[100:103]
 v_and_b32 v5, s26, v5
 v_mul_f32 v6, v6, v174
 v_mfma_f32_16x16x32_bf16 v[100:103], a[208:211], a[168:171], v[100:103]
 v_mul_f32 v5, v5, v175
 v_cvt_pk_bf16_f32 v11, v6, v5
 v_mfma_f32_16x16x32_bf16 v[104:107], a[208:211], a[176:179], v[104:107]
 ds_write_b128 v3, v[8:11] offset:6144
 v_mfma_f32_16x16x32_bf16 v[104:107], a[212:215], a[180:183], v[104:107]
 buffer_store_dwordx4 v[8:11], v3, s[32:35], s68 offen offset:2048 sc1
 v_accvgpr_read_b32 v5, a100
 v_lshlrev_b32 v6, 16, v5
 v_and_b32 v5, s26, v5
 v_mul_f32 v6, v6, v204
 v_mfma_f32_16x16x32_bf16 v[108:111], a[212:215], a[188:191], v[108:111]
 v_mul_f32 v5, v5, v205
 v_cvt_pk_bf16_f32 v12, v6, v5
 v_mfma_f32_16x16x32_bf16 v[108:111], a[208:211], a[184:187], v[108:111]
 v_accvgpr_read_b32 v5, a101
 v_lshlrev_b32 v6, 16, v5
 s_waitcnt vmcnt(12)
 v_mfma_f32_16x16x32_bf16 a[244:247], a[216:219], a[184:187], a[244:247]
 ds_read_b128 a[184:187], v1 offset:61440
 v_and_b32 v5, s26, v5
 v_mfma_f32_16x16x32_bf16 a[244:247], a[220:223], a[188:191], a[244:247]
 global_load_dwordx4 a[212:215], v0, s[70:71] offset:-3072 sc1
 ds_read_b128 a[188:191], v1 offset:62464
 v_mfma_f32_16x16x32_bf16 a[240:243], a[220:223], a[180:183], a[240:243]
 ds_read_b128 a[180:183], v1 offset:58368
 v_mul_f32 v6, v6, v206
 v_mfma_f32_16x16x32_bf16 a[240:243], a[216:219], a[176:179], a[240:243]
 global_load_dwordx4 a[208:211], v0, s[70:71] offset:-4096 sc1
 ds_read_b128 a[176:179], v1 offset:57344
 v_mfma_f32_16x16x32_bf16 v[132:135], a[216:219], a[168:171], v[132:135]
 ds_read_b128 a[168:171], v1 offset:53248
 v_mul_f32 v5, v5, v207
 v_mfma_f32_16x16x32_bf16 v[132:135], a[220:223], a[172:175], v[132:135]
 ds_read_b128 a[172:175], v1 offset:54272
 v_cvt_pk_bf16_f32 v13, v6, v5
 v_mfma_f32_16x16x32_bf16 v[128:131], a[220:223], a[164:167], v[128:131]
 ds_read_b128 a[164:167], v1 offset:50176
 v_accvgpr_read_b32 v5, a102
 v_lshlrev_b32 v6, 16, v5
 v_mfma_f32_16x16x32_bf16 v[128:131], a[216:219], a[160:163], v[128:131]
 ds_read_b128 a[160:163], v1 offset:49152
 v_and_b32 v5, s26, v5
 v_mul_f32 v6, v6, v236
 v_mfma_f32_16x16x32_bf16 v[124:127], a[216:219], a[152:155], v[124:127]
 ds_read_b128 a[152:155], v1 offset:45056
 v_mul_f32 v5, v5, v237
 v_mfma_f32_16x16x32_bf16 v[124:127], a[220:223], a[156:159], v[124:127]
 ds_read_b128 a[156:159], v1 offset:46080
 v_cvt_pk_bf16_f32 v14, v6, v5
 v_mfma_f32_16x16x32_bf16 v[120:123], a[220:223], a[148:151], v[120:123]
 ds_read_b128 a[148:151], v1 offset:41984
 v_accvgpr_read_b32 v5, a103
 v_mfma_f32_16x16x32_bf16 v[120:123], a[216:219], a[144:147], v[120:123]
 ds_read_b128 a[144:147], v1 offset:40960
 v_lshlrev_b32 v6, 16, v5
 v_mfma_f32_16x16x32_bf16 v[116:119], a[216:219], a[136:139], v[116:119]
 ds_read_b128 a[136:139], v1 offset:36864
 v_and_b32 v5, s26, v5
 v_mfma_f32_16x16x32_bf16 v[116:119], a[220:223], a[140:143], v[116:119]
 ds_read_b128 a[140:143], v1 offset:37888
 v_mul_f32 v6, v6, v238
 v_mfma_f32_16x16x32_bf16 v[112:115], a[220:223], a[132:135], v[112:115]
 ds_read_b128 a[132:135], v1 offset:33792
 v_mul_f32 v5, v5, v239
 v_mfma_f32_16x16x32_bf16 v[112:115], a[216:219], a[128:131], v[112:115]
 ds_read_b128 a[128:131], v1 offset:32768
 v_cvt_pk_bf16_f32 v15, v6, v5
 s_waitcnt vmcnt(11) lgkmcnt(8)
 v_mfma_f32_16x16x32_bf16 v[44:47], a[224:227], a[184:187], v[44:47]
 ds_write_b128 v3, v[12:15] offset:7168
 v_mfma_f32_16x16x32_bf16 v[44:47], a[228:231], a[188:191], v[44:47]
 buffer_store_dwordx4 v[12:15], v3, s[32:35], s68 offen offset:3072 sc1
 global_load_dwordx4 a[220:223], v0, s[70:71] offset:-1024 sc1
 v_accvgpr_read_b32 v5, a72
 v_lshlrev_b32 v6, 16, v5
 v_and_b32 v5, s26, v5
 v_mfma_f32_16x16x32_bf16 v[40:43], a[228:231], a[180:183], v[40:43]
 v_mul_f32 v6, v6, v144
 v_mul_f32 v5, v5, v145
 v_mfma_f32_16x16x32_bf16 v[40:43], a[224:227], a[176:179], v[40:43]
 global_load_dwordx4 a[216:219], v0, s[70:71] offset:-2048 sc1
 v_cvt_pk_bf16_f32 v8, v6, v5
 v_mfma_f32_16x16x32_bf16 v[36:39], a[224:227], a[168:171], v[36:39]
 v_accvgpr_read_b32 v5, a73
 v_lshlrev_b32 v6, 16, v5
 v_mfma_f32_16x16x32_bf16 v[36:39], a[228:231], a[172:175], v[36:39]
 v_and_b32 v5, s26, v5
 v_mul_f32 v6, v6, v146
 v_mfma_f32_16x16x32_bf16 v[32:35], a[228:231], a[164:167], v[32:35]
 v_mul_f32 v5, v5, v147
 v_cvt_pk_bf16_f32 v9, v6, v5
 v_mfma_f32_16x16x32_bf16 v[32:35], a[224:227], a[160:163], v[32:35]
 v_accvgpr_read_b32 v5, a74
 v_lshlrev_b32 v6, 16, v5
 s_waitcnt lgkmcnt(1)
 v_mfma_f32_16x16x32_bf16 v[28:31], a[224:227], a[152:155], v[28:31]
 v_and_b32 v5, s26, v5
 v_mul_f32 v6, v6, v176
 v_mfma_f32_16x16x32_bf16 v[28:31], a[228:231], a[156:159], v[28:31]
 v_mul_f32 v5, v5, v177
 v_cvt_pk_bf16_f32 v10, v6, v5
 v_mfma_f32_16x16x32_bf16 v[24:27], a[228:231], a[148:151], v[24:27]
 v_accvgpr_read_b32 v5, a75
 v_lshlrev_b32 v6, 16, v5
 v_mfma_f32_16x16x32_bf16 v[24:27], a[224:227], a[144:147], v[24:27]
 v_and_b32 v5, s26, v5
 v_mul_f32 v6, v6, v178
 v_mfma_f32_16x16x32_bf16 v[20:23], a[224:227], a[136:139], v[20:23]
 v_mul_f32 v5, v5, v179
 v_cvt_pk_bf16_f32 v11, v6, v5
 v_mfma_f32_16x16x32_bf16 v[20:23], a[228:231], a[140:143], v[20:23]
 ds_write_b128 v3, v[8:11] offset:10240
 s_add_u32 s68, s29, 20480
 v_mfma_f32_16x16x32_bf16 v[16:19], a[228:231], a[132:135], v[16:19]
 buffer_store_dwordx4 v[8:11], v3, s[32:35], s68 offen sc1
 v_accvgpr_read_b32 v5, a104
 v_lshlrev_b32 v6, 16, v5
 v_mfma_f32_16x16x32_bf16 v[16:19], a[224:227], a[128:131], v[16:19]
 v_and_b32 v5, s26, v5
 v_mul_f32 v6, v6, v208
 s_waitcnt vmcnt(13)
 v_mfma_f32_16x16x32_bf16 v[48:51], a[232:235], a[128:131], v[48:51]
 v_mul_f32 v5, v5, v209
 v_cvt_pk_bf16_f32 v12, v6, v5
 v_mfma_f32_16x16x32_bf16 v[48:51], a[236:239], a[132:135], v[48:51]
 global_load_dwordx4 a[228:231], v0, s[70:71] offset:1024 sc1
 v_accvgpr_read_b32 v5, a105
 v_mfma_f32_16x16x32_bf16 v[52:55], a[236:239], a[140:143], v[52:55]
 v_lshlrev_b32 v6, 16, v5
 v_and_b32 v5, s26, v5
 v_mfma_f32_16x16x32_bf16 v[52:55], a[232:235], a[136:139], v[52:55]
 global_load_dwordx4 a[224:227], v0, s[70:71] offset:0 sc1
 v_mul_f32 v6, v6, v210
 v_mfma_f32_16x16x32_bf16 v[56:59], a[232:235], a[144:147], v[56:59]
 v_mul_f32 v5, v5, v211
 v_cvt_pk_bf16_f32 v13, v6, v5
 v_mfma_f32_16x16x32_bf16 v[56:59], a[236:239], a[148:151], v[56:59]
 v_accvgpr_read_b32 v5, a106
 v_lshlrev_b32 v6, 16, v5
 v_mfma_f32_16x16x32_bf16 v[60:63], a[236:239], a[156:159], v[60:63]
 v_and_b32 v5, s26, v5
 v_mfma_f32_16x16x32_bf16 v[60:63], a[232:235], a[152:155], v[60:63]
 v_mul_f32 v6, v6, v240
 v_mul_f32 v5, v5, v241
 v_mfma_f32_16x16x32_bf16 v[64:67], a[232:235], a[160:163], v[64:67]
 v_cvt_pk_bf16_f32 v14, v6, v5
 v_accvgpr_read_b32 v5, a107
 v_mfma_f32_16x16x32_bf16 v[64:67], a[236:239], a[164:167], v[64:67]
 v_lshlrev_b32 v6, 16, v5
 v_mfma_f32_16x16x32_bf16 v[68:71], a[236:239], a[172:175], v[68:71]
 v_and_b32 v5, s26, v5
 v_mul_f32 v6, v6, v242
 v_mfma_f32_16x16x32_bf16 v[68:71], a[232:235], a[168:171], v[68:71]
 v_mul_f32 v5, v5, v243
 v_cvt_pk_bf16_f32 v15, v6, v5
 v_mfma_f32_16x16x32_bf16 v[72:75], a[232:235], a[176:179], v[72:75]
 ds_write_b128 v3, v[12:15] offset:11264
 v_mfma_f32_16x16x32_bf16 v[72:75], a[236:239], a[180:183], v[72:75]
 buffer_store_dwordx4 v[12:15], v3, s[32:35], s68 offen offset:1024 sc1
 v_accvgpr_read_b32 v5, a76
 v_lshlrev_b32 v6, 16, v5
 v_mfma_f32_16x16x32_bf16 v[76:79], a[236:239], a[188:191], v[76:79]
 v_and_b32 v5, s26, v5
 v_mul_f32 v6, v6, v148
 v_mfma_f32_16x16x32_bf16 v[76:79], a[232:235], a[184:187], v[76:79]
 v_mul_f32 v5, v5, v149
 v_cvt_pk_bf16_f32 v8, v6, v5
 s_waitcnt vmcnt(13)
 v_mfma_f32_16x16x32_bf16 v[108:111], a[192:195], a[184:187], v[108:111]
 v_accvgpr_read_b32 v5, a77
 v_lshlrev_b32 v6, 16, v5
 v_mfma_f32_16x16x32_bf16 v[108:111], a[196:199], a[188:191], v[108:111]
 global_load_dwordx4 a[236:239], v0, s[70:71] offset:3072 sc1
 v_and_b32 v5, s26, v5
 v_mfma_f32_16x16x32_bf16 v[104:107], a[196:199], a[180:183], v[104:107]
 v_mul_f32 v6, v6, v150
 v_mul_f32 v5, v5, v151
 v_mfma_f32_16x16x32_bf16 v[104:107], a[192:195], a[176:179], v[104:107]
 global_load_dwordx4 a[232:235], v0, s[70:71] offset:2048 sc1
 v_cvt_pk_bf16_f32 v9, v6, v5
 v_mfma_f32_16x16x32_bf16 v[100:103], a[192:195], a[168:171], v[100:103]
 v_accvgpr_read_b32 v5, a78
 v_lshlrev_b32 v6, 16, v5
 s_add_u32 s70, s70, 8192
 s_addc_u32 s71, s71, 0
 v_mfma_f32_16x16x32_bf16 v[100:103], a[196:199], a[172:175], v[100:103]
 v_and_b32 v5, s26, v5
 v_mul_f32 v6, v6, v180
 v_mfma_f32_16x16x32_bf16 v[96:99], a[196:199], a[164:167], v[96:99]
 v_mul_f32 v5, v5, v181
 v_cvt_pk_bf16_f32 v10, v6, v5
 v_mfma_f32_16x16x32_bf16 v[96:99], a[192:195], a[160:163], v[96:99]
 v_accvgpr_read_b32 v5, a79
 v_lshlrev_b32 v6, 16, v5
 v_mfma_f32_16x16x32_bf16 v[92:95], a[192:195], a[152:155], v[92:95]
 v_and_b32 v5, s26, v5
 v_mul_f32 v6, v6, v182
 v_mfma_f32_16x16x32_bf16 v[92:95], a[196:199], a[156:159], v[92:95]
 v_mul_f32 v5, v5, v183
 v_cvt_pk_bf16_f32 v11, v6, v5
 v_mfma_f32_16x16x32_bf16 v[88:91], a[196:199], a[148:151], v[88:91]
 ds_write_b128 v3, v[8:11] offset:14336
 v_mfma_f32_16x16x32_bf16 v[88:91], a[192:195], a[144:147], v[88:91]
 buffer_store_dwordx4 v[8:11], v3, s[32:35], s68 offen offset:2048 sc1
 v_accvgpr_read_b32 v5, a108
 v_lshlrev_b32 v6, 16, v5
 v_and_b32 v5, s26, v5
 v_mul_f32 v6, v6, v212
 v_mfma_f32_16x16x32_bf16 v[84:87], a[192:195], a[136:139], v[84:87]
 v_mul_f32 v5, v5, v213
 v_cvt_pk_bf16_f32 v12, v6, v5
 v_mfma_f32_16x16x32_bf16 v[84:87], a[196:199], a[140:143], v[84:87]
 v_accvgpr_read_b32 v5, a109
 v_lshlrev_b32 v6, 16, v5
 v_mfma_f32_16x16x32_bf16 v[80:83], a[196:199], a[132:135], v[80:83]
 v_and_b32 v5, s26, v5
 v_mul_f32 v6, v6, v214
 v_mfma_f32_16x16x32_bf16 v[80:83], a[192:195], a[128:131], v[80:83]
 v_mul_f32 v5, v5, v215
 v_cvt_pk_bf16_f32 v13, v6, v5
 s_waitcnt vmcnt(13)
 v_mfma_f32_16x16x32_bf16 v[112:115], a[200:203], a[128:131], v[112:115]
 ds_read_b128 a[128:131], v2
 v_accvgpr_read_b32 v5, a110
 v_mfma_f32_16x16x32_bf16 v[112:115], a[204:207], a[132:135], v[112:115]
 global_load_dwordx4 a[196:199], v0, s[70:71] offset:-3072 sc1
 ds_read_b128 a[132:135], v2 offset:1024
 v_mfma_f32_16x16x32_bf16 v[116:119], a[204:207], a[140:143], v[116:119]
 ds_read_b128 a[140:143], v2 offset:5120
 v_lshlrev_b32 v6, 16, v5
 v_mfma_f32_16x16x32_bf16 v[116:119], a[200:203], a[136:139], v[116:119]
 global_load_dwordx4 a[192:195], v0, s[70:71] offset:-4096 sc1
 ds_read_b128 a[136:139], v2 offset:4096
 v_mfma_f32_16x16x32_bf16 v[120:123], a[200:203], a[144:147], v[120:123]
 ds_read_b128 a[144:147], v2 offset:8192
 v_and_b32 v5, s26, v5
 v_mfma_f32_16x16x32_bf16 v[120:123], a[204:207], a[148:151], v[120:123]
 ds_read_b128 a[148:151], v2 offset:9216
 v_mul_f32 v6, v6, v244
 v_mfma_f32_16x16x32_bf16 v[124:127], a[204:207], a[156:159], v[124:127]
 ds_read_b128 a[156:159], v2 offset:13312
 v_mul_f32 v5, v5, v245
 v_cvt_pk_bf16_f32 v14, v6, v5
 v_mfma_f32_16x16x32_bf16 v[124:127], a[200:203], a[152:155], v[124:127]
 ds_read_b128 a[152:155], v2 offset:12288
 v_accvgpr_read_b32 v5, a111
 v_mfma_f32_16x16x32_bf16 v[128:131], a[200:203], a[160:163], v[128:131]
 ds_read_b128 a[160:163], v2 offset:16384
 v_lshlrev_b32 v6, 16, v5
 v_mfma_f32_16x16x32_bf16 v[128:131], a[204:207], a[164:167], v[128:131]
 ds_read_b128 a[164:167], v2 offset:17408
 v_and_b32 v5, s26, v5
 v_mfma_f32_16x16x32_bf16 v[132:135], a[204:207], a[172:175], v[132:135]
 ds_read_b128 a[172:175], v2 offset:21504
 v_mul_f32 v6, v6, v246
 v_mfma_f32_16x16x32_bf16 v[132:135], a[200:203], a[168:171], v[132:135]
 ds_read_b128 a[168:171], v2 offset:20480
 v_mul_f32 v5, v5, v247
 v_mfma_f32_16x16x32_bf16 a[240:243], a[200:203], a[176:179], a[240:243]
 ds_read_b128 a[176:179], v2 offset:24576
 v_cvt_pk_bf16_f32 v15, v6, v5
 v_mfma_f32_16x16x32_bf16 a[240:243], a[204:207], a[180:183], a[240:243]
 ds_read_b128 a[180:183], v2 offset:25600
 ds_write_b128 v3, v[12:15] offset:15360
 s_add_u32 s31, s31, 1
 v_mov_b32 v7, s31
 v_mfma_f32_16x16x32_bf16 a[244:247], a[204:207], a[188:191], a[244:247]
 buffer_store_dword v7, v1, s[60:63], 0 offen sc1
 ds_read_b128 a[188:191], v2 offset:29696
 v_mfma_f32_16x16x32_bf16 a[244:247], a[200:203], a[184:187], a[244:247]
 buffer_store_dwordx4 v[12:15], v3, s[32:35], s68 offen offset:3072 sc1
 ds_read_b128 a[184:187], v2 offset:28672
 v_accvgpr_read_b32 v5, a80
 v_lshlrev_b32 v6, 16, v5
 v_and_b32 v5, s26, v5
 s_waitcnt vmcnt(14) lgkmcnt(9)
 v_mfma_f32_16x16x32_bf16 v[16:19], a[208:211], a[128:131], v[16:19]
 v_mul_f32 v6, v6, v152
 v_mul_f32 v5, v5, v153
 v_mfma_f32_16x16x32_bf16 v[16:19], a[212:215], a[132:135], v[16:19]
 global_load_dwordx4 a[204:207], v0, s[70:71] offset:-1024 sc1
 v_cvt_pk_bf16_f32 v8, v6, v5
 v_mfma_f32_16x16x32_bf16 v[20:23], a[212:215], a[140:143], v[20:23]
 v_accvgpr_read_b32 v5, a81
 v_lshlrev_b32 v6, 16, v5
 v_mfma_f32_16x16x32_bf16 v[20:23], a[208:211], a[136:139], v[20:23]
 global_load_dwordx4 a[200:203], v0, s[70:71] offset:-2048 sc1
 v_and_b32 v5, s26, v5
 v_mfma_f32_16x16x32_bf16 v[24:27], a[208:211], a[144:147], v[24:27]
 v_mul_f32 v6, v6, v154
 v_mul_f32 v5, v5, v155
 v_mfma_f32_16x16x32_bf16 v[24:27], a[212:215], a[148:151], v[24:27]
 v_cvt_pk_bf16_f32 v9, v6, v5
 v_accvgpr_read_b32 v5, a82
 v_mfma_f32_16x16x32_bf16 v[28:31], a[212:215], a[156:159], v[28:31]
 v_lshlrev_b32 v6, 16, v5
 v_and_b32 v5, s26, v5
 v_mfma_f32_16x16x32_bf16 v[28:31], a[208:211], a[152:155], v[28:31]
 v_mul_f32 v6, v6, v184
 s_waitcnt lgkmcnt(0)
 v_mfma_f32_16x16x32_bf16 v[32:35], a[208:211], a[160:163], v[32:35]
 v_mul_f32 v5, v5, v185
 v_cvt_pk_bf16_f32 v10, v6, v5
 v_mfma_f32_16x16x32_bf16 v[32:35], a[212:215], a[164:167], v[32:35]
 v_accvgpr_read_b32 v5, a83
 v_lshlrev_b32 v6, 16, v5
 v_mfma_f32_16x16x32_bf16 v[36:39], a[212:215], a[172:175], v[36:39]
 v_and_b32 v5, s26, v5
 v_mul_f32 v6, v6, v186
 v_mfma_f32_16x16x32_bf16 v[36:39], a[208:211], a[168:171], v[36:39]
 v_mul_f32 v5, v5, v187
 v_cvt_pk_bf16_f32 v11, v6, v5
 v_mfma_f32_16x16x32_bf16 v[40:43], a[208:211], a[176:179], v[40:43]
 ds_write_b128 v3, v[8:11] offset:18432
 v_mfma_f32_16x16x32_bf16 v[40:43], a[212:215], a[180:183], v[40:43]
 s_add_u32 s68, s29, 24576
 buffer_store_dwordx4 v[8:11], v3, s[32:35], s68 offen sc1
 v_mfma_f32_16x16x32_bf16 v[44:47], a[212:215], a[188:191], v[44:47]
 v_accvgpr_read_b32 v5, a112
 v_mfma_f32_16x16x32_bf16 v[44:47], a[208:211], a[184:187], v[44:47]
 v_lshlrev_b32 v6, 16, v5
 v_and_b32 v5, s26, v5
 s_waitcnt vmcnt(14)
 v_mfma_f32_16x16x32_bf16 v[76:79], a[216:219], a[184:187], v[76:79]
 v_mul_f32 v6, v6, v216
 v_mul_f32 v5, v5, v217
 v_mfma_f32_16x16x32_bf16 v[76:79], a[220:223], a[188:191], v[76:79]
 global_load_dwordx4 a[212:215], v0, s[70:71] offset:1024 sc1
 v_cvt_pk_bf16_f32 v12, v6, v5
 v_mfma_f32_16x16x32_bf16 v[72:75], a[220:223], a[180:183], v[72:75]
 v_accvgpr_read_b32 v5, a113
 v_lshlrev_b32 v6, 16, v5
 v_mfma_f32_16x16x32_bf16 v[72:75], a[216:219], a[176:179], v[72:75]
 global_load_dwordx4 a[208:211], v0, s[70:71] offset:0 sc1
 v_and_b32 v5, s26, v5
 v_mfma_f32_16x16x32_bf16 v[68:71], a[216:219], a[168:171], v[68:71]
 v_mul_f32 v6, v6, v218
 v_mul_f32 v5, v5, v219
 v_mfma_f32_16x16x32_bf16 v[68:71], a[220:223], a[172:175], v[68:71]
 v_cvt_pk_bf16_f32 v13, v6, v5
 v_accvgpr_read_b32 v5, a114
 v_mfma_f32_16x16x32_bf16 v[64:67], a[220:223], a[164:167], v[64:67]
 v_lshlrev_b32 v6, 16, v5
 v_and_b32 v5, s26, v5
 v_mfma_f32_16x16x32_bf16 v[64:67], a[216:219], a[160:163], v[64:67]
 v_mul_f32 v6, v6, v248
 v_mul_f32 v5, v5, v249
 v_mfma_f32_16x16x32_bf16 v[60:63], a[216:219], a[152:155], v[60:63]
 v_cvt_pk_bf16_f32 v14, v6, v5
 v_mfma_f32_16x16x32_bf16 v[60:63], a[220:223], a[156:159], v[60:63]
 v_accvgpr_read_b32 v5, a115
 v_lshlrev_b32 v6, 16, v5
 v_mfma_f32_16x16x32_bf16 v[56:59], a[220:223], a[148:151], v[56:59]
 v_and_b32 v5, s26, v5
 v_mul_f32 v6, v6, v250
 v_mfma_f32_16x16x32_bf16 v[56:59], a[216:219], a[144:147], v[56:59]
 v_mul_f32 v5, v5, v251
 v_cvt_pk_bf16_f32 v15, v6, v5
 v_mfma_f32_16x16x32_bf16 v[52:55], a[216:219], a[136:139], v[52:55]
 ds_write_b128 v3, v[12:15] offset:19456
 v_mfma_f32_16x16x32_bf16 v[52:55], a[220:223], a[140:143], v[52:55]
 buffer_store_dwordx4 v[12:15], v3, s[32:35], s68 offen offset:1024 sc1
 v_accvgpr_read_b32 v5, a84
 v_mfma_f32_16x16x32_bf16 v[48:51], a[220:223], a[132:135], v[48:51]
 v_lshlrev_b32 v6, 16, v5
 v_mfma_f32_16x16x32_bf16 v[48:51], a[216:219], a[128:131], v[48:51]
 v_and_b32 v5, s26, v5
 v_mul_f32 v6, v6, v156
 s_waitcnt vmcnt(14)
 v_mfma_f32_16x16x32_bf16 v[80:83], a[224:227], a[128:131], v[80:83]
 v_mul_f32 v5, v5, v157
 v_cvt_pk_bf16_f32 v8, v6, v5
 v_mfma_f32_16x16x32_bf16 v[80:83], a[228:231], a[132:135], v[80:83]
 global_load_dwordx4 a[220:223], v0, s[70:71] offset:3072 sc1
 v_accvgpr_read_b32 v5, a85
 v_mfma_f32_16x16x32_bf16 v[84:87], a[228:231], a[140:143], v[84:87]
 v_lshlrev_b32 v6, 16, v5
 v_and_b32 v5, s26, v5
 v_mfma_f32_16x16x32_bf16 v[84:87], a[224:227], a[136:139], v[84:87]
 global_load_dwordx4 a[216:219], v0, s[70:71] offset:2048 sc1
 v_mul_f32 v6, v6, v158
 v_mfma_f32_16x16x32_bf16 v[88:91], a[224:227], a[144:147], v[88:91]
 v_mul_f32 v5, v5, v159
 v_cvt_pk_bf16_f32 v9, v6, v5
 s_add_u32 s70, s70, 8192
 s_addc_u32 s71, s71, 0
 v_mfma_f32_16x16x32_bf16 v[88:91], a[228:231], a[148:151], v[88:91]
 v_accvgpr_read_b32 v5, a86
 v_lshlrev_b32 v6, 16, v5
 v_mfma_f32_16x16x32_bf16 v[92:95], a[228:231], a[156:159], v[92:95]
 v_and_b32 v5, s26, v5
 v_mul_f32 v6, v6, v188
 v_mfma_f32_16x16x32_bf16 v[92:95], a[224:227], a[152:155], v[92:95]
 v_mul_f32 v5, v5, v189
 v_cvt_pk_bf16_f32 v10, v6, v5
 v_mfma_f32_16x16x32_bf16 v[96:99], a[224:227], a[160:163], v[96:99]
 v_accvgpr_read_b32 v5, a87
 v_lshlrev_b32 v6, 16, v5
 v_mfma_f32_16x16x32_bf16 v[96:99], a[228:231], a[164:167], v[96:99]
 v_and_b32 v5, s26, v5
 v_mul_f32 v6, v6, v190
 v_mfma_f32_16x16x32_bf16 v[100:103], a[228:231], a[172:175], v[100:103]
 v_mul_f32 v5, v5, v191
 v_cvt_pk_bf16_f32 v11, v6, v5
 v_mfma_f32_16x16x32_bf16 v[100:103], a[224:227], a[168:171], v[100:103]
 ds_write_b128 v3, v[8:11] offset:22528
 v_mfma_f32_16x16x32_bf16 v[104:107], a[224:227], a[176:179], v[104:107]
 buffer_store_dwordx4 v[8:11], v3, s[32:35], s68 offen offset:2048 sc1
 v_accvgpr_read_b32 v5, a116
 v_lshlrev_b32 v6, 16, v5
 v_and_b32 v5, s26, v5
 v_mul_f32 v6, v6, v220
 v_mfma_f32_16x16x32_bf16 v[104:107], a[228:231], a[180:183], v[104:107]
 v_mul_f32 v5, v5, v221
 v_cvt_pk_bf16_f32 v12, v6, v5
 v_mfma_f32_16x16x32_bf16 v[108:111], a[228:231], a[188:191], v[108:111]
 v_accvgpr_read_b32 v5, a117
 v_lshlrev_b32 v6, 16, v5
 v_mfma_f32_16x16x32_bf16 v[108:111], a[224:227], a[184:187], v[108:111]
 v_and_b32 v5, s26, v5
 v_mul_f32 v6, v6, v222
 s_waitcnt vmcnt(14)
 v_mfma_f32_16x16x32_bf16 a[244:247], a[232:235], a[184:187], a[244:247]
 ds_read_b128 a[184:187], v2 offset:61440
 v_mul_f32 v5, v5, v223
 v_mfma_f32_16x16x32_bf16 a[244:247], a[236:239], a[188:191], a[244:247]
 global_load_dwordx4 a[228:231], v0, s[70:71] offset:-3072 sc1
 ds_read_b128 a[188:191], v2 offset:62464
 v_mfma_f32_16x16x32_bf16 a[240:243], a[236:239], a[180:183], a[240:243]
 ds_read_b128 a[180:183], v2 offset:58368
 v_cvt_pk_bf16_f32 v13, v6, v5
 v_mfma_f32_16x16x32_bf16 a[240:243], a[232:235], a[176:179], a[240:243]
 global_load_dwordx4 a[224:227], v0, s[70:71] offset:-4096 sc1
 ds_read_b128 a[176:179], v2 offset:57344
 v_accvgpr_read_b32 v5, a118
 v_mfma_f32_16x16x32_bf16 v[132:135], a[232:235], a[168:171], v[132:135]
 ds_read_b128 a[168:171], v2 offset:53248
 v_lshlrev_b32 v6, 16, v5
 v_mfma_f32_16x16x32_bf16 v[132:135], a[236:239], a[172:175], v[132:135]
 ds_read_b128 a[172:175], v2 offset:54272
 v_and_b32 v5, s26, v5
 v_mfma_f32_16x16x32_bf16 v[128:131], a[236:239], a[164:167], v[128:131]
 ds_read_b128 a[164:167], v2 offset:50176
 v_mul_f32 v6, v6, v252
 v_mfma_f32_16x16x32_bf16 v[128:131], a[232:235], a[160:163], v[128:131]
 ds_read_b128 a[160:163], v2 offset:49152
 v_mul_f32 v5, v5, v253
 v_mfma_f32_16x16x32_bf16 v[124:127], a[232:235], a[152:155], v[124:127]
 ds_read_b128 a[152:155], v2 offset:45056
 v_cvt_pk_bf16_f32 v14, v6, v5
 v_mfma_f32_16x16x32_bf16 v[124:127], a[236:239], a[156:159], v[124:127]
 ds_read_b128 a[156:159], v2 offset:46080
 v_accvgpr_read_b32 v5, a119
 v_mfma_f32_16x16x32_bf16 v[120:123], a[236:239], a[148:151], v[120:123]
 ds_read_b128 a[148:151], v2 offset:41984
 v_lshlrev_b32 v6, 16, v5
 v_mfma_f32_16x16x32_bf16 v[120:123], a[232:235], a[144:147], v[120:123]
 ds_read_b128 a[144:147], v2 offset:40960
 v_and_b32 v5, s26, v5
 v_mfma_f32_16x16x32_bf16 v[116:119], a[232:235], a[136:139], v[116:119]
 ds_read_b128 a[136:139], v2 offset:36864
 v_mul_f32 v6, v6, v254
 v_mfma_f32_16x16x32_bf16 v[116:119], a[236:239], a[140:143], v[116:119]
 ds_read_b128 a[140:143], v2 offset:37888
 v_mul_f32 v5, v5, v255
 v_mfma_f32_16x16x32_bf16 v[112:115], a[236:239], a[132:135], v[112:115]
 ds_read_b128 a[132:135], v2 offset:33792
 v_cvt_pk_bf16_f32 v15, v6, v5
 v_mfma_f32_16x16x32_bf16 v[112:115], a[232:235], a[128:131], v[112:115]
 ds_read_b128 a[128:131], v2 offset:32768
 ds_write_b128 v3, v[12:15] offset:23552
 buffer_store_dwordx4 v[12:15], v3, s[32:35], s68 offen offset:3072 sc1
 v_accvgpr_read_b32 v5, a88
 v_lshlrev_b32 v6, 16, v5
 v_and_b32 v5, s26, v5
 s_waitcnt vmcnt(14) lgkmcnt(9)
 v_mfma_f32_16x16x32_bf16 v[44:47], a[192:195], a[184:187], v[44:47]
 v_mul_f32 v6, v6, v160
 v_mul_f32 v5, v5, v161
 v_mfma_f32_16x16x32_bf16 v[44:47], a[196:199], a[188:191], v[44:47]
 global_load_dwordx4 a[236:239], v0, s[70:71] offset:-1024 sc1
 v_cvt_pk_bf16_f32 v8, v6, v5
 v_mfma_f32_16x16x32_bf16 v[40:43], a[196:199], a[180:183], v[40:43]
 v_accvgpr_read_b32 v5, a89
 v_lshlrev_b32 v6, 16, v5
 v_mfma_f32_16x16x32_bf16 v[40:43], a[192:195], a[176:179], v[40:43]
 global_load_dwordx4 a[232:235], v0, s[70:71] offset:-2048 sc1
 v_and_b32 v5, s26, v5
 v_mfma_f32_16x16x32_bf16 v[36:39], a[192:195], a[168:171], v[36:39]
 v_mul_f32 v6, v6, v162
 v_mul_f32 v5, v5, v163
 v_mfma_f32_16x16x32_bf16 v[36:39], a[196:199], a[172:175], v[36:39]
 v_cvt_pk_bf16_f32 v9, v6, v5
 v_accvgpr_read_b32 v5, a90
 v_mfma_f32_16x16x32_bf16 v[32:35], a[196:199], a[164:167], v[32:35]
 v_lshlrev_b32 v6, 16, v5
 v_and_b32 v5, s26, v5
 v_mfma_f32_16x16x32_bf16 v[32:35], a[192:195], a[160:163], v[32:35]
 v_mul_f32 v6, v6, v192
 v_mul_f32 v5, v5, v193
 s_waitcnt lgkmcnt(1)
 v_mfma_f32_16x16x32_bf16 v[28:31], a[192:195], a[152:155], v[28:31]
 v_cvt_pk_bf16_f32 v10, v6, v5
 v_accvgpr_read_b32 v5, a91
 v_mfma_f32_16x16x32_bf16 v[28:31], a[196:199], a[156:159], v[28:31]
 v_lshlrev_b32 v6, 16, v5
 v_and_b32 v5, s26, v5
 v_mfma_f32_16x16x32_bf16 v[24:27], a[196:199], a[148:151], v[24:27]
 v_mul_f32 v6, v6, v194
 v_mul_f32 v5, v5, v195
 v_mfma_f32_16x16x32_bf16 v[24:27], a[192:195], a[144:147], v[24:27]
 v_cvt_pk_bf16_f32 v11, v6, v5
 v_mfma_f32_16x16x32_bf16 v[20:23], a[192:195], a[136:139], v[20:23]
 ds_write_b128 v3, v[8:11] offset:26624
 s_add_u32 s68, s29, 28672
 v_mfma_f32_16x16x32_bf16 v[20:23], a[196:199], a[140:143], v[20:23]
 buffer_store_dwordx4 v[8:11], v3, s[32:35], s68 offen sc1
 v_accvgpr_read_b32 v5, a120
 v_lshlrev_b32 v6, 16, v5
 v_and_b32 v5, s26, v5
 v_mfma_f32_16x16x32_bf16 v[16:19], a[196:199], a[132:135], v[16:19]
 v_mul_f32 v6, v6, v224
 v_mul_f32 v5, v5, v225
 v_mfma_f32_16x16x32_bf16 v[16:19], a[192:195], a[128:131], v[16:19]
 v_cvt_pk_bf16_f32 v12, v6, v5
 v_accvgpr_read_b32 v5, a121
 s_waitcnt vmcnt(13)
 v_mfma_f32_16x16x32_bf16 v[48:51], a[200:203], a[128:131], v[48:51]
 v_lshlrev_b32 v6, 16, v5
 v_and_b32 v5, s26, v5
 v_mfma_f32_16x16x32_bf16 v[48:51], a[204:207], a[132:135], v[48:51]
 global_load_dwordx4 a[196:199], v0, s[70:71] offset:1024 sc1
 v_mul_f32 v6, v6, v226
 v_mfma_f32_16x16x32_bf16 v[52:55], a[204:207], a[140:143], v[52:55]
 v_mul_f32 v5, v5, v227
 v_cvt_pk_bf16_f32 v13, v6, v5
 v_mfma_f32_16x16x32_bf16 v[52:55], a[200:203], a[136:139], v[52:55]
 global_load_dwordx4 a[192:195], v0, s[70:71] offset:0 sc1
 v_accvgpr_read_b32 v5, a122
 v_mfma_f32_16x16x32_bf16 v[56:59], a[200:203], a[144:147], v[56:59]
 v_accvgpr_read_b32 v7, a248
 v_lshlrev_b32 v6, 16, v5
 v_mfma_f32_16x16x32_bf16 v[56:59], a[204:207], a[148:151], v[56:59]
 v_and_b32 v5, s26, v5
 v_mul_f32 v6, v6, v7
 v_mfma_f32_16x16x32_bf16 v[60:63], a[204:207], a[156:159], v[60:63]
 v_accvgpr_read_b32 v7, a249
 v_mfma_f32_16x16x32_bf16 v[60:63], a[200:203], a[152:155], v[60:63]
 v_mul_f32 v5, v5, v7
 v_cvt_pk_bf16_f32 v14, v6, v5
 v_mfma_f32_16x16x32_bf16 v[64:67], a[200:203], a[160:163], v[64:67]
 v_accvgpr_read_b32 v5, a123
 v_accvgpr_read_b32 v7, a250
 v_mfma_f32_16x16x32_bf16 v[64:67], a[204:207], a[164:167], v[64:67]
 v_lshlrev_b32 v6, 16, v5
 v_mfma_f32_16x16x32_bf16 v[68:71], a[204:207], a[172:175], v[68:71]
 v_and_b32 v5, s26, v5
 v_mul_f32 v6, v6, v7
 v_mfma_f32_16x16x32_bf16 v[68:71], a[200:203], a[168:171], v[68:71]
 v_accvgpr_read_b32 v7, a251
 v_mul_f32 v5, v5, v7
 v_mfma_f32_16x16x32_bf16 v[72:75], a[200:203], a[176:179], v[72:75]
 v_cvt_pk_bf16_f32 v15, v6, v5
 v_mfma_f32_16x16x32_bf16 v[72:75], a[204:207], a[180:183], v[72:75]
 ds_write_b128 v3, v[12:15] offset:27648
 v_mfma_f32_16x16x32_bf16 v[76:79], a[204:207], a[188:191], v[76:79]
 buffer_store_dwordx4 v[12:15], v3, s[32:35], s68 offen offset:1024 sc1
 v_accvgpr_read_b32 v5, a92
 v_lshlrev_b32 v6, 16, v5
 v_mfma_f32_16x16x32_bf16 v[76:79], a[200:203], a[184:187], v[76:79]
 v_and_b32 v5, s26, v5
 v_mul_f32 v6, v6, v164
 s_waitcnt vmcnt(13)
 v_mfma_f32_16x16x32_bf16 v[108:111], a[208:211], a[184:187], v[108:111]
 v_mul_f32 v5, v5, v165
 v_cvt_pk_bf16_f32 v8, v6, v5
 v_mfma_f32_16x16x32_bf16 v[108:111], a[212:215], a[188:191], v[108:111]
 global_load_dwordx4 a[204:207], v0, s[70:71] offset:3072 sc1
 v_accvgpr_read_b32 v5, a93
 v_mfma_f32_16x16x32_bf16 v[104:107], a[212:215], a[180:183], v[104:107]
 v_lshlrev_b32 v6, 16, v5
 v_and_b32 v5, s26, v5
 v_mfma_f32_16x16x32_bf16 v[104:107], a[208:211], a[176:179], v[104:107]
 global_load_dwordx4 a[200:203], v0, s[70:71] offset:2048 sc1
 v_mul_f32 v6, v6, v166
 v_mfma_f32_16x16x32_bf16 v[100:103], a[208:211], a[168:171], v[100:103]
 v_mul_f32 v5, v5, v167
 v_cvt_pk_bf16_f32 v9, v6, v5
 s_add_u32 s70, s70, 8192
 s_addc_u32 s71, s71, 0
 v_mfma_f32_16x16x32_bf16 v[100:103], a[212:215], a[172:175], v[100:103]
 v_accvgpr_read_b32 v5, a94
 v_lshlrev_b32 v6, 16, v5
 v_mfma_f32_16x16x32_bf16 v[96:99], a[212:215], a[164:167], v[96:99]
 v_and_b32 v5, s26, v5
 v_mul_f32 v6, v6, v196
 v_mfma_f32_16x16x32_bf16 v[96:99], a[208:211], a[160:163], v[96:99]
 v_mul_f32 v5, v5, v197
 v_cvt_pk_bf16_f32 v10, v6, v5
 v_mfma_f32_16x16x32_bf16 v[92:95], a[208:211], a[152:155], v[92:95]
 v_accvgpr_read_b32 v5, a95
 v_lshlrev_b32 v6, 16, v5
 v_mfma_f32_16x16x32_bf16 v[92:95], a[212:215], a[156:159], v[92:95]
 v_and_b32 v5, s26, v5
 v_mul_f32 v6, v6, v198
 v_mfma_f32_16x16x32_bf16 v[88:91], a[212:215], a[148:151], v[88:91]
 v_mul_f32 v5, v5, v199
 v_cvt_pk_bf16_f32 v11, v6, v5
 v_mfma_f32_16x16x32_bf16 v[88:91], a[208:211], a[144:147], v[88:91]
 ds_write_b128 v3, v[8:11] offset:30720
 v_mfma_f32_16x16x32_bf16 v[84:87], a[208:211], a[136:139], v[84:87]
 buffer_store_dwordx4 v[8:11], v3, s[32:35], s68 offen offset:2048 sc1
 v_accvgpr_read_b32 v5, a124
 v_lshlrev_b32 v6, 16, v5
 v_and_b32 v5, s26, v5
 v_mul_f32 v6, v6, v228
 v_mfma_f32_16x16x32_bf16 v[84:87], a[212:215], a[140:143], v[84:87]
 v_mul_f32 v5, v5, v229
 v_cvt_pk_bf16_f32 v12, v6, v5
 v_mfma_f32_16x16x32_bf16 v[80:83], a[212:215], a[132:135], v[80:83]
 v_accvgpr_read_b32 v5, a125
 v_lshlrev_b32 v6, 16, v5
 v_mfma_f32_16x16x32_bf16 v[80:83], a[208:211], a[128:131], v[80:83]
 v_and_b32 v5, s26, v5
 v_mul_f32 v6, v6, v230
 s_waitcnt vmcnt(13)
 v_mfma_f32_16x16x32_bf16 v[112:115], a[216:219], a[128:131], v[112:115]
 ds_read_b128 a[128:131], v1
 v_mul_f32 v5, v5, v231
 v_mfma_f32_16x16x32_bf16 v[112:115], a[220:223], a[132:135], v[112:115]
 global_load_dwordx4 a[212:215], v0, s[70:71] offset:-3072 sc1
 ds_read_b128 a[132:135], v1 offset:1024
 v_mfma_f32_16x16x32_bf16 v[116:119], a[220:223], a[140:143], v[116:119]
 ds_read_b128 a[140:143], v1 offset:5120
 v_cvt_pk_bf16_f32 v13, v6, v5
 v_mfma_f32_16x16x32_bf16 v[116:119], a[216:219], a[136:139], v[116:119]
 global_load_dwordx4 a[208:211], v0, s[70:71] offset:-4096 sc1
 ds_read_b128 a[136:139], v1 offset:4096
 v_mfma_f32_16x16x32_bf16 v[120:123], a[216:219], a[144:147], v[120:123]
 ds_read_b128 a[144:147], v1 offset:8192
 v_accvgpr_read_b32 v5, a126
 v_mfma_f32_16x16x32_bf16 v[120:123], a[220:223], a[148:151], v[120:123]
 ds_read_b128 a[148:151], v1 offset:9216
 v_accvgpr_read_b32 v7, a252
 v_lshlrev_b32 v6, 16, v5
 v_mfma_f32_16x16x32_bf16 v[124:127], a[220:223], a[156:159], v[124:127]
 ds_read_b128 a[156:159], v1 offset:13312
 v_and_b32 v5, s26, v5
 v_mfma_f32_16x16x32_bf16 v[124:127], a[216:219], a[152:155], v[124:127]
 ds_read_b128 a[152:155], v1 offset:12288
 v_mul_f32 v6, v6, v7
 v_accvgpr_read_b32 v7, a253
 v_mfma_f32_16x16x32_bf16 v[128:131], a[216:219], a[160:163], v[128:131]
 ds_read_b128 a[160:163], v1 offset:16384
 v_mul_f32 v5, v5, v7
 v_cvt_pk_bf16_f32 v14, v6, v5
 v_mfma_f32_16x16x32_bf16 v[128:131], a[220:223], a[164:167], v[128:131]
 ds_read_b128 a[164:167], v1 offset:17408
 v_accvgpr_read_b32 v5, a127
 v_accvgpr_read_b32 v7, a254
 v_mfma_f32_16x16x32_bf16 v[132:135], a[220:223], a[172:175], v[132:135]
 ds_read_b128 a[172:175], v1 offset:21504
 v_lshlrev_b32 v6, 16, v5
 v_mfma_f32_16x16x32_bf16 v[132:135], a[216:219], a[168:171], v[132:135]
 ds_read_b128 a[168:171], v1 offset:20480
 v_and_b32 v5, s26, v5
 v_mul_f32 v6, v6, v7
 v_mfma_f32_16x16x32_bf16 a[240:243], a[216:219], a[176:179], a[240:243]
 ds_read_b128 a[176:179], v1 offset:24576
 v_accvgpr_read_b32 v7, a255
 v_mul_f32 v5, v5, v7
 v_cvt_pk_bf16_f32 v15, v6, v5
 v_mfma_f32_16x16x32_bf16 a[240:243], a[220:223], a[180:183], a[240:243]
 ds_read_b128 a[180:183], v1 offset:25600
 ds_write_b128 v3, v[12:15] offset:31744
 v_mfma_f32_16x16x32_bf16 a[244:247], a[220:223], a[188:191], a[244:247]
 buffer_store_dwordx4 v[12:15], v3, s[32:35], s68 offen offset:3072 sc1
 global_load_dwordx4 a[220:223], v0, s[70:71] offset:-1024 sc1
 ds_read_b128 a[188:191], v1 offset:29696
 v_mfma_f32_16x16x32_bf16 a[244:247], a[216:219], a[184:187], a[244:247]
 global_load_dwordx4 a[216:219], v0, s[70:71] offset:-2048 sc1
 ds_read_b128 a[184:187], v1 offset:28672
 s_waitcnt vmcnt(15) lgkmcnt(9)
Ls1b:
 v_mfma_f32_16x16x32_bf16 v[136:139], a[224:227], a[128:131], v[136:139]
 v_bfe_u32 v4, v3, 8, 2
 v_mfma_f32_16x16x32_bf16 v[136:139], a[228:231], a[132:135], v[136:139]
 v_mfma_f32_16x16x32_bf16 v[140:143], a[228:231], a[140:143], v[140:143]
 v_lshl_add_u32 v4, v4, 5, s51
 v_mfma_f32_16x16x32_bf16 v[140:143], a[224:227], a[136:139], v[140:143]
 ds_read_b128 v[8:11], v4
 v_mfma_f32_16x16x32_bf16 v[144:147], a[224:227], a[144:147], v[144:147]
 v_mfma_f32_16x16x32_bf16 v[144:147], a[228:231], a[148:151], v[144:147]
 v_mfma_f32_16x16x32_bf16 v[148:151], a[228:231], a[156:159], v[148:151]
 v_mfma_f32_16x16x32_bf16 v[148:151], a[224:227], a[152:155], v[148:151]
 s_waitcnt lgkmcnt(1)
 v_mfma_f32_16x16x32_bf16 v[152:155], a[224:227], a[160:163], v[152:155]
 v_mfma_f32_16x16x32_bf16 v[152:155], a[228:231], a[164:167], v[152:155]
 v_mfma_f32_16x16x32_bf16 v[156:159], a[228:231], a[172:175], v[156:159]
 v_mfma_f32_16x16x32_bf16 v[156:159], a[224:227], a[168:171], v[156:159]
 v_mfma_f32_16x16x32_bf16 v[160:163], a[224:227], a[176:179], v[160:163]
 v_mfma_f32_16x16x32_bf16 v[160:163], a[228:231], a[180:183], v[160:163]
 v_mfma_f32_16x16x32_bf16 v[164:167], a[228:231], a[188:191], v[164:167]
 v_mfma_f32_16x16x32_bf16 v[164:167], a[224:227], a[184:187], v[164:167]
 s_waitcnt vmcnt(12)
 v_mfma_f32_16x16x32_bf16 v[196:199], a[232:235], a[184:187], v[196:199]
 s_waitcnt lgkmcnt(0)
 v_mfma_f32_16x16x32_bf16 v[196:199], a[236:239], a[188:191], v[196:199]
 global_load_dwordx4 a[228:231], v0, s[70:71] offset:1024 sc1
 v_add_f32 v16, v16, v8
 v_mfma_f32_16x16x32_bf16 v[192:195], a[236:239], a[180:183], v[192:195]
 v_mfma_f32_16x16x32_bf16 v[192:195], a[232:235], a[176:179], v[192:195]
 global_load_dwordx4 a[224:227], v0, s[70:71] offset:0 sc1
 ds_read_b128 v[12:15], v4 offset:16
 v_mfma_f32_16x16x32_bf16 v[188:191], a[232:235], a[168:171], v[188:191]
 v_add_f32 v17, v17, v9
 v_mfma_f32_16x16x32_bf16 v[188:191], a[236:239], a[172:175], v[188:191]
 v_mfma_f32_16x16x32_bf16 v[184:187], a[236:239], a[164:167], v[184:187]
 v_add_f32 v18, v18, v10
 v_mfma_f32_16x16x32_bf16 v[184:187], a[232:235], a[160:163], v[184:187]
 v_add_f32 v19, v19, v11
 v_mfma_f32_16x16x32_bf16 v[180:183], a[232:235], a[152:155], v[180:183]
 v_mfma_f32_16x16x32_bf16 v[180:183], a[236:239], a[156:159], v[180:183]
 v_add_f32 v20, v20, v8
 v_mfma_f32_16x16x32_bf16 v[176:179], a[236:239], a[148:151], v[176:179]
 v_add_f32 v21, v21, v9
 v_mfma_f32_16x16x32_bf16 v[176:179], a[232:235], a[144:147], v[176:179]
 v_add_f32 v22, v22, v10
 v_mfma_f32_16x16x32_bf16 v[172:175], a[232:235], a[136:139], v[172:175]
 v_mfma_f32_16x16x32_bf16 v[172:175], a[236:239], a[140:143], v[172:175]
 v_add_f32 v23, v23, v11
 v_mfma_f32_16x16x32_bf16 v[168:171], a[236:239], a[132:135], v[168:171]
 v_add_f32 v24, v24, v8
 v_mfma_f32_16x16x32_bf16 v[168:171], a[232:235], a[128:131], v[168:171]
 s_waitcnt vmcnt(11)
 v_mfma_f32_16x16x32_bf16 v[200:203], a[192:195], a[128:131], v[200:203]
 v_add_f32 v25, v25, v9
 v_mfma_f32_16x16x32_bf16 v[200:203], a[196:199], a[132:135], v[200:203]
 global_load_dwordx4 a[236:239], v0, s[70:71] offset:3072 sc1
 v_add_f32 v26, v26, v10
 v_mfma_f32_16x16x32_bf16 v[204:207], a[196:199], a[140:143], v[204:207]
 v_mfma_f32_16x16x32_bf16 v[204:207], a[192:195], a[136:139], v[204:207]
 global_load_dwordx4 a[232:235], v0, s[70:71] offset:2048 sc1
 v_add_f32 v27, v27, v11
 v_mfma_f32_16x16x32_bf16 v[208:211], a[192:195], a[144:147], v[208:211]
 v_add_f32 v28, v28, v8
 s_add_u32 s70, s70, 8192
 s_addc_u32 s71, s71, 0
 v_mfma_f32_16x16x32_bf16 v[208:211], a[196:199], a[148:151], v[208:211]
 v_mfma_f32_16x16x32_bf16 v[212:215], a[196:199], a[156:159], v[212:215]
 v_add_f32 v29, v29, v9
 v_mfma_f32_16x16x32_bf16 v[212:215], a[192:195], a[152:155], v[212:215]
 v_add_f32 v30, v30, v10
 v_mfma_f32_16x16x32_bf16 v[216:219], a[192:195], a[160:163], v[216:219]
 v_add_f32 v31, v31, v11
 v_mfma_f32_16x16x32_bf16 v[216:219], a[196:199], a[164:167], v[216:219]
 v_mfma_f32_16x16x32_bf16 v[220:223], a[196:199], a[172:175], v[220:223]
 v_add_f32 v32, v32, v8
 v_mfma_f32_16x16x32_bf16 v[220:223], a[192:195], a[168:171], v[220:223]
 v_add_f32 v33, v33, v9
 v_mfma_f32_16x16x32_bf16 v[224:227], a[192:195], a[176:179], v[224:227]
 v_mfma_f32_16x16x32_bf16 v[224:227], a[196:199], a[180:183], v[224:227]
 v_add_f32 v34, v34, v10
 v_mfma_f32_16x16x32_bf16 v[228:231], a[196:199], a[188:191], v[228:231]
 v_add_f32 v35, v35, v11
 v_mfma_f32_16x16x32_bf16 v[228:231], a[192:195], a[184:187], v[228:231]
 v_add_f32 v36, v36, v8
 s_waitcnt vmcnt(10)
 v_mfma_f32_16x16x32_bf16 a[252:255], a[200:203], a[184:187], a[252:255]
 ds_read_b128 a[184:187], v1 offset:61440
 v_add_f32 v37, v37, v9
 v_mfma_f32_16x16x32_bf16 a[252:255], a[204:207], a[188:191], a[252:255]
 global_load_dwordx4 a[196:199], v0, s[70:71] offset:-3072 sc1
 ds_read_b128 a[188:191], v1 offset:62464
 v_mfma_f32_16x16x32_bf16 a[248:251], a[204:207], a[180:183], a[248:251]
 ds_read_b128 a[180:183], v1 offset:58368
 v_add_f32 v38, v38, v10
 v_mfma_f32_16x16x32_bf16 a[248:251], a[200:203], a[176:179], a[248:251]
 global_load_dwordx4 a[192:195], v0, s[70:71] offset:-4096 sc1
 ds_read_b128 a[176:179], v1 offset:57344
 v_mfma_f32_16x16x32_bf16 v[252:255], a[200:203], a[168:171], v[252:255]
 ds_read_b128 a[168:171], v1 offset:53248
 v_add_f32 v39, v39, v11
 v_mfma_f32_16x16x32_bf16 v[252:255], a[204:207], a[172:175], v[252:255]
 ds_read_b128 a[172:175], v1 offset:54272
 v_add_f32 v40, v40, v8
 v_mfma_f32_16x16x32_bf16 v[248:251], a[204:207], a[164:167], v[248:251]
 ds_read_b128 a[164:167], v1 offset:50176
 v_mfma_f32_16x16x32_bf16 v[248:251], a[200:203], a[160:163], v[248:251]
 ds_read_b128 a[160:163], v1 offset:49152
 v_add_f32 v41, v41, v9
 v_mfma_f32_16x16x32_bf16 v[244:247], a[200:203], a[152:155], v[244:247]
 ds_read_b128 a[152:155], v1 offset:45056
 v_add_f32 v42, v42, v10
 v_mfma_f32_16x16x32_bf16 v[244:247], a[204:207], a[156:159], v[244:247]
 ds_read_b128 a[156:159], v1 offset:46080
 v_mfma_f32_16x16x32_bf16 v[240:243], a[204:207], a[148:151], v[240:243]
 ds_read_b128 a[148:151], v1 offset:41984
 v_add_f32 v43, v43, v11
 v_mfma_f32_16x16x32_bf16 v[240:243], a[200:203], a[144:147], v[240:243]
 ds_read_b128 a[144:147], v1 offset:40960
 v_add_f32 v44, v44, v8
 v_mfma_f32_16x16x32_bf16 v[236:239], a[200:203], a[136:139], v[236:239]
 ds_read_b128 a[136:139], v1 offset:36864
 v_mfma_f32_16x16x32_bf16 v[236:239], a[204:207], a[140:143], v[236:239]
 ds_read_b128 a[140:143], v1 offset:37888
 v_add_f32 v45, v45, v9
 v_mfma_f32_16x16x32_bf16 v[232:235], a[204:207], a[132:135], v[232:235]
 ds_read_b128 a[132:135], v1 offset:33792
 v_add_f32 v46, v46, v10
 v_mfma_f32_16x16x32_bf16 v[232:235], a[200:203], a[128:131], v[232:235]
 ds_read_b128 a[128:131], v1 offset:32768
 v_add_f32 v47, v47, v11
 s_waitcnt vmcnt(9) lgkmcnt(8)
 v_mfma_f32_16x16x32_bf16 v[164:167], a[208:211], a[184:187], v[164:167]
 v_mfma_f32_16x16x32_bf16 v[164:167], a[212:215], a[188:191], v[164:167]
 global_load_dwordx4 a[204:207], v0, s[70:71] offset:-1024 sc1
 v_mfma_f32_16x16x32_bf16 v[160:163], a[212:215], a[180:183], v[160:163]
 v_add_f32 v48, v48, v12
 v_mfma_f32_16x16x32_bf16 v[160:163], a[208:211], a[176:179], v[160:163]
 global_load_dwordx4 a[200:203], v0, s[70:71] offset:-2048 sc1
 v_mfma_f32_16x16x32_bf16 v[156:159], a[208:211], a[168:171], v[156:159]
 ds_read_b128 v[8:11], v4 offset:128
 v_mfma_f32_16x16x32_bf16 v[156:159], a[212:215], a[172:175], v[156:159]
 v_add_f32 v49, v49, v13
 v_mfma_f32_16x16x32_bf16 v[152:155], a[212:215], a[164:167], v[152:155]
 v_mfma_f32_16x16x32_bf16 v[152:155], a[208:211], a[160:163], v[152:155]
 v_add_f32 v50, v50, v14
 s_waitcnt lgkmcnt(1)
 v_mfma_f32_16x16x32_bf16 v[148:151], a[208:211], a[152:155], v[148:151]
 v_add_f32 v51, v51, v15
 v_mfma_f32_16x16x32_bf16 v[148:151], a[212:215], a[156:159], v[148:151]
 v_add_f32 v52, v52, v12
 v_mfma_f32_16x16x32_bf16 v[144:147], a[212:215], a[148:151], v[144:147]
 v_mfma_f32_16x16x32_bf16 v[144:147], a[208:211], a[144:147], v[144:147]
 v_add_f32 v53, v53, v13
 v_mfma_f32_16x16x32_bf16 v[140:143], a[208:211], a[136:139], v[140:143]
 v_add_f32 v54, v54, v14
 v_mfma_f32_16x16x32_bf16 v[140:143], a[212:215], a[140:143], v[140:143]
 v_mfma_f32_16x16x32_bf16 v[136:139], a[212:215], a[132:135], v[136:139]
 v_add_f32 v55, v55, v15
 v_mfma_f32_16x16x32_bf16 v[136:139], a[208:211], a[128:131], v[136:139]
 v_add_f32 v56, v56, v12
 s_waitcnt vmcnt(8)
 v_mfma_f32_16x16x32_bf16 v[168:171], a[216:219], a[128:131], v[168:171]
 v_mfma_f32_16x16x32_bf16 v[168:171], a[220:223], a[132:135], v[168:171]
 global_load_dwordx4 a[212:215], v0, s[70:71] offset:1024 sc1
 v_add_f32 v57, v57, v13
 v_mfma_f32_16x16x32_bf16 v[172:175], a[220:223], a[140:143], v[172:175]
 v_add_f32 v58, v58, v14
 v_mfma_f32_16x16x32_bf16 v[172:175], a[216:219], a[136:139], v[172:175]
 global_load_dwordx4 a[208:211], v0, s[70:71] offset:0 sc1
 v_add_f32 v59, v59, v15
 v_mfma_f32_16x16x32_bf16 v[176:179], a[216:219], a[144:147], v[176:179]
 v_mfma_f32_16x16x32_bf16 v[176:179], a[220:223], a[148:151], v[176:179]
 v_add_f32 v60, v60, v12
 v_mfma_f32_16x16x32_bf16 v[180:183], a[220:223], a[156:159], v[180:183]
 v_add_f32 v61, v61, v13
 v_mfma_f32_16x16x32_bf16 v[180:183], a[216:219], a[152:155], v[180:183]
 v_mfma_f32_16x16x32_bf16 v[184:187], a[216:219], a[160:163], v[184:187]
 v_add_f32 v62, v62, v14
 v_mfma_f32_16x16x32_bf16 v[184:187], a[220:223], a[164:167], v[184:187]
 v_add_f32 v63, v63, v15
 v_mfma_f32_16x16x32_bf16 v[188:191], a[220:223], a[172:175], v[188:191]
 v_mfma_f32_16x16x32_bf16 v[188:191], a[216:219], a[168:171], v[188:191]
 v_add_f32 v64, v64, v12
 v_mfma_f32_16x16x32_bf16 v[192:195], a[216:219], a[176:179], v[192:195]
 v_add_f32 v65, v65, v13
 v_mfma_f32_16x16x32_bf16 v[192:195], a[220:223], a[180:183], v[192:195]
 v_mfma_f32_16x16x32_bf16 v[196:199], a[220:223], a[188:191], v[196:199]
 v_add_f32 v66, v66, v14
 v_mfma_f32_16x16x32_bf16 v[196:199], a[216:219], a[184:187], v[196:199]
 v_add_f32 v67, v67, v15
 s_waitcnt vmcnt(8)
 v_mfma_f32_16x16x32_bf16 v[228:231], a[224:227], a[184:187], v[228:231]
 v_add_f32 v68, v68, v12
 v_mfma_f32_16x16x32_bf16 v[228:231], a[228:231], a[188:191], v[228:231]
 global_load_dwordx4 a[220:223], v0, s[70:71] offset:3072 sc1
 v_mfma_f32_16x16x32_bf16 v[224:227], a[228:231], a[180:183], v[224:227]
 v_add_f32 v69, v69, v13
 v_mfma_f32_16x16x32_bf16 v[224:227], a[224:227], a[176:179], v[224:227]
 global_load_dwordx4 a[216:219], v0, s[70:71] offset:2048 sc1
 v_add_f32 v70, v70, v14
 v_mfma_f32_16x16x32_bf16 v[220:223], a[224:227], a[168:171], v[220:223]
 s_add_u32 s70, s70, 8192
 s_addc_u32 s71, s71, 0
 v_mfma_f32_16x16x32_bf16 v[220:223], a[228:231], a[172:175], v[220:223]
 v_add_f32 v71, v71, v15
 v_mfma_f32_16x16x32_bf16 v[216:219], a[228:231], a[164:167], v[216:219]
 v_add_f32 v72, v72, v12
 v_mfma_f32_16x16x32_bf16 v[216:219], a[224:227], a[160:163], v[216:219]
 v_mfma_f32_16x16x32_bf16 v[212:215], a[224:227], a[152:155], v[212:215]
 v_add_f32 v73, v73, v13
 v_mfma_f32_16x16x32_bf16 v[212:215], a[228:231], a[156:159], v[212:215]
 v_add_f32 v74, v74, v14
 v_mfma_f32_16x16x32_bf16 v[208:211], a[228:231], a[148:151], v[208:211]
 v_add_f32 v75, v75, v15
 v_mfma_f32_16x16x32_bf16 v[208:211], a[224:227], a[144:147], v[208:211]
 v_mfma_f32_16x16x32_bf16 v[204:207], a[224:227], a[136:139], v[204:207]
 v_add_f32 v76, v76, v12
 v_mfma_f32_16x16x32_bf16 v[204:207], a[228:231], a[140:143], v[204:207]
 v_add_f32 v77, v77, v13
 v_mfma_f32_16x16x32_bf16 v[200:203], a[228:231], a[132:135], v[200:203]
 v_mfma_f32_16x16x32_bf16 v[200:203], a[224:227], a[128:131], v[200:203]
 v_add_f32 v78, v78, v14
 s_waitcnt vmcnt(8)
 v_mfma_f32_16x16x32_bf16 v[232:235], a[232:235], a[128:131], v[232:235]
 ds_read_b128 a[128:131], v2
 v_add_f32 v79, v79, v15
 v_mfma_f32_16x16x32_bf16 v[232:235], a[236:239], a[132:135], v[232:235]
 global_load_dwordx4 a[228:231], v0, s[70:71] offset:-3072 sc1
 ds_read_b128 a[132:135], v2 offset:1024
 v_mfma_f32_16x16x32_bf16 v[236:239], a[236:239], a[140:143], v[236:239]
 ds_read_b128 a[140:143], v2 offset:5120
 s_waitcnt lgkmcnt(3)
 v_mfma_f32_16x16x32_bf16 v[236:239], a[232:235], a[136:139], v[236:239]
 global_load_dwordx4 a[224:227], v0, s[70:71] offset:-4096 sc1
 ds_read_b128 a[136:139], v2 offset:4096
 v_mfma_f32_16x16x32_bf16 v[240:243], a[232:235], a[144:147], v[240:243]
 ds_read_b128 a[144:147], v2 offset:8192
 v_add_f32 v80, v80, v8
 v_mfma_f32_16x16x32_bf16 v[240:243], a[236:239], a[148:151], v[240:243]
 ds_read_b128 a[148:151], v2 offset:9216
 ds_read_b128 v[12:15], v4 offset:144
 v_mfma_f32_16x16x32_bf16 v[244:247], a[236:239], a[156:159], v[244:247]
 ds_read_b128 a[156:159], v2 offset:13312
 v_add_f32 v81, v81, v9
 v_mfma_f32_16x16x32_bf16 v[244:247], a[232:235], a[152:155], v[244:247]
 ds_read_b128 a[152:155], v2 offset:12288
 v_add_f32 v82, v82, v10
 v_mfma_f32_16x16x32_bf16 v[248:251], a[232:235], a[160:163], v[248:251]
 ds_read_b128 a[160:163], v2 offset:16384
 v_mfma_f32_16x16x32_bf16 v[248:251], a[236:239], a[164:167], v[248:251]
 ds_read_b128 a[164:167], v2 offset:17408
 v_add_f32 v83, v83, v11
 v_mfma_f32_16x16x32_bf16 v[252:255], a[236:239], a[172:175], v[252:255]
 ds_read_b128 a[172:175], v2 offset:21504
 v_add_f32 v84, v84, v8
 v_mfma_f32_16x16x32_bf16 v[252:255], a[232:235], a[168:171], v[252:255]
 ds_read_b128 a[168:171], v2 offset:20480
 v_mfma_f32_16x16x32_bf16 a[248:251], a[232:235], a[176:179], a[248:251]
 ds_read_b128 a[176:179], v2 offset:24576
 v_add_f32 v85, v85, v9
 v_mfma_f32_16x16x32_bf16 a[248:251], a[236:239], a[180:183], a[248:251]
 ds_read_b128 a[180:183], v2 offset:25600
 v_add_f32 v86, v86, v10
 v_mfma_f32_16x16x32_bf16 a[252:255], a[236:239], a[188:191], a[252:255]
 ds_read_b128 a[188:191], v2 offset:29696
 v_mfma_f32_16x16x32_bf16 a[252:255], a[232:235], a[184:187], a[252:255]
 ds_read_b128 a[184:187], v2 offset:28672
 v_add_f32 v87, v87, v11
 s_waitcnt vmcnt(8) lgkmcnt(8)
 v_mfma_f32_16x16x32_bf16 v[136:139], a[192:195], a[128:131], v[136:139]
 v_add_f32 v88, v88, v8
 v_mfma_f32_16x16x32_bf16 v[136:139], a[196:199], a[132:135], v[136:139]
 global_load_dwordx4 a[236:239], v0, s[70:71] offset:-1024 sc1
 v_add_f32 v89, v89, v9
 v_mfma_f32_16x16x32_bf16 v[140:143], a[196:199], a[140:143], v[140:143]
 v_mfma_f32_16x16x32_bf16 v[140:143], a[192:195], a[136:139], v[140:143]
 global_load_dwordx4 a[232:235], v0, s[70:71] offset:-2048 sc1
 v_add_f32 v90, v90, v10
 v_mfma_f32_16x16x32_bf16 v[144:147], a[192:195], a[144:147], v[144:147]
 v_add_f32 v91, v91, v11
 v_mfma_f32_16x16x32_bf16 v[144:147], a[196:199], a[148:151], v[144:147]
 v_mfma_f32_16x16x32_bf16 v[148:151], a[196:199], a[156:159], v[148:151]
 v_add_f32 v92, v92, v8
 v_mfma_f32_16x16x32_bf16 v[148:151], a[192:195], a[152:155], v[148:151]
 v_add_f32 v93, v93, v9
 s_waitcnt lgkmcnt(0)
 v_mfma_f32_16x16x32_bf16 v[152:155], a[192:195], a[160:163], v[152:155]
 v_mfma_f32_16x16x32_bf16 v[152:155], a[196:199], a[164:167], v[152:155]
 v_add_f32 v94, v94, v10
 v_mfma_f32_16x16x32_bf16 v[156:159], a[196:199], a[172:175], v[156:159]
 v_add_f32 v95, v95, v11
 v_mfma_f32_16x16x32_bf16 v[156:159], a[192:195], a[168:171], v[156:159]
 buffer_load_dword v4, off, s[64:67], 0 sc1
 v_mfma_f32_16x16x32_bf16 v[160:163], a[192:195], a[176:179], v[160:163]
 v_mfma_f32_16x16x32_bf16 v[160:163], a[196:199], a[180:183], v[160:163]
 v_add_f32 v96, v96, v8
 v_mfma_f32_16x16x32_bf16 v[164:167], a[196:199], a[188:191], v[164:167]
 v_add_f32 v97, v97, v9
 v_mfma_f32_16x16x32_bf16 v[164:167], a[192:195], a[184:187], v[164:167]
 s_waitcnt vmcnt(9)
 v_mfma_f32_16x16x32_bf16 v[196:199], a[200:203], a[184:187], v[196:199]
 v_add_f32 v98, v98, v10
 v_mfma_f32_16x16x32_bf16 v[196:199], a[204:207], a[188:191], v[196:199]
 global_load_dwordx4 a[196:199], v0, s[70:71] offset:1024 sc1
 v_add_f32 v99, v99, v11
 v_mfma_f32_16x16x32_bf16 v[192:195], a[204:207], a[180:183], v[192:195]
 v_mfma_f32_16x16x32_bf16 v[192:195], a[200:203], a[176:179], v[192:195]
 global_load_dwordx4 a[192:195], v0, s[70:71] offset:0 sc1
 v_add_f32 v100, v100, v8
 v_mfma_f32_16x16x32_bf16 v[188:191], a[200:203], a[168:171], v[188:191]
 v_add_f32 v101, v101, v9
 v_mfma_f32_16x16x32_bf16 v[188:191], a[204:207], a[172:175], v[188:191]
 v_mfma_f32_16x16x32_bf16 v[184:187], a[204:207], a[164:167], v[184:187]
 v_add_f32 v102, v102, v10
 v_mfma_f32_16x16x32_bf16 v[184:187], a[200:203], a[160:163], v[184:187]
 v_add_f32 v103, v103, v11
 v_mfma_f32_16x16x32_bf16 v[180:183], a[200:203], a[152:155], v[180:183]
 v_add_f32 v104, v104, v8
 v_mfma_f32_16x16x32_bf16 v[180:183], a[204:207], a[156:159], v[180:183]
 v_mfma_f32_16x16x32_bf16 v[176:179], a[204:207], a[148:151], v[176:179]
 v_add_f32 v105, v105, v9
 v_mfma_f32_16x16x32_bf16 v[176:179], a[200:203], a[144:147], v[176:179]
 v_add_f32 v106, v106, v10
 v_mfma_f32_16x16x32_bf16 v[172:175], a[200:203], a[136:139], v[172:175]
 v_mfma_f32_16x16x32_bf16 v[172:175], a[204:207], a[140:143], v[172:175]
 v_add_f32 v107, v107, v11
 v_mfma_f32_16x16x32_bf16 v[168:171], a[204:207], a[132:135], v[168:171]
 v_add_f32 v108, v108, v8
 v_mfma_f32_16x16x32_bf16 v[168:171], a[200:203], a[128:131], v[168:171]
 s_waitcnt vmcnt(9)
 v_mfma_f32_16x16x32_bf16 v[200:203], a[208:211], a[128:131], v[200:203]
 v_add_f32 v109, v109, v9
 v_mfma_f32_16x16x32_bf16 v[200:203], a[212:215], a[132:135], v[200:203]
 global_load_dwordx4 a[204:207], v0, s[70:71] offset:3072 sc1
 v_add_f32 v110, v110, v10
 v_mfma_f32_16x16x32_bf16 v[204:207], a[212:215], a[140:143], v[204:207]
 v_add_f32 v111, v111, v11
 v_mfma_f32_16x16x32_bf16 v[204:207], a[208:211], a[136:139], v[204:207]
 global_load_dwordx4 a[200:203], v0, s[70:71] offset:2048 sc1
 v_mfma_f32_16x16x32_bf16 v[208:211], a[208:211], a[144:147], v[208:211]
 s_add_u32 s70, s70, 8192
 s_addc_u32 s71, s71, 0
 v_mfma_f32_16x16x32_bf16 v[208:211], a[212:215], a[148:151], v[208:211]
 v_add_f32 v112, v112, v12
 v_mfma_f32_16x16x32_bf16 v[212:215], a[212:215], a[156:159], v[212:215]
 v_mfma_f32_16x16x32_bf16 v[212:215], a[208:211], a[152:155], v[212:215]
 v_add_f32 v113, v113, v13
 v_mfma_f32_16x16x32_bf16 v[216:219], a[208:211], a[160:163], v[216:219]
 v_add_f32 v114, v114, v14
 v_mfma_f32_16x16x32_bf16 v[216:219], a[212:215], a[164:167], v[216:219]
 v_mfma_f32_16x16x32_bf16 v[220:223], a[212:215], a[172:175], v[220:223]
 v_add_f32 v115, v115, v15
 v_mfma_f32_16x16x32_bf16 v[220:223], a[208:211], a[168:171], v[220:223]
 v_add_f32 v116, v116, v12
 v_mfma_f32_16x16x32_bf16 v[224:227], a[208:211], a[176:179], v[224:227]
 v_add_f32 v117, v117, v13
 v_mfma_f32_16x16x32_bf16 v[224:227], a[212:215], a[180:183], v[224:227]
 v_mfma_f32_16x16x32_bf16 v[228:231], a[212:215], a[188:191], v[228:231]
 v_add_f32 v118, v118, v14
 v_mfma_f32_16x16x32_bf16 v[228:231], a[208:211], a[184:187], v[228:231]
 v_add_f32 v119, v119, v15
 s_waitcnt vmcnt(9)
 v_mfma_f32_16x16x32_bf16 a[252:255], a[216:219], a[184:187], a[252:255]
 ds_read_b128 a[184:187], v2 offset:61440
 v_add_f32 v120, v120, v12
 v_mfma_f32_16x16x32_bf16 a[252:255], a[220:223], a[188:191], a[252:255]
 global_load_dwordx4 a[212:215], v0, s[70:71] offset:-3072 sc1
 ds_read_b128 a[188:191], v2 offset:62464
 v_mfma_f32_16x16x32_bf16 a[248:251], a[220:223], a[180:183], a[248:251]
 ds_read_b128 a[180:183], v2 offset:58368
 v_add_f32 v121, v121, v13
 v_mfma_f32_16x16x32_bf16 a[248:251], a[216:219], a[176:179], a[248:251]
 global_load_dwordx4 a[208:211], v0, s[70:71] offset:-4096 sc1
 ds_read_b128 a[176:179], v2 offset:57344
 v_mfma_f32_16x16x32_bf16 v[252:255], a[216:219], a[168:171], v[252:255]
 ds_read_b128 a[168:171], v2 offset:53248
 v_add_f32 v122, v122, v14
 v_mfma_f32_16x16x32_bf16 v[252:255], a[220:223], a[172:175], v[252:255]
 ds_read_b128 a[172:175], v2 offset:54272
 v_add_f32 v123, v123, v15
 v_mfma_f32_16x16x32_bf16 v[248:251], a[220:223], a[164:167], v[248:251]
 ds_read_b128 a[164:167], v2 offset:50176
 v_mfma_f32_16x16x32_bf16 v[248:251], a[216:219], a[160:163], v[248:251]
 ds_read_b128 a[160:163], v2 offset:49152
 v_add_f32 v124, v124, v12
 v_mfma_f32_16x16x32_bf16 v[244:247], a[216:219], a[152:155], v[244:247]
 ds_read_b128 a[152:155], v2 offset:45056
 v_add_f32 v125, v125, v13
 v_mfma_f32_16x16x32_bf16 v[244:247], a[220:223], a[156:159], v[244:247]
 ds_read_b128 a[156:159], v2 offset:46080
 v_add_f32 v126, v126, v14
 v_mfma_f32_16x16x32_bf16 v[240:243], a[220:223], a[148:151], v[240:243]
 ds_read_b128 a[148:151], v2 offset:41984
 v_mfma_f32_16x16x32_bf16 v[240:243], a[216:219], a[144:147], v[240:243]
 ds_read_b128 a[144:147], v2 offset:40960
 v_add_f32 v127, v127, v15
 v_mfma_f32_16x16x32_bf16 v[236:239], a[216:219], a[136:139], v[236:239]
 ds_read_b128 a[136:139], v2 offset:36864
 v_add_f32 v128, v128, v12
 v_mfma_f32_16x16x32_bf16 v[236:239], a[220:223], a[140:143], v[236:239]
 ds_read_b128 a[140:143], v2 offset:37888
 v_mfma_f32_16x16x32_bf16 v[232:235], a[220:223], a[132:135], v[232:235]
 ds_read_b128 a[132:135], v2 offset:33792
 v_add_f32 v129, v129, v13
 v_mfma_f32_16x16x32_bf16 v[232:235], a[216:219], a[128:131], v[232:235]
 ds_read_b128 a[128:131], v2 offset:32768
 v_add_f32 v130, v130, v14
 s_waitcnt vmcnt(9) lgkmcnt(8)
 v_mfma_f32_16x16x32_bf16 v[164:167], a[224:227], a[184:187], v[164:167]
 v_mfma_f32_16x16x32_bf16 v[164:167], a[228:231], a[188:191], v[164:167]
 global_load_dwordx4 a[220:223], v0, s[70:71] offset:-1024 sc1
 v_add_f32 v131, v131, v15
 v_mfma_f32_16x16x32_bf16 v[160:163], a[228:231], a[180:183], v[160:163]
 v_add_f32 v132, v132, v12
 v_mfma_f32_16x16x32_bf16 v[160:163], a[224:227], a[176:179], v[160:163]
 global_load_dwordx4 a[216:219], v0, s[70:71] offset:-2048 sc1
 v_add_f32 v133, v133, v13
 v_mfma_f32_16x16x32_bf16 v[156:159], a[224:227], a[168:171], v[156:159]
 v_mfma_f32_16x16x32_bf16 v[156:159], a[228:231], a[172:175], v[156:159]
 v_add_f32 v134, v134, v14
 v_mfma_f32_16x16x32_bf16 v[152:155], a[228:231], a[164:167], v[152:155]
 v_add_f32 v135, v135, v15
 v_mfma_f32_16x16x32_bf16 v[152:155], a[224:227], a[160:163], v[152:155]
 s_waitcnt lgkmcnt(0)
 v_mfma_f32_16x16x32_bf16 v[148:151], a[224:227], a[152:155], v[148:151]
 v_accvgpr_read_b32 v5, a240
 v_mfma_f32_16x16x32_bf16 v[148:151], a[228:231], a[156:159], v[148:151]
 v_add_f32 v5, v5, v12
 v_mfma_f32_16x16x32_bf16 v[144:147], a[228:231], a[148:151], v[144:147]
 v_mfma_f32_16x16x32_bf16 v[144:147], a[224:227], a[144:147], v[144:147]
 v_accvgpr_write_b32 a240, v5
 v_mfma_f32_16x16x32_bf16 v[140:143], a[224:227], a[136:139], v[140:143]
 v_accvgpr_read_b32 v6, a241
 v_mfma_f32_16x16x32_bf16 v[140:143], a[228:231], a[140:143], v[140:143]
 v_mfma_f32_16x16x32_bf16 v[136:139], a[228:231], a[132:135], v[136:139]
 v_add_f32 v6, v6, v13
 v_mfma_f32_16x16x32_bf16 v[136:139], a[224:227], a[128:131], v[136:139]
 v_accvgpr_write_b32 a241, v6
 s_waitcnt vmcnt(9)
 v_mfma_f32_16x16x32_bf16 v[168:171], a[232:235], a[128:131], v[168:171]
 v_accvgpr_read_b32 v5, a242
 v_mfma_f32_16x16x32_bf16 v[168:171], a[236:239], a[132:135], v[168:171]
 global_load_dwordx4 a[228:231], v0, s[70:71] offset:1024 sc1
 v_mfma_f32_16x16x32_bf16 v[172:175], a[236:239], a[140:143], v[172:175]
 v_add_f32 v5, v5, v14
 v_mfma_f32_16x16x32_bf16 v[172:175], a[232:235], a[136:139], v[172:175]
 global_load_dwordx4 a[224:227], v0, s[70:71] offset:0 sc1
 v_accvgpr_write_b32 a242, v5
 v_mfma_f32_16x16x32_bf16 v[176:179], a[232:235], a[144:147], v[176:179]
 v_mfma_f32_16x16x32_bf16 v[176:179], a[236:239], a[148:151], v[176:179]
 v_accvgpr_read_b32 v6, a243
 v_mfma_f32_16x16x32_bf16 v[180:183], a[236:239], a[156:159], v[180:183]
 v_add_f32 v6, v6, v15
 v_mfma_f32_16x16x32_bf16 v[180:183], a[232:235], a[152:155], v[180:183]
 v_mfma_f32_16x16x32_bf16 v[184:187], a[232:235], a[160:163], v[184:187]
 v_accvgpr_write_b32 a243, v6
 v_mfma_f32_16x16x32_bf16 v[184:187], a[236:239], a[164:167], v[184:187]
 v_accvgpr_read_b32 v5, a244
 v_mfma_f32_16x16x32_bf16 v[188:191], a[236:239], a[172:175], v[188:191]
 v_add_f32 v5, v5, v12
 v_mfma_f32_16x16x32_bf16 v[188:191], a[232:235], a[168:171], v[188:191]
 v_mfma_f32_16x16x32_bf16 v[192:195], a[232:235], a[176:179], v[192:195]
 v_accvgpr_write_b32 a244, v5
 v_mfma_f32_16x16x32_bf16 v[192:195], a[236:239], a[180:183], v[192:195]
 v_accvgpr_read_b32 v6, a245
 v_mfma_f32_16x16x32_bf16 v[196:199], a[236:239], a[188:191], v[196:199]
 v_mfma_f32_16x16x32_bf16 v[196:199], a[232:235], a[184:187], v[196:199]
 v_add_f32 v6, v6, v13
 s_waitcnt vmcnt(8)
 v_mfma_f32_16x16x32_bf16 v[228:231], a[192:195], a[184:187], v[228:231]
 v_accvgpr_write_b32 a245, v6
 v_mfma_f32_16x16x32_bf16 v[228:231], a[196:199], a[188:191], v[228:231]
 global_load_dwordx4 a[236:239], v0, s[70:71] offset:3072 sc1
 v_mfma_f32_16x16x32_bf16 v[224:227], a[196:199], a[180:183], v[224:227]
 v_accvgpr_read_b32 v5, a246
 v_mfma_f32_16x16x32_bf16 v[224:227], a[192:195], a[176:179], v[224:227]
 global_load_dwordx4 a[232:235], v0, s[70:71] offset:2048 sc1
 v_add_f32 v5, v5, v14
 v_mfma_f32_16x16x32_bf16 v[220:223], a[192:195], a[168:171], v[220:223]
 v_accvgpr_write_b32 a246, v5
 s_add_u32 s70, s70, 8192
 s_addc_u32 s71, s71, 0
 v_mfma_f32_16x16x32_bf16 v[220:223], a[196:199], a[172:175], v[220:223]
 v_mfma_f32_16x16x32_bf16 v[216:219], a[196:199], a[164:167], v[216:219]
 v_accvgpr_read_b32 v6, a247
 v_mfma_f32_16x16x32_bf16 v[216:219], a[192:195], a[160:163], v[216:219]
 v_add_f32 v6, v6, v15
 v_mfma_f32_16x16x32_bf16 v[212:215], a[192:195], a[152:155], v[212:215]
 v_mfma_f32_16x16x32_bf16 v[212:215], a[196:199], a[156:159], v[212:215]
 v_accvgpr_write_b32 a247, v6
 v_mfma_f32_16x16x32_bf16 v[208:211], a[196:199], a[148:151], v[208:211]
 v_cmp_gt_i32 vcc, s55, v4
 s_and_b64 vcc, exec, vcc
 s_cbranch_vccnz Lspin_pa
Lok_pa:
 s_add_u32 s55, s55, 1
 s_waitcnt lgkmcnt(0)
 s_barrier
 v_mfma_f32_16x16x32_bf16 v[208:211], a[192:195], a[144:147], v[208:211]
 v_mfma_f32_16x16x32_bf16 v[204:207], a[192:195], a[136:139], v[204:207]
 v_mfma_f32_16x16x32_bf16 v[204:207], a[196:199], a[140:143], v[204:207]
 v_mfma_f32_16x16x32_bf16 v[200:203], a[196:199], a[132:135], v[200:203]
 v_mfma_f32_16x16x32_bf16 v[200:203], a[192:195], a[128:131], v[200:203]
 s_waitcnt vmcnt(8)
 v_mfma_f32_16x16x32_bf16 v[232:235], a[200:203], a[128:131], v[232:235]
 ds_read_b128 a[128:131], v1 offset:2048
 v_mfma_f32_16x16x32_bf16 v[232:235], a[204:207], a[132:135], v[232:235]
 global_load_dwordx4 a[196:199], v0, s[70:71] offset:-3072 sc1
 ds_read_b128 a[132:135], v1 offset:3072
 v_mfma_f32_16x16x32_bf16 v[236:239], a[204:207], a[140:143], v[236:239]
 ds_read_b128 a[140:143], v1 offset:7168
 v_mfma_f32_16x16x32_bf16 v[236:239], a[200:203], a[136:139], v[236:239]
 global_load_dwordx4 a[192:195], v0, s[70:71] offset:-4096 sc1
 ds_read_b128 a[136:139], v1 offset:6144
 v_mfma_f32_16x16x32_bf16 v[240:243], a[200:203], a[144:147], v[240:243]
 ds_read_b128 a[144:147], v1 offset:10240
 v_mfma_f32_16x16x32_bf16 v[240:243], a[204:207], a[148:151], v[240:243]
 ds_read_b128 a[148:151], v1 offset:11264
 v_mfma_f32_16x16x32_bf16 v[244:247], a[204:207], a[156:159], v[244:247]
 ds_read_b128 a[156:159], v1 offset:15360
 v_mfma_f32_16x16x32_bf16 v[244:247], a[200:203], a[152:155], v[244:247]
 ds_read_b128 a[152:155], v1 offset:14336
 v_mfma_f32_16x16x32_bf16 v[248:251], a[200:203], a[160:163], v[248:251]
 ds_read_b128 a[160:163], v1 offset:18432
 v_mfma_f32_16x16x32_bf16 v[248:251], a[204:207], a[164:167], v[248:251]
 ds_read_b128 a[164:167], v1 offset:19456
 v_mfma_f32_16x16x32_bf16 v[252:255], a[204:207], a[172:175], v[252:255]
 ds_read_b128 a[172:175], v1 offset:23552
 v_mfma_f32_16x16x32_bf16 v[252:255], a[200:203], a[168:171], v[252:255]
 ds_read_b128 a[168:171], v1 offset:22528
 v_mfma_f32_16x16x32_bf16 a[248:251], a[200:203], a[176:179], a[248:251]
 ds_read_b128 a[176:179], v1 offset:26624
 v_mfma_f32_16x16x32_bf16 a[248:251], a[204:207], a[180:183], a[248:251]
 ds_read_b128 a[180:183], v1 offset:27648
 v_mfma_f32_16x16x32_bf16 a[252:255], a[204:207], a[188:191], a[252:255]
 global_load_dwordx4 a[204:207], v0, s[70:71] offset:-1024 sc1
 ds_read_b128 a[188:191], v1 offset:31744
 v_mfma_f32_16x16x32_bf16 a[252:255], a[200:203], a[184:187], a[252:255]
 global_load_dwordx4 a[200:203], v0, s[70:71] offset:-2048 sc1
 ds_read_b128 a[184:187], v1 offset:30720
 s_waitcnt vmcnt(10) lgkmcnt(8)
 s_branch Lloop
Llast:
 v_mfma_f32_16x16x32_bf16 v[136:139], a[208:211], a[128:131], v[136:139]
 v_accvgpr_read_b32 v5, a0
 v_lshlrev_b32 v6, 16, v5
 v_mfma_f32_16x16x32_bf16 v[136:139], a[212:215], a[132:135], v[136:139]
 v_and_b32 v5, s26, v5
 v_mul_f32 v6, v6, v16
 v_mfma_f32_16x16x32_bf16 v[140:143], a[212:215], a[140:143], v[140:143]
 v_mul_f32 v5, v5, v17
 v_cvt_pk_bf16_f32 v8, v6, v5
 v_mfma_f32_16x16x32_bf16 v[140:143], a[208:211], a[136:139], v[140:143]
 v_accvgpr_read_b32 v5, a1
 v_lshlrev_b32 v6, 16, v5
 v_mfma_f32_16x16x32_bf16 v[144:147], a[208:211], a[144:147], v[144:147]
 v_and_b32 v5, s26, v5
 v_mul_f32 v6, v6, v18
 v_mfma_f32_16x16x32_bf16 v[144:147], a[212:215], a[148:151], v[144:147]
 v_mul_f32 v5, v5, v19
 v_cvt_pk_bf16_f32 v9, v6, v5
 v_mfma_f32_16x16x32_bf16 v[148:151], a[212:215], a[156:159], v[148:151]
 v_accvgpr_read_b32 v5, a2
 v_lshlrev_b32 v6, 16, v5
 v_mfma_f32_16x16x32_bf16 v[148:151], a[208:211], a[152:155], v[148:151]
 v_and_b32 v5, s26, v5
 v_mul_f32 v6, v6, v48
 s_waitcnt lgkmcnt(0)
 v_mfma_f32_16x16x32_bf16 v[152:155], a[208:211], a[160:163], v[152:155]
 v_mul_f32 v5, v5, v49
 v_cvt_pk_bf16_f32 v10, v6, v5
 v_mfma_f32_16x16x32_bf16 v[152:155], a[212:215], a[164:167], v[152:155]
 v_accvgpr_read_b32 v5, a3
 v_lshlrev_b32 v6, 16, v5
 v_mfma_f32_16x16x32_bf16 v[156:159], a[212:215], a[172:175], v[156:159]
 v_and_b32 v5, s26, v5
 v_mul_f32 v6, v6, v50
 v_mfma_f32_16x16x32_bf16 v[156:159], a[208:211], a[168:171], v[156:159]
 v_mul_f32 v5, v5, v51
 v_cvt_pk_bf16_f32 v11, v6, v5
 v_mfma_f32_16x16x32_bf16 v[160:163], a[208:211], a[176:179], v[160:163]
 v_lshrrev_b32 v5, 7, v1
 v_lshlrev_b32 v6, 4, v5
 v_mfma_f32_16x16x32_bf16 v[160:163], a[212:215], a[180:183], v[160:163]
 v_xor_b32 v6, v6, v1
 v_and_b32 v6, 112, v6
 v_mfma_f32_16x16x32_bf16 v[164:167], a[212:215], a[188:191], v[164:167]
 v_lshl_add_u32 v16, v5, 11, v6
 v_lshrrev_b32 v5, 4, v1
 v_mfma_f32_16x16x32_bf16 v[164:167], a[208:211], a[184:187], v[164:167]
 v_and_b32 v5, 48, v5
 v_xor_b32 v5, v5, v1
 s_waitcnt vmcnt(8)
 v_mfma_f32_16x16x32_bf16 v[196:199], a[216:219], a[184:187], v[196:199]
 v_and_b32 v5, 112, v5
 v_and_b32 v6, 240, v1
 v_mfma_f32_16x16x32_bf16 v[196:199], a[220:223], a[188:191], v[196:199]
 global_load_dwordx4 a[212:215], v0, s[70:71] offset:1024 sc1
 v_lshl_add_u32 v5, v6, 3, v5
 v_mfma_f32_16x16x32_bf16 v[192:195], a[220:223], a[180:183], v[192:195]
 v_add_u32 v17, s50, v5
 v_xor_b32 v18, 64, v17
 v_mfma_f32_16x16x32_bf16 v[192:195], a[216:219], a[176:179], v[192:195]
 global_load_dwordx4 a[208:211], v0, s[70:71] offset:0 sc1
 ds_write_b128 v17, v[8:11]
 v_mfma_f32_16x16x32_bf16 v[188:191], a[216:219], a[168:171], v[188:191]
 v_accvgpr_read_b32 v5, a32
 v_lshlrev_b32 v6, 16, v5
 v_mfma_f32_16x16x32_bf16 v[188:191], a[220:223], a[172:175], v[188:191]
 v_and_b32 v5, s26, v5
 v_mul_f32 v6, v6, v80
 v_mfma_f32_16x16x32_bf16 v[184:187], a[220:223], a[164:167], v[184:187]
 v_mul_f32 v5, v5, v81
 v_cvt_pk_bf16_f32 v12, v6, v5
 v_mfma_f32_16x16x32_bf16 v[184:187], a[216:219], a[160:163], v[184:187]
 v_accvgpr_read_b32 v5, a33
 v_lshlrev_b32 v6, 16, v5
 v_mfma_f32_16x16x32_bf16 v[180:183], a[216:219], a[152:155], v[180:183]
 v_and_b32 v5, s26, v5
 v_mul_f32 v6, v6, v82
 v_mfma_f32_16x16x32_bf16 v[180:183], a[220:223], a[156:159], v[180:183]
 v_mul_f32 v5, v5, v83
 v_cvt_pk_bf16_f32 v13, v6, v5
 v_mfma_f32_16x16x32_bf16 v[176:179], a[220:223], a[148:151], v[176:179]
 v_accvgpr_read_b32 v5, a34
 v_lshlrev_b32 v6, 16, v5
 v_mfma_f32_16x16x32_bf16 v[176:179], a[216:219], a[144:147], v[176:179]
 v_and_b32 v5, s26, v5
 v_mul_f32 v6, v6, v112
 v_mfma_f32_16x16x32_bf16 v[172:175], a[216:219], a[136:139], v[172:175]
 v_mul_f32 v5, v5, v113
 v_cvt_pk_bf16_f32 v14, v6, v5
 v_mfma_f32_16x16x32_bf16 v[172:175], a[220:223], a[140:143], v[172:175]
 v_accvgpr_read_b32 v5, a35
 v_lshlrev_b32 v6, 16, v5
 v_mfma_f32_16x16x32_bf16 v[168:171], a[220:223], a[132:135], v[168:171]
 v_and_b32 v5, s26, v5
 v_mul_f32 v6, v6, v114
 v_mfma_f32_16x16x32_bf16 v[168:171], a[216:219], a[128:131], v[168:171]
 v_mul_f32 v5, v5, v115
 v_cvt_pk_bf16_f32 v15, v6, v5
 s_waitcnt vmcnt(8)
 v_mfma_f32_16x16x32_bf16 v[200:203], a[224:227], a[128:131], v[200:203]
 ds_write_b128 v18, v[12:15]
 v_mfma_f32_16x16x32_bf16 v[200:203], a[228:231], a[132:135], v[200:203]
 global_load_dwordx4 a[220:223], v0, s[70:71] offset:3072 sc1
 ds_read_b128 v[48:51], v3
 v_mfma_f32_16x16x32_bf16 v[204:207], a[228:231], a[140:143], v[204:207]
 ds_read_b128 v[80:83], v3 offset:1024
 v_accvgpr_read_b32 v5, a4
 v_mfma_f32_16x16x32_bf16 v[204:207], a[224:227], a[136:139], v[204:207]
 global_load_dwordx4 a[216:219], v0, s[70:71] offset:2048 sc1
 v_lshlrev_b32 v6, 16, v5
 v_mfma_f32_16x16x32_bf16 v[208:211], a[224:227], a[144:147], v[208:211]
 v_and_b32 v5, s26, v5
 v_mul_f32 v6, v6, v20
 s_add_u32 s70, s70, 8192
 s_addc_u32 s71, s71, 0
 v_mfma_f32_16x16x32_bf16 v[208:211], a[228:231], a[148:151], v[208:211]
 v_mul_f32 v5, v5, v21
 v_cvt_pk_bf16_f32 v8, v6, v5
 v_mfma_f32_16x16x32_bf16 v[212:215], a[228:231], a[156:159], v[212:215]
 v_accvgpr_read_b32 v5, a5
 v_lshlrev_b32 v6, 16, v5
 v_mfma_f32_16x16x32_bf16 v[212:215], a[224:227], a[152:155], v[212:215]
 v_and_b32 v5, s26, v5
 v_mul_f32 v6, v6, v22
 v_mfma_f32_16x16x32_bf16 v[216:219], a[224:227], a[160:163], v[216:219]
 v_mul_f32 v5, v5, v23
 v_cvt_pk_bf16_f32 v9, v6, v5
 s_waitcnt lgkmcnt(1)
 s_add_u32 s3, s28, 0
 v_mfma_f32_16x16x32_bf16 v[216:219], a[228:231], a[164:167], v[216:219]
 buffer_store_dwordx4 v[48:51], v16, s[16:19], s3 offen nt
 s_waitcnt lgkmcnt(0)
 s_add_u32 s3, s28, 16384
 buffer_store_dwordx4 v[80:83], v16, s[16:19], s3 offen nt
 v_accvgpr_read_b32 v5, a6
 v_lshlrev_b32 v6, 16, v5
 v_and_b32 v5, s26, v5
 v_mul_f32 v6, v6, v52
 v_mfma_f32_16x16x32_bf16 v[220:223], a[228:231], a[172:175], v[220:223]
 v_mul_f32 v5, v5, v53
 v_cvt_pk_bf16_f32 v10, v6, v5
 v_mfma_f32_16x16x32_bf16 v[220:223], a[224:227], a[168:171], v[220:223]
 v_accvgpr_read_b32 v5, a7
 v_lshlrev_b32 v6, 16, v5
 v_mfma_f32_16x16x32_bf16 v[224:227], a[224:227], a[176:179], v[224:227]
 v_and_b32 v5, s26, v5
 v_mul_f32 v6, v6, v54
 v_mul_f32 v5, v5, v55
 v_cvt_pk_bf16_f32 v11, v6, v5
 v_mfma_f32_16x16x32_bf16 v[224:227], a[228:231], a[180:183], v[224:227]
 ds_write_b128 v17, v[8:11] offset:4096
 v_mfma_f32_16x16x32_bf16 v[228:231], a[228:231], a[188:191], v[228:231]
 v_accvgpr_read_b32 v5, a36
 v_lshlrev_b32 v6, 16, v5
 v_mfma_f32_16x16x32_bf16 v[228:231], a[224:227], a[184:187], v[228:231]
 v_and_b32 v5, s26, v5
 v_mul_f32 v6, v6, v84
 s_waitcnt vmcnt(10)
 v_mfma_f32_16x16x32_bf16 a[252:255], a[232:235], a[184:187], a[252:255]
 ds_read_b128 a[184:187], v1 offset:63488
 v_mul_f32 v5, v5, v85
 v_mfma_f32_16x16x32_bf16 a[252:255], a[236:239], a[188:191], a[252:255]
 global_load_dwordx4 a[228:231], v0, s[70:71] offset:-3072 sc1
 ds_read_b128 a[188:191], v1 offset:64512
 v_mfma_f32_16x16x32_bf16 a[248:251], a[236:239], a[180:183], a[248:251]
 ds_read_b128 a[180:183], v1 offset:60416
 v_cvt_pk_bf16_f32 v12, v6, v5
 v_mfma_f32_16x16x32_bf16 a[248:251], a[232:235], a[176:179], a[248:251]
 global_load_dwordx4 a[224:227], v0, s[70:71] offset:-4096 sc1
 ds_read_b128 a[176:179], v1 offset:59392
 v_mfma_f32_16x16x32_bf16 v[252:255], a[232:235], a[168:171], v[252:255]
 ds_read_b128 a[168:171], v1 offset:55296
 v_accvgpr_read_b32 v5, a37
 v_mfma_f32_16x16x32_bf16 v[252:255], a[236:239], a[172:175], v[252:255]
 ds_read_b128 a[172:175], v1 offset:56320
 v_lshlrev_b32 v6, 16, v5
 v_mfma_f32_16x16x32_bf16 v[248:251], a[236:239], a[164:167], v[248:251]
 ds_read_b128 a[164:167], v1 offset:52224
 v_and_b32 v5, s26, v5
 v_mfma_f32_16x16x32_bf16 v[248:251], a[232:235], a[160:163], v[248:251]
 ds_read_b128 a[160:163], v1 offset:51200
 v_mul_f32 v6, v6, v86
 v_mul_f32 v5, v5, v87
 v_mfma_f32_16x16x32_bf16 v[244:247], a[232:235], a[152:155], v[244:247]
 ds_read_b128 a[152:155], v1 offset:47104
 v_cvt_pk_bf16_f32 v13, v6, v5
 v_mfma_f32_16x16x32_bf16 v[244:247], a[236:239], a[156:159], v[244:247]
 ds_read_b128 a[156:159], v1 offset:48128
 v_accvgpr_read_b32 v5, a38
 v_lshlrev_b32 v6, 16, v5
 v_mfma_f32_16x16x32_bf16 v[240:243], a[236:239], a[148:151], v[240:243]
 ds_read_b128 a[148:151], v1 offset:44032
 v_and_b32 v5, s26, v5
 v_mul_f32 v6, v6, v116
 v_mfma_f32_16x16x32_bf16 v[240:243], a[232:235], a[144:147], v[240:243]
 ds_read_b128 a[144:147], v1 offset:43008
 v_mul_f32 v5, v5, v117
 v_mfma_f32_16x16x32_bf16 v[236:239], a[232:235], a[136:139], v[236:239]
 ds_read_b128 a[136:139], v1 offset:38912
 v_cvt_pk_bf16_f32 v14, v6, v5
 v_mfma_f32_16x16x32_bf16 v[236:239], a[236:239], a[140:143], v[236:239]
 ds_read_b128 a[140:143], v1 offset:39936
 v_accvgpr_read_b32 v5, a39
 v_mfma_f32_16x16x32_bf16 v[232:235], a[236:239], a[132:135], v[232:235]
 ds_read_b128 a[132:135], v1 offset:35840
 v_lshlrev_b32 v6, 16, v5
 v_mfma_f32_16x16x32_bf16 v[232:235], a[232:235], a[128:131], v[232:235]
 ds_read_b128 a[128:131], v1 offset:34816
 v_and_b32 v5, s26, v5
 s_waitcnt vmcnt(10) lgkmcnt(8)
 v_mfma_f32_16x16x32_bf16 v[164:167], a[192:195], a[184:187], v[164:167]
 v_mul_f32 v6, v6, v118
 v_mul_f32 v5, v5, v119
 v_mfma_f32_16x16x32_bf16 v[164:167], a[196:199], a[188:191], v[164:167]
 global_load_dwordx4 a[236:239], v0, s[70:71] offset:-1024 sc1
 v_cvt_pk_bf16_f32 v15, v6, v5
 v_mfma_f32_16x16x32_bf16 v[160:163], a[196:199], a[180:183], v[160:163]
 ds_write_b128 v18, v[12:15] offset:4096
 ds_read_b128 v[48:51], v3 offset:4096
 v_mfma_f32_16x16x32_bf16 v[160:163], a[192:195], a[176:179], v[160:163]
 global_load_dwordx4 a[232:235], v0, s[70:71] offset:-2048 sc1
 ds_read_b128 v[80:83], v3 offset:5120
 v_mfma_f32_16x16x32_bf16 v[156:159], a[192:195], a[168:171], v[156:159]
 v_accvgpr_read_b32 v5, a8
 v_lshlrev_b32 v6, 16, v5
 v_mfma_f32_16x16x32_bf16 v[156:159], a[196:199], a[172:175], v[156:159]
 v_and_b32 v5, s26, v5
 v_mul_f32 v6, v6, v24
 v_mfma_f32_16x16x32_bf16 v[152:155], a[196:199], a[164:167], v[152:155]
 v_mul_f32 v5, v5, v25
 v_cvt_pk_bf16_f32 v8, v6, v5
 v_mfma_f32_16x16x32_bf16 v[152:155], a[192:195], a[160:163], v[152:155]
 v_accvgpr_read_b32 v5, a9
 v_lshlrev_b32 v6, 16, v5
 s_waitcnt lgkmcnt(3)
 v_mfma_f32_16x16x32_bf16 v[148:151], a[192:195], a[152:155], v[148:151]
 v_and_b32 v5, s26, v5
 v_mul_f32 v6, v6, v26
 v_mfma_f32_16x16x32_bf16 v[148:151], a[196:199], a[156:159], v[148:151]
 v_mul_f32 v5, v5, v27
 v_cvt_pk_bf16_f32 v9, v6, v5
 s_waitcnt lgkmcnt(1)
 s_add_u32 s3, s28, 32768
 v_mfma_f32_16x16x32_bf16 v[144:147], a[196:199], a[148:151], v[144:147]
 buffer_store_dwordx4 v[48:51], v16, s[16:19], s3 offen nt
 s_waitcnt lgkmcnt(0)
 s_add_u32 s3, s28, 49152
 buffer_store_dwordx4 v[80:83], v16, s[16:19], s3 offen nt
 v_accvgpr_read_b32 v5, a10
 v_lshlrev_b32 v6, 16, v5
 v_and_b32 v5, s26, v5
 v_mul_f32 v6, v6, v56
 v_mfma_f32_16x16x32_bf16 v[144:147], a[192:195], a[144:147], v[144:147]
 v_mul_f32 v5, v5, v57
 v_cvt_pk_bf16_f32 v10, v6, v5
 v_mfma_f32_16x16x32_bf16 v[140:143], a[192:195], a[136:139], v[140:143]
 v_accvgpr_read_b32 v5, a11
 v_lshlrev_b32 v6, 16, v5
 v_mfma_f32_16x16x32_bf16 v[140:143], a[196:199], a[140:143], v[140:143]
 v_and_b32 v5, s26, v5
 v_mul_f32 v6, v6, v58
 v_mfma_f32_16x16x32_bf16 v[136:139], a[196:199], a[132:135], v[136:139]
 v_mul_f32 v5, v5, v59
 v_cvt_pk_bf16_f32 v11, v6, v5
 v_mfma_f32_16x16x32_bf16 v[136:139], a[192:195], a[128:131], v[136:139]
 ds_write_b128 v17, v[8:11] offset:8192
 s_waitcnt vmcnt(12)
 v_mfma_f32_16x16x32_bf16 v[168:171], a[200:203], a[128:131], v[168:171]
 v_accvgpr_read_b32 v5, a40
 v_lshlrev_b32 v6, 16, v5
 v_mfma_f32_16x16x32_bf16 v[168:171], a[204:207], a[132:135], v[168:171]
 global_load_dwordx4 a[196:199], v0, s[70:71] offset:1024 sc1
 v_and_b32 v5, s26, v5
 v_mfma_f32_16x16x32_bf16 v[172:175], a[204:207], a[140:143], v[172:175]
 v_mul_f32 v6, v6, v88
 v_mul_f32 v5, v5, v89
 v_mfma_f32_16x16x32_bf16 v[172:175], a[200:203], a[136:139], v[172:175]
 global_load_dwordx4 a[192:195], v0, s[70:71] offset:0 sc1
 v_cvt_pk_bf16_f32 v12, v6, v5
 v_mfma_f32_16x16x32_bf16 v[176:179], a[200:203], a[144:147], v[176:179]
 v_accvgpr_read_b32 v5, a41
 v_lshlrev_b32 v6, 16, v5
 v_mfma_f32_16x16x32_bf16 v[176:179], a[204:207], a[148:151], v[176:179]
 v_and_b32 v5, s26, v5
 v_mul_f32 v6, v6, v90
 v_mfma_f32_16x16x32_bf16 v[180:183], a[204:207], a[156:159], v[180:183]
 v_mul_f32 v5, v5, v91
 v_cvt_pk_bf16_f32 v13, v6, v5
 v_mfma_f32_16x16x32_bf16 v[180:183], a[200:203], a[152:155], v[180:183]
 v_accvgpr_read_b32 v5, a42
 v_lshlrev_b32 v6, 16, v5
 v_mfma_f32_16x16x32_bf16 v[184:187], a[200:203], a[160:163], v[184:187]
 v_and_b32 v5, s26, v5
 v_mul_f32 v6, v6, v120
 v_mfma_f32_16x16x32_bf16 v[184:187], a[204:207], a[164:167], v[184:187]
 v_mul_f32 v5, v5, v121
 v_cvt_pk_bf16_f32 v14, v6, v5
 v_mfma_f32_16x16x32_bf16 v[188:191], a[204:207], a[172:175], v[188:191]
 v_accvgpr_read_b32 v5, a43
 v_lshlrev_b32 v6, 16, v5
 v_mfma_f32_16x16x32_bf16 v[188:191], a[200:203], a[168:171], v[188:191]
 v_and_b32 v5, s26, v5
 v_mul_f32 v6, v6, v122
 v_mfma_f32_16x16x32_bf16 v[192:195], a[200:203], a[176:179], v[192:195]
 v_mul_f32 v5, v5, v123
 v_cvt_pk_bf16_f32 v15, v6, v5
 v_mfma_f32_16x16x32_bf16 v[192:195], a[204:207], a[180:183], v[192:195]
 ds_write_b128 v18, v[12:15] offset:8192
 v_mfma_f32_16x16x32_bf16 v[196:199], a[204:207], a[188:191], v[196:199]
 ds_read_b128 v[48:51], v3 offset:8192
 ds_read_b128 v[80:83], v3 offset:9216
 v_mfma_f32_16x16x32_bf16 v[196:199], a[200:203], a[184:187], v[196:199]
 v_accvgpr_read_b32 v5, a12
 v_lshlrev_b32 v6, 16, v5
 s_waitcnt vmcnt(12)
 v_mfma_f32_16x16x32_bf16 v[228:231], a[208:211], a[184:187], v[228:231]
 v_and_b32 v5, s26, v5
 v_mul_f32 v6, v6, v28
 v_mfma_f32_16x16x32_bf16 v[228:231], a[212:215], a[188:191], v[228:231]
 global_load_dwordx4 a[204:207], v0, s[70:71] offset:3072 sc1
 v_mul_f32 v5, v5, v29
 v_mfma_f32_16x16x32_bf16 v[224:227], a[212:215], a[180:183], v[224:227]
 v_cvt_pk_bf16_f32 v8, v6, v5
 v_accvgpr_read_b32 v5, a13
 v_mfma_f32_16x16x32_bf16 v[224:227], a[208:211], a[176:179], v[224:227]
 global_load_dwordx4 a[200:203], v0, s[70:71] offset:2048 sc1
 v_lshlrev_b32 v6, 16, v5
 v_mfma_f32_16x16x32_bf16 v[220:223], a[208:211], a[168:171], v[220:223]
 v_and_b32 v5, s26, v5
 v_mul_f32 v6, v6, v30
 s_add_u32 s70, s70, 8192
 s_addc_u32 s71, s71, 0
 v_mfma_f32_16x16x32_bf16 v[220:223], a[212:215], a[172:175], v[220:223]
 v_mul_f32 v5, v5, v31
 v_cvt_pk_bf16_f32 v9, v6, v5
 s_waitcnt lgkmcnt(1)
 v_mfma_f32_16x16x32_bf16 v[216:219], a[212:215], a[164:167], v[216:219]
 s_add_u32 s3, s28, 65536
 buffer_store_dwordx4 v[48:51], v16, s[16:19], s3 offen nt
 s_waitcnt lgkmcnt(0)
 v_mfma_f32_16x16x32_bf16 v[216:219], a[208:211], a[160:163], v[216:219]
 s_add_u32 s3, s28, 81920
 buffer_store_dwordx4 v[80:83], v16, s[16:19], s3 offen nt
 v_accvgpr_read_b32 v5, a14
 v_lshlrev_b32 v6, 16, v5
 v_and_b32 v5, s26, v5
 v_mul_f32 v6, v6, v60
 v_mfma_f32_16x16x32_bf16 v[212:215], a[208:211], a[152:155], v[212:215]
 v_mul_f32 v5, v5, v61
 v_cvt_pk_bf16_f32 v10, v6, v5
 v_mfma_f32_16x16x32_bf16 v[212:215], a[212:215], a[156:159], v[212:215]
 v_accvgpr_read_b32 v5, a15
 v_lshlrev_b32 v6, 16, v5
 v_mfma_f32_16x16x32_bf16 v[208:211], a[212:215], a[148:151], v[208:211]
 v_and_b32 v5, s26, v5
 v_mul_f32 v6, v6, v62
 v_mfma_f32_16x16x32_bf16 v[208:211], a[208:211], a[144:147], v[208:211]
 v_mul_f32 v5, v5, v63
 v_cvt_pk_bf16_f32 v11, v6, v5
 v_mfma_f32_16x16x32_bf16 v[204:207], a[208:211], a[136:139], v[204:207]
 ds_write_b128 v17, v[8:11] offset:12288
 v_mfma_f32_16x16x32_bf16 v[204:207], a[212:215], a[140:143], v[204:207]
 v_accvgpr_read_b32 v5, a44
 v_lshlrev_b32 v6, 16, v5
 v_mfma_f32_16x16x32_bf16 v[200:203], a[212:215], a[132:135], v[200:203]
 v_and_b32 v5, s26, v5
 v_mul_f32 v6, v6, v92
 v_mfma_f32_16x16x32_bf16 v[200:203], a[208:211], a[128:131], v[200:203]
 v_mul_f32 v5, v5, v93
 v_cvt_pk_bf16_f32 v12, v6, v5
 s_waitcnt vmcnt(14)
 v_mfma_f32_16x16x32_bf16 v[232:235], a[216:219], a[128:131], v[232:235]
 ds_read_b128 a[128:131], v2 offset:2048
 v_accvgpr_read_b32 v5, a45
 v_mfma_f32_16x16x32_bf16 v[232:235], a[220:223], a[132:135], v[232:235]
 global_load_dwordx4 a[212:215], v0, s[70:71] offset:-3072 sc1
 ds_read_b128 a[132:135], v2 offset:3072
 v_mfma_f32_16x16x32_bf16 v[236:239], a[220:223], a[140:143], v[236:239]
 ds_read_b128 a[140:143], v2 offset:7168
 v_lshlrev_b32 v6, 16, v5
 v_mfma_f32_16x16x32_bf16 v[236:239], a[216:219], a[136:139], v[236:239]
 global_load_dwordx4 a[208:211], v0, s[70:71] offset:-4096 sc1
 ds_read_b128 a[136:139], v2 offset:6144
 v_and_b32 v5, s26, v5
 v_mfma_f32_16x16x32_bf16 v[240:243], a[216:219], a[144:147], v[240:243]
 ds_read_b128 a[144:147], v2 offset:10240
 v_mul_f32 v6, v6, v94
 v_mul_f32 v5, v5, v95
 v_mfma_f32_16x16x32_bf16 v[240:243], a[220:223], a[148:151], v[240:243]
 ds_read_b128 a[148:151], v2 offset:11264
 v_cvt_pk_bf16_f32 v13, v6, v5
 v_mfma_f32_16x16x32_bf16 v[244:247], a[220:223], a[156:159], v[244:247]
 ds_read_b128 a[156:159], v2 offset:15360
 v_accvgpr_read_b32 v5, a46
 v_lshlrev_b32 v6, 16, v5
 v_mfma_f32_16x16x32_bf16 v[244:247], a[216:219], a[152:155], v[244:247]
 ds_read_b128 a[152:155], v2 offset:14336
 v_and_b32 v5, s26, v5
 v_mul_f32 v6, v6, v124
 v_mfma_f32_16x16x32_bf16 v[248:251], a[216:219], a[160:163], v[248:251]
 ds_read_b128 a[160:163], v2 offset:18432
 v_mul_f32 v5, v5, v125
 v_mfma_f32_16x16x32_bf16 v[248:251], a[220:223], a[164:167], v[248:251]
 ds_read_b128 a[164:167], v2 offset:19456
 v_cvt_pk_bf16_f32 v14, v6, v5
 v_mfma_f32_16x16x32_bf16 v[252:255], a[220:223], a[172:175], v[252:255]
 ds_read_b128 a[172:175], v2 offset:23552
 v_accvgpr_read_b32 v5, a47
 v_mfma_f32_16x16x32_bf16 v[252:255], a[216:219], a[168:171], v[252:255]
 ds_read_b128 a[168:171], v2 offset:22528
 v_lshlrev_b32 v6, 16, v5
 v_mfma_f32_16x16x32_bf16 a[248:251], a[216:219], a[176:179], a[248:251]
 ds_read_b128 a[176:179], v2 offset:26624
 v_and_b32 v5, s26, v5
 v_mfma_f32_16x16x32_bf16 a[248:251], a[220:223], a[180:183], a[248:251]
 ds_read_b128 a[180:183], v2 offset:27648
 v_mul_f32 v6, v6, v126
 v_mfma_f32_16x16x32_bf16 a[252:255], a[220:223], a[188:191], a[252:255]
 ds_read_b128 a[188:191], v2 offset:31744
 v_mul_f32 v5, v5, v127
 v_mfma_f32_16x16x32_bf16 a[252:255], a[216:219], a[184:187], a[252:255]
 ds_read_b128 a[184:187], v2 offset:30720
 v_cvt_pk_bf16_f32 v15, v6, v5
 s_waitcnt vmcnt(12) lgkmcnt(8)
 v_mfma_f32_16x16x32_bf16 v[136:139], a[224:227], a[128:131], v[136:139]
 ds_write_b128 v18, v[12:15] offset:12288
 ds_read_b128 v[48:51], v3 offset:12288
 ds_read_b128 v[80:83], v3 offset:13312
 v_mfma_f32_16x16x32_bf16 v[136:139], a[228:231], a[132:135], v[136:139]
 global_load_dwordx4 a[220:223], v0, s[70:71] offset:-1024 sc1
 v_accvgpr_read_b32 v5, a16
 v_mfma_f32_16x16x32_bf16 v[140:143], a[228:231], a[140:143], v[140:143]
 v_lshlrev_b32 v6, 16, v5
 v_and_b32 v5, s26, v5
 v_mfma_f32_16x16x32_bf16 v[140:143], a[224:227], a[136:139], v[140:143]
 global_load_dwordx4 a[216:219], v0, s[70:71] offset:-2048 sc1
 v_mul_f32 v6, v6, v32
 v_mfma_f32_16x16x32_bf16 v[144:147], a[224:227], a[144:147], v[144:147]
 v_mul_f32 v5, v5, v33
 v_cvt_pk_bf16_f32 v8, v6, v5
 v_mfma_f32_16x16x32_bf16 v[144:147], a[228:231], a[148:151], v[144:147]
 v_accvgpr_read_b32 v5, a17
 v_lshlrev_b32 v6, 16, v5
 v_mfma_f32_16x16x32_bf16 v[148:151], a[228:231], a[156:159], v[148:151]
 v_and_b32 v5, s26, v5
 v_mul_f32 v6, v6, v34
 v_mfma_f32_16x16x32_bf16 v[148:151], a[224:227], a[152:155], v[148:151]
 v_mul_f32 v5, v5, v35
 v_cvt_pk_bf16_f32 v9, v6, v5
 s_waitcnt lgkmcnt(1)
 s_add_u32 s3, s28, 98304
 v_mfma_f32_16x16x32_bf16 v[152:155], a[224:227], a[160:163], v[152:155]
 buffer_store_dwordx4 v[48:51], v16, s[16:19], s3 offen nt
 s_waitcnt lgkmcnt(0)
 s_add_u32 s3, s28, 114688
 buffer_store_dwordx4 v[80:83], v16, s[16:19], s3 offen nt
 v_accvgpr_read_b32 v5, a18
 v_lshlrev_b32 v6, 16, v5
 v_and_b32 v5, s26, v5
 v_mul_f32 v6, v6, v64
 v_mfma_f32_16x16x32_bf16 v[152:155], a[228:231], a[164:167], v[152:155]
 v_mul_f32 v5, v5, v65
 v_cvt_pk_bf16_f32 v10, v6, v5
 v_mfma_f32_16x16x32_bf16 v[156:159], a[228:231], a[172:175], v[156:159]
 v_accvgpr_read_b32 v5, a19
 v_lshlrev_b32 v6, 16, v5
 v_mfma_f32_16x16x32_bf16 v[156:159], a[224:227], a[168:171], v[156:159]
 v_and_b32 v5, s26, v5
 v_mul_f32 v6, v6, v66
 v_mfma_f32_16x16x32_bf16 v[160:163], a[224:227], a[176:179], v[160:163]
 v_mul_f32 v5, v5, v67
 v_cvt_pk_bf16_f32 v11, v6, v5
 v_mfma_f32_16x16x32_bf16 v[160:163], a[228:231], a[180:183], v[160:163]
 ds_write_b128 v17, v[8:11] offset:16384
 v_mfma_f32_16x16x32_bf16 v[164:167], a[228:231], a[188:191], v[164:167]
 v_accvgpr_read_b32 v5, a48
 v_lshlrev_b32 v6, 16, v5
 v_mfma_f32_16x16x32_bf16 v[164:167], a[224:227], a[184:187], v[164:167]
 v_and_b32 v5, s26, v5
 v_mul_f32 v6, v6, v96
 s_waitcnt vmcnt(14)
 v_mfma_f32_16x16x32_bf16 v[196:199], a[232:235], a[184:187], v[196:199]
 v_mul_f32 v5, v5, v97
 v_cvt_pk_bf16_f32 v12, v6, v5
 v_mfma_f32_16x16x32_bf16 v[196:199], a[236:239], a[188:191], v[196:199]
 global_load_dwordx4 a[228:231], v0, s[70:71] offset:1024 sc1
 v_accvgpr_read_b32 v5, a49
 v_mfma_f32_16x16x32_bf16 v[192:195], a[236:239], a[180:183], v[192:195]
 v_lshlrev_b32 v6, 16, v5
 v_and_b32 v5, s26, v5
 v_mfma_f32_16x16x32_bf16 v[192:195], a[232:235], a[176:179], v[192:195]
 global_load_dwordx4 a[224:227], v0, s[70:71] offset:0 sc1
 v_mul_f32 v6, v6, v98
 v_mfma_f32_16x16x32_bf16 v[188:191], a[232:235], a[168:171], v[188:191]
 v_mul_f32 v5, v5, v99
 v_cvt_pk_bf16_f32 v13, v6, v5
 v_mfma_f32_16x16x32_bf16 v[188:191], a[236:239], a[172:175], v[188:191]
 v_accvgpr_read_b32 v5, a50
 v_lshlrev_b32 v6, 16, v5
 v_mfma_f32_16x16x32_bf16 v[184:187], a[236:239], a[164:167], v[184:187]
 v_and_b32 v5, s26, v5
 v_mul_f32 v6, v6, v128
 v_mfma_f32_16x16x32_bf16 v[184:187], a[232:235], a[160:163], v[184:187]
 v_mul_f32 v5, v5, v129
 v_cvt_pk_bf16_f32 v14, v6, v5
 v_mfma_f32_16x16x32_bf16 v[180:183], a[232:235], a[152:155], v[180:183]
 v_accvgpr_read_b32 v5, a51
 v_lshlrev_b32 v6, 16, v5
 v_mfma_f32_16x16x32_bf16 v[180:183], a[236:239], a[156:159], v[180:183]
 v_and_b32 v5, s26, v5
 v_mul_f32 v6, v6, v130
 v_mfma_f32_16x16x32_bf16 v[176:179], a[236:239], a[148:151], v[176:179]
 v_mul_f32 v5, v5, v131
 v_cvt_pk_bf16_f32 v15, v6, v5
 v_mfma_f32_16x16x32_bf16 v[176:179], a[232:235], a[144:147], v[176:179]
 ds_write_b128 v18, v[12:15] offset:16384
 v_mfma_f32_16x16x32_bf16 v[172:175], a[232:235], a[136:139], v[172:175]
 ds_read_b128 v[48:51], v3 offset:16384
 ds_read_b128 v[80:83], v3 offset:17408
 v_mfma_f32_16x16x32_bf16 v[172:175], a[236:239], a[140:143], v[172:175]
 v_accvgpr_read_b32 v5, a20
 v_lshlrev_b32 v6, 16, v5
 v_mfma_f32_16x16x32_bf16 v[168:171], a[236:239], a[132:135], v[168:171]
 v_and_b32 v5, s26, v5
 v_mul_f32 v6, v6, v36
 v_mfma_f32_16x16x32_bf16 v[168:171], a[232:235], a[128:131], v[168:171]
 v_mul_f32 v5, v5, v37
 v_cvt_pk_bf16_f32 v8, v6, v5
 s_waitcnt vmcnt(12)
 v_mfma_f32_16x16x32_bf16 v[200:203], a[192:195], a[128:131], v[200:203]
 v_accvgpr_read_b32 v5, a21
 v_lshlrev_b32 v6, 16, v5
 v_mfma_f32_16x16x32_bf16 v[200:203], a[196:199], a[132:135], v[200:203]
 global_load_dwordx4 a[236:239], v0, s[70:71] offset:3072 sc1
 v_and_b32 v5, s26, v5
 v_mfma_f32_16x16x32_bf16 v[204:207], a[196:199], a[140:143], v[204:207]
 v_mul_f32 v6, v6, v38
 v_mul_f32 v5, v5, v39
 v_mfma_f32_16x16x32_bf16 v[204:207], a[192:195], a[136:139], v[204:207]
 global_load_dwordx4 a[232:235], v0, s[70:71] offset:2048 sc1
 v_cvt_pk_bf16_f32 v9, v6, v5
 s_waitcnt lgkmcnt(1)
 s_add_u32 s3, s28, 131072
 v_mfma_f32_16x16x32_bf16 v[208:211], a[192:195], a[144:147], v[208:211]
 buffer_store_dwordx4 v[48:51], v16, s[16:19], s3 offen nt
 s_waitcnt lgkmcnt(0)
 s_add_u32 s3, s28, 147456
 s_add_u32 s70, s70, 1843200
 s_addc_u32 s71, s71, 0
 v_mfma_f32_16x16x32_bf16 v[208:211], a[196:199], a[148:151], v[208:211]
 buffer_store_dwordx4 v[80:83], v16, s[16:19], s3 offen nt
 v_accvgpr_read_b32 v5, a22
 v_lshlrev_b32 v6, 16, v5
 v_and_b32 v5, s26, v5
 v_mul_f32 v6, v6, v68
 v_mfma_f32_16x16x32_bf16 v[212:215], a[196:199], a[156:159], v[212:215]
 v_mul_f32 v5, v5, v69
 v_cvt_pk_bf16_f32 v10, v6, v5
 v_mfma_f32_16x16x32_bf16 v[212:215], a[192:195], a[152:155], v[212:215]
 v_accvgpr_read_b32 v5, a23
 v_lshlrev_b32 v6, 16, v5
 v_mfma_f32_16x16x32_bf16 v[216:219], a[192:195], a[160:163], v[216:219]
 v_and_b32 v5, s26, v5
 v_mul_f32 v6, v6, v70
 v_mfma_f32_16x16x32_bf16 v[216:219], a[196:199], a[164:167], v[216:219]
 v_mul_f32 v5, v5, v71
 v_cvt_pk_bf16_f32 v11, v6, v5
 v_mfma_f32_16x16x32_bf16 v[220:223], a[196:199], a[172:175], v[220:223]
 ds_write_b128 v17, v[8:11] offset:20480
 v_mfma_f32_16x16x32_bf16 v[220:223], a[192:195], a[168:171], v[220:223]
 v_accvgpr_read_b32 v5, a52
 v_lshlrev_b32 v6, 16, v5
 v_mfma_f32_16x16x32_bf16 v[224:227], a[192:195], a[176:179], v[224:227]
 v_and_b32 v5, s26, v5
 v_mul_f32 v6, v6, v100
 v_mfma_f32_16x16x32_bf16 v[224:227], a[196:199], a[180:183], v[224:227]
 v_mul_f32 v5, v5, v101
 v_cvt_pk_bf16_f32 v12, v6, v5
 v_mfma_f32_16x16x32_bf16 v[228:231], a[196:199], a[188:191], v[228:231]
 v_accvgpr_read_b32 v5, a53
 v_lshlrev_b32 v6, 16, v5
 v_mfma_f32_16x16x32_bf16 v[228:231], a[192:195], a[184:187], v[228:231]
 v_and_b32 v5, s26, v5
 v_mul_f32 v6, v6, v102
 s_waitcnt vmcnt(14)
 v_mfma_f32_16x16x32_bf16 a[252:255], a[200:203], a[184:187], a[252:255]
 ds_read_b128 a[184:187], v2 offset:63488
 v_mul_f32 v5, v5, v103
 v_mfma_f32_16x16x32_bf16 a[252:255], a[204:207], a[188:191], a[252:255]
 ds_read_b128 a[188:191], v2 offset:64512
 v_cvt_pk_bf16_f32 v13, v6, v5
 v_mfma_f32_16x16x32_bf16 a[248:251], a[204:207], a[180:183], a[248:251]
 ds_read_b128 a[180:183], v2 offset:60416
 v_accvgpr_read_b32 v5, a54
 v_mfma_f32_16x16x32_bf16 a[248:251], a[200:203], a[176:179], a[248:251]
 ds_read_b128 a[176:179], v2 offset:59392
 v_lshlrev_b32 v6, 16, v5
 v_mfma_f32_16x16x32_bf16 v[252:255], a[200:203], a[168:171], v[252:255]
 ds_read_b128 a[168:171], v2 offset:55296
 v_and_b32 v5, s26, v5
 v_mfma_f32_16x16x32_bf16 v[252:255], a[204:207], a[172:175], v[252:255]
 ds_read_b128 a[172:175], v2 offset:56320
 v_mul_f32 v6, v6, v132
 v_mfma_f32_16x16x32_bf16 v[248:251], a[204:207], a[164:167], v[248:251]
 ds_read_b128 a[164:167], v2 offset:52224
 v_mul_f32 v5, v5, v133
 v_mfma_f32_16x16x32_bf16 v[248:251], a[200:203], a[160:163], v[248:251]
 ds_read_b128 a[160:163], v2 offset:51200
 v_cvt_pk_bf16_f32 v14, v6, v5
 v_mfma_f32_16x16x32_bf16 v[244:247], a[200:203], a[152:155], v[244:247]
 ds_read_b128 a[152:155], v2 offset:47104
 v_accvgpr_read_b32 v5, a55
 v_mfma_f32_16x16x32_bf16 v[244:247], a[204:207], a[156:159], v[244:247]
 ds_read_b128 a[156:159], v2 offset:48128
 v_lshlrev_b32 v6, 16, v5
 v_mfma_f32_16x16x32_bf16 v[240:243], a[204:207], a[148:151], v[240:243]
 ds_read_b128 a[148:151], v2 offset:44032
 v_and_b32 v5, s26, v5
 v_mfma_f32_16x16x32_bf16 v[240:243], a[200:203], a[144:147], v[240:243]
 ds_read_b128 a[144:147], v2 offset:43008
 v_mul_f32 v6, v6, v134
 v_mfma_f32_16x16x32_bf16 v[236:239], a[200:203], a[136:139], v[236:239]
 ds_read_b128 a[136:139], v2 offset:38912
 v_mul_f32 v5, v5, v135
 v_mfma_f32_16x16x32_bf16 v[236:239], a[204:207], a[140:143], v[236:239]
 ds_read_b128 a[140:143], v2 offset:39936
 v_cvt_pk_bf16_f32 v15, v6, v5
 v_mfma_f32_16x16x32_bf16 v[232:235], a[204:207], a[132:135], v[232:235]
 ds_read_b128 a[132:135], v2 offset:35840
 v_mfma_f32_16x16x32_bf16 v[232:235], a[200:203], a[128:131], v[232:235]
 ds_read_b128 a[128:131], v2 offset:34816
 ds_write_b128 v18, v[12:15] offset:20480
 ds_read_b128 v[48:51], v3 offset:20480
 ds_read_b128 v[80:83], v3 offset:21504
 v_accvgpr_read_b32 v5, a24
 v_lshlrev_b32 v6, 16, v5
 s_waitcnt vmcnt(10) lgkmcnt(11)
 v_mfma_f32_16x16x32_bf16 v[164:167], a[208:211], a[184:187], v[164:167]
 v_and_b32 v5, s26, v5
 v_mul_f32 v6, v6, v40
 v_mfma_f32_16x16x32_bf16 v[164:167], a[212:215], a[188:191], v[164:167]
 v_mul_f32 v5, v5, v41
 v_cvt_pk_bf16_f32 v8, v6, v5
 v_mfma_f32_16x16x32_bf16 v[160:163], a[212:215], a[180:183], v[160:163]
 v_accvgpr_read_b32 v5, a25
 v_lshlrev_b32 v6, 16, v5
 v_mfma_f32_16x16x32_bf16 v[160:163], a[208:211], a[176:179], v[160:163]
 v_and_b32 v5, s26, v5
 v_mul_f32 v6, v6, v42
 v_mfma_f32_16x16x32_bf16 v[156:159], a[208:211], a[168:171], v[156:159]
 v_mul_f32 v5, v5, v43
 v_cvt_pk_bf16_f32 v9, v6, v5
 s_waitcnt lgkmcnt(1)
 s_add_u32 s3, s28, 163840
 v_mfma_f32_16x16x32_bf16 v[156:159], a[212:215], a[172:175], v[156:159]
 buffer_store_dwordx4 v[48:51], v16, s[16:19], s3 offen nt
 s_waitcnt lgkmcnt(0)
 s_add_u32 s3, s28, 180224
 buffer_store_dwordx4 v[80:83], v16, s[16:19], s3 offen nt
 v_accvgpr_read_b32 v5, a26
 v_lshlrev_b32 v6, 16, v5
 v_and_b32 v5, s26, v5
 v_mul_f32 v6, v6, v72
 v_mfma_f32_16x16x32_bf16 v[152:155], a[212:215], a[164:167], v[152:155]
 v_mul_f32 v5, v5, v73
 v_cvt_pk_bf16_f32 v10, v6, v5
 v_mfma_f32_16x16x32_bf16 v[152:155], a[208:211], a[160:163], v[152:155]
 v_accvgpr_read_b32 v5, a27
 v_lshlrev_b32 v6, 16, v5
 v_mfma_f32_16x16x32_bf16 v[148:151], a[208:211], a[152:155], v[148:151]
 v_and_b32 v5, s26, v5
 v_mul_f32 v6, v6, v74
 v_mfma_f32_16x16x32_bf16 v[148:151], a[212:215], a[156:159], v[148:151]
 v_mul_f32 v5, v5, v75
 v_cvt_pk_bf16_f32 v11, v6, v5
 v_mfma_f32_16x16x32_bf16 v[144:147], a[212:215], a[148:151], v[144:147]
 ds_write_b128 v17, v[8:11] offset:24576
 v_mfma_f32_16x16x32_bf16 v[144:147], a[208:211], a[144:147], v[144:147]
 v_accvgpr_read_b32 v5, a56
 v_lshlrev_b32 v6, 16, v5
 v_mfma_f32_16x16x32_bf16 v[140:143], a[208:211], a[136:139], v[140:143]
 v_and_b32 v5, s26, v5
 v_mul_f32 v6, v6, v104
 v_mfma_f32_16x16x32_bf16 v[140:143], a[212:215], a[140:143], v[140:143]
 v_mul_f32 v5, v5, v105
 v_cvt_pk_bf16_f32 v12, v6, v5
 v_mfma_f32_16x16x32_bf16 v[136:139], a[212:215], a[132:135], v[136:139]
 v_accvgpr_read_b32 v5, a57
 v_lshlrev_b32 v6, 16, v5
 v_mfma_f32_16x16x32_bf16 v[136:139], a[208:211], a[128:131], v[136:139]
 v_and_b32 v5, s26, v5
 v_mul_f32 v6, v6, v106
 s_waitcnt vmcnt(10)
 v_mfma_f32_16x16x32_bf16 v[168:171], a[216:219], a[128:131], v[168:171]
 v_mul_f32 v5, v5, v107
 v_cvt_pk_bf16_f32 v13, v6, v5
 v_mfma_f32_16x16x32_bf16 v[168:171], a[220:223], a[132:135], v[168:171]
 v_accvgpr_read_b32 v5, a58
 v_accvgpr_read_b32 v7, a240
 v_mfma_f32_16x16x32_bf16 v[172:175], a[220:223], a[140:143], v[172:175]
 v_lshlrev_b32 v6, 16, v5
 v_and_b32 v5, s26, v5
 v_mfma_f32_16x16x32_bf16 v[172:175], a[216:219], a[136:139], v[172:175]
 v_mul_f32 v6, v6, v7
 v_accvgpr_read_b32 v7, a241
 v_mfma_f32_16x16x32_bf16 v[176:179], a[216:219], a[144:147], v[176:179]
 v_mul_f32 v5, v5, v7
 v_cvt_pk_bf16_f32 v14, v6, v5
 v_mfma_f32_16x16x32_bf16 v[176:179], a[220:223], a[148:151], v[176:179]
 v_accvgpr_read_b32 v5, a59
 v_accvgpr_read_b32 v7, a242
 v_mfma_f32_16x16x32_bf16 v[180:183], a[220:223], a[156:159], v[180:183]
 v_lshlrev_b32 v6, 16, v5
 v_and_b32 v5, s26, v5
 v_mfma_f32_16x16x32_bf16 v[180:183], a[216:219], a[152:155], v[180:183]
 v_mul_f32 v6, v6, v7
 v_accvgpr_read_b32 v7, a243
 v_mfma_f32_16x16x32_bf16 v[184:187], a[216:219], a[160:163], v[184:187]
 v_mul_f32 v5, v5, v7
 v_cvt_pk_bf16_f32 v15, v6, v5
 v_mfma_f32_16x16x32_bf16 v[184:187], a[220:223], a[164:167], v[184:187]
 ds_write_b128 v18, v[12:15] offset:24576
 v_mfma_f32_16x16x32_bf16 v[188:191], a[220:223], a[172:175], v[188:191]
 ds_read_b128 v[48:51], v3 offset:24576
 ds_read_b128 v[80:83], v3 offset:25600
 v_mfma_f32_16x16x32_bf16 v[188:191], a[216:219], a[168:171], v[188:191]
 v_accvgpr_read_b32 v5, a28
 v_mfma_f32_16x16x32_bf16 v[192:195], a[216:219], a[176:179], v[192:195]
 v_lshlrev_b32 v6, 16, v5
 v_and_b32 v5, s26, v5
 v_mfma_f32_16x16x32_bf16 v[192:195], a[220:223], a[180:183], v[192:195]
 v_mul_f32 v6, v6, v44
 v_mul_f32 v5, v5, v45
 v_mfma_f32_16x16x32_bf16 v[196:199], a[220:223], a[188:191], v[196:199]
 v_cvt_pk_bf16_f32 v8, v6, v5
 v_accvgpr_read_b32 v5, a29
 v_mfma_f32_16x16x32_bf16 v[196:199], a[216:219], a[184:187], v[196:199]
 v_lshlrev_b32 v6, 16, v5
 v_and_b32 v5, s26, v5
 s_waitcnt vmcnt(6)
 v_mfma_f32_16x16x32_bf16 v[228:231], a[224:227], a[184:187], v[228:231]
 v_mul_f32 v6, v6, v46
 v_mul_f32 v5, v5, v47
 v_mfma_f32_16x16x32_bf16 v[228:231], a[228:231], a[188:191], v[228:231]
 v_cvt_pk_bf16_f32 v9, v6, v5
 s_waitcnt lgkmcnt(1)
 v_mfma_f32_16x16x32_bf16 v[224:227], a[228:231], a[180:183], v[224:227]
 s_add_u32 s3, s28, 196608
 buffer_store_dwordx4 v[48:51], v16, s[16:19], s3 offen nt
 v_mfma_f32_16x16x32_bf16 v[224:227], a[224:227], a[176:179], v[224:227]
 s_waitcnt lgkmcnt(0)
 s_add_u32 s3, s28, 212992
 v_mfma_f32_16x16x32_bf16 v[220:223], a[224:227], a[168:171], v[220:223]
 buffer_store_dwordx4 v[80:83], v16, s[16:19], s3 offen nt
 v_accvgpr_read_b32 v5, a30
 v_mfma_f32_16x16x32_bf16 v[220:223], a[228:231], a[172:175], v[220:223]
 v_lshlrev_b32 v6, 16, v5
 v_mfma_f32_16x16x32_bf16 v[216:219], a[228:231], a[164:167], v[216:219]
 v_and_b32 v5, s26, v5
 v_mul_f32 v6, v6, v76
 v_mfma_f32_16x16x32_bf16 v[216:219], a[224:227], a[160:163], v[216:219]
 v_mul_f32 v5, v5, v77
 v_cvt_pk_bf16_f32 v10, v6, v5
 v_mfma_f32_16x16x32_bf16 v[212:215], a[224:227], a[152:155], v[212:215]
 v_accvgpr_read_b32 v5, a31
 v_lshlrev_b32 v6, 16, v5
 v_mfma_f32_16x16x32_bf16 v[212:215], a[228:231], a[156:159], v[212:215]
 v_and_b32 v5, s26, v5
 v_mul_f32 v6, v6, v78
 v_mfma_f32_16x16x32_bf16 v[208:211], a[228:231], a[148:151], v[208:211]
 v_mul_f32 v5, v5, v79
 v_cvt_pk_bf16_f32 v11, v6, v5
 v_mfma_f32_16x16x32_bf16 v[208:211], a[224:227], a[144:147], v[208:211]
 ds_write_b128 v17, v[8:11] offset:28672
 v_mfma_f32_16x16x32_bf16 v[204:207], a[224:227], a[136:139], v[204:207]
 v_accvgpr_read_b32 v5, a60
 v_lshlrev_b32 v6, 16, v5
 v_mfma_f32_16x16x32_bf16 v[204:207], a[228:231], a[140:143], v[204:207]
 v_and_b32 v5, s26, v5
 v_mul_f32 v6, v6, v108
 v_mfma_f32_16x16x32_bf16 v[200:203], a[228:231], a[132:135], v[200:203]
 v_mul_f32 v5, v5, v109
 v_cvt_pk_bf16_f32 v12, v6, v5
 v_mfma_f32_16x16x32_bf16 v[200:203], a[224:227], a[128:131], v[200:203]
 v_accvgpr_read_b32 v5, a61
 v_lshlrev_b32 v6, 16, v5
 s_waitcnt vmcnt(6)
 v_mfma_f32_16x16x32_bf16 v[232:235], a[232:235], a[128:131], v[232:235]
 v_and_b32 v5, s26, v5
 v_mul_f32 v6, v6, v110
 v_mfma_f32_16x16x32_bf16 v[232:235], a[236:239], a[132:135], v[232:235]
 v_mul_f32 v5, v5, v111
 v_cvt_pk_bf16_f32 v13, v6, v5
 v_mfma_f32_16x16x32_bf16 v[236:239], a[236:239], a[140:143], v[236:239]
 v_accvgpr_read_b32 v5, a62
 v_accvgpr_read_b32 v7, a244
 v_mfma_f32_16x16x32_bf16 v[236:239], a[232:235], a[136:139], v[236:239]
 v_lshlrev_b32 v6, 16, v5
 v_and_b32 v5, s26, v5
 v_mfma_f32_16x16x32_bf16 v[240:243], a[232:235], a[144:147], v[240:243]
 v_mul_f32 v6, v6, v7
 v_accvgpr_read_b32 v7, a245
 v_mfma_f32_16x16x32_bf16 v[240:243], a[236:239], a[148:151], v[240:243]
 v_mul_f32 v5, v5, v7
 v_cvt_pk_bf16_f32 v14, v6, v5
 v_mfma_f32_16x16x32_bf16 v[244:247], a[236:239], a[156:159], v[244:247]
 v_accvgpr_read_b32 v5, a63
 v_accvgpr_read_b32 v7, a246
 v_mfma_f32_16x16x32_bf16 v[244:247], a[232:235], a[152:155], v[244:247]
 v_lshlrev_b32 v6, 16, v5
 v_and_b32 v5, s26, v5
 v_mfma_f32_16x16x32_bf16 v[248:251], a[232:235], a[160:163], v[248:251]
 v_mul_f32 v6, v6, v7
 v_accvgpr_read_b32 v7, a247
 v_mfma_f32_16x16x32_bf16 v[248:251], a[236:239], a[164:167], v[248:251]
 v_mul_f32 v5, v5, v7
 v_cvt_pk_bf16_f32 v15, v6, v5
 v_mfma_f32_16x16x32_bf16 v[252:255], a[236:239], a[172:175], v[252:255]
 ds_write_b128 v18, v[12:15] offset:28672
 v_mfma_f32_16x16x32_bf16 v[252:255], a[232:235], a[168:171], v[252:255]
 ds_read_b128 v[48:51], v3 offset:28672
 ds_read_b128 v[80:83], v3 offset:29696
 v_mfma_f32_16x16x32_bf16 a[248:251], a[232:235], a[176:179], a[248:251]
 s_waitcnt lgkmcnt(1)
 s_add_u32 s3, s28, 229376
 v_mfma_f32_16x16x32_bf16 a[248:251], a[236:239], a[180:183], a[248:251]
 buffer_store_dwordx4 v[48:51], v16, s[16:19], s3 offen nt
 s_waitcnt lgkmcnt(0)
 v_mfma_f32_16x16x32_bf16 a[252:255], a[236:239], a[188:191], a[252:255]
 s_add_u32 s3, s28, 245760
 buffer_store_dwordx4 v[80:83], v16, s[16:19], s3 offen nt
 v_mfma_f32_16x16x32_bf16 a[252:255], a[232:235], a[184:187], a[252:255]
 s_nop 7
 v_accvgpr_read_b32 v7, a64
 v_lshlrev_b32 v6, 16, v7
 v_and_b32 v7, s26, v7
 v_pk_mul_f32 v[6:7], v[6:7], v[136:137]
 v_cvt_pk_bf16_f32 v8, v6, v7
 v_accvgpr_read_b32 v7, a65
 v_lshlrev_b32 v6, 16, v7
 v_and_b32 v7, s26, v7
 v_pk_mul_f32 v[6:7], v[6:7], v[138:139]
 v_cvt_pk_bf16_f32 v9, v6, v7
 v_accvgpr_read_b32 v7, a66
 v_lshlrev_b32 v6, 16, v7
 v_and_b32 v7, s26, v7
 v_pk_mul_f32 v[6:7], v[6:7], v[168:169]
 v_cvt_pk_bf16_f32 v10, v6, v7
 v_accvgpr_read_b32 v7, a67
 v_lshlrev_b32 v6, 16, v7
 v_and_b32 v7, s26, v7
 v_pk_mul_f32 v[6:7], v[6:7], v[170:171]
 v_cvt_pk_bf16_f32 v11, v6, v7
 ds_write_b128 v17, v[8:11]
 v_accvgpr_read_b32 v7, a96
 v_lshlrev_b32 v6, 16, v7
 v_and_b32 v7, s26, v7
 v_pk_mul_f32 v[6:7], v[6:7], v[200:201]
 v_cvt_pk_bf16_f32 v12, v6, v7
 v_accvgpr_read_b32 v7, a97
 v_lshlrev_b32 v6, 16, v7
 v_and_b32 v7, s26, v7
 v_pk_mul_f32 v[6:7], v[6:7], v[202:203]
 v_cvt_pk_bf16_f32 v13, v6, v7
 v_accvgpr_read_b32 v7, a98
 v_lshlrev_b32 v6, 16, v7
 v_and_b32 v7, s26, v7
 v_pk_mul_f32 v[6:7], v[6:7], v[232:233]
 v_cvt_pk_bf16_f32 v14, v6, v7
 v_accvgpr_read_b32 v7, a99
 v_lshlrev_b32 v6, 16, v7
 v_and_b32 v7, s26, v7
 v_pk_mul_f32 v[6:7], v[6:7], v[234:235]
 v_cvt_pk_bf16_f32 v15, v6, v7
 ds_write_b128 v18, v[12:15]
 ds_read_b128 v[48:51], v3
 ds_read_b128 v[80:83], v3 offset:1024
 v_accvgpr_read_b32 v7, a68
 v_lshlrev_b32 v6, 16, v7
 v_and_b32 v7, s26, v7
 v_pk_mul_f32 v[6:7], v[6:7], v[140:141]
 v_cvt_pk_bf16_f32 v8, v6, v7
 v_accvgpr_read_b32 v7, a69
 v_lshlrev_b32 v6, 16, v7
 v_and_b32 v7, s26, v7
 v_pk_mul_f32 v[6:7], v[6:7], v[142:143]
 v_cvt_pk_bf16_f32 v9, v6, v7
 v_accvgpr_read_b32 v7, a70
 v_lshlrev_b32 v6, 16, v7
 s_waitcnt lgkmcnt(1)
 s_add_u32 s3, s28, 0
 buffer_store_dwordx4 v[48:51], v16, s[16:19], s3 offen offset:128 nt
 s_waitcnt lgkmcnt(0)
 s_add_u32 s3, s28, 16384
 buffer_store_dwordx4 v[80:83], v16, s[16:19], s3 offen offset:128 nt
 v_and_b32 v7, s26, v7
 v_pk_mul_f32 v[6:7], v[6:7], v[172:173]
 v_cvt_pk_bf16_f32 v10, v6, v7
 v_accvgpr_read_b32 v7, a71
 v_lshlrev_b32 v6, 16, v7
 v_and_b32 v7, s26, v7
 v_pk_mul_f32 v[6:7], v[6:7], v[174:175]
 v_cvt_pk_bf16_f32 v11, v6, v7
 ds_write_b128 v17, v[8:11] offset:4096
 v_accvgpr_read_b32 v7, a100
 v_lshlrev_b32 v6, 16, v7
 v_and_b32 v7, s26, v7
 v_pk_mul_f32 v[6:7], v[6:7], v[204:205]
 v_cvt_pk_bf16_f32 v12, v6, v7
 v_accvgpr_read_b32 v7, a101
 v_lshlrev_b32 v6, 16, v7
 v_and_b32 v7, s26, v7
 v_pk_mul_f32 v[6:7], v[6:7], v[206:207]
 v_cvt_pk_bf16_f32 v13, v6, v7
 v_accvgpr_read_b32 v7, a102
 v_lshlrev_b32 v6, 16, v7
 v_and_b32 v7, s26, v7
 v_pk_mul_f32 v[6:7], v[6:7], v[236:237]
 v_cvt_pk_bf16_f32 v14, v6, v7
 v_accvgpr_read_b32 v7, a103
 v_lshlrev_b32 v6, 16, v7
 v_and_b32 v7, s26, v7
 v_pk_mul_f32 v[6:7], v[6:7], v[238:239]
 v_cvt_pk_bf16_f32 v15, v6, v7
 ds_write_b128 v18, v[12:15] offset:4096
 ds_read_b128 v[48:51], v3 offset:4096
 ds_read_b128 v[80:83], v3 offset:5120
 v_accvgpr_read_b32 v7, a72
 v_lshlrev_b32 v6, 16, v7
 v_and_b32 v7, s26, v7
 v_pk_mul_f32 v[6:7], v[6:7], v[144:145]
 v_cvt_pk_bf16_f32 v8, v6, v7
 v_accvgpr_read_b32 v7, a73
 v_lshlrev_b32 v6, 16, v7
 v_and_b32 v7, s26, v7
 v_pk_mul_f32 v[6:7], v[6:7], v[146:147]
 v_cvt_pk_bf16_f32 v9, v6, v7
 v_accvgpr_read_b32 v7, a74
 v_lshlrev_b32 v6, 16, v7
 s_waitcnt lgkmcnt(1)
 s_add_u32 s3, s28, 32768
 buffer_store_dwordx4 v[48:51], v16, s[16:19], s3 offen offset:128 nt
 s_waitcnt lgkmcnt(0)
 s_add_u32 s3, s28, 49152
 buffer_store_dwordx4 v[80:83], v16, s[16:19], s3 offen offset:128 nt
 v_and_b32 v7, s26, v7
 v_pk_mul_f32 v[6:7], v[6:7], v[176:177]
 v_cvt_pk_bf16_f32 v10, v6, v7
 v_accvgpr_read_b32 v7, a75
 v_lshlrev_b32 v6, 16, v7
 v_and_b32 v7, s26, v7
 v_pk_mul_f32 v[6:7], v[6:7], v[178:179]
 v_cvt_pk_bf16_f32 v11, v6, v7
 ds_write_b128 v17, v[8:11] offset:8192
 v_accvgpr_read_b32 v7, a104
 v_lshlrev_b32 v6, 16, v7
 v_and_b32 v7, s26, v7
 v_pk_mul_f32 v[6:7], v[6:7], v[208:209]
 v_cvt_pk_bf16_f32 v12, v6, v7
 v_accvgpr_read_b32 v7, a105
 v_lshlrev_b32 v6, 16, v7
 v_and_b32 v7, s26, v7
 v_pk_mul_f32 v[6:7], v[6:7], v[210:211]
 v_cvt_pk_bf16_f32 v13, v6, v7
 v_accvgpr_read_b32 v7, a106
 v_lshlrev_b32 v6, 16, v7
 v_and_b32 v7, s26, v7
 v_pk_mul_f32 v[6:7], v[6:7], v[240:241]
 v_cvt_pk_bf16_f32 v14, v6, v7
 v_accvgpr_read_b32 v7, a107
 v_lshlrev_b32 v6, 16, v7
 v_and_b32 v7, s26, v7
 v_pk_mul_f32 v[6:7], v[6:7], v[242:243]
 v_cvt_pk_bf16_f32 v15, v6, v7
 ds_write_b128 v18, v[12:15] offset:8192
 ds_read_b128 v[48:51], v3 offset:8192
 ds_read_b128 v[80:83], v3 offset:9216
 v_accvgpr_read_b32 v7, a76
 v_lshlrev_b32 v6, 16, v7
 v_and_b32 v7, s26, v7
 v_pk_mul_f32 v[6:7], v[6:7], v[148:149]
 v_cvt_pk_bf16_f32 v8, v6, v7
 v_accvgpr_read_b32 v7, a77
 v_lshlrev_b32 v6, 16, v7
 v_and_b32 v7, s26, v7
 v_pk_mul_f32 v[6:7], v[6:7], v[150:151]
 v_cvt_pk_bf16_f32 v9, v6, v7
 v_accvgpr_read_b32 v7, a78
 v_lshlrev_b32 v6, 16, v7
 s_waitcnt lgkmcnt(1)
 s_add_u32 s3, s28, 65536
 buffer_store_dwordx4 v[48:51], v16, s[16:19], s3 offen offset:128 nt
 s_waitcnt lgkmcnt(0)
 s_add_u32 s3, s28, 81920
 buffer_store_dwordx4 v[80:83], v16, s[16:19], s3 offen offset:128 nt
 v_and_b32 v7, s26, v7
 v_pk_mul_f32 v[6:7], v[6:7], v[180:181]
 v_cvt_pk_bf16_f32 v10, v6, v7
 v_accvgpr_read_b32 v7, a79
 v_lshlrev_b32 v6, 16, v7
 v_and_b32 v7, s26, v7
 v_pk_mul_f32 v[6:7], v[6:7], v[182:183]
 v_cvt_pk_bf16_f32 v11, v6, v7
 ds_write_b128 v17, v[8:11] offset:12288
 v_accvgpr_read_b32 v7, a108
 v_lshlrev_b32 v6, 16, v7
 v_and_b32 v7, s26, v7
 v_pk_mul_f32 v[6:7], v[6:7], v[212:213]
 v_cvt_pk_bf16_f32 v12, v6, v7
 v_accvgpr_read_b32 v7, a109
 v_lshlrev_b32 v6, 16, v7
 v_and_b32 v7, s26, v7
 v_pk_mul_f32 v[6:7], v[6:7], v[214:215]
 v_cvt_pk_bf16_f32 v13, v6, v7
 v_accvgpr_read_b32 v7, a110
 v_lshlrev_b32 v6, 16, v7
 v_and_b32 v7, s26, v7
 v_pk_mul_f32 v[6:7], v[6:7], v[244:245]
 v_cvt_pk_bf16_f32 v14, v6, v7
 v_accvgpr_read_b32 v7, a111
 v_lshlrev_b32 v6, 16, v7
 v_and_b32 v7, s26, v7
 v_pk_mul_f32 v[6:7], v[6:7], v[246:247]
 v_cvt_pk_bf16_f32 v15, v6, v7
 ds_write_b128 v18, v[12:15] offset:12288
 ds_read_b128 v[48:51], v3 offset:12288
 ds_read_b128 v[80:83], v3 offset:13312
 v_accvgpr_read_b32 v7, a80
 v_lshlrev_b32 v6, 16, v7
 v_and_b32 v7, s26, v7
 v_pk_mul_f32 v[6:7], v[6:7], v[152:153]
 v_cvt_pk_bf16_f32 v8, v6, v7
 v_accvgpr_read_b32 v7, a81
 v_lshlrev_b32 v6, 16, v7
 v_and_b32 v7, s26, v7
 v_pk_mul_f32 v[6:7], v[6:7], v[154:155]
 v_cvt_pk_bf16_f32 v9, v6, v7
 v_accvgpr_read_b32 v7, a82
 v_lshlrev_b32 v6, 16, v7
 s_waitcnt lgkmcnt(1)
 s_add_u32 s3, s28, 98304
 buffer_store_dwordx4 v[48:51], v16, s[16:19], s3 offen offset:128 nt
 s_waitcnt lgkmcnt(0)
 s_add_u32 s3, s28, 114688
 buffer_store_dwordx4 v[80:83], v16, s[16:19], s3 offen offset:128 nt
 v_and_b32 v7, s26, v7
 v_pk_mul_f32 v[6:7], v[6:7], v[184:185]
 v_cvt_pk_bf16_f32 v10, v6, v7
 v_accvgpr_read_b32 v7, a83
 v_lshlrev_b32 v6, 16, v7
 v_and_b32 v7, s26, v7
 v_pk_mul_f32 v[6:7], v[6:7], v[186:187]
 v_cvt_pk_bf16_f32 v11, v6, v7
 ds_write_b128 v17, v[8:11] offset:16384
 v_accvgpr_read_b32 v7, a112
 v_lshlrev_b32 v6, 16, v7
 v_and_b32 v7, s26, v7
 v_pk_mul_f32 v[6:7], v[6:7], v[216:217]
 v_cvt_pk_bf16_f32 v12, v6, v7
 v_accvgpr_read_b32 v7, a113
 v_lshlrev_b32 v6, 16, v7
 v_and_b32 v7, s26, v7
 v_pk_mul_f32 v[6:7], v[6:7], v[218:219]
 v_cvt_pk_bf16_f32 v13, v6, v7
 v_accvgpr_read_b32 v7, a114
 v_lshlrev_b32 v6, 16, v7
 v_and_b32 v7, s26, v7
 v_pk_mul_f32 v[6:7], v[6:7], v[248:249]
 v_cvt_pk_bf16_f32 v14, v6, v7
 v_accvgpr_read_b32 v7, a115
 v_lshlrev_b32 v6, 16, v7
 v_and_b32 v7, s26, v7
 v_pk_mul_f32 v[6:7], v[6:7], v[250:251]
 v_cvt_pk_bf16_f32 v15, v6, v7
 ds_write_b128 v18, v[12:15] offset:16384
 ds_read_b128 v[48:51], v3 offset:16384
 ds_read_b128 v[80:83], v3 offset:17408
 v_accvgpr_read_b32 v7, a84
 v_lshlrev_b32 v6, 16, v7
 v_and_b32 v7, s26, v7
 v_pk_mul_f32 v[6:7], v[6:7], v[156:157]
 v_cvt_pk_bf16_f32 v8, v6, v7
 v_accvgpr_read_b32 v7, a85
 v_lshlrev_b32 v6, 16, v7
 v_and_b32 v7, s26, v7
 v_pk_mul_f32 v[6:7], v[6:7], v[158:159]
 v_cvt_pk_bf16_f32 v9, v6, v7
 v_accvgpr_read_b32 v7, a86
 v_lshlrev_b32 v6, 16, v7
 s_waitcnt lgkmcnt(1)
 s_add_u32 s3, s28, 131072
 buffer_store_dwordx4 v[48:51], v16, s[16:19], s3 offen offset:128 nt
 s_waitcnt lgkmcnt(0)
 s_add_u32 s3, s28, 147456
 buffer_store_dwordx4 v[80:83], v16, s[16:19], s3 offen offset:128 nt
 v_and_b32 v7, s26, v7
 v_pk_mul_f32 v[6:7], v[6:7], v[188:189]
 v_cvt_pk_bf16_f32 v10, v6, v7
 v_accvgpr_read_b32 v7, a87
 v_lshlrev_b32 v6, 16, v7
 v_and_b32 v7, s26, v7
 v_pk_mul_f32 v[6:7], v[6:7], v[190:191]
 v_cvt_pk_bf16_f32 v11, v6, v7
 ds_write_b128 v17, v[8:11] offset:20480
 v_accvgpr_read_b32 v7, a116
 v_lshlrev_b32 v6, 16, v7
 v_and_b32 v7, s26, v7
 v_pk_mul_f32 v[6:7], v[6:7], v[220:221]
 v_cvt_pk_bf16_f32 v12, v6, v7
 v_accvgpr_read_b32 v7, a117
 v_lshlrev_b32 v6, 16, v7
 v_and_b32 v7, s26, v7
 v_pk_mul_f32 v[6:7], v[6:7], v[222:223]
 v_cvt_pk_bf16_f32 v13, v6, v7
 v_accvgpr_read_b32 v7, a118
 v_lshlrev_b32 v6, 16, v7
 v_and_b32 v7, s26, v7
 v_pk_mul_f32 v[6:7], v[6:7], v[252:253]
 v_cvt_pk_bf16_f32 v14, v6, v7
 v_accvgpr_read_b32 v7, a119
 v_lshlrev_b32 v6, 16, v7
 v_and_b32 v7, s26, v7
 v_pk_mul_f32 v[6:7], v[6:7], v[254:255]
 v_cvt_pk_bf16_f32 v15, v6, v7
 ds_write_b128 v18, v[12:15] offset:20480
 ds_read_b128 v[48:51], v3 offset:20480
 ds_read_b128 v[80:83], v3 offset:21504
 v_accvgpr_read_b32 v7, a88
 v_lshlrev_b32 v6, 16, v7
 v_and_b32 v7, s26, v7
 v_pk_mul_f32 v[6:7], v[6:7], v[160:161]
 v_cvt_pk_bf16_f32 v8, v6, v7
 v_accvgpr_read_b32 v7, a89
 v_lshlrev_b32 v6, 16, v7
 v_and_b32 v7, s26, v7
 v_pk_mul_f32 v[6:7], v[6:7], v[162:163]
 v_cvt_pk_bf16_f32 v9, v6, v7
 v_accvgpr_read_b32 v7, a90
 v_lshlrev_b32 v6, 16, v7
 s_waitcnt lgkmcnt(1)
 s_add_u32 s3, s28, 163840
 buffer_store_dwordx4 v[48:51], v16, s[16:19], s3 offen offset:128 nt
 s_waitcnt lgkmcnt(0)
 s_add_u32 s3, s28, 180224
 buffer_store_dwordx4 v[80:83], v16, s[16:19], s3 offen offset:128 nt
 v_and_b32 v7, s26, v7
 v_pk_mul_f32 v[6:7], v[6:7], v[192:193]
 v_cvt_pk_bf16_f32 v10, v6, v7
 v_accvgpr_read_b32 v7, a91
 v_lshlrev_b32 v6, 16, v7
 v_and_b32 v7, s26, v7
 v_pk_mul_f32 v[6:7], v[6:7], v[194:195]
 v_cvt_pk_bf16_f32 v11, v6, v7
 ds_write_b128 v17, v[8:11] offset:24576
 v_accvgpr_read_b32 v7, a120
 v_lshlrev_b32 v6, 16, v7
 v_and_b32 v7, s26, v7
 v_pk_mul_f32 v[6:7], v[6:7], v[224:225]
 v_cvt_pk_bf16_f32 v12, v6, v7
 v_accvgpr_read_b32 v7, a121
 v_lshlrev_b32 v6, 16, v7
 v_and_b32 v7, s26, v7
 v_pk_mul_f32 v[6:7], v[6:7], v[226:227]
 v_cvt_pk_bf16_f32 v13, v6, v7
 v_accvgpr_read_b32 v7, a122
 v_accvgpr_read_b32 v112, a248
 v_accvgpr_read_b32 v113, a249
 v_lshlrev_b32 v6, 16, v7
 v_and_b32 v7, s26, v7
 v_pk_mul_f32 v[6:7], v[6:7], v[112:113]
 v_cvt_pk_bf16_f32 v14, v6, v7
 v_accvgpr_read_b32 v7, a123
 v_accvgpr_read_b32 v112, a250
 v_accvgpr_read_b32 v113, a251
 v_lshlrev_b32 v6, 16, v7
 v_and_b32 v7, s26, v7
 v_pk_mul_f32 v[6:7], v[6:7], v[112:113]
 v_cvt_pk_bf16_f32 v15, v6, v7
 ds_write_b128 v18, v[12:15] offset:24576
 ds_read_b128 v[48:51], v3 offset:24576
 ds_read_b128 v[80:83], v3 offset:25600
 v_accvgpr_read_b32 v7, a92
 v_lshlrev_b32 v6, 16, v7
 v_and_b32 v7, s26, v7
 v_pk_mul_f32 v[6:7], v[6:7], v[164:165]
 v_cvt_pk_bf16_f32 v8, v6, v7
 v_accvgpr_read_b32 v7, a93
 v_lshlrev_b32 v6, 16, v7
 v_and_b32 v7, s26, v7
 v_pk_mul_f32 v[6:7], v[6:7], v[166:167]
 v_cvt_pk_bf16_f32 v9, v6, v7
 v_accvgpr_read_b32 v7, a94
 v_lshlrev_b32 v6, 16, v7
 s_waitcnt lgkmcnt(1)
 s_add_u32 s3, s28, 196608
 buffer_store_dwordx4 v[48:51], v16, s[16:19], s3 offen offset:128 nt
 s_waitcnt lgkmcnt(0)
 s_add_u32 s3, s28, 212992
 buffer_store_dwordx4 v[80:83], v16, s[16:19], s3 offen offset:128 nt
 v_and_b32 v7, s26, v7
 v_pk_mul_f32 v[6:7], v[6:7], v[196:197]
 v_cvt_pk_bf16_f32 v10, v6, v7
 v_accvgpr_read_b32 v7, a95
 v_lshlrev_b32 v6, 16, v7
 v_and_b32 v7, s26, v7
 v_pk_mul_f32 v[6:7], v[6:7], v[198:199]
 v_cvt_pk_bf16_f32 v11, v6, v7
 ds_write_b128 v17, v[8:11] offset:28672
 v_accvgpr_read_b32 v7, a124
 v_lshlrev_b32 v6, 16, v7
 v_and_b32 v7, s26, v7
 v_pk_mul_f32 v[6:7], v[6:7], v[228:229]
 v_cvt_pk_bf16_f32 v12, v6, v7
 v_accvgpr_read_b32 v7, a125
 v_lshlrev_b32 v6, 16, v7
 v_and_b32 v7, s26, v7
 v_pk_mul_f32 v[6:7], v[6:7], v[230:231]
 v_cvt_pk_bf16_f32 v13, v6, v7
 v_accvgpr_read_b32 v7, a126
 v_accvgpr_read_b32 v112, a252
 v_accvgpr_read_b32 v113, a253
 v_lshlrev_b32 v6, 16, v7
 v_and_b32 v7, s26, v7
 v_pk_mul_f32 v[6:7], v[6:7], v[112:113]
 v_cvt_pk_bf16_f32 v14, v6, v7
 v_accvgpr_read_b32 v7, a127
 v_accvgpr_read_b32 v112, a254
 v_accvgpr_read_b32 v113, a255
 v_lshlrev_b32 v6, 16, v7
 v_and_b32 v7, s26, v7
 v_pk_mul_f32 v[6:7], v[6:7], v[112:113]
 v_cvt_pk_bf16_f32 v15, v6, v7
 ds_write_b128 v18, v[12:15] offset:28672
 ds_read_b128 v[48:51], v3 offset:28672
 ds_read_b128 v[80:83], v3 offset:29696
 s_waitcnt lgkmcnt(1)
 s_add_u32 s3, s28, 229376
 buffer_store_dwordx4 v[48:51], v16, s[16:19], s3 offen offset:128 nt
 s_waitcnt lgkmcnt(0)
 s_add_u32 s3, s28, 245760
 buffer_store_dwordx4 v[80:83], v16, s[16:19], s3 offen offset:128 nt
Lend:
 s_endpgm
Lspin_pro:
 s_add_u32 s53, s53, 1
 v_lshlrev_b32 v4, 2, v3
 v_and_b32 v4, 192, v4
 buffer_load_dword v4, v4, s[44:47], 0 offen sc1
 s_cmp_ge_u32 s53, 0x100000
 s_cbranch_scc1 Lgiveup_pro
 s_waitcnt vmcnt(0)
 v_cmp_gt_i32 vcc, s27, v4
 s_and_b64 vcc, exec, vcc
 s_cbranch_vccnz Lspin_pro
Lgiveup_pro:
 s_waitcnt vmcnt(0)
 s_branch Lok_pro
Lspin_pa:
 s_add_u32 s53, s53, 1
 buffer_load_dword v4, off, s[64:67], 0 sc1
 s_cmp_ge_u32 s53, 0x100000
 s_cbranch_scc1 Lgiveup_pa
 s_waitcnt vmcnt(0)
 v_cmp_gt_i32 vcc, s55, v4
 s_and_b64 vcc, exec, vcc
 s_cbranch_vccnz Lspin_pa
Lgiveup_pa:
 s_waitcnt vmcnt(0)
 s_branch Lok_pa
Lgat0:
 v_lshrrev_b32 v5, 4, v3
 v_and_b32 v5, 0x20, v5
 v_xor_b32 v5, v5, v3
 v_and_b32 v5, 0x30, v5
 v_bfe_u32 v6, v3, 6, 4
 v_lshl_add_u32 v6, v6, 11, v5
 s_branch Lgatr0
Lxrg:
 v_lshrrev_b32 v5, 2, v3
 v_and_b32 v5, 0x20, v5
 v_lshrrev_b32 v2, 4, v3
 v_xor_b32 v5, v5, v2
 v_and_b32 v5, 0x30, v5
 v_bfe_u32 v1, v3, 4, 4
 v_lshl_add_u32 v1, v1, 6, v5
 v_add_u32 v2, 0x10000, v1
 s_branch Lxrgr
Lspin_pb:
 s_add_u32 s53, s53, 1
 buffer_load_dword v4, off, s[64:67], 0 sc1
 s_cmp_ge_u32 s53, 0x100000
 s_cbranch_scc1 Lgiveup_pb
 s_waitcnt vmcnt(0)
 v_cmp_gt_i32 vcc, s55, v4
 s_and_b64 vcc, exec, vcc
 s_cbranch_vccnz Lspin_pb
Lgiveup_pb:
 s_waitcnt vmcnt(0)
 s_branch Lok_pb
Lgat1:
 v_lshrrev_b32 v5, 4, v3
 v_and_b32 v5, 0x20, v5
 v_xor_b32 v5, v5, v3
 v_and_b32 v5, 0x30, v5
 v_bfe_u32 v6, v3, 6, 4
 v_lshl_add_u32 v6, v6, 11, v5
 s_branch Lgatr1
Lspin_w:
 s_add_u32 s53, s53, 1
 v_lshlrev_b32 v4, 2, v3
 v_and_b32 v4, 192, v4
 buffer_load_dword v4, v4, s[44:47], 0 offen sc1
 s_cmp_ge_u32 s53, 0x100000
 s_cbranch_scc1 Lgiveup_w
 s_waitcnt vmcnt(0)
 v_cmp_gt_i32 vcc, s27, v4
 s_and_b64 vcc, exec, vcc
 s_cbranch_vccnz Lspin_w
Lgiveup_w:
 s_waitcnt vmcnt(0)
 s_branch Lok_w
.section .rodata,"a"
.p2align 6
.amdhsa_kernel standalone__cross_network_dcn__recsys_kernel
  .amdhsa_next_free_vgpr 512
  .amdhsa_next_free_sgpr 102
  .amdhsa_accum_offset 256
  .amdhsa_group_segment_fixed_size 0
  .amdhsa_kernarg_size 48
  .amdhsa_user_sgpr_count 2
  .amdhsa_user_sgpr_kernarg_segment_ptr 1
  .amdhsa_system_sgpr_workgroup_id_x 1
  .amdhsa_float_denorm_mode_32 3
.end_amdhsa_kernel
```

```asm
; @launch grid=(256,1,1) block=(256,1,1) lds=151552
.amdgcn_target "amdgcn-amd-amdhsa--gfx950"
.text
.globl standalone__cross_network_dcn__recsys_kernel
.p2align 8
.type standalone__cross_network_dcn__recsys_kernel,@function
standalone__cross_network_dcn__recsys_kernel:
 s_cmp_ge_u32 s2, 256
 s_cbranch_scc1 Lend
 s_load_dwordx4 s[56:59], s[0:1], 0
 s_load_dwordx4 s[60:63], s[0:1], 16
 s_load_dwordx4 s[64:67], s[0:1], 32
 v_lshrrev_b32 v9, 6, v0
 v_and_b32 v10, 63, v0
 v_readfirstlane_b32 s54, v9
 v_lshlrev_b32 v1, 4, v10
 s_getpc_b64 s[4:5]
Lpc:
 v_lshlrev_b32 v11, 6, v0
 s_bfe_u32 s3, s2, 0x20003
 s_lshl_b32 s3, s3, 14
 v_add_u32 v11, s3, v11
 v_min_u32 v12, Lend-Lpc, v11
 global_load_dword v60, v12, s[4:5]
 v_add_u32 v11, 16384, v11
 v_lshrrev_b32 v11, 7, v0
 v_and_b32 v12, 127, v0
 v_lshlrev_b32 v12, 3, v12
 v_lshl_add_u32 v30, v11, 11, v12
 v_lshlrev_b32 v31, 4, v0
 v_add_u32 v31, 131072, v31
 v_add_u32 v2, 65536, v1
 v_lshl_add_u32 v3, v9, 15, v1
 v_lshl_add_u32 v0, v9, 18, v1
 s_and_b32 s7, s2, 1
 s_lshr_b32 s28, s2, 1
 s_lshl_b32 s28, s28, 18
 s_lshl_b32 s6, s7, 10
 s_add_u32 s28, s28, s6
 s_lshl_b32 s6, s54, 8
 s_add_u32 s28, s28, s6
 s_mov_b32 s26, 0xffff0000
 s_lshl_b32 s24, s7, 20
 s_mov_b32 s25, 0
 s_mov_b32 s53, 0
 s_mov_b32 s31, -1
 s_mov_b32 s27, 64
 s_mov_b32 s55, -1
 s_lshl_b32 s50, s54, 15
 s_lshl_b32 s29, s2, 17
 s_add_u32 s29, s29, 33554432
 s_xor_b32 s30, s29, 131072
 s_lshr_b32 s4, s2, 3
 s_and_b32 s5, s2, 7
 s_lshl_b32 s48, s4, 16
 s_lshl_b32 s6, s5, 8
 s_add_u32 s48, s48, s6
 s_lshl_b32 s6, s54, 6
 s_add_u32 s48, s48, s6
 s_lshl_b32 s49, s5, 18
 s_and_b32 s6, s4, 1
 s_lshl_b32 s6, s6, 10
 s_add_u32 s49, s49, s6
 s_lshr_b32 s6, s4, 4
 s_lshr_b32 s5, s5, 2
 s_xor_b32 s5, s5, s6
 s_bfe_u32 s6, s4, 0x10001
 s_lshl_b32 s3, s5, 1
 s_add_u32 s3, s3, s6
 s_lshl_b32 s3, s3, 16
 s_add_u32 s49, s49, s3
 s_bfe_u32 s4, s4, 0x20002
 s_xor_b32 s5, s5, s6
 s_lshr_b32 s3, s54, 1
 s_lshl_b32 s3, s3, 4
 s_lshl_b32 s6, s4, 2
 s_add_u32 s3, s3, s6
 s_and_b32 s6, s54, 1
 s_lshl_b32 s6, s6, 1
 s_add_u32 s3, s3, s6
 s_lshl_b32 s4, s4, 3
 s_lshl_b32 s6, s54, 1
 s_add_u32 s4, s4, s6
 s_cmp_eq_u32 s5, 0
 s_cselect_b32 s3, s3, s4
 s_lshl_b32 s3, s3, 11
 s_add_u32 s49, s49, s3
 s_lshl_b32 s52, s54, 11
 s_add_u32 s52, s52, 143360
 s_lshl_b32 s51, s54, 9
 s_add_u32 s51, s51, 131072
 s_waitcnt lgkmcnt(0)
 s_mov_b32 s40, s58
 s_mov_b32 s41, s59
 s_mov_b32 s42, 0xc00000
 s_mov_b32 s43, 0x20000
 v_lshrrev_b32 v5, 6, v1
 v_and_b32 v6, 48, v1
 v_lshl_add_u32 v5, v5, 11, v6
 s_mov_b32 m0, s52
 s_add_u32 s3, s48, 31744
 buffer_load_dwordx4 v5, s[40:43], s48 offen lds
 buffer_load_dwordx4 v5, s[40:43], s3 offen offset:1024 lds
 s_add_u32 s48, s48, 2097152
 s_mov_b32 s20, s60
 s_mov_b32 s21, s61
 s_mov_b32 s22, 0x3000
 s_mov_b32 s23, 0x20000
 s_lshl_b32 s3, s7, 10
 buffer_load_dwordx2 v[32:33], v30, s[20:23], s3 offen
 s_add_u32 s3, s3, 4096
 buffer_load_dwordx2 v[34:35], v30, s[20:23], s3 offen
 s_add_u32 s3, s3, 4096
 buffer_load_dwordx2 v[36:37], v30, s[20:23], s3 offen
 s_add_u32 s3, s3, 4096
 s_mov_b32 s8, s56
 s_mov_b32 s9, s57
 s_mov_b32 s10, 0x2000000
 s_mov_b32 s11, 0x20000
 s_mov_b32 s16, s62
 s_mov_b32 s17, s63
 s_mov_b32 s18, 0x2000000
 s_mov_b32 s19, 0x20000
 s_mov_b32 s12, s66
 s_mov_b32 s13, s67
 s_mov_b32 s14, 0xc00000
 s_mov_b32 s15, 0x20000
 s_mov_b32 s32, s66
 s_mov_b32 s33, s67
 s_mov_b32 s34, 0x10000000
 s_mov_b32 s35, 0x20000
 s_mov_b32 s44, s64
 s_mov_b32 s45, s65
 s_mov_b32 s46, 0x100
 s_mov_b32 s47, 0x20000
 s_add_u32 s24, s24, 4096
 s_add_u32 s70, s66, s24
 s_addc_u32 s71, s67, 0
 s_sub_u32 s24, s24, 4096
 s_and_b32 s3, s2, 3
 s_lshl_b32 s3, s3, 6
 s_add_u32 s56, s44, s3
 s_addc_u32 s57, s45, 0
 s_mov_b32 s58, 0x4
 s_mov_b32 s59, 0x20000
 s_lshl_b32 s3, s2, 2
 s_add_u32 s3, s3, s54
 s_lshl_b32 s3, s3, 7
 s_add_u32 s3, s3, 15728640
 s_add_u32 s60, s32, s3
 s_addc_u32 s61, s33, 0
 s_mov_b32 s62, 0x4
 s_mov_b32 s63, 0x20000
 s_xor_b32 s3, s3, 512
 s_add_u32 s64, s32, s3
 s_addc_u32 s65, s33, 0
 s_mov_b32 s66, 0x4
 s_mov_b32 s67, 0x20000
 v_lshrrev_b32 v5, 2, v1
 v_and_b32 v5, 64, v5
 v_xor_b32 v5, v5, v1
 v_and_b32 v5, 112, v5
 v_lshrrev_b32 v6, 7, v1
 v_lshl_add_u32 v23, v6, 11, v5
 s_and_b32 s69, s28, 2047
 s_lshl_b32 s3, s7, 20
 s_add_u32 s69, s69, s3
 s_add_u32 m0, s50, 0
 s_add_u32 s3, s69, 0
 buffer_load_dwordx4 v23, s[40:43], s3 offen lds
 s_add_u32 m0, s50, 1024
 s_add_u32 s3, s69, 16384
 buffer_load_dwordx4 v23, s[40:43], s3 offen lds
 s_add_u32 m0, s50, 4096
 s_add_u32 s3, s69, 32768
 buffer_load_dwordx4 v23, s[40:43], s3 offen lds
 s_add_u32 m0, s50, 5120
 s_add_u32 s3, s69, 49152
 buffer_load_dwordx4 v23, s[40:43], s3 offen lds
 s_add_u32 m0, s50, 8192
 s_add_u32 s3, s69, 65536
 buffer_load_dwordx4 v23, s[40:43], s3 offen lds
 s_add_u32 m0, s50, 9216
 s_add_u32 s3, s69, 81920
 buffer_load_dwordx4 v23, s[40:43], s3 offen lds
 s_add_u32 m0, s50, 12288
 s_add_u32 s3, s69, 98304
 buffer_load_dwordx4 v23, s[40:43], s3 offen lds
 s_add_u32 m0, s50, 13312
 s_add_u32 s3, s69, 114688
 buffer_load_dwordx4 v23, s[40:43], s3 offen lds
 s_add_u32 m0, s50, 16384
 s_add_u32 s3, s69, 262144
 buffer_load_dwordx4 v23, s[40:43], s3 offen lds
 s_add_u32 m0, s50, 17408
 s_add_u32 s3, s69, 278528
 buffer_load_dwordx4 v23, s[40:43], s3 offen lds
 s_add_u32 m0, s50, 20480
 s_add_u32 s3, s69, 294912
 buffer_load_dwordx4 v23, s[40:43], s3 offen lds
 s_add_u32 m0, s50, 21504
 s_add_u32 s3, s69, 311296
 buffer_load_dwordx4 v23, s[40:43], s3 offen lds
 s_add_u32 m0, s50, 24576
 s_add_u32 s3, s69, 327680
 buffer_load_dwordx4 v23, s[40:43], s3 offen lds
 s_add_u32 m0, s50, 25600
 s_add_u32 s3, s69, 344064
 buffer_load_dwordx4 v23, s[40:43], s3 offen lds
 s_add_u32 m0, s50, 28672
 s_add_u32 s3, s69, 360448
 buffer_load_dwordx4 v23, s[40:43], s3 offen lds
 s_add_u32 m0, s50, 29696
 s_add_u32 s3, s69, 376832
 buffer_load_dwordx4 v23, s[40:43], s3 offen lds
 v_mov_b32 v7, 0
 buffer_store_dword v7, v1, s[60:63], 0 offen sc1
 v_lshrrev_b32 v5, 7, v1
 v_lshlrev_b32 v6, 4, v5
 v_xor_b32 v6, v6, v1
 v_and_b32 v6, 112, v6
 v_lshl_add_u32 v20, v5, 11, v6
 v_lshrrev_b32 v5, 4, v1
 v_and_b32 v5, 48, v5
 v_xor_b32 v5, v5, v1
 v_and_b32 v5, 112, v5
 v_and_b32 v6, 240, v1
 v_lshl_add_u32 v5, v6, 3, v5
 v_add_u32 v21, s50, v5
 v_xor_b32 v22, 64, v21
 v_lshrrev_b32 v5, 1, v1
 v_and_b32 v5, 64, v5
 v_and_b32 v6, 48, v1
 v_or_b32 v5, v5, v6
 v_and_b32 v6, 192, v1
 v_lshl_add_u32 v5, v6, 1, v5
 v_and_b32 v6, 256, v1
 v_lshl_add_u32 v5, v6, 2, v5
 v_and_b32 v6, 512, v1
 v_lshl_add_u32 v5, v6, 3, v5
 v_add_u32 v24, s50, v5
 v_xor_b32 v25, 64, v24
 v_mov_b32 v64, 1.0
 v_mov_b32 v65, 1.0
 v_mov_b32 v66, 1.0
 v_mov_b32 v67, 1.0
 v_mov_b32 v68, 1.0
 v_mov_b32 v69, 1.0
 v_mov_b32 v70, 1.0
 v_mov_b32 v71, 1.0
 v_mov_b32 v72, 1.0
 v_mov_b32 v73, 1.0
 v_mov_b32 v74, 1.0
 v_mov_b32 v75, 1.0
 v_mov_b32 v76, 1.0
 v_mov_b32 v77, 1.0
 v_mov_b32 v78, 1.0
 v_mov_b32 v79, 1.0
 v_mov_b32 v80, 1.0
 v_mov_b32 v81, 1.0
 v_mov_b32 v82, 1.0
 v_mov_b32 v83, 1.0
 v_mov_b32 v84, 1.0
 v_mov_b32 v85, 1.0
 v_mov_b32 v86, 1.0
 v_mov_b32 v87, 1.0
 v_mov_b32 v88, 1.0
 v_mov_b32 v89, 1.0
 v_mov_b32 v90, 1.0
 v_mov_b32 v91, 1.0
 v_mov_b32 v92, 1.0
 v_mov_b32 v93, 1.0
 v_mov_b32 v94, 1.0
 v_mov_b32 v95, 1.0
 v_mov_b32 v96, 1.0
 v_mov_b32 v97, 1.0
 v_mov_b32 v98, 1.0
 v_mov_b32 v99, 1.0
 v_mov_b32 v100, 1.0
 v_mov_b32 v101, 1.0
 v_mov_b32 v102, 1.0
 v_mov_b32 v103, 1.0
 v_mov_b32 v104, 1.0
 v_mov_b32 v105, 1.0
 v_mov_b32 v106, 1.0
 v_mov_b32 v107, 1.0
 v_mov_b32 v108, 1.0
 v_mov_b32 v109, 1.0
 v_mov_b32 v110, 1.0
 v_mov_b32 v111, 1.0
 v_mov_b32 v112, 1.0
 v_mov_b32 v113, 1.0
 v_mov_b32 v114, 1.0
 v_mov_b32 v115, 1.0
 v_mov_b32 v116, 1.0
 v_mov_b32 v117, 1.0
 v_mov_b32 v118, 1.0
 v_mov_b32 v119, 1.0
 v_mov_b32 v120, 1.0
 v_mov_b32 v121, 1.0
 v_mov_b32 v122, 1.0
 v_mov_b32 v123, 1.0
 v_mov_b32 v124, 1.0
 v_mov_b32 v125, 1.0
 v_mov_b32 v126, 1.0
 v_mov_b32 v127, 1.0
 v_mov_b32 v128, 1.0
 v_mov_b32 v129, 1.0
 v_mov_b32 v130, 1.0
 v_mov_b32 v131, 1.0
 v_mov_b32 v132, 1.0
 v_mov_b32 v133, 1.0
 v_mov_b32 v134, 1.0
 v_mov_b32 v135, 1.0
 v_accvgpr_write_b32 a240, 1.0
 v_accvgpr_write_b32 a241, 1.0
 v_accvgpr_write_b32 a242, 1.0
 v_accvgpr_write_b32 a243, 1.0
 v_accvgpr_write_b32 a244, 1.0
 v_accvgpr_write_b32 a245, 1.0
 v_accvgpr_write_b32 a246, 1.0
 v_accvgpr_write_b32 a247, 1.0
 v_mov_b32 v216, 1.0
 v_mov_b32 v217, 1.0
 v_mov_b32 v218, 1.0
 v_mov_b32 v219, 1.0
 v_mov_b32 v220, 1.0
 v_mov_b32 v221, 1.0
 v_mov_b32 v222, 1.0
 v_mov_b32 v223, 1.0
 v_mov_b32 v224, 1.0
 v_mov_b32 v225, 1.0
 v_mov_b32 v226, 1.0
 v_mov_b32 v227, 1.0
 v_mov_b32 v228, 1.0
 v_mov_b32 v229, 1.0
 v_mov_b32 v230, 1.0
 v_mov_b32 v231, 1.0
 v_mov_b32 v232, 1.0
 v_mov_b32 v233, 1.0
 v_mov_b32 v234, 1.0
 v_mov_b32 v235, 1.0
 v_mov_b32 v236, 1.0
 v_mov_b32 v237, 1.0
 v_mov_b32 v238, 1.0
 v_mov_b32 v239, 1.0
 v_mov_b32 v240, 1.0
 v_mov_b32 v241, 1.0
 v_mov_b32 v242, 1.0
 v_mov_b32 v243, 1.0
 v_mov_b32 v244, 1.0
 v_mov_b32 v245, 1.0
 v_mov_b32 v246, 1.0
 v_mov_b32 v247, 1.0
 v_mov_b32 v248, 1.0
 v_mov_b32 v249, 1.0
 v_mov_b32 v250, 1.0
 v_mov_b32 v251, 1.0
 v_mov_b32 v252, 1.0
 v_mov_b32 v253, 1.0
 v_mov_b32 v254, 1.0
 v_mov_b32 v255, 1.0
 v_accvgpr_write_b32 a248, 1.0
 v_accvgpr_write_b32 a249, 1.0
 v_accvgpr_write_b32 a250, 1.0
 v_accvgpr_write_b32 a251, 1.0
 v_accvgpr_write_b32 a252, 1.0
 v_accvgpr_write_b32 a253, 1.0
 v_accvgpr_write_b32 a254, 1.0
 v_accvgpr_write_b32 a255, 1.0
 v_and_b32 v5, 768, v3
 v_and_b32 v7, 1023, v3
 v_add3_u32 v5, v5, v7, s52
 s_waitcnt vmcnt(20)
 ds_read_b64_tr_b16 v[8:9], v5 offset:0
 ds_read_b64_tr_b16 v[10:11], v5 offset:256
 ds_read_b64_tr_b16 v[12:13], v5 offset:8
 ds_read_b64_tr_b16 v[14:15], v5 offset:264
 s_waitcnt lgkmcnt(2)
 buffer_store_dwordx4 v[8:11], v7, s[12:15], s49 offen sc1
 s_waitcnt lgkmcnt(0)
 buffer_store_dwordx4 v[12:15], v7, s[12:15], s49 offen offset:2048 sc1
 s_add_u32 s49, s49, 2097152
 s_add_u32 m0, s50, 2048
 s_add_u32 s3, s69, 524288
 buffer_load_dwordx4 v23, s[40:43], s3 offen lds
 s_add_u32 m0, s50, 3072
 s_add_u32 s3, s69, 540672
 buffer_load_dwordx4 v23, s[40:43], s3 offen lds
 s_add_u32 m0, s50, 6144
 s_add_u32 s3, s69, 557056
 buffer_load_dwordx4 v23, s[40:43], s3 offen lds
 s_add_u32 m0, s50, 7168
 s_add_u32 s3, s69, 573440
 buffer_load_dwordx4 v23, s[40:43], s3 offen lds
 s_add_u32 m0, s50, 10240
 s_add_u32 s3, s69, 589824
 buffer_load_dwordx4 v23, s[40:43], s3 offen lds
 s_add_u32 m0, s50, 11264
 s_add_u32 s3, s69, 606208
 buffer_load_dwordx4 v23, s[40:43], s3 offen lds
 s_add_u32 m0, s50, 14336
 s_add_u32 s3, s69, 622592
 buffer_load_dwordx4 v23, s[40:43], s3 offen lds
 s_add_u32 m0, s50, 15360
 s_add_u32 s3, s69, 638976
 buffer_load_dwordx4 v23, s[40:43], s3 offen lds
 s_waitcnt vmcnt(29)
 v_lshlrev_b32 v40, 16, v32
 v_and_b32 v41, s26, v32
 v_lshlrev_b32 v42, 16, v33
 v_and_b32 v43, s26, v33
 ds_write_b128 v31, v[40:43]
 s_waitcnt vmcnt(28)
 v_lshlrev_b32 v44, 16, v34
 v_and_b32 v45, s26, v34
 v_lshlrev_b32 v46, 16, v35
 v_and_b32 v47, s26, v35
 ds_write_b128 v31, v[44:47] offset:4096
 s_waitcnt vmcnt(27)
 v_lshlrev_b32 v48, 16, v36
 v_and_b32 v49, s26, v36
 v_lshlrev_b32 v50, 16, v37
 v_and_b32 v51, s26, v37
 ds_write_b128 v31, v[48:51] offset:8192
 s_waitcnt lgkmcnt(0)
 v_mov_b32 v32, 1.0
 v_mov_b32 v33, 1.0
 v_mov_b32 v34, 1.0
 v_mov_b32 v35, 1.0
 v_mov_b32 v36, 1.0
 v_mov_b32 v37, 1.0
 v_mov_b32 v38, 1.0
 v_mov_b32 v39, 1.0
 v_mov_b32 v40, 1.0
 v_mov_b32 v41, 1.0
 v_mov_b32 v42, 1.0
 v_mov_b32 v43, 1.0
 v_mov_b32 v44, 1.0
 v_mov_b32 v45, 1.0
 v_mov_b32 v46, 1.0
 v_mov_b32 v47, 1.0
 v_mov_b32 v48, 1.0
 v_mov_b32 v49, 1.0
 v_mov_b32 v50, 1.0
 v_mov_b32 v51, 1.0
 v_mov_b32 v52, 1.0
 v_mov_b32 v53, 1.0
 v_mov_b32 v54, 1.0
 v_mov_b32 v55, 1.0
 v_mov_b32 v56, 1.0
 v_mov_b32 v57, 1.0
 v_mov_b32 v58, 1.0
 v_mov_b32 v59, 1.0
 v_mov_b32 v60, 1.0
 v_mov_b32 v61, 1.0
 v_mov_b32 v62, 1.0
 v_mov_b32 v63, 1.0
 s_waitcnt vmcnt(23)
 ds_read_b64_tr_b16 v[136:137], v24 offset:0
 ds_read_b64_tr_b16 v[138:139], v24 offset:512
 ds_read_b64_tr_b16 v[144:145], v24 offset:8
 ds_read_b64_tr_b16 v[146:147], v24 offset:520
 ds_read_b64_tr_b16 v[152:153], v25 offset:0
 ds_read_b64_tr_b16 v[154:155], v25 offset:512
 ds_read_b64_tr_b16 v[160:161], v25 offset:8
 ds_read_b64_tr_b16 v[162:163], v25 offset:520
 s_waitcnt vmcnt(19)
 ds_read_b64_tr_b16 v[140:141], v24 offset:8192
 ds_read_b64_tr_b16 v[142:143], v24 offset:8704
 ds_read_b64_tr_b16 v[148:149], v24 offset:8200
 ds_read_b64_tr_b16 v[150:151], v24 offset:8712
 ds_read_b64_tr_b16 v[156:157], v25 offset:8192
 ds_read_b64_tr_b16 v[158:159], v25 offset:8704
 ds_read_b64_tr_b16 v[164:165], v25 offset:8200
 ds_read_b64_tr_b16 v[166:167], v25 offset:8712
 s_waitcnt lgkmcnt(8)
 s_add_u32 m0, s50, 0
 s_add_u32 s3, s28, 0
 buffer_load_dwordx4 v20, s[8:11], s3 offen lds
 s_add_u32 m0, s50, 1024
 s_add_u32 s3, s28, 16384
 buffer_load_dwordx4 v20, s[8:11], s3 offen lds
 s_add_u32 m0, s50, 4096
 s_add_u32 s3, s28, 32768
 buffer_load_dwordx4 v20, s[8:11], s3 offen lds
 s_add_u32 m0, s50, 5120
 s_add_u32 s3, s28, 49152
 buffer_load_dwordx4 v20, s[8:11], s3 offen lds
 s_waitcnt vmcnt(19)
 ds_read_b64_tr_b16 v[168:169], v24 offset:16384
 ds_read_b64_tr_b16 v[170:171], v24 offset:16896
 ds_read_b64_tr_b16 v[176:177], v24 offset:16392
 ds_read_b64_tr_b16 v[178:179], v24 offset:16904
 ds_read_b64_tr_b16 v[184:185], v25 offset:16384
 ds_read_b64_tr_b16 v[186:187], v25 offset:16896
 ds_read_b64_tr_b16 v[192:193], v25 offset:16392
 ds_read_b64_tr_b16 v[194:195], v25 offset:16904
 s_waitcnt lgkmcnt(8)
 s_add_u32 m0, s50, 8192
 s_add_u32 s3, s28, 65536
 buffer_load_dwordx4 v20, s[8:11], s3 offen lds
 s_add_u32 m0, s50, 9216
 s_add_u32 s3, s28, 81920
 buffer_load_dwordx4 v20, s[8:11], s3 offen lds
 s_add_u32 m0, s50, 12288
 s_add_u32 s3, s28, 98304
 buffer_load_dwordx4 v20, s[8:11], s3 offen lds
 s_add_u32 m0, s50, 13312
 s_add_u32 s3, s28, 114688
 buffer_load_dwordx4 v20, s[8:11], s3 offen lds
 s_waitcnt vmcnt(19)
 ds_read_b64_tr_b16 v[172:173], v24 offset:24576
 ds_read_b64_tr_b16 v[174:175], v24 offset:25088
 ds_read_b64_tr_b16 v[180:181], v24 offset:24584
 ds_read_b64_tr_b16 v[182:183], v24 offset:25096
 ds_read_b64_tr_b16 v[188:189], v25 offset:24576
 ds_read_b64_tr_b16 v[190:191], v25 offset:25088
 ds_read_b64_tr_b16 v[196:197], v25 offset:24584
 ds_read_b64_tr_b16 v[198:199], v25 offset:25096
 s_waitcnt vmcnt(16)
 s_barrier
 v_mov_b32 v7, 1
 buffer_atomic_add v7, v0, s[56:59], 0 offen sc1
 s_add_u32 m0, s50, 18432
 s_add_u32 s3, s69, 786432
 buffer_load_dwordx4 v23, s[40:43], s3 offen lds
 s_add_u32 m0, s50, 19456
 s_add_u32 s3, s69, 802816
 buffer_load_dwordx4 v23, s[40:43], s3 offen lds
 s_add_u32 m0, s50, 22528
 s_add_u32 s3, s69, 819200
 buffer_load_dwordx4 v23, s[40:43], s3 offen lds
 s_add_u32 m0, s50, 23552
 s_add_u32 s3, s69, 835584
 buffer_load_dwordx4 v23, s[40:43], s3 offen lds
 s_add_u32 m0, s50, 26624
 s_add_u32 s3, s69, 851968
 buffer_load_dwordx4 v23, s[40:43], s3 offen lds
 s_add_u32 m0, s50, 27648
 s_add_u32 s3, s69, 868352
 buffer_load_dwordx4 v23, s[40:43], s3 offen lds
 s_add_u32 m0, s50, 30720
 s_add_u32 s3, s69, 884736
 buffer_load_dwordx4 v23, s[40:43], s3 offen lds
 s_add_u32 m0, s50, 31744
 s_add_u32 s3, s69, 901120
 buffer_load_dwordx4 v23, s[40:43], s3 offen lds
 s_waitcnt lgkmcnt(0)
 s_add_u32 m0, s50, 16384
 s_add_u32 s3, s28, 131072
 buffer_load_dwordx4 v20, s[8:11], s3 offen lds
 s_add_u32 m0, s50, 17408
 s_add_u32 s3, s28, 147456
 buffer_load_dwordx4 v20, s[8:11], s3 offen lds
 s_add_u32 m0, s50, 20480
 s_add_u32 s3, s28, 163840
 buffer_load_dwordx4 v20, s[8:11], s3 offen lds
 s_add_u32 m0, s50, 21504
 s_add_u32 s3, s28, 180224
 buffer_load_dwordx4 v20, s[8:11], s3 offen lds
 s_add_u32 m0, s50, 24576
 s_add_u32 s3, s28, 196608
 buffer_load_dwordx4 v20, s[8:11], s3 offen lds
 s_add_u32 m0, s50, 25600
 s_add_u32 s3, s28, 212992
 buffer_load_dwordx4 v20, s[8:11], s3 offen lds
 s_add_u32 m0, s50, 28672
 s_add_u32 s3, s28, 229376
 buffer_load_dwordx4 v20, s[8:11], s3 offen lds
 s_add_u32 m0, s50, 29696
 s_add_u32 s3, s28, 245760
 buffer_load_dwordx4 v20, s[8:11], s3 offen lds
 s_waitcnt vmcnt(29)
 ds_read_b64_tr_b16 v[200:201], v24 offset:2048
 ds_read_b64_tr_b16 v[202:203], v24 offset:2560
 ds_read_b64_tr_b16 v[208:209], v24 offset:2056
 ds_read_b64_tr_b16 v[210:211], v24 offset:2568
 ds_read_b64_tr_b16 a[224:225], v25 offset:2048
 ds_read_b64_tr_b16 a[226:227], v25 offset:2560
 ds_read_b64_tr_b16 a[232:233], v25 offset:2056
 ds_read_b64_tr_b16 a[234:235], v25 offset:2568
 s_waitcnt vmcnt(25)
 ds_read_b64_tr_b16 v[204:205], v24 offset:10240
 ds_read_b64_tr_b16 v[206:207], v24 offset:10752
 ds_read_b64_tr_b16 v[212:213], v24 offset:10248
 ds_read_b64_tr_b16 v[214:215], v24 offset:10760
 ds_read_b64_tr_b16 a[228:229], v25 offset:10240
 ds_read_b64_tr_b16 a[230:231], v25 offset:10752
 ds_read_b64_tr_b16 a[236:237], v25 offset:10248
 ds_read_b64_tr_b16 a[238:239], v25 offset:10760
 s_waitcnt vmcnt(12)
 ds_read_b64_tr_b16 a[192:193], v24 offset:18432
 ds_read_b64_tr_b16 a[194:195], v24 offset:18944
 ds_read_b64_tr_b16 a[200:201], v24 offset:18440
 ds_read_b64_tr_b16 a[202:203], v24 offset:18952
 ds_read_b64_tr_b16 a[208:209], v25 offset:18432
 ds_read_b64_tr_b16 a[210:211], v25 offset:18944
 ds_read_b64_tr_b16 a[216:217], v25 offset:18440
 ds_read_b64_tr_b16 a[218:219], v25 offset:18952
 s_waitcnt vmcnt(8)
 ds_read_b64_tr_b16 a[196:197], v24 offset:26624
 ds_read_b64_tr_b16 a[198:199], v24 offset:27136
 ds_read_b64_tr_b16 a[204:205], v24 offset:26632
 ds_read_b64_tr_b16 a[206:207], v24 offset:27144
 ds_read_b64_tr_b16 a[212:213], v25 offset:26624
 ds_read_b64_tr_b16 a[214:215], v25 offset:27136
 ds_read_b64_tr_b16 a[220:221], v25 offset:26632
 ds_read_b64_tr_b16 a[222:223], v25 offset:27144
 ds_read_b128 a[0:3], v21
 ds_read_b128 a[32:35], v22
 ds_read_b128 a[4:7], v21 offset:4096
 ds_read_b128 a[36:39], v22 offset:4096
 s_waitcnt lgkmcnt(2)
 ds_write_b128 v3, a[0:3]
 ds_write_b128 v3, a[32:35] offset:1024
 ds_read_b128 a[8:11], v21 offset:8192
 ds_read_b128 a[40:43], v22 offset:8192
 s_waitcnt lgkmcnt(4)
 ds_write_b128 v3, a[4:7] offset:4096
 ds_write_b128 v3, a[36:39] offset:5120
 ds_read_b128 a[12:15], v21 offset:12288
 ds_read_b128 a[44:47], v22 offset:12288
 s_waitcnt lgkmcnt(4)
 ds_write_b128 v3, a[8:11] offset:8192
 ds_write_b128 v3, a[40:43] offset:9216
 s_waitcnt vmcnt(6)
 ds_read_b128 a[16:19], v21 offset:16384
 ds_read_b128 a[48:51], v22 offset:16384
 s_waitcnt lgkmcnt(4)
 ds_write_b128 v3, a[12:15] offset:12288
 ds_write_b128 v3, a[44:47] offset:13312
 s_waitcnt vmcnt(4)
 ds_read_b128 a[20:23], v21 offset:20480
 ds_read_b128 a[52:55], v22 offset:20480
 s_waitcnt lgkmcnt(4)
 ds_write_b128 v3, a[16:19] offset:16384
 ds_write_b128 v3, a[48:51] offset:17408
 s_waitcnt vmcnt(2)
 ds_read_b128 a[24:27], v21 offset:24576
 ds_read_b128 a[56:59], v22 offset:24576
 s_waitcnt lgkmcnt(4)
 ds_write_b128 v3, a[20:23] offset:20480
 ds_write_b128 v3, a[52:55] offset:21504
 s_waitcnt lgkmcnt(0)
 v_lshlrev_b32 v4, 2, v3
 v_and_b32 v4, 192, v4
 buffer_load_dword v4, v4, s[44:47], 0 offen sc1
 s_add_u32 m0, s50, 2048
 s_add_u32 s3, s28, 128
 buffer_load_dwordx4 v20, s[8:11], s3 offen lds
 s_add_u32 m0, s50, 3072
 s_add_u32 s3, s28, 16512
 buffer_load_dwordx4 v20, s[8:11], s3 offen lds
 s_waitcnt vmcnt(3)
 ds_read_b128 a[28:31], v21 offset:28672
 ds_read_b128 a[60:63], v22 offset:28672
 ds_write_b128 v3, a[24:27] offset:24576
 ds_write_b128 v3, a[56:59] offset:25600
 s_waitcnt lgkmcnt(2)
 ds_write_b128 v3, a[28:31] offset:28672
 ds_write_b128 v3, a[60:63] offset:29696
 s_add_u32 m0, s50, 6144
 s_add_u32 s3, s28, 32896
 buffer_load_dwordx4 v20, s[8:11], s3 offen lds
 s_add_u32 m0, s50, 7168
 s_add_u32 s3, s28, 49280
 buffer_load_dwordx4 v20, s[8:11], s3 offen lds
 s_add_u32 m0, s50, 10240
 s_add_u32 s3, s28, 65664
 buffer_load_dwordx4 v20, s[8:11], s3 offen lds
 s_add_u32 m0, s50, 11264
 s_add_u32 s3, s28, 82048
 buffer_load_dwordx4 v20, s[8:11], s3 offen lds
 v_mov_b32 v8, v20
 v_mov_b32 v16, 1.0
 v_mov_b32 v17, 1.0
 v_mov_b32 v18, 1.0
 v_mov_b32 v19, 1.0
 v_mov_b32 v20, 1.0
 v_mov_b32 v21, 1.0
 v_mov_b32 v22, 1.0
 v_mov_b32 v23, 1.0
 v_mov_b32 v24, 1.0
 v_mov_b32 v25, 1.0
 v_mov_b32 v26, 1.0
 v_mov_b32 v27, 1.0
 v_mov_b32 v28, 1.0
 v_mov_b32 v29, 1.0
 v_mov_b32 v30, 1.0
 v_mov_b32 v31, 1.0
 s_add_u32 s70, s70, 32768
 s_addc_u32 s71, s71, 0
 s_xor_b32 s30, s28, 1024
 s_mov_b32 s20, 64
 s_mov_b32 s21, 32704
 s_mov_b32 s22, 0xfffc8040
 s_waitcnt lgkmcnt(0)
 s_barrier
 ds_read_b128 a[128:131], v1
 ds_read_b128 a[132:135], v1 offset:1024
 ds_read_b128 a[140:143], v1 offset:5120
 ds_read_b128 a[136:139], v1 offset:4096
 ds_read_b128 a[144:147], v1 offset:8192
 ds_read_b128 a[148:151], v1 offset:9216
 ds_read_b128 a[156:159], v1 offset:13312
 ds_read_b128 a[152:155], v1 offset:12288
 ds_read_b128 a[160:163], v1 offset:16384
 ds_read_b128 a[164:167], v1 offset:17408
 ds_read_b128 a[172:175], v1 offset:21504
 ds_read_b128 a[168:171], v1 offset:20480
 ds_read_b128 a[176:179], v1 offset:24576
 ds_read_b128 a[180:183], v1 offset:25600
 ds_read_b128 a[188:191], v1 offset:29696
 ds_read_b128 a[184:187], v1 offset:28672
 s_waitcnt lgkmcnt(8)
 v_mfma_f32_16x16x32_bf16 v[16:19], v[136:139], a[128:131], v[16:19]
 s_add_u32 m0, s50, 14336
 v_mfma_f32_16x16x32_bf16 v[16:19], v[140:143], a[132:135], v[16:19]
 v_mfma_f32_16x16x32_bf16 v[20:23], v[140:143], a[140:143], v[20:23]
 s_add_u32 s3, s28, 98432
 v_mfma_f32_16x16x32_bf16 v[20:23], v[136:139], a[136:139], v[20:23]
 buffer_load_dwordx4 v8, s[8:11], s3 offen lds
 v_mfma_f32_16x16x32_bf16 v[24:27], v[136:139], a[144:147], v[24:27]
 s_add_u32 m0, s50, 15360
 v_mfma_f32_16x16x32_bf16 v[24:27], v[140:143], a[148:151], v[24:27]
 v_mfma_f32_16x16x32_bf16 v[28:31], v[140:143], a[156:159], v[28:31]
 s_add_u32 s3, s28, 114816
 v_mfma_f32_16x16x32_bf16 v[28:31], v[136:139], a[152:155], v[28:31]
 buffer_load_dwordx4 v8, s[8:11], s3 offen lds
 s_waitcnt lgkmcnt(0)
 v_mfma_f32_16x16x32_bf16 v[32:35], v[136:139], a[160:163], v[32:35]
 s_add_u32 m0, s50, 18432
 v_mfma_f32_16x16x32_bf16 v[32:35], v[140:143], a[164:167], v[32:35]
 s_add_u32 s3, s28, 131200
 v_mfma_f32_16x16x32_bf16 v[36:39], v[140:143], a[172:175], v[36:39]
 v_mfma_f32_16x16x32_bf16 v[36:39], v[136:139], a[168:171], v[36:39]
 buffer_load_dwordx4 v8, s[8:11], s3 offen lds
 v_mfma_f32_16x16x32_bf16 v[40:43], v[136:139], a[176:179], v[40:43]
 s_add_u32 m0, s50, 19456
 v_mfma_f32_16x16x32_bf16 v[40:43], v[140:143], a[180:183], v[40:43]
 s_add_u32 s3, s28, 147584
 v_mfma_f32_16x16x32_bf16 v[44:47], v[140:143], a[188:191], v[44:47]
 v_mfma_f32_16x16x32_bf16 v[44:47], v[136:139], a[184:187], v[44:47]
 buffer_load_dwordx4 v8, s[8:11], s3 offen lds
 v_mfma_f32_16x16x32_bf16 v[76:79], v[144:147], a[184:187], v[76:79]
 s_add_u32 m0, s50, 22528
 v_mfma_f32_16x16x32_bf16 v[76:79], v[148:151], a[188:191], v[76:79]
 s_add_u32 s3, s28, 163968
 v_mfma_f32_16x16x32_bf16 v[72:75], v[148:151], a[180:183], v[72:75]
 v_mov_b32 v136, 1.0
 v_mfma_f32_16x16x32_bf16 v[72:75], v[144:147], a[176:179], v[72:75]
 buffer_load_dwordx4 v8, s[8:11], s3 offen lds
 v_mfma_f32_16x16x32_bf16 v[68:71], v[144:147], a[168:171], v[68:71]
 s_add_u32 m0, s50, 23552
 v_mov_b32 v137, 1.0
 v_mfma_f32_16x16x32_bf16 v[68:71], v[148:151], a[172:175], v[68:71]
 s_add_u32 s3, s28, 180352
 v_mov_b32 v138, 1.0
 v_mfma_f32_16x16x32_bf16 v[64:67], v[148:151], a[164:167], v[64:67]
 buffer_load_dwordx4 v8, s[8:11], s3 offen lds
 v_mfma_f32_16x16x32_bf16 v[64:67], v[144:147], a[160:163], v[64:67]
 v_mov_b32 v139, 1.0
 v_mfma_f32_16x16x32_bf16 v[60:63], v[144:147], a[152:155], v[60:63]
 s_add_u32 m0, s50, 26624
 v_mov_b32 v140, 1.0
 v_mfma_f32_16x16x32_bf16 v[60:63], v[148:151], a[156:159], v[60:63]
 v_mfma_f32_16x16x32_bf16 v[56:59], v[148:151], a[148:151], v[56:59]
 s_add_u32 s3, s28, 196736
 v_mov_b32 v141, 1.0
 v_mfma_f32_16x16x32_bf16 v[56:59], v[144:147], a[144:147], v[56:59]
 v_mov_b32 v142, 1.0
 v_mfma_f32_16x16x32_bf16 v[52:55], v[144:147], a[136:139], v[52:55]
 buffer_load_dwordx4 v8, s[8:11], s3 offen lds
 s_add_u32 m0, s50, 27648
 v_mfma_f32_16x16x32_bf16 v[52:55], v[148:151], a[140:143], v[52:55]
 v_mov_b32 v143, 1.0
 v_mfma_f32_16x16x32_bf16 v[48:51], v[148:151], a[132:135], v[48:51]
 s_add_u32 s3, s28, 213120
 v_mfma_f32_16x16x32_bf16 v[48:51], v[144:147], a[128:131], v[48:51]
 buffer_load_dwordx4 v8, s[8:11], s3 offen lds
 v_mfma_f32_16x16x32_bf16 v[80:83], v[152:155], a[128:131], v[80:83]
 s_add_u32 m0, s50, 30720
 v_mfma_f32_16x16x32_bf16 v[80:83], v[156:159], a[132:135], v[80:83]
 v_mfma_f32_16x16x32_bf16 v[84:87], v[156:159], a[140:143], v[84:87]
 s_add_u32 s3, s28, 229504
 v_mov_b32 v144, 1.0
 v_mfma_f32_16x16x32_bf16 v[84:87], v[152:155], a[136:139], v[84:87]
 buffer_load_dwordx4 v8, s[8:11], s3 offen lds
 v_mfma_f32_16x16x32_bf16 v[88:91], v[152:155], a[144:147], v[88:91]
 s_add_u32 m0, s50, 31744
 v_mov_b32 v145, 1.0
 v_mfma_f32_16x16x32_bf16 v[88:91], v[156:159], a[148:151], v[88:91]
 s_add_u32 s3, s28, 245888
 v_mov_b32 v146, 1.0
 v_mfma_f32_16x16x32_bf16 v[92:95], v[156:159], a[156:159], v[92:95]
 buffer_load_dwordx4 v8, s[8:11], s3 offen lds
 v_mfma_f32_16x16x32_bf16 v[92:95], v[152:155], a[152:155], v[92:95]
 v_mov_b32 v147, 1.0
 v_mfma_f32_16x16x32_bf16 v[96:99], v[152:155], a[160:163], v[96:99]
 v_mov_b32 v148, 1.0
 v_mfma_f32_16x16x32_bf16 v[96:99], v[156:159], a[164:167], v[96:99]
 v_mfma_f32_16x16x32_bf16 v[100:103], v[156:159], a[172:175], v[100:103]
 v_mov_b32 v149, 1.0
 v_mfma_f32_16x16x32_bf16 v[100:103], v[152:155], a[168:171], v[100:103]
 v_mov_b32 v150, 1.0
 v_mfma_f32_16x16x32_bf16 v[104:107], v[152:155], a[176:179], v[104:107]
 v_mfma_f32_16x16x32_bf16 v[104:107], v[156:159], a[180:183], v[104:107]
 v_mov_b32 v151, 1.0
 v_mfma_f32_16x16x32_bf16 v[108:111], v[156:159], a[188:191], v[108:111]
 v_mfma_f32_16x16x32_bf16 v[108:111], v[152:155], a[184:187], v[108:111]
 v_mfma_f32_16x16x32_bf16 a[244:247], v[160:163], a[184:187], a[244:247]
 ds_read_b128 a[184:187], v1 offset:61440
 v_mfma_f32_16x16x32_bf16 a[244:247], v[164:167], a[188:191], a[244:247]
 ds_read_b128 a[188:191], v1 offset:62464
 v_mfma_f32_16x16x32_bf16 a[240:243], v[164:167], a[180:183], a[240:243]
 ds_read_b128 a[180:183], v1 offset:58368
 v_mov_b32 v152, 1.0
 v_mfma_f32_16x16x32_bf16 a[240:243], v[160:163], a[176:179], a[240:243]
 ds_read_b128 a[176:179], v1 offset:57344
 v_mfma_f32_16x16x32_bf16 v[132:135], v[160:163], a[168:171], v[132:135]
 ds_read_b128 a[168:171], v1 offset:53248
 v_mov_b32 v153, 1.0
 v_mfma_f32_16x16x32_bf16 v[132:135], v[164:167], a[172:175], v[132:135]
 ds_read_b128 a[172:175], v1 offset:54272
 v_mov_b32 v154, 1.0
 v_mfma_f32_16x16x32_bf16 v[128:131], v[164:167], a[164:167], v[128:131]
 ds_read_b128 a[164:167], v1 offset:50176
 v_mfma_f32_16x16x32_bf16 v[128:131], v[160:163], a[160:163], v[128:131]
 ds_read_b128 a[160:163], v1 offset:49152
 v_mov_b32 v155, 1.0
 v_mfma_f32_16x16x32_bf16 v[124:127], v[160:163], a[152:155], v[124:127]
 ds_read_b128 a[152:155], v1 offset:45056
 v_mov_b32 v156, 1.0
 v_mfma_f32_16x16x32_bf16 v[124:127], v[164:167], a[156:159], v[124:127]
 ds_read_b128 a[156:159], v1 offset:46080
 v_mfma_f32_16x16x32_bf16 v[120:123], v[164:167], a[148:151], v[120:123]
 ds_read_b128 a[148:151], v1 offset:41984
 v_mov_b32 v157, 1.0
 v_mfma_f32_16x16x32_bf16 v[120:123], v[160:163], a[144:147], v[120:123]
 ds_read_b128 a[144:147], v1 offset:40960
 v_mov_b32 v158, 1.0
 v_mfma_f32_16x16x32_bf16 v[116:119], v[160:163], a[136:139], v[116:119]
 ds_read_b128 a[136:139], v1 offset:36864
 v_mfma_f32_16x16x32_bf16 v[116:119], v[164:167], a[140:143], v[116:119]
 ds_read_b128 a[140:143], v1 offset:37888
 v_mov_b32 v159, 1.0
 v_mfma_f32_16x16x32_bf16 v[112:115], v[164:167], a[132:135], v[112:115]
 ds_read_b128 a[132:135], v1 offset:33792
 v_mfma_f32_16x16x32_bf16 v[112:115], v[160:163], a[128:131], v[112:115]
 ds_read_b128 a[128:131], v1 offset:32768
 s_waitcnt lgkmcnt(8)
 v_mfma_f32_16x16x32_bf16 v[44:47], v[168:171], a[184:187], v[44:47]
 v_mfma_f32_16x16x32_bf16 v[44:47], v[172:175], a[188:191], v[44:47]
 v_mfma_f32_16x16x32_bf16 v[40:43], v[172:175], a[180:183], v[40:43]
 v_mov_b32 v160, 1.0
 v_mfma_f32_16x16x32_bf16 v[40:43], v[168:171], a[176:179], v[40:43]
 v_mfma_f32_16x16x32_bf16 v[36:39], v[168:171], a[168:171], v[36:39]
 v_mov_b32 v161, 1.0
 v_mfma_f32_16x16x32_bf16 v[36:39], v[172:175], a[172:175], v[36:39]
 v_mov_b32 v162, 1.0
 v_mfma_f32_16x16x32_bf16 v[32:35], v[172:175], a[164:167], v[32:35]
 v_mfma_f32_16x16x32_bf16 v[32:35], v[168:171], a[160:163], v[32:35]
 v_mov_b32 v163, 1.0
 s_waitcnt lgkmcnt(0)
 v_mfma_f32_16x16x32_bf16 v[28:31], v[168:171], a[152:155], v[28:31]
 v_mov_b32 v164, 1.0
 v_mfma_f32_16x16x32_bf16 v[28:31], v[172:175], a[156:159], v[28:31]
 v_mfma_f32_16x16x32_bf16 v[24:27], v[172:175], a[148:151], v[24:27]
 v_mov_b32 v165, 1.0
 v_mfma_f32_16x16x32_bf16 v[24:27], v[168:171], a[144:147], v[24:27]
 v_mov_b32 v166, 1.0
 v_mfma_f32_16x16x32_bf16 v[20:23], v[168:171], a[136:139], v[20:23]
 v_mfma_f32_16x16x32_bf16 v[20:23], v[172:175], a[140:143], v[20:23]
 v_mov_b32 v167, 1.0
 v_mfma_f32_16x16x32_bf16 v[16:19], v[172:175], a[132:135], v[16:19]
 v_mfma_f32_16x16x32_bf16 v[16:19], v[168:171], a[128:131], v[16:19]
 v_mfma_f32_16x16x32_bf16 v[48:51], v[176:179], a[128:131], v[48:51]
 v_mfma_f32_16x16x32_bf16 v[48:51], v[180:183], a[132:135], v[48:51]
 v_mfma_f32_16x16x32_bf16 v[52:55], v[180:183], a[140:143], v[52:55]
 v_mov_b32 v168, 1.0
 v_mfma_f32_16x16x32_bf16 v[52:55], v[176:179], a[136:139], v[52:55]
 v_mfma_f32_16x16x32_bf16 v[56:59], v[176:179], a[144:147], v[56:59]
 v_mov_b32 v169, 1.0
 v_mfma_f32_16x16x32_bf16 v[56:59], v[180:183], a[148:151], v[56:59]
 v_mov_b32 v170, 1.0
 v_mfma_f32_16x16x32_bf16 v[60:63], v[180:183], a[156:159], v[60:63]
 v_mfma_f32_16x16x32_bf16 v[60:63], v[176:179], a[152:155], v[60:63]
 v_mov_b32 v171, 1.0
 v_mfma_f32_16x16x32_bf16 v[64:67], v[176:179], a[160:163], v[64:67]
 v_mov_b32 v172, 1.0
 v_mfma_f32_16x16x32_bf16 v[64:67], v[180:183], a[164:167], v[64:67]
 v_mfma_f32_16x16x32_bf16 v[68:71], v[180:183], a[172:175], v[68:71]
 v_mov_b32 v173, 1.0
 v_mfma_f32_16x16x32_bf16 v[68:71], v[176:179], a[168:171], v[68:71]
 v_mov_b32 v174, 1.0
 v_mfma_f32_16x16x32_bf16 v[72:75], v[176:179], a[176:179], v[72:75]
 v_mfma_f32_16x16x32_bf16 v[72:75], v[180:183], a[180:183], v[72:75]
 v_mov_b32 v175, 1.0
 v_mfma_f32_16x16x32_bf16 v[76:79], v[180:183], a[188:191], v[76:79]
 v_mfma_f32_16x16x32_bf16 v[76:79], v[176:179], a[184:187], v[76:79]
 v_mfma_f32_16x16x32_bf16 v[108:111], v[184:187], a[184:187], v[108:111]
 v_mfma_f32_16x16x32_bf16 v[108:111], v[188:191], a[188:191], v[108:111]
 v_mfma_f32_16x16x32_bf16 v[104:107], v[188:191], a[180:183], v[104:107]
 v_mov_b32 v176, 1.0
 v_mfma_f32_16x16x32_bf16 v[104:107], v[184:187], a[176:179], v[104:107]
 v_mfma_f32_16x16x32_bf16 v[100:103], v[184:187], a[168:171], v[100:103]
 v_mov_b32 v177, 1.0
 v_mfma_f32_16x16x32_bf16 v[100:103], v[188:191], a[172:175], v[100:103]
 v_mov_b32 v178, 1.0
 v_mfma_f32_16x16x32_bf16 v[96:99], v[188:191], a[164:167], v[96:99]
 v_mfma_f32_16x16x32_bf16 v[96:99], v[184:187], a[160:163], v[96:99]
 v_mov_b32 v179, 1.0
 v_mfma_f32_16x16x32_bf16 v[92:95], v[184:187], a[152:155], v[92:95]
 v_mov_b32 v180, 1.0
 v_mfma_f32_16x16x32_bf16 v[92:95], v[188:191], a[156:159], v[92:95]
 v_mfma_f32_16x16x32_bf16 v[88:91], v[188:191], a[148:151], v[88:91]
 v_mov_b32 v181, 1.0
 v_mfma_f32_16x16x32_bf16 v[88:91], v[184:187], a[144:147], v[88:91]
 v_mov_b32 v182, 1.0
 v_mfma_f32_16x16x32_bf16 v[84:87], v[184:187], a[136:139], v[84:87]
 v_mfma_f32_16x16x32_bf16 v[84:87], v[188:191], a[140:143], v[84:87]
 v_mov_b32 v183, 1.0
 v_mfma_f32_16x16x32_bf16 v[80:83], v[188:191], a[132:135], v[80:83]
 v_mfma_f32_16x16x32_bf16 v[80:83], v[184:187], a[128:131], v[80:83]
 v_mfma_f32_16x16x32_bf16 v[112:115], v[192:195], a[128:131], v[112:115]
 ds_read_b128 a[128:131], v2
 v_mfma_f32_16x16x32_bf16 v[112:115], v[196:199], a[132:135], v[112:115]
 ds_read_b128 a[132:135], v2 offset:1024
 v_mfma_f32_16x16x32_bf16 v[116:119], v[196:199], a[140:143], v[116:119]
 ds_read_b128 a[140:143], v2 offset:5120
 v_mov_b32 v184, 1.0
 v_mfma_f32_16x16x32_bf16 v[116:119], v[192:195], a[136:139], v[116:119]
 ds_read_b128 a[136:139], v2 offset:4096
 v_mfma_f32_16x16x32_bf16 v[120:123], v[192:195], a[144:147], v[120:123]
 ds_read_b128 a[144:147], v2 offset:8192
 v_mov_b32 v185, 1.0
 v_mfma_f32_16x16x32_bf16 v[120:123], v[196:199], a[148:151], v[120:123]
 ds_read_b128 a[148:151], v2 offset:9216
 v_mov_b32 v186, 1.0
 v_mfma_f32_16x16x32_bf16 v[124:127], v[196:199], a[156:159], v[124:127]
 ds_read_b128 a[156:159], v2 offset:13312
 v_mfma_f32_16x16x32_bf16 v[124:127], v[192:195], a[152:155], v[124:127]
 ds_read_b128 a[152:155], v2 offset:12288
 v_mov_b32 v187, 1.0
 v_mfma_f32_16x16x32_bf16 v[128:131], v[192:195], a[160:163], v[128:131]
 ds_read_b128 a[160:163], v2 offset:16384
 v_mov_b32 v188, 1.0
 v_mfma_f32_16x16x32_bf16 v[128:131], v[196:199], a[164:167], v[128:131]
 ds_read_b128 a[164:167], v2 offset:17408
 v_mfma_f32_16x16x32_bf16 v[132:135], v[196:199], a[172:175], v[132:135]
 ds_read_b128 a[172:175], v2 offset:21504
 v_mov_b32 v189, 1.0
 v_mfma_f32_16x16x32_bf16 v[132:135], v[192:195], a[168:171], v[132:135]
 ds_read_b128 a[168:171], v2 offset:20480
 v_mov_b32 v190, 1.0
 v_mfma_f32_16x16x32_bf16 a[240:243], v[192:195], a[176:179], a[240:243]
 ds_read_b128 a[176:179], v2 offset:24576
 v_mfma_f32_16x16x32_bf16 a[240:243], v[196:199], a[180:183], a[240:243]
 ds_read_b128 a[180:183], v2 offset:25600
 v_mov_b32 v191, 1.0
 v_mfma_f32_16x16x32_bf16 a[244:247], v[196:199], a[188:191], a[244:247]
 ds_read_b128 a[188:191], v2 offset:29696
 v_mfma_f32_16x16x32_bf16 a[244:247], v[192:195], a[184:187], a[244:247]
 ds_read_b128 a[184:187], v2 offset:28672
 s_waitcnt lgkmcnt(8)
 v_mfma_f32_16x16x32_bf16 v[16:19], v[200:203], a[128:131], v[16:19]
 v_mfma_f32_16x16x32_bf16 v[16:19], v[204:207], a[132:135], v[16:19]
 v_mfma_f32_16x16x32_bf16 v[20:23], v[204:207], a[140:143], v[20:23]
 v_mov_b32 v192, 1.0
 v_mfma_f32_16x16x32_bf16 v[20:23], v[200:203], a[136:139], v[20:23]
 v_mfma_f32_16x16x32_bf16 v[24:27], v[200:203], a[144:147], v[24:27]
 v_mov_b32 v193, 1.0
 v_mfma_f32_16x16x32_bf16 v[24:27], v[204:207], a[148:151], v[24:27]
 v_mov_b32 v194, 1.0
 v_mfma_f32_16x16x32_bf16 v[28:31], v[204:207], a[156:159], v[28:31]
 v_mfma_f32_16x16x32_bf16 v[28:31], v[200:203], a[152:155], v[28:31]
 v_mov_b32 v195, 1.0
 s_waitcnt lgkmcnt(0)
 v_mfma_f32_16x16x32_bf16 v[32:35], v[200:203], a[160:163], v[32:35]
 v_mov_b32 v196, 1.0
 v_mfma_f32_16x16x32_bf16 v[32:35], v[204:207], a[164:167], v[32:35]
 v_mfma_f32_16x16x32_bf16 v[36:39], v[204:207], a[172:175], v[36:39]
 v_mov_b32 v197, 1.0
 v_mfma_f32_16x16x32_bf16 v[36:39], v[200:203], a[168:171], v[36:39]
 v_mov_b32 v198, 1.0
 v_mfma_f32_16x16x32_bf16 v[40:43], v[200:203], a[176:179], v[40:43]
 v_mfma_f32_16x16x32_bf16 v[40:43], v[204:207], a[180:183], v[40:43]
 v_mov_b32 v199, 1.0
 v_mfma_f32_16x16x32_bf16 v[44:47], v[204:207], a[188:191], v[44:47]
 v_mfma_f32_16x16x32_bf16 v[44:47], v[200:203], a[184:187], v[44:47]
 v_mfma_f32_16x16x32_bf16 v[76:79], v[208:211], a[184:187], v[76:79]
 v_mfma_f32_16x16x32_bf16 v[76:79], v[212:215], a[188:191], v[76:79]
 v_mfma_f32_16x16x32_bf16 v[72:75], v[212:215], a[180:183], v[72:75]
 v_mov_b32 v200, 1.0
 v_mfma_f32_16x16x32_bf16 v[72:75], v[208:211], a[176:179], v[72:75]
 v_mfma_f32_16x16x32_bf16 v[68:71], v[208:211], a[168:171], v[68:71]
 v_mov_b32 v201, 1.0
 v_mfma_f32_16x16x32_bf16 v[68:71], v[212:215], a[172:175], v[68:71]
 v_mov_b32 v202, 1.0
 v_mfma_f32_16x16x32_bf16 v[64:67], v[212:215], a[164:167], v[64:67]
 v_mfma_f32_16x16x32_bf16 v[64:67], v[208:211], a[160:163], v[64:67]
 v_mov_b32 v203, 1.0
 v_mfma_f32_16x16x32_bf16 v[60:63], v[208:211], a[152:155], v[60:63]
 v_mov_b32 v204, 1.0
 v_mfma_f32_16x16x32_bf16 v[60:63], v[212:215], a[156:159], v[60:63]
 v_mfma_f32_16x16x32_bf16 v[56:59], v[212:215], a[148:151], v[56:59]
 v_mov_b32 v205, 1.0
 v_mfma_f32_16x16x32_bf16 v[56:59], v[208:211], a[144:147], v[56:59]
 v_mov_b32 v206, 1.0
 v_mfma_f32_16x16x32_bf16 v[52:55], v[208:211], a[136:139], v[52:55]
 v_mfma_f32_16x16x32_bf16 v[52:55], v[212:215], a[140:143], v[52:55]
 v_mov_b32 v207, 1.0
 v_mfma_f32_16x16x32_bf16 v[48:51], v[212:215], a[132:135], v[48:51]
 v_mfma_f32_16x16x32_bf16 v[48:51], v[208:211], a[128:131], v[48:51]
 v_mfma_f32_16x16x32_bf16 v[80:83], a[224:227], a[128:131], v[80:83]
 v_mfma_f32_16x16x32_bf16 v[80:83], a[228:231], a[132:135], v[80:83]
 v_mfma_f32_16x16x32_bf16 v[84:87], a[228:231], a[140:143], v[84:87]
 v_mov_b32 v208, 1.0
 s_waitcnt vmcnt(16)
 v_cmp_gt_i32 vcc, s27, v4
 s_and_b64 vcc, exec, vcc
 s_cbranch_vccnz Lspin_pro
Lok_pro:
 s_add_u32 s27, s27, 64
 v_mfma_f32_16x16x32_bf16 v[84:87], a[224:227], a[136:139], v[84:87]
 v_mfma_f32_16x16x32_bf16 v[88:91], a[224:227], a[144:147], v[88:91]
 v_mov_b32 v209, 1.0
 v_mfma_f32_16x16x32_bf16 v[88:91], a[228:231], a[148:151], v[88:91]
 v_mov_b32 v210, 1.0
 v_mfma_f32_16x16x32_bf16 v[92:95], a[228:231], a[156:159], v[92:95]
 v_mfma_f32_16x16x32_bf16 v[92:95], a[224:227], a[152:155], v[92:95]
 v_mov_b32 v211, 1.0
 v_mfma_f32_16x16x32_bf16 v[96:99], a[224:227], a[160:163], v[96:99]
 v_mov_b32 v212, 1.0
 v_mfma_f32_16x16x32_bf16 v[96:99], a[228:231], a[164:167], v[96:99]
 v_mfma_f32_16x16x32_bf16 v[100:103], a[228:231], a[172:175], v[100:103]
 v_mov_b32 v213, 1.0
 v_mfma_f32_16x16x32_bf16 v[100:103], a[224:227], a[168:171], v[100:103]
 v_mov_b32 v214, 1.0
 v_mfma_f32_16x16x32_bf16 v[104:107], a[224:227], a[176:179], v[104:107]
 v_mfma_f32_16x16x32_bf16 v[104:107], a[228:231], a[180:183], v[104:107]
 v_mov_b32 v215, 1.0
 v_mfma_f32_16x16x32_bf16 v[108:111], a[228:231], a[188:191], v[108:111]
 v_mfma_f32_16x16x32_bf16 v[108:111], a[224:227], a[184:187], v[108:111]
 v_mfma_f32_16x16x32_bf16 a[244:247], a[232:235], a[184:187], a[244:247]
 ds_read_b128 a[184:187], v2 offset:61440
 v_mfma_f32_16x16x32_bf16 a[244:247], a[236:239], a[188:191], a[244:247]
 global_load_dwordx4 a[228:231], v0, s[70:71] offset:-3072 sc1
 ds_read_b128 a[188:191], v2 offset:62464
 v_mfma_f32_16x16x32_bf16 a[240:243], a[236:239], a[180:183], a[240:243]
 ds_read_b128 a[180:183], v2 offset:58368
 v_mfma_f32_16x16x32_bf16 a[240:243], a[232:235], a[176:179], a[240:243]
 global_load_dwordx4 a[224:227], v0, s[70:71] offset:-4096 sc1
 ds_read_b128 a[176:179], v2 offset:57344
 v_mfma_f32_16x16x32_bf16 v[132:135], a[232:235], a[168:171], v[132:135]
 ds_read_b128 a[168:171], v2 offset:53248
 v_mfma_f32_16x16x32_bf16 v[132:135], a[236:239], a[172:175], v[132:135]
 ds_read_b128 a[172:175], v2 offset:54272
 v_mfma_f32_16x16x32_bf16 v[128:131], a[236:239], a[164:167], v[128:131]
 ds_read_b128 a[164:167], v2 offset:50176
 v_mfma_f32_16x16x32_bf16 v[128:131], a[232:235], a[160:163], v[128:131]
 ds_read_b128 a[160:163], v2 offset:49152
 v_mfma_f32_16x16x32_bf16 v[124:127], a[232:235], a[152:155], v[124:127]
 ds_read_b128 a[152:155], v2 offset:45056
 v_mfma_f32_16x16x32_bf16 v[124:127], a[236:239], a[156:159], v[124:127]
 ds_read_b128 a[156:159], v2 offset:46080
 v_mfma_f32_16x16x32_bf16 v[120:123], a[236:239], a[148:151], v[120:123]
 ds_read_b128 a[148:151], v2 offset:41984
 v_mfma_f32_16x16x32_bf16 v[120:123], a[232:235], a[144:147], v[120:123]
 ds_read_b128 a[144:147], v2 offset:40960
 v_mfma_f32_16x16x32_bf16 v[116:119], a[232:235], a[136:139], v[116:119]
 ds_read_b128 a[136:139], v2 offset:36864
 v_mfma_f32_16x16x32_bf16 v[116:119], a[236:239], a[140:143], v[116:119]
 ds_read_b128 a[140:143], v2 offset:37888
 v_mfma_f32_16x16x32_bf16 v[112:115], a[236:239], a[132:135], v[112:115]
 ds_read_b128 a[132:135], v2 offset:33792
 v_mfma_f32_16x16x32_bf16 v[112:115], a[232:235], a[128:131], v[112:115]
 ds_read_b128 a[128:131], v2 offset:32768
 s_waitcnt lgkmcnt(8)
 v_mfma_f32_16x16x32_bf16 v[44:47], a[192:195], a[184:187], v[44:47]
 v_mfma_f32_16x16x32_bf16 v[44:47], a[196:199], a[188:191], v[44:47]
 global_load_dwordx4 a[236:239], v0, s[70:71] offset:-1024 sc1
 v_mfma_f32_16x16x32_bf16 v[40:43], a[196:199], a[180:183], v[40:43]
 v_mfma_f32_16x16x32_bf16 v[40:43], a[192:195], a[176:179], v[40:43]
 global_load_dwordx4 a[232:235], v0, s[70:71] offset:-2048 sc1
 v_mfma_f32_16x16x32_bf16 v[36:39], a[192:195], a[168:171], v[36:39]
 v_mfma_f32_16x16x32_bf16 v[36:39], a[196:199], a[172:175], v[36:39]
 v_mfma_f32_16x16x32_bf16 v[32:35], a[196:199], a[164:167], v[32:35]
 v_mfma_f32_16x16x32_bf16 v[32:35], a[192:195], a[160:163], v[32:35]
 s_waitcnt lgkmcnt(0)
 v_mfma_f32_16x16x32_bf16 v[28:31], a[192:195], a[152:155], v[28:31]
 v_mfma_f32_16x16x32_bf16 v[28:31], a[196:199], a[156:159], v[28:31]
 v_mfma_f32_16x16x32_bf16 v[24:27], a[196:199], a[148:151], v[24:27]
 v_mfma_f32_16x16x32_bf16 v[24:27], a[192:195], a[144:147], v[24:27]
 v_mfma_f32_16x16x32_bf16 v[20:23], a[192:195], a[136:139], v[20:23]
 v_mfma_f32_16x16x32_bf16 v[20:23], a[196:199], a[140:143], v[20:23]
 v_mfma_f32_16x16x32_bf16 v[16:19], a[196:199], a[132:135], v[16:19]
 v_mfma_f32_16x16x32_bf16 v[16:19], a[192:195], a[128:131], v[16:19]
 v_mfma_f32_16x16x32_bf16 v[48:51], a[200:203], a[128:131], v[48:51]
 v_mfma_f32_16x16x32_bf16 v[48:51], a[204:207], a[132:135], v[48:51]
 global_load_dwordx4 a[196:199], v0, s[70:71] offset:1024 sc1
 v_mfma_f32_16x16x32_bf16 v[52:55], a[204:207], a[140:143], v[52:55]
 v_mfma_f32_16x16x32_bf16 v[52:55], a[200:203], a[136:139], v[52:55]
 global_load_dwordx4 a[192:195], v0, s[70:71] offset:0 sc1
 v_mfma_f32_16x16x32_bf16 v[56:59], a[200:203], a[144:147], v[56:59]
 v_mfma_f32_16x16x32_bf16 v[56:59], a[204:207], a[148:151], v[56:59]
 v_mfma_f32_16x16x32_bf16 v[60:63], a[204:207], a[156:159], v[60:63]
 v_mfma_f32_16x16x32_bf16 v[60:63], a[200:203], a[152:155], v[60:63]
 v_mfma_f32_16x16x32_bf16 v[64:67], a[200:203], a[160:163], v[64:67]
 v_mfma_f32_16x16x32_bf16 v[64:67], a[204:207], a[164:167], v[64:67]
 v_mfma_f32_16x16x32_bf16 v[68:71], a[204:207], a[172:175], v[68:71]
 v_mfma_f32_16x16x32_bf16 v[68:71], a[200:203], a[168:171], v[68:71]
 v_mfma_f32_16x16x32_bf16 v[72:75], a[200:203], a[176:179], v[72:75]
 v_mfma_f32_16x16x32_bf16 v[72:75], a[204:207], a[180:183], v[72:75]
 v_mfma_f32_16x16x32_bf16 v[76:79], a[204:207], a[188:191], v[76:79]
 v_mfma_f32_16x16x32_bf16 v[76:79], a[200:203], a[184:187], v[76:79]
 v_mfma_f32_16x16x32_bf16 v[108:111], a[208:211], a[184:187], v[108:111]
 v_mfma_f32_16x16x32_bf16 v[108:111], a[212:215], a[188:191], v[108:111]
 global_load_dwordx4 a[204:207], v0, s[70:71] offset:3072 sc1
 v_mfma_f32_16x16x32_bf16 v[104:107], a[212:215], a[180:183], v[104:107]
 v_mfma_f32_16x16x32_bf16 v[104:107], a[208:211], a[176:179], v[104:107]
 global_load_dwordx4 a[200:203], v0, s[70:71] offset:2048 sc1
 v_mfma_f32_16x16x32_bf16 v[100:103], a[208:211], a[168:171], v[100:103]
 s_add_u32 s70, s70, 8192
 s_addc_u32 s71, s71, 0
 v_mfma_f32_16x16x32_bf16 v[100:103], a[212:215], a[172:175], v[100:103]
 v_mfma_f32_16x16x32_bf16 v[96:99], a[212:215], a[164:167], v[96:99]
 v_mfma_f32_16x16x32_bf16 v[96:99], a[208:211], a[160:163], v[96:99]
 v_mfma_f32_16x16x32_bf16 v[92:95], a[208:211], a[152:155], v[92:95]
 v_mfma_f32_16x16x32_bf16 v[92:95], a[212:215], a[156:159], v[92:95]
 v_mfma_f32_16x16x32_bf16 v[88:91], a[212:215], a[148:151], v[88:91]
 v_mfma_f32_16x16x32_bf16 v[88:91], a[208:211], a[144:147], v[88:91]
 v_mfma_f32_16x16x32_bf16 v[84:87], a[208:211], a[136:139], v[84:87]
 v_mfma_f32_16x16x32_bf16 v[84:87], a[212:215], a[140:143], v[84:87]
 v_mfma_f32_16x16x32_bf16 v[80:83], a[212:215], a[132:135], v[80:83]
 v_mfma_f32_16x16x32_bf16 v[80:83], a[208:211], a[128:131], v[80:83]
 v_mfma_f32_16x16x32_bf16 v[112:115], a[216:219], a[128:131], v[112:115]
 ds_read_b128 a[128:131], v1
 v_mfma_f32_16x16x32_bf16 v[112:115], a[220:223], a[132:135], v[112:115]
 global_load_dwordx4 a[212:215], v0, s[70:71] offset:-3072 sc1
 ds_read_b128 a[132:135], v1 offset:1024
 v_mfma_f32_16x16x32_bf16 v[116:119], a[220:223], a[140:143], v[116:119]
 ds_read_b128 a[140:143], v1 offset:5120
 v_mfma_f32_16x16x32_bf16 v[116:119], a[216:219], a[136:139], v[116:119]
 global_load_dwordx4 a[208:211], v0, s[70:71] offset:-4096 sc1
 ds_read_b128 a[136:139], v1 offset:4096
 v_mfma_f32_16x16x32_bf16 v[120:123], a[216:219], a[144:147], v[120:123]
 ds_read_b128 a[144:147], v1 offset:8192
 v_mfma_f32_16x16x32_bf16 v[120:123], a[220:223], a[148:151], v[120:123]
 ds_read_b128 a[148:151], v1 offset:9216
 v_mfma_f32_16x16x32_bf16 v[124:127], a[220:223], a[156:159], v[124:127]
 ds_read_b128 a[156:159], v1 offset:13312
 v_mfma_f32_16x16x32_bf16 v[124:127], a[216:219], a[152:155], v[124:127]
 ds_read_b128 a[152:155], v1 offset:12288
 v_mfma_f32_16x16x32_bf16 v[128:131], a[216:219], a[160:163], v[128:131]
 ds_read_b128 a[160:163], v1 offset:16384
 v_mfma_f32_16x16x32_bf16 v[128:131], a[220:223], a[164:167], v[128:131]
 ds_read_b128 a[164:167], v1 offset:17408
 v_mfma_f32_16x16x32_bf16 v[132:135], a[220:223], a[172:175], v[132:135]
 ds_read_b128 a[172:175], v1 offset:21504
 v_mfma_f32_16x16x32_bf16 v[132:135], a[216:219], a[168:171], v[132:135]
 ds_read_b128 a[168:171], v1 offset:20480
 v_mfma_f32_16x16x32_bf16 a[240:243], a[216:219], a[176:179], a[240:243]
 ds_read_b128 a[176:179], v1 offset:24576
 v_mfma_f32_16x16x32_bf16 a[240:243], a[220:223], a[180:183], a[240:243]
 ds_read_b128 a[180:183], v1 offset:25600
 v_mfma_f32_16x16x32_bf16 a[244:247], a[220:223], a[188:191], a[244:247]
 global_load_dwordx4 a[220:223], v0, s[70:71] offset:-1024 sc1
 ds_read_b128 a[188:191], v1 offset:29696
 v_mfma_f32_16x16x32_bf16 a[244:247], a[216:219], a[184:187], a[244:247]
 global_load_dwordx4 a[216:219], v0, s[70:71] offset:-2048 sc1
 ds_read_b128 a[184:187], v1 offset:28672
 s_waitcnt vmcnt(10) lgkmcnt(8)
 v_mfma_f32_16x16x32_bf16 v[136:139], a[224:227], a[128:131], v[136:139]
 v_lshrrev_b32 v5, 4, v1
 v_mfma_f32_16x16x32_bf16 v[136:139], a[228:231], a[132:135], v[136:139]
 v_and_b32 v5, 48, v5
 v_mfma_f32_16x16x32_bf16 v[140:143], a[228:231], a[140:143], v[140:143]
 v_xor_b32 v5, v5, v1
 v_mfma_f32_16x16x32_bf16 v[140:143], a[224:227], a[136:139], v[140:143]
 v_and_b32 v5, 112, v5
 v_mfma_f32_16x16x32_bf16 v[144:147], a[224:227], a[144:147], v[144:147]
 v_and_b32 v6, 240, v1
 v_mfma_f32_16x16x32_bf16 v[144:147], a[228:231], a[148:151], v[144:147]
 v_lshl_add_u32 v5, v6, 3, v5
 v_mfma_f32_16x16x32_bf16 v[148:151], a[228:231], a[156:159], v[148:151]
 v_add_u32 v8, s50, v5
 v_mfma_f32_16x16x32_bf16 v[148:151], a[224:227], a[152:155], v[148:151]
 v_xor_b32 v9, 64, v8
 s_waitcnt lgkmcnt(0)
 v_mfma_f32_16x16x32_bf16 v[152:155], a[224:227], a[160:163], v[152:155]
 v_mfma_f32_16x16x32_bf16 v[152:155], a[228:231], a[164:167], v[152:155]
 ds_read_b128 a[64:67], v8 offset:2048
 ds_read_b128 a[96:99], v9 offset:2048
 v_mfma_f32_16x16x32_bf16 v[156:159], a[228:231], a[172:175], v[156:159]
 v_mfma_f32_16x16x32_bf16 v[156:159], a[224:227], a[168:171], v[156:159]
 v_mfma_f32_16x16x32_bf16 v[160:163], a[224:227], a[176:179], v[160:163]
 v_mfma_f32_16x16x32_bf16 v[160:163], a[228:231], a[180:183], v[160:163]
 v_mfma_f32_16x16x32_bf16 v[164:167], a[228:231], a[188:191], v[164:167]
 ds_read_b128 a[68:71], v8 offset:6144
 v_mfma_f32_16x16x32_bf16 v[164:167], a[224:227], a[184:187], v[164:167]
 ds_read_b128 a[100:103], v9 offset:6144
 s_waitcnt vmcnt(8)
 v_mfma_f32_16x16x32_bf16 v[196:199], a[232:235], a[184:187], v[196:199]
 v_mfma_f32_16x16x32_bf16 v[196:199], a[236:239], a[188:191], v[196:199]
 global_load_dwordx4 a[228:231], v0, s[70:71] offset:1024 sc1
 v_mfma_f32_16x16x32_bf16 v[192:195], a[236:239], a[180:183], v[192:195]
 v_mfma_f32_16x16x32_bf16 v[192:195], a[232:235], a[176:179], v[192:195]
 global_load_dwordx4 a[224:227], v0, s[70:71] offset:0 sc1
 s_waitcnt lgkmcnt(2)
 v_mfma_f32_16x16x32_bf16 v[188:191], a[232:235], a[168:171], v[188:191]
 ds_write_b128 v3, a[64:67] offset:2048
 v_mfma_f32_16x16x32_bf16 v[188:191], a[236:239], a[172:175], v[188:191]
 ds_write_b128 v3, a[96:99] offset:3072
 v_mfma_f32_16x16x32_bf16 v[184:187], a[236:239], a[164:167], v[184:187]
 v_mfma_f32_16x16x32_bf16 v[184:187], a[232:235], a[160:163], v[184:187]
 ds_read_b128 a[72:75], v8 offset:10240
 v_mfma_f32_16x16x32_bf16 v[180:183], a[232:235], a[152:155], v[180:183]
 ds_read_b128 a[104:107], v9 offset:10240
 v_mfma_f32_16x16x32_bf16 v[180:183], a[236:239], a[156:159], v[180:183]
 v_mfma_f32_16x16x32_bf16 v[176:179], a[236:239], a[148:151], v[176:179]
 v_mfma_f32_16x16x32_bf16 v[176:179], a[232:235], a[144:147], v[176:179]
 v_mfma_f32_16x16x32_bf16 v[172:175], a[232:235], a[136:139], v[172:175]
 s_waitcnt lgkmcnt(4)
 v_mfma_f32_16x16x32_bf16 v[172:175], a[236:239], a[140:143], v[172:175]
 ds_write_b128 v3, a[68:71] offset:6144
 ds_write_b128 v3, a[100:103] offset:7168
 v_mfma_f32_16x16x32_bf16 v[168:171], a[236:239], a[132:135], v[168:171]
 v_mfma_f32_16x16x32_bf16 v[168:171], a[232:235], a[128:131], v[168:171]
 ds_read_b128 a[76:79], v8 offset:14336
 s_waitcnt vmcnt(8)
 v_mfma_f32_16x16x32_bf16 v[200:203], a[192:195], a[128:131], v[200:203]
 ds_read_b128 a[108:111], v9 offset:14336
 v_mfma_f32_16x16x32_bf16 v[200:203], a[196:199], a[132:135], v[200:203]
 global_load_dwordx4 a[236:239], v0, s[70:71] offset:3072 sc1
 v_mfma_f32_16x16x32_bf16 v[204:207], a[196:199], a[140:143], v[204:207]
 v_mfma_f32_16x16x32_bf16 v[204:207], a[192:195], a[136:139], v[204:207]
 global_load_dwordx4 a[232:235], v0, s[70:71] offset:2048 sc1
 v_mfma_f32_16x16x32_bf16 v[208:211], a[192:195], a[144:147], v[208:211]
 s_waitcnt lgkmcnt(4)
 s_add_u32 s70, s70, 8192
 s_addc_u32 s71, s71, 0
 v_mfma_f32_16x16x32_bf16 v[208:211], a[196:199], a[148:151], v[208:211]
 ds_write_b128 v3, a[72:75] offset:10240
 v_mfma_f32_16x16x32_bf16 v[212:215], a[196:199], a[156:159], v[212:215]
 ds_write_b128 v3, a[104:107] offset:11264
 v_mfma_f32_16x16x32_bf16 v[212:215], a[192:195], a[152:155], v[212:215]
 v_mfma_f32_16x16x32_bf16 v[216:219], a[192:195], a[160:163], v[216:219]
 ds_read_b128 a[80:83], v8 offset:18432
 v_mfma_f32_16x16x32_bf16 v[216:219], a[196:199], a[164:167], v[216:219]
 ds_read_b128 a[112:115], v9 offset:18432
 v_mfma_f32_16x16x32_bf16 v[220:223], a[196:199], a[172:175], v[220:223]
 v_mfma_f32_16x16x32_bf16 v[220:223], a[192:195], a[168:171], v[220:223]
 v_mfma_f32_16x16x32_bf16 v[224:227], a[192:195], a[176:179], v[224:227]
 s_waitcnt lgkmcnt(4)
 ds_write_b128 v3, a[76:79] offset:14336
 ds_write_b128 v3, a[108:111] offset:15360
 v_mfma_f32_16x16x32_bf16 v[224:227], a[196:199], a[180:183], v[224:227]
 v_mfma_f32_16x16x32_bf16 v[228:231], a[196:199], a[188:191], v[228:231]
 v_mfma_f32_16x16x32_bf16 v[228:231], a[192:195], a[184:187], v[228:231]
 s_waitcnt vmcnt(8)
 v_mfma_f32_16x16x32_bf16 a[252:255], a[200:203], a[184:187], a[252:255]
 ds_read_b128 a[184:187], v1 offset:61440
 ds_read_b128 a[84:87], v8 offset:22528
 v_mfma_f32_16x16x32_bf16 a[252:255], a[204:207], a[188:191], a[252:255]
 global_load_dwordx4 a[196:199], v0, s[70:71] offset:-3072 sc1
 ds_read_b128 a[188:191], v1 offset:62464
 v_mfma_f32_16x16x32_bf16 a[248:251], a[204:207], a[180:183], a[248:251]
 ds_read_b128 a[180:183], v1 offset:58368
 ds_read_b128 a[116:119], v9 offset:22528
 v_mfma_f32_16x16x32_bf16 a[248:251], a[200:203], a[176:179], a[248:251]
 global_load_dwordx4 a[192:195], v0, s[70:71] offset:-4096 sc1
 ds_read_b128 a[176:179], v1 offset:57344
 v_mfma_f32_16x16x32_bf16 v[252:255], a[200:203], a[168:171], v[252:255]
 ds_read_b128 a[168:171], v1 offset:53248
 v_mfma_f32_16x16x32_bf16 v[252:255], a[204:207], a[172:175], v[252:255]
 ds_read_b128 a[172:175], v1 offset:54272
 s_waitcnt lgkmcnt(10)
 v_mfma_f32_16x16x32_bf16 v[248:251], a[204:207], a[164:167], v[248:251]
 ds_read_b128 a[164:167], v1 offset:50176
 v_mfma_f32_16x16x32_bf16 v[248:251], a[200:203], a[160:163], v[248:251]
 ds_read_b128 a[160:163], v1 offset:49152
 v_mfma_f32_16x16x32_bf16 v[244:247], a[200:203], a[152:155], v[244:247]
 ds_read_b128 a[152:155], v1 offset:45056
 v_mfma_f32_16x16x32_bf16 v[244:247], a[204:207], a[156:159], v[244:247]
 ds_read_b128 a[156:159], v1 offset:46080
 v_mfma_f32_16x16x32_bf16 v[240:243], a[204:207], a[148:151], v[240:243]
 ds_read_b128 a[148:151], v1 offset:41984
 v_mfma_f32_16x16x32_bf16 v[240:243], a[200:203], a[144:147], v[240:243]
 ds_read_b128 a[144:147], v1 offset:40960
 v_mfma_f32_16x16x32_bf16 v[236:239], a[200:203], a[136:139], v[236:239]
 ds_read_b128 a[136:139], v1 offset:36864
 v_mfma_f32_16x16x32_bf16 v[236:239], a[204:207], a[140:143], v[236:239]
 ds_read_b128 a[140:143], v1 offset:37888
 v_mfma_f32_16x16x32_bf16 v[232:235], a[204:207], a[132:135], v[232:235]
 ds_read_b128 a[132:135], v1 offset:33792
 v_mfma_f32_16x16x32_bf16 v[232:235], a[200:203], a[128:131], v[232:235]
 ds_read_b128 a[128:131], v1 offset:32768
 ds_write_b128 v3, a[80:83] offset:18432
 ds_write_b128 v3, a[112:115] offset:19456
 ds_read_b128 a[88:91], v8 offset:26624
 ds_read_b128 a[120:123], v9 offset:26624
 s_waitcnt vmcnt(8) lgkmcnt(12)
 v_mfma_f32_16x16x32_bf16 v[164:167], a[208:211], a[184:187], v[164:167]
 v_mfma_f32_16x16x32_bf16 v[164:167], a[212:215], a[188:191], v[164:167]
 global_load_dwordx4 a[204:207], v0, s[70:71] offset:-1024 sc1
 v_mfma_f32_16x16x32_bf16 v[160:163], a[212:215], a[180:183], v[160:163]
 ds_write_b128 v3, a[84:87] offset:22528
 ds_write_b128 v3, a[116:119] offset:23552
 v_mfma_f32_16x16x32_bf16 v[160:163], a[208:211], a[176:179], v[160:163]
 global_load_dwordx4 a[200:203], v0, s[70:71] offset:-2048 sc1
 ds_read_b128 a[92:95], v8 offset:30720
 v_mfma_f32_16x16x32_bf16 v[156:159], a[208:211], a[168:171], v[156:159]
 ds_read_b128 a[124:127], v9 offset:30720
 v_mfma_f32_16x16x32_bf16 v[156:159], a[212:215], a[172:175], v[156:159]
 v_mfma_f32_16x16x32_bf16 v[152:155], a[212:215], a[164:167], v[152:155]
 v_mfma_f32_16x16x32_bf16 v[152:155], a[208:211], a[160:163], v[152:155]
 s_waitcnt lgkmcnt(4)
 ds_write_b128 v3, a[88:91] offset:26624
 v_mfma_f32_16x16x32_bf16 v[148:151], a[208:211], a[152:155], v[148:151]
 ds_write_b128 v3, a[120:123] offset:27648
 v_mfma_f32_16x16x32_bf16 v[148:151], a[212:215], a[156:159], v[148:151]
 v_mfma_f32_16x16x32_bf16 v[144:147], a[212:215], a[148:151], v[144:147]
 v_mfma_f32_16x16x32_bf16 v[144:147], a[208:211], a[144:147], v[144:147]
 v_mfma_f32_16x16x32_bf16 v[140:143], a[208:211], a[136:139], v[140:143]
 v_mfma_f32_16x16x32_bf16 v[140:143], a[212:215], a[140:143], v[140:143]
 s_waitcnt lgkmcnt(2)
 v_mfma_f32_16x16x32_bf16 v[136:139], a[212:215], a[132:135], v[136:139]
 ds_write_b128 v3, a[92:95] offset:30720
 v_mfma_f32_16x16x32_bf16 v[136:139], a[208:211], a[128:131], v[136:139]
 ds_write_b128 v3, a[124:127] offset:31744
 s_waitcnt vmcnt(8)
 v_mfma_f32_16x16x32_bf16 v[168:171], a[216:219], a[128:131], v[168:171]
 v_bfe_u32 v4, v3, 8, 2
 v_mfma_f32_16x16x32_bf16 v[168:171], a[220:223], a[132:135], v[168:171]
 global_load_dwordx4 a[212:215], v0, s[70:71] offset:1024 sc1
 v_lshl_add_u32 v4, v4, 5, s51
 v_mfma_f32_16x16x32_bf16 v[172:175], a[220:223], a[140:143], v[172:175]
 ds_read_b128 v[8:11], v4
 v_mfma_f32_16x16x32_bf16 v[172:175], a[216:219], a[136:139], v[172:175]
 global_load_dwordx4 a[208:211], v0, s[70:71] offset:0 sc1
 v_mfma_f32_16x16x32_bf16 v[176:179], a[216:219], a[144:147], v[176:179]
 v_mfma_f32_16x16x32_bf16 v[176:179], a[220:223], a[148:151], v[176:179]
 v_mfma_f32_16x16x32_bf16 v[180:183], a[220:223], a[156:159], v[180:183]
 v_mfma_f32_16x16x32_bf16 v[180:183], a[216:219], a[152:155], v[180:183]
 v_mfma_f32_16x16x32_bf16 v[184:187], a[216:219], a[160:163], v[184:187]
 v_mfma_f32_16x16x32_bf16 v[184:187], a[220:223], a[164:167], v[184:187]
 v_mfma_f32_16x16x32_bf16 v[188:191], a[220:223], a[172:175], v[188:191]
 v_mfma_f32_16x16x32_bf16 v[188:191], a[216:219], a[168:171], v[188:191]
 s_waitcnt lgkmcnt(0)
 v_add_f32 v16, v16, v8
 v_mfma_f32_16x16x32_bf16 v[192:195], a[216:219], a[176:179], v[192:195]
 ds_read_b128 v[12:15], v4 offset:16
 v_mfma_f32_16x16x32_bf16 v[192:195], a[220:223], a[180:183], v[192:195]
 v_add_f32 v17, v17, v9
 v_mfma_f32_16x16x32_bf16 v[196:199], a[220:223], a[188:191], v[196:199]
 v_add_f32 v18, v18, v10
 v_mfma_f32_16x16x32_bf16 v[196:199], a[216:219], a[184:187], v[196:199]
 v_add_f32 v19, v19, v11
 s_waitcnt vmcnt(8)
 v_mfma_f32_16x16x32_bf16 v[228:231], a[224:227], a[184:187], v[228:231]
 v_add_f32 v20, v20, v8
 v_mfma_f32_16x16x32_bf16 v[228:231], a[228:231], a[188:191], v[228:231]
 global_load_dwordx4 a[220:223], v0, s[70:71] offset:3072 sc1
 v_add_f32 v21, v21, v9
 v_mfma_f32_16x16x32_bf16 v[224:227], a[228:231], a[180:183], v[224:227]
 v_add_f32 v22, v22, v10
 v_mfma_f32_16x16x32_bf16 v[224:227], a[224:227], a[176:179], v[224:227]
 global_load_dwordx4 a[216:219], v0, s[70:71] offset:2048 sc1
 v_add_f32 v23, v23, v11
 v_mfma_f32_16x16x32_bf16 v[220:223], a[224:227], a[168:171], v[220:223]
 v_add_f32 v24, v24, v8
 s_add_u32 s70, s70, 8192
 s_addc_u32 s71, s71, 0
 v_mfma_f32_16x16x32_bf16 v[220:223], a[228:231], a[172:175], v[220:223]
 v_add_f32 v25, v25, v9
 v_mfma_f32_16x16x32_bf16 v[216:219], a[228:231], a[164:167], v[216:219]
 v_add_f32 v26, v26, v10
 v_mfma_f32_16x16x32_bf16 v[216:219], a[224:227], a[160:163], v[216:219]
 v_add_f32 v27, v27, v11
 v_mfma_f32_16x16x32_bf16 v[212:215], a[224:227], a[152:155], v[212:215]
 v_add_f32 v28, v28, v8
 v_mfma_f32_16x16x32_bf16 v[212:215], a[228:231], a[156:159], v[212:215]
 v_add_f32 v29, v29, v9
 v_mfma_f32_16x16x32_bf16 v[208:211], a[228:231], a[148:151], v[208:211]
 v_add_f32 v30, v30, v10
 v_mfma_f32_16x16x32_bf16 v[208:211], a[224:227], a[144:147], v[208:211]
 v_add_f32 v31, v31, v11
 v_add_f32 v32, v32, v8
 v_mfma_f32_16x16x32_bf16 v[204:207], a[224:227], a[136:139], v[204:207]
 v_add_f32 v33, v33, v9
 v_mfma_f32_16x16x32_bf16 v[204:207], a[228:231], a[140:143], v[204:207]
 v_add_f32 v34, v34, v10
 v_mfma_f32_16x16x32_bf16 v[200:203], a[228:231], a[132:135], v[200:203]
 v_add_f32 v35, v35, v11
 v_mfma_f32_16x16x32_bf16 v[200:203], a[224:227], a[128:131], v[200:203]
 v_add_f32 v36, v36, v8
 v_add_f32 v37, v37, v9
 s_waitcnt vmcnt(8)
 v_mfma_f32_16x16x32_bf16 v[232:235], a[232:235], a[128:131], v[232:235]
 ds_read_b128 a[128:131], v2
 v_add_f32 v38, v38, v10
 v_mfma_f32_16x16x32_bf16 v[232:235], a[236:239], a[132:135], v[232:235]
 global_load_dwordx4 a[228:231], v0, s[70:71] offset:-3072 sc1
 ds_read_b128 a[132:135], v2 offset:1024
 v_mfma_f32_16x16x32_bf16 v[236:239], a[236:239], a[140:143], v[236:239]
 ds_read_b128 a[140:143], v2 offset:5120
 v_add_f32 v39, v39, v11
 v_mfma_f32_16x16x32_bf16 v[236:239], a[232:235], a[136:139], v[236:239]
 global_load_dwordx4 a[224:227], v0, s[70:71] offset:-4096 sc1
 ds_read_b128 a[136:139], v2 offset:4096
 v_mfma_f32_16x16x32_bf16 v[240:243], a[232:235], a[144:147], v[240:243]
 ds_read_b128 a[144:147], v2 offset:8192
 v_add_f32 v40, v40, v8
 v_mfma_f32_16x16x32_bf16 v[240:243], a[236:239], a[148:151], v[240:243]
 ds_read_b128 a[148:151], v2 offset:9216
 v_add_f32 v41, v41, v9
 v_mfma_f32_16x16x32_bf16 v[244:247], a[236:239], a[156:159], v[244:247]
 ds_read_b128 a[156:159], v2 offset:13312
 v_add_f32 v42, v42, v10
 v_mfma_f32_16x16x32_bf16 v[244:247], a[232:235], a[152:155], v[244:247]
 ds_read_b128 a[152:155], v2 offset:12288
 v_add_f32 v43, v43, v11
 v_mfma_f32_16x16x32_bf16 v[248:251], a[232:235], a[160:163], v[248:251]
 ds_read_b128 a[160:163], v2 offset:16384
 v_add_f32 v44, v44, v8
 v_mfma_f32_16x16x32_bf16 v[248:251], a[236:239], a[164:167], v[248:251]
 ds_read_b128 a[164:167], v2 offset:17408
 v_add_f32 v45, v45, v9
 v_mfma_f32_16x16x32_bf16 v[252:255], a[236:239], a[172:175], v[252:255]
 ds_read_b128 a[172:175], v2 offset:21504
 v_add_f32 v46, v46, v10
 v_mfma_f32_16x16x32_bf16 v[252:255], a[232:235], a[168:171], v[252:255]
 ds_read_b128 a[168:171], v2 offset:20480
 v_add_f32 v47, v47, v11
 s_waitcnt lgkmcnt(12)
 v_mfma_f32_16x16x32_bf16 a[248:251], a[232:235], a[176:179], a[248:251]
 ds_read_b128 a[176:179], v2 offset:24576
 v_add_f32 v48, v48, v12
 v_mfma_f32_16x16x32_bf16 a[248:251], a[236:239], a[180:183], a[248:251]
 ds_read_b128 a[180:183], v2 offset:25600
 ds_read_b128 v[8:11], v4 offset:128
 v_mfma_f32_16x16x32_bf16 a[252:255], a[236:239], a[188:191], a[252:255]
 ds_read_b128 a[188:191], v2 offset:29696
 v_add_f32 v49, v49, v13
 v_mfma_f32_16x16x32_bf16 a[252:255], a[232:235], a[184:187], a[252:255]
 ds_read_b128 a[184:187], v2 offset:28672
 v_add_f32 v50, v50, v14
 s_waitcnt vmcnt(8) lgkmcnt(9)
 v_mfma_f32_16x16x32_bf16 v[136:139], a[192:195], a[128:131], v[136:139]
 v_add_f32 v51, v51, v15
 v_add_f32 v52, v52, v12
 v_mfma_f32_16x16x32_bf16 v[136:139], a[196:199], a[132:135], v[136:139]
 global_load_dwordx4 a[236:239], v0, s[70:71] offset:-1024 sc1
 v_add_f32 v53, v53, v13
 v_mfma_f32_16x16x32_bf16 v[140:143], a[196:199], a[140:143], v[140:143]
 v_add_f32 v54, v54, v14
 v_mfma_f32_16x16x32_bf16 v[140:143], a[192:195], a[136:139], v[140:143]
 global_load_dwordx4 a[232:235], v0, s[70:71] offset:-2048 sc1
 v_add_f32 v55, v55, v15
 v_mfma_f32_16x16x32_bf16 v[144:147], a[192:195], a[144:147], v[144:147]
 v_add_f32 v56, v56, v12
 v_mfma_f32_16x16x32_bf16 v[144:147], a[196:199], a[148:151], v[144:147]
 v_add_f32 v57, v57, v13
 v_mfma_f32_16x16x32_bf16 v[148:151], a[196:199], a[156:159], v[148:151]
 v_add_f32 v58, v58, v14
 v_mfma_f32_16x16x32_bf16 v[148:151], a[192:195], a[152:155], v[148:151]
 v_add_f32 v59, v59, v15
 s_waitcnt lgkmcnt(0)
 v_mfma_f32_16x16x32_bf16 v[152:155], a[192:195], a[160:163], v[152:155]
 v_add_f32 v60, v60, v12
 v_mfma_f32_16x16x32_bf16 v[152:155], a[196:199], a[164:167], v[152:155]
 v_add_f32 v61, v61, v13
 v_mfma_f32_16x16x32_bf16 v[156:159], a[196:199], a[172:175], v[156:159]
 v_add_f32 v62, v62, v14
 v_mfma_f32_16x16x32_bf16 v[156:159], a[192:195], a[168:171], v[156:159]
 v_add_f32 v63, v63, v15
 v_mfma_f32_16x16x32_bf16 v[160:163], a[192:195], a[176:179], v[160:163]
 v_add_f32 v64, v64, v12
 v_mfma_f32_16x16x32_bf16 v[160:163], a[196:199], a[180:183], v[160:163]
 v_add_f32 v65, v65, v13
 v_mfma_f32_16x16x32_bf16 v[164:167], a[196:199], a[188:191], v[164:167]
 v_add_f32 v66, v66, v14
 v_mfma_f32_16x16x32_bf16 v[164:167], a[192:195], a[184:187], v[164:167]
 v_add_f32 v67, v67, v15
 s_waitcnt vmcnt(8)
 v_mfma_f32_16x16x32_bf16 v[196:199], a[200:203], a[184:187], v[196:199]
 v_add_f32 v68, v68, v12
 v_mfma_f32_16x16x32_bf16 v[196:199], a[204:207], a[188:191], v[196:199]
 global_load_dwordx4 a[196:199], v0, s[70:71] offset:1024 sc1
 v_add_f32 v69, v69, v13
 v_mfma_f32_16x16x32_bf16 v[192:195], a[204:207], a[180:183], v[192:195]
 v_add_f32 v70, v70, v14
 v_add_f32 v71, v71, v15
 v_mfma_f32_16x16x32_bf16 v[192:195], a[200:203], a[176:179], v[192:195]
 global_load_dwordx4 a[192:195], v0, s[70:71] offset:0 sc1
 v_add_f32 v72, v72, v12
 v_mfma_f32_16x16x32_bf16 v[188:191], a[200:203], a[168:171], v[188:191]
 v_add_f32 v73, v73, v13
 v_mfma_f32_16x16x32_bf16 v[188:191], a[204:207], a[172:175], v[188:191]
 v_add_f32 v74, v74, v14
 v_mfma_f32_16x16x32_bf16 v[184:187], a[204:207], a[164:167], v[184:187]
 v_add_f32 v75, v75, v15
 v_mfma_f32_16x16x32_bf16 v[184:187], a[200:203], a[160:163], v[184:187]
 v_add_f32 v76, v76, v12
 v_mfma_f32_16x16x32_bf16 v[180:183], a[200:203], a[152:155], v[180:183]
 v_add_f32 v77, v77, v13
 v_mfma_f32_16x16x32_bf16 v[180:183], a[204:207], a[156:159], v[180:183]
 v_add_f32 v78, v78, v14
 v_mfma_f32_16x16x32_bf16 v[176:179], a[204:207], a[148:151], v[176:179]
 v_add_f32 v79, v79, v15
 v_mfma_f32_16x16x32_bf16 v[176:179], a[200:203], a[144:147], v[176:179]
 v_mfma_f32_16x16x32_bf16 v[172:175], a[200:203], a[136:139], v[172:175]
 v_add_f32 v80, v80, v8
 v_mfma_f32_16x16x32_bf16 v[172:175], a[204:207], a[140:143], v[172:175]
 ds_read_b128 v[12:15], v4 offset:144
 v_mfma_f32_16x16x32_bf16 v[168:171], a[204:207], a[132:135], v[168:171]
 v_add_f32 v81, v81, v9
 v_mfma_f32_16x16x32_bf16 v[168:171], a[200:203], a[128:131], v[168:171]
 v_add_f32 v82, v82, v10
 s_waitcnt vmcnt(8)
 v_mfma_f32_16x16x32_bf16 v[200:203], a[208:211], a[128:131], v[200:203]
 v_add_f32 v83, v83, v11
 v_mfma_f32_16x16x32_bf16 v[200:203], a[212:215], a[132:135], v[200:203]
 global_load_dwordx4 a[204:207], v0, s[70:71] offset:3072 sc1
 v_add_f32 v84, v84, v8
 v_mfma_f32_16x16x32_bf16 v[204:207], a[212:215], a[140:143], v[204:207]
 v_add_f32 v85, v85, v9
 v_mfma_f32_16x16x32_bf16 v[204:207], a[208:211], a[136:139], v[204:207]
 global_load_dwordx4 a[200:203], v0, s[70:71] offset:2048 sc1
 v_add_f32 v86, v86, v10
 v_mfma_f32_16x16x32_bf16 v[208:211], a[208:211], a[144:147], v[208:211]
 v_add_f32 v87, v87, v11
 s_add_u32 s70, s70, 8192
 s_addc_u32 s71, s71, 0
 v_mfma_f32_16x16x32_bf16 v[208:211], a[212:215], a[148:151], v[208:211]
 v_add_f32 v88, v88, v8
 v_add_f32 v89, v89, v9
 v_mfma_f32_16x16x32_bf16 v[212:215], a[212:215], a[156:159], v[212:215]
 v_add_f32 v90, v90, v10
 v_mfma_f32_16x16x32_bf16 v[212:215], a[208:211], a[152:155], v[212:215]
 v_add_f32 v91, v91, v11
 v_mfma_f32_16x16x32_bf16 v[216:219], a[208:211], a[160:163], v[216:219]
 v_add_f32 v92, v92, v8
 v_mfma_f32_16x16x32_bf16 v[216:219], a[212:215], a[164:167], v[216:219]
 v_add_f32 v93, v93, v9
 v_mfma_f32_16x16x32_bf16 v[220:223], a[212:215], a[172:175], v[220:223]
 v_add_f32 v94, v94, v10
 v_mfma_f32_16x16x32_bf16 v[220:223], a[208:211], a[168:171], v[220:223]
 v_add_f32 v95, v95, v11
 v_mfma_f32_16x16x32_bf16 v[224:227], a[208:211], a[176:179], v[224:227]
 v_add_f32 v96, v96, v8
 v_mfma_f32_16x16x32_bf16 v[224:227], a[212:215], a[180:183], v[224:227]
 v_add_f32 v97, v97, v9
 v_mfma_f32_16x16x32_bf16 v[228:231], a[212:215], a[188:191], v[228:231]
 v_add_f32 v98, v98, v10
 v_add_f32 v99, v99, v11
 v_mfma_f32_16x16x32_bf16 v[228:231], a[208:211], a[184:187], v[228:231]
 v_add_f32 v100, v100, v8
 v_add_f32 v101, v101, v9
 s_waitcnt vmcnt(8)
 v_mfma_f32_16x16x32_bf16 a[252:255], a[216:219], a[184:187], a[252:255]
 ds_read_b128 a[184:187], v2 offset:61440
 v_add_f32 v102, v102, v10
 v_mfma_f32_16x16x32_bf16 a[252:255], a[220:223], a[188:191], a[252:255]
 global_load_dwordx4 a[212:215], v0, s[70:71] offset:-3072 sc1
 ds_read_b128 a[188:191], v2 offset:62464
 v_mfma_f32_16x16x32_bf16 a[248:251], a[220:223], a[180:183], a[248:251]
 ds_read_b128 a[180:183], v2 offset:58368
 v_add_f32 v103, v103, v11
 v_mfma_f32_16x16x32_bf16 a[248:251], a[216:219], a[176:179], a[248:251]
 global_load_dwordx4 a[208:211], v0, s[70:71] offset:-4096 sc1
 ds_read_b128 a[176:179], v2 offset:57344
 v_mfma_f32_16x16x32_bf16 v[252:255], a[216:219], a[168:171], v[252:255]
 ds_read_b128 a[168:171], v2 offset:53248
 v_add_f32 v104, v104, v8
 v_mfma_f32_16x16x32_bf16 v[252:255], a[220:223], a[172:175], v[252:255]
 ds_read_b128 a[172:175], v2 offset:54272
 v_add_f32 v105, v105, v9
 v_mfma_f32_16x16x32_bf16 v[248:251], a[220:223], a[164:167], v[248:251]
 ds_read_b128 a[164:167], v2 offset:50176
 v_add_f32 v106, v106, v10
 v_mfma_f32_16x16x32_bf16 v[248:251], a[216:219], a[160:163], v[248:251]
 ds_read_b128 a[160:163], v2 offset:49152
 v_add_f32 v107, v107, v11
 v_mfma_f32_16x16x32_bf16 v[244:247], a[216:219], a[152:155], v[244:247]
 ds_read_b128 a[152:155], v2 offset:45056
 v_add_f32 v108, v108, v8
 v_mfma_f32_16x16x32_bf16 v[244:247], a[220:223], a[156:159], v[244:247]
 ds_read_b128 a[156:159], v2 offset:46080
 v_add_f32 v109, v109, v9
 v_mfma_f32_16x16x32_bf16 v[240:243], a[220:223], a[148:151], v[240:243]
 ds_read_b128 a[148:151], v2 offset:41984
 v_add_f32 v110, v110, v10
 v_mfma_f32_16x16x32_bf16 v[240:243], a[216:219], a[144:147], v[240:243]
 ds_read_b128 a[144:147], v2 offset:40960
 v_add_f32 v111, v111, v11
 s_waitcnt lgkmcnt(12)
 v_mfma_f32_16x16x32_bf16 v[236:239], a[216:219], a[136:139], v[236:239]
 ds_read_b128 a[136:139], v2 offset:36864
 v_add_f32 v112, v112, v12
 v_mfma_f32_16x16x32_bf16 v[236:239], a[220:223], a[140:143], v[236:239]
 ds_read_b128 a[140:143], v2 offset:37888
 v_add_f32 v113, v113, v13
 v_mfma_f32_16x16x32_bf16 v[232:235], a[220:223], a[132:135], v[232:235]
 ds_read_b128 a[132:135], v2 offset:33792
 v_add_f32 v114, v114, v14
 v_mfma_f32_16x16x32_bf16 v[232:235], a[216:219], a[128:131], v[232:235]
 ds_read_b128 a[128:131], v2 offset:32768
 v_add_f32 v115, v115, v15
 s_waitcnt vmcnt(8) lgkmcnt(8)
 v_mfma_f32_16x16x32_bf16 v[164:167], a[224:227], a[184:187], v[164:167]
 v_add_f32 v116, v116, v12
 v_mfma_f32_16x16x32_bf16 v[164:167], a[228:231], a[188:191], v[164:167]
 global_load_dwordx4 a[220:223], v0, s[70:71] offset:-1024 sc1
 v_add_f32 v117, v117, v13
 v_mfma_f32_16x16x32_bf16 v[160:163], a[228:231], a[180:183], v[160:163]
 v_add_f32 v118, v118, v14
 v_mfma_f32_16x16x32_bf16 v[160:163], a[224:227], a[176:179], v[160:163]
 global_load_dwordx4 a[216:219], v0, s[70:71] offset:-2048 sc1
 v_add_f32 v119, v119, v15
 v_mfma_f32_16x16x32_bf16 v[156:159], a[224:227], a[168:171], v[156:159]
 v_add_f32 v120, v120, v12
 v_mfma_f32_16x16x32_bf16 v[156:159], a[228:231], a[172:175], v[156:159]
 v_add_f32 v121, v121, v13
 v_mfma_f32_16x16x32_bf16 v[152:155], a[228:231], a[164:167], v[152:155]
 v_add_f32 v122, v122, v14
 v_mfma_f32_16x16x32_bf16 v[152:155], a[224:227], a[160:163], v[152:155]
 v_add_f32 v123, v123, v15
 s_waitcnt lgkmcnt(0)
 v_mfma_f32_16x16x32_bf16 v[148:151], a[224:227], a[152:155], v[148:151]
 v_add_f32 v124, v124, v12
 v_mfma_f32_16x16x32_bf16 v[148:151], a[228:231], a[156:159], v[148:151]
 v_add_f32 v125, v125, v13
 v_mfma_f32_16x16x32_bf16 v[144:147], a[228:231], a[148:151], v[144:147]
 v_add_f32 v126, v126, v14
 v_mfma_f32_16x16x32_bf16 v[144:147], a[224:227], a[144:147], v[144:147]
 v_add_f32 v127, v127, v15
 v_mfma_f32_16x16x32_bf16 v[140:143], a[224:227], a[136:139], v[140:143]
 v_add_f32 v128, v128, v12
 v_add_f32 v129, v129, v13
 v_mfma_f32_16x16x32_bf16 v[140:143], a[228:231], a[140:143], v[140:143]
 v_add_f32 v130, v130, v14
 v_mfma_f32_16x16x32_bf16 v[136:139], a[228:231], a[132:135], v[136:139]
 v_add_f32 v131, v131, v15
 v_mfma_f32_16x16x32_bf16 v[136:139], a[224:227], a[128:131], v[136:139]
 v_add_f32 v132, v132, v12
 s_waitcnt vmcnt(8)
 v_mfma_f32_16x16x32_bf16 v[168:171], a[232:235], a[128:131], v[168:171]
 v_add_f32 v133, v133, v13
 v_mfma_f32_16x16x32_bf16 v[168:171], a[236:239], a[132:135], v[168:171]
 global_load_dwordx4 a[228:231], v0, s[70:71] offset:1024 sc1
 v_add_f32 v134, v134, v14
 v_mfma_f32_16x16x32_bf16 v[172:175], a[236:239], a[140:143], v[172:175]
 v_add_f32 v135, v135, v15
 v_mfma_f32_16x16x32_bf16 v[172:175], a[232:235], a[136:139], v[172:175]
 global_load_dwordx4 a[224:227], v0, s[70:71] offset:0 sc1
 v_accvgpr_read_b32 v5, a240
 v_mfma_f32_16x16x32_bf16 v[176:179], a[232:235], a[144:147], v[176:179]
 v_add_f32 v5, v5, v12
 v_mfma_f32_16x16x32_bf16 v[176:179], a[236:239], a[148:151], v[176:179]
 v_accvgpr_write_b32 a240, v5
 v_mfma_f32_16x16x32_bf16 v[180:183], a[236:239], a[156:159], v[180:183]
 v_accvgpr_read_b32 v6, a241
 v_mfma_f32_16x16x32_bf16 v[180:183], a[232:235], a[152:155], v[180:183]
 v_add_f32 v6, v6, v13
 v_mfma_f32_16x16x32_bf16 v[184:187], a[232:235], a[160:163], v[184:187]
 v_accvgpr_write_b32 a241, v6
 v_mfma_f32_16x16x32_bf16 v[184:187], a[236:239], a[164:167], v[184:187]
 v_accvgpr_read_b32 v5, a242
 v_mfma_f32_16x16x32_bf16 v[188:191], a[236:239], a[172:175], v[188:191]
 v_add_f32 v5, v5, v14
 v_mfma_f32_16x16x32_bf16 v[188:191], a[232:235], a[168:171], v[188:191]
 v_accvgpr_write_b32 a242, v5
 v_mfma_f32_16x16x32_bf16 v[192:195], a[232:235], a[176:179], v[192:195]
 v_accvgpr_read_b32 v6, a243
 v_mfma_f32_16x16x32_bf16 v[192:195], a[236:239], a[180:183], v[192:195]
 v_add_f32 v6, v6, v15
 v_mfma_f32_16x16x32_bf16 v[196:199], a[236:239], a[188:191], v[196:199]
 v_accvgpr_write_b32 a243, v6
 v_mfma_f32_16x16x32_bf16 v[196:199], a[232:235], a[184:187], v[196:199]
 v_accvgpr_read_b32 v5, a244
 s_waitcnt vmcnt(8)
 v_mfma_f32_16x16x32_bf16 v[228:231], a[192:195], a[184:187], v[228:231]
 v_add_f32 v5, v5, v12
 v_accvgpr_write_b32 a244, v5
 v_mfma_f32_16x16x32_bf16 v[228:231], a[196:199], a[188:191], v[228:231]
 global_load_dwordx4 a[236:239], v0, s[70:71] offset:3072 sc1
 v_accvgpr_read_b32 v6, a245
 v_mfma_f32_16x16x32_bf16 v[224:227], a[196:199], a[180:183], v[224:227]
 v_add_f32 v6, v6, v13
 v_mfma_f32_16x16x32_bf16 v[224:227], a[192:195], a[176:179], v[224:227]
 global_load_dwordx4 a[232:235], v0, s[70:71] offset:2048 sc1
 v_accvgpr_write_b32 a245, v6
 v_mfma_f32_16x16x32_bf16 v[220:223], a[192:195], a[168:171], v[220:223]
 v_accvgpr_read_b32 v5, a246
 s_add_u32 s70, s70, 8192
 s_addc_u32 s71, s71, 0
 v_mfma_f32_16x16x32_bf16 v[220:223], a[196:199], a[172:175], v[220:223]
 v_add_f32 v5, v5, v14
 v_mfma_f32_16x16x32_bf16 v[216:219], a[196:199], a[164:167], v[216:219]
 v_accvgpr_write_b32 a246, v5
 v_mfma_f32_16x16x32_bf16 v[216:219], a[192:195], a[160:163], v[216:219]
 v_accvgpr_read_b32 v6, a247
 v_mfma_f32_16x16x32_bf16 v[212:215], a[192:195], a[152:155], v[212:215]
 v_add_f32 v6, v6, v15
 v_mfma_f32_16x16x32_bf16 v[212:215], a[196:199], a[156:159], v[212:215]
 v_accvgpr_write_b32 a247, v6
 v_mfma_f32_16x16x32_bf16 v[208:211], a[196:199], a[148:151], v[208:211]
 s_add_u32 s55, s55, 1
 s_waitcnt lgkmcnt(0)
 s_barrier
 v_mfma_f32_16x16x32_bf16 v[208:211], a[192:195], a[144:147], v[208:211]
 v_mfma_f32_16x16x32_bf16 v[204:207], a[192:195], a[136:139], v[204:207]
 v_mfma_f32_16x16x32_bf16 v[204:207], a[196:199], a[140:143], v[204:207]
 v_mfma_f32_16x16x32_bf16 v[200:203], a[196:199], a[132:135], v[200:203]
 v_mfma_f32_16x16x32_bf16 v[200:203], a[192:195], a[128:131], v[200:203]
 s_waitcnt vmcnt(8)
 v_mfma_f32_16x16x32_bf16 v[232:235], a[200:203], a[128:131], v[232:235]
 ds_read_b128 a[128:131], v1 offset:2048
 v_mfma_f32_16x16x32_bf16 v[232:235], a[204:207], a[132:135], v[232:235]
 global_load_dwordx4 a[196:199], v0, s[70:71] offset:-3072 sc1
 ds_read_b128 a[132:135], v1 offset:3072
 v_mfma_f32_16x16x32_bf16 v[236:239], a[204:207], a[140:143], v[236:239]
 ds_read_b128 a[140:143], v1 offset:7168
 v_mfma_f32_16x16x32_bf16 v[236:239], a[200:203], a[136:139], v[236:239]
 global_load_dwordx4 a[192:195], v0, s[70:71] offset:-4096 sc1
 ds_read_b128 a[136:139], v1 offset:6144
 v_mfma_f32_16x16x32_bf16 v[240:243], a[200:203], a[144:147], v[240:243]
 ds_read_b128 a[144:147], v1 offset:10240
 v_mfma_f32_16x16x32_bf16 v[240:243], a[204:207], a[148:151], v[240:243]
 ds_read_b128 a[148:151], v1 offset:11264
 v_mfma_f32_16x16x32_bf16 v[244:247], a[204:207], a[156:159], v[244:247]
 ds_read_b128 a[156:159], v1 offset:15360
 v_mfma_f32_16x16x32_bf16 v[244:247], a[200:203], a[152:155], v[244:247]
 ds_read_b128 a[152:155], v1 offset:14336
 v_mfma_f32_16x16x32_bf16 v[248:251], a[200:203], a[160:163], v[248:251]
 ds_read_b128 a[160:163], v1 offset:18432
 v_mfma_f32_16x16x32_bf16 v[248:251], a[204:207], a[164:167], v[248:251]
 ds_read_b128 a[164:167], v1 offset:19456
 v_mfma_f32_16x16x32_bf16 v[252:255], a[204:207], a[172:175], v[252:255]
 ds_read_b128 a[172:175], v1 offset:23552
 v_mfma_f32_16x16x32_bf16 v[252:255], a[200:203], a[168:171], v[252:255]
 ds_read_b128 a[168:171], v1 offset:22528
 v_mfma_f32_16x16x32_bf16 a[248:251], a[200:203], a[176:179], a[248:251]
 ds_read_b128 a[176:179], v1 offset:26624
 v_mfma_f32_16x16x32_bf16 a[248:251], a[204:207], a[180:183], a[248:251]
 ds_read_b128 a[180:183], v1 offset:27648
 v_mfma_f32_16x16x32_bf16 a[252:255], a[204:207], a[188:191], a[252:255]
 global_load_dwordx4 a[204:207], v0, s[70:71] offset:-1024 sc1
 ds_read_b128 a[188:191], v1 offset:31744
 v_mfma_f32_16x16x32_bf16 a[252:255], a[200:203], a[184:187], a[252:255]
 global_load_dwordx4 a[200:203], v0, s[70:71] offset:-2048 sc1
 ds_read_b128 a[184:187], v1 offset:30720
 s_waitcnt vmcnt(10) lgkmcnt(8)
Lloop:
 v_mfma_f32_16x16x32_bf16 v[16:19], a[208:211], a[128:131], v[16:19]
 v_mfma_f32_16x16x32_bf16 v[16:19], a[212:215], a[132:135], v[16:19]
 v_mov_b32 v6, v3
 s_cmp_eq_u32 s25, 0
 s_cbranch_scc1 Lgat0
Lgatr0:
 s_add_u32 s29, s29, 0x2000000
 v_mfma_f32_16x16x32_bf16 v[20:23], a[212:215], a[140:143], v[20:23]
 v_mfma_f32_16x16x32_bf16 v[20:23], a[208:211], a[136:139], v[20:23]
 v_mfma_f32_16x16x32_bf16 v[24:27], a[208:211], a[144:147], v[24:27]
 s_add_u32 m0, s50, 0
 v_mfma_f32_16x16x32_bf16 v[24:27], a[212:215], a[148:151], v[24:27]
 v_mfma_f32_16x16x32_bf16 v[28:31], a[212:215], a[156:159], v[28:31]
 v_mfma_f32_16x16x32_bf16 v[28:31], a[208:211], a[152:155], v[28:31]
 s_waitcnt lgkmcnt(0)
 v_mfma_f32_16x16x32_bf16 v[32:35], a[208:211], a[160:163], v[32:35]
 v_mfma_f32_16x16x32_bf16 v[32:35], a[212:215], a[164:167], v[32:35]
 v_mfma_f32_16x16x32_bf16 v[36:39], a[212:215], a[172:175], v[36:39]
 v_mfma_f32_16x16x32_bf16 v[36:39], a[208:211], a[168:171], v[36:39]
 buffer_load_dwordx4 v6, s[8:11], s30 offen lds
 v_mfma_f32_16x16x32_bf16 v[40:43], a[208:211], a[176:179], v[40:43]
 v_mfma_f32_16x16x32_bf16 v[40:43], a[212:215], a[180:183], v[40:43]
 v_mfma_f32_16x16x32_bf16 v[44:47], a[212:215], a[188:191], v[44:47]
 s_add_u32 m0, m0, 1024
 v_mfma_f32_16x16x32_bf16 v[44:47], a[208:211], a[184:187], v[44:47]
 s_waitcnt vmcnt(9)
 v_mfma_f32_16x16x32_bf16 v[76:79], a[216:219], a[184:187], v[76:79]
 v_mfma_f32_16x16x32_bf16 v[76:79], a[220:223], a[188:191], v[76:79]
 global_load_dwordx4 a[212:215], v0, s[70:71] offset:1024 sc1
 s_add_u32 s30, s30, s20
 v_mfma_f32_16x16x32_bf16 v[72:75], a[220:223], a[180:183], v[72:75]
 v_mfma_f32_16x16x32_bf16 v[72:75], a[216:219], a[176:179], v[72:75]
 global_load_dwordx4 a[208:211], v0, s[70:71] offset:0 sc1
 v_mfma_f32_16x16x32_bf16 v[68:71], a[216:219], a[168:171], v[68:71]
 buffer_load_dwordx4 v6, s[8:11], s30 offen lds
 v_mfma_f32_16x16x32_bf16 v[68:71], a[220:223], a[172:175], v[68:71]
 v_mfma_f32_16x16x32_bf16 v[64:67], a[220:223], a[164:167], v[64:67]
 v_mfma_f32_16x16x32_bf16 v[64:67], a[216:219], a[160:163], v[64:67]
 v_mfma_f32_16x16x32_bf16 v[60:63], a[216:219], a[152:155], v[60:63]
 s_add_u32 m0, m0, 3072
 v_mfma_f32_16x16x32_bf16 v[60:63], a[220:223], a[156:159], v[60:63]
 v_mfma_f32_16x16x32_bf16 v[56:59], a[220:223], a[148:151], v[56:59]
 v_mfma_f32_16x16x32_bf16 v[56:59], a[216:219], a[144:147], v[56:59]
 s_add_u32 s30, s30, s21
 v_mfma_f32_16x16x32_bf16 v[52:55], a[216:219], a[136:139], v[52:55]
 v_mfma_f32_16x16x32_bf16 v[52:55], a[220:223], a[140:143], v[52:55]
 v_mfma_f32_16x16x32_bf16 v[48:51], a[220:223], a[132:135], v[48:51]
 v_mfma_f32_16x16x32_bf16 v[48:51], a[216:219], a[128:131], v[48:51]
 s_waitcnt vmcnt(10)
 v_mfma_f32_16x16x32_bf16 v[80:83], a[224:227], a[128:131], v[80:83]
 v_mfma_f32_16x16x32_bf16 v[80:83], a[228:231], a[132:135], v[80:83]
 global_load_dwordx4 a[220:223], v0, s[70:71] offset:3072 sc1
 v_mfma_f32_16x16x32_bf16 v[84:87], a[228:231], a[140:143], v[84:87]
 v_mfma_f32_16x16x32_bf16 v[84:87], a[224:227], a[136:139], v[84:87]
 global_load_dwordx4 a[216:219], v0, s[70:71] offset:2048 sc1
 v_mfma_f32_16x16x32_bf16 v[88:91], a[224:227], a[144:147], v[88:91]
 s_add_u32 s70, s70, 8192
 s_addc_u32 s71, s71, 0
 v_mfma_f32_16x16x32_bf16 v[88:91], a[228:231], a[148:151], v[88:91]
 v_mfma_f32_16x16x32_bf16 v[92:95], a[228:231], a[156:159], v[92:95]
 v_mfma_f32_16x16x32_bf16 v[92:95], a[224:227], a[152:155], v[92:95]
 v_mfma_f32_16x16x32_bf16 v[96:99], a[224:227], a[160:163], v[96:99]
 v_mfma_f32_16x16x32_bf16 v[96:99], a[228:231], a[164:167], v[96:99]
 v_mfma_f32_16x16x32_bf16 v[100:103], a[228:231], a[172:175], v[100:103]
 v_mfma_f32_16x16x32_bf16 v[100:103], a[224:227], a[168:171], v[100:103]
 v_mfma_f32_16x16x32_bf16 v[104:107], a[224:227], a[176:179], v[104:107]
 v_mfma_f32_16x16x32_bf16 v[104:107], a[228:231], a[180:183], v[104:107]
 v_mfma_f32_16x16x32_bf16 v[108:111], a[228:231], a[188:191], v[108:111]
 v_mfma_f32_16x16x32_bf16 v[108:111], a[224:227], a[184:187], v[108:111]
 s_waitcnt vmcnt(10)
 v_mfma_f32_16x16x32_bf16 a[244:247], a[232:235], a[184:187], a[244:247]
 v_mfma_f32_16x16x32_bf16 a[244:247], a[236:239], a[188:191], a[244:247]
 global_load_dwordx4 a[228:231], v0, s[70:71] offset:-3072 sc1
 v_mfma_f32_16x16x32_bf16 a[240:243], a[236:239], a[180:183], a[240:243]
 v_mfma_f32_16x16x32_bf16 a[240:243], a[232:235], a[176:179], a[240:243]
 global_load_dwordx4 a[224:227], v0, s[70:71] offset:-4096 sc1
 v_mfma_f32_16x16x32_bf16 v[132:135], a[232:235], a[168:171], v[132:135]
 v_mfma_f32_16x16x32_bf16 v[132:135], a[236:239], a[172:175], v[132:135]
 v_mfma_f32_16x16x32_bf16 v[128:131], a[236:239], a[164:167], v[128:131]
 v_mfma_f32_16x16x32_bf16 v[128:131], a[232:235], a[160:163], v[128:131]
 v_mfma_f32_16x16x32_bf16 v[124:127], a[232:235], a[152:155], v[124:127]
 v_mfma_f32_16x16x32_bf16 v[124:127], a[236:239], a[156:159], v[124:127]
 v_mfma_f32_16x16x32_bf16 v[120:123], a[236:239], a[148:151], v[120:123]
 v_mfma_f32_16x16x32_bf16 v[120:123], a[232:235], a[144:147], v[120:123]
 v_mfma_f32_16x16x32_bf16 v[116:119], a[232:235], a[136:139], v[116:119]
 v_mfma_f32_16x16x32_bf16 v[116:119], a[236:239], a[140:143], v[116:119]
 v_mfma_f32_16x16x32_bf16 v[112:115], a[236:239], a[132:135], v[112:115]
 buffer_load_dwordx4 v6, s[8:11], s30 offen lds
 v_mfma_f32_16x16x32_bf16 v[112:115], a[232:235], a[128:131], v[112:115]
 s_waitcnt vmcnt(11)
 v_mfma_f32_16x16x32_bf16 v[136:139], a[192:195], a[128:131], v[136:139]
 v_mfma_f32_16x16x32_bf16 v[136:139], a[196:199], a[132:135], v[136:139]
 global_load_dwordx4 a[236:239], v0, s[70:71] offset:-1024 sc1
 v_mfma_f32_16x16x32_bf16 v[140:143], a[196:199], a[140:143], v[140:143]
 s_add_u32 m0, m0, 1024
 v_mfma_f32_16x16x32_bf16 v[140:143], a[192:195], a[136:139], v[140:143]
 global_load_dwordx4 a[232:235], v0, s[70:71] offset:-2048 sc1
 v_mfma_f32_16x16x32_bf16 v[144:147], a[192:195], a[144:147], v[144:147]
 v_mfma_f32_16x16x32_bf16 v[144:147], a[196:199], a[148:151], v[144:147]
 s_add_u32 s30, s30, s20
 v_mfma_f32_16x16x32_bf16 v[148:151], a[196:199], a[156:159], v[148:151]
 v_mfma_f32_16x16x32_bf16 v[148:151], a[192:195], a[152:155], v[148:151]
 v_mfma_f32_16x16x32_bf16 v[152:155], a[192:195], a[160:163], v[152:155]
 buffer_load_dwordx4 v6, s[8:11], s30 offen lds
 v_mfma_f32_16x16x32_bf16 v[152:155], a[196:199], a[164:167], v[152:155]
 v_mfma_f32_16x16x32_bf16 v[156:159], a[196:199], a[172:175], v[156:159]
 v_mfma_f32_16x16x32_bf16 v[156:159], a[192:195], a[168:171], v[156:159]
 s_add_u32 m0, m0, 3072
 v_mfma_f32_16x16x32_bf16 v[160:163], a[192:195], a[176:179], v[160:163]
 v_mfma_f32_16x16x32_bf16 v[160:163], a[196:199], a[180:183], v[160:163]
 v_mfma_f32_16x16x32_bf16 v[164:167], a[196:199], a[188:191], v[164:167]
 s_add_u32 s30, s30, s21
 v_mfma_f32_16x16x32_bf16 v[164:167], a[192:195], a[184:187], v[164:167]
 s_waitcnt vmcnt(12)
 v_mfma_f32_16x16x32_bf16 v[196:199], a[200:203], a[184:187], v[196:199]
 v_mfma_f32_16x16x32_bf16 v[196:199], a[204:207], a[188:191], v[196:199]
 global_load_dwordx4 a[196:199], v0, s[70:71] offset:1024 sc1
 v_mfma_f32_16x16x32_bf16 v[192:195], a[204:207], a[180:183], v[192:195]
 s_add_u32 s31, s31, 1
 v_mov_b32 v7, s31
 buffer_store_dword v7, v1, s[60:63], 0 offen sc1
 v_mfma_f32_16x16x32_bf16 v[192:195], a[200:203], a[176:179], v[192:195]
 global_load_dwordx4 a[192:195], v0, s[70:71] offset:0 sc1
 v_mfma_f32_16x16x32_bf16 v[188:191], a[200:203], a[168:171], v[188:191]
 v_mfma_f32_16x16x32_bf16 v[188:191], a[204:207], a[172:175], v[188:191]
 v_mfma_f32_16x16x32_bf16 v[184:187], a[204:207], a[164:167], v[184:187]
 v_mfma_f32_16x16x32_bf16 v[184:187], a[200:203], a[160:163], v[184:187]
 v_mfma_f32_16x16x32_bf16 v[180:183], a[200:203], a[152:155], v[180:183]
 v_mfma_f32_16x16x32_bf16 v[180:183], a[204:207], a[156:159], v[180:183]
 v_mfma_f32_16x16x32_bf16 v[176:179], a[204:207], a[148:151], v[176:179]
 v_mfma_f32_16x16x32_bf16 v[176:179], a[200:203], a[144:147], v[176:179]
 v_mfma_f32_16x16x32_bf16 v[172:175], a[200:203], a[136:139], v[172:175]
 v_mfma_f32_16x16x32_bf16 v[172:175], a[204:207], a[140:143], v[172:175]
 v_mfma_f32_16x16x32_bf16 v[168:171], a[204:207], a[132:135], v[168:171]
 v_mfma_f32_16x16x32_bf16 v[168:171], a[200:203], a[128:131], v[168:171]
 s_waitcnt vmcnt(12)
 v_mfma_f32_16x16x32_bf16 v[200:203], a[208:211], a[128:131], v[200:203]
 v_mfma_f32_16x16x32_bf16 v[200:203], a[212:215], a[132:135], v[200:203]
 global_load_dwordx4 a[204:207], v0, s[70:71] offset:3072 sc1
 v_mfma_f32_16x16x32_bf16 v[204:207], a[212:215], a[140:143], v[204:207]
 v_mfma_f32_16x16x32_bf16 v[204:207], a[208:211], a[136:139], v[204:207]
 global_load_dwordx4 a[200:203], v0, s[70:71] offset:2048 sc1
 v_mfma_f32_16x16x32_bf16 v[208:211], a[208:211], a[144:147], v[208:211]
 s_add_u32 s70, s70, 8192
 s_addc_u32 s71, s71, 0
 v_mfma_f32_16x16x32_bf16 v[208:211], a[212:215], a[148:151], v[208:211]
 v_mfma_f32_16x16x32_bf16 v[212:215], a[212:215], a[156:159], v[212:215]
 v_mfma_f32_16x16x32_bf16 v[212:215], a[208:211], a[152:155], v[212:215]
 v_mfma_f32_16x16x32_bf16 v[216:219], a[208:211], a[160:163], v[216:219]
 v_mfma_f32_16x16x32_bf16 v[216:219], a[212:215], a[164:167], v[216:219]
 v_mfma_f32_16x16x32_bf16 v[220:223], a[212:215], a[172:175], v[220:223]
 v_mfma_f32_16x16x32_bf16 v[220:223], a[208:211], a[168:171], v[220:223]
 v_mfma_f32_16x16x32_bf16 v[224:227], a[208:211], a[176:179], v[224:227]
 v_mfma_f32_16x16x32_bf16 v[224:227], a[212:215], a[180:183], v[224:227]
 v_mfma_f32_16x16x32_bf16 v[228:231], a[212:215], a[188:191], v[228:231]
 v_mfma_f32_16x16x32_bf16 v[228:231], a[208:211], a[184:187], v[228:231]
 buffer_load_dwordx4 v6, s[8:11], s30 offen lds
 s_waitcnt vmcnt(12)
 v_mfma_f32_16x16x32_bf16 a[252:255], a[216:219], a[184:187], a[252:255]
 ds_read_b128 a[184:187], v1 offset:63488
 v_mfma_f32_16x16x32_bf16 a[252:255], a[220:223], a[188:191], a[252:255]
 global_load_dwordx4 a[212:215], v0, s[70:71] offset:-3072 sc1
 ds_read_b128 a[188:191], v1 offset:64512
 v_mfma_f32_16x16x32_bf16 a[248:251], a[220:223], a[180:183], a[248:251]
 ds_read_b128 a[180:183], v1 offset:60416
 v_mfma_f32_16x16x32_bf16 a[248:251], a[216:219], a[176:179], a[248:251]
 global_load_dwordx4 a[208:211], v0, s[70:71] offset:-4096 sc1
 ds_read_b128 a[176:179], v1 offset:59392
 v_mfma_f32_16x16x32_bf16 v[252:255], a[216:219], a[168:171], v[252:255]
 ds_read_b128 a[168:171], v1 offset:55296
 v_mfma_f32_16x16x32_bf16 v[252:255], a[220:223], a[172:175], v[252:255]
 ds_read_b128 a[172:175], v1 offset:56320
 s_add_u32 m0, m0, 1024
 v_mfma_f32_16x16x32_bf16 v[248:251], a[220:223], a[164:167], v[248:251]
 ds_read_b128 a[164:167], v1 offset:52224
 v_mfma_f32_16x16x32_bf16 v[248:251], a[216:219], a[160:163], v[248:251]
 ds_read_b128 a[160:163], v1 offset:51200
 v_mfma_f32_16x16x32_bf16 v[244:247], a[216:219], a[152:155], v[244:247]
 ds_read_b128 a[152:155], v1 offset:47104
 s_add_u32 s30, s30, s20
 v_mfma_f32_16x16x32_bf16 v[244:247], a[220:223], a[156:159], v[244:247]
 ds_read_b128 a[156:159], v1 offset:48128
 v_mfma_f32_16x16x32_bf16 v[240:243], a[220:223], a[148:151], v[240:243]
 ds_read_b128 a[148:151], v1 offset:44032
 v_mfma_f32_16x16x32_bf16 v[240:243], a[216:219], a[144:147], v[240:243]
 ds_read_b128 a[144:147], v1 offset:43008
 v_mfma_f32_16x16x32_bf16 v[236:239], a[216:219], a[136:139], v[236:239]
 ds_read_b128 a[136:139], v1 offset:38912
 v_mfma_f32_16x16x32_bf16 v[236:239], a[220:223], a[140:143], v[236:239]
 ds_read_b128 a[140:143], v1 offset:39936
 v_mfma_f32_16x16x32_bf16 v[232:235], a[220:223], a[132:135], v[232:235]
 ds_read_b128 a[132:135], v1 offset:35840
 v_mfma_f32_16x16x32_bf16 v[232:235], a[216:219], a[128:131], v[232:235]
 ds_read_b128 a[128:131], v1 offset:34816
 s_waitcnt vmcnt(12) lgkmcnt(8)
 v_mfma_f32_16x16x32_bf16 v[44:47], a[224:227], a[184:187], v[44:47]
 buffer_load_dwordx4 v6, s[8:11], s30 offen lds
 s_add_u32 m0, m0, 3072
 v_mfma_f32_16x16x32_bf16 v[44:47], a[228:231], a[188:191], v[44:47]
 global_load_dwordx4 a[220:223], v0, s[70:71] offset:-1024 sc1
 v_mfma_f32_16x16x32_bf16 v[40:43], a[228:231], a[180:183], v[40:43]
 s_add_u32 s30, s30, s21
 v_mfma_f32_16x16x32_bf16 v[40:43], a[224:227], a[176:179], v[40:43]
 global_load_dwordx4 a[216:219], v0, s[70:71] offset:-2048 sc1
 v_mfma_f32_16x16x32_bf16 v[36:39], a[224:227], a[168:171], v[36:39]
 v_mfma_f32_16x16x32_bf16 v[36:39], a[228:231], a[172:175], v[36:39]
 v_mfma_f32_16x16x32_bf16 v[32:35], a[228:231], a[164:167], v[32:35]
 v_mfma_f32_16x16x32_bf16 v[32:35], a[224:227], a[160:163], v[32:35]
 s_waitcnt lgkmcnt(0)
 v_mfma_f32_16x16x32_bf16 v[28:31], a[224:227], a[152:155], v[28:31]
 v_mfma_f32_16x16x32_bf16 v[28:31], a[228:231], a[156:159], v[28:31]
 v_mfma_f32_16x16x32_bf16 v[24:27], a[228:231], a[148:151], v[24:27]
 v_mfma_f32_16x16x32_bf16 v[24:27], a[224:227], a[144:147], v[24:27]
 v_mfma_f32_16x16x32_bf16 v[20:23], a[224:227], a[136:139], v[20:23]
 v_mfma_f32_16x16x32_bf16 v[20:23], a[228:231], a[140:143], v[20:23]
 v_mfma_f32_16x16x32_bf16 v[16:19], a[228:231], a[132:135], v[16:19]
 v_mfma_f32_16x16x32_bf16 v[16:19], a[224:227], a[128:131], v[16:19]
 s_waitcnt vmcnt(12)
 v_mfma_f32_16x16x32_bf16 v[48:51], a[232:235], a[128:131], v[48:51]
 v_mfma_f32_16x16x32_bf16 v[48:51], a[236:239], a[132:135], v[48:51]
 global_load_dwordx4 a[228:231], v0, s[70:71] offset:1024 sc1
 v_mfma_f32_16x16x32_bf16 v[52:55], a[236:239], a[140:143], v[52:55]
 v_mfma_f32_16x16x32_bf16 v[52:55], a[232:235], a[136:139], v[52:55]
 global_load_dwordx4 a[224:227], v0, s[70:71] offset:0 sc1
 v_mfma_f32_16x16x32_bf16 v[56:59], a[232:235], a[144:147], v[56:59]
 v_mfma_f32_16x16x32_bf16 v[56:59], a[236:239], a[148:151], v[56:59]
 v_mfma_f32_16x16x32_bf16 v[60:63], a[236:239], a[156:159], v[60:63]
 v_mfma_f32_16x16x32_bf16 v[60:63], a[232:235], a[152:155], v[60:63]
 v_mfma_f32_16x16x32_bf16 v[64:67], a[232:235], a[160:163], v[64:67]
 v_mfma_f32_16x16x32_bf16 v[64:67], a[236:239], a[164:167], v[64:67]
 v_mfma_f32_16x16x32_bf16 v[68:71], a[236:239], a[172:175], v[68:71]
 v_mfma_f32_16x16x32_bf16 v[68:71], a[232:235], a[168:171], v[68:71]
 v_mfma_f32_16x16x32_bf16 v[72:75], a[232:235], a[176:179], v[72:75]
 v_mfma_f32_16x16x32_bf16 v[72:75], a[236:239], a[180:183], v[72:75]
 v_mfma_f32_16x16x32_bf16 v[76:79], a[236:239], a[188:191], v[76:79]
 v_mfma_f32_16x16x32_bf16 v[76:79], a[232:235], a[184:187], v[76:79]
 s_waitcnt vmcnt(10)
 v_mfma_f32_16x16x32_bf16 v[108:111], a[192:195], a[184:187], v[108:111]
 v_mfma_f32_16x16x32_bf16 v[108:111], a[196:199], a[188:191], v[108:111]
 global_load_dwordx4 a[236:239], v0, s[70:71] offset:3072 sc1
 v_mfma_f32_16x16x32_bf16 v[104:107], a[196:199], a[180:183], v[104:107]
 v_mfma_f32_16x16x32_bf16 v[104:107], a[192:195], a[176:179], v[104:107]
 global_load_dwordx4 a[232:235], v0, s[70:71] offset:2048 sc1
 v_mfma_f32_16x16x32_bf16 v[100:103], a[192:195], a[168:171], v[100:103]
 s_add_u32 s70, s70, 8192
 s_addc_u32 s71, s71, 0
 v_mfma_f32_16x16x32_bf16 v[100:103], a[196:199], a[172:175], v[100:103]
 buffer_load_dwordx4 v6, s[8:11], s30 offen lds
 v_mfma_f32_16x16x32_bf16 v[96:99], a[196:199], a[164:167], v[96:99]
 v_mfma_f32_16x16x32_bf16 v[96:99], a[192:195], a[160:163], v[96:99]
 v_mfma_f32_16x16x32_bf16 v[92:95], a[192:195], a[152:155], v[92:95]
 v_mfma_f32_16x16x32_bf16 v[92:95], a[196:199], a[156:159], v[92:95]
 s_add_u32 m0, m0, 1024
 v_mfma_f32_16x16x32_bf16 v[88:91], a[196:199], a[148:151], v[88:91]
 v_mfma_f32_16x16x32_bf16 v[88:91], a[192:195], a[144:147], v[88:91]
 v_mfma_f32_16x16x32_bf16 v[84:87], a[192:195], a[136:139], v[84:87]
 s_add_u32 s30, s30, s20
 v_mfma_f32_16x16x32_bf16 v[84:87], a[196:199], a[140:143], v[84:87]
 v_mfma_f32_16x16x32_bf16 v[80:83], a[196:199], a[132:135], v[80:83]
 v_mfma_f32_16x16x32_bf16 v[80:83], a[192:195], a[128:131], v[80:83]
 buffer_load_dwordx4 v6, s[8:11], s30 offen lds
 s_waitcnt vmcnt(12)
 v_mfma_f32_16x16x32_bf16 v[112:115], a[200:203], a[128:131], v[112:115]
 v_mfma_f32_16x16x32_bf16 v[112:115], a[204:207], a[132:135], v[112:115]
 global_load_dwordx4 a[196:199], v0, s[70:71] offset:-3072 sc1
 v_mfma_f32_16x16x32_bf16 v[116:119], a[204:207], a[140:143], v[116:119]
 s_add_u32 m0, m0, 3072
 v_mfma_f32_16x16x32_bf16 v[116:119], a[200:203], a[136:139], v[116:119]
 global_load_dwordx4 a[192:195], v0, s[70:71] offset:-4096 sc1
 v_mfma_f32_16x16x32_bf16 v[120:123], a[200:203], a[144:147], v[120:123]
 v_mfma_f32_16x16x32_bf16 v[120:123], a[204:207], a[148:151], v[120:123]
 v_mfma_f32_16x16x32_bf16 v[124:127], a[204:207], a[156:159], v[124:127]
 s_add_u32 s30, s30, s21
 v_mfma_f32_16x16x32_bf16 v[124:127], a[200:203], a[152:155], v[124:127]
 v_mfma_f32_16x16x32_bf16 v[128:131], a[200:203], a[160:163], v[128:131]
 v_mfma_f32_16x16x32_bf16 v[128:131], a[204:207], a[164:167], v[128:131]
 v_mfma_f32_16x16x32_bf16 v[132:135], a[204:207], a[172:175], v[132:135]
 v_mfma_f32_16x16x32_bf16 v[132:135], a[200:203], a[168:171], v[132:135]
 v_mfma_f32_16x16x32_bf16 a[240:243], a[200:203], a[176:179], a[240:243]
 v_mfma_f32_16x16x32_bf16 a[240:243], a[204:207], a[180:183], a[240:243]
 v_mfma_f32_16x16x32_bf16 a[244:247], a[204:207], a[188:191], a[244:247]
 v_mfma_f32_16x16x32_bf16 a[244:247], a[200:203], a[184:187], a[244:247]
 s_waitcnt vmcnt(11)
 v_mfma_f32_16x16x32_bf16 v[164:167], a[208:211], a[184:187], v[164:167]
 v_mfma_f32_16x16x32_bf16 v[164:167], a[212:215], a[188:191], v[164:167]
 global_load_dwordx4 a[204:207], v0, s[70:71] offset:-1024 sc1
 v_mfma_f32_16x16x32_bf16 v[160:163], a[212:215], a[180:183], v[160:163]
 v_mfma_f32_16x16x32_bf16 v[160:163], a[208:211], a[176:179], v[160:163]
 global_load_dwordx4 a[200:203], v0, s[70:71] offset:-2048 sc1
 v_mfma_f32_16x16x32_bf16 v[156:159], a[208:211], a[168:171], v[156:159]
 v_mfma_f32_16x16x32_bf16 v[156:159], a[212:215], a[172:175], v[156:159]
 v_mfma_f32_16x16x32_bf16 v[152:155], a[212:215], a[164:167], v[152:155]
 v_mfma_f32_16x16x32_bf16 v[152:155], a[208:211], a[160:163], v[152:155]
 v_mfma_f32_16x16x32_bf16 v[148:151], a[208:211], a[152:155], v[148:151]
 v_mfma_f32_16x16x32_bf16 v[148:151], a[212:215], a[156:159], v[148:151]
 v_mfma_f32_16x16x32_bf16 v[144:147], a[212:215], a[148:151], v[144:147]
 v_mfma_f32_16x16x32_bf16 v[144:147], a[208:211], a[144:147], v[144:147]
 v_mfma_f32_16x16x32_bf16 v[140:143], a[208:211], a[136:139], v[140:143]
 v_mfma_f32_16x16x32_bf16 v[140:143], a[212:215], a[140:143], v[140:143]
 v_mfma_f32_16x16x32_bf16 v[136:139], a[212:215], a[132:135], v[136:139]
 v_mfma_f32_16x16x32_bf16 v[136:139], a[208:211], a[128:131], v[136:139]
 s_waitcnt vmcnt(10)
 v_mfma_f32_16x16x32_bf16 v[168:171], a[216:219], a[128:131], v[168:171]
 v_mfma_f32_16x16x32_bf16 v[168:171], a[220:223], a[132:135], v[168:171]
 global_load_dwordx4 a[212:215], v0, s[70:71] offset:1024 sc1
 v_mfma_f32_16x16x32_bf16 v[172:175], a[220:223], a[140:143], v[172:175]
 v_mfma_f32_16x16x32_bf16 v[172:175], a[216:219], a[136:139], v[172:175]
 global_load_dwordx4 a[208:211], v0, s[70:71] offset:0 sc1
 v_mfma_f32_16x16x32_bf16 v[176:179], a[216:219], a[144:147], v[176:179]
 v_mfma_f32_16x16x32_bf16 v[176:179], a[220:223], a[148:151], v[176:179]
 v_mfma_f32_16x16x32_bf16 v[180:183], a[220:223], a[156:159], v[180:183]
 v_mfma_f32_16x16x32_bf16 v[180:183], a[216:219], a[152:155], v[180:183]
 v_mfma_f32_16x16x32_bf16 v[184:187], a[216:219], a[160:163], v[184:187]
 v_mfma_f32_16x16x32_bf16 v[184:187], a[220:223], a[164:167], v[184:187]
 buffer_load_dwordx4 v6, s[8:11], s30 offen lds
 v_mfma_f32_16x16x32_bf16 v[188:191], a[220:223], a[172:175], v[188:191]
 v_mfma_f32_16x16x32_bf16 v[188:191], a[216:219], a[168:171], v[188:191]
 v_mfma_f32_16x16x32_bf16 v[192:195], a[216:219], a[176:179], v[192:195]
 s_add_u32 m0, m0, 1024
 v_mfma_f32_16x16x32_bf16 v[192:195], a[220:223], a[180:183], v[192:195]
 v_mfma_f32_16x16x32_bf16 v[196:199], a[220:223], a[188:191], v[196:199]
 v_mfma_f32_16x16x32_bf16 v[196:199], a[216:219], a[184:187], v[196:199]
 s_waitcnt vmcnt(11)
 v_mfma_f32_16x16x32_bf16 v[228:231], a[224:227], a[184:187], v[228:231]
 s_add_u32 s30, s30, s20
 v_mfma_f32_16x16x32_bf16 v[228:231], a[228:231], a[188:191], v[228:231]
 global_load_dwordx4 a[220:223], v0, s[70:71] offset:3072 sc1
 v_mfma_f32_16x16x32_bf16 v[224:227], a[228:231], a[180:183], v[224:227]
 buffer_load_dwordx4 v6, s[8:11], s30 offen lds
 v_mfma_f32_16x16x32_bf16 v[224:227], a[224:227], a[176:179], v[224:227]
 global_load_dwordx4 a[216:219], v0, s[70:71] offset:2048 sc1
 v_mfma_f32_16x16x32_bf16 v[220:223], a[224:227], a[168:171], v[220:223]
 s_add_u32 s70, s70, 8192
 s_addc_u32 s71, s71, 0
 v_mfma_f32_16x16x32_bf16 v[220:223], a[228:231], a[172:175], v[220:223]
 v_mfma_f32_16x16x32_bf16 v[216:219], a[228:231], a[164:167], v[216:219]
 s_add_u32 m0, m0, 3072
 v_mfma_f32_16x16x32_bf16 v[216:219], a[224:227], a[160:163], v[216:219]
 v_mfma_f32_16x16x32_bf16 v[212:215], a[224:227], a[152:155], v[212:215]
 v_mfma_f32_16x16x32_bf16 v[212:215], a[228:231], a[156:159], v[212:215]
 s_add_u32 s30, s30, s21
 v_mfma_f32_16x16x32_bf16 v[208:211], a[228:231], a[148:151], v[208:211]
 v_mfma_f32_16x16x32_bf16 v[208:211], a[224:227], a[144:147], v[208:211]
 v_mfma_f32_16x16x32_bf16 v[204:207], a[224:227], a[136:139], v[204:207]
 v_mfma_f32_16x16x32_bf16 v[204:207], a[228:231], a[140:143], v[204:207]
 v_mfma_f32_16x16x32_bf16 v[200:203], a[228:231], a[132:135], v[200:203]
 v_mfma_f32_16x16x32_bf16 v[200:203], a[224:227], a[128:131], v[200:203]
 s_waitcnt vmcnt(12)
 v_mfma_f32_16x16x32_bf16 v[232:235], a[232:235], a[128:131], v[232:235]
 ds_read_b128 a[128:131], v2 offset:2048
 v_mfma_f32_16x16x32_bf16 v[232:235], a[236:239], a[132:135], v[232:235]
 global_load_dwordx4 a[228:231], v0, s[70:71] offset:-3072 sc1
 ds_read_b128 a[132:135], v2 offset:3072
 v_mfma_f32_16x16x32_bf16 v[236:239], a[236:239], a[140:143], v[236:239]
 ds_read_b128 a[140:143], v2 offset:7168
 v_mfma_f32_16x16x32_bf16 v[236:239], a[232:235], a[136:139], v[236:239]
 global_load_dwordx4 a[224:227], v0, s[70:71] offset:-4096 sc1
 ds_read_b128 a[136:139], v2 offset:6144
 v_mfma_f32_16x16x32_bf16 v[240:243], a[232:235], a[144:147], v[240:243]
 ds_read_b128 a[144:147], v2 offset:10240
 v_mfma_f32_16x16x32_bf16 v[240:243], a[236:239], a[148:151], v[240:243]
 ds_read_b128 a[148:151], v2 offset:11264
 v_mfma_f32_16x16x32_bf16 v[244:247], a[236:239], a[156:159], v[244:247]
 ds_read_b128 a[156:159], v2 offset:15360
 v_mfma_f32_16x16x32_bf16 v[244:247], a[232:235], a[152:155], v[244:247]
 ds_read_b128 a[152:155], v2 offset:14336
 v_mfma_f32_16x16x32_bf16 v[248:251], a[232:235], a[160:163], v[248:251]
 ds_read_b128 a[160:163], v2 offset:18432
 v_mfma_f32_16x16x32_bf16 v[248:251], a[236:239], a[164:167], v[248:251]
 ds_read_b128 a[164:167], v2 offset:19456
 v_mfma_f32_16x16x32_bf16 v[252:255], a[236:239], a[172:175], v[252:255]
 ds_read_b128 a[172:175], v2 offset:23552
 v_mfma_f32_16x16x32_bf16 v[252:255], a[232:235], a[168:171], v[252:255]
 ds_read_b128 a[168:171], v2 offset:22528
 v_mfma_f32_16x16x32_bf16 a[248:251], a[232:235], a[176:179], a[248:251]
 ds_read_b128 a[176:179], v2 offset:26624
 v_mfma_f32_16x16x32_bf16 a[248:251], a[236:239], a[180:183], a[248:251]
 ds_read_b128 a[180:183], v2 offset:27648
 v_mfma_f32_16x16x32_bf16 a[252:255], a[236:239], a[188:191], a[252:255]
 ds_read_b128 a[188:191], v2 offset:31744
 v_mfma_f32_16x16x32_bf16 a[252:255], a[232:235], a[184:187], a[252:255]
 ds_read_b128 a[184:187], v2 offset:30720
 s_waitcnt vmcnt(10) lgkmcnt(8)
 v_mfma_f32_16x16x32_bf16 v[16:19], a[192:195], a[128:131], v[16:19]
 v_mfma_f32_16x16x32_bf16 v[16:19], a[196:199], a[132:135], v[16:19]
 global_load_dwordx4 a[236:239], v0, s[70:71] offset:-1024 sc1
 v_mfma_f32_16x16x32_bf16 v[20:23], a[196:199], a[140:143], v[20:23]
 v_mfma_f32_16x16x32_bf16 v[20:23], a[192:195], a[136:139], v[20:23]
 global_load_dwordx4 a[232:235], v0, s[70:71] offset:-2048 sc1
 v_mfma_f32_16x16x32_bf16 v[24:27], a[192:195], a[144:147], v[24:27]
 v_mfma_f32_16x16x32_bf16 v[24:27], a[196:199], a[148:151], v[24:27]
 v_mfma_f32_16x16x32_bf16 v[28:31], a[196:199], a[156:159], v[28:31]
 v_mfma_f32_16x16x32_bf16 v[28:31], a[192:195], a[152:155], v[28:31]
 s_waitcnt lgkmcnt(0)
 v_mfma_f32_16x16x32_bf16 v[32:35], a[192:195], a[160:163], v[32:35]
 v_mfma_f32_16x16x32_bf16 v[32:35], a[196:199], a[164:167], v[32:35]
 v_mfma_f32_16x16x32_bf16 v[36:39], a[196:199], a[172:175], v[36:39]
 v_mfma_f32_16x16x32_bf16 v[36:39], a[192:195], a[168:171], v[36:39]
 v_mfma_f32_16x16x32_bf16 v[40:43], a[192:195], a[176:179], v[40:43]
 v_mfma_f32_16x16x32_bf16 v[40:43], a[196:199], a[180:183], v[40:43]
 buffer_load_dwordx4 v6, s[8:11], s30 offen lds
 v_mfma_f32_16x16x32_bf16 v[44:47], a[196:199], a[188:191], v[44:47]
 v_mfma_f32_16x16x32_bf16 v[44:47], a[192:195], a[184:187], v[44:47]
 s_waitcnt vmcnt(11)
 v_mfma_f32_16x16x32_bf16 v[76:79], a[200:203], a[184:187], v[76:79]
 s_add_u32 m0, m0, 1024
 v_mfma_f32_16x16x32_bf16 v[76:79], a[204:207], a[188:191], v[76:79]
 global_load_dwordx4 a[196:199], v0, s[70:71] offset:1024 sc1
 v_mfma_f32_16x16x32_bf16 v[72:75], a[204:207], a[180:183], v[72:75]
 v_mfma_f32_16x16x32_bf16 v[72:75], a[200:203], a[176:179], v[72:75]
 global_load_dwordx4 a[192:195], v0, s[70:71] offset:0 sc1
 s_add_u32 s30, s30, s20
 v_mfma_f32_16x16x32_bf16 v[68:71], a[200:203], a[168:171], v[68:71]
 v_mfma_f32_16x16x32_bf16 v[68:71], a[204:207], a[172:175], v[68:71]
 v_mfma_f32_16x16x32_bf16 v[64:67], a[204:207], a[164:167], v[64:67]
 buffer_load_dwordx4 v6, s[8:11], s30 offen lds
 v_mfma_f32_16x16x32_bf16 v[64:67], a[200:203], a[160:163], v[64:67]
 v_mfma_f32_16x16x32_bf16 v[60:63], a[200:203], a[152:155], v[60:63]
 v_mfma_f32_16x16x32_bf16 v[60:63], a[204:207], a[156:159], v[60:63]
 v_mfma_f32_16x16x32_bf16 v[56:59], a[204:207], a[148:151], v[56:59]
 s_add_u32 m0, m0, 3072
 v_mfma_f32_16x16x32_bf16 v[56:59], a[200:203], a[144:147], v[56:59]
 v_mfma_f32_16x16x32_bf16 v[52:55], a[200:203], a[136:139], v[52:55]
 v_mfma_f32_16x16x32_bf16 v[52:55], a[204:207], a[140:143], v[52:55]
 s_add_u32 s30, s30, s21
 v_mfma_f32_16x16x32_bf16 v[48:51], a[204:207], a[132:135], v[48:51]
 v_mfma_f32_16x16x32_bf16 v[48:51], a[200:203], a[128:131], v[48:51]
 s_waitcnt vmcnt(12)
 v_mfma_f32_16x16x32_bf16 v[80:83], a[208:211], a[128:131], v[80:83]
 v_mfma_f32_16x16x32_bf16 v[80:83], a[212:215], a[132:135], v[80:83]
 global_load_dwordx4 a[204:207], v0, s[70:71] offset:3072 sc1
 v_mfma_f32_16x16x32_bf16 v[84:87], a[212:215], a[140:143], v[84:87]
 v_mfma_f32_16x16x32_bf16 v[84:87], a[208:211], a[136:139], v[84:87]
 global_load_dwordx4 a[200:203], v0, s[70:71] offset:2048 sc1
 v_mfma_f32_16x16x32_bf16 v[88:91], a[208:211], a[144:147], v[88:91]
 s_add_u32 s70, s70, 8192
 s_addc_u32 s71, s71, 0
 v_mfma_f32_16x16x32_bf16 v[88:91], a[212:215], a[148:151], v[88:91]
 v_mfma_f32_16x16x32_bf16 v[92:95], a[212:215], a[156:159], v[92:95]
 v_mfma_f32_16x16x32_bf16 v[92:95], a[208:211], a[152:155], v[92:95]
 v_mfma_f32_16x16x32_bf16 v[96:99], a[208:211], a[160:163], v[96:99]
 v_mfma_f32_16x16x32_bf16 v[96:99], a[212:215], a[164:167], v[96:99]
 v_mfma_f32_16x16x32_bf16 v[100:103], a[212:215], a[172:175], v[100:103]
 v_mfma_f32_16x16x32_bf16 v[100:103], a[208:211], a[168:171], v[100:103]
 v_mfma_f32_16x16x32_bf16 v[104:107], a[208:211], a[176:179], v[104:107]
 v_mfma_f32_16x16x32_bf16 v[104:107], a[212:215], a[180:183], v[104:107]
 v_mfma_f32_16x16x32_bf16 v[108:111], a[212:215], a[188:191], v[108:111]
 v_mfma_f32_16x16x32_bf16 v[108:111], a[208:211], a[184:187], v[108:111]
 s_waitcnt vmcnt(10)
 v_mfma_f32_16x16x32_bf16 a[244:247], a[216:219], a[184:187], a[244:247]
 v_mfma_f32_16x16x32_bf16 a[244:247], a[220:223], a[188:191], a[244:247]
 global_load_dwordx4 a[212:215], v0, s[70:71] offset:-3072 sc1
 v_mfma_f32_16x16x32_bf16 a[240:243], a[220:223], a[180:183], a[240:243]
 v_mfma_f32_16x16x32_bf16 a[240:243], a[216:219], a[176:179], a[240:243]
 global_load_dwordx4 a[208:211], v0, s[70:71] offset:-4096 sc1
 v_mfma_f32_16x16x32_bf16 v[132:135], a[216:219], a[168:171], v[132:135]
 v_mfma_f32_16x16x32_bf16 v[132:135], a[220:223], a[172:175], v[132:135]
 v_mfma_f32_16x16x32_bf16 v[128:131], a[220:223], a[164:167], v[128:131]
 v_mfma_f32_16x16x32_bf16 v[128:131], a[216:219], a[160:163], v[128:131]
 v_mfma_f32_16x16x32_bf16 v[124:127], a[216:219], a[152:155], v[124:127]
 v_mfma_f32_16x16x32_bf16 v[124:127], a[220:223], a[156:159], v[124:127]
 v_mfma_f32_16x16x32_bf16 v[120:123], a[220:223], a[148:151], v[120:123]
 v_mfma_f32_16x16x32_bf16 v[120:123], a[216:219], a[144:147], v[120:123]
 v_mfma_f32_16x16x32_bf16 v[116:119], a[216:219], a[136:139], v[116:119]
 v_mfma_f32_16x16x32_bf16 v[116:119], a[220:223], a[140:143], v[116:119]
 v_mfma_f32_16x16x32_bf16 v[112:115], a[220:223], a[132:135], v[112:115]
 v_mfma_f32_16x16x32_bf16 v[112:115], a[216:219], a[128:131], v[112:115]
 s_waitcnt vmcnt(10)
 v_mfma_f32_16x16x32_bf16 v[136:139], a[224:227], a[128:131], v[136:139]
 buffer_load_dwordx4 v6, s[8:11], s30 offen lds
 v_mfma_f32_16x16x32_bf16 v[136:139], a[228:231], a[132:135], v[136:139]
 global_load_dwordx4 a[220:223], v0, s[70:71] offset:-1024 sc1
 v_mfma_f32_16x16x32_bf16 v[140:143], a[228:231], a[140:143], v[140:143]
 v_mfma_f32_16x16x32_bf16 v[140:143], a[224:227], a[136:139], v[140:143]
 global_load_dwordx4 a[216:219], v0, s[70:71] offset:-2048 sc1
 s_add_u32 m0, m0, 1024
 v_mfma_f32_16x16x32_bf16 v[144:147], a[224:227], a[144:147], v[144:147]
 v_mfma_f32_16x16x32_bf16 v[144:147], a[228:231], a[148:151], v[144:147]
 v_mfma_f32_16x16x32_bf16 v[148:151], a[228:231], a[156:159], v[148:151]
 v_mfma_f32_16x16x32_bf16 v[148:151], a[224:227], a[152:155], v[148:151]
 s_add_u32 s30, s30, s20
 v_mfma_f32_16x16x32_bf16 v[152:155], a[224:227], a[160:163], v[152:155]
 v_mfma_f32_16x16x32_bf16 v[152:155], a[228:231], a[164:167], v[152:155]
 v_mfma_f32_16x16x32_bf16 v[156:159], a[228:231], a[172:175], v[156:159]
 buffer_load_dwordx4 v6, s[8:11], s30 offen lds
 v_mfma_f32_16x16x32_bf16 v[156:159], a[224:227], a[168:171], v[156:159]
 v_mfma_f32_16x16x32_bf16 v[160:163], a[224:227], a[176:179], v[160:163]
 v_mfma_f32_16x16x32_bf16 v[160:163], a[228:231], a[180:183], v[160:163]
 s_add_u32 m0, m0, 3072
 v_mfma_f32_16x16x32_bf16 v[164:167], a[228:231], a[188:191], v[164:167]
 v_mfma_f32_16x16x32_bf16 v[164:167], a[224:227], a[184:187], v[164:167]
 s_waitcnt vmcnt(12)
 v_mfma_f32_16x16x32_bf16 v[196:199], a[232:235], a[184:187], v[196:199]
 s_add_u32 s30, s30, s21
 v_mfma_f32_16x16x32_bf16 v[196:199], a[236:239], a[188:191], v[196:199]
 global_load_dwordx4 a[228:231], v0, s[70:71] offset:1024 sc1
 v_mfma_f32_16x16x32_bf16 v[192:195], a[236:239], a[180:183], v[192:195]
 v_mfma_f32_16x16x32_bf16 v[192:195], a[232:235], a[176:179], v[192:195]
 global_load_dwordx4 a[224:227], v0, s[70:71] offset:0 sc1
 v_mfma_f32_16x16x32_bf16 v[188:191], a[232:235], a[168:171], v[188:191]
 v_mfma_f32_16x16x32_bf16 v[188:191], a[236:239], a[172:175], v[188:191]
 v_mfma_f32_16x16x32_bf16 v[184:187], a[236:239], a[164:167], v[184:187]
 v_mfma_f32_16x16x32_bf16 v[184:187], a[232:235], a[160:163], v[184:187]
 v_mfma_f32_16x16x32_bf16 v[180:183], a[232:235], a[152:155], v[180:183]
 v_mfma_f32_16x16x32_bf16 v[180:183], a[236:239], a[156:159], v[180:183]
 v_mfma_f32_16x16x32_bf16 v[176:179], a[236:239], a[148:151], v[176:179]
 v_mfma_f32_16x16x32_bf16 v[176:179], a[232:235], a[144:147], v[176:179]
 v_mfma_f32_16x16x32_bf16 v[172:175], a[232:235], a[136:139], v[172:175]
 v_mfma_f32_16x16x32_bf16 v[172:175], a[236:239], a[140:143], v[172:175]
 v_mfma_f32_16x16x32_bf16 v[168:171], a[236:239], a[132:135], v[168:171]
 v_mfma_f32_16x16x32_bf16 v[168:171], a[232:235], a[128:131], v[168:171]
 s_waitcnt vmcnt(11)
 v_mfma_f32_16x16x32_bf16 v[200:203], a[192:195], a[128:131], v[200:203]
 v_mfma_f32_16x16x32_bf16 v[200:203], a[196:199], a[132:135], v[200:203]
 global_load_dwordx4 a[236:239], v0, s[70:71] offset:3072 sc1
 v_mfma_f32_16x16x32_bf16 v[204:207], a[196:199], a[140:143], v[204:207]
 v_mfma_f32_16x16x32_bf16 v[204:207], a[192:195], a[136:139], v[204:207]
 global_load_dwordx4 a[232:235], v0, s[70:71] offset:2048 sc1
 v_mfma_f32_16x16x32_bf16 v[208:211], a[192:195], a[144:147], v[208:211]
 s_add_u32 s70, s70, 8192
 s_addc_u32 s71, s71, 0
 v_mfma_f32_16x16x32_bf16 v[208:211], a[196:199], a[148:151], v[208:211]
 v_mfma_f32_16x16x32_bf16 v[212:215], a[196:199], a[156:159], v[212:215]
 v_mfma_f32_16x16x32_bf16 v[212:215], a[192:195], a[152:155], v[212:215]
 v_mfma_f32_16x16x32_bf16 v[216:219], a[192:195], a[160:163], v[216:219]
 v_mfma_f32_16x16x32_bf16 v[216:219], a[196:199], a[164:167], v[216:219]
 v_mfma_f32_16x16x32_bf16 v[220:223], a[196:199], a[172:175], v[220:223]
 v_mfma_f32_16x16x32_bf16 v[220:223], a[192:195], a[168:171], v[220:223]
 v_mfma_f32_16x16x32_bf16 v[224:227], a[192:195], a[176:179], v[224:227]
 v_mfma_f32_16x16x32_bf16 v[224:227], a[196:199], a[180:183], v[224:227]
 v_mfma_f32_16x16x32_bf16 v[228:231], a[196:199], a[188:191], v[228:231]
 v_mfma_f32_16x16x32_bf16 v[228:231], a[192:195], a[184:187], v[228:231]
 buffer_load_dwordx4 v6, s[8:11], s30 offen lds
 s_waitcnt vmcnt(11)
 v_mfma_f32_16x16x32_bf16 a[252:255], a[200:203], a[184:187], a[252:255]
 ds_read_b128 a[184:187], v2 offset:63488
 v_mfma_f32_16x16x32_bf16 a[252:255], a[204:207], a[188:191], a[252:255]
 global_load_dwordx4 a[196:199], v0, s[70:71] offset:-3072 sc1
 ds_read_b128 a[188:191], v2 offset:64512
 v_mfma_f32_16x16x32_bf16 a[248:251], a[204:207], a[180:183], a[248:251]
 ds_read_b128 a[180:183], v2 offset:60416
 v_mfma_f32_16x16x32_bf16 a[248:251], a[200:203], a[176:179], a[248:251]
 global_load_dwordx4 a[192:195], v0, s[70:71] offset:-4096 sc1
 ds_read_b128 a[176:179], v2 offset:59392
 v_mfma_f32_16x16x32_bf16 v[252:255], a[200:203], a[168:171], v[252:255]
 ds_read_b128 a[168:171], v2 offset:55296
 v_mfma_f32_16x16x32_bf16 v[252:255], a[204:207], a[172:175], v[252:255]
 ds_read_b128 a[172:175], v2 offset:56320
 v_mfma_f32_16x16x32_bf16 v[248:251], a[204:207], a[164:167], v[248:251]
 ds_read_b128 a[164:167], v2 offset:52224
 v_mfma_f32_16x16x32_bf16 v[248:251], a[200:203], a[160:163], v[248:251]
 ds_read_b128 a[160:163], v2 offset:51200
 s_add_u32 m0, m0, 1024
 v_mfma_f32_16x16x32_bf16 v[244:247], a[200:203], a[152:155], v[244:247]
 ds_read_b128 a[152:155], v2 offset:47104
 v_mfma_f32_16x16x32_bf16 v[244:247], a[204:207], a[156:159], v[244:247]
 ds_read_b128 a[156:159], v2 offset:48128
 v_mfma_f32_16x16x32_bf16 v[240:243], a[204:207], a[148:151], v[240:243]
 ds_read_b128 a[148:151], v2 offset:44032
 s_add_u32 s30, s30, s20
 v_mfma_f32_16x16x32_bf16 v[240:243], a[200:203], a[144:147], v[240:243]
 ds_read_b128 a[144:147], v2 offset:43008
 v_mfma_f32_16x16x32_bf16 v[236:239], a[200:203], a[136:139], v[236:239]
 ds_read_b128 a[136:139], v2 offset:38912
 v_mfma_f32_16x16x32_bf16 v[236:239], a[204:207], a[140:143], v[236:239]
 ds_read_b128 a[140:143], v2 offset:39936
 v_mfma_f32_16x16x32_bf16 v[232:235], a[204:207], a[132:135], v[232:235]
 ds_read_b128 a[132:135], v2 offset:35840
 v_mfma_f32_16x16x32_bf16 v[232:235], a[200:203], a[128:131], v[232:235]
 ds_read_b128 a[128:131], v2 offset:34816
 s_waitcnt vmcnt(11) lgkmcnt(8)
 v_mfma_f32_16x16x32_bf16 v[44:47], a[208:211], a[184:187], v[44:47]
 buffer_load_dwordx4 v6, s[8:11], s30 offen lds
 v_mfma_f32_16x16x32_bf16 v[44:47], a[212:215], a[188:191], v[44:47]
 global_load_dwordx4 a[204:207], v0, s[70:71] offset:-1024 sc1
 s_add_u32 m0, m0, 3072
 v_mfma_f32_16x16x32_bf16 v[40:43], a[212:215], a[180:183], v[40:43]
 buffer_load_dword v4, off, s[64:67], 0 sc1
 v_mfma_f32_16x16x32_bf16 v[40:43], a[208:211], a[176:179], v[40:43]
 global_load_dwordx4 a[200:203], v0, s[70:71] offset:-2048 sc1
 v_mfma_f32_16x16x32_bf16 v[36:39], a[208:211], a[168:171], v[36:39]
 s_add_u32 s30, s30, s22
 v_mfma_f32_16x16x32_bf16 v[36:39], a[212:215], a[172:175], v[36:39]
 v_mfma_f32_16x16x32_bf16 v[32:35], a[212:215], a[164:167], v[32:35]
 v_mfma_f32_16x16x32_bf16 v[32:35], a[208:211], a[160:163], v[32:35]
 s_waitcnt lgkmcnt(0)
 v_mfma_f32_16x16x32_bf16 v[28:31], a[208:211], a[152:155], v[28:31]
 v_mfma_f32_16x16x32_bf16 v[28:31], a[212:215], a[156:159], v[28:31]
 v_mfma_f32_16x16x32_bf16 v[24:27], a[212:215], a[148:151], v[24:27]
 v_mfma_f32_16x16x32_bf16 v[24:27], a[208:211], a[144:147], v[24:27]
 v_mfma_f32_16x16x32_bf16 v[20:23], a[208:211], a[136:139], v[20:23]
 v_mfma_f32_16x16x32_bf16 v[20:23], a[212:215], a[140:143], v[20:23]
 v_mfma_f32_16x16x32_bf16 v[16:19], a[212:215], a[132:135], v[16:19]
 v_mfma_f32_16x16x32_bf16 v[16:19], a[208:211], a[128:131], v[16:19]
 s_waitcnt vmcnt(12)
 v_mfma_f32_16x16x32_bf16 v[48:51], a[216:219], a[128:131], v[48:51]
 v_lshrrev_b32 v5, 6, v1
 v_mfma_f32_16x16x32_bf16 v[48:51], a[220:223], a[132:135], v[48:51]
 global_load_dwordx4 a[212:215], v0, s[70:71] offset:1024 sc1
 v_mfma_f32_16x16x32_bf16 v[52:55], a[220:223], a[140:143], v[52:55]
 v_and_b32 v6, 48, v1
 v_mfma_f32_16x16x32_bf16 v[52:55], a[216:219], a[136:139], v[52:55]
 global_load_dwordx4 a[208:211], v0, s[70:71] offset:0 sc1
 v_lshl_add_u32 v5, v5, 11, v6
 v_mfma_f32_16x16x32_bf16 v[56:59], a[216:219], a[144:147], v[56:59]
 v_mfma_f32_16x16x32_bf16 v[56:59], a[220:223], a[148:151], v[56:59]
 s_mov_b32 m0, s52
 v_mfma_f32_16x16x32_bf16 v[60:63], a[220:223], a[156:159], v[60:63]
 s_add_u32 s3, s48, 31744
 v_mfma_f32_16x16x32_bf16 v[60:63], a[216:219], a[152:155], v[60:63]
 v_mfma_f32_16x16x32_bf16 v[64:67], a[216:219], a[160:163], v[64:67]
 buffer_load_dwordx4 v5, s[40:43], s48 offen lds
 v_mfma_f32_16x16x32_bf16 v[64:67], a[220:223], a[164:167], v[64:67]
 buffer_load_dwordx4 v5, s[40:43], s3 offen offset:1024 lds
 v_mfma_f32_16x16x32_bf16 v[68:71], a[220:223], a[172:175], v[68:71]
 v_mfma_f32_16x16x32_bf16 v[68:71], a[216:219], a[168:171], v[68:71]
 s_add_u32 s48, s48, 2097152
 v_mfma_f32_16x16x32_bf16 v[72:75], a[216:219], a[176:179], v[72:75]
 v_mfma_f32_16x16x32_bf16 v[72:75], a[220:223], a[180:183], v[72:75]
 v_mfma_f32_16x16x32_bf16 v[76:79], a[220:223], a[188:191], v[76:79]
 v_mfma_f32_16x16x32_bf16 v[76:79], a[216:219], a[184:187], v[76:79]
 s_waitcnt vmcnt(13)
 v_mfma_f32_16x16x32_bf16 v[108:111], a[224:227], a[184:187], v[108:111]
 v_mfma_f32_16x16x32_bf16 v[108:111], a[228:231], a[188:191], v[108:111]
 global_load_dwordx4 a[220:223], v0, s[70:71] offset:3072 sc1
 v_mfma_f32_16x16x32_bf16 v[104:107], a[228:231], a[180:183], v[104:107]
 v_mfma_f32_16x16x32_bf16 v[104:107], a[224:227], a[176:179], v[104:107]
 global_load_dwordx4 a[216:219], v0, s[70:71] offset:2048 sc1
 v_mfma_f32_16x16x32_bf16 v[100:103], a[224:227], a[168:171], v[100:103]
 s_add_u32 s70, s70, 8192
 s_addc_u32 s71, s71, 0
 v_mfma_f32_16x16x32_bf16 v[100:103], a[228:231], a[172:175], v[100:103]
 v_mfma_f32_16x16x32_bf16 v[96:99], a[228:231], a[164:167], v[96:99]
 v_mfma_f32_16x16x32_bf16 v[96:99], a[224:227], a[160:163], v[96:99]
 v_mfma_f32_16x16x32_bf16 v[92:95], a[224:227], a[152:155], v[92:95]
 v_mfma_f32_16x16x32_bf16 v[92:95], a[228:231], a[156:159], v[92:95]
 v_mfma_f32_16x16x32_bf16 v[88:91], a[228:231], a[148:151], v[88:91]
 v_mfma_f32_16x16x32_bf16 v[88:91], a[224:227], a[144:147], v[88:91]
 v_mfma_f32_16x16x32_bf16 v[84:87], a[224:227], a[136:139], v[84:87]
 v_mfma_f32_16x16x32_bf16 v[84:87], a[228:231], a[140:143], v[84:87]
 v_mfma_f32_16x16x32_bf16 v[80:83], a[228:231], a[132:135], v[80:83]
 v_mfma_f32_16x16x32_bf16 v[80:83], a[224:227], a[128:131], v[80:83]
 s_waitcnt vmcnt(13)
 v_mfma_f32_16x16x32_bf16 v[112:115], a[232:235], a[128:131], v[112:115]
 v_mfma_f32_16x16x32_bf16 v[112:115], a[236:239], a[132:135], v[112:115]
 global_load_dwordx4 a[228:231], v0, s[70:71] offset:-3072 sc1
 v_mfma_f32_16x16x32_bf16 v[116:119], a[236:239], a[140:143], v[116:119]
 v_mfma_f32_16x16x32_bf16 v[116:119], a[232:235], a[136:139], v[116:119]
 global_load_dwordx4 a[224:227], v0, s[70:71] offset:-4096 sc1
 v_mfma_f32_16x16x32_bf16 v[120:123], a[232:235], a[144:147], v[120:123]
 v_mfma_f32_16x16x32_bf16 v[120:123], a[236:239], a[148:151], v[120:123]
 v_mfma_f32_16x16x32_bf16 v[124:127], a[236:239], a[156:159], v[124:127]
 v_mfma_f32_16x16x32_bf16 v[124:127], a[232:235], a[152:155], v[124:127]
 v_mfma_f32_16x16x32_bf16 v[128:131], a[232:235], a[160:163], v[128:131]
 v_mfma_f32_16x16x32_bf16 v[128:131], a[236:239], a[164:167], v[128:131]
 v_mfma_f32_16x16x32_bf16 v[132:135], a[236:239], a[172:175], v[132:135]
 v_mfma_f32_16x16x32_bf16 v[132:135], a[232:235], a[168:171], v[132:135]
 v_mfma_f32_16x16x32_bf16 a[240:243], a[232:235], a[176:179], a[240:243]
 v_mfma_f32_16x16x32_bf16 a[240:243], a[236:239], a[180:183], a[240:243]
 v_mfma_f32_16x16x32_bf16 a[244:247], a[236:239], a[188:191], a[244:247]
 v_mfma_f32_16x16x32_bf16 a[244:247], a[232:235], a[184:187], a[244:247]
 s_waitcnt vmcnt(12)
 v_mfma_f32_16x16x32_bf16 v[164:167], a[192:195], a[184:187], v[164:167]
 v_mfma_f32_16x16x32_bf16 v[164:167], a[196:199], a[188:191], v[164:167]
 global_load_dwordx4 a[236:239], v0, s[70:71] offset:-1024 sc1
 v_mfma_f32_16x16x32_bf16 v[160:163], a[196:199], a[180:183], v[160:163]
 v_mfma_f32_16x16x32_bf16 v[160:163], a[192:195], a[176:179], v[160:163]
 global_load_dwordx4 a[232:235], v0, s[70:71] offset:-2048 sc1
 v_mfma_f32_16x16x32_bf16 v[156:159], a[192:195], a[168:171], v[156:159]
 v_mfma_f32_16x16x32_bf16 v[156:159], a[196:199], a[172:175], v[156:159]
 v_mfma_f32_16x16x32_bf16 v[152:155], a[196:199], a[164:167], v[152:155]
 v_mfma_f32_16x16x32_bf16 v[152:155], a[192:195], a[160:163], v[152:155]
 v_mfma_f32_16x16x32_bf16 v[148:151], a[192:195], a[152:155], v[148:151]
 v_mfma_f32_16x16x32_bf16 v[148:151], a[196:199], a[156:159], v[148:151]
 v_mfma_f32_16x16x32_bf16 v[144:147], a[196:199], a[148:151], v[144:147]
 v_mfma_f32_16x16x32_bf16 v[144:147], a[192:195], a[144:147], v[144:147]
 v_mfma_f32_16x16x32_bf16 v[140:143], a[192:195], a[136:139], v[140:143]
 v_mfma_f32_16x16x32_bf16 v[140:143], a[196:199], a[140:143], v[140:143]
 v_mfma_f32_16x16x32_bf16 v[136:139], a[196:199], a[132:135], v[136:139]
 v_mfma_f32_16x16x32_bf16 v[136:139], a[192:195], a[128:131], v[136:139]
 s_waitcnt vmcnt(10)
 v_mfma_f32_16x16x32_bf16 v[168:171], a[200:203], a[128:131], v[168:171]
 v_mfma_f32_16x16x32_bf16 v[168:171], a[204:207], a[132:135], v[168:171]
 global_load_dwordx4 a[196:199], v0, s[70:71] offset:1024 sc1
 v_mfma_f32_16x16x32_bf16 v[172:175], a[204:207], a[140:143], v[172:175]
 v_mfma_f32_16x16x32_bf16 v[172:175], a[200:203], a[136:139], v[172:175]
 global_load_dwordx4 a[192:195], v0, s[70:71] offset:0 sc1
 v_mfma_f32_16x16x32_bf16 v[176:179], a[200:203], a[144:147], v[176:179]
 v_mfma_f32_16x16x32_bf16 v[176:179], a[204:207], a[148:151], v[176:179]
 v_mfma_f32_16x16x32_bf16 v[180:183], a[204:207], a[156:159], v[180:183]
 v_mfma_f32_16x16x32_bf16 v[180:183], a[200:203], a[152:155], v[180:183]
 v_mfma_f32_16x16x32_bf16 v[184:187], a[200:203], a[160:163], v[184:187]
 v_mfma_f32_16x16x32_bf16 v[184:187], a[204:207], a[164:167], v[184:187]
 v_mfma_f32_16x16x32_bf16 v[188:191], a[204:207], a[172:175], v[188:191]
 v_mfma_f32_16x16x32_bf16 v[188:191], a[200:203], a[168:171], v[188:191]
 v_mfma_f32_16x16x32_bf16 v[192:195], a[200:203], a[176:179], v[192:195]
 v_mfma_f32_16x16x32_bf16 v[192:195], a[204:207], a[180:183], v[192:195]
 v_mfma_f32_16x16x32_bf16 v[196:199], a[204:207], a[188:191], v[196:199]
 v_mfma_f32_16x16x32_bf16 v[196:199], a[200:203], a[184:187], v[196:199]
 s_waitcnt vmcnt(10)
 v_mfma_f32_16x16x32_bf16 v[228:231], a[208:211], a[184:187], v[228:231]
 v_mfma_f32_16x16x32_bf16 v[228:231], a[212:215], a[188:191], v[228:231]
 global_load_dwordx4 a[204:207], v0, s[70:71] offset:3072 sc1
 v_mfma_f32_16x16x32_bf16 v[224:227], a[212:215], a[180:183], v[224:227]
 v_mfma_f32_16x16x32_bf16 v[224:227], a[208:211], a[176:179], v[224:227]
 global_load_dwordx4 a[200:203], v0, s[70:71] offset:2048 sc1
 v_mfma_f32_16x16x32_bf16 v[220:223], a[208:211], a[168:171], v[220:223]
 s_add_u32 s70, s70, 8192
 s_addc_u32 s71, s71, 0
 v_mfma_f32_16x16x32_bf16 v[220:223], a[212:215], a[172:175], v[220:223]
 v_mfma_f32_16x16x32_bf16 v[216:219], a[212:215], a[164:167], v[216:219]
 v_mfma_f32_16x16x32_bf16 v[216:219], a[208:211], a[160:163], v[216:219]
 v_mfma_f32_16x16x32_bf16 v[212:215], a[208:211], a[152:155], v[212:215]
 v_mfma_f32_16x16x32_bf16 v[212:215], a[212:215], a[156:159], v[212:215]
 v_mfma_f32_16x16x32_bf16 v[208:211], a[212:215], a[148:151], v[208:211]
 v_cmp_gt_i32 vcc, s55, v4
 s_and_b64 vcc, exec, vcc
 s_cbranch_vccnz Lspin_pb
Lok_pb:
 s_add_u32 s55, s55, 1
 s_waitcnt lgkmcnt(0)
 s_barrier
 v_mfma_f32_16x16x32_bf16 v[208:211], a[208:211], a[144:147], v[208:211]
 s_cmp_eq_u32 s25, 0
 s_cbranch_scc1 Lxrg
Lxrgr:
 v_mfma_f32_16x16x32_bf16 v[204:207], a[208:211], a[136:139], v[204:207]
 v_mfma_f32_16x16x32_bf16 v[204:207], a[212:215], a[140:143], v[204:207]
 v_mfma_f32_16x16x32_bf16 v[200:203], a[212:215], a[132:135], v[200:203]
 v_mfma_f32_16x16x32_bf16 v[200:203], a[208:211], a[128:131], v[200:203]
 s_waitcnt vmcnt(8)
 v_mfma_f32_16x16x32_bf16 v[232:235], a[216:219], a[128:131], v[232:235]
 ds_read_b128 a[128:131], v1
 v_mfma_f32_16x16x32_bf16 v[232:235], a[220:223], a[132:135], v[232:235]
 global_load_dwordx4 a[212:215], v0, s[70:71] offset:-3072 sc1
 ds_read_b128 a[132:135], v1 offset:1024
 v_mfma_f32_16x16x32_bf16 v[236:239], a[220:223], a[140:143], v[236:239]
 ds_read_b128 a[140:143], v1 offset:5120
 v_mfma_f32_16x16x32_bf16 v[236:239], a[216:219], a[136:139], v[236:239]
 global_load_dwordx4 a[208:211], v0, s[70:71] offset:-4096 sc1
 ds_read_b128 a[136:139], v1 offset:4096
 v_mfma_f32_16x16x32_bf16 v[240:243], a[216:219], a[144:147], v[240:243]
 ds_read_b128 a[144:147], v1 offset:8192
 v_mfma_f32_16x16x32_bf16 v[240:243], a[220:223], a[148:151], v[240:243]
 ds_read_b128 a[148:151], v1 offset:9216
 v_mfma_f32_16x16x32_bf16 v[244:247], a[220:223], a[156:159], v[244:247]
 ds_read_b128 a[156:159], v1 offset:13312
 v_mfma_f32_16x16x32_bf16 v[244:247], a[216:219], a[152:155], v[244:247]
 ds_read_b128 a[152:155], v1 offset:12288
 v_mfma_f32_16x16x32_bf16 v[248:251], a[216:219], a[160:163], v[248:251]
 ds_read_b128 a[160:163], v1 offset:16384
 v_mfma_f32_16x16x32_bf16 v[248:251], a[220:223], a[164:167], v[248:251]
 ds_read_b128 a[164:167], v1 offset:17408
 v_mfma_f32_16x16x32_bf16 v[252:255], a[220:223], a[172:175], v[252:255]
 ds_read_b128 a[172:175], v1 offset:21504
 v_mfma_f32_16x16x32_bf16 v[252:255], a[216:219], a[168:171], v[252:255]
 ds_read_b128 a[168:171], v1 offset:20480
 v_mfma_f32_16x16x32_bf16 a[248:251], a[216:219], a[176:179], a[248:251]
 ds_read_b128 a[176:179], v1 offset:24576
 v_mfma_f32_16x16x32_bf16 a[248:251], a[220:223], a[180:183], a[248:251]
 ds_read_b128 a[180:183], v1 offset:25600
 v_mfma_f32_16x16x32_bf16 a[252:255], a[220:223], a[188:191], a[252:255]
 global_load_dwordx4 a[220:223], v0, s[70:71] offset:-1024 sc1
 ds_read_b128 a[188:191], v1 offset:29696
 v_mfma_f32_16x16x32_bf16 a[252:255], a[216:219], a[184:187], a[252:255]
 global_load_dwordx4 a[216:219], v0, s[70:71] offset:-2048 sc1
 ds_read_b128 a[184:187], v1 offset:28672
 s_waitcnt vmcnt(10) lgkmcnt(8)
 v_mfma_f32_16x16x32_bf16 v[16:19], a[224:227], a[128:131], v[16:19]
 v_mfma_f32_16x16x32_bf16 v[16:19], a[228:231], a[132:135], v[16:19]
 v_mov_b32 v6, v3
 s_cmp_eq_u32 s25, 0
 s_cbranch_scc1 Lgat1
Lgatr1:
 v_mfma_f32_16x16x32_bf16 v[20:23], a[228:231], a[140:143], v[20:23]
 v_mfma_f32_16x16x32_bf16 v[20:23], a[224:227], a[136:139], v[20:23]
 v_mfma_f32_16x16x32_bf16 v[24:27], a[224:227], a[144:147], v[24:27]
 v_mfma_f32_16x16x32_bf16 v[24:27], a[228:231], a[148:151], v[24:27]
 s_add_u32 m0, s50, 2048
 v_mfma_f32_16x16x32_bf16 v[28:31], a[228:231], a[156:159], v[28:31]
 v_mfma_f32_16x16x32_bf16 v[28:31], a[224:227], a[152:155], v[28:31]
 s_waitcnt lgkmcnt(0)
 v_mfma_f32_16x16x32_bf16 v[32:35], a[224:227], a[160:163], v[32:35]
 v_mfma_f32_16x16x32_bf16 v[32:35], a[228:231], a[164:167], v[32:35]
 v_mfma_f32_16x16x32_bf16 v[36:39], a[228:231], a[172:175], v[36:39]
 v_mfma_f32_16x16x32_bf16 v[36:39], a[224:227], a[168:171], v[36:39]
 v_mfma_f32_16x16x32_bf16 v[40:43], a[224:227], a[176:179], v[40:43]
 buffer_load_dwordx4 v6, s[8:11], s30 offen lds
 v_mfma_f32_16x16x32_bf16 v[40:43], a[228:231], a[180:183], v[40:43]
 v_mfma_f32_16x16x32_bf16 v[44:47], a[228:231], a[188:191], v[44:47]
 v_mfma_f32_16x16x32_bf16 v[44:47], a[224:227], a[184:187], v[44:47]
 s_waitcnt vmcnt(9)
 v_mfma_f32_16x16x32_bf16 v[76:79], a[232:235], a[184:187], v[76:79]
 s_add_u32 m0, m0, 1024
 v_mfma_f32_16x16x32_bf16 v[76:79], a[236:239], a[188:191], v[76:79]
 global_load_dwordx4 a[228:231], v0, s[70:71] offset:1024 sc1
 v_mfma_f32_16x16x32_bf16 v[72:75], a[236:239], a[180:183], v[72:75]
 v_mfma_f32_16x16x32_bf16 v[72:75], a[232:235], a[176:179], v[72:75]
 global_load_dwordx4 a[224:227], v0, s[70:71] offset:0 sc1
 s_add_u32 s30, s30, s20
 v_mfma_f32_16x16x32_bf16 v[68:71], a[232:235], a[168:171], v[68:71]
 v_mfma_f32_16x16x32_bf16 v[68:71], a[236:239], a[172:175], v[68:71]
 v_mfma_f32_16x16x32_bf16 v[64:67], a[236:239], a[164:167], v[64:67]
 v_mfma_f32_16x16x32_bf16 v[64:67], a[232:235], a[160:163], v[64:67]
 buffer_load_dwordx4 v6, s[8:11], s30 offen lds
 v_mfma_f32_16x16x32_bf16 v[60:63], a[232:235], a[152:155], v[60:63]
 v_mfma_f32_16x16x32_bf16 v[60:63], a[236:239], a[156:159], v[60:63]
 v_mfma_f32_16x16x32_bf16 v[56:59], a[236:239], a[148:151], v[56:59]
 v_mfma_f32_16x16x32_bf16 v[56:59], a[232:235], a[144:147], v[56:59]
 s_add_u32 m0, m0, 3072
 v_mfma_f32_16x16x32_bf16 v[52:55], a[232:235], a[136:139], v[52:55]
 v_mfma_f32_16x16x32_bf16 v[52:55], a[236:239], a[140:143], v[52:55]
 v_mfma_f32_16x16x32_bf16 v[48:51], a[236:239], a[132:135], v[48:51]
 s_add_u32 s30, s30, s21
 v_mfma_f32_16x16x32_bf16 v[48:51], a[232:235], a[128:131], v[48:51]
 s_waitcnt vmcnt(10)
 v_mfma_f32_16x16x32_bf16 v[80:83], a[192:195], a[128:131], v[80:83]
 v_mfma_f32_16x16x32_bf16 v[80:83], a[196:199], a[132:135], v[80:83]
 global_load_dwordx4 a[236:239], v0, s[70:71] offset:3072 sc1
 v_mfma_f32_16x16x32_bf16 v[84:87], a[196:199], a[140:143], v[84:87]
 v_mfma_f32_16x16x32_bf16 v[84:87], a[192:195], a[136:139], v[84:87]
 global_load_dwordx4 a[232:235], v0, s[70:71] offset:2048 sc1
 v_mfma_f32_16x16x32_bf16 v[88:91], a[192:195], a[144:147], v[88:91]
 s_add_u32 s70, s70, 8192
 s_addc_u32 s71, s71, 0
 v_mfma_f32_16x16x32_bf16 v[88:91], a[196:199], a[148:151], v[88:91]
 v_mfma_f32_16x16x32_bf16 v[92:95], a[196:199], a[156:159], v[92:95]
 v_mfma_f32_16x16x32_bf16 v[92:95], a[192:195], a[152:155], v[92:95]
 v_mfma_f32_16x16x32_bf16 v[96:99], a[192:195], a[160:163], v[96:99]
 v_mfma_f32_16x16x32_bf16 v[96:99], a[196:199], a[164:167], v[96:99]
 v_mfma_f32_16x16x32_bf16 v[100:103], a[196:199], a[172:175], v[100:103]
 v_mfma_f32_16x16x32_bf16 v[100:103], a[192:195], a[168:171], v[100:103]
 v_mfma_f32_16x16x32_bf16 v[104:107], a[192:195], a[176:179], v[104:107]
 v_mfma_f32_16x16x32_bf16 v[104:107], a[196:199], a[180:183], v[104:107]
 v_mfma_f32_16x16x32_bf16 v[108:111], a[196:199], a[188:191], v[108:111]
 v_mfma_f32_16x16x32_bf16 v[108:111], a[192:195], a[184:187], v[108:111]
 s_waitcnt vmcnt(10)
 v_mfma_f32_16x16x32_bf16 a[244:247], a[200:203], a[184:187], a[244:247]
 v_mfma_f32_16x16x32_bf16 a[244:247], a[204:207], a[188:191], a[244:247]
 global_load_dwordx4 a[196:199], v0, s[70:71] offset:-3072 sc1
 v_mfma_f32_16x16x32_bf16 a[240:243], a[204:207], a[180:183], a[240:243]
 v_mfma_f32_16x16x32_bf16 a[240:243], a[200:203], a[176:179], a[240:243]
 global_load_dwordx4 a[192:195], v0, s[70:71] offset:-4096 sc1
 v_mfma_f32_16x16x32_bf16 v[132:135], a[200:203], a[168:171], v[132:135]
 v_mfma_f32_16x16x32_bf16 v[132:135], a[204:207], a[172:175], v[132:135]
 v_mfma_f32_16x16x32_bf16 v[128:131], a[204:207], a[164:167], v[128:131]
 v_mfma_f32_16x16x32_bf16 v[128:131], a[200:203], a[160:163], v[128:131]
 v_mfma_f32_16x16x32_bf16 v[124:127], a[200:203], a[152:155], v[124:127]
 v_mfma_f32_16x16x32_bf16 v[124:127], a[204:207], a[156:159], v[124:127]
 v_mfma_f32_16x16x32_bf16 v[120:123], a[204:207], a[148:151], v[120:123]
 v_mfma_f32_16x16x32_bf16 v[120:123], a[200:203], a[144:147], v[120:123]
 v_mfma_f32_16x16x32_bf16 v[116:119], a[200:203], a[136:139], v[116:119]
 v_mfma_f32_16x16x32_bf16 v[116:119], a[204:207], a[140:143], v[116:119]
 v_mfma_f32_16x16x32_bf16 v[112:115], a[204:207], a[132:135], v[112:115]
 v_mfma_f32_16x16x32_bf16 v[112:115], a[200:203], a[128:131], v[112:115]
 s_waitcnt vmcnt(10)
 v_mfma_f32_16x16x32_bf16 v[136:139], a[208:211], a[128:131], v[136:139]
 v_mfma_f32_16x16x32_bf16 v[136:139], a[212:215], a[132:135], v[136:139]
 global_load_dwordx4 a[204:207], v0, s[70:71] offset:-1024 sc1
 v_mfma_f32_16x16x32_bf16 v[140:143], a[212:215], a[140:143], v[140:143]
 v_mfma_f32_16x16x32_bf16 v[140:143], a[208:211], a[136:139], v[140:143]
 global_load_dwordx4 a[200:203], v0, s[70:71] offset:-2048 sc1
 v_mfma_f32_16x16x32_bf16 v[144:147], a[208:211], a[144:147], v[144:147]
 v_mfma_f32_16x16x32_bf16 v[144:147], a[212:215], a[148:151], v[144:147]
 v_mfma_f32_16x16x32_bf16 v[148:151], a[212:215], a[156:159], v[148:151]
 buffer_load_dwordx4 v6, s[8:11], s30 offen lds
 v_mfma_f32_16x16x32_bf16 v[148:151], a[208:211], a[152:155], v[148:151]
 v_mfma_f32_16x16x32_bf16 v[152:155], a[208:211], a[160:163], v[152:155]
 v_mfma_f32_16x16x32_bf16 v[152:155], a[212:215], a[164:167], v[152:155]
 v_mfma_f32_16x16x32_bf16 v[156:159], a[212:215], a[172:175], v[156:159]
 s_add_u32 m0, m0, 1024
 v_mfma_f32_16x16x32_bf16 v[156:159], a[208:211], a[168:171], v[156:159]
 v_mfma_f32_16x16x32_bf16 v[160:163], a[208:211], a[176:179], v[160:163]
 v_mfma_f32_16x16x32_bf16 v[160:163], a[212:215], a[180:183], v[160:163]
 v_mfma_f32_16x16x32_bf16 v[164:167], a[212:215], a[188:191], v[164:167]
 s_add_u32 s30, s30, s20
 v_mfma_f32_16x16x32_bf16 v[164:167], a[208:211], a[184:187], v[164:167]
 s_waitcnt vmcnt(11)
 v_mfma_f32_16x16x32_bf16 v[196:199], a[216:219], a[184:187], v[196:199]
 v_mfma_f32_16x16x32_bf16 v[196:199], a[220:223], a[188:191], v[196:199]
 global_load_dwordx4 a[212:215], v0, s[70:71] offset:1024 sc1
 v_mfma_f32_16x16x32_bf16 v[192:195], a[220:223], a[180:183], v[192:195]
 buffer_load_dwordx4 v6, s[8:11], s30 offen lds
 v_mfma_f32_16x16x32_bf16 v[192:195], a[216:219], a[176:179], v[192:195]
 global_load_dwordx4 a[208:211], v0, s[70:71] offset:0 sc1
 v_mfma_f32_16x16x32_bf16 v[188:191], a[216:219], a[168:171], v[188:191]
 v_mfma_f32_16x16x32_bf16 v[188:191], a[220:223], a[172:175], v[188:191]
 s_add_u32 m0, m0, 3072
 v_mfma_f32_16x16x32_bf16 v[184:187], a[220:223], a[164:167], v[184:187]
 v_mfma_f32_16x16x32_bf16 v[184:187], a[216:219], a[160:163], v[184:187]
 v_mfma_f32_16x16x32_bf16 v[180:183], a[216:219], a[152:155], v[180:183]
 v_mfma_f32_16x16x32_bf16 v[180:183], a[220:223], a[156:159], v[180:183]
 s_add_u32 s30, s30, s21
 v_mfma_f32_16x16x32_bf16 v[176:179], a[220:223], a[148:151], v[176:179]
 v_mfma_f32_16x16x32_bf16 v[176:179], a[216:219], a[144:147], v[176:179]
 v_mfma_f32_16x16x32_bf16 v[172:175], a[216:219], a[136:139], v[172:175]
 v_mfma_f32_16x16x32_bf16 v[172:175], a[220:223], a[140:143], v[172:175]
 v_mfma_f32_16x16x32_bf16 v[168:171], a[220:223], a[132:135], v[168:171]
 v_mfma_f32_16x16x32_bf16 v[168:171], a[216:219], a[128:131], v[168:171]
 s_waitcnt vmcnt(11)
 v_mfma_f32_16x16x32_bf16 v[200:203], a[224:227], a[128:131], v[200:203]
 v_mfma_f32_16x16x32_bf16 v[200:203], a[228:231], a[132:135], v[200:203]
 global_load_dwordx4 a[220:223], v0, s[70:71] offset:3072 sc1
 v_mfma_f32_16x16x32_bf16 v[204:207], a[228:231], a[140:143], v[204:207]
 v_mfma_f32_16x16x32_bf16 v[204:207], a[224:227], a[136:139], v[204:207]
 global_load_dwordx4 a[216:219], v0, s[70:71] offset:2048 sc1
 v_mfma_f32_16x16x32_bf16 v[208:211], a[224:227], a[144:147], v[208:211]
 s_add_u32 s70, s70, 8192
 s_addc_u32 s71, s71, 0
 v_mfma_f32_16x16x32_bf16 v[208:211], a[228:231], a[148:151], v[208:211]
 v_mfma_f32_16x16x32_bf16 v[212:215], a[228:231], a[156:159], v[212:215]
 v_mfma_f32_16x16x32_bf16 v[212:215], a[224:227], a[152:155], v[212:215]
 v_mfma_f32_16x16x32_bf16 v[216:219], a[224:227], a[160:163], v[216:219]
 v_mfma_f32_16x16x32_bf16 v[216:219], a[228:231], a[164:167], v[216:219]
 v_mfma_f32_16x16x32_bf16 v[220:223], a[228:231], a[172:175], v[220:223]
 v_mfma_f32_16x16x32_bf16 v[220:223], a[224:227], a[168:171], v[220:223]
 v_mfma_f32_16x16x32_bf16 v[224:227], a[224:227], a[176:179], v[224:227]
 v_mfma_f32_16x16x32_bf16 v[224:227], a[228:231], a[180:183], v[224:227]
 v_mfma_f32_16x16x32_bf16 v[228:231], a[228:231], a[188:191], v[228:231]
 v_mfma_f32_16x16x32_bf16 v[228:231], a[224:227], a[184:187], v[228:231]
 s_waitcnt vmcnt(10)
 v_mfma_f32_16x16x32_bf16 a[252:255], a[232:235], a[184:187], a[252:255]
 ds_read_b128 a[184:187], v1 offset:61440
 v_mfma_f32_16x16x32_bf16 a[252:255], a[236:239], a[188:191], a[252:255]
 global_load_dwordx4 a[228:231], v0, s[70:71] offset:-3072 sc1
 ds_read_b128 a[188:191], v1 offset:62464
 v_mfma_f32_16x16x32_bf16 a[248:251], a[236:239], a[180:183], a[248:251]
 ds_read_b128 a[180:183], v1 offset:58368
 v_mfma_f32_16x16x32_bf16 a[248:251], a[232:235], a[176:179], a[248:251]
 global_load_dwordx4 a[224:227], v0, s[70:71] offset:-4096 sc1
 ds_read_b128 a[176:179], v1 offset:57344
 v_mfma_f32_16x16x32_bf16 v[252:255], a[232:235], a[168:171], v[252:255]
 ds_read_b128 a[168:171], v1 offset:53248
 v_mfma_f32_16x16x32_bf16 v[252:255], a[236:239], a[172:175], v[252:255]
 ds_read_b128 a[172:175], v1 offset:54272
 v_mfma_f32_16x16x32_bf16 v[248:251], a[236:239], a[164:167], v[248:251]
 ds_read_b128 a[164:167], v1 offset:50176
 v_mfma_f32_16x16x32_bf16 v[248:251], a[232:235], a[160:163], v[248:251]
 ds_read_b128 a[160:163], v1 offset:49152
 v_mfma_f32_16x16x32_bf16 v[244:247], a[232:235], a[152:155], v[244:247]
 ds_read_b128 a[152:155], v1 offset:45056
 v_mfma_f32_16x16x32_bf16 v[244:247], a[236:239], a[156:159], v[244:247]
 ds_read_b128 a[156:159], v1 offset:46080
 v_mfma_f32_16x16x32_bf16 v[240:243], a[236:239], a[148:151], v[240:243]
 ds_read_b128 a[148:151], v1 offset:41984
 v_mfma_f32_16x16x32_bf16 v[240:243], a[232:235], a[144:147], v[240:243]
 ds_read_b128 a[144:147], v1 offset:40960
 v_mfma_f32_16x16x32_bf16 v[236:239], a[232:235], a[136:139], v[236:239]
 ds_read_b128 a[136:139], v1 offset:36864
 v_mfma_f32_16x16x32_bf16 v[236:239], a[236:239], a[140:143], v[236:239]
 ds_read_b128 a[140:143], v1 offset:37888
 v_mfma_f32_16x16x32_bf16 v[232:235], a[236:239], a[132:135], v[232:235]
 ds_read_b128 a[132:135], v1 offset:33792
 v_mfma_f32_16x16x32_bf16 v[232:235], a[232:235], a[128:131], v[232:235]
 ds_read_b128 a[128:131], v1 offset:32768
 s_waitcnt vmcnt(10) lgkmcnt(8)
 v_mfma_f32_16x16x32_bf16 v[44:47], a[192:195], a[184:187], v[44:47]
 v_mfma_f32_16x16x32_bf16 v[44:47], a[196:199], a[188:191], v[44:47]
 buffer_load_dwordx4 v6, s[8:11], s30 offen lds
 v_mfma_f32_16x16x32_bf16 v[40:43], a[196:199], a[180:183], v[40:43]
 v_mfma_f32_16x16x32_bf16 v[40:43], a[192:195], a[176:179], v[40:43]
 v_mfma_f32_16x16x32_bf16 v[36:39], a[192:195], a[168:171], v[36:39]
 s_add_u32 m0, m0, 1024
 v_mfma_f32_16x16x32_bf16 v[36:39], a[196:199], a[172:175], v[36:39]
 v_mfma_f32_16x16x32_bf16 v[32:35], a[196:199], a[164:167], v[32:35]
 v_mfma_f32_16x16x32_bf16 v[32:35], a[192:195], a[160:163], v[32:35]
 s_waitcnt lgkmcnt(0)
 v_mfma_f32_16x16x32_bf16 v[28:31], a[192:195], a[152:155], v[28:31]
 s_add_u32 s30, s30, s20
 v_mfma_f32_16x16x32_bf16 v[28:31], a[196:199], a[156:159], v[28:31]
 v_mfma_f32_16x16x32_bf16 v[24:27], a[196:199], a[148:151], v[24:27]
 v_mfma_f32_16x16x32_bf16 v[24:27], a[192:195], a[144:147], v[24:27]
 v_mfma_f32_16x16x32_bf16 v[20:23], a[192:195], a[136:139], v[20:23]
 buffer_load_dwordx4 v6, s[8:11], s30 offen lds
 v_mfma_f32_16x16x32_bf16 v[20:23], a[196:199], a[140:143], v[20:23]
 v_mfma_f32_16x16x32_bf16 v[16:19], a[196:199], a[132:135], v[16:19]
 v_mfma_f32_16x16x32_bf16 v[16:19], a[192:195], a[128:131], v[16:19]
 s_add_u32 m0, m0, 3072
 s_waitcnt vmcnt(10)
 v_mfma_f32_16x16x32_bf16 v[48:51], a[200:203], a[128:131], v[48:51]
 v_mfma_f32_16x16x32_bf16 v[48:51], a[204:207], a[132:135], v[48:51]
 global_load_dwordx4 a[196:199], v0, s[70:71] offset:-1024 sc1
 v_mfma_f32_16x16x32_bf16 v[52:55], a[204:207], a[140:143], v[52:55]
 v_mfma_f32_16x16x32_bf16 v[52:55], a[200:203], a[136:139], v[52:55]
 global_load_dwordx4 a[192:195], v0, s[70:71] offset:-2048 sc1
 s_add_u32 s30, s30, s21
 v_mfma_f32_16x16x32_bf16 v[56:59], a[200:203], a[144:147], v[56:59]
 v_mfma_f32_16x16x32_bf16 v[56:59], a[204:207], a[148:151], v[56:59]
 v_mfma_f32_16x16x32_bf16 v[60:63], a[204:207], a[156:159], v[60:63]
 v_mfma_f32_16x16x32_bf16 v[60:63], a[200:203], a[152:155], v[60:63]
 v_mfma_f32_16x16x32_bf16 v[64:67], a[200:203], a[160:163], v[64:67]
 v_mfma_f32_16x16x32_bf16 v[64:67], a[204:207], a[164:167], v[64:67]
 v_mfma_f32_16x16x32_bf16 v[68:71], a[204:207], a[172:175], v[68:71]
 v_mfma_f32_16x16x32_bf16 v[68:71], a[200:203], a[168:171], v[68:71]
 v_mfma_f32_16x16x32_bf16 v[72:75], a[200:203], a[176:179], v[72:75]
 v_mfma_f32_16x16x32_bf16 v[72:75], a[204:207], a[180:183], v[72:75]
 v_mfma_f32_16x16x32_bf16 v[76:79], a[204:207], a[188:191], v[76:79]
 v_mfma_f32_16x16x32_bf16 v[76:79], a[200:203], a[184:187], v[76:79]
 s_waitcnt vmcnt(8)
 v_mfma_f32_16x16x32_bf16 v[108:111], a[208:211], a[184:187], v[108:111]
 v_mfma_f32_16x16x32_bf16 v[108:111], a[212:215], a[188:191], v[108:111]
 global_load_dwordx4 a[204:207], v0, s[70:71] offset:1024 sc1
 v_mfma_f32_16x16x32_bf16 v[104:107], a[212:215], a[180:183], v[104:107]
 v_mfma_f32_16x16x32_bf16 v[104:107], a[208:211], a[176:179], v[104:107]
 global_load_dwordx4 a[200:203], v0, s[70:71] offset:0 sc1
 v_mfma_f32_16x16x32_bf16 v[100:103], a[208:211], a[168:171], v[100:103]
 v_mfma_f32_16x16x32_bf16 v[100:103], a[212:215], a[172:175], v[100:103]
 v_mfma_f32_16x16x32_bf16 v[96:99], a[212:215], a[164:167], v[96:99]
 v_mfma_f32_16x16x32_bf16 v[96:99], a[208:211], a[160:163], v[96:99]
 v_mfma_f32_16x16x32_bf16 v[92:95], a[208:211], a[152:155], v[92:95]
 v_mfma_f32_16x16x32_bf16 v[92:95], a[212:215], a[156:159], v[92:95]
 v_mfma_f32_16x16x32_bf16 v[88:91], a[212:215], a[148:151], v[88:91]
 v_mfma_f32_16x16x32_bf16 v[88:91], a[208:211], a[144:147], v[88:91]
 v_mfma_f32_16x16x32_bf16 v[84:87], a[208:211], a[136:139], v[84:87]
 v_mfma_f32_16x16x32_bf16 v[84:87], a[212:215], a[140:143], v[84:87]
 v_mfma_f32_16x16x32_bf16 v[80:83], a[212:215], a[132:135], v[80:83]
 v_mfma_f32_16x16x32_bf16 v[80:83], a[208:211], a[128:131], v[80:83]
 s_waitcnt vmcnt(8)
 v_mfma_f32_16x16x32_bf16 v[112:115], a[216:219], a[128:131], v[112:115]
 v_mfma_f32_16x16x32_bf16 v[112:115], a[220:223], a[132:135], v[112:115]
 global_load_dwordx4 a[212:215], v0, s[70:71] offset:3072 sc1
 v_mfma_f32_16x16x32_bf16 v[116:119], a[220:223], a[140:143], v[116:119]
 v_mfma_f32_16x16x32_bf16 v[116:119], a[216:219], a[136:139], v[116:119]
 global_load_dwordx4 a[208:211], v0, s[70:71] offset:2048 sc1
 v_mfma_f32_16x16x32_bf16 v[120:123], a[216:219], a[144:147], v[120:123]
 s_add_u32 s70, s70, 8192
 s_addc_u32 s71, s71, 0
 v_mfma_f32_16x16x32_bf16 v[120:123], a[220:223], a[148:151], v[120:123]
 v_mfma_f32_16x16x32_bf16 v[124:127], a[220:223], a[156:159], v[124:127]
 v_mfma_f32_16x16x32_bf16 v[124:127], a[216:219], a[152:155], v[124:127]
 v_mfma_f32_16x16x32_bf16 v[128:131], a[216:219], a[160:163], v[128:131]
 v_mfma_f32_16x16x32_bf16 v[128:131], a[220:223], a[164:167], v[128:131]
 v_mfma_f32_16x16x32_bf16 v[132:135], a[220:223], a[172:175], v[132:135]
 v_mfma_f32_16x16x32_bf16 v[132:135], a[216:219], a[168:171], v[132:135]
 buffer_load_dwordx4 v6, s[8:11], s30 offen lds
 v_mfma_f32_16x16x32_bf16 a[240:243], a[216:219], a[176:179], a[240:243]
 v_mfma_f32_16x16x32_bf16 a[240:243], a[220:223], a[180:183], a[240:243]
 v_mfma_f32_16x16x32_bf16 a[244:247], a[220:223], a[188:191], a[244:247]
 s_add_u32 m0, m0, 1024
 v_mfma_f32_16x16x32_bf16 a[244:247], a[216:219], a[184:187], a[244:247]
 s_waitcnt vmcnt(9)
 v_mfma_f32_16x16x32_bf16 v[164:167], a[224:227], a[184:187], v[164:167]
 v_mfma_f32_16x16x32_bf16 v[164:167], a[228:231], a[188:191], v[164:167]
 global_load_dwordx4 a[220:223], v0, s[70:71] offset:-3072 sc1
 v_mfma_f32_16x16x32_bf16 v[160:163], a[228:231], a[180:183], v[160:163]
 s_add_u32 s30, s30, s20
 v_mfma_f32_16x16x32_bf16 v[160:163], a[224:227], a[176:179], v[160:163]
 global_load_dwordx4 a[216:219], v0, s[70:71] offset:-4096 sc1
 v_mfma_f32_16x16x32_bf16 v[156:159], a[224:227], a[168:171], v[156:159]
 v_mfma_f32_16x16x32_bf16 v[156:159], a[228:231], a[172:175], v[156:159]
 v_mfma_f32_16x16x32_bf16 v[152:155], a[228:231], a[164:167], v[152:155]
 buffer_load_dwordx4 v6, s[8:11], s30 offen lds
 v_mfma_f32_16x16x32_bf16 v[152:155], a[224:227], a[160:163], v[152:155]
 v_mfma_f32_16x16x32_bf16 v[148:151], a[224:227], a[152:155], v[148:151]
 v_mfma_f32_16x16x32_bf16 v[148:151], a[228:231], a[156:159], v[148:151]
 s_add_u32 m0, m0, 3072
 v_mfma_f32_16x16x32_bf16 v[144:147], a[228:231], a[148:151], v[144:147]
 v_mfma_f32_16x16x32_bf16 v[144:147], a[224:227], a[144:147], v[144:147]
 v_mfma_f32_16x16x32_bf16 v[140:143], a[224:227], a[136:139], v[140:143]
 v_mfma_f32_16x16x32_bf16 v[140:143], a[228:231], a[140:143], v[140:143]
 s_add_u32 s30, s30, s21
 v_mfma_f32_16x16x32_bf16 v[136:139], a[228:231], a[132:135], v[136:139]
 v_mfma_f32_16x16x32_bf16 v[136:139], a[224:227], a[128:131], v[136:139]
 s_waitcnt vmcnt(8)
 v_mfma_f32_16x16x32_bf16 v[168:171], a[192:195], a[128:131], v[168:171]
 v_mfma_f32_16x16x32_bf16 v[168:171], a[196:199], a[132:135], v[168:171]
 global_load_dwordx4 a[228:231], v0, s[70:71] offset:-1024 sc1
 v_mfma_f32_16x16x32_bf16 v[172:175], a[196:199], a[140:143], v[172:175]
 v_mfma_f32_16x16x32_bf16 v[172:175], a[192:195], a[136:139], v[172:175]
 global_load_dwordx4 a[224:227], v0, s[70:71] offset:-2048 sc1
 v_mfma_f32_16x16x32_bf16 v[176:179], a[192:195], a[144:147], v[176:179]
 v_mfma_f32_16x16x32_bf16 v[176:179], a[196:199], a[148:151], v[176:179]
 v_mfma_f32_16x16x32_bf16 v[180:183], a[196:199], a[156:159], v[180:183]
 v_mfma_f32_16x16x32_bf16 v[180:183], a[192:195], a[152:155], v[180:183]
 v_mfma_f32_16x16x32_bf16 v[184:187], a[192:195], a[160:163], v[184:187]
 v_mfma_f32_16x16x32_bf16 v[184:187], a[196:199], a[164:167], v[184:187]
 v_mfma_f32_16x16x32_bf16 v[188:191], a[196:199], a[172:175], v[188:191]
 v_mfma_f32_16x16x32_bf16 v[188:191], a[192:195], a[168:171], v[188:191]
 v_mfma_f32_16x16x32_bf16 v[192:195], a[192:195], a[176:179], v[192:195]
 v_mfma_f32_16x16x32_bf16 v[192:195], a[196:199], a[180:183], v[192:195]
 v_mfma_f32_16x16x32_bf16 v[196:199], a[196:199], a[188:191], v[196:199]
 v_mfma_f32_16x16x32_bf16 v[196:199], a[192:195], a[184:187], v[196:199]
 s_waitcnt vmcnt(8)
 v_mfma_f32_16x16x32_bf16 v[228:231], a[200:203], a[184:187], v[228:231]
 v_mfma_f32_16x16x32_bf16 v[228:231], a[204:207], a[188:191], v[228:231]
 global_load_dwordx4 a[196:199], v0, s[70:71] offset:1024 sc1
 v_mfma_f32_16x16x32_bf16 v[224:227], a[204:207], a[180:183], v[224:227]
 v_mfma_f32_16x16x32_bf16 v[224:227], a[200:203], a[176:179], v[224:227]
 global_load_dwordx4 a[192:195], v0, s[70:71] offset:0 sc1
 v_mfma_f32_16x16x32_bf16 v[220:223], a[200:203], a[168:171], v[220:223]
 v_mfma_f32_16x16x32_bf16 v[220:223], a[204:207], a[172:175], v[220:223]
 v_mfma_f32_16x16x32_bf16 v[216:219], a[204:207], a[164:167], v[216:219]
 v_mfma_f32_16x16x32_bf16 v[216:219], a[200:203], a[160:163], v[216:219]
 v_mfma_f32_16x16x32_bf16 v[212:215], a[200:203], a[152:155], v[212:215]
 v_mfma_f32_16x16x32_bf16 v[212:215], a[204:207], a[156:159], v[212:215]
 v_mfma_f32_16x16x32_bf16 v[208:211], a[204:207], a[148:151], v[208:211]
 v_mfma_f32_16x16x32_bf16 v[208:211], a[200:203], a[144:147], v[208:211]
 v_mfma_f32_16x16x32_bf16 v[204:207], a[200:203], a[136:139], v[204:207]
 v_mfma_f32_16x16x32_bf16 v[204:207], a[204:207], a[140:143], v[204:207]
 v_mfma_f32_16x16x32_bf16 v[200:203], a[204:207], a[132:135], v[200:203]
 v_mfma_f32_16x16x32_bf16 v[200:203], a[200:203], a[128:131], v[200:203]
 buffer_load_dwordx4 v6, s[8:11], s30 offen lds
 s_waitcnt vmcnt(9)
 v_mfma_f32_16x16x32_bf16 v[232:235], a[208:211], a[128:131], v[232:235]
 ds_read_b128 a[128:131], v2
 v_mfma_f32_16x16x32_bf16 v[232:235], a[212:215], a[132:135], v[232:235]
 global_load_dwordx4 a[204:207], v0, s[70:71] offset:3072 sc1
 ds_read_b128 a[132:135], v2 offset:1024
 v_mfma_f32_16x16x32_bf16 v[236:239], a[212:215], a[140:143], v[236:239]
 ds_read_b128 a[140:143], v2 offset:5120
 v_mfma_f32_16x16x32_bf16 v[236:239], a[208:211], a[136:139], v[236:239]
 global_load_dwordx4 a[200:203], v0, s[70:71] offset:2048 sc1
 ds_read_b128 a[136:139], v2 offset:4096
 v_mfma_f32_16x16x32_bf16 v[240:243], a[208:211], a[144:147], v[240:243]
 s_add_u32 s70, s70, 8192
 s_addc_u32 s71, s71, 0
 ds_read_b128 a[144:147], v2 offset:8192
 v_mfma_f32_16x16x32_bf16 v[240:243], a[212:215], a[148:151], v[240:243]
 ds_read_b128 a[148:151], v2 offset:9216
 v_mfma_f32_16x16x32_bf16 v[244:247], a[212:215], a[156:159], v[244:247]
 ds_read_b128 a[156:159], v2 offset:13312
 v_mfma_f32_16x16x32_bf16 v[244:247], a[208:211], a[152:155], v[244:247]
 ds_read_b128 a[152:155], v2 offset:12288
 v_mfma_f32_16x16x32_bf16 v[248:251], a[208:211], a[160:163], v[248:251]
 ds_read_b128 a[160:163], v2 offset:16384
 v_mfma_f32_16x16x32_bf16 v[248:251], a[212:215], a[164:167], v[248:251]
 ds_read_b128 a[164:167], v2 offset:17408
 s_add_u32 m0, m0, 1024
 v_mfma_f32_16x16x32_bf16 v[252:255], a[212:215], a[172:175], v[252:255]
 ds_read_b128 a[172:175], v2 offset:21504
 v_mfma_f32_16x16x32_bf16 v[252:255], a[208:211], a[168:171], v[252:255]
 ds_read_b128 a[168:171], v2 offset:20480
 v_mfma_f32_16x16x32_bf16 a[248:251], a[208:211], a[176:179], a[248:251]
 ds_read_b128 a[176:179], v2 offset:24576
 s_add_u32 s30, s30, s20
 v_mfma_f32_16x16x32_bf16 a[248:251], a[212:215], a[180:183], a[248:251]
 ds_read_b128 a[180:183], v2 offset:25600
 v_mfma_f32_16x16x32_bf16 a[252:255], a[212:215], a[188:191], a[252:255]
 ds_read_b128 a[188:191], v2 offset:29696
 v_mfma_f32_16x16x32_bf16 a[252:255], a[208:211], a[184:187], a[252:255]
 ds_read_b128 a[184:187], v2 offset:28672
 s_waitcnt vmcnt(8) lgkmcnt(8)
 v_mfma_f32_16x16x32_bf16 v[16:19], a[216:219], a[128:131], v[16:19]
 buffer_load_dwordx4 v6, s[8:11], s30 offen lds
 v_mfma_f32_16x16x32_bf16 v[16:19], a[220:223], a[132:135], v[16:19]
 global_load_dwordx4 a[212:215], v0, s[70:71] offset:-3072 sc1
 v_mfma_f32_16x16x32_bf16 v[20:23], a[220:223], a[140:143], v[20:23]
 v_mfma_f32_16x16x32_bf16 v[20:23], a[216:219], a[136:139], v[20:23]
 global_load_dwordx4 a[208:211], v0, s[70:71] offset:-4096 sc1
 s_add_u32 m0, m0, 3072
 v_mfma_f32_16x16x32_bf16 v[24:27], a[216:219], a[144:147], v[24:27]
 v_mfma_f32_16x16x32_bf16 v[24:27], a[220:223], a[148:151], v[24:27]
 v_mfma_f32_16x16x32_bf16 v[28:31], a[220:223], a[156:159], v[28:31]
 v_mfma_f32_16x16x32_bf16 v[28:31], a[216:219], a[152:155], v[28:31]
 s_add_u32 s30, s30, s21
 s_waitcnt lgkmcnt(0)
 v_mfma_f32_16x16x32_bf16 v[32:35], a[216:219], a[160:163], v[32:35]
 v_mfma_f32_16x16x32_bf16 v[32:35], a[220:223], a[164:167], v[32:35]
 v_mfma_f32_16x16x32_bf16 v[36:39], a[220:223], a[172:175], v[36:39]
 v_mfma_f32_16x16x32_bf16 v[36:39], a[216:219], a[168:171], v[36:39]
 v_mfma_f32_16x16x32_bf16 v[40:43], a[216:219], a[176:179], v[40:43]
 v_mfma_f32_16x16x32_bf16 v[40:43], a[220:223], a[180:183], v[40:43]
 v_mfma_f32_16x16x32_bf16 v[44:47], a[220:223], a[188:191], v[44:47]
 v_mfma_f32_16x16x32_bf16 v[44:47], a[216:219], a[184:187], v[44:47]
 s_waitcnt vmcnt(8)
 v_mfma_f32_16x16x32_bf16 v[76:79], a[224:227], a[184:187], v[76:79]
 v_mfma_f32_16x16x32_bf16 v[76:79], a[228:231], a[188:191], v[76:79]
 global_load_dwordx4 a[220:223], v0, s[70:71] offset:-1024 sc1
 v_mfma_f32_16x16x32_bf16 v[72:75], a[228:231], a[180:183], v[72:75]
 v_mfma_f32_16x16x32_bf16 v[72:75], a[224:227], a[176:179], v[72:75]
 global_load_dwordx4 a[216:219], v0, s[70:71] offset:-2048 sc1
 v_mfma_f32_16x16x32_bf16 v[68:71], a[224:227], a[168:171], v[68:71]
 v_mfma_f32_16x16x32_bf16 v[68:71], a[228:231], a[172:175], v[68:71]
 v_mfma_f32_16x16x32_bf16 v[64:67], a[228:231], a[164:167], v[64:67]
 v_mfma_f32_16x16x32_bf16 v[64:67], a[224:227], a[160:163], v[64:67]
 v_mfma_f32_16x16x32_bf16 v[60:63], a[224:227], a[152:155], v[60:63]
 v_mfma_f32_16x16x32_bf16 v[60:63], a[228:231], a[156:159], v[60:63]
 v_mfma_f32_16x16x32_bf16 v[56:59], a[228:231], a[148:151], v[56:59]
 v_mfma_f32_16x16x32_bf16 v[56:59], a[224:227], a[144:147], v[56:59]
 v_mfma_f32_16x16x32_bf16 v[52:55], a[224:227], a[136:139], v[52:55]
 v_mfma_f32_16x16x32_bf16 v[52:55], a[228:231], a[140:143], v[52:55]
 v_mfma_f32_16x16x32_bf16 v[48:51], a[228:231], a[132:135], v[48:51]
 v_mfma_f32_16x16x32_bf16 v[48:51], a[224:227], a[128:131], v[48:51]
 s_waitcnt vmcnt(8)
 v_mfma_f32_16x16x32_bf16 v[80:83], a[192:195], a[128:131], v[80:83]
 v_mfma_f32_16x16x32_bf16 v[80:83], a[196:199], a[132:135], v[80:83]
 global_load_dwordx4 a[228:231], v0, s[70:71] offset:1024 sc1
 v_mfma_f32_16x16x32_bf16 v[84:87], a[196:199], a[140:143], v[84:87]
 v_mfma_f32_16x16x32_bf16 v[84:87], a[192:195], a[136:139], v[84:87]
 global_load_dwordx4 a[224:227], v0, s[70:71] offset:0 sc1
 v_mfma_f32_16x16x32_bf16 v[88:91], a[192:195], a[144:147], v[88:91]
 v_mfma_f32_16x16x32_bf16 v[88:91], a[196:199], a[148:151], v[88:91]
 v_mfma_f32_16x16x32_bf16 v[92:95], a[196:199], a[156:159], v[92:95]
 v_mfma_f32_16x16x32_bf16 v[92:95], a[192:195], a[152:155], v[92:95]
 v_mfma_f32_16x16x32_bf16 v[96:99], a[192:195], a[160:163], v[96:99]
 v_mfma_f32_16x16x32_bf16 v[96:99], a[196:199], a[164:167], v[96:99]
 v_mfma_f32_16x16x32_bf16 v[100:103], a[196:199], a[172:175], v[100:103]
 v_mfma_f32_16x16x32_bf16 v[100:103], a[192:195], a[168:171], v[100:103]
 v_mfma_f32_16x16x32_bf16 v[104:107], a[192:195], a[176:179], v[104:107]
 v_mfma_f32_16x16x32_bf16 v[104:107], a[196:199], a[180:183], v[104:107]
 v_mfma_f32_16x16x32_bf16 v[108:111], a[196:199], a[188:191], v[108:111]
 v_mfma_f32_16x16x32_bf16 v[108:111], a[192:195], a[184:187], v[108:111]
 buffer_load_dwordx4 v6, s[8:11], s30 offen lds
 s_waitcnt vmcnt(8)
 v_mfma_f32_16x16x32_bf16 a[244:247], a[200:203], a[184:187], a[244:247]
 v_mfma_f32_16x16x32_bf16 a[244:247], a[204:207], a[188:191], a[244:247]
 global_load_dwordx4 a[196:199], v0, s[70:71] offset:3072 sc1
 v_mfma_f32_16x16x32_bf16 a[240:243], a[204:207], a[180:183], a[240:243]
 v_mfma_f32_16x16x32_bf16 a[240:243], a[200:203], a[176:179], a[240:243]
 global_load_dwordx4 a[192:195], v0, s[70:71] offset:2048 sc1
 s_add_u32 m0, m0, 1024
 v_mfma_f32_16x16x32_bf16 v[132:135], a[200:203], a[168:171], v[132:135]
 s_add_u32 s70, s70, 8192
 s_addc_u32 s71, s71, 0
 v_mfma_f32_16x16x32_bf16 v[132:135], a[204:207], a[172:175], v[132:135]
 v_mfma_f32_16x16x32_bf16 v[128:131], a[204:207], a[164:167], v[128:131]
 s_add_u32 s30, s30, s20
 v_mfma_f32_16x16x32_bf16 v[128:131], a[200:203], a[160:163], v[128:131]
 v_mfma_f32_16x16x32_bf16 v[124:127], a[200:203], a[152:155], v[124:127]
 v_mfma_f32_16x16x32_bf16 v[124:127], a[204:207], a[156:159], v[124:127]
 v_mfma_f32_16x16x32_bf16 v[120:123], a[204:207], a[148:151], v[120:123]
 buffer_load_dwordx4 v6, s[8:11], s30 offen lds
 v_mfma_f32_16x16x32_bf16 v[120:123], a[200:203], a[144:147], v[120:123]
 v_mfma_f32_16x16x32_bf16 v[116:119], a[200:203], a[136:139], v[116:119]
 v_mfma_f32_16x16x32_bf16 v[116:119], a[204:207], a[140:143], v[116:119]
 v_mfma_f32_16x16x32_bf16 v[112:115], a[204:207], a[132:135], v[112:115]
 s_add_u32 m0, m0, 3072
 v_mfma_f32_16x16x32_bf16 v[112:115], a[200:203], a[128:131], v[112:115]
 s_waitcnt vmcnt(8)
 v_mfma_f32_16x16x32_bf16 v[136:139], a[208:211], a[128:131], v[136:139]
 v_mfma_f32_16x16x32_bf16 v[136:139], a[212:215], a[132:135], v[136:139]
 global_load_dwordx4 a[204:207], v0, s[70:71] offset:-3072 sc1
 s_add_u32 s30, s30, s21
 v_mfma_f32_16x16x32_bf16 v[140:143], a[212:215], a[140:143], v[140:143]
 v_mfma_f32_16x16x32_bf16 v[140:143], a[208:211], a[136:139], v[140:143]
 global_load_dwordx4 a[200:203], v0, s[70:71] offset:-4096 sc1
 v_mfma_f32_16x16x32_bf16 v[144:147], a[208:211], a[144:147], v[144:147]
 v_mfma_f32_16x16x32_bf16 v[144:147], a[212:215], a[148:151], v[144:147]
 v_mfma_f32_16x16x32_bf16 v[148:151], a[212:215], a[156:159], v[148:151]
 v_mfma_f32_16x16x32_bf16 v[148:151], a[208:211], a[152:155], v[148:151]
 v_mfma_f32_16x16x32_bf16 v[152:155], a[208:211], a[160:163], v[152:155]
 v_mfma_f32_16x16x32_bf16 v[152:155], a[212:215], a[164:167], v[152:155]
 v_mfma_f32_16x16x32_bf16 v[156:159], a[212:215], a[172:175], v[156:159]
 v_and_b32 v5, 768, v3
 v_mfma_f32_16x16x32_bf16 v[156:159], a[208:211], a[168:171], v[156:159]
 v_and_b32 v7, 1023, v3
 v_mfma_f32_16x16x32_bf16 v[160:163], a[208:211], a[176:179], v[160:163]
 v_mfma_f32_16x16x32_bf16 v[160:163], a[212:215], a[180:183], v[160:163]
 v_add3_u32 v5, v5, v7, s52
 v_mfma_f32_16x16x32_bf16 v[164:167], a[212:215], a[188:191], v[164:167]
 v_mfma_f32_16x16x32_bf16 v[164:167], a[208:211], a[184:187], v[164:167]
 ds_read_b64_tr_b16 v[8:9], v5 offset:0
 s_waitcnt vmcnt(8)
 v_mfma_f32_16x16x32_bf16 v[196:199], a[216:219], a[184:187], v[196:199]
 v_mfma_f32_16x16x32_bf16 v[196:199], a[220:223], a[188:191], v[196:199]
 global_load_dwordx4 a[212:215], v0, s[70:71] offset:-1024 sc1
 ds_read_b64_tr_b16 v[10:11], v5 offset:256
 v_mfma_f32_16x16x32_bf16 v[192:195], a[220:223], a[180:183], v[192:195]
 ds_read_b64_tr_b16 v[12:13], v5 offset:8
 v_mfma_f32_16x16x32_bf16 v[192:195], a[216:219], a[176:179], v[192:195]
 global_load_dwordx4 a[208:211], v0, s[70:71] offset:-2048 sc1
 ds_read_b64_tr_b16 v[14:15], v5 offset:264
 v_mfma_f32_16x16x32_bf16 v[188:191], a[216:219], a[168:171], v[188:191]
 v_mfma_f32_16x16x32_bf16 v[188:191], a[220:223], a[172:175], v[188:191]
 v_mfma_f32_16x16x32_bf16 v[184:187], a[220:223], a[164:167], v[184:187]
 v_mfma_f32_16x16x32_bf16 v[184:187], a[216:219], a[160:163], v[184:187]
 v_mfma_f32_16x16x32_bf16 v[180:183], a[216:219], a[152:155], v[180:183]
 v_mfma_f32_16x16x32_bf16 v[180:183], a[220:223], a[156:159], v[180:183]
 v_mfma_f32_16x16x32_bf16 v[176:179], a[220:223], a[148:151], v[176:179]
 v_mfma_f32_16x16x32_bf16 v[176:179], a[216:219], a[144:147], v[176:179]
 v_mfma_f32_16x16x32_bf16 v[172:175], a[216:219], a[136:139], v[172:175]
 v_mfma_f32_16x16x32_bf16 v[172:175], a[220:223], a[140:143], v[172:175]
 v_mfma_f32_16x16x32_bf16 v[168:171], a[220:223], a[132:135], v[168:171]
 v_mfma_f32_16x16x32_bf16 v[168:171], a[216:219], a[128:131], v[168:171]
 s_waitcnt vmcnt(8)
 v_mfma_f32_16x16x32_bf16 v[200:203], a[224:227], a[128:131], v[200:203]
 v_mfma_f32_16x16x32_bf16 v[200:203], a[228:231], a[132:135], v[200:203]
 global_load_dwordx4 a[220:223], v0, s[70:71] offset:1024 sc1
 v_mfma_f32_16x16x32_bf16 v[204:207], a[228:231], a[140:143], v[204:207]
 s_waitcnt lgkmcnt(2)
 v_mfma_f32_16x16x32_bf16 v[204:207], a[224:227], a[136:139], v[204:207]
 global_load_dwordx4 a[216:219], v0, s[70:71] offset:0 sc1
 v_mfma_f32_16x16x32_bf16 v[208:211], a[224:227], a[144:147], v[208:211]
 buffer_store_dwordx4 v[8:11], v7, s[12:15], s49 offen sc1
 v_mfma_f32_16x16x32_bf16 v[208:211], a[228:231], a[148:151], v[208:211]
 s_waitcnt lgkmcnt(0)
 v_mfma_f32_16x16x32_bf16 v[212:215], a[228:231], a[156:159], v[212:215]
 buffer_store_dwordx4 v[12:15], v7, s[12:15], s49 offen offset:2048 sc1
 v_mfma_f32_16x16x32_bf16 v[212:215], a[224:227], a[152:155], v[212:215]
 s_add_u32 s49, s49, 2097152
 v_mfma_f32_16x16x32_bf16 v[216:219], a[224:227], a[160:163], v[216:219]
 v_mfma_f32_16x16x32_bf16 v[216:219], a[228:231], a[164:167], v[216:219]
 buffer_load_dwordx4 v6, s[8:11], s30 offen lds
 v_mfma_f32_16x16x32_bf16 v[220:223], a[228:231], a[172:175], v[220:223]
 v_mfma_f32_16x16x32_bf16 v[220:223], a[224:227], a[168:171], v[220:223]
 v_mfma_f32_16x16x32_bf16 v[224:227], a[224:227], a[176:179], v[224:227]
 v_mfma_f32_16x16x32_bf16 v[224:227], a[228:231], a[180:183], v[224:227]
 s_add_u32 m0, m0, 1024
 v_mfma_f32_16x16x32_bf16 v[228:231], a[228:231], a[188:191], v[228:231]
 v_mfma_f32_16x16x32_bf16 v[228:231], a[224:227], a[184:187], v[228:231]
 s_add_u32 s30, s30, s20
 buffer_load_dwordx4 v6, s[8:11], s30 offen lds
 s_waitcnt vmcnt(11)
 v_mfma_f32_16x16x32_bf16 a[252:255], a[192:195], a[184:187], a[252:255]
 ds_read_b128 a[184:187], v2 offset:61440
 v_mfma_f32_16x16x32_bf16 a[252:255], a[196:199], a[188:191], a[252:255]
 global_load_dwordx4 a[228:231], v0, s[70:71] offset:3072 sc1
 ds_read_b128 a[188:191], v2 offset:62464
 v_mfma_f32_16x16x32_bf16 a[248:251], a[196:199], a[180:183], a[248:251]
 ds_read_b128 a[180:183], v2 offset:58368
 v_mfma_f32_16x16x32_bf16 a[248:251], a[192:195], a[176:179], a[248:251]
 global_load_dwordx4 a[224:227], v0, s[70:71] offset:2048 sc1
 ds_read_b128 a[176:179], v2 offset:57344
 v_mfma_f32_16x16x32_bf16 v[252:255], a[192:195], a[168:171], v[252:255]
 s_add_u32 s70, s70, 8192
 s_addc_u32 s71, s71, 0
 ds_read_b128 a[168:171], v2 offset:53248
 v_mfma_f32_16x16x32_bf16 v[252:255], a[196:199], a[172:175], v[252:255]
 ds_read_b128 a[172:175], v2 offset:54272
 v_mfma_f32_16x16x32_bf16 v[248:251], a[196:199], a[164:167], v[248:251]
 ds_read_b128 a[164:167], v2 offset:50176
 v_mfma_f32_16x16x32_bf16 v[248:251], a[192:195], a[160:163], v[248:251]
 ds_read_b128 a[160:163], v2 offset:49152
 v_mfma_f32_16x16x32_bf16 v[244:247], a[192:195], a[152:155], v[244:247]
 ds_read_b128 a[152:155], v2 offset:45056
 s_add_u32 m0, m0, 3072
 v_mfma_f32_16x16x32_bf16 v[244:247], a[196:199], a[156:159], v[244:247]
 ds_read_b128 a[156:159], v2 offset:46080
 v_mfma_f32_16x16x32_bf16 v[240:243], a[196:199], a[148:151], v[240:243]
 ds_read_b128 a[148:151], v2 offset:41984
 v_mfma_f32_16x16x32_bf16 v[240:243], a[192:195], a[144:147], v[240:243]
 ds_read_b128 a[144:147], v2 offset:40960
 s_add_u32 s30, s30, s21
 v_mfma_f32_16x16x32_bf16 v[236:239], a[192:195], a[136:139], v[236:239]
 ds_read_b128 a[136:139], v2 offset:36864
 v_mfma_f32_16x16x32_bf16 v[236:239], a[196:199], a[140:143], v[236:239]
 ds_read_b128 a[140:143], v2 offset:37888
 v_mfma_f32_16x16x32_bf16 v[232:235], a[196:199], a[132:135], v[232:235]
 ds_read_b128 a[132:135], v2 offset:33792
 v_mfma_f32_16x16x32_bf16 v[232:235], a[192:195], a[128:131], v[232:235]
 ds_read_b128 a[128:131], v2 offset:32768
 s_waitcnt vmcnt(10) lgkmcnt(8)
 v_mfma_f32_16x16x32_bf16 v[44:47], a[200:203], a[184:187], v[44:47]
 v_mfma_f32_16x16x32_bf16 v[44:47], a[204:207], a[188:191], v[44:47]
 global_load_dwordx4 a[196:199], v0, s[70:71] offset:-3072 sc1
 v_mfma_f32_16x16x32_bf16 v[40:43], a[204:207], a[180:183], v[40:43]
 v_mfma_f32_16x16x32_bf16 v[40:43], a[200:203], a[176:179], v[40:43]
 global_load_dwordx4 a[192:195], v0, s[70:71] offset:-4096 sc1
 v_mfma_f32_16x16x32_bf16 v[36:39], a[200:203], a[168:171], v[36:39]
 v_mfma_f32_16x16x32_bf16 v[36:39], a[204:207], a[172:175], v[36:39]
 v_mfma_f32_16x16x32_bf16 v[32:35], a[204:207], a[164:167], v[32:35]
 v_mfma_f32_16x16x32_bf16 v[32:35], a[200:203], a[160:163], v[32:35]
 s_waitcnt lgkmcnt(0)
 v_mfma_f32_16x16x32_bf16 v[28:31], a[200:203], a[152:155], v[28:31]
 v_mfma_f32_16x16x32_bf16 v[28:31], a[204:207], a[156:159], v[28:31]
 v_mfma_f32_16x16x32_bf16 v[24:27], a[204:207], a[148:151], v[24:27]
 v_mfma_f32_16x16x32_bf16 v[24:27], a[200:203], a[144:147], v[24:27]
 v_mfma_f32_16x16x32_bf16 v[20:23], a[200:203], a[136:139], v[20:23]
 v_mfma_f32_16x16x32_bf16 v[20:23], a[204:207], a[140:143], v[20:23]
 v_mfma_f32_16x16x32_bf16 v[16:19], a[204:207], a[132:135], v[16:19]
 v_mfma_f32_16x16x32_bf16 v[16:19], a[200:203], a[128:131], v[16:19]
 s_waitcnt vmcnt(10)
 v_mfma_f32_16x16x32_bf16 v[48:51], a[208:211], a[128:131], v[48:51]
 v_mfma_f32_16x16x32_bf16 v[48:51], a[212:215], a[132:135], v[48:51]
 global_load_dwordx4 a[204:207], v0, s[70:71] offset:-1024 sc1
 v_mfma_f32_16x16x32_bf16 v[52:55], a[212:215], a[140:143], v[52:55]
 v_mfma_f32_16x16x32_bf16 v[52:55], a[208:211], a[136:139], v[52:55]
 global_load_dwordx4 a[200:203], v0, s[70:71] offset:-2048 sc1
 v_mfma_f32_16x16x32_bf16 v[56:59], a[208:211], a[144:147], v[56:59]
 v_mfma_f32_16x16x32_bf16 v[56:59], a[212:215], a[148:151], v[56:59]
 v_mfma_f32_16x16x32_bf16 v[60:63], a[212:215], a[156:159], v[60:63]
 v_mfma_f32_16x16x32_bf16 v[60:63], a[208:211], a[152:155], v[60:63]
 v_mfma_f32_16x16x32_bf16 v[64:67], a[208:211], a[160:163], v[64:67]
 v_mfma_f32_16x16x32_bf16 v[64:67], a[212:215], a[164:167], v[64:67]
 v_mfma_f32_16x16x32_bf16 v[68:71], a[212:215], a[172:175], v[68:71]
 v_mfma_f32_16x16x32_bf16 v[68:71], a[208:211], a[168:171], v[68:71]
 v_mfma_f32_16x16x32_bf16 v[72:75], a[208:211], a[176:179], v[72:75]
 v_mfma_f32_16x16x32_bf16 v[72:75], a[212:215], a[180:183], v[72:75]
 v_mfma_f32_16x16x32_bf16 v[76:79], a[212:215], a[188:191], v[76:79]
 v_mfma_f32_16x16x32_bf16 v[76:79], a[208:211], a[184:187], v[76:79]
 s_waitcnt vmcnt(10)
 v_mfma_f32_16x16x32_bf16 v[108:111], a[216:219], a[184:187], v[108:111]
 v_mfma_f32_16x16x32_bf16 v[108:111], a[220:223], a[188:191], v[108:111]
 global_load_dwordx4 a[212:215], v0, s[70:71] offset:1024 sc1
 v_mfma_f32_16x16x32_bf16 v[104:107], a[220:223], a[180:183], v[104:107]
 v_mfma_f32_16x16x32_bf16 v[104:107], a[216:219], a[176:179], v[104:107]
 global_load_dwordx4 a[208:211], v0, s[70:71] offset:0 sc1
 v_mfma_f32_16x16x32_bf16 v[100:103], a[216:219], a[168:171], v[100:103]
 buffer_load_dwordx4 v6, s[8:11], s30 offen lds
 v_mfma_f32_16x16x32_bf16 v[100:103], a[220:223], a[172:175], v[100:103]
 v_mfma_f32_16x16x32_bf16 v[96:99], a[220:223], a[164:167], v[96:99]
 v_mfma_f32_16x16x32_bf16 v[96:99], a[216:219], a[160:163], v[96:99]
 s_add_u32 m0, m0, 1024
 v_mfma_f32_16x16x32_bf16 v[92:95], a[216:219], a[152:155], v[92:95]
 v_mfma_f32_16x16x32_bf16 v[92:95], a[220:223], a[156:159], v[92:95]
 v_mfma_f32_16x16x32_bf16 v[88:91], a[220:223], a[148:151], v[88:91]
 v_mfma_f32_16x16x32_bf16 v[88:91], a[216:219], a[144:147], v[88:91]
 s_add_u32 s30, s30, s20
 v_mfma_f32_16x16x32_bf16 v[84:87], a[216:219], a[136:139], v[84:87]
 v_mfma_f32_16x16x32_bf16 v[84:87], a[220:223], a[140:143], v[84:87]
 v_mfma_f32_16x16x32_bf16 v[80:83], a[220:223], a[132:135], v[80:83]
 buffer_load_dwordx4 v6, s[8:11], s30 offen lds
 v_mfma_f32_16x16x32_bf16 v[80:83], a[216:219], a[128:131], v[80:83]
 s_waitcnt vmcnt(8)
 v_mfma_f32_16x16x32_bf16 v[112:115], a[224:227], a[128:131], v[112:115]
 v_mfma_f32_16x16x32_bf16 v[112:115], a[228:231], a[132:135], v[112:115]
 global_load_dwordx4 a[220:223], v0, s[70:71] offset:3072 sc1
 v_mfma_f32_16x16x32_bf16 v[116:119], a[228:231], a[140:143], v[116:119]
 s_add_u32 m0, m0, 3072
 v_mfma_f32_16x16x32_bf16 v[116:119], a[224:227], a[136:139], v[116:119]
 global_load_dwordx4 a[216:219], v0, s[70:71] offset:2048 sc1
 v_mfma_f32_16x16x32_bf16 v[120:123], a[224:227], a[144:147], v[120:123]
 s_add_u32 s70, s70, 8192
 s_addc_u32 s71, s71, 0
 v_mfma_f32_16x16x32_bf16 v[120:123], a[228:231], a[148:151], v[120:123]
 v_mfma_f32_16x16x32_bf16 v[124:127], a[228:231], a[156:159], v[124:127]
 s_add_u32 s30, s30, s22
 v_mfma_f32_16x16x32_bf16 v[124:127], a[224:227], a[152:155], v[124:127]
 v_mfma_f32_16x16x32_bf16 v[128:131], a[224:227], a[160:163], v[128:131]
 v_mfma_f32_16x16x32_bf16 v[128:131], a[228:231], a[164:167], v[128:131]
 v_mfma_f32_16x16x32_bf16 v[132:135], a[228:231], a[172:175], v[132:135]
 v_mfma_f32_16x16x32_bf16 v[132:135], a[224:227], a[168:171], v[132:135]
 v_mfma_f32_16x16x32_bf16 a[240:243], a[224:227], a[176:179], a[240:243]
 v_mfma_f32_16x16x32_bf16 a[240:243], a[228:231], a[180:183], a[240:243]
 v_mfma_f32_16x16x32_bf16 a[244:247], a[228:231], a[188:191], a[244:247]
 v_mfma_f32_16x16x32_bf16 a[244:247], a[224:227], a[184:187], a[244:247]
 s_waitcnt vmcnt(8)
 v_mfma_f32_16x16x32_bf16 v[164:167], a[192:195], a[184:187], v[164:167]
 v_mfma_f32_16x16x32_bf16 v[164:167], a[196:199], a[188:191], v[164:167]
 global_load_dwordx4 a[228:231], v0, s[70:71] offset:-3072 sc1
 v_mfma_f32_16x16x32_bf16 v[160:163], a[196:199], a[180:183], v[160:163]
 v_mfma_f32_16x16x32_bf16 v[160:163], a[192:195], a[176:179], v[160:163]
 global_load_dwordx4 a[224:227], v0, s[70:71] offset:-4096 sc1
 v_mfma_f32_16x16x32_bf16 v[156:159], a[192:195], a[168:171], v[156:159]
 v_mfma_f32_16x16x32_bf16 v[156:159], a[196:199], a[172:175], v[156:159]
 global_load_dwordx4 a[236:239], v0, s[70:71] offset:-1024 sc1
 v_mfma_f32_16x16x32_bf16 v[152:155], a[196:199], a[164:167], v[152:155]
 v_mfma_f32_16x16x32_bf16 v[152:155], a[192:195], a[160:163], v[152:155]
 global_load_dwordx4 a[232:235], v0, s[70:71] offset:-2048 sc1
 v_mfma_f32_16x16x32_bf16 v[148:151], a[192:195], a[152:155], v[148:151]
 v_mfma_f32_16x16x32_bf16 v[148:151], a[196:199], a[156:159], v[148:151]
 v_mfma_f32_16x16x32_bf16 v[144:147], a[196:199], a[148:151], v[144:147]
 v_mfma_f32_16x16x32_bf16 v[144:147], a[192:195], a[144:147], v[144:147]
 v_mfma_f32_16x16x32_bf16 v[140:143], a[192:195], a[136:139], v[140:143]
 v_mfma_f32_16x16x32_bf16 v[140:143], a[196:199], a[140:143], v[140:143]
 v_mfma_f32_16x16x32_bf16 v[136:139], a[196:199], a[132:135], v[136:139]
 v_mfma_f32_16x16x32_bf16 v[136:139], a[192:195], a[128:131], v[136:139]
 s_waitcnt vmcnt(10)
 v_mfma_f32_16x16x32_bf16 v[168:171], a[200:203], a[128:131], v[168:171]
 v_mfma_f32_16x16x32_bf16 v[168:171], a[204:207], a[132:135], v[168:171]
 global_load_dwordx4 a[196:199], v0, s[70:71] offset:1024 sc1
 v_mfma_f32_16x16x32_bf16 v[172:175], a[204:207], a[140:143], v[172:175]
 v_mfma_f32_16x16x32_bf16 v[172:175], a[200:203], a[136:139], v[172:175]
 global_load_dwordx4 a[192:195], v0, s[70:71] offset:0 sc1
 v_mfma_f32_16x16x32_bf16 v[176:179], a[200:203], a[144:147], v[176:179]
 v_mfma_f32_16x16x32_bf16 v[176:179], a[204:207], a[148:151], v[176:179]
 v_mfma_f32_16x16x32_bf16 v[180:183], a[204:207], a[156:159], v[180:183]
 v_mfma_f32_16x16x32_bf16 v[180:183], a[200:203], a[152:155], v[180:183]
 v_mfma_f32_16x16x32_bf16 v[184:187], a[200:203], a[160:163], v[184:187]
 v_mfma_f32_16x16x32_bf16 v[184:187], a[204:207], a[164:167], v[184:187]
 v_mfma_f32_16x16x32_bf16 v[188:191], a[204:207], a[172:175], v[188:191]
 v_mfma_f32_16x16x32_bf16 v[188:191], a[200:203], a[168:171], v[188:191]
 v_mfma_f32_16x16x32_bf16 v[192:195], a[200:203], a[176:179], v[192:195]
 v_mfma_f32_16x16x32_bf16 v[192:195], a[204:207], a[180:183], v[192:195]
 v_mfma_f32_16x16x32_bf16 v[196:199], a[204:207], a[188:191], v[196:199]
 v_mfma_f32_16x16x32_bf16 v[196:199], a[200:203], a[184:187], v[196:199]
 s_waitcnt vmcnt(10)
 v_mfma_f32_16x16x32_bf16 v[228:231], a[208:211], a[184:187], v[228:231]
 v_mfma_f32_16x16x32_bf16 v[228:231], a[212:215], a[188:191], v[228:231]
 global_load_dwordx4 a[204:207], v0, s[70:71] offset:3072 sc1
 v_mfma_f32_16x16x32_bf16 v[224:227], a[212:215], a[180:183], v[224:227]
 v_mfma_f32_16x16x32_bf16 v[224:227], a[208:211], a[176:179], v[224:227]
 global_load_dwordx4 a[200:203], v0, s[70:71] offset:2048 sc1
 v_mfma_f32_16x16x32_bf16 v[220:223], a[208:211], a[168:171], v[220:223]
 s_add_u32 s70, s70, 8192
 s_addc_u32 s71, s71, 0
 v_mfma_f32_16x16x32_bf16 v[220:223], a[212:215], a[172:175], v[220:223]
 v_mfma_f32_16x16x32_bf16 v[216:219], a[212:215], a[164:167], v[216:219]
 v_mfma_f32_16x16x32_bf16 v[216:219], a[208:211], a[160:163], v[216:219]
 v_mfma_f32_16x16x32_bf16 v[212:215], a[208:211], a[152:155], v[212:215]
 v_mfma_f32_16x16x32_bf16 v[212:215], a[212:215], a[156:159], v[212:215]
 v_mfma_f32_16x16x32_bf16 v[208:211], a[212:215], a[148:151], v[208:211]
 s_waitcnt vmcnt(10)
 s_waitcnt lgkmcnt(0)
 s_barrier
 v_mfma_f32_16x16x32_bf16 v[208:211], a[208:211], a[144:147], v[208:211]
 v_mfma_f32_16x16x32_bf16 v[204:207], a[208:211], a[136:139], v[204:207]
 v_mfma_f32_16x16x32_bf16 v[204:207], a[212:215], a[140:143], v[204:207]
 v_mfma_f32_16x16x32_bf16 v[200:203], a[212:215], a[132:135], v[200:203]
 v_mfma_f32_16x16x32_bf16 v[200:203], a[208:211], a[128:131], v[200:203]
 s_waitcnt vmcnt(8)
 v_mfma_f32_16x16x32_bf16 v[232:235], a[216:219], a[128:131], v[232:235]
 ds_read_b128 a[128:131], v1 offset:2048
 v_mfma_f32_16x16x32_bf16 v[232:235], a[220:223], a[132:135], v[232:235]
 global_load_dwordx4 a[212:215], v0, s[70:71] offset:-3072 sc1
 ds_read_b128 a[132:135], v1 offset:3072
 v_mfma_f32_16x16x32_bf16 v[236:239], a[220:223], a[140:143], v[236:239]
 ds_read_b128 a[140:143], v1 offset:7168
 v_mfma_f32_16x16x32_bf16 v[236:239], a[216:219], a[136:139], v[236:239]
 global_load_dwordx4 a[208:211], v0, s[70:71] offset:-4096 sc1
 ds_read_b128 a[136:139], v1 offset:6144
 v_mfma_f32_16x16x32_bf16 v[240:243], a[216:219], a[144:147], v[240:243]
 ds_read_b128 a[144:147], v1 offset:10240
 v_mfma_f32_16x16x32_bf16 v[240:243], a[220:223], a[148:151], v[240:243]
 ds_read_b128 a[148:151], v1 offset:11264
 v_mfma_f32_16x16x32_bf16 v[244:247], a[220:223], a[156:159], v[244:247]
 ds_read_b128 a[156:159], v1 offset:15360
 v_mfma_f32_16x16x32_bf16 v[244:247], a[216:219], a[152:155], v[244:247]
 ds_read_b128 a[152:155], v1 offset:14336
 v_mfma_f32_16x16x32_bf16 v[248:251], a[216:219], a[160:163], v[248:251]
 ds_read_b128 a[160:163], v1 offset:18432
 v_mfma_f32_16x16x32_bf16 v[248:251], a[220:223], a[164:167], v[248:251]
 ds_read_b128 a[164:167], v1 offset:19456
 v_mfma_f32_16x16x32_bf16 v[252:255], a[220:223], a[172:175], v[252:255]
 ds_read_b128 a[172:175], v1 offset:23552
 v_mfma_f32_16x16x32_bf16 v[252:255], a[216:219], a[168:171], v[252:255]
 ds_read_b128 a[168:171], v1 offset:22528
 v_mfma_f32_16x16x32_bf16 a[248:251], a[216:219], a[176:179], a[248:251]
 ds_read_b128 a[176:179], v1 offset:26624
 v_mfma_f32_16x16x32_bf16 a[248:251], a[220:223], a[180:183], a[248:251]
 ds_read_b128 a[180:183], v1 offset:27648
 v_mfma_f32_16x16x32_bf16 a[252:255], a[220:223], a[188:191], a[252:255]
 global_load_dwordx4 a[220:223], v0, s[70:71] offset:-1024 sc1
 ds_read_b128 a[188:191], v1 offset:31744
 v_mfma_f32_16x16x32_bf16 a[252:255], a[216:219], a[184:187], a[252:255]
 global_load_dwordx4 a[216:219], v0, s[70:71] offset:-2048 sc1
 ds_read_b128 a[184:187], v1 offset:30720
 s_waitcnt vmcnt(10) lgkmcnt(8)
 v_mfma_f32_16x16x32_bf16 v[16:19], a[224:227], a[128:131], v[16:19]
 v_mov_b32 v7, 1
 v_mfma_f32_16x16x32_bf16 v[16:19], a[228:231], a[132:135], v[16:19]
 v_mfma_f32_16x16x32_bf16 v[20:23], a[228:231], a[140:143], v[20:23]
 buffer_atomic_add v7, v0, s[56:59], 0 offen sc1
 v_mfma_f32_16x16x32_bf16 v[20:23], a[224:227], a[136:139], v[20:23]
 v_bfe_u32 v4, v3, 8, 2
 v_mfma_f32_16x16x32_bf16 v[24:27], a[224:227], a[144:147], v[24:27]
 v_mfma_f32_16x16x32_bf16 v[24:27], a[228:231], a[148:151], v[24:27]
 v_lshl_add_u32 v4, v4, 5, s51
 v_mfma_f32_16x16x32_bf16 v[28:31], a[228:231], a[156:159], v[28:31]
 ds_read_b128 v[8:11], v4 offset:256
 v_mfma_f32_16x16x32_bf16 v[28:31], a[224:227], a[152:155], v[28:31]
 s_waitcnt lgkmcnt(1)
 v_mfma_f32_16x16x32_bf16 v[32:35], a[224:227], a[160:163], v[32:35]
 v_mfma_f32_16x16x32_bf16 v[32:35], a[228:231], a[164:167], v[32:35]
 v_mfma_f32_16x16x32_bf16 v[36:39], a[228:231], a[172:175], v[36:39]
 v_mfma_f32_16x16x32_bf16 v[36:39], a[224:227], a[168:171], v[36:39]
 v_mfma_f32_16x16x32_bf16 v[40:43], a[224:227], a[176:179], v[40:43]
 v_mfma_f32_16x16x32_bf16 v[40:43], a[228:231], a[180:183], v[40:43]
 v_mfma_f32_16x16x32_bf16 v[44:47], a[228:231], a[188:191], v[44:47]
 v_mfma_f32_16x16x32_bf16 v[44:47], a[224:227], a[184:187], v[44:47]
 s_waitcnt vmcnt(9)
 v_mfma_f32_16x16x32_bf16 v[76:79], a[232:235], a[184:187], v[76:79]
 v_mfma_f32_16x16x32_bf16 v[76:79], a[236:239], a[188:191], v[76:79]
 global_load_dwordx4 a[228:231], v0, s[70:71] offset:1024 sc1
 v_mfma_f32_16x16x32_bf16 v[72:75], a[236:239], a[180:183], v[72:75]
 v_mfma_f32_16x16x32_bf16 v[72:75], a[232:235], a[176:179], v[72:75]
 global_load_dwordx4 a[224:227], v0, s[70:71] offset:0 sc1
 v_mfma_f32_16x16x32_bf16 v[68:71], a[232:235], a[168:171], v[68:71]
 s_waitcnt lgkmcnt(0)
 v_mfma_f32_16x16x32_bf16 v[68:71], a[236:239], a[172:175], v[68:71]
 v_mfma_f32_16x16x32_bf16 v[64:67], a[236:239], a[164:167], v[64:67]
 v_add_f32 v136, v136, v8
 v_mfma_f32_16x16x32_bf16 v[64:67], a[232:235], a[160:163], v[64:67]
 v_mfma_f32_16x16x32_bf16 v[60:63], a[232:235], a[152:155], v[60:63]
 ds_read_b128 v[12:15], v4 offset:272
 v_mfma_f32_16x16x32_bf16 v[60:63], a[236:239], a[156:159], v[60:63]
 v_add_f32 v137, v137, v9
 v_mfma_f32_16x16x32_bf16 v[56:59], a[236:239], a[148:151], v[56:59]
 v_mfma_f32_16x16x32_bf16 v[56:59], a[232:235], a[144:147], v[56:59]
 v_add_f32 v138, v138, v10
 v_mfma_f32_16x16x32_bf16 v[52:55], a[232:235], a[136:139], v[52:55]
 v_add_f32 v139, v139, v11
 v_mfma_f32_16x16x32_bf16 v[52:55], a[236:239], a[140:143], v[52:55]
 v_mfma_f32_16x16x32_bf16 v[48:51], a[236:239], a[132:135], v[48:51]
 v_add_f32 v140, v140, v8
 v_mfma_f32_16x16x32_bf16 v[48:51], a[232:235], a[128:131], v[48:51]
 v_add_f32 v141, v141, v9
 s_waitcnt vmcnt(9)
 v_mfma_f32_16x16x32_bf16 v[80:83], a[192:195], a[128:131], v[80:83]
 v_mfma_f32_16x16x32_bf16 v[80:83], a[196:199], a[132:135], v[80:83]
 global_load_dwordx4 a[236:239], v0, s[70:71] offset:3072 sc1
 v_add_f32 v142, v142, v10
 v_mfma_f32_16x16x32_bf16 v[84:87], a[196:199], a[140:143], v[84:87]
 v_add_f32 v143, v143, v11
 v_mfma_f32_16x16x32_bf16 v[84:87], a[192:195], a[136:139], v[84:87]
 global_load_dwordx4 a[232:235], v0, s[70:71] offset:2048 sc1
 v_mfma_f32_16x16x32_bf16 v[88:91], a[192:195], a[144:147], v[88:91]
 v_add_f32 v144, v144, v8
 s_add_u32 s70, s70, 8192
 s_addc_u32 s71, s71, 0
 v_mfma_f32_16x16x32_bf16 v[88:91], a[196:199], a[148:151], v[88:91]
 v_mfma_f32_16x16x32_bf16 v[92:95], a[196:199], a[156:159], v[92:95]
 v_add_f32 v145, v145, v9
 v_mfma_f32_16x16x32_bf16 v[92:95], a[192:195], a[152:155], v[92:95]
 v_add_f32 v146, v146, v10
 v_mfma_f32_16x16x32_bf16 v[96:99], a[192:195], a[160:163], v[96:99]
 v_mfma_f32_16x16x32_bf16 v[96:99], a[196:199], a[164:167], v[96:99]
 v_add_f32 v147, v147, v11
 v_mfma_f32_16x16x32_bf16 v[100:103], a[196:199], a[172:175], v[100:103]
 v_add_f32 v148, v148, v8
 v_mfma_f32_16x16x32_bf16 v[100:103], a[192:195], a[168:171], v[100:103]
 v_mfma_f32_16x16x32_bf16 v[104:107], a[192:195], a[176:179], v[104:107]
 v_add_f32 v149, v149, v9
 v_mfma_f32_16x16x32_bf16 v[104:107], a[196:199], a[180:183], v[104:107]
 v_add_f32 v150, v150, v10
 v_mfma_f32_16x16x32_bf16 v[108:111], a[196:199], a[188:191], v[108:111]
 v_mfma_f32_16x16x32_bf16 v[108:111], a[192:195], a[184:187], v[108:111]
 v_add_f32 v151, v151, v11
 s_waitcnt vmcnt(9)
 v_mfma_f32_16x16x32_bf16 a[244:247], a[200:203], a[184:187], a[244:247]
 ds_read_b128 a[184:187], v1 offset:63488
 v_add_f32 v152, v152, v8
 v_mfma_f32_16x16x32_bf16 a[244:247], a[204:207], a[188:191], a[244:247]
 global_load_dwordx4 a[196:199], v0, s[70:71] offset:-3072 sc1
 ds_read_b128 a[188:191], v1 offset:64512
 v_mfma_f32_16x16x32_bf16 a[240:243], a[204:207], a[180:183], a[240:243]
 ds_read_b128 a[180:183], v1 offset:60416
 v_add_f32 v153, v153, v9
 v_mfma_f32_16x16x32_bf16 a[240:243], a[200:203], a[176:179], a[240:243]
 global_load_dwordx4 a[192:195], v0, s[70:71] offset:-4096 sc1
 ds_read_b128 a[176:179], v1 offset:59392
 v_mfma_f32_16x16x32_bf16 v[132:135], a[200:203], a[168:171], v[132:135]
 ds_read_b128 a[168:171], v1 offset:55296
 v_add_f32 v154, v154, v10
 v_mfma_f32_16x16x32_bf16 v[132:135], a[204:207], a[172:175], v[132:135]
 ds_read_b128 a[172:175], v1 offset:56320
 v_add_f32 v155, v155, v11
 v_mfma_f32_16x16x32_bf16 v[128:131], a[204:207], a[164:167], v[128:131]
 ds_read_b128 a[164:167], v1 offset:52224
 v_mfma_f32_16x16x32_bf16 v[128:131], a[200:203], a[160:163], v[128:131]
 ds_read_b128 a[160:163], v1 offset:51200
 v_add_f32 v156, v156, v8
 v_mfma_f32_16x16x32_bf16 v[124:127], a[200:203], a[152:155], v[124:127]
 ds_read_b128 a[152:155], v1 offset:47104
 v_add_f32 v157, v157, v9
 v_mfma_f32_16x16x32_bf16 v[124:127], a[204:207], a[156:159], v[124:127]
 ds_read_b128 a[156:159], v1 offset:48128
 v_mfma_f32_16x16x32_bf16 v[120:123], a[204:207], a[148:151], v[120:123]
 ds_read_b128 a[148:151], v1 offset:44032
 v_add_f32 v158, v158, v10
 v_mfma_f32_16x16x32_bf16 v[120:123], a[200:203], a[144:147], v[120:123]
 ds_read_b128 a[144:147], v1 offset:43008
 v_add_f32 v159, v159, v11
 v_mfma_f32_16x16x32_bf16 v[116:119], a[200:203], a[136:139], v[116:119]
 ds_read_b128 a[136:139], v1 offset:38912
 v_mfma_f32_16x16x32_bf16 v[116:119], a[204:207], a[140:143], v[116:119]
 ds_read_b128 a[140:143], v1 offset:39936
 v_add_f32 v160, v160, v8
 v_mfma_f32_16x16x32_bf16 v[112:115], a[204:207], a[132:135], v[112:115]
 ds_read_b128 a[132:135], v1 offset:35840
 v_add_f32 v161, v161, v9
 v_mfma_f32_16x16x32_bf16 v[112:115], a[200:203], a[128:131], v[112:115]
 ds_read_b128 a[128:131], v1 offset:34816
 s_waitcnt vmcnt(9) lgkmcnt(8)
 v_mfma_f32_16x16x32_bf16 v[44:47], a[208:211], a[184:187], v[44:47]
 v_add_f32 v162, v162, v10
 v_mfma_f32_16x16x32_bf16 v[44:47], a[212:215], a[188:191], v[44:47]
 global_load_dwordx4 a[204:207], v0, s[70:71] offset:-1024 sc1
 v_mfma_f32_16x16x32_bf16 v[40:43], a[212:215], a[180:183], v[40:43]
 v_add_f32 v163, v163, v11
 v_mfma_f32_16x16x32_bf16 v[40:43], a[208:211], a[176:179], v[40:43]
 global_load_dwordx4 a[200:203], v0, s[70:71] offset:-2048 sc1
 v_add_f32 v164, v164, v8
 v_mfma_f32_16x16x32_bf16 v[36:39], a[208:211], a[168:171], v[36:39]
 v_mfma_f32_16x16x32_bf16 v[36:39], a[212:215], a[172:175], v[36:39]
 v_add_f32 v165, v165, v9
 v_mfma_f32_16x16x32_bf16 v[32:35], a[212:215], a[164:167], v[32:35]
 v_add_f32 v166, v166, v10
 v_mfma_f32_16x16x32_bf16 v[32:35], a[208:211], a[160:163], v[32:35]
 s_waitcnt lgkmcnt(0)
 v_mfma_f32_16x16x32_bf16 v[28:31], a[208:211], a[152:155], v[28:31]
 v_add_f32 v167, v167, v11
 v_mfma_f32_16x16x32_bf16 v[28:31], a[212:215], a[156:159], v[28:31]
 v_mfma_f32_16x16x32_bf16 v[24:27], a[212:215], a[148:151], v[24:27]
 v_mfma_f32_16x16x32_bf16 v[24:27], a[208:211], a[144:147], v[24:27]
 v_add_f32 v168, v168, v12
 v_mfma_f32_16x16x32_bf16 v[20:23], a[208:211], a[136:139], v[20:23]
 ds_read_b128 v[8:11], v4 offset:384
 v_mfma_f32_16x16x32_bf16 v[20:23], a[212:215], a[140:143], v[20:23]
 v_mfma_f32_16x16x32_bf16 v[16:19], a[212:215], a[132:135], v[16:19]
 v_add_f32 v169, v169, v13
 v_mfma_f32_16x16x32_bf16 v[16:19], a[208:211], a[128:131], v[16:19]
 s_waitcnt vmcnt(9)
 v_mfma_f32_16x16x32_bf16 v[48:51], a[216:219], a[128:131], v[48:51]
 v_add_f32 v170, v170, v14
 v_mfma_f32_16x16x32_bf16 v[48:51], a[220:223], a[132:135], v[48:51]
 global_load_dwordx4 a[212:215], v0, s[70:71] offset:1024 sc1
 v_add_f32 v171, v171, v15
 v_mfma_f32_16x16x32_bf16 v[52:55], a[220:223], a[140:143], v[52:55]
 v_mfma_f32_16x16x32_bf16 v[52:55], a[216:219], a[136:139], v[52:55]
 global_load_dwordx4 a[208:211], v0, s[70:71] offset:0 sc1
 v_add_f32 v172, v172, v12
 v_mfma_f32_16x16x32_bf16 v[56:59], a[216:219], a[144:147], v[56:59]
 v_add_f32 v173, v173, v13
 v_mfma_f32_16x16x32_bf16 v[56:59], a[220:223], a[148:151], v[56:59]
 v_mfma_f32_16x16x32_bf16 v[60:63], a[220:223], a[156:159], v[60:63]
 v_add_f32 v174, v174, v14
 v_mfma_f32_16x16x32_bf16 v[60:63], a[216:219], a[152:155], v[60:63]
 v_add_f32 v175, v175, v15
 v_mfma_f32_16x16x32_bf16 v[64:67], a[216:219], a[160:163], v[64:67]
 v_mfma_f32_16x16x32_bf16 v[64:67], a[220:223], a[164:167], v[64:67]
 v_add_f32 v176, v176, v12
 v_mfma_f32_16x16x32_bf16 v[68:71], a[220:223], a[172:175], v[68:71]
 v_add_f32 v177, v177, v13
 v_mfma_f32_16x16x32_bf16 v[68:71], a[216:219], a[168:171], v[68:71]
 v_mfma_f32_16x16x32_bf16 v[72:75], a[216:219], a[176:179], v[72:75]
 v_add_f32 v178, v178, v14
 v_mfma_f32_16x16x32_bf16 v[72:75], a[220:223], a[180:183], v[72:75]
 v_mfma_f32_16x16x32_bf16 v[76:79], a[220:223], a[188:191], v[76:79]
 v_add_f32 v179, v179, v15
 v_mfma_f32_16x16x32_bf16 v[76:79], a[216:219], a[184:187], v[76:79]
 v_add_f32 v180, v180, v12
 s_waitcnt vmcnt(8)
 v_mfma_f32_16x16x32_bf16 v[108:111], a[224:227], a[184:187], v[108:111]
 v_mfma_f32_16x16x32_bf16 v[108:111], a[228:231], a[188:191], v[108:111]
 global_load_dwordx4 a[220:223], v0, s[70:71] offset:3072 sc1
 v_add_f32 v181, v181, v13
 v_mfma_f32_16x16x32_bf16 v[104:107], a[228:231], a[180:183], v[104:107]
 v_add_f32 v182, v182, v14
 v_mfma_f32_16x16x32_bf16 v[104:107], a[224:227], a[176:179], v[104:107]
 global_load_dwordx4 a[216:219], v0, s[70:71] offset:2048 sc1
 v_mfma_f32_16x16x32_bf16 v[100:103], a[224:227], a[168:171], v[100:103]
 v_add_f32 v183, v183, v15
 s_add_u32 s70, s70, 8192
 s_addc_u32 s71, s71, 0
 v_mfma_f32_16x16x32_bf16 v[100:103], a[228:231], a[172:175], v[100:103]
 v_add_f32 v184, v184, v12
 v_mfma_f32_16x16x32_bf16 v[96:99], a[228:231], a[164:167], v[96:99]
 v_mfma_f32_16x16x32_bf16 v[96:99], a[224:227], a[160:163], v[96:99]
 v_add_f32 v185, v185, v13
 v_mfma_f32_16x16x32_bf16 v[92:95], a[224:227], a[152:155], v[92:95]
 v_add_f32 v186, v186, v14
 v_mfma_f32_16x16x32_bf16 v[92:95], a[228:231], a[156:159], v[92:95]
 v_mfma_f32_16x16x32_bf16 v[88:91], a[228:231], a[148:151], v[88:91]
 v_add_f32 v187, v187, v15
 v_mfma_f32_16x16x32_bf16 v[88:91], a[224:227], a[144:147], v[88:91]
 v_mfma_f32_16x16x32_bf16 v[84:87], a[224:227], a[136:139], v[84:87]
 v_add_f32 v188, v188, v12
 v_mfma_f32_16x16x32_bf16 v[84:87], a[228:231], a[140:143], v[84:87]
 v_add_f32 v189, v189, v13
 v_mfma_f32_16x16x32_bf16 v[80:83], a[228:231], a[132:135], v[80:83]
 v_mfma_f32_16x16x32_bf16 v[80:83], a[224:227], a[128:131], v[80:83]
 v_add_f32 v190, v190, v14
 s_waitcnt vmcnt(8)
 v_mfma_f32_16x16x32_bf16 v[112:115], a[232:235], a[128:131], v[112:115]
 ds_read_b128 a[128:131], v2 offset:2048
 v_add_f32 v191, v191, v15
 v_mfma_f32_16x16x32_bf16 v[112:115], a[236:239], a[132:135], v[112:115]
 global_load_dwordx4 a[228:231], v0, s[70:71] offset:-3072 sc1
 ds_read_b128 a[132:135], v2 offset:3072
 v_mfma_f32_16x16x32_bf16 v[116:119], a[236:239], a[140:143], v[116:119]
 ds_read_b128 a[140:143], v2 offset:7168
 v_add_f32 v192, v192, v12
 v_mfma_f32_16x16x32_bf16 v[116:119], a[232:235], a[136:139], v[116:119]
 global_load_dwordx4 a[224:227], v0, s[70:71] offset:-4096 sc1
 ds_read_b128 a[136:139], v2 offset:6144
 v_mfma_f32_16x16x32_bf16 v[120:123], a[232:235], a[144:147], v[120:123]
 ds_read_b128 a[144:147], v2 offset:10240
 v_add_f32 v193, v193, v13
 v_mfma_f32_16x16x32_bf16 v[120:123], a[236:239], a[148:151], v[120:123]
 ds_read_b128 a[148:151], v2 offset:11264
 v_add_f32 v194, v194, v14
 v_mfma_f32_16x16x32_bf16 v[124:127], a[236:239], a[156:159], v[124:127]
 ds_read_b128 a[156:159], v2 offset:15360
 v_add_f32 v195, v195, v15
 v_mfma_f32_16x16x32_bf16 v[124:127], a[232:235], a[152:155], v[124:127]
 ds_read_b128 a[152:155], v2 offset:14336
 v_mfma_f32_16x16x32_bf16 v[128:131], a[232:235], a[160:163], v[128:131]
 ds_read_b128 a[160:163], v2 offset:18432
 v_add_f32 v196, v196, v12
 v_mfma_f32_16x16x32_bf16 v[128:131], a[236:239], a[164:167], v[128:131]
 ds_read_b128 a[164:167], v2 offset:19456
 v_mfma_f32_16x16x32_bf16 v[132:135], a[236:239], a[172:175], v[132:135]
 ds_read_b128 a[172:175], v2 offset:23552
 v_add_f32 v197, v197, v13
 v_mfma_f32_16x16x32_bf16 v[132:135], a[232:235], a[168:171], v[132:135]
 ds_read_b128 a[168:171], v2 offset:22528
 v_add_f32 v198, v198, v14
 v_mfma_f32_16x16x32_bf16 a[240:243], a[232:235], a[176:179], a[240:243]
 ds_read_b128 a[176:179], v2 offset:26624
 v_mfma_f32_16x16x32_bf16 a[240:243], a[236:239], a[180:183], a[240:243]
 ds_read_b128 a[180:183], v2 offset:27648
 v_add_f32 v199, v199, v15
 v_mfma_f32_16x16x32_bf16 a[244:247], a[236:239], a[188:191], a[244:247]
 ds_read_b128 a[188:191], v2 offset:31744
 s_waitcnt lgkmcnt(15)
 v_mfma_f32_16x16x32_bf16 a[244:247], a[232:235], a[184:187], a[244:247]
 ds_read_b128 a[184:187], v2 offset:30720
 s_waitcnt vmcnt(8) lgkmcnt(8)
 v_mfma_f32_16x16x32_bf16 v[16:19], a[192:195], a[128:131], v[16:19]
 v_add_f32 v200, v200, v8
 v_mfma_f32_16x16x32_bf16 v[16:19], a[196:199], a[132:135], v[16:19]
 global_load_dwordx4 a[236:239], v0, s[70:71] offset:-1024 sc1
 ds_read_b128 v[12:15], v4 offset:400
 v_mfma_f32_16x16x32_bf16 v[20:23], a[196:199], a[140:143], v[20:23]
 v_mfma_f32_16x16x32_bf16 v[20:23], a[192:195], a[136:139], v[20:23]
 global_load_dwordx4 a[232:235], v0, s[70:71] offset:-2048 sc1
 v_add_f32 v201, v201, v9
 v_mfma_f32_16x16x32_bf16 v[24:27], a[192:195], a[144:147], v[24:27]
 v_add_f32 v202, v202, v10
 v_mfma_f32_16x16x32_bf16 v[24:27], a[196:199], a[148:151], v[24:27]
 v_mfma_f32_16x16x32_bf16 v[28:31], a[196:199], a[156:159], v[28:31]
 v_add_f32 v203, v203, v11
 v_mfma_f32_16x16x32_bf16 v[28:31], a[192:195], a[152:155], v[28:31]
 s_waitcnt lgkmcnt(1)
 v_mfma_f32_16x16x32_bf16 v[32:35], a[192:195], a[160:163], v[32:35]
 v_add_f32 v204, v204, v8
 v_mfma_f32_16x16x32_bf16 v[32:35], a[196:199], a[164:167], v[32:35]
 v_add_f32 v205, v205, v9
 v_mfma_f32_16x16x32_bf16 v[36:39], a[196:199], a[172:175], v[36:39]
 v_mfma_f32_16x16x32_bf16 v[36:39], a[192:195], a[168:171], v[36:39]
 v_add_f32 v206, v206, v10
 v_mfma_f32_16x16x32_bf16 v[40:43], a[192:195], a[176:179], v[40:43]
 v_add_f32 v207, v207, v11
 v_mfma_f32_16x16x32_bf16 v[40:43], a[196:199], a[180:183], v[40:43]
 v_mfma_f32_16x16x32_bf16 v[44:47], a[196:199], a[188:191], v[44:47]
 v_add_f32 v208, v208, v8
 v_mfma_f32_16x16x32_bf16 v[44:47], a[192:195], a[184:187], v[44:47]
 v_add_f32 v209, v209, v9
 s_waitcnt vmcnt(8)
 v_mfma_f32_16x16x32_bf16 v[76:79], a[200:203], a[184:187], v[76:79]
 v_mfma_f32_16x16x32_bf16 v[76:79], a[204:207], a[188:191], v[76:79]
 global_load_dwordx4 a[196:199], v0, s[70:71] offset:1024 sc1
 v_add_f32 v210, v210, v10
 v_mfma_f32_16x16x32_bf16 v[72:75], a[204:207], a[180:183], v[72:75]
 v_add_f32 v211, v211, v11
 v_mfma_f32_16x16x32_bf16 v[72:75], a[200:203], a[176:179], v[72:75]
 global_load_dwordx4 a[192:195], v0, s[70:71] offset:0 sc1
 v_mfma_f32_16x16x32_bf16 v[68:71], a[200:203], a[168:171], v[68:71]
 v_add_f32 v212, v212, v8
 v_mfma_f32_16x16x32_bf16 v[68:71], a[204:207], a[172:175], v[68:71]
 v_mfma_f32_16x16x32_bf16 v[64:67], a[204:207], a[164:167], v[64:67]
 v_add_f32 v213, v213, v9
 v_mfma_f32_16x16x32_bf16 v[64:67], a[200:203], a[160:163], v[64:67]
 v_add_f32 v214, v214, v10
 v_mfma_f32_16x16x32_bf16 v[60:63], a[200:203], a[152:155], v[60:63]
 v_mfma_f32_16x16x32_bf16 v[60:63], a[204:207], a[156:159], v[60:63]
 v_add_f32 v215, v215, v11
 v_mfma_f32_16x16x32_bf16 v[56:59], a[204:207], a[148:151], v[56:59]
 v_add_f32 v216, v216, v8
 v_mfma_f32_16x16x32_bf16 v[56:59], a[200:203], a[144:147], v[56:59]
 v_mfma_f32_16x16x32_bf16 v[52:55], a[200:203], a[136:139], v[52:55]
 v_add_f32 v217, v217, v9
 v_mfma_f32_16x16x32_bf16 v[52:55], a[204:207], a[140:143], v[52:55]
 v_add_f32 v218, v218, v10
 v_mfma_f32_16x16x32_bf16 v[48:51], a[204:207], a[132:135], v[48:51]
 v_mfma_f32_16x16x32_bf16 v[48:51], a[200:203], a[128:131], v[48:51]
 v_add_f32 v219, v219, v11
 s_waitcnt vmcnt(8)
 v_mfma_f32_16x16x32_bf16 v[80:83], a[208:211], a[128:131], v[80:83]
 v_add_f32 v220, v220, v8
 v_mfma_f32_16x16x32_bf16 v[80:83], a[212:215], a[132:135], v[80:83]
 global_load_dwordx4 a[204:207], v0, s[70:71] offset:3072 sc1
 v_mfma_f32_16x16x32_bf16 v[84:87], a[212:215], a[140:143], v[84:87]
 v_add_f32 v221, v221, v9
 v_mfma_f32_16x16x32_bf16 v[84:87], a[208:211], a[136:139], v[84:87]
 global_load_dwordx4 a[200:203], v0, s[70:71] offset:2048 sc1
 v_mfma_f32_16x16x32_bf16 v[88:91], a[208:211], a[144:147], v[88:91]
 v_add_f32 v222, v222, v10
 s_add_u32 s70, s70, 8192
 s_addc_u32 s71, s71, 0
 v_mfma_f32_16x16x32_bf16 v[88:91], a[212:215], a[148:151], v[88:91]
 v_add_f32 v223, v223, v11
 v_mfma_f32_16x16x32_bf16 v[92:95], a[212:215], a[156:159], v[92:95]
 v_mfma_f32_16x16x32_bf16 v[92:95], a[208:211], a[152:155], v[92:95]
 v_add_f32 v224, v224, v8
 v_mfma_f32_16x16x32_bf16 v[96:99], a[208:211], a[160:163], v[96:99]
 v_add_f32 v225, v225, v9
 v_mfma_f32_16x16x32_bf16 v[96:99], a[212:215], a[164:167], v[96:99]
 v_mfma_f32_16x16x32_bf16 v[100:103], a[212:215], a[172:175], v[100:103]
 v_add_f32 v226, v226, v10
 v_mfma_f32_16x16x32_bf16 v[100:103], a[208:211], a[168:171], v[100:103]
 v_add_f32 v227, v227, v11
 v_mfma_f32_16x16x32_bf16 v[104:107], a[208:211], a[176:179], v[104:107]
 v_mfma_f32_16x16x32_bf16 v[104:107], a[212:215], a[180:183], v[104:107]
 v_add_f32 v228, v228, v8
 v_mfma_f32_16x16x32_bf16 v[108:111], a[212:215], a[188:191], v[108:111]
 v_add_f32 v229, v229, v9
 v_mfma_f32_16x16x32_bf16 v[108:111], a[208:211], a[184:187], v[108:111]
 s_waitcnt vmcnt(8)
 v_mfma_f32_16x16x32_bf16 a[244:247], a[216:219], a[184:187], a[244:247]
 ds_read_b128 a[184:187], v2 offset:63488
 v_add_f32 v230, v230, v10
 v_mfma_f32_16x16x32_bf16 a[244:247], a[220:223], a[188:191], a[244:247]
 global_load_dwordx4 a[212:215], v0, s[70:71] offset:-3072 sc1
 ds_read_b128 a[188:191], v2 offset:64512
 v_mfma_f32_16x16x32_bf16 a[240:243], a[220:223], a[180:183], a[240:243]
 ds_read_b128 a[180:183], v2 offset:60416
 v_add_f32 v231, v231, v11
 v_mfma_f32_16x16x32_bf16 a[240:243], a[216:219], a[176:179], a[240:243]
 global_load_dwordx4 a[208:211], v0, s[70:71] offset:-4096 sc1
 ds_read_b128 a[176:179], v2 offset:59392
 s_waitcnt lgkmcnt(4)
 v_mfma_f32_16x16x32_bf16 v[132:135], a[216:219], a[168:171], v[132:135]
 ds_read_b128 a[168:171], v2 offset:55296
 v_mfma_f32_16x16x32_bf16 v[132:135], a[220:223], a[172:175], v[132:135]
 ds_read_b128 a[172:175], v2 offset:56320
 v_add_f32 v232, v232, v12
 v_mfma_f32_16x16x32_bf16 v[128:131], a[220:223], a[164:167], v[128:131]
 ds_read_b128 a[164:167], v2 offset:52224
 v_add_f32 v233, v233, v13
 v_mfma_f32_16x16x32_bf16 v[128:131], a[216:219], a[160:163], v[128:131]
 ds_read_b128 a[160:163], v2 offset:51200
 v_mfma_f32_16x16x32_bf16 v[124:127], a[216:219], a[152:155], v[124:127]
 ds_read_b128 a[152:155], v2 offset:47104
 v_add_f32 v234, v234, v14
 v_mfma_f32_16x16x32_bf16 v[124:127], a[220:223], a[156:159], v[124:127]
 ds_read_b128 a[156:159], v2 offset:48128
 v_add_f32 v235, v235, v15
 v_mfma_f32_16x16x32_bf16 v[120:123], a[220:223], a[148:151], v[120:123]
 ds_read_b128 a[148:151], v2 offset:44032
 v_mfma_f32_16x16x32_bf16 v[120:123], a[216:219], a[144:147], v[120:123]
 ds_read_b128 a[144:147], v2 offset:43008
 v_add_f32 v236, v236, v12
 v_mfma_f32_16x16x32_bf16 v[116:119], a[216:219], a[136:139], v[116:119]
 ds_read_b128 a[136:139], v2 offset:38912
 v_add_f32 v237, v237, v13
 v_mfma_f32_16x16x32_bf16 v[116:119], a[220:223], a[140:143], v[116:119]
 ds_read_b128 a[140:143], v2 offset:39936
 v_mfma_f32_16x16x32_bf16 v[112:115], a[220:223], a[132:135], v[112:115]
 ds_read_b128 a[132:135], v2 offset:35840
 v_add_f32 v238, v238, v14
 v_mfma_f32_16x16x32_bf16 v[112:115], a[216:219], a[128:131], v[112:115]
 ds_read_b128 a[128:131], v2 offset:34816
 s_waitcnt vmcnt(8) lgkmcnt(8)
 v_mfma_f32_16x16x32_bf16 v[44:47], a[224:227], a[184:187], v[44:47]
 v_add_f32 v239, v239, v15
 v_mfma_f32_16x16x32_bf16 v[44:47], a[228:231], a[188:191], v[44:47]
 global_load_dwordx4 a[220:223], v0, s[70:71] offset:-1024 sc1
 v_add_f32 v240, v240, v12
 v_mfma_f32_16x16x32_bf16 v[40:43], a[228:231], a[180:183], v[40:43]
 v_mfma_f32_16x16x32_bf16 v[40:43], a[224:227], a[176:179], v[40:43]
 global_load_dwordx4 a[216:219], v0, s[70:71] offset:-2048 sc1
 v_add_f32 v241, v241, v13
 v_mfma_f32_16x16x32_bf16 v[36:39], a[224:227], a[168:171], v[36:39]
 v_add_f32 v242, v242, v14
 v_mfma_f32_16x16x32_bf16 v[36:39], a[228:231], a[172:175], v[36:39]
 v_mfma_f32_16x16x32_bf16 v[32:35], a[228:231], a[164:167], v[32:35]
 v_add_f32 v243, v243, v15
 v_mfma_f32_16x16x32_bf16 v[32:35], a[224:227], a[160:163], v[32:35]
 v_add_f32 v244, v244, v12
 s_waitcnt lgkmcnt(0)
 v_mfma_f32_16x16x32_bf16 v[28:31], a[224:227], a[152:155], v[28:31]
 v_mfma_f32_16x16x32_bf16 v[28:31], a[228:231], a[156:159], v[28:31]
 v_add_f32 v245, v245, v13
 v_mfma_f32_16x16x32_bf16 v[24:27], a[228:231], a[148:151], v[24:27]
 v_add_f32 v246, v246, v14
 v_mfma_f32_16x16x32_bf16 v[24:27], a[224:227], a[144:147], v[24:27]
 v_mfma_f32_16x16x32_bf16 v[20:23], a[224:227], a[136:139], v[20:23]
 v_add_f32 v247, v247, v15
 v_mfma_f32_16x16x32_bf16 v[20:23], a[228:231], a[140:143], v[20:23]
 v_mfma_f32_16x16x32_bf16 v[16:19], a[228:231], a[132:135], v[16:19]
 v_add_f32 v248, v248, v12
 v_mfma_f32_16x16x32_bf16 v[16:19], a[224:227], a[128:131], v[16:19]
 v_add_f32 v249, v249, v13
 s_waitcnt vmcnt(8)
 v_mfma_f32_16x16x32_bf16 v[48:51], a[232:235], a[128:131], v[48:51]
 v_mfma_f32_16x16x32_bf16 v[48:51], a[236:239], a[132:135], v[48:51]
 global_load_dwordx4 a[228:231], v0, s[70:71] offset:1024 sc1
 v_add_f32 v250, v250, v14
 v_mfma_f32_16x16x32_bf16 v[52:55], a[236:239], a[140:143], v[52:55]
 v_add_f32 v251, v251, v15
 v_mfma_f32_16x16x32_bf16 v[52:55], a[232:235], a[136:139], v[52:55]
 global_load_dwordx4 a[224:227], v0, s[70:71] offset:0 sc1
 v_mfma_f32_16x16x32_bf16 v[56:59], a[232:235], a[144:147], v[56:59]
 v_add_f32 v252, v252, v12
 v_mfma_f32_16x16x32_bf16 v[56:59], a[236:239], a[148:151], v[56:59]
 v_add_f32 v253, v253, v13
 v_mfma_f32_16x16x32_bf16 v[60:63], a[236:239], a[156:159], v[60:63]
 v_mfma_f32_16x16x32_bf16 v[60:63], a[232:235], a[152:155], v[60:63]
 v_add_f32 v254, v254, v14
 v_mfma_f32_16x16x32_bf16 v[64:67], a[232:235], a[160:163], v[64:67]
 v_add_f32 v255, v255, v15
 v_mfma_f32_16x16x32_bf16 v[64:67], a[236:239], a[164:167], v[64:67]
 v_mfma_f32_16x16x32_bf16 v[68:71], a[236:239], a[172:175], v[68:71]
 v_accvgpr_read_b32 v5, a248
 v_mfma_f32_16x16x32_bf16 v[68:71], a[232:235], a[168:171], v[68:71]
 v_mfma_f32_16x16x32_bf16 v[72:75], a[232:235], a[176:179], v[72:75]
 v_add_f32 v5, v5, v12
 v_mfma_f32_16x16x32_bf16 v[72:75], a[236:239], a[180:183], v[72:75]
 v_accvgpr_write_b32 a248, v5
 v_mfma_f32_16x16x32_bf16 v[76:79], a[236:239], a[188:191], v[76:79]
 v_mfma_f32_16x16x32_bf16 v[76:79], a[232:235], a[184:187], v[76:79]
 v_accvgpr_read_b32 v6, a249
 s_waitcnt vmcnt(8)
 v_mfma_f32_16x16x32_bf16 v[108:111], a[192:195], a[184:187], v[108:111]
 v_add_f32 v6, v6, v13
 v_mfma_f32_16x16x32_bf16 v[108:111], a[196:199], a[188:191], v[108:111]
 global_load_dwordx4 a[236:239], v0, s[70:71] offset:3072 sc1
 v_mfma_f32_16x16x32_bf16 v[104:107], a[196:199], a[180:183], v[104:107]
 v_accvgpr_write_b32 a249, v6
 v_mfma_f32_16x16x32_bf16 v[104:107], a[192:195], a[176:179], v[104:107]
 global_load_dwordx4 a[232:235], v0, s[70:71] offset:2048 sc1
 v_accvgpr_read_b32 v5, a250
 v_mfma_f32_16x16x32_bf16 v[100:103], a[192:195], a[168:171], v[100:103]
 s_add_u32 s70, s70, 8192
 s_addc_u32 s71, s71, 0
 v_mfma_f32_16x16x32_bf16 v[100:103], a[196:199], a[172:175], v[100:103]
 v_add_f32 v5, v5, v14
 v_mfma_f32_16x16x32_bf16 v[96:99], a[196:199], a[164:167], v[96:99]
 v_accvgpr_write_b32 a250, v5
 v_mfma_f32_16x16x32_bf16 v[96:99], a[192:195], a[160:163], v[96:99]
 v_mfma_f32_16x16x32_bf16 v[92:95], a[192:195], a[152:155], v[92:95]
 v_accvgpr_read_b32 v6, a251
 v_mfma_f32_16x16x32_bf16 v[92:95], a[196:199], a[156:159], v[92:95]
 v_mfma_f32_16x16x32_bf16 v[88:91], a[196:199], a[148:151], v[88:91]
 v_add_f32 v6, v6, v15
 v_mfma_f32_16x16x32_bf16 v[88:91], a[192:195], a[144:147], v[88:91]
 v_accvgpr_write_b32 a251, v6
 v_mfma_f32_16x16x32_bf16 v[84:87], a[192:195], a[136:139], v[84:87]
 v_mfma_f32_16x16x32_bf16 v[84:87], a[196:199], a[140:143], v[84:87]
 v_accvgpr_read_b32 v5, a252
 v_mfma_f32_16x16x32_bf16 v[80:83], a[196:199], a[132:135], v[80:83]
 v_add_f32 v5, v5, v12
 v_mfma_f32_16x16x32_bf16 v[80:83], a[192:195], a[128:131], v[80:83]
 s_waitcnt vmcnt(8)
 v_mfma_f32_16x16x32_bf16 v[112:115], a[200:203], a[128:131], v[112:115]
 ds_read_b128 a[128:131], v1 offset:2048
 v_accvgpr_write_b32 a252, v5
 v_mfma_f32_16x16x32_bf16 v[112:115], a[204:207], a[132:135], v[112:115]
 global_load_dwordx4 a[196:199], v0, s[70:71] offset:-3072 sc1
 ds_read_b128 a[132:135], v1 offset:3072
 v_mfma_f32_16x16x32_bf16 v[116:119], a[204:207], a[140:143], v[116:119]
 ds_read_b128 a[140:143], v1 offset:7168
 v_accvgpr_read_b32 v6, a253
 v_mfma_f32_16x16x32_bf16 v[116:119], a[200:203], a[136:139], v[116:119]
 global_load_dwordx4 a[192:195], v0, s[70:71] offset:-4096 sc1
 ds_read_b128 a[136:139], v1 offset:6144
 v_mfma_f32_16x16x32_bf16 v[120:123], a[200:203], a[144:147], v[120:123]
 ds_read_b128 a[144:147], v1 offset:10240
 v_add_f32 v6, v6, v13
 v_mfma_f32_16x16x32_bf16 v[120:123], a[204:207], a[148:151], v[120:123]
 ds_read_b128 a[148:151], v1 offset:11264
 v_accvgpr_write_b32 a253, v6
 v_mfma_f32_16x16x32_bf16 v[124:127], a[204:207], a[156:159], v[124:127]
 ds_read_b128 a[156:159], v1 offset:15360
 v_accvgpr_read_b32 v5, a254
 v_mfma_f32_16x16x32_bf16 v[124:127], a[200:203], a[152:155], v[124:127]
 ds_read_b128 a[152:155], v1 offset:14336
 v_mfma_f32_16x16x32_bf16 v[128:131], a[200:203], a[160:163], v[128:131]
 ds_read_b128 a[160:163], v1 offset:18432
 v_add_f32 v5, v5, v14
 v_mfma_f32_16x16x32_bf16 v[128:131], a[204:207], a[164:167], v[128:131]
 ds_read_b128 a[164:167], v1 offset:19456
 v_accvgpr_write_b32 a254, v5
 v_mfma_f32_16x16x32_bf16 v[132:135], a[204:207], a[172:175], v[132:135]
 ds_read_b128 a[172:175], v1 offset:23552
 v_mfma_f32_16x16x32_bf16 v[132:135], a[200:203], a[168:171], v[132:135]
 ds_read_b128 a[168:171], v1 offset:22528
 v_accvgpr_read_b32 v6, a255
 v_mfma_f32_16x16x32_bf16 a[240:243], a[200:203], a[176:179], a[240:243]
 ds_read_b128 a[176:179], v1 offset:26624
 v_add_f32 v6, v6, v15
 v_mfma_f32_16x16x32_bf16 a[240:243], a[204:207], a[180:183], a[240:243]
 ds_read_b128 a[180:183], v1 offset:27648
 v_accvgpr_write_b32 a255, v6
 v_mfma_f32_16x16x32_bf16 a[244:247], a[204:207], a[188:191], a[244:247]
 global_load_dwordx4 a[204:207], v0, s[70:71] offset:-1024 sc1
 ds_read_b128 a[188:191], v1 offset:31744
 v_mfma_f32_16x16x32_bf16 a[244:247], a[200:203], a[184:187], a[244:247]
 global_load_dwordx4 a[200:203], v0, s[70:71] offset:-2048 sc1
 ds_read_b128 a[184:187], v1 offset:30720
 s_waitcnt vmcnt(10) lgkmcnt(8)
 s_mov_b32 s8, s32
 s_mov_b32 s9, s33
 s_mov_b32 s10, s34
 s_mov_b32 s20, 1024
 s_mov_b32 s21, 1024
 s_mov_b32 s22, 1024
 s_xor_b32 s30, s29, 131072
 s_add_u32 s51, s51, 2048
 s_add_u32 s25, s25, 1
 s_cmp_eq_u32 s25, 6
 s_cbranch_scc1 Llast
 v_mfma_f32_16x16x32_bf16 v[136:139], a[208:211], a[128:131], v[136:139]
 v_accvgpr_read_b32 v5, a0
 v_lshlrev_b32 v6, 16, v5
 v_mfma_f32_16x16x32_bf16 v[136:139], a[212:215], a[132:135], v[136:139]
 v_and_b32 v5, s26, v5
 v_mul_f32 v6, v6, v16
 v_mfma_f32_16x16x32_bf16 v[140:143], a[212:215], a[140:143], v[140:143]
 v_mul_f32 v5, v5, v17
 v_cvt_pk_bf16_f32 v8, v6, v5
 v_mfma_f32_16x16x32_bf16 v[140:143], a[208:211], a[136:139], v[140:143]
 v_accvgpr_read_b32 v5, a1
 v_mfma_f32_16x16x32_bf16 v[144:147], a[208:211], a[144:147], v[144:147]
 v_lshlrev_b32 v6, 16, v5
 v_and_b32 v5, s26, v5
 v_mfma_f32_16x16x32_bf16 v[144:147], a[212:215], a[148:151], v[144:147]
 v_mul_f32 v6, v6, v18
 v_mul_f32 v5, v5, v19
 v_mfma_f32_16x16x32_bf16 v[148:151], a[212:215], a[156:159], v[148:151]
 v_cvt_pk_bf16_f32 v9, v6, v5
 v_accvgpr_read_b32 v5, a2
 v_mfma_f32_16x16x32_bf16 v[148:151], a[208:211], a[152:155], v[148:151]
 v_lshlrev_b32 v6, 16, v5
 v_and_b32 v5, s26, v5
 s_waitcnt lgkmcnt(0)
 v_mfma_f32_16x16x32_bf16 v[152:155], a[208:211], a[160:163], v[152:155]
 v_mul_f32 v6, v6, v48
 v_mul_f32 v5, v5, v49
 v_mfma_f32_16x16x32_bf16 v[152:155], a[212:215], a[164:167], v[152:155]
 v_cvt_pk_bf16_f32 v10, v6, v5
 v_mfma_f32_16x16x32_bf16 v[156:159], a[212:215], a[172:175], v[156:159]
 v_accvgpr_read_b32 v5, a3
 v_lshlrev_b32 v6, 16, v5
 v_mfma_f32_16x16x32_bf16 v[156:159], a[208:211], a[168:171], v[156:159]
 v_and_b32 v5, s26, v5
 v_mul_f32 v6, v6, v50
 v_mfma_f32_16x16x32_bf16 v[160:163], a[208:211], a[176:179], v[160:163]
 v_mul_f32 v5, v5, v51
 v_cvt_pk_bf16_f32 v11, v6, v5
 v_mfma_f32_16x16x32_bf16 v[160:163], a[212:215], a[180:183], v[160:163]
 ds_write_b128 v3, v[8:11]
 s_add_u32 s68, s29, 0
 v_mfma_f32_16x16x32_bf16 v[164:167], a[212:215], a[188:191], v[164:167]
 buffer_store_dwordx4 v[8:11], v3, s[32:35], s68 offen sc1
 v_accvgpr_read_b32 v5, a32
 v_mfma_f32_16x16x32_bf16 v[164:167], a[208:211], a[184:187], v[164:167]
 v_lshlrev_b32 v6, 16, v5
 v_and_b32 v5, s26, v5
 s_waitcnt vmcnt(9)
 v_mfma_f32_16x16x32_bf16 v[196:199], a[216:219], a[184:187], v[196:199]
 v_mul_f32 v6, v6, v80
 v_mul_f32 v5, v5, v81
 v_mfma_f32_16x16x32_bf16 v[196:199], a[220:223], a[188:191], v[196:199]
 global_load_dwordx4 a[212:215], v0, s[70:71] offset:1024 sc1
 v_cvt_pk_bf16_f32 v12, v6, v5
 v_mfma_f32_16x16x32_bf16 v[192:195], a[220:223], a[180:183], v[192:195]
 v_accvgpr_read_b32 v5, a33
 v_lshlrev_b32 v6, 16, v5
 v_mfma_f32_16x16x32_bf16 v[192:195], a[216:219], a[176:179], v[192:195]
 global_load_dwordx4 a[208:211], v0, s[70:71] offset:0 sc1
 v_and_b32 v5, s26, v5
 v_mfma_f32_16x16x32_bf16 v[188:191], a[216:219], a[168:171], v[188:191]
 v_mul_f32 v6, v6, v82
 v_mul_f32 v5, v5, v83
 v_mfma_f32_16x16x32_bf16 v[188:191], a[220:223], a[172:175], v[188:191]
 v_cvt_pk_bf16_f32 v13, v6, v5
 v_accvgpr_read_b32 v5, a34
 v_mfma_f32_16x16x32_bf16 v[184:187], a[220:223], a[164:167], v[184:187]
 v_lshlrev_b32 v6, 16, v5
 v_and_b32 v5, s26, v5
 v_mfma_f32_16x16x32_bf16 v[184:187], a[216:219], a[160:163], v[184:187]
 v_mul_f32 v6, v6, v112
 v_mul_f32 v5, v5, v113
 v_mfma_f32_16x16x32_bf16 v[180:183], a[216:219], a[152:155], v[180:183]
 v_cvt_pk_bf16_f32 v14, v6, v5
 v_accvgpr_read_b32 v5, a35
 v_mfma_f32_16x16x32_bf16 v[180:183], a[220:223], a[156:159], v[180:183]
 v_lshlrev_b32 v6, 16, v5
 v_and_b32 v5, s26, v5
 v_mfma_f32_16x16x32_bf16 v[176:179], a[220:223], a[148:151], v[176:179]
 v_mul_f32 v6, v6, v114
 v_mul_f32 v5, v5, v115
 v_mfma_f32_16x16x32_bf16 v[176:179], a[216:219], a[144:147], v[176:179]
 v_cvt_pk_bf16_f32 v15, v6, v5
 v_mfma_f32_16x16x32_bf16 v[172:175], a[216:219], a[136:139], v[172:175]
 ds_write_b128 v3, v[12:15] offset:1024
 v_mfma_f32_16x16x32_bf16 v[172:175], a[220:223], a[140:143], v[172:175]
 buffer_store_dwordx4 v[12:15], v3, s[32:35], s68 offen offset:1024 sc1
 v_accvgpr_read_b32 v5, a4
 v_lshlrev_b32 v6, 16, v5
 v_and_b32 v5, s26, v5
 v_mul_f32 v6, v6, v20
 v_mfma_f32_16x16x32_bf16 v[168:171], a[220:223], a[132:135], v[168:171]
 v_mul_f32 v5, v5, v21
 v_cvt_pk_bf16_f32 v8, v6, v5
 v_mfma_f32_16x16x32_bf16 v[168:171], a[216:219], a[128:131], v[168:171]
 v_accvgpr_read_b32 v5, a5
 v_lshlrev_b32 v6, 16, v5
 s_waitcnt vmcnt(10)
 v_mfma_f32_16x16x32_bf16 v[200:203], a[224:227], a[128:131], v[200:203]
 v_and_b32 v5, s26, v5
 v_mul_f32 v6, v6, v22
 v_mfma_f32_16x16x32_bf16 v[200:203], a[228:231], a[132:135], v[200:203]
 global_load_dwordx4 a[220:223], v0, s[70:71] offset:3072 sc1
 v_mul_f32 v5, v5, v23
 v_mfma_f32_16x16x32_bf16 v[204:207], a[228:231], a[140:143], v[204:207]
 v_cvt_pk_bf16_f32 v9, v6, v5
 v_accvgpr_read_b32 v5, a6
 v_mfma_f32_16x16x32_bf16 v[204:207], a[224:227], a[136:139], v[204:207]
 global_load_dwordx4 a[216:219], v0, s[70:71] offset:2048 sc1
 v_lshlrev_b32 v6, 16, v5
 v_mfma_f32_16x16x32_bf16 v[208:211], a[224:227], a[144:147], v[208:211]
 v_and_b32 v5, s26, v5
 v_mul_f32 v6, v6, v52
 s_add_u32 s70, s70, 8192
 s_addc_u32 s71, s71, 0
 v_mfma_f32_16x16x32_bf16 v[208:211], a[228:231], a[148:151], v[208:211]
 v_mul_f32 v5, v5, v53
 v_cvt_pk_bf16_f32 v10, v6, v5
 v_mfma_f32_16x16x32_bf16 v[212:215], a[228:231], a[156:159], v[212:215]
 v_accvgpr_read_b32 v5, a7
 v_lshlrev_b32 v6, 16, v5
 v_mfma_f32_16x16x32_bf16 v[212:215], a[224:227], a[152:155], v[212:215]
 v_and_b32 v5, s26, v5
 v_mul_f32 v6, v6, v54
 v_mfma_f32_16x16x32_bf16 v[216:219], a[224:227], a[160:163], v[216:219]
 v_mul_f32 v5, v5, v55
 v_cvt_pk_bf16_f32 v11, v6, v5
 v_mfma_f32_16x16x32_bf16 v[216:219], a[228:231], a[164:167], v[216:219]
 ds_write_b128 v3, v[8:11] offset:4096
 v_mfma_f32_16x16x32_bf16 v[220:223], a[228:231], a[172:175], v[220:223]
 buffer_store_dwordx4 v[8:11], v3, s[32:35], s68 offen offset:2048 sc1
 v_accvgpr_read_b32 v5, a36
 v_lshlrev_b32 v6, 16, v5
 v_and_b32 v5, s26, v5
 v_mul_f32 v6, v6, v84
 v_mfma_f32_16x16x32_bf16 v[220:223], a[224:227], a[168:171], v[220:223]
 v_mul_f32 v5, v5, v85
 v_cvt_pk_bf16_f32 v12, v6, v5
 v_mfma_f32_16x16x32_bf16 v[224:227], a[224:227], a[176:179], v[224:227]
 v_accvgpr_read_b32 v5, a37
 v_lshlrev_b32 v6, 16, v5
 v_mfma_f32_16x16x32_bf16 v[224:227], a[228:231], a[180:183], v[224:227]
 v_and_b32 v5, s26, v5
 v_mul_f32 v6, v6, v86
 v_mfma_f32_16x16x32_bf16 v[228:231], a[228:231], a[188:191], v[228:231]
 v_mul_f32 v5, v5, v87
 v_cvt_pk_bf16_f32 v13, v6, v5
 v_mfma_f32_16x16x32_bf16 v[228:231], a[224:227], a[184:187], v[228:231]
 v_accvgpr_read_b32 v5, a38
 v_lshlrev_b32 v6, 16, v5
 s_waitcnt vmcnt(11)
 v_mfma_f32_16x16x32_bf16 a[252:255], a[232:235], a[184:187], a[252:255]
 ds_read_b128 a[184:187], v1 offset:63488
 v_and_b32 v5, s26, v5
 v_mfma_f32_16x16x32_bf16 a[252:255], a[236:239], a[188:191], a[252:255]
 global_load_dwordx4 a[228:231], v0, s[70:71] offset:-3072 sc1
 ds_read_b128 a[188:191], v1 offset:64512
 v_mfma_f32_16x16x32_bf16 a[248:251], a[236:239], a[180:183], a[248:251]
 ds_read_b128 a[180:183], v1 offset:60416
 v_mul_f32 v6, v6, v116
 v_mfma_f32_16x16x32_bf16 a[248:251], a[232:235], a[176:179], a[248:251]
 global_load_dwordx4 a[224:227], v0, s[70:71] offset:-4096 sc1
 ds_read_b128 a[176:179], v1 offset:59392
 v_mul_f32 v5, v5, v117
 v_mfma_f32_16x16x32_bf16 v[252:255], a[232:235], a[168:171], v[252:255]
 ds_read_b128 a[168:171], v1 offset:55296
 v_cvt_pk_bf16_f32 v14, v6, v5
 v_accvgpr_read_b32 v5, a39
 v_mfma_f32_16x16x32_bf16 v[252:255], a[236:239], a[172:175], v[252:255]
 ds_read_b128 a[172:175], v1 offset:56320
 v_lshlrev_b32 v6, 16, v5
 v_mfma_f32_16x16x32_bf16 v[248:251], a[236:239], a[164:167], v[248:251]
 ds_read_b128 a[164:167], v1 offset:52224
 v_and_b32 v5, s26, v5
 v_mul_f32 v6, v6, v118
 v_mfma_f32_16x16x32_bf16 v[248:251], a[232:235], a[160:163], v[248:251]
 ds_read_b128 a[160:163], v1 offset:51200
 v_mul_f32 v5, v5, v119
 v_cvt_pk_bf16_f32 v15, v6, v5
 v_mfma_f32_16x16x32_bf16 v[244:247], a[232:235], a[152:155], v[244:247]
 ds_read_b128 a[152:155], v1 offset:47104
 ds_write_b128 v3, v[12:15] offset:5120
 v_mfma_f32_16x16x32_bf16 v[244:247], a[236:239], a[156:159], v[244:247]
 buffer_store_dwordx4 v[12:15], v3, s[32:35], s68 offen offset:3072 sc1
 ds_read_b128 a[156:159], v1 offset:48128
 v_accvgpr_read_b32 v5, a8
 v_lshlrev_b32 v6, 16, v5
 v_and_b32 v5, s26, v5
 v_mfma_f32_16x16x32_bf16 v[240:243], a[236:239], a[148:151], v[240:243]
 ds_read_b128 a[148:151], v1 offset:44032
 v_mul_f32 v6, v6, v24
 v_mfma_f32_16x16x32_bf16 v[240:243], a[232:235], a[144:147], v[240:243]
 ds_read_b128 a[144:147], v1 offset:43008
 v_mul_f32 v5, v5, v25
 v_cvt_pk_bf16_f32 v8, v6, v5
 v_mfma_f32_16x16x32_bf16 v[236:239], a[232:235], a[136:139], v[236:239]
 ds_read_b128 a[136:139], v1 offset:38912
 v_accvgpr_read_b32 v5, a9
 v_mfma_f32_16x16x32_bf16 v[236:239], a[236:239], a[140:143], v[236:239]
 ds_read_b128 a[140:143], v1 offset:39936
 v_lshlrev_b32 v6, 16, v5
 v_mfma_f32_16x16x32_bf16 v[232:235], a[236:239], a[132:135], v[232:235]
 ds_read_b128 a[132:135], v1 offset:35840
 v_and_b32 v5, s26, v5
 v_mfma_f32_16x16x32_bf16 v[232:235], a[232:235], a[128:131], v[232:235]
 ds_read_b128 a[128:131], v1 offset:34816
 v_mul_f32 v6, v6, v26
 s_waitcnt vmcnt(12) lgkmcnt(9)
 v_mfma_f32_16x16x32_bf16 v[164:167], a[192:195], a[184:187], v[164:167]
 v_mul_f32 v5, v5, v27
 v_cvt_pk_bf16_f32 v9, v6, v5
 v_mfma_f32_16x16x32_bf16 v[164:167], a[196:199], a[188:191], v[164:167]
 global_load_dwordx4 a[236:239], v0, s[70:71] offset:-1024 sc1
 v_accvgpr_read_b32 v5, a10
 v_mfma_f32_16x16x32_bf16 v[160:163], a[196:199], a[180:183], v[160:163]
 v_lshlrev_b32 v6, 16, v5
 v_and_b32 v5, s26, v5
 v_mfma_f32_16x16x32_bf16 v[160:163], a[192:195], a[176:179], v[160:163]
 global_load_dwordx4 a[232:235], v0, s[70:71] offset:-2048 sc1
 v_mul_f32 v6, v6, v56
 v_mfma_f32_16x16x32_bf16 v[156:159], a[192:195], a[168:171], v[156:159]
 v_mul_f32 v5, v5, v57
 v_cvt_pk_bf16_f32 v10, v6, v5
 v_mfma_f32_16x16x32_bf16 v[156:159], a[196:199], a[172:175], v[156:159]
 v_accvgpr_read_b32 v5, a11
 v_lshlrev_b32 v6, 16, v5
 v_mfma_f32_16x16x32_bf16 v[152:155], a[196:199], a[164:167], v[152:155]
 v_and_b32 v5, s26, v5
 v_mul_f32 v6, v6, v58
 v_mfma_f32_16x16x32_bf16 v[152:155], a[192:195], a[160:163], v[152:155]
 v_mul_f32 v5, v5, v59
 v_cvt_pk_bf16_f32 v11, v6, v5
 s_waitcnt lgkmcnt(0)
 v_mfma_f32_16x16x32_bf16 v[148:151], a[192:195], a[152:155], v[148:151]
 ds_write_b128 v3, v[8:11] offset:8192
 s_add_u32 s68, s29, 4096
 v_mfma_f32_16x16x32_bf16 v[148:151], a[196:199], a[156:159], v[148:151]
 buffer_store_dwordx4 v[8:11], v3, s[32:35], s68 offen sc1
 v_accvgpr_read_b32 v5, a40
 v_lshlrev_b32 v6, 16, v5
 v_and_b32 v5, s26, v5
 v_mul_f32 v6, v6, v88
 v_mfma_f32_16x16x32_bf16 v[144:147], a[196:199], a[148:151], v[144:147]
 v_mul_f32 v5, v5, v89
 v_cvt_pk_bf16_f32 v12, v6, v5
 v_mfma_f32_16x16x32_bf16 v[144:147], a[192:195], a[144:147], v[144:147]
 v_accvgpr_read_b32 v5, a41
 v_lshlrev_b32 v6, 16, v5
 v_mfma_f32_16x16x32_bf16 v[140:143], a[192:195], a[136:139], v[140:143]
 v_and_b32 v5, s26, v5
 v_mul_f32 v6, v6, v90
 v_mfma_f32_16x16x32_bf16 v[140:143], a[196:199], a[140:143], v[140:143]
 v_mul_f32 v5, v5, v91
 v_cvt_pk_bf16_f32 v13, v6, v5
 v_mfma_f32_16x16x32_bf16 v[136:139], a[196:199], a[132:135], v[136:139]
 v_accvgpr_read_b32 v5, a42
 v_lshlrev_b32 v6, 16, v5
 v_mfma_f32_16x16x32_bf16 v[136:139], a[192:195], a[128:131], v[136:139]
 v_and_b32 v5, s26, v5
 v_mul_f32 v6, v6, v120
 s_waitcnt vmcnt(13)
 v_mfma_f32_16x16x32_bf16 v[168:171], a[200:203], a[128:131], v[168:171]
 v_mul_f32 v5, v5, v121
 v_cvt_pk_bf16_f32 v14, v6, v5
 v_mfma_f32_16x16x32_bf16 v[168:171], a[204:207], a[132:135], v[168:171]
 global_load_dwordx4 a[196:199], v0, s[70:71] offset:1024 sc1
 v_accvgpr_read_b32 v5, a43
 v_mfma_f32_16x16x32_bf16 v[172:175], a[204:207], a[140:143], v[172:175]
 v_lshlrev_b32 v6, 16, v5
 v_and_b32 v5, s26, v5
 v_mfma_f32_16x16x32_bf16 v[172:175], a[200:203], a[136:139], v[172:175]
 global_load_dwordx4 a[192:195], v0, s[70:71] offset:0 sc1
 v_mul_f32 v6, v6, v122
 v_mfma_f32_16x16x32_bf16 v[176:179], a[200:203], a[144:147], v[176:179]
 v_mul_f32 v5, v5, v123
 v_cvt_pk_bf16_f32 v15, v6, v5
 v_mfma_f32_16x16x32_bf16 v[176:179], a[204:207], a[148:151], v[176:179]
 ds_write_b128 v3, v[12:15] offset:9216
 v_mfma_f32_16x16x32_bf16 v[180:183], a[204:207], a[156:159], v[180:183]
 v_lshlrev_b32 v4, 2, v3
 v_and_b32 v4, 192, v4
 v_mfma_f32_16x16x32_bf16 v[180:183], a[200:203], a[152:155], v[180:183]
 buffer_load_dword v4, v4, s[44:47], 0 offen sc1
 v_mfma_f32_16x16x32_bf16 v[184:187], a[200:203], a[160:163], v[184:187]
 buffer_store_dwordx4 v[12:15], v3, s[32:35], s68 offen offset:1024 sc1
 v_accvgpr_read_b32 v5, a12
 v_lshlrev_b32 v6, 16, v5
 v_and_b32 v5, s26, v5
 v_mul_f32 v6, v6, v28
 v_mfma_f32_16x16x32_bf16 v[184:187], a[204:207], a[164:167], v[184:187]
 v_mul_f32 v5, v5, v29
 v_cvt_pk_bf16_f32 v8, v6, v5
 v_mfma_f32_16x16x32_bf16 v[188:191], a[204:207], a[172:175], v[188:191]
 v_accvgpr_read_b32 v5, a13
 v_lshlrev_b32 v6, 16, v5
 v_mfma_f32_16x16x32_bf16 v[188:191], a[200:203], a[168:171], v[188:191]
 v_and_b32 v5, s26, v5
 v_mul_f32 v6, v6, v30
 v_mfma_f32_16x16x32_bf16 v[192:195], a[200:203], a[176:179], v[192:195]
 v_mul_f32 v5, v5, v31
 v_cvt_pk_bf16_f32 v9, v6, v5
 v_mfma_f32_16x16x32_bf16 v[192:195], a[204:207], a[180:183], v[192:195]
 v_accvgpr_read_b32 v5, a14
 v_lshlrev_b32 v6, 16, v5
 v_mfma_f32_16x16x32_bf16 v[196:199], a[204:207], a[188:191], v[196:199]
 v_and_b32 v5, s26, v5
 v_mul_f32 v6, v6, v60
 v_mfma_f32_16x16x32_bf16 v[196:199], a[200:203], a[184:187], v[196:199]
 v_mul_f32 v5, v5, v61
 v_cvt_pk_bf16_f32 v10, v6, v5
 s_waitcnt vmcnt(14)
 v_mfma_f32_16x16x32_bf16 v[228:231], a[208:211], a[184:187], v[228:231]
 v_accvgpr_read_b32 v5, a15
 v_lshlrev_b32 v6, 16, v5
 v_mfma_f32_16x16x32_bf16 v[228:231], a[212:215], a[188:191], v[228:231]
 global_load_dwordx4 a[204:207], v0, s[70:71] offset:3072 sc1
 v_and_b32 v5, s26, v5
 v_mfma_f32_16x16x32_bf16 v[224:227], a[212:215], a[180:183], v[224:227]
 v_mul_f32 v6, v6, v62
 v_mul_f32 v5, v5, v63
 v_mfma_f32_16x16x32_bf16 v[224:227], a[208:211], a[176:179], v[224:227]
 global_load_dwordx4 a[200:203], v0, s[70:71] offset:2048 sc1
 v_cvt_pk_bf16_f32 v11, v6, v5
 v_mfma_f32_16x16x32_bf16 v[220:223], a[208:211], a[168:171], v[220:223]
 ds_write_b128 v3, v[8:11] offset:12288
 s_add_u32 s70, s70, 8192
 s_addc_u32 s71, s71, 0
 v_mfma_f32_16x16x32_bf16 v[220:223], a[212:215], a[172:175], v[220:223]
 buffer_store_dwordx4 v[8:11], v3, s[32:35], s68 offen offset:2048 sc1
 v_accvgpr_read_b32 v5, a44
 v_lshlrev_b32 v6, 16, v5
 v_and_b32 v5, s26, v5
 v_mfma_f32_16x16x32_bf16 v[216:219], a[212:215], a[164:167], v[216:219]
 v_mul_f32 v6, v6, v92
 v_mul_f32 v5, v5, v93
 v_mfma_f32_16x16x32_bf16 v[216:219], a[208:211], a[160:163], v[216:219]
 v_cvt_pk_bf16_f32 v12, v6, v5
 v_accvgpr_read_b32 v5, a45
 v_mfma_f32_16x16x32_bf16 v[212:215], a[208:211], a[152:155], v[212:215]
 v_lshlrev_b32 v6, 16, v5
 v_and_b32 v5, s26, v5
 v_mfma_f32_16x16x32_bf16 v[212:215], a[212:215], a[156:159], v[212:215]
 v_mul_f32 v6, v6, v94
 v_mul_f32 v5, v5, v95
 v_mfma_f32_16x16x32_bf16 v[208:211], a[212:215], a[148:151], v[208:211]
 v_cvt_pk_bf16_f32 v13, v6, v5
 v_accvgpr_read_b32 v5, a46
 v_mfma_f32_16x16x32_bf16 v[208:211], a[208:211], a[144:147], v[208:211]
 v_lshlrev_b32 v6, 16, v5
 v_and_b32 v5, s26, v5
 v_mfma_f32_16x16x32_bf16 v[204:207], a[208:211], a[136:139], v[204:207]
 v_mul_f32 v6, v6, v124
 v_mul_f32 v5, v5, v125
 v_mfma_f32_16x16x32_bf16 v[204:207], a[212:215], a[140:143], v[204:207]
 v_cvt_pk_bf16_f32 v14, v6, v5
 v_accvgpr_read_b32 v5, a47
 v_mfma_f32_16x16x32_bf16 v[200:203], a[212:215], a[132:135], v[200:203]
 v_lshlrev_b32 v6, 16, v5
 v_and_b32 v5, s26, v5
 v_mfma_f32_16x16x32_bf16 v[200:203], a[208:211], a[128:131], v[200:203]
 v_mul_f32 v6, v6, v126
 v_mul_f32 v5, v5, v127
 s_waitcnt vmcnt(14)
 v_mfma_f32_16x16x32_bf16 v[232:235], a[216:219], a[128:131], v[232:235]
 ds_read_b128 a[128:131], v2 offset:2048
 v_cvt_pk_bf16_f32 v15, v6, v5
 v_mfma_f32_16x16x32_bf16 v[232:235], a[220:223], a[132:135], v[232:235]
 global_load_dwordx4 a[212:215], v0, s[70:71] offset:-3072 sc1
 ds_read_b128 a[132:135], v2 offset:3072
 v_mfma_f32_16x16x32_bf16 v[236:239], a[220:223], a[140:143], v[236:239]
 ds_read_b128 a[140:143], v2 offset:7168
 ds_write_b128 v3, v[12:15] offset:13312
 v_mfma_f32_16x16x32_bf16 v[236:239], a[216:219], a[136:139], v[236:239]
 global_load_dwordx4 a[208:211], v0, s[70:71] offset:-4096 sc1
 ds_read_b128 a[136:139], v2 offset:6144
 v_mfma_f32_16x16x32_bf16 v[240:243], a[216:219], a[144:147], v[240:243]
 buffer_store_dwordx4 v[12:15], v3, s[32:35], s68 offen offset:3072 sc1
 ds_read_b128 a[144:147], v2 offset:10240
 v_accvgpr_read_b32 v5, a16
 v_lshlrev_b32 v6, 16, v5
 v_and_b32 v5, s26, v5
 v_mfma_f32_16x16x32_bf16 v[240:243], a[220:223], a[148:151], v[240:243]
 ds_read_b128 a[148:151], v2 offset:11264
 v_mul_f32 v6, v6, v32
 v_mfma_f32_16x16x32_bf16 v[244:247], a[220:223], a[156:159], v[244:247]
 ds_read_b128 a[156:159], v2 offset:15360
 v_mul_f32 v5, v5, v33
 v_cvt_pk_bf16_f32 v8, v6, v5
 v_mfma_f32_16x16x32_bf16 v[244:247], a[216:219], a[152:155], v[244:247]
 ds_read_b128 a[152:155], v2 offset:14336
 v_accvgpr_read_b32 v5, a17
 v_lshlrev_b32 v6, 16, v5
 v_mfma_f32_16x16x32_bf16 v[248:251], a[216:219], a[160:163], v[248:251]
 ds_read_b128 a[160:163], v2 offset:18432
 v_and_b32 v5, s26, v5
 v_mul_f32 v6, v6, v34
 v_mfma_f32_16x16x32_bf16 v[248:251], a[220:223], a[164:167], v[248:251]
 ds_read_b128 a[164:167], v2 offset:19456
 v_mul_f32 v5, v5, v35
 v_cvt_pk_bf16_f32 v9, v6, v5
 v_mfma_f32_16x16x32_bf16 v[252:255], a[220:223], a[172:175], v[252:255]
 ds_read_b128 a[172:175], v2 offset:23552
 v_accvgpr_read_b32 v5, a18
 v_mfma_f32_16x16x32_bf16 v[252:255], a[216:219], a[168:171], v[252:255]
 ds_read_b128 a[168:171], v2 offset:22528
 v_lshlrev_b32 v6, 16, v5
 v_mfma_f32_16x16x32_bf16 a[248:251], a[216:219], a[176:179], a[248:251]
 ds_read_b128 a[176:179], v2 offset:26624
 v_and_b32 v5, s26, v5
 v_mfma_f32_16x16x32_bf16 a[248:251], a[220:223], a[180:183], a[248:251]
 ds_read_b128 a[180:183], v2 offset:27648
 v_mul_f32 v6, v6, v64
 v_mfma_f32_16x16x32_bf16 a[252:255], a[220:223], a[188:191], a[252:255]
 ds_read_b128 a[188:191], v2 offset:31744
 v_mul_f32 v5, v5, v65
 v_mfma_f32_16x16x32_bf16 a[252:255], a[216:219], a[184:187], a[252:255]
 ds_read_b128 a[184:187], v2 offset:30720
 v_cvt_pk_bf16_f32 v10, v6, v5
 s_waitcnt vmcnt(14) lgkmcnt(8)
 v_mfma_f32_16x16x32_bf16 v[136:139], a[224:227], a[128:131], v[136:139]
 v_accvgpr_read_b32 v5, a19
 v_lshlrev_b32 v6, 16, v5
 v_mfma_f32_16x16x32_bf16 v[136:139], a[228:231], a[132:135], v[136:139]
 global_load_dwordx4 a[220:223], v0, s[70:71] offset:-1024 sc1
 v_and_b32 v5, s26, v5
 v_mfma_f32_16x16x32_bf16 v[140:143], a[228:231], a[140:143], v[140:143]
 v_mul_f32 v6, v6, v66
 v_mul_f32 v5, v5, v67
 v_mfma_f32_16x16x32_bf16 v[140:143], a[224:227], a[136:139], v[140:143]
 global_load_dwordx4 a[216:219], v0, s[70:71] offset:-2048 sc1
 v_cvt_pk_bf16_f32 v11, v6, v5
 v_mfma_f32_16x16x32_bf16 v[144:147], a[224:227], a[144:147], v[144:147]
 ds_write_b128 v3, v[8:11] offset:16384
 s_add_u32 s68, s29, 8192
 v_mfma_f32_16x16x32_bf16 v[144:147], a[228:231], a[148:151], v[144:147]
 buffer_store_dwordx4 v[8:11], v3, s[32:35], s68 offen sc1
 v_accvgpr_read_b32 v5, a48
 v_lshlrev_b32 v6, 16, v5
 v_and_b32 v5, s26, v5
 v_mul_f32 v6, v6, v96
 v_mfma_f32_16x16x32_bf16 v[148:151], a[228:231], a[156:159], v[148:151]
 v_mul_f32 v5, v5, v97
 v_cvt_pk_bf16_f32 v12, v6, v5
 v_mfma_f32_16x16x32_bf16 v[148:151], a[224:227], a[152:155], v[148:151]
 v_accvgpr_read_b32 v5, a49
 v_lshlrev_b32 v6, 16, v5
 s_waitcnt lgkmcnt(1)
 v_mfma_f32_16x16x32_bf16 v[152:155], a[224:227], a[160:163], v[152:155]
 v_and_b32 v5, s26, v5
 v_mul_f32 v6, v6, v98
 v_mfma_f32_16x16x32_bf16 v[152:155], a[228:231], a[164:167], v[152:155]
 v_mul_f32 v5, v5, v99
 v_cvt_pk_bf16_f32 v13, v6, v5
 v_mfma_f32_16x16x32_bf16 v[156:159], a[228:231], a[172:175], v[156:159]
 v_accvgpr_read_b32 v5, a50
 v_lshlrev_b32 v6, 16, v5
 v_mfma_f32_16x16x32_bf16 v[156:159], a[224:227], a[168:171], v[156:159]
 v_and_b32 v5, s26, v5
 v_mul_f32 v6, v6, v128
 v_mfma_f32_16x16x32_bf16 v[160:163], a[224:227], a[176:179], v[160:163]
 v_mul_f32 v5, v5, v129
 v_cvt_pk_bf16_f32 v14, v6, v5
 v_mfma_f32_16x16x32_bf16 v[160:163], a[228:231], a[180:183], v[160:163]
 v_accvgpr_read_b32 v5, a51
 v_lshlrev_b32 v6, 16, v5
 v_mfma_f32_16x16x32_bf16 v[164:167], a[228:231], a[188:191], v[164:167]
 v_and_b32 v5, s26, v5
 v_mul_f32 v6, v6, v130
 v_mfma_f32_16x16x32_bf16 v[164:167], a[224:227], a[184:187], v[164:167]
 v_mul_f32 v5, v5, v131
 v_cvt_pk_bf16_f32 v15, v6, v5
 s_waitcnt vmcnt(14)
 v_mfma_f32_16x16x32_bf16 v[196:199], a[232:235], a[184:187], v[196:199]
 ds_write_b128 v3, v[12:15] offset:17408
 v_mfma_f32_16x16x32_bf16 v[196:199], a[236:239], a[188:191], v[196:199]
 buffer_store_dwordx4 v[12:15], v3, s[32:35], s68 offen offset:1024 sc1
 global_load_dwordx4 a[228:231], v0, s[70:71] offset:1024 sc1
 v_accvgpr_read_b32 v5, a20
 v_lshlrev_b32 v6, 16, v5
 v_and_b32 v5, s26, v5
 v_mfma_f32_16x16x32_bf16 v[192:195], a[236:239], a[180:183], v[192:195]
 v_mul_f32 v6, v6, v36
 v_mul_f32 v5, v5, v37
 v_mfma_f32_16x16x32_bf16 v[192:195], a[232:235], a[176:179], v[192:195]
 global_load_dwordx4 a[224:227], v0, s[70:71] offset:0 sc1
 v_cvt_pk_bf16_f32 v8, v6, v5
 v_mfma_f32_16x16x32_bf16 v[188:191], a[232:235], a[168:171], v[188:191]
 v_accvgpr_read_b32 v5, a21
 v_lshlrev_b32 v6, 16, v5
 v_mfma_f32_16x16x32_bf16 v[188:191], a[236:239], a[172:175], v[188:191]
 v_and_b32 v5, s26, v5
 v_mul_f32 v6, v6, v38
 v_mfma_f32_16x16x32_bf16 v[184:187], a[236:239], a[164:167], v[184:187]
 v_mul_f32 v5, v5, v39
 v_cvt_pk_bf16_f32 v9, v6, v5
 v_mfma_f32_16x16x32_bf16 v[184:187], a[232:235], a[160:163], v[184:187]
 v_accvgpr_read_b32 v5, a22
 v_lshlrev_b32 v6, 16, v5
 v_mfma_f32_16x16x32_bf16 v[180:183], a[232:235], a[152:155], v[180:183]
 v_and_b32 v5, s26, v5
 v_mul_f32 v6, v6, v68
 v_mfma_f32_16x16x32_bf16 v[180:183], a[236:239], a[156:159], v[180:183]
 v_mul_f32 v5, v5, v69
 v_cvt_pk_bf16_f32 v10, v6, v5
 v_mfma_f32_16x16x32_bf16 v[176:179], a[236:239], a[148:151], v[176:179]
 v_accvgpr_read_b32 v5, a23
 v_lshlrev_b32 v6, 16, v5
 v_mfma_f32_16x16x32_bf16 v[176:179], a[232:235], a[144:147], v[176:179]
 v_and_b32 v5, s26, v5
 v_mul_f32 v6, v6, v70
 v_mfma_f32_16x16x32_bf16 v[172:175], a[232:235], a[136:139], v[172:175]
 v_mul_f32 v5, v5, v71
 v_cvt_pk_bf16_f32 v11, v6, v5
 v_mfma_f32_16x16x32_bf16 v[172:175], a[236:239], a[140:143], v[172:175]
 ds_write_b128 v3, v[8:11] offset:20480
 v_mfma_f32_16x16x32_bf16 v[168:171], a[236:239], a[132:135], v[168:171]
 buffer_store_dwordx4 v[8:11], v3, s[32:35], s68 offen offset:2048 sc1
 v_accvgpr_read_b32 v5, a52
 v_lshlrev_b32 v6, 16, v5
 v_and_b32 v5, s26, v5
 v_mfma_f32_16x16x32_bf16 v[168:171], a[232:235], a[128:131], v[168:171]
 v_mul_f32 v6, v6, v100
 v_mul_f32 v5, v5, v101
 s_waitcnt vmcnt(15)
 v_mfma_f32_16x16x32_bf16 v[200:203], a[192:195], a[128:131], v[200:203]
 v_cvt_pk_bf16_f32 v12, v6, v5
 v_accvgpr_read_b32 v5, a53
 v_mfma_f32_16x16x32_bf16 v[200:203], a[196:199], a[132:135], v[200:203]
 global_load_dwordx4 a[236:239], v0, s[70:71] offset:3072 sc1
 v_lshlrev_b32 v6, 16, v5
 v_mfma_f32_16x16x32_bf16 v[204:207], a[196:199], a[140:143], v[204:207]
 v_and_b32 v5, s26, v5
 s_waitcnt vmcnt(15)
 v_cmp_gt_i32 vcc, s27, v4
 s_and_b64 vcc, exec, vcc
 s_cbranch_vccnz Lspin_w
Lok_w:
 s_add_u32 s27, s27, 64
 v_mfma_f32_16x16x32_bf16 v[204:207], a[192:195], a[136:139], v[204:207]
 global_load_dwordx4 a[232:235], v0, s[70:71] offset:2048 sc1
 v_mul_f32 v6, v6, v102
 v_mfma_f32_16x16x32_bf16 v[208:211], a[192:195], a[144:147], v[208:211]
 v_mul_f32 v5, v5, v103
 v_cvt_pk_bf16_f32 v13, v6, v5
 s_add_u32 s70, s70, 1843200
 s_addc_u32 s71, s71, 0
 v_mfma_f32_16x16x32_bf16 v[208:211], a[196:199], a[148:151], v[208:211]
 v_accvgpr_read_b32 v5, a54
 v_lshlrev_b32 v6, 16, v5
 v_mfma_f32_16x16x32_bf16 v[212:215], a[196:199], a[156:159], v[212:215]
 v_and_b32 v5, s26, v5
 v_mul_f32 v6, v6, v132
 v_mfma_f32_16x16x32_bf16 v[212:215], a[192:195], a[152:155], v[212:215]
 v_mul_f32 v5, v5, v133
 v_cvt_pk_bf16_f32 v14, v6, v5
 v_mfma_f32_16x16x32_bf16 v[216:219], a[192:195], a[160:163], v[216:219]
 v_accvgpr_read_b32 v5, a55
 v_lshlrev_b32 v6, 16, v5
 v_mfma_f32_16x16x32_bf16 v[216:219], a[196:199], a[164:167], v[216:219]
 v_and_b32 v5, s26, v5
 v_mul_f32 v6, v6, v134
 v_mfma_f32_16x16x32_bf16 v[220:223], a[196:199], a[172:175], v[220:223]
 v_mul_f32 v5, v5, v135
 v_cvt_pk_bf16_f32 v15, v6, v5
 v_mfma_f32_16x16x32_bf16 v[220:223], a[192:195], a[168:171], v[220:223]
 ds_write_b128 v3, v[12:15] offset:21504
 v_mfma_f32_16x16x32_bf16 v[224:227], a[192:195], a[176:179], v[224:227]
 buffer_store_dwordx4 v[12:15], v3, s[32:35], s68 offen offset:3072 sc1
 v_accvgpr_read_b32 v5, a24
 v_lshlrev_b32 v6, 16, v5
 v_and_b32 v5, s26, v5
 v_mul_f32 v6, v6, v40
 v_mfma_f32_16x16x32_bf16 v[224:227], a[196:199], a[180:183], v[224:227]
 v_mul_f32 v5, v5, v41
 v_cvt_pk_bf16_f32 v8, v6, v5
 v_mfma_f32_16x16x32_bf16 v[228:231], a[196:199], a[188:191], v[228:231]
 v_accvgpr_read_b32 v5, a25
 v_lshlrev_b32 v6, 16, v5
 v_mfma_f32_16x16x32_bf16 v[228:231], a[192:195], a[184:187], v[228:231]
 v_and_b32 v5, s26, v5
 v_mul_f32 v6, v6, v42
 s_waitcnt vmcnt(14)
 v_mfma_f32_16x16x32_bf16 a[252:255], a[200:203], a[184:187], a[252:255]
 ds_read_b128 a[184:187], v2 offset:63488
 v_mul_f32 v5, v5, v43
 v_mfma_f32_16x16x32_bf16 a[252:255], a[204:207], a[188:191], a[252:255]
 global_load_dwordx4 a[196:199], v0, s[70:71] offset:-3072 sc1
 ds_read_b128 a[188:191], v2 offset:64512
 v_mfma_f32_16x16x32_bf16 a[248:251], a[204:207], a[180:183], a[248:251]
 ds_read_b128 a[180:183], v2 offset:60416
 v_cvt_pk_bf16_f32 v9, v6, v5
 v_mfma_f32_16x16x32_bf16 a[248:251], a[200:203], a[176:179], a[248:251]
 global_load_dwordx4 a[192:195], v0, s[70:71] offset:-4096 sc1
 ds_read_b128 a[176:179], v2 offset:59392
 v_accvgpr_read_b32 v5, a26
 v_lshlrev_b32 v6, 16, v5
 v_mfma_f32_16x16x32_bf16 v[252:255], a[200:203], a[168:171], v[252:255]
 ds_read_b128 a[168:171], v2 offset:55296
 v_and_b32 v5, s26, v5
 v_mfma_f32_16x16x32_bf16 v[252:255], a[204:207], a[172:175], v[252:255]
 ds_read_b128 a[172:175], v2 offset:56320
 v_mul_f32 v6, v6, v72
 v_mfma_f32_16x16x32_bf16 v[248:251], a[204:207], a[164:167], v[248:251]
 ds_read_b128 a[164:167], v2 offset:52224
 v_mul_f32 v5, v5, v73
 v_mfma_f32_16x16x32_bf16 v[248:251], a[200:203], a[160:163], v[248:251]
 ds_read_b128 a[160:163], v2 offset:51200
 v_cvt_pk_bf16_f32 v10, v6, v5
 v_mfma_f32_16x16x32_bf16 v[244:247], a[200:203], a[152:155], v[244:247]
 ds_read_b128 a[152:155], v2 offset:47104
 v_accvgpr_read_b32 v5, a27
 v_mfma_f32_16x16x32_bf16 v[244:247], a[204:207], a[156:159], v[244:247]
 ds_read_b128 a[156:159], v2 offset:48128
 v_lshlrev_b32 v6, 16, v5
 v_mfma_f32_16x16x32_bf16 v[240:243], a[204:207], a[148:151], v[240:243]
 ds_read_b128 a[148:151], v2 offset:44032
 v_and_b32 v5, s26, v5
 v_mfma_f32_16x16x32_bf16 v[240:243], a[200:203], a[144:147], v[240:243]
 ds_read_b128 a[144:147], v2 offset:43008
 v_mul_f32 v6, v6, v74
 v_mfma_f32_16x16x32_bf16 v[236:239], a[200:203], a[136:139], v[236:239]
 ds_read_b128 a[136:139], v2 offset:38912
 v_mul_f32 v5, v5, v75
 v_mfma_f32_16x16x32_bf16 v[236:239], a[204:207], a[140:143], v[236:239]
 ds_read_b128 a[140:143], v2 offset:39936
 v_cvt_pk_bf16_f32 v11, v6, v5
 v_mfma_f32_16x16x32_bf16 v[232:235], a[204:207], a[132:135], v[232:235]
 ds_read_b128 a[132:135], v2 offset:35840
 ds_write_b128 v3, v[8:11] offset:24576
 s_add_u32 s68, s29, 12288
 buffer_store_dwordx4 v[8:11], v3, s[32:35], s68 offen sc1
 v_accvgpr_read_b32 v5, a56
 v_lshlrev_b32 v6, 16, v5
 v_and_b32 v5, s26, v5
 v_mul_f32 v6, v6, v104
 v_mfma_f32_16x16x32_bf16 v[232:235], a[200:203], a[128:131], v[232:235]
 ds_read_b128 a[128:131], v2 offset:34816
 v_mul_f32 v5, v5, v105
 v_cvt_pk_bf16_f32 v12, v6, v5
 s_waitcnt vmcnt(14) lgkmcnt(9)
 v_mfma_f32_16x16x32_bf16 v[164:167], a[208:211], a[184:187], v[164:167]
 v_accvgpr_read_b32 v5, a57
 v_lshlrev_b32 v6, 16, v5
 v_mfma_f32_16x16x32_bf16 v[164:167], a[212:215], a[188:191], v[164:167]
 global_load_dwordx4 a[204:207], v0, s[70:71] offset:-1024 sc1
 v_and_b32 v5, s26, v5
 v_mfma_f32_16x16x32_bf16 v[160:163], a[212:215], a[180:183], v[160:163]
 v_mul_f32 v6, v6, v106
 v_mul_f32 v5, v5, v107
 v_mfma_f32_16x16x32_bf16 v[160:163], a[208:211], a[176:179], v[160:163]
 global_load_dwordx4 a[200:203], v0, s[70:71] offset:-2048 sc1
 v_cvt_pk_bf16_f32 v13, v6, v5
 v_mfma_f32_16x16x32_bf16 v[156:159], a[208:211], a[168:171], v[156:159]
 v_accvgpr_read_b32 v5, a58
 v_accvgpr_read_b32 v7, a240
 v_mfma_f32_16x16x32_bf16 v[156:159], a[212:215], a[172:175], v[156:159]
 v_lshlrev_b32 v6, 16, v5
 v_and_b32 v5, s26, v5
 v_mfma_f32_16x16x32_bf16 v[152:155], a[212:215], a[164:167], v[152:155]
 v_mul_f32 v6, v6, v7
 v_accvgpr_read_b32 v7, a241
 v_mfma_f32_16x16x32_bf16 v[152:155], a[208:211], a[160:163], v[152:155]
 v_mul_f32 v5, v5, v7
 v_cvt_pk_bf16_f32 v14, v6, v5
 s_waitcnt lgkmcnt(0)
 v_mfma_f32_16x16x32_bf16 v[148:151], a[208:211], a[152:155], v[148:151]
 v_accvgpr_read_b32 v5, a59
 v_accvgpr_read_b32 v7, a242
 v_mfma_f32_16x16x32_bf16 v[148:151], a[212:215], a[156:159], v[148:151]
 v_lshlrev_b32 v6, 16, v5
 v_and_b32 v5, s26, v5
 v_mfma_f32_16x16x32_bf16 v[144:147], a[212:215], a[148:151], v[144:147]
 v_mul_f32 v6, v6, v7
 v_accvgpr_read_b32 v7, a243
 v_mfma_f32_16x16x32_bf16 v[144:147], a[208:211], a[144:147], v[144:147]
 v_mul_f32 v5, v5, v7
 v_cvt_pk_bf16_f32 v15, v6, v5
 v_mfma_f32_16x16x32_bf16 v[140:143], a[208:211], a[136:139], v[140:143]
 ds_write_b128 v3, v[12:15] offset:25600
 v_mfma_f32_16x16x32_bf16 v[140:143], a[212:215], a[140:143], v[140:143]
 buffer_store_dwordx4 v[12:15], v3, s[32:35], s68 offen offset:1024 sc1
 v_accvgpr_read_b32 v5, a28
 v_lshlrev_b32 v6, 16, v5
 v_and_b32 v5, s26, v5
 v_mul_f32 v6, v6, v44
 v_mfma_f32_16x16x32_bf16 v[136:139], a[212:215], a[132:135], v[136:139]
 v_mul_f32 v5, v5, v45
 v_cvt_pk_bf16_f32 v8, v6, v5
 v_mfma_f32_16x16x32_bf16 v[136:139], a[208:211], a[128:131], v[136:139]
 v_accvgpr_read_b32 v5, a29
 v_lshlrev_b32 v6, 16, v5
 s_waitcnt vmcnt(14)
 v_mfma_f32_16x16x32_bf16 v[168:171], a[216:219], a[128:131], v[168:171]
 v_and_b32 v5, s26, v5
 v_mul_f32 v6, v6, v46
 v_mfma_f32_16x16x32_bf16 v[168:171], a[220:223], a[132:135], v[168:171]
 global_load_dwordx4 a[212:215], v0, s[70:71] offset:1024 sc1
 v_mul_f32 v5, v5, v47
 v_mfma_f32_16x16x32_bf16 v[172:175], a[220:223], a[140:143], v[172:175]
 v_cvt_pk_bf16_f32 v9, v6, v5
 v_accvgpr_read_b32 v5, a30
 v_mfma_f32_16x16x32_bf16 v[172:175], a[216:219], a[136:139], v[172:175]
 global_load_dwordx4 a[208:211], v0, s[70:71] offset:0 sc1
 v_lshlrev_b32 v6, 16, v5
 v_mfma_f32_16x16x32_bf16 v[176:179], a[216:219], a[144:147], v[176:179]
 v_and_b32 v5, s26, v5
 v_mul_f32 v6, v6, v76
 v_mfma_f32_16x16x32_bf16 v[176:179], a[220:223], a[148:151], v[176:179]
 v_mul_f32 v5, v5, v77
 v_cvt_pk_bf16_f32 v10, v6, v5
 v_mfma_f32_16x16x32_bf16 v[180:183], a[220:223], a[156:159], v[180:183]
 v_accvgpr_read_b32 v5, a31
 v_lshlrev_b32 v6, 16, v5
 v_mfma_f32_16x16x32_bf16 v[180:183], a[216:219], a[152:155], v[180:183]
 v_and_b32 v5, s26, v5
 v_mul_f32 v6, v6, v78
 v_mfma_f32_16x16x32_bf16 v[184:187], a[216:219], a[160:163], v[184:187]
 v_mul_f32 v5, v5, v79
 v_cvt_pk_bf16_f32 v11, v6, v5
 v_mfma_f32_16x16x32_bf16 v[184:187], a[220:223], a[164:167], v[184:187]
 ds_write_b128 v3, v[8:11] offset:28672
 v_mfma_f32_16x16x32_bf16 v[188:191], a[220:223], a[172:175], v[188:191]
 buffer_store_dwordx4 v[8:11], v3, s[32:35], s68 offen offset:2048 sc1
 v_accvgpr_read_b32 v5, a60
 v_lshlrev_b32 v6, 16, v5
 v_and_b32 v5, s26, v5
 v_mul_f32 v6, v6, v108
 v_mfma_f32_16x16x32_bf16 v[188:191], a[216:219], a[168:171], v[188:191]
 v_mul_f32 v5, v5, v109
 v_cvt_pk_bf16_f32 v12, v6, v5
 v_mfma_f32_16x16x32_bf16 v[192:195], a[216:219], a[176:179], v[192:195]
 v_accvgpr_read_b32 v5, a61
 v_lshlrev_b32 v6, 16, v5
 v_mfma_f32_16x16x32_bf16 v[192:195], a[220:223], a[180:183], v[192:195]
 v_and_b32 v5, s26, v5
 v_mul_f32 v6, v6, v110
 v_mfma_f32_16x16x32_bf16 v[196:199], a[220:223], a[188:191], v[196:199]
 v_mul_f32 v5, v5, v111
 v_cvt_pk_bf16_f32 v13, v6, v5
 v_mfma_f32_16x16x32_bf16 v[196:199], a[216:219], a[184:187], v[196:199]
 v_accvgpr_read_b32 v5, a62
 v_accvgpr_read_b32 v7, a244
 s_waitcnt vmcnt(13)
 v_mfma_f32_16x16x32_bf16 v[228:231], a[224:227], a[184:187], v[228:231]
 v_lshlrev_b32 v6, 16, v5
 v_and_b32 v5, s26, v5
 v_mfma_f32_16x16x32_bf16 v[228:231], a[228:231], a[188:191], v[228:231]
 global_load_dwordx4 a[220:223], v0, s[70:71] offset:3072 sc1
 v_mul_f32 v6, v6, v7
 v_mfma_f32_16x16x32_bf16 v[224:227], a[228:231], a[180:183], v[224:227]
 v_accvgpr_read_b32 v7, a245
 v_mul_f32 v5, v5, v7
 v_mfma_f32_16x16x32_bf16 v[224:227], a[224:227], a[176:179], v[224:227]
 global_load_dwordx4 a[216:219], v0, s[70:71] offset:2048 sc1
 v_cvt_pk_bf16_f32 v14, v6, v5
 v_mfma_f32_16x16x32_bf16 v[220:223], a[224:227], a[168:171], v[220:223]
 v_accvgpr_read_b32 v5, a63
 v_accvgpr_read_b32 v7, a246
 s_add_u32 s70, s70, 8192
 s_addc_u32 s71, s71, 0
 v_mfma_f32_16x16x32_bf16 v[220:223], a[228:231], a[172:175], v[220:223]
 v_lshlrev_b32 v6, 16, v5
 v_and_b32 v5, s26, v5
 v_mfma_f32_16x16x32_bf16 v[216:219], a[228:231], a[164:167], v[216:219]
 v_mul_f32 v6, v6, v7
 v_accvgpr_read_b32 v7, a247
 v_mfma_f32_16x16x32_bf16 v[216:219], a[224:227], a[160:163], v[216:219]
 v_mul_f32 v5, v5, v7
 v_cvt_pk_bf16_f32 v15, v6, v5
 v_mfma_f32_16x16x32_bf16 v[212:215], a[224:227], a[152:155], v[212:215]
 ds_write_b128 v3, v[12:15] offset:29696
 v_mfma_f32_16x16x32_bf16 v[212:215], a[228:231], a[156:159], v[212:215]
 buffer_store_dwordx4 v[12:15], v3, s[32:35], s68 offen offset:3072 sc1
 v_mfma_f32_16x16x32_bf16 v[208:211], a[228:231], a[148:151], v[208:211]
 s_waitcnt lgkmcnt(0)
 s_barrier
 v_mfma_f32_16x16x32_bf16 v[208:211], a[224:227], a[144:147], v[208:211]
 v_and_b32 v1, 1023, v3
 v_add_u32 v2, 65536, v1
 v_mfma_f32_16x16x32_bf16 v[204:207], a[224:227], a[136:139], v[204:207]
 v_mfma_f32_16x16x32_bf16 v[204:207], a[228:231], a[140:143], v[204:207]
 v_mfma_f32_16x16x32_bf16 v[200:203], a[228:231], a[132:135], v[200:203]
 v_mfma_f32_16x16x32_bf16 v[200:203], a[224:227], a[128:131], v[200:203]
 s_waitcnt vmcnt(13)
 v_mfma_f32_16x16x32_bf16 v[232:235], a[232:235], a[128:131], v[232:235]
 ds_read_b128 a[128:131], v1
 v_mfma_f32_16x16x32_bf16 v[232:235], a[236:239], a[132:135], v[232:235]
 global_load_dwordx4 a[228:231], v0, s[70:71] offset:-3072 sc1
 ds_read_b128 a[132:135], v1 offset:1024
 v_mfma_f32_16x16x32_bf16 v[236:239], a[236:239], a[140:143], v[236:239]
 ds_read_b128 a[140:143], v1 offset:5120
 v_mfma_f32_16x16x32_bf16 v[236:239], a[232:235], a[136:139], v[236:239]
 global_load_dwordx4 a[224:227], v0, s[70:71] offset:-4096 sc1
 ds_read_b128 a[136:139], v1 offset:4096
 v_mfma_f32_16x16x32_bf16 v[240:243], a[232:235], a[144:147], v[240:243]
 ds_read_b128 a[144:147], v1 offset:8192
 v_mfma_f32_16x16x32_bf16 v[240:243], a[236:239], a[148:151], v[240:243]
 ds_read_b128 a[148:151], v1 offset:9216
 v_mfma_f32_16x16x32_bf16 v[244:247], a[236:239], a[156:159], v[244:247]
 ds_read_b128 a[156:159], v1 offset:13312
 v_mfma_f32_16x16x32_bf16 v[244:247], a[232:235], a[152:155], v[244:247]
 ds_read_b128 a[152:155], v1 offset:12288
 v_mfma_f32_16x16x32_bf16 v[248:251], a[232:235], a[160:163], v[248:251]
 ds_read_b128 a[160:163], v1 offset:16384
 v_mfma_f32_16x16x32_bf16 v[248:251], a[236:239], a[164:167], v[248:251]
 ds_read_b128 a[164:167], v1 offset:17408
 v_mfma_f32_16x16x32_bf16 v[252:255], a[236:239], a[172:175], v[252:255]
 ds_read_b128 a[172:175], v1 offset:21504
 v_mfma_f32_16x16x32_bf16 v[252:255], a[232:235], a[168:171], v[252:255]
 ds_read_b128 a[168:171], v1 offset:20480
 v_mfma_f32_16x16x32_bf16 a[248:251], a[232:235], a[176:179], a[248:251]
 ds_read_b128 a[176:179], v1 offset:24576
 v_mfma_f32_16x16x32_bf16 a[248:251], a[236:239], a[180:183], a[248:251]
 ds_read_b128 a[180:183], v1 offset:25600
 v_mfma_f32_16x16x32_bf16 a[252:255], a[236:239], a[188:191], a[252:255]
 global_load_dwordx4 a[236:239], v0, s[70:71] offset:-1024 sc1
 ds_read_b128 a[188:191], v1 offset:29696
 v_mfma_f32_16x16x32_bf16 a[252:255], a[232:235], a[184:187], a[252:255]
 global_load_dwordx4 a[232:235], v0, s[70:71] offset:-2048 sc1
 ds_read_b128 a[184:187], v1 offset:28672
 s_waitcnt vmcnt(14) lgkmcnt(8)
 v_mfma_f32_16x16x32_bf16 v[16:19], a[192:195], a[128:131], v[16:19]
 v_accvgpr_read_b32 v5, a64
 v_lshlrev_b32 v6, 16, v5
 v_mfma_f32_16x16x32_bf16 v[16:19], a[196:199], a[132:135], v[16:19]
 v_and_b32 v5, s26, v5
 v_mfma_f32_16x16x32_bf16 v[20:23], a[196:199], a[140:143], v[20:23]
 v_mul_f32 v6, v6, v136
 v_mul_f32 v5, v5, v137
 v_mfma_f32_16x16x32_bf16 v[20:23], a[192:195], a[136:139], v[20:23]
 v_cvt_pk_bf16_f32 v8, v6, v5
 v_accvgpr_read_b32 v5, a65
 v_mfma_f32_16x16x32_bf16 v[24:27], a[192:195], a[144:147], v[24:27]
 v_lshlrev_b32 v6, 16, v5
 v_mfma_f32_16x16x32_bf16 v[24:27], a[196:199], a[148:151], v[24:27]
 v_and_b32 v5, s26, v5
 v_mul_f32 v6, v6, v138
 v_mfma_f32_16x16x32_bf16 v[28:31], a[196:199], a[156:159], v[28:31]
 v_mul_f32 v5, v5, v139
 v_cvt_pk_bf16_f32 v9, v6, v5
 v_mfma_f32_16x16x32_bf16 v[28:31], a[192:195], a[152:155], v[28:31]
 v_accvgpr_read_b32 v5, a66
 v_lshlrev_b32 v6, 16, v5
 s_waitcnt lgkmcnt(0)
 v_mfma_f32_16x16x32_bf16 v[32:35], a[192:195], a[160:163], v[32:35]
 v_and_b32 v5, s26, v5
 v_mul_f32 v6, v6, v168
 v_mfma_f32_16x16x32_bf16 v[32:35], a[196:199], a[164:167], v[32:35]
 v_mul_f32 v5, v5, v169
 v_cvt_pk_bf16_f32 v10, v6, v5
 v_mfma_f32_16x16x32_bf16 v[36:39], a[196:199], a[172:175], v[36:39]
 v_accvgpr_read_b32 v5, a67
 v_lshlrev_b32 v6, 16, v5
 v_mfma_f32_16x16x32_bf16 v[36:39], a[192:195], a[168:171], v[36:39]
 v_and_b32 v5, s26, v5
 v_mul_f32 v6, v6, v170
 v_mfma_f32_16x16x32_bf16 v[40:43], a[192:195], a[176:179], v[40:43]
 v_mul_f32 v5, v5, v171
 v_cvt_pk_bf16_f32 v11, v6, v5
 v_mfma_f32_16x16x32_bf16 v[40:43], a[196:199], a[180:183], v[40:43]
 ds_write_b128 v3, v[8:11] offset:2048
 v_mfma_f32_16x16x32_bf16 v[44:47], a[196:199], a[188:191], v[44:47]
 s_add_u32 s68, s29, 16384
 buffer_store_dwordx4 v[8:11], v3, s[32:35], s68 offen sc1
 v_mfma_f32_16x16x32_bf16 v[44:47], a[192:195], a[184:187], v[44:47]
 v_accvgpr_read_b32 v5, a96
 s_waitcnt vmcnt(12)
 v_mfma_f32_16x16x32_bf16 v[76:79], a[200:203], a[184:187], v[76:79]
 v_lshlrev_b32 v6, 16, v5
 v_mfma_f32_16x16x32_bf16 v[76:79], a[204:207], a[188:191], v[76:79]
 global_load_dwordx4 a[196:199], v0, s[70:71] offset:1024 sc1
 v_and_b32 v5, s26, v5
 v_mfma_f32_16x16x32_bf16 v[72:75], a[204:207], a[180:183], v[72:75]
 v_mul_f32 v6, v6, v200
 v_mul_f32 v5, v5, v201
 v_mfma_f32_16x16x32_bf16 v[72:75], a[200:203], a[176:179], v[72:75]
 global_load_dwordx4 a[192:195], v0, s[70:71] offset:0 sc1
 v_cvt_pk_bf16_f32 v12, v6, v5
 v_mfma_f32_16x16x32_bf16 v[68:71], a[200:203], a[168:171], v[68:71]
 v_accvgpr_read_b32 v5, a97
 v_lshlrev_b32 v6, 16, v5
 v_mfma_f32_16x16x32_bf16 v[68:71], a[204:207], a[172:175], v[68:71]
 v_and_b32 v5, s26, v5
 v_mul_f32 v6, v6, v202
 v_mfma_f32_16x16x32_bf16 v[64:67], a[204:207], a[164:167], v[64:67]
 v_mul_f32 v5, v5, v203
 v_cvt_pk_bf16_f32 v13, v6, v5
 v_mfma_f32_16x16x32_bf16 v[64:67], a[200:203], a[160:163], v[64:67]
 v_accvgpr_read_b32 v5, a98
 v_lshlrev_b32 v6, 16, v5
 v_mfma_f32_16x16x32_bf16 v[60:63], a[200:203], a[152:155], v[60:63]
 v_and_b32 v5, s26, v5
 v_mul_f32 v6, v6, v232
 v_mfma_f32_16x16x32_bf16 v[60:63], a[204:207], a[156:159], v[60:63]
 v_mul_f32 v5, v5, v233
 v_cvt_pk_bf16_f32 v14, v6, v5
 v_mfma_f32_16x16x32_bf16 v[56:59], a[204:207], a[148:151], v[56:59]
 v_accvgpr_read_b32 v5, a99
 v_lshlrev_b32 v6, 16, v5
 v_mfma_f32_16x16x32_bf16 v[56:59], a[200:203], a[144:147], v[56:59]
 v_and_b32 v5, s26, v5
 v_mul_f32 v6, v6, v234
 v_mfma_f32_16x16x32_bf16 v[52:55], a[200:203], a[136:139], v[52:55]
 v_mul_f32 v5, v5, v235
 v_cvt_pk_bf16_f32 v15, v6, v5
 v_mfma_f32_16x16x32_bf16 v[52:55], a[204:207], a[140:143], v[52:55]
 ds_write_b128 v3, v[12:15] offset:3072
 v_mfma_f32_16x16x32_bf16 v[48:51], a[204:207], a[132:135], v[48:51]
 buffer_store_dwordx4 v[12:15], v3, s[32:35], s68 offen offset:1024 sc1
 v_mfma_f32_16x16x32_bf16 v[48:51], a[200:203], a[128:131], v[48:51]
 v_accvgpr_read_b32 v5, a68
 v_lshlrev_b32 v6, 16, v5
 s_waitcnt vmcnt(12)
 v_mfma_f32_16x16x32_bf16 v[80:83], a[208:211], a[128:131], v[80:83]
 v_and_b32 v5, s26, v5
 v_mul_f32 v6, v6, v140
 v_mfma_f32_16x16x32_bf16 v[80:83], a[212:215], a[132:135], v[80:83]
 global_load_dwordx4 a[204:207], v0, s[70:71] offset:3072 sc1
 v_mul_f32 v5, v5, v141
 v_mfma_f32_16x16x32_bf16 v[84:87], a[212:215], a[140:143], v[84:87]
 v_cvt_pk_bf16_f32 v8, v6, v5
 v_accvgpr_read_b32 v5, a69
 v_mfma_f32_16x16x32_bf16 v[84:87], a[208:211], a[136:139], v[84:87]
 global_load_dwordx4 a[200:203], v0, s[70:71] offset:2048 sc1
 v_lshlrev_b32 v6, 16, v5
 v_mfma_f32_16x16x32_bf16 v[88:91], a[208:211], a[144:147], v[88:91]
 v_and_b32 v5, s26, v5
 v_mul_f32 v6, v6, v142
 s_add_u32 s70, s70, 8192
 s_addc_u32 s71, s71, 0
 v_mfma_f32_16x16x32_bf16 v[88:91], a[212:215], a[148:151], v[88:91]
 v_mul_f32 v5, v5, v143
 v_cvt_pk_bf16_f32 v9, v6, v5
 v_mfma_f32_16x16x32_bf16 v[92:95], a[212:215], a[156:159], v[92:95]
 v_accvgpr_read_b32 v5, a70
 v_lshlrev_b32 v6, 16, v5
 v_mfma_f32_16x16x32_bf16 v[92:95], a[208:211], a[152:155], v[92:95]
 v_and_b32 v5, s26, v5
 v_mul_f32 v6, v6, v172
 v_mfma_f32_16x16x32_bf16 v[96:99], a[208:211], a[160:163], v[96:99]
 v_mul_f32 v5, v5, v173
 v_cvt_pk_bf16_f32 v10, v6, v5
 v_mfma_f32_16x16x32_bf16 v[96:99], a[212:215], a[164:167], v[96:99]
 v_accvgpr_read_b32 v5, a71
 v_lshlrev_b32 v6, 16, v5
 v_mfma_f32_16x16x32_bf16 v[100:103], a[212:215], a[172:175], v[100:103]
 v_and_b32 v5, s26, v5
 v_mul_f32 v6, v6, v174
 v_mfma_f32_16x16x32_bf16 v[100:103], a[208:211], a[168:171], v[100:103]
 v_mul_f32 v5, v5, v175
 v_cvt_pk_bf16_f32 v11, v6, v5
 v_mfma_f32_16x16x32_bf16 v[104:107], a[208:211], a[176:179], v[104:107]
 ds_write_b128 v3, v[8:11] offset:6144
 v_mfma_f32_16x16x32_bf16 v[104:107], a[212:215], a[180:183], v[104:107]
 buffer_store_dwordx4 v[8:11], v3, s[32:35], s68 offen offset:2048 sc1
 v_accvgpr_read_b32 v5, a100
 v_lshlrev_b32 v6, 16, v5
 v_and_b32 v5, s26, v5
 v_mul_f32 v6, v6, v204
 v_mfma_f32_16x16x32_bf16 v[108:111], a[212:215], a[188:191], v[108:111]
 v_mul_f32 v5, v5, v205
 v_cvt_pk_bf16_f32 v12, v6, v5
 v_mfma_f32_16x16x32_bf16 v[108:111], a[208:211], a[184:187], v[108:111]
 v_accvgpr_read_b32 v5, a101
 v_lshlrev_b32 v6, 16, v5
 s_waitcnt vmcnt(12)
 v_mfma_f32_16x16x32_bf16 a[244:247], a[216:219], a[184:187], a[244:247]
 ds_read_b128 a[184:187], v1 offset:61440
 v_and_b32 v5, s26, v5
 v_mfma_f32_16x16x32_bf16 a[244:247], a[220:223], a[188:191], a[244:247]
 global_load_dwordx4 a[212:215], v0, s[70:71] offset:-3072 sc1
 ds_read_b128 a[188:191], v1 offset:62464
 v_mfma_f32_16x16x32_bf16 a[240:243], a[220:223], a[180:183], a[240:243]
 ds_read_b128 a[180:183], v1 offset:58368
 v_mul_f32 v6, v6, v206
 v_mfma_f32_16x16x32_bf16 a[240:243], a[216:219], a[176:179], a[240:243]
 global_load_dwordx4 a[208:211], v0, s[70:71] offset:-4096 sc1
 ds_read_b128 a[176:179], v1 offset:57344
 v_mfma_f32_16x16x32_bf16 v[132:135], a[216:219], a[168:171], v[132:135]
 ds_read_b128 a[168:171], v1 offset:53248
 v_mul_f32 v5, v5, v207
 v_mfma_f32_16x16x32_bf16 v[132:135], a[220:223], a[172:175], v[132:135]
 ds_read_b128 a[172:175], v1 offset:54272
 v_cvt_pk_bf16_f32 v13, v6, v5
 v_mfma_f32_16x16x32_bf16 v[128:131], a[220:223], a[164:167], v[128:131]
 ds_read_b128 a[164:167], v1 offset:50176
 v_accvgpr_read_b32 v5, a102
 v_lshlrev_b32 v6, 16, v5
 v_mfma_f32_16x16x32_bf16 v[128:131], a[216:219], a[160:163], v[128:131]
 ds_read_b128 a[160:163], v1 offset:49152
 v_and_b32 v5, s26, v5
 v_mul_f32 v6, v6, v236
 v_mfma_f32_16x16x32_bf16 v[124:127], a[216:219], a[152:155], v[124:127]
 ds_read_b128 a[152:155], v1 offset:45056
 v_mul_f32 v5, v5, v237
 v_mfma_f32_16x16x32_bf16 v[124:127], a[220:223], a[156:159], v[124:127]
 ds_read_b128 a[156:159], v1 offset:46080
 v_cvt_pk_bf16_f32 v14, v6, v5
 v_mfma_f32_16x16x32_bf16 v[120:123], a[220:223], a[148:151], v[120:123]
 ds_read_b128 a[148:151], v1 offset:41984
 v_accvgpr_read_b32 v5, a103
 v_mfma_f32_16x16x32_bf16 v[120:123], a[216:219], a[144:147], v[120:123]
 ds_read_b128 a[144:147], v1 offset:40960
 v_lshlrev_b32 v6, 16, v5
 v_mfma_f32_16x16x32_bf16 v[116:119], a[216:219], a[136:139], v[116:119]
 ds_read_b128 a[136:139], v1 offset:36864
 v_and_b32 v5, s26, v5
 v_mfma_f32_16x16x32_bf16 v[116:119], a[220:223], a[140:143], v[116:119]
 ds_read_b128 a[140:143], v1 offset:37888
 v_mul_f32 v6, v6, v238
 v_mfma_f32_16x16x32_bf16 v[112:115], a[220:223], a[132:135], v[112:115]
 ds_read_b128 a[132:135], v1 offset:33792
 v_mul_f32 v5, v5, v239
 v_mfma_f32_16x16x32_bf16 v[112:115], a[216:219], a[128:131], v[112:115]
 ds_read_b128 a[128:131], v1 offset:32768
 v_cvt_pk_bf16_f32 v15, v6, v5
 s_waitcnt vmcnt(11) lgkmcnt(8)
 v_mfma_f32_16x16x32_bf16 v[44:47], a[224:227], a[184:187], v[44:47]
 ds_write_b128 v3, v[12:15] offset:7168
 v_mfma_f32_16x16x32_bf16 v[44:47], a[228:231], a[188:191], v[44:47]
 buffer_store_dwordx4 v[12:15], v3, s[32:35], s68 offen offset:3072 sc1
 global_load_dwordx4 a[220:223], v0, s[70:71] offset:-1024 sc1
 v_accvgpr_read_b32 v5, a72
 v_lshlrev_b32 v6, 16, v5
 v_and_b32 v5, s26, v5
 v_mfma_f32_16x16x32_bf16 v[40:43], a[228:231], a[180:183], v[40:43]
 v_mul_f32 v6, v6, v144
 v_mul_f32 v5, v5, v145
 v_mfma_f32_16x16x32_bf16 v[40:43], a[224:227], a[176:179], v[40:43]
 global_load_dwordx4 a[216:219], v0, s[70:71] offset:-2048 sc1
 v_cvt_pk_bf16_f32 v8, v6, v5
 v_mfma_f32_16x16x32_bf16 v[36:39], a[224:227], a[168:171], v[36:39]
 v_accvgpr_read_b32 v5, a73
 v_lshlrev_b32 v6, 16, v5
 v_mfma_f32_16x16x32_bf16 v[36:39], a[228:231], a[172:175], v[36:39]
 v_and_b32 v5, s26, v5
 v_mul_f32 v6, v6, v146
 v_mfma_f32_16x16x32_bf16 v[32:35], a[228:231], a[164:167], v[32:35]
 v_mul_f32 v5, v5, v147
 v_cvt_pk_bf16_f32 v9, v6, v5
 v_mfma_f32_16x16x32_bf16 v[32:35], a[224:227], a[160:163], v[32:35]
 v_accvgpr_read_b32 v5, a74
 v_lshlrev_b32 v6, 16, v5
 s_waitcnt lgkmcnt(1)
 v_mfma_f32_16x16x32_bf16 v[28:31], a[224:227], a[152:155], v[28:31]
 v_and_b32 v5, s26, v5
 v_mul_f32 v6, v6, v176
 v_mfma_f32_16x16x32_bf16 v[28:31], a[228:231], a[156:159], v[28:31]
 v_mul_f32 v5, v5, v177
 v_cvt_pk_bf16_f32 v10, v6, v5
 v_mfma_f32_16x16x32_bf16 v[24:27], a[228:231], a[148:151], v[24:27]
 v_accvgpr_read_b32 v5, a75
 v_lshlrev_b32 v6, 16, v5
 v_mfma_f32_16x16x32_bf16 v[24:27], a[224:227], a[144:147], v[24:27]
 v_and_b32 v5, s26, v5
 v_mul_f32 v6, v6, v178
 v_mfma_f32_16x16x32_bf16 v[20:23], a[224:227], a[136:139], v[20:23]
 v_mul_f32 v5, v5, v179
 v_cvt_pk_bf16_f32 v11, v6, v5
 v_mfma_f32_16x16x32_bf16 v[20:23], a[228:231], a[140:143], v[20:23]
 ds_write_b128 v3, v[8:11] offset:10240
 s_add_u32 s68, s29, 20480
 v_mfma_f32_16x16x32_bf16 v[16:19], a[228:231], a[132:135], v[16:19]
 buffer_store_dwordx4 v[8:11], v3, s[32:35], s68 offen sc1
 v_accvgpr_read_b32 v5, a104
 v_lshlrev_b32 v6, 16, v5
 v_mfma_f32_16x16x32_bf16 v[16:19], a[224:227], a[128:131], v[16:19]
 v_and_b32 v5, s26, v5
 v_mul_f32 v6, v6, v208
 s_waitcnt vmcnt(13)
 v_mfma_f32_16x16x32_bf16 v[48:51], a[232:235], a[128:131], v[48:51]
 v_mul_f32 v5, v5, v209
 v_cvt_pk_bf16_f32 v12, v6, v5
 v_mfma_f32_16x16x32_bf16 v[48:51], a[236:239], a[132:135], v[48:51]
 global_load_dwordx4 a[228:231], v0, s[70:71] offset:1024 sc1
 v_accvgpr_read_b32 v5, a105
 v_mfma_f32_16x16x32_bf16 v[52:55], a[236:239], a[140:143], v[52:55]
 v_lshlrev_b32 v6, 16, v5
 v_and_b32 v5, s26, v5
 v_mfma_f32_16x16x32_bf16 v[52:55], a[232:235], a[136:139], v[52:55]
 global_load_dwordx4 a[224:227], v0, s[70:71] offset:0 sc1
 v_mul_f32 v6, v6, v210
 v_mfma_f32_16x16x32_bf16 v[56:59], a[232:235], a[144:147], v[56:59]
 v_mul_f32 v5, v5, v211
 v_cvt_pk_bf16_f32 v13, v6, v5
 v_mfma_f32_16x16x32_bf16 v[56:59], a[236:239], a[148:151], v[56:59]
 v_accvgpr_read_b32 v5, a106
 v_lshlrev_b32 v6, 16, v5
 v_mfma_f32_16x16x32_bf16 v[60:63], a[236:239], a[156:159], v[60:63]
 v_and_b32 v5, s26, v5
 v_mfma_f32_16x16x32_bf16 v[60:63], a[232:235], a[152:155], v[60:63]
 v_mul_f32 v6, v6, v240
 v_mul_f32 v5, v5, v241
 v_mfma_f32_16x16x32_bf16 v[64:67], a[232:235], a[160:163], v[64:67]
 v_cvt_pk_bf16_f32 v14, v6, v5
 v_accvgpr_read_b32 v5, a107
 v_mfma_f32_16x16x32_bf16 v[64:67], a[236:239], a[164:167], v[64:67]
 v_lshlrev_b32 v6, 16, v5
 v_mfma_f32_16x16x32_bf16 v[68:71], a[236:239], a[172:175], v[68:71]
 v_and_b32 v5, s26, v5
 v_mul_f32 v6, v6, v242
 v_mfma_f32_16x16x32_bf16 v[68:71], a[232:235], a[168:171], v[68:71]
 v_mul_f32 v5, v5, v243
 v_cvt_pk_bf16_f32 v15, v6, v5
 v_mfma_f32_16x16x32_bf16 v[72:75], a[232:235], a[176:179], v[72:75]
 ds_write_b128 v3, v[12:15] offset:11264
 v_mfma_f32_16x16x32_bf16 v[72:75], a[236:239], a[180:183], v[72:75]
 buffer_store_dwordx4 v[12:15], v3, s[32:35], s68 offen offset:1024 sc1
 v_accvgpr_read_b32 v5, a76
 v_lshlrev_b32 v6, 16, v5
 v_mfma_f32_16x16x32_bf16 v[76:79], a[236:239], a[188:191], v[76:79]
 v_and_b32 v5, s26, v5
 v_mul_f32 v6, v6, v148
 v_mfma_f32_16x16x32_bf16 v[76:79], a[232:235], a[184:187], v[76:79]
 v_mul_f32 v5, v5, v149
 v_cvt_pk_bf16_f32 v8, v6, v5
 s_waitcnt vmcnt(13)
 v_mfma_f32_16x16x32_bf16 v[108:111], a[192:195], a[184:187], v[108:111]
 v_accvgpr_read_b32 v5, a77
 v_lshlrev_b32 v6, 16, v5
 v_mfma_f32_16x16x32_bf16 v[108:111], a[196:199], a[188:191], v[108:111]
 global_load_dwordx4 a[236:239], v0, s[70:71] offset:3072 sc1
 v_and_b32 v5, s26, v5
 v_mfma_f32_16x16x32_bf16 v[104:107], a[196:199], a[180:183], v[104:107]
 v_mul_f32 v6, v6, v150
 v_mul_f32 v5, v5, v151
 v_mfma_f32_16x16x32_bf16 v[104:107], a[192:195], a[176:179], v[104:107]
 global_load_dwordx4 a[232:235], v0, s[70:71] offset:2048 sc1
 v_cvt_pk_bf16_f32 v9, v6, v5
 v_mfma_f32_16x16x32_bf16 v[100:103], a[192:195], a[168:171], v[100:103]
 v_accvgpr_read_b32 v5, a78
 v_lshlrev_b32 v6, 16, v5
 s_add_u32 s70, s70, 8192
 s_addc_u32 s71, s71, 0
 v_mfma_f32_16x16x32_bf16 v[100:103], a[196:199], a[172:175], v[100:103]
 v_and_b32 v5, s26, v5
 v_mul_f32 v6, v6, v180
 v_mfma_f32_16x16x32_bf16 v[96:99], a[196:199], a[164:167], v[96:99]
 v_mul_f32 v5, v5, v181
 v_cvt_pk_bf16_f32 v10, v6, v5
 v_mfma_f32_16x16x32_bf16 v[96:99], a[192:195], a[160:163], v[96:99]
 v_accvgpr_read_b32 v5, a79
 v_lshlrev_b32 v6, 16, v5
 v_mfma_f32_16x16x32_bf16 v[92:95], a[192:195], a[152:155], v[92:95]
 v_and_b32 v5, s26, v5
 v_mul_f32 v6, v6, v182
 v_mfma_f32_16x16x32_bf16 v[92:95], a[196:199], a[156:159], v[92:95]
 v_mul_f32 v5, v5, v183
 v_cvt_pk_bf16_f32 v11, v6, v5
 v_mfma_f32_16x16x32_bf16 v[88:91], a[196:199], a[148:151], v[88:91]
 ds_write_b128 v3, v[8:11] offset:14336
 v_mfma_f32_16x16x32_bf16 v[88:91], a[192:195], a[144:147], v[88:91]
 buffer_store_dwordx4 v[8:11], v3, s[32:35], s68 offen offset:2048 sc1
 v_accvgpr_read_b32 v5, a108
 v_lshlrev_b32 v6, 16, v5
 v_and_b32 v5, s26, v5
 v_mul_f32 v6, v6, v212
 v_mfma_f32_16x16x32_bf16 v[84:87], a[192:195], a[136:139], v[84:87]
 v_mul_f32 v5, v5, v213
 v_cvt_pk_bf16_f32 v12, v6, v5
 v_mfma_f32_16x16x32_bf16 v[84:87], a[196:199], a[140:143], v[84:87]
 v_accvgpr_read_b32 v5, a109
 v_lshlrev_b32 v6, 16, v5
 v_mfma_f32_16x16x32_bf16 v[80:83], a[196:199], a[132:135], v[80:83]
 v_and_b32 v5, s26, v5
 v_mul_f32 v6, v6, v214
 v_mfma_f32_16x16x32_bf16 v[80:83], a[192:195], a[128:131], v[80:83]
 v_mul_f32 v5, v5, v215
 v_cvt_pk_bf16_f32 v13, v6, v5
 s_waitcnt vmcnt(13)
 v_mfma_f32_16x16x32_bf16 v[112:115], a[200:203], a[128:131], v[112:115]
 ds_read_b128 a[128:131], v2
 v_accvgpr_read_b32 v5, a110
 v_mfma_f32_16x16x32_bf16 v[112:115], a[204:207], a[132:135], v[112:115]
 global_load_dwordx4 a[196:199], v0, s[70:71] offset:-3072 sc1
 ds_read_b128 a[132:135], v2 offset:1024
 v_mfma_f32_16x16x32_bf16 v[116:119], a[204:207], a[140:143], v[116:119]
 ds_read_b128 a[140:143], v2 offset:5120
 v_lshlrev_b32 v6, 16, v5
 v_mfma_f32_16x16x32_bf16 v[116:119], a[200:203], a[136:139], v[116:119]
 global_load_dwordx4 a[192:195], v0, s[70:71] offset:-4096 sc1
 ds_read_b128 a[136:139], v2 offset:4096
 v_mfma_f32_16x16x32_bf16 v[120:123], a[200:203], a[144:147], v[120:123]
 ds_read_b128 a[144:147], v2 offset:8192
 v_and_b32 v5, s26, v5
 v_mfma_f32_16x16x32_bf16 v[120:123], a[204:207], a[148:151], v[120:123]
 ds_read_b128 a[148:151], v2 offset:9216
 v_mul_f32 v6, v6, v244
 v_mfma_f32_16x16x32_bf16 v[124:127], a[204:207], a[156:159], v[124:127]
 ds_read_b128 a[156:159], v2 offset:13312
 v_mul_f32 v5, v5, v245
 v_cvt_pk_bf16_f32 v14, v6, v5
 v_mfma_f32_16x16x32_bf16 v[124:127], a[200:203], a[152:155], v[124:127]
 ds_read_b128 a[152:155], v2 offset:12288
 v_accvgpr_read_b32 v5, a111
 v_mfma_f32_16x16x32_bf16 v[128:131], a[200:203], a[160:163], v[128:131]
 ds_read_b128 a[160:163], v2 offset:16384
 v_lshlrev_b32 v6, 16, v5
 v_mfma_f32_16x16x32_bf16 v[128:131], a[204:207], a[164:167], v[128:131]
 ds_read_b128 a[164:167], v2 offset:17408
 v_and_b32 v5, s26, v5
 v_mfma_f32_16x16x32_bf16 v[132:135], a[204:207], a[172:175], v[132:135]
 ds_read_b128 a[172:175], v2 offset:21504
 v_mul_f32 v6, v6, v246
 v_mfma_f32_16x16x32_bf16 v[132:135], a[200:203], a[168:171], v[132:135]
 ds_read_b128 a[168:171], v2 offset:20480
 v_mul_f32 v5, v5, v247
 v_mfma_f32_16x16x32_bf16 a[240:243], a[200:203], a[176:179], a[240:243]
 ds_read_b128 a[176:179], v2 offset:24576
 v_cvt_pk_bf16_f32 v15, v6, v5
 v_mfma_f32_16x16x32_bf16 a[240:243], a[204:207], a[180:183], a[240:243]
 ds_read_b128 a[180:183], v2 offset:25600
 ds_write_b128 v3, v[12:15] offset:15360
 s_add_u32 s31, s31, 1
 v_mov_b32 v7, s31
 v_mfma_f32_16x16x32_bf16 a[244:247], a[204:207], a[188:191], a[244:247]
 buffer_store_dword v7, v1, s[60:63], 0 offen sc1
 ds_read_b128 a[188:191], v2 offset:29696
 v_mfma_f32_16x16x32_bf16 a[244:247], a[200:203], a[184:187], a[244:247]
 buffer_store_dwordx4 v[12:15], v3, s[32:35], s68 offen offset:3072 sc1
 ds_read_b128 a[184:187], v2 offset:28672
 v_accvgpr_read_b32 v5, a80
 v_lshlrev_b32 v6, 16, v5
 v_and_b32 v5, s26, v5
 s_waitcnt vmcnt(14) lgkmcnt(9)
 v_mfma_f32_16x16x32_bf16 v[16:19], a[208:211], a[128:131], v[16:19]
 v_mul_f32 v6, v6, v152
 v_mul_f32 v5, v5, v153
 v_mfma_f32_16x16x32_bf16 v[16:19], a[212:215], a[132:135], v[16:19]
 global_load_dwordx4 a[204:207], v0, s[70:71] offset:-1024 sc1
 v_cvt_pk_bf16_f32 v8, v6, v5
 v_mfma_f32_16x16x32_bf16 v[20:23], a[212:215], a[140:143], v[20:23]
 v_accvgpr_read_b32 v5, a81
 v_lshlrev_b32 v6, 16, v5
 v_mfma_f32_16x16x32_bf16 v[20:23], a[208:211], a[136:139], v[20:23]
 global_load_dwordx4 a[200:203], v0, s[70:71] offset:-2048 sc1
 v_and_b32 v5, s26, v5
 v_mfma_f32_16x16x32_bf16 v[24:27], a[208:211], a[144:147], v[24:27]
 v_mul_f32 v6, v6, v154
 v_mul_f32 v5, v5, v155
 v_mfma_f32_16x16x32_bf16 v[24:27], a[212:215], a[148:151], v[24:27]
 v_cvt_pk_bf16_f32 v9, v6, v5
 v_accvgpr_read_b32 v5, a82
 v_mfma_f32_16x16x32_bf16 v[28:31], a[212:215], a[156:159], v[28:31]
 v_lshlrev_b32 v6, 16, v5
 v_and_b32 v5, s26, v5
 v_mfma_f32_16x16x32_bf16 v[28:31], a[208:211], a[152:155], v[28:31]
 v_mul_f32 v6, v6, v184
 s_waitcnt lgkmcnt(0)
 v_mfma_f32_16x16x32_bf16 v[32:35], a[208:211], a[160:163], v[32:35]
 v_mul_f32 v5, v5, v185
 v_cvt_pk_bf16_f32 v10, v6, v5
 v_mfma_f32_16x16x32_bf16 v[32:35], a[212:215], a[164:167], v[32:35]
 v_accvgpr_read_b32 v5, a83
 v_lshlrev_b32 v6, 16, v5
 v_mfma_f32_16x16x32_bf16 v[36:39], a[212:215], a[172:175], v[36:39]
 v_and_b32 v5, s26, v5
 v_mul_f32 v6, v6, v186
 v_mfma_f32_16x16x32_bf16 v[36:39], a[208:211], a[168:171], v[36:39]
 v_mul_f32 v5, v5, v187
 v_cvt_pk_bf16_f32 v11, v6, v5
 v_mfma_f32_16x16x32_bf16 v[40:43], a[208:211], a[176:179], v[40:43]
 ds_write_b128 v3, v[8:11] offset:18432
 v_mfma_f32_16x16x32_bf16 v[40:43], a[212:215], a[180:183], v[40:43]
 s_add_u32 s68, s29, 24576
 buffer_store_dwordx4 v[8:11], v3, s[32:35], s68 offen sc1
 v_mfma_f32_16x16x32_bf16 v[44:47], a[212:215], a[188:191], v[44:47]
 v_accvgpr_read_b32 v5, a112
 v_mfma_f32_16x16x32_bf16 v[44:47], a[208:211], a[184:187], v[44:47]
 v_lshlrev_b32 v6, 16, v5
 v_and_b32 v5, s26, v5
 s_waitcnt vmcnt(14)
 v_mfma_f32_16x16x32_bf16 v[76:79], a[216:219], a[184:187], v[76:79]
 v_mul_f32 v6, v6, v216
 v_mul_f32 v5, v5, v217
 v_mfma_f32_16x16x32_bf16 v[76:79], a[220:223], a[188:191], v[76:79]
 global_load_dwordx4 a[212:215], v0, s[70:71] offset:1024 sc1
 v_cvt_pk_bf16_f32 v12, v6, v5
 v_mfma_f32_16x16x32_bf16 v[72:75], a[220:223], a[180:183], v[72:75]
 v_accvgpr_read_b32 v5, a113
 v_lshlrev_b32 v6, 16, v5
 v_mfma_f32_16x16x32_bf16 v[72:75], a[216:219], a[176:179], v[72:75]
 global_load_dwordx4 a[208:211], v0, s[70:71] offset:0 sc1
 v_and_b32 v5, s26, v5
 v_mfma_f32_16x16x32_bf16 v[68:71], a[216:219], a[168:171], v[68:71]
 v_mul_f32 v6, v6, v218
 v_mul_f32 v5, v5, v219
 v_mfma_f32_16x16x32_bf16 v[68:71], a[220:223], a[172:175], v[68:71]
 v_cvt_pk_bf16_f32 v13, v6, v5
 v_accvgpr_read_b32 v5, a114
 v_mfma_f32_16x16x32_bf16 v[64:67], a[220:223], a[164:167], v[64:67]
 v_lshlrev_b32 v6, 16, v5
 v_and_b32 v5, s26, v5
 v_mfma_f32_16x16x32_bf16 v[64:67], a[216:219], a[160:163], v[64:67]
 v_mul_f32 v6, v6, v248
 v_mul_f32 v5, v5, v249
 v_mfma_f32_16x16x32_bf16 v[60:63], a[216:219], a[152:155], v[60:63]
 v_cvt_pk_bf16_f32 v14, v6, v5
 v_mfma_f32_16x16x32_bf16 v[60:63], a[220:223], a[156:159], v[60:63]
 v_accvgpr_read_b32 v5, a115
 v_lshlrev_b32 v6, 16, v5
 v_mfma_f32_16x16x32_bf16 v[56:59], a[220:223], a[148:151], v[56:59]
 v_and_b32 v5, s26, v5
 v_mul_f32 v6, v6, v250
 v_mfma_f32_16x16x32_bf16 v[56:59], a[216:219], a[144:147], v[56:59]
 v_mul_f32 v5, v5, v251
 v_cvt_pk_bf16_f32 v15, v6, v5
 v_mfma_f32_16x16x32_bf16 v[52:55], a[216:219], a[136:139], v[52:55]
 ds_write_b128 v3, v[12:15] offset:19456
 v_mfma_f32_16x16x32_bf16 v[52:55], a[220:223], a[140:143], v[52:55]
 buffer_store_dwordx4 v[12:15], v3, s[32:35], s68 offen offset:1024 sc1
 v_accvgpr_read_b32 v5, a84
 v_mfma_f32_16x16x32_bf16 v[48:51], a[220:223], a[132:135], v[48:51]
 v_lshlrev_b32 v6, 16, v5
 v_mfma_f32_16x16x32_bf16 v[48:51], a[216:219], a[128:131], v[48:51]
 v_and_b32 v5, s26, v5
 v_mul_f32 v6, v6, v156
 s_waitcnt vmcnt(14)
 v_mfma_f32_16x16x32_bf16 v[80:83], a[224:227], a[128:131], v[80:83]
 v_mul_f32 v5, v5, v157
 v_cvt_pk_bf16_f32 v8, v6, v5
 v_mfma_f32_16x16x32_bf16 v[80:83], a[228:231], a[132:135], v[80:83]
 global_load_dwordx4 a[220:223], v0, s[70:71] offset:3072 sc1
 v_accvgpr_read_b32 v5, a85
 v_mfma_f32_16x16x32_bf16 v[84:87], a[228:231], a[140:143], v[84:87]
 v_lshlrev_b32 v6, 16, v5
 v_and_b32 v5, s26, v5
 v_mfma_f32_16x16x32_bf16 v[84:87], a[224:227], a[136:139], v[84:87]
 global_load_dwordx4 a[216:219], v0, s[70:71] offset:2048 sc1
 v_mul_f32 v6, v6, v158
 v_mfma_f32_16x16x32_bf16 v[88:91], a[224:227], a[144:147], v[88:91]
 v_mul_f32 v5, v5, v159
 v_cvt_pk_bf16_f32 v9, v6, v5
 s_add_u32 s70, s70, 8192
 s_addc_u32 s71, s71, 0
 v_mfma_f32_16x16x32_bf16 v[88:91], a[228:231], a[148:151], v[88:91]
 v_accvgpr_read_b32 v5, a86
 v_lshlrev_b32 v6, 16, v5
 v_mfma_f32_16x16x32_bf16 v[92:95], a[228:231], a[156:159], v[92:95]
 v_and_b32 v5, s26, v5
 v_mul_f32 v6, v6, v188
 v_mfma_f32_16x16x32_bf16 v[92:95], a[224:227], a[152:155], v[92:95]
 v_mul_f32 v5, v5, v189
 v_cvt_pk_bf16_f32 v10, v6, v5
 v_mfma_f32_16x16x32_bf16 v[96:99], a[224:227], a[160:163], v[96:99]
 v_accvgpr_read_b32 v5, a87
 v_lshlrev_b32 v6, 16, v5
 v_mfma_f32_16x16x32_bf16 v[96:99], a[228:231], a[164:167], v[96:99]
 v_and_b32 v5, s26, v5
 v_mul_f32 v6, v6, v190
 v_mfma_f32_16x16x32_bf16 v[100:103], a[228:231], a[172:175], v[100:103]
 v_mul_f32 v5, v5, v191
 v_cvt_pk_bf16_f32 v11, v6, v5
 v_mfma_f32_16x16x32_bf16 v[100:103], a[224:227], a[168:171], v[100:103]
 ds_write_b128 v3, v[8:11] offset:22528
 v_mfma_f32_16x16x32_bf16 v[104:107], a[224:227], a[176:179], v[104:107]
 buffer_store_dwordx4 v[8:11], v3, s[32:35], s68 offen offset:2048 sc1
 v_accvgpr_read_b32 v5, a116
 v_lshlrev_b32 v6, 16, v5
 v_and_b32 v5, s26, v5
 v_mul_f32 v6, v6, v220
 v_mfma_f32_16x16x32_bf16 v[104:107], a[228:231], a[180:183], v[104:107]
 v_mul_f32 v5, v5, v221
 v_cvt_pk_bf16_f32 v12, v6, v5
 v_mfma_f32_16x16x32_bf16 v[108:111], a[228:231], a[188:191], v[108:111]
 v_accvgpr_read_b32 v5, a117
 v_lshlrev_b32 v6, 16, v5
 v_mfma_f32_16x16x32_bf16 v[108:111], a[224:227], a[184:187], v[108:111]
 v_and_b32 v5, s26, v5
 v_mul_f32 v6, v6, v222
 s_waitcnt vmcnt(14)
 v_mfma_f32_16x16x32_bf16 a[244:247], a[232:235], a[184:187], a[244:247]
 ds_read_b128 a[184:187], v2 offset:61440
 v_mul_f32 v5, v5, v223
 v_mfma_f32_16x16x32_bf16 a[244:247], a[236:239], a[188:191], a[244:247]
 global_load_dwordx4 a[228:231], v0, s[70:71] offset:-3072 sc1
 ds_read_b128 a[188:191], v2 offset:62464
 v_mfma_f32_16x16x32_bf16 a[240:243], a[236:239], a[180:183], a[240:243]
 ds_read_b128 a[180:183], v2 offset:58368
 v_cvt_pk_bf16_f32 v13, v6, v5
 v_mfma_f32_16x16x32_bf16 a[240:243], a[232:235], a[176:179], a[240:243]
 global_load_dwordx4 a[224:227], v0, s[70:71] offset:-4096 sc1
 ds_read_b128 a[176:179], v2 offset:57344
 v_accvgpr_read_b32 v5, a118
 v_mfma_f32_16x16x32_bf16 v[132:135], a[232:235], a[168:171], v[132:135]
 ds_read_b128 a[168:171], v2 offset:53248
 v_lshlrev_b32 v6, 16, v5
 v_mfma_f32_16x16x32_bf16 v[132:135], a[236:239], a[172:175], v[132:135]
 ds_read_b128 a[172:175], v2 offset:54272
 v_and_b32 v5, s26, v5
 v_mfma_f32_16x16x32_bf16 v[128:131], a[236:239], a[164:167], v[128:131]
 ds_read_b128 a[164:167], v2 offset:50176
 v_mul_f32 v6, v6, v252
 v_mfma_f32_16x16x32_bf16 v[128:131], a[232:235], a[160:163], v[128:131]
 ds_read_b128 a[160:163], v2 offset:49152
 v_mul_f32 v5, v5, v253
 v_mfma_f32_16x16x32_bf16 v[124:127], a[232:235], a[152:155], v[124:127]
 ds_read_b128 a[152:155], v2 offset:45056
 v_cvt_pk_bf16_f32 v14, v6, v5
 v_mfma_f32_16x16x32_bf16 v[124:127], a[236:239], a[156:159], v[124:127]
 ds_read_b128 a[156:159], v2 offset:46080
 v_accvgpr_read_b32 v5, a119
 v_mfma_f32_16x16x32_bf16 v[120:123], a[236:239], a[148:151], v[120:123]
 ds_read_b128 a[148:151], v2 offset:41984
 v_lshlrev_b32 v6, 16, v5
 v_mfma_f32_16x16x32_bf16 v[120:123], a[232:235], a[144:147], v[120:123]
 ds_read_b128 a[144:147], v2 offset:40960
 v_and_b32 v5, s26, v5
 v_mfma_f32_16x16x32_bf16 v[116:119], a[232:235], a[136:139], v[116:119]
 ds_read_b128 a[136:139], v2 offset:36864
 v_mul_f32 v6, v6, v254
 v_mfma_f32_16x16x32_bf16 v[116:119], a[236:239], a[140:143], v[116:119]
 ds_read_b128 a[140:143], v2 offset:37888
 v_mul_f32 v5, v5, v255
 v_mfma_f32_16x16x32_bf16 v[112:115], a[236:239], a[132:135], v[112:115]
 ds_read_b128 a[132:135], v2 offset:33792
 v_cvt_pk_bf16_f32 v15, v6, v5
 v_mfma_f32_16x16x32_bf16 v[112:115], a[232:235], a[128:131], v[112:115]
 ds_read_b128 a[128:131], v2 offset:32768
 ds_write_b128 v3, v[12:15] offset:23552
 buffer_store_dwordx4 v[12:15], v3, s[32:35], s68 offen offset:3072 sc1
 v_accvgpr_read_b32 v5, a88
 v_lshlrev_b32 v6, 16, v5
 v_and_b32 v5, s26, v5
 s_waitcnt vmcnt(14) lgkmcnt(9)
 v_mfma_f32_16x16x32_bf16 v[44:47], a[192:195], a[184:187], v[44:47]
 v_mul_f32 v6, v6, v160
 v_mul_f32 v5, v5, v161
 v_mfma_f32_16x16x32_bf16 v[44:47], a[196:199], a[188:191], v[44:47]
 global_load_dwordx4 a[236:239], v0, s[70:71] offset:-1024 sc1
 v_cvt_pk_bf16_f32 v8, v6, v5
 v_mfma_f32_16x16x32_bf16 v[40:43], a[196:199], a[180:183], v[40:43]
 v_accvgpr_read_b32 v5, a89
 v_lshlrev_b32 v6, 16, v5
 v_mfma_f32_16x16x32_bf16 v[40:43], a[192:195], a[176:179], v[40:43]
 global_load_dwordx4 a[232:235], v0, s[70:71] offset:-2048 sc1
 v_and_b32 v5, s26, v5
 v_mfma_f32_16x16x32_bf16 v[36:39], a[192:195], a[168:171], v[36:39]
 v_mul_f32 v6, v6, v162
 v_mul_f32 v5, v5, v163
 v_mfma_f32_16x16x32_bf16 v[36:39], a[196:199], a[172:175], v[36:39]
 v_cvt_pk_bf16_f32 v9, v6, v5
 v_accvgpr_read_b32 v5, a90
 v_mfma_f32_16x16x32_bf16 v[32:35], a[196:199], a[164:167], v[32:35]
 v_lshlrev_b32 v6, 16, v5
 v_and_b32 v5, s26, v5
 v_mfma_f32_16x16x32_bf16 v[32:35], a[192:195], a[160:163], v[32:35]
 v_mul_f32 v6, v6, v192
 v_mul_f32 v5, v5, v193
 s_waitcnt lgkmcnt(1)
 v_mfma_f32_16x16x32_bf16 v[28:31], a[192:195], a[152:155], v[28:31]
 v_cvt_pk_bf16_f32 v10, v6, v5
 v_accvgpr_read_b32 v5, a91
 v_mfma_f32_16x16x32_bf16 v[28:31], a[196:199], a[156:159], v[28:31]
 v_lshlrev_b32 v6, 16, v5
 v_and_b32 v5, s26, v5
 v_mfma_f32_16x16x32_bf16 v[24:27], a[196:199], a[148:151], v[24:27]
 v_mul_f32 v6, v6, v194
 v_mul_f32 v5, v5, v195
 v_mfma_f32_16x16x32_bf16 v[24:27], a[192:195], a[144:147], v[24:27]
 v_cvt_pk_bf16_f32 v11, v6, v5
 v_mfma_f32_16x16x32_bf16 v[20:23], a[192:195], a[136:139], v[20:23]
 ds_write_b128 v3, v[8:11] offset:26624
 s_add_u32 s68, s29, 28672
 v_mfma_f32_16x16x32_bf16 v[20:23], a[196:199], a[140:143], v[20:23]
 buffer_store_dwordx4 v[8:11], v3, s[32:35], s68 offen sc1
 v_accvgpr_read_b32 v5, a120
 v_lshlrev_b32 v6, 16, v5
 v_and_b32 v5, s26, v5
 v_mfma_f32_16x16x32_bf16 v[16:19], a[196:199], a[132:135], v[16:19]
 v_mul_f32 v6, v6, v224
 v_mul_f32 v5, v5, v225
 v_mfma_f32_16x16x32_bf16 v[16:19], a[192:195], a[128:131], v[16:19]
 v_cvt_pk_bf16_f32 v12, v6, v5
 v_accvgpr_read_b32 v5, a121
 s_waitcnt vmcnt(13)
 v_mfma_f32_16x16x32_bf16 v[48:51], a[200:203], a[128:131], v[48:51]
 v_lshlrev_b32 v6, 16, v5
 v_and_b32 v5, s26, v5
 v_mfma_f32_16x16x32_bf16 v[48:51], a[204:207], a[132:135], v[48:51]
 global_load_dwordx4 a[196:199], v0, s[70:71] offset:1024 sc1
 v_mul_f32 v6, v6, v226
 v_mfma_f32_16x16x32_bf16 v[52:55], a[204:207], a[140:143], v[52:55]
 v_mul_f32 v5, v5, v227
 v_cvt_pk_bf16_f32 v13, v6, v5
 v_mfma_f32_16x16x32_bf16 v[52:55], a[200:203], a[136:139], v[52:55]
 global_load_dwordx4 a[192:195], v0, s[70:71] offset:0 sc1
 v_accvgpr_read_b32 v5, a122
 v_mfma_f32_16x16x32_bf16 v[56:59], a[200:203], a[144:147], v[56:59]
 v_accvgpr_read_b32 v7, a248
 v_lshlrev_b32 v6, 16, v5
 v_mfma_f32_16x16x32_bf16 v[56:59], a[204:207], a[148:151], v[56:59]
 v_and_b32 v5, s26, v5
 v_mul_f32 v6, v6, v7
 v_mfma_f32_16x16x32_bf16 v[60:63], a[204:207], a[156:159], v[60:63]
 v_accvgpr_read_b32 v7, a249
 v_mfma_f32_16x16x32_bf16 v[60:63], a[200:203], a[152:155], v[60:63]
 v_mul_f32 v5, v5, v7
 v_cvt_pk_bf16_f32 v14, v6, v5
 v_mfma_f32_16x16x32_bf16 v[64:67], a[200:203], a[160:163], v[64:67]
 v_accvgpr_read_b32 v5, a123
 v_accvgpr_read_b32 v7, a250
 v_mfma_f32_16x16x32_bf16 v[64:67], a[204:207], a[164:167], v[64:67]
 v_lshlrev_b32 v6, 16, v5
 v_mfma_f32_16x16x32_bf16 v[68:71], a[204:207], a[172:175], v[68:71]
 v_and_b32 v5, s26, v5
 v_mul_f32 v6, v6, v7
 v_mfma_f32_16x16x32_bf16 v[68:71], a[200:203], a[168:171], v[68:71]
 v_accvgpr_read_b32 v7, a251
 v_mul_f32 v5, v5, v7
 v_mfma_f32_16x16x32_bf16 v[72:75], a[200:203], a[176:179], v[72:75]
 v_cvt_pk_bf16_f32 v15, v6, v5
 v_mfma_f32_16x16x32_bf16 v[72:75], a[204:207], a[180:183], v[72:75]
 ds_write_b128 v3, v[12:15] offset:27648
 v_mfma_f32_16x16x32_bf16 v[76:79], a[204:207], a[188:191], v[76:79]
 buffer_store_dwordx4 v[12:15], v3, s[32:35], s68 offen offset:1024 sc1
 v_accvgpr_read_b32 v5, a92
 v_lshlrev_b32 v6, 16, v5
 v_mfma_f32_16x16x32_bf16 v[76:79], a[200:203], a[184:187], v[76:79]
 v_and_b32 v5, s26, v5
 v_mul_f32 v6, v6, v164
 s_waitcnt vmcnt(13)
 v_mfma_f32_16x16x32_bf16 v[108:111], a[208:211], a[184:187], v[108:111]
 v_mul_f32 v5, v5, v165
 v_cvt_pk_bf16_f32 v8, v6, v5
 v_mfma_f32_16x16x32_bf16 v[108:111], a[212:215], a[188:191], v[108:111]
 global_load_dwordx4 a[204:207], v0, s[70:71] offset:3072 sc1
 v_accvgpr_read_b32 v5, a93
 v_mfma_f32_16x16x32_bf16 v[104:107], a[212:215], a[180:183], v[104:107]
 v_lshlrev_b32 v6, 16, v5
 v_and_b32 v5, s26, v5
 v_mfma_f32_16x16x32_bf16 v[104:107], a[208:211], a[176:179], v[104:107]
 global_load_dwordx4 a[200:203], v0, s[70:71] offset:2048 sc1
 v_mul_f32 v6, v6, v166
 v_mfma_f32_16x16x32_bf16 v[100:103], a[208:211], a[168:171], v[100:103]
 v_mul_f32 v5, v5, v167
 v_cvt_pk_bf16_f32 v9, v6, v5
 s_add_u32 s70, s70, 8192
 s_addc_u32 s71, s71, 0
 v_mfma_f32_16x16x32_bf16 v[100:103], a[212:215], a[172:175], v[100:103]
 v_accvgpr_read_b32 v5, a94
 v_lshlrev_b32 v6, 16, v5
 v_mfma_f32_16x16x32_bf16 v[96:99], a[212:215], a[164:167], v[96:99]
 v_and_b32 v5, s26, v5
 v_mul_f32 v6, v6, v196
 v_mfma_f32_16x16x32_bf16 v[96:99], a[208:211], a[160:163], v[96:99]
 v_mul_f32 v5, v5, v197
 v_cvt_pk_bf16_f32 v10, v6, v5
 v_mfma_f32_16x16x32_bf16 v[92:95], a[208:211], a[152:155], v[92:95]
 v_accvgpr_read_b32 v5, a95
 v_lshlrev_b32 v6, 16, v5
 v_mfma_f32_16x16x32_bf16 v[92:95], a[212:215], a[156:159], v[92:95]
 v_and_b32 v5, s26, v5
 v_mul_f32 v6, v6, v198
 v_mfma_f32_16x16x32_bf16 v[88:91], a[212:215], a[148:151], v[88:91]
 v_mul_f32 v5, v5, v199
 v_cvt_pk_bf16_f32 v11, v6, v5
 v_mfma_f32_16x16x32_bf16 v[88:91], a[208:211], a[144:147], v[88:91]
 ds_write_b128 v3, v[8:11] offset:30720
 v_mfma_f32_16x16x32_bf16 v[84:87], a[208:211], a[136:139], v[84:87]
 buffer_store_dwordx4 v[8:11], v3, s[32:35], s68 offen offset:2048 sc1
 v_accvgpr_read_b32 v5, a124
 v_lshlrev_b32 v6, 16, v5
 v_and_b32 v5, s26, v5
 v_mul_f32 v6, v6, v228
 v_mfma_f32_16x16x32_bf16 v[84:87], a[212:215], a[140:143], v[84:87]
 v_mul_f32 v5, v5, v229
 v_cvt_pk_bf16_f32 v12, v6, v5
 v_mfma_f32_16x16x32_bf16 v[80:83], a[212:215], a[132:135], v[80:83]
 v_accvgpr_read_b32 v5, a125
 v_lshlrev_b32 v6, 16, v5
 v_mfma_f32_16x16x32_bf16 v[80:83], a[208:211], a[128:131], v[80:83]
 v_and_b32 v5, s26, v5
 v_mul_f32 v6, v6, v230
 s_waitcnt vmcnt(13)
 v_mfma_f32_16x16x32_bf16 v[112:115], a[216:219], a[128:131], v[112:115]
 ds_read_b128 a[128:131], v1
 v_mul_f32 v5, v5, v231
 v_mfma_f32_16x16x32_bf16 v[112:115], a[220:223], a[132:135], v[112:115]
 global_load_dwordx4 a[212:215], v0, s[70:71] offset:-3072 sc1
 ds_read_b128 a[132:135], v1 offset:1024
 v_mfma_f32_16x16x32_bf16 v[116:119], a[220:223], a[140:143], v[116:119]
 ds_read_b128 a[140:143], v1 offset:5120
 v_cvt_pk_bf16_f32 v13, v6, v5
 v_mfma_f32_16x16x32_bf16 v[116:119], a[216:219], a[136:139], v[116:119]
 global_load_dwordx4 a[208:211], v0, s[70:71] offset:-4096 sc1
 ds_read_b128 a[136:139], v1 offset:4096
 v_mfma_f32_16x16x32_bf16 v[120:123], a[216:219], a[144:147], v[120:123]
 ds_read_b128 a[144:147], v1 offset:8192
 v_accvgpr_read_b32 v5, a126
 v_mfma_f32_16x16x32_bf16 v[120:123], a[220:223], a[148:151], v[120:123]
 ds_read_b128 a[148:151], v1 offset:9216
 v_accvgpr_read_b32 v7, a252
 v_lshlrev_b32 v6, 16, v5
 v_mfma_f32_16x16x32_bf16 v[124:127], a[220:223], a[156:159], v[124:127]
 ds_read_b128 a[156:159], v1 offset:13312
 v_and_b32 v5, s26, v5
 v_mfma_f32_16x16x32_bf16 v[124:127], a[216:219], a[152:155], v[124:127]
 ds_read_b128 a[152:155], v1 offset:12288
 v_mul_f32 v6, v6, v7
 v_accvgpr_read_b32 v7, a253
 v_mfma_f32_16x16x32_bf16 v[128:131], a[216:219], a[160:163], v[128:131]
 ds_read_b128 a[160:163], v1 offset:16384
 v_mul_f32 v5, v5, v7
 v_cvt_pk_bf16_f32 v14, v6, v5
 v_mfma_f32_16x16x32_bf16 v[128:131], a[220:223], a[164:167], v[128:131]
 ds_read_b128 a[164:167], v1 offset:17408
 v_accvgpr_read_b32 v5, a127
 v_accvgpr_read_b32 v7, a254
 v_mfma_f32_16x16x32_bf16 v[132:135], a[220:223], a[172:175], v[132:135]
 ds_read_b128 a[172:175], v1 offset:21504
 v_lshlrev_b32 v6, 16, v5
 v_mfma_f32_16x16x32_bf16 v[132:135], a[216:219], a[168:171], v[132:135]
 ds_read_b128 a[168:171], v1 offset:20480
 v_and_b32 v5, s26, v5
 v_mul_f32 v6, v6, v7
 v_mfma_f32_16x16x32_bf16 a[240:243], a[216:219], a[176:179], a[240:243]
 ds_read_b128 a[176:179], v1 offset:24576
 v_accvgpr_read_b32 v7, a255
 v_mul_f32 v5, v5, v7
 v_cvt_pk_bf16_f32 v15, v6, v5
 v_mfma_f32_16x16x32_bf16 a[240:243], a[220:223], a[180:183], a[240:243]
 ds_read_b128 a[180:183], v1 offset:25600
 ds_write_b128 v3, v[12:15] offset:31744
 v_mfma_f32_16x16x32_bf16 a[244:247], a[220:223], a[188:191], a[244:247]
 buffer_store_dwordx4 v[12:15], v3, s[32:35], s68 offen offset:3072 sc1
 global_load_dwordx4 a[220:223], v0, s[70:71] offset:-1024 sc1
 ds_read_b128 a[188:191], v1 offset:29696
 v_mfma_f32_16x16x32_bf16 a[244:247], a[216:219], a[184:187], a[244:247]
 global_load_dwordx4 a[216:219], v0, s[70:71] offset:-2048 sc1
 ds_read_b128 a[184:187], v1 offset:28672
 s_waitcnt vmcnt(15) lgkmcnt(9)
Ls1b:
 v_mfma_f32_16x16x32_bf16 v[136:139], a[224:227], a[128:131], v[136:139]
 v_bfe_u32 v4, v3, 8, 2
 v_mfma_f32_16x16x32_bf16 v[136:139], a[228:231], a[132:135], v[136:139]
 v_mfma_f32_16x16x32_bf16 v[140:143], a[228:231], a[140:143], v[140:143]
 v_lshl_add_u32 v4, v4, 5, s51
 v_mfma_f32_16x16x32_bf16 v[140:143], a[224:227], a[136:139], v[140:143]
 ds_read_b128 v[8:11], v4
 v_mfma_f32_16x16x32_bf16 v[144:147], a[224:227], a[144:147], v[144:147]
 v_mfma_f32_16x16x32_bf16 v[144:147], a[228:231], a[148:151], v[144:147]
 v_mfma_f32_16x16x32_bf16 v[148:151], a[228:231], a[156:159], v[148:151]
 v_mfma_f32_16x16x32_bf16 v[148:151], a[224:227], a[152:155], v[148:151]
 s_waitcnt lgkmcnt(1)
 v_mfma_f32_16x16x32_bf16 v[152:155], a[224:227], a[160:163], v[152:155]
 v_mfma_f32_16x16x32_bf16 v[152:155], a[228:231], a[164:167], v[152:155]
 v_mfma_f32_16x16x32_bf16 v[156:159], a[228:231], a[172:175], v[156:159]
 v_mfma_f32_16x16x32_bf16 v[156:159], a[224:227], a[168:171], v[156:159]
 v_mfma_f32_16x16x32_bf16 v[160:163], a[224:227], a[176:179], v[160:163]
 v_mfma_f32_16x16x32_bf16 v[160:163], a[228:231], a[180:183], v[160:163]
 v_mfma_f32_16x16x32_bf16 v[164:167], a[228:231], a[188:191], v[164:167]
 v_mfma_f32_16x16x32_bf16 v[164:167], a[224:227], a[184:187], v[164:167]
 s_waitcnt vmcnt(12)
 v_mfma_f32_16x16x32_bf16 v[196:199], a[232:235], a[184:187], v[196:199]
 s_waitcnt lgkmcnt(0)
 v_mfma_f32_16x16x32_bf16 v[196:199], a[236:239], a[188:191], v[196:199]
 global_load_dwordx4 a[228:231], v0, s[70:71] offset:1024 sc1
 v_add_f32 v16, v16, v8
 v_mfma_f32_16x16x32_bf16 v[192:195], a[236:239], a[180:183], v[192:195]
 v_mfma_f32_16x16x32_bf16 v[192:195], a[232:235], a[176:179], v[192:195]
 global_load_dwordx4 a[224:227], v0, s[70:71] offset:0 sc1
 ds_read_b128 v[12:15], v4 offset:16
 v_mfma_f32_16x16x32_bf16 v[188:191], a[232:235], a[168:171], v[188:191]
 v_add_f32 v17, v17, v9
 v_mfma_f32_16x16x32_bf16 v[188:191], a[236:239], a[172:175], v[188:191]
 v_mfma_f32_16x16x32_bf16 v[184:187], a[236:239], a[164:167], v[184:187]
 v_add_f32 v18, v18, v10
 v_mfma_f32_16x16x32_bf16 v[184:187], a[232:235], a[160:163], v[184:187]
 v_add_f32 v19, v19, v11
 v_mfma_f32_16x16x32_bf16 v[180:183], a[232:235], a[152:155], v[180:183]
 v_mfma_f32_16x16x32_bf16 v[180:183], a[236:239], a[156:159], v[180:183]
 v_add_f32 v20, v20, v8
 v_mfma_f32_16x16x32_bf16 v[176:179], a[236:239], a[148:151], v[176:179]
 v_add_f32 v21, v21, v9
 v_mfma_f32_16x16x32_bf16 v[176:179], a[232:235], a[144:147], v[176:179]
 v_add_f32 v22, v22, v10
 v_mfma_f32_16x16x32_bf16 v[172:175], a[232:235], a[136:139], v[172:175]
 v_mfma_f32_16x16x32_bf16 v[172:175], a[236:239], a[140:143], v[172:175]
 v_add_f32 v23, v23, v11
 v_mfma_f32_16x16x32_bf16 v[168:171], a[236:239], a[132:135], v[168:171]
 v_add_f32 v24, v24, v8
 v_mfma_f32_16x16x32_bf16 v[168:171], a[232:235], a[128:131], v[168:171]
 s_waitcnt vmcnt(11)
 v_mfma_f32_16x16x32_bf16 v[200:203], a[192:195], a[128:131], v[200:203]
 v_add_f32 v25, v25, v9
 v_mfma_f32_16x16x32_bf16 v[200:203], a[196:199], a[132:135], v[200:203]
 global_load_dwordx4 a[236:239], v0, s[70:71] offset:3072 sc1
 v_add_f32 v26, v26, v10
 v_mfma_f32_16x16x32_bf16 v[204:207], a[196:199], a[140:143], v[204:207]
 v_mfma_f32_16x16x32_bf16 v[204:207], a[192:195], a[136:139], v[204:207]
 global_load_dwordx4 a[232:235], v0, s[70:71] offset:2048 sc1
 v_add_f32 v27, v27, v11
 v_mfma_f32_16x16x32_bf16 v[208:211], a[192:195], a[144:147], v[208:211]
 v_add_f32 v28, v28, v8
 s_add_u32 s70, s70, 8192
 s_addc_u32 s71, s71, 0
 v_mfma_f32_16x16x32_bf16 v[208:211], a[196:199], a[148:151], v[208:211]
 v_mfma_f32_16x16x32_bf16 v[212:215], a[196:199], a[156:159], v[212:215]
 v_add_f32 v29, v29, v9
 v_mfma_f32_16x16x32_bf16 v[212:215], a[192:195], a[152:155], v[212:215]
 v_add_f32 v30, v30, v10
 v_mfma_f32_16x16x32_bf16 v[216:219], a[192:195], a[160:163], v[216:219]
 v_add_f32 v31, v31, v11
 v_mfma_f32_16x16x32_bf16 v[216:219], a[196:199], a[164:167], v[216:219]
 v_mfma_f32_16x16x32_bf16 v[220:223], a[196:199], a[172:175], v[220:223]
 v_add_f32 v32, v32, v8
 v_mfma_f32_16x16x32_bf16 v[220:223], a[192:195], a[168:171], v[220:223]
 v_add_f32 v33, v33, v9
 v_mfma_f32_16x16x32_bf16 v[224:227], a[192:195], a[176:179], v[224:227]
 v_mfma_f32_16x16x32_bf16 v[224:227], a[196:199], a[180:183], v[224:227]
 v_add_f32 v34, v34, v10
 v_mfma_f32_16x16x32_bf16 v[228:231], a[196:199], a[188:191], v[228:231]
 v_add_f32 v35, v35, v11
 v_mfma_f32_16x16x32_bf16 v[228:231], a[192:195], a[184:187], v[228:231]
 v_add_f32 v36, v36, v8
 s_waitcnt vmcnt(10)
 v_mfma_f32_16x16x32_bf16 a[252:255], a[200:203], a[184:187], a[252:255]
 ds_read_b128 a[184:187], v1 offset:61440
 v_add_f32 v37, v37, v9
 v_mfma_f32_16x16x32_bf16 a[252:255], a[204:207], a[188:191], a[252:255]
 global_load_dwordx4 a[196:199], v0, s[70:71] offset:-3072 sc1
 ds_read_b128 a[188:191], v1 offset:62464
 v_mfma_f32_16x16x32_bf16 a[248:251], a[204:207], a[180:183], a[248:251]
 ds_read_b128 a[180:183], v1 offset:58368
 v_add_f32 v38, v38, v10
 v_mfma_f32_16x16x32_bf16 a[248:251], a[200:203], a[176:179], a[248:251]
 global_load_dwordx4 a[192:195], v0, s[70:71] offset:-4096 sc1
 ds_read_b128 a[176:179], v1 offset:57344
 v_mfma_f32_16x16x32_bf16 v[252:255], a[200:203], a[168:171], v[252:255]
 ds_read_b128 a[168:171], v1 offset:53248
 v_add_f32 v39, v39, v11
 v_mfma_f32_16x16x32_bf16 v[252:255], a[204:207], a[172:175], v[252:255]
 ds_read_b128 a[172:175], v1 offset:54272
 v_add_f32 v40, v40, v8
 v_mfma_f32_16x16x32_bf16 v[248:251], a[204:207], a[164:167], v[248:251]
 ds_read_b128 a[164:167], v1 offset:50176
 v_mfma_f32_16x16x32_bf16 v[248:251], a[200:203], a[160:163], v[248:251]
 ds_read_b128 a[160:163], v1 offset:49152
 v_add_f32 v41, v41, v9
 v_mfma_f32_16x16x32_bf16 v[244:247], a[200:203], a[152:155], v[244:247]
 ds_read_b128 a[152:155], v1 offset:45056
 v_add_f32 v42, v42, v10
 v_mfma_f32_16x16x32_bf16 v[244:247], a[204:207], a[156:159], v[244:247]
 ds_read_b128 a[156:159], v1 offset:46080
 v_mfma_f32_16x16x32_bf16 v[240:243], a[204:207], a[148:151], v[240:243]
 ds_read_b128 a[148:151], v1 offset:41984
 v_add_f32 v43, v43, v11
 v_mfma_f32_16x16x32_bf16 v[240:243], a[200:203], a[144:147], v[240:243]
 ds_read_b128 a[144:147], v1 offset:40960
 v_add_f32 v44, v44, v8
 v_mfma_f32_16x16x32_bf16 v[236:239], a[200:203], a[136:139], v[236:239]
 ds_read_b128 a[136:139], v1 offset:36864
 v_mfma_f32_16x16x32_bf16 v[236:239], a[204:207], a[140:143], v[236:239]
 ds_read_b128 a[140:143], v1 offset:37888
 v_add_f32 v45, v45, v9
 v_mfma_f32_16x16x32_bf16 v[232:235], a[204:207], a[132:135], v[232:235]
 ds_read_b128 a[132:135], v1 offset:33792
 v_add_f32 v46, v46, v10
 v_mfma_f32_16x16x32_bf16 v[232:235], a[200:203], a[128:131], v[232:235]
 ds_read_b128 a[128:131], v1 offset:32768
 v_add_f32 v47, v47, v11
 s_waitcnt vmcnt(9) lgkmcnt(8)
 v_mfma_f32_16x16x32_bf16 v[164:167], a[208:211], a[184:187], v[164:167]
 v_mfma_f32_16x16x32_bf16 v[164:167], a[212:215], a[188:191], v[164:167]
 global_load_dwordx4 a[204:207], v0, s[70:71] offset:-1024 sc1
 v_mfma_f32_16x16x32_bf16 v[160:163], a[212:215], a[180:183], v[160:163]
 v_add_f32 v48, v48, v12
 v_mfma_f32_16x16x32_bf16 v[160:163], a[208:211], a[176:179], v[160:163]
 global_load_dwordx4 a[200:203], v0, s[70:71] offset:-2048 sc1
 v_mfma_f32_16x16x32_bf16 v[156:159], a[208:211], a[168:171], v[156:159]
 ds_read_b128 v[8:11], v4 offset:128
 v_mfma_f32_16x16x32_bf16 v[156:159], a[212:215], a[172:175], v[156:159]
 v_add_f32 v49, v49, v13
 v_mfma_f32_16x16x32_bf16 v[152:155], a[212:215], a[164:167], v[152:155]
 v_mfma_f32_16x16x32_bf16 v[152:155], a[208:211], a[160:163], v[152:155]
 v_add_f32 v50, v50, v14
 s_waitcnt lgkmcnt(1)
 v_mfma_f32_16x16x32_bf16 v[148:151], a[208:211], a[152:155], v[148:151]
 v_add_f32 v51, v51, v15
 v_mfma_f32_16x16x32_bf16 v[148:151], a[212:215], a[156:159], v[148:151]
 v_add_f32 v52, v52, v12
 v_mfma_f32_16x16x32_bf16 v[144:147], a[212:215], a[148:151], v[144:147]
 v_mfma_f32_16x16x32_bf16 v[144:147], a[208:211], a[144:147], v[144:147]
 v_add_f32 v53, v53, v13
 v_mfma_f32_16x16x32_bf16 v[140:143], a[208:211], a[136:139], v[140:143]
 v_add_f32 v54, v54, v14
 v_mfma_f32_16x16x32_bf16 v[140:143], a[212:215], a[140:143], v[140:143]
 v_mfma_f32_16x16x32_bf16 v[136:139], a[212:215], a[132:135], v[136:139]
 v_add_f32 v55, v55, v15
 v_mfma_f32_16x16x32_bf16 v[136:139], a[208:211], a[128:131], v[136:139]
 v_add_f32 v56, v56, v12
 s_waitcnt vmcnt(8)
 v_mfma_f32_16x16x32_bf16 v[168:171], a[216:219], a[128:131], v[168:171]
 v_mfma_f32_16x16x32_bf16 v[168:171], a[220:223], a[132:135], v[168:171]
 global_load_dwordx4 a[212:215], v0, s[70:71] offset:1024 sc1
 v_add_f32 v57, v57, v13
 v_mfma_f32_16x16x32_bf16 v[172:175], a[220:223], a[140:143], v[172:175]
 v_add_f32 v58, v58, v14
 v_mfma_f32_16x16x32_bf16 v[172:175], a[216:219], a[136:139], v[172:175]
 global_load_dwordx4 a[208:211], v0, s[70:71] offset:0 sc1
 v_add_f32 v59, v59, v15
 v_mfma_f32_16x16x32_bf16 v[176:179], a[216:219], a[144:147], v[176:179]
 v_mfma_f32_16x16x32_bf16 v[176:179], a[220:223], a[148:151], v[176:179]
 v_add_f32 v60, v60, v12
 v_mfma_f32_16x16x32_bf16 v[180:183], a[220:223], a[156:159], v[180:183]
 v_add_f32 v61, v61, v13
 v_mfma_f32_16x16x32_bf16 v[180:183], a[216:219], a[152:155], v[180:183]
 v_mfma_f32_16x16x32_bf16 v[184:187], a[216:219], a[160:163], v[184:187]
 v_add_f32 v62, v62, v14
 v_mfma_f32_16x16x32_bf16 v[184:187], a[220:223], a[164:167], v[184:187]
 v_add_f32 v63, v63, v15
 v_mfma_f32_16x16x32_bf16 v[188:191], a[220:223], a[172:175], v[188:191]
 v_mfma_f32_16x16x32_bf16 v[188:191], a[216:219], a[168:171], v[188:191]
 v_add_f32 v64, v64, v12
 v_mfma_f32_16x16x32_bf16 v[192:195], a[216:219], a[176:179], v[192:195]
 v_add_f32 v65, v65, v13
 v_mfma_f32_16x16x32_bf16 v[192:195], a[220:223], a[180:183], v[192:195]
 v_mfma_f32_16x16x32_bf16 v[196:199], a[220:223], a[188:191], v[196:199]
 v_add_f32 v66, v66, v14
 v_mfma_f32_16x16x32_bf16 v[196:199], a[216:219], a[184:187], v[196:199]
 v_add_f32 v67, v67, v15
 s_waitcnt vmcnt(8)
 v_mfma_f32_16x16x32_bf16 v[228:231], a[224:227], a[184:187], v[228:231]
 v_add_f32 v68, v68, v12
 v_mfma_f32_16x16x32_bf16 v[228:231], a[228:231], a[188:191], v[228:231]
 global_load_dwordx4 a[220:223], v0, s[70:71] offset:3072 sc1
 v_mfma_f32_16x16x32_bf16 v[224:227], a[228:231], a[180:183], v[224:227]
 v_add_f32 v69, v69, v13
 v_mfma_f32_16x16x32_bf16 v[224:227], a[224:227], a[176:179], v[224:227]
 global_load_dwordx4 a[216:219], v0, s[70:71] offset:2048 sc1
 v_add_f32 v70, v70, v14
 v_mfma_f32_16x16x32_bf16 v[220:223], a[224:227], a[168:171], v[220:223]
 s_add_u32 s70, s70, 8192
 s_addc_u32 s71, s71, 0
 v_mfma_f32_16x16x32_bf16 v[220:223], a[228:231], a[172:175], v[220:223]
 v_add_f32 v71, v71, v15
 v_mfma_f32_16x16x32_bf16 v[216:219], a[228:231], a[164:167], v[216:219]
 v_add_f32 v72, v72, v12
 v_mfma_f32_16x16x32_bf16 v[216:219], a[224:227], a[160:163], v[216:219]
 v_mfma_f32_16x16x32_bf16 v[212:215], a[224:227], a[152:155], v[212:215]
 v_add_f32 v73, v73, v13
 v_mfma_f32_16x16x32_bf16 v[212:215], a[228:231], a[156:159], v[212:215]
 v_add_f32 v74, v74, v14
 v_mfma_f32_16x16x32_bf16 v[208:211], a[228:231], a[148:151], v[208:211]
 v_add_f32 v75, v75, v15
 v_mfma_f32_16x16x32_bf16 v[208:211], a[224:227], a[144:147], v[208:211]
 v_mfma_f32_16x16x32_bf16 v[204:207], a[224:227], a[136:139], v[204:207]
 v_add_f32 v76, v76, v12
 v_mfma_f32_16x16x32_bf16 v[204:207], a[228:231], a[140:143], v[204:207]
 v_add_f32 v77, v77, v13
 v_mfma_f32_16x16x32_bf16 v[200:203], a[228:231], a[132:135], v[200:203]
 v_mfma_f32_16x16x32_bf16 v[200:203], a[224:227], a[128:131], v[200:203]
 v_add_f32 v78, v78, v14
 s_waitcnt vmcnt(8)
 v_mfma_f32_16x16x32_bf16 v[232:235], a[232:235], a[128:131], v[232:235]
 ds_read_b128 a[128:131], v2
 v_add_f32 v79, v79, v15
 v_mfma_f32_16x16x32_bf16 v[232:235], a[236:239], a[132:135], v[232:235]
 global_load_dwordx4 a[228:231], v0, s[70:71] offset:-3072 sc1
 ds_read_b128 a[132:135], v2 offset:1024
 v_mfma_f32_16x16x32_bf16 v[236:239], a[236:239], a[140:143], v[236:239]
 ds_read_b128 a[140:143], v2 offset:5120
 s_waitcnt lgkmcnt(3)
 v_mfma_f32_16x16x32_bf16 v[236:239], a[232:235], a[136:139], v[236:239]
 global_load_dwordx4 a[224:227], v0, s[70:71] offset:-4096 sc1
 ds_read_b128 a[136:139], v2 offset:4096
 v_mfma_f32_16x16x32_bf16 v[240:243], a[232:235], a[144:147], v[240:243]
 ds_read_b128 a[144:147], v2 offset:8192
 v_add_f32 v80, v80, v8
 v_mfma_f32_16x16x32_bf16 v[240:243], a[236:239], a[148:151], v[240:243]
 ds_read_b128 a[148:151], v2 offset:9216
 ds_read_b128 v[12:15], v4 offset:144
 v_mfma_f32_16x16x32_bf16 v[244:247], a[236:239], a[156:159], v[244:247]
 ds_read_b128 a[156:159], v2 offset:13312
 v_add_f32 v81, v81, v9
 v_mfma_f32_16x16x32_bf16 v[244:247], a[232:235], a[152:155], v[244:247]
 ds_read_b128 a[152:155], v2 offset:12288
 v_add_f32 v82, v82, v10
 v_mfma_f32_16x16x32_bf16 v[248:251], a[232:235], a[160:163], v[248:251]
 ds_read_b128 a[160:163], v2 offset:16384
 v_mfma_f32_16x16x32_bf16 v[248:251], a[236:239], a[164:167], v[248:251]
 ds_read_b128 a[164:167], v2 offset:17408
 v_add_f32 v83, v83, v11
 v_mfma_f32_16x16x32_bf16 v[252:255], a[236:239], a[172:175], v[252:255]
 ds_read_b128 a[172:175], v2 offset:21504
 v_add_f32 v84, v84, v8
 v_mfma_f32_16x16x32_bf16 v[252:255], a[232:235], a[168:171], v[252:255]
 ds_read_b128 a[168:171], v2 offset:20480
 v_mfma_f32_16x16x32_bf16 a[248:251], a[232:235], a[176:179], a[248:251]
 ds_read_b128 a[176:179], v2 offset:24576
 v_add_f32 v85, v85, v9
 v_mfma_f32_16x16x32_bf16 a[248:251], a[236:239], a[180:183], a[248:251]
 ds_read_b128 a[180:183], v2 offset:25600
 v_add_f32 v86, v86, v10
 v_mfma_f32_16x16x32_bf16 a[252:255], a[236:239], a[188:191], a[252:255]
 ds_read_b128 a[188:191], v2 offset:29696
 v_mfma_f32_16x16x32_bf16 a[252:255], a[232:235], a[184:187], a[252:255]
 ds_read_b128 a[184:187], v2 offset:28672
 v_add_f32 v87, v87, v11
 s_waitcnt vmcnt(8) lgkmcnt(8)
 v_mfma_f32_16x16x32_bf16 v[136:139], a[192:195], a[128:131], v[136:139]
 v_add_f32 v88, v88, v8
 v_mfma_f32_16x16x32_bf16 v[136:139], a[196:199], a[132:135], v[136:139]
 global_load_dwordx4 a[236:239], v0, s[70:71] offset:-1024 sc1
 v_add_f32 v89, v89, v9
 v_mfma_f32_16x16x32_bf16 v[140:143], a[196:199], a[140:143], v[140:143]
 v_mfma_f32_16x16x32_bf16 v[140:143], a[192:195], a[136:139], v[140:143]
 global_load_dwordx4 a[232:235], v0, s[70:71] offset:-2048 sc1
 v_add_f32 v90, v90, v10
 v_mfma_f32_16x16x32_bf16 v[144:147], a[192:195], a[144:147], v[144:147]
 v_add_f32 v91, v91, v11
 v_mfma_f32_16x16x32_bf16 v[144:147], a[196:199], a[148:151], v[144:147]
 v_mfma_f32_16x16x32_bf16 v[148:151], a[196:199], a[156:159], v[148:151]
 v_add_f32 v92, v92, v8
 v_mfma_f32_16x16x32_bf16 v[148:151], a[192:195], a[152:155], v[148:151]
 v_add_f32 v93, v93, v9
 s_waitcnt lgkmcnt(0)
 v_mfma_f32_16x16x32_bf16 v[152:155], a[192:195], a[160:163], v[152:155]
 v_mfma_f32_16x16x32_bf16 v[152:155], a[196:199], a[164:167], v[152:155]
 v_add_f32 v94, v94, v10
 v_mfma_f32_16x16x32_bf16 v[156:159], a[196:199], a[172:175], v[156:159]
 v_add_f32 v95, v95, v11
 v_mfma_f32_16x16x32_bf16 v[156:159], a[192:195], a[168:171], v[156:159]
 buffer_load_dword v4, off, s[64:67], 0 sc1
 v_mfma_f32_16x16x32_bf16 v[160:163], a[192:195], a[176:179], v[160:163]
 v_mfma_f32_16x16x32_bf16 v[160:163], a[196:199], a[180:183], v[160:163]
 v_add_f32 v96, v96, v8
 v_mfma_f32_16x16x32_bf16 v[164:167], a[196:199], a[188:191], v[164:167]
 v_add_f32 v97, v97, v9
 v_mfma_f32_16x16x32_bf16 v[164:167], a[192:195], a[184:187], v[164:167]
 s_waitcnt vmcnt(9)
 v_mfma_f32_16x16x32_bf16 v[196:199], a[200:203], a[184:187], v[196:199]
 v_add_f32 v98, v98, v10
 v_mfma_f32_16x16x32_bf16 v[196:199], a[204:207], a[188:191], v[196:199]
 global_load_dwordx4 a[196:199], v0, s[70:71] offset:1024 sc1
 v_add_f32 v99, v99, v11
 v_mfma_f32_16x16x32_bf16 v[192:195], a[204:207], a[180:183], v[192:195]
 v_mfma_f32_16x16x32_bf16 v[192:195], a[200:203], a[176:179], v[192:195]
 global_load_dwordx4 a[192:195], v0, s[70:71] offset:0 sc1
 v_add_f32 v100, v100, v8
 v_mfma_f32_16x16x32_bf16 v[188:191], a[200:203], a[168:171], v[188:191]
 v_add_f32 v101, v101, v9
 v_mfma_f32_16x16x32_bf16 v[188:191], a[204:207], a[172:175], v[188:191]
 v_mfma_f32_16x16x32_bf16 v[184:187], a[204:207], a[164:167], v[184:187]
 v_add_f32 v102, v102, v10
 v_mfma_f32_16x16x32_bf16 v[184:187], a[200:203], a[160:163], v[184:187]
 v_add_f32 v103, v103, v11
 v_mfma_f32_16x16x32_bf16 v[180:183], a[200:203], a[152:155], v[180:183]
 v_add_f32 v104, v104, v8
 v_mfma_f32_16x16x32_bf16 v[180:183], a[204:207], a[156:159], v[180:183]
 v_mfma_f32_16x16x32_bf16 v[176:179], a[204:207], a[148:151], v[176:179]
 v_add_f32 v105, v105, v9
 v_mfma_f32_16x16x32_bf16 v[176:179], a[200:203], a[144:147], v[176:179]
 v_add_f32 v106, v106, v10
 v_mfma_f32_16x16x32_bf16 v[172:175], a[200:203], a[136:139], v[172:175]
 v_mfma_f32_16x16x32_bf16 v[172:175], a[204:207], a[140:143], v[172:175]
 v_add_f32 v107, v107, v11
 v_mfma_f32_16x16x32_bf16 v[168:171], a[204:207], a[132:135], v[168:171]
 v_add_f32 v108, v108, v8
 v_mfma_f32_16x16x32_bf16 v[168:171], a[200:203], a[128:131], v[168:171]
 s_waitcnt vmcnt(9)
 v_mfma_f32_16x16x32_bf16 v[200:203], a[208:211], a[128:131], v[200:203]
 v_add_f32 v109, v109, v9
 v_mfma_f32_16x16x32_bf16 v[200:203], a[212:215], a[132:135], v[200:203]
 global_load_dwordx4 a[204:207], v0, s[70:71] offset:3072 sc1
 v_add_f32 v110, v110, v10
 v_mfma_f32_16x16x32_bf16 v[204:207], a[212:215], a[140:143], v[204:207]
 v_add_f32 v111, v111, v11
 v_mfma_f32_16x16x32_bf16 v[204:207], a[208:211], a[136:139], v[204:207]
 global_load_dwordx4 a[200:203], v0, s[70:71] offset:2048 sc1
 v_mfma_f32_16x16x32_bf16 v[208:211], a[208:211], a[144:147], v[208:211]
 s_add_u32 s70, s70, 8192
 s_addc_u32 s71, s71, 0
 v_mfma_f32_16x16x32_bf16 v[208:211], a[212:215], a[148:151], v[208:211]
 v_add_f32 v112, v112, v12
 v_mfma_f32_16x16x32_bf16 v[212:215], a[212:215], a[156:159], v[212:215]
 v_mfma_f32_16x16x32_bf16 v[212:215], a[208:211], a[152:155], v[212:215]
 v_add_f32 v113, v113, v13
 v_mfma_f32_16x16x32_bf16 v[216:219], a[208:211], a[160:163], v[216:219]
 v_add_f32 v114, v114, v14
 v_mfma_f32_16x16x32_bf16 v[216:219], a[212:215], a[164:167], v[216:219]
 v_mfma_f32_16x16x32_bf16 v[220:223], a[212:215], a[172:175], v[220:223]
 v_add_f32 v115, v115, v15
 v_mfma_f32_16x16x32_bf16 v[220:223], a[208:211], a[168:171], v[220:223]
 v_add_f32 v116, v116, v12
 v_mfma_f32_16x16x32_bf16 v[224:227], a[208:211], a[176:179], v[224:227]
 v_add_f32 v117, v117, v13
 v_mfma_f32_16x16x32_bf16 v[224:227], a[212:215], a[180:183], v[224:227]
 v_mfma_f32_16x16x32_bf16 v[228:231], a[212:215], a[188:191], v[228:231]
 v_add_f32 v118, v118, v14
 v_mfma_f32_16x16x32_bf16 v[228:231], a[208:211], a[184:187], v[228:231]
 v_add_f32 v119, v119, v15
 s_waitcnt vmcnt(9)
 v_mfma_f32_16x16x32_bf16 a[252:255], a[216:219], a[184:187], a[252:255]
 ds_read_b128 a[184:187], v2 offset:61440
 v_add_f32 v120, v120, v12
 v_mfma_f32_16x16x32_bf16 a[252:255], a[220:223], a[188:191], a[252:255]
 global_load_dwordx4 a[212:215], v0, s[70:71] offset:-3072 sc1
 ds_read_b128 a[188:191], v2 offset:62464
 v_mfma_f32_16x16x32_bf16 a[248:251], a[220:223], a[180:183], a[248:251]
 ds_read_b128 a[180:183], v2 offset:58368
 v_add_f32 v121, v121, v13
 v_mfma_f32_16x16x32_bf16 a[248:251], a[216:219], a[176:179], a[248:251]
 global_load_dwordx4 a[208:211], v0, s[70:71] offset:-4096 sc1
 ds_read_b128 a[176:179], v2 offset:57344
 v_mfma_f32_16x16x32_bf16 v[252:255], a[216:219], a[168:171], v[252:255]
 ds_read_b128 a[168:171], v2 offset:53248
 v_add_f32 v122, v122, v14
 v_mfma_f32_16x16x32_bf16 v[252:255], a[220:223], a[172:175], v[252:255]
 ds_read_b128 a[172:175], v2 offset:54272
 v_add_f32 v123, v123, v15
 v_mfma_f32_16x16x32_bf16 v[248:251], a[220:223], a[164:167], v[248:251]
 ds_read_b128 a[164:167], v2 offset:50176
 v_mfma_f32_16x16x32_bf16 v[248:251], a[216:219], a[160:163], v[248:251]
 ds_read_b128 a[160:163], v2 offset:49152
 v_add_f32 v124, v124, v12
 v_mfma_f32_16x16x32_bf16 v[244:247], a[216:219], a[152:155], v[244:247]
 ds_read_b128 a[152:155], v2 offset:45056
 v_add_f32 v125, v125, v13
 v_mfma_f32_16x16x32_bf16 v[244:247], a[220:223], a[156:159], v[244:247]
 ds_read_b128 a[156:159], v2 offset:46080
 v_add_f32 v126, v126, v14
 v_mfma_f32_16x16x32_bf16 v[240:243], a[220:223], a[148:151], v[240:243]
 ds_read_b128 a[148:151], v2 offset:41984
 v_mfma_f32_16x16x32_bf16 v[240:243], a[216:219], a[144:147], v[240:243]
 ds_read_b128 a[144:147], v2 offset:40960
 v_add_f32 v127, v127, v15
 v_mfma_f32_16x16x32_bf16 v[236:239], a[216:219], a[136:139], v[236:239]
 ds_read_b128 a[136:139], v2 offset:36864
 v_add_f32 v128, v128, v12
 v_mfma_f32_16x16x32_bf16 v[236:239], a[220:223], a[140:143], v[236:239]
 ds_read_b128 a[140:143], v2 offset:37888
 v_mfma_f32_16x16x32_bf16 v[232:235], a[220:223], a[132:135], v[232:235]
 ds_read_b128 a[132:135], v2 offset:33792
 v_add_f32 v129, v129, v13
 v_mfma_f32_16x16x32_bf16 v[232:235], a[216:219], a[128:131], v[232:235]
 ds_read_b128 a[128:131], v2 offset:32768
 v_add_f32 v130, v130, v14
 s_waitcnt vmcnt(9) lgkmcnt(8)
 v_mfma_f32_16x16x32_bf16 v[164:167], a[224:227], a[184:187], v[164:167]
 v_mfma_f32_16x16x32_bf16 v[164:167], a[228:231], a[188:191], v[164:167]
 global_load_dwordx4 a[220:223], v0, s[70:71] offset:-1024 sc1
 v_add_f32 v131, v131, v15
 v_mfma_f32_16x16x32_bf16 v[160:163], a[228:231], a[180:183], v[160:163]
 v_add_f32 v132, v132, v12
 v_mfma_f32_16x16x32_bf16 v[160:163], a[224:227], a[176:179], v[160:163]
 global_load_dwordx4 a[216:219], v0, s[70:71] offset:-2048 sc1
 v_add_f32 v133, v133, v13
 v_mfma_f32_16x16x32_bf16 v[156:159], a[224:227], a[168:171], v[156:159]
 v_mfma_f32_16x16x32_bf16 v[156:159], a[228:231], a[172:175], v[156:159]
 v_add_f32 v134, v134, v14
 v_mfma_f32_16x16x32_bf16 v[152:155], a[228:231], a[164:167], v[152:155]
 v_add_f32 v135, v135, v15
 v_mfma_f32_16x16x32_bf16 v[152:155], a[224:227], a[160:163], v[152:155]
 s_waitcnt lgkmcnt(0)
 v_mfma_f32_16x16x32_bf16 v[148:151], a[224:227], a[152:155], v[148:151]
 v_accvgpr_read_b32 v5, a240
 v_mfma_f32_16x16x32_bf16 v[148:151], a[228:231], a[156:159], v[148:151]
 v_add_f32 v5, v5, v12
 v_mfma_f32_16x16x32_bf16 v[144:147], a[228:231], a[148:151], v[144:147]
 v_mfma_f32_16x16x32_bf16 v[144:147], a[224:227], a[144:147], v[144:147]
 v_accvgpr_write_b32 a240, v5
 v_mfma_f32_16x16x32_bf16 v[140:143], a[224:227], a[136:139], v[140:143]
 v_accvgpr_read_b32 v6, a241
 v_mfma_f32_16x16x32_bf16 v[140:143], a[228:231], a[140:143], v[140:143]
 v_mfma_f32_16x16x32_bf16 v[136:139], a[228:231], a[132:135], v[136:139]
 v_add_f32 v6, v6, v13
 v_mfma_f32_16x16x32_bf16 v[136:139], a[224:227], a[128:131], v[136:139]
 v_accvgpr_write_b32 a241, v6
 s_waitcnt vmcnt(9)
 v_mfma_f32_16x16x32_bf16 v[168:171], a[232:235], a[128:131], v[168:171]
 v_accvgpr_read_b32 v5, a242
 v_mfma_f32_16x16x32_bf16 v[168:171], a[236:239], a[132:135], v[168:171]
 global_load_dwordx4 a[228:231], v0, s[70:71] offset:1024 sc1
 v_mfma_f32_16x16x32_bf16 v[172:175], a[236:239], a[140:143], v[172:175]
 v_add_f32 v5, v5, v14
 v_mfma_f32_16x16x32_bf16 v[172:175], a[232:235], a[136:139], v[172:175]
 global_load_dwordx4 a[224:227], v0, s[70:71] offset:0 sc1
 v_accvgpr_write_b32 a242, v5
 v_mfma_f32_16x16x32_bf16 v[176:179], a[232:235], a[144:147], v[176:179]
 v_mfma_f32_16x16x32_bf16 v[176:179], a[236:239], a[148:151], v[176:179]
 v_accvgpr_read_b32 v6, a243
 v_mfma_f32_16x16x32_bf16 v[180:183], a[236:239], a[156:159], v[180:183]
 v_add_f32 v6, v6, v15
 v_mfma_f32_16x16x32_bf16 v[180:183], a[232:235], a[152:155], v[180:183]
 v_mfma_f32_16x16x32_bf16 v[184:187], a[232:235], a[160:163], v[184:187]
 v_accvgpr_write_b32 a243, v6
 v_mfma_f32_16x16x32_bf16 v[184:187], a[236:239], a[164:167], v[184:187]
 v_accvgpr_read_b32 v5, a244
 v_mfma_f32_16x16x32_bf16 v[188:191], a[236:239], a[172:175], v[188:191]
 v_add_f32 v5, v5, v12
 v_mfma_f32_16x16x32_bf16 v[188:191], a[232:235], a[168:171], v[188:191]
 v_mfma_f32_16x16x32_bf16 v[192:195], a[232:235], a[176:179], v[192:195]
 v_accvgpr_write_b32 a244, v5
 v_mfma_f32_16x16x32_bf16 v[192:195], a[236:239], a[180:183], v[192:195]
 v_accvgpr_read_b32 v6, a245
 v_mfma_f32_16x16x32_bf16 v[196:199], a[236:239], a[188:191], v[196:199]
 v_mfma_f32_16x16x32_bf16 v[196:199], a[232:235], a[184:187], v[196:199]
 v_add_f32 v6, v6, v13
 s_waitcnt vmcnt(8)
 v_mfma_f32_16x16x32_bf16 v[228:231], a[192:195], a[184:187], v[228:231]
 v_accvgpr_write_b32 a245, v6
 v_mfma_f32_16x16x32_bf16 v[228:231], a[196:199], a[188:191], v[228:231]
 global_load_dwordx4 a[236:239], v0, s[70:71] offset:3072 sc1
 v_mfma_f32_16x16x32_bf16 v[224:227], a[196:199], a[180:183], v[224:227]
 v_accvgpr_read_b32 v5, a246
 v_mfma_f32_16x16x32_bf16 v[224:227], a[192:195], a[176:179], v[224:227]
 global_load_dwordx4 a[232:235], v0, s[70:71] offset:2048 sc1
 v_add_f32 v5, v5, v14
 v_mfma_f32_16x16x32_bf16 v[220:223], a[192:195], a[168:171], v[220:223]
 v_accvgpr_write_b32 a246, v5
 s_add_u32 s70, s70, 8192
 s_addc_u32 s71, s71, 0
 v_mfma_f32_16x16x32_bf16 v[220:223], a[196:199], a[172:175], v[220:223]
 v_mfma_f32_16x16x32_bf16 v[216:219], a[196:199], a[164:167], v[216:219]
 v_accvgpr_read_b32 v6, a247
 v_mfma_f32_16x16x32_bf16 v[216:219], a[192:195], a[160:163], v[216:219]
 v_add_f32 v6, v6, v15
 v_mfma_f32_16x16x32_bf16 v[212:215], a[192:195], a[152:155], v[212:215]
 v_mfma_f32_16x16x32_bf16 v[212:215], a[196:199], a[156:159], v[212:215]
 v_accvgpr_write_b32 a247, v6
 v_mfma_f32_16x16x32_bf16 v[208:211], a[196:199], a[148:151], v[208:211]
 v_cmp_gt_i32 vcc, s55, v4
 s_and_b64 vcc, exec, vcc
 s_cbranch_vccnz Lspin_pa
Lok_pa:
 s_add_u32 s55, s55, 1
 s_waitcnt lgkmcnt(0)
 s_barrier
 v_mfma_f32_16x16x32_bf16 v[208:211], a[192:195], a[144:147], v[208:211]
 v_mfma_f32_16x16x32_bf16 v[204:207], a[192:195], a[136:139], v[204:207]
 v_mfma_f32_16x16x32_bf16 v[204:207], a[196:199], a[140:143], v[204:207]
 v_mfma_f32_16x16x32_bf16 v[200:203], a[196:199], a[132:135], v[200:203]
 v_mfma_f32_16x16x32_bf16 v[200:203], a[192:195], a[128:131], v[200:203]
 s_waitcnt vmcnt(8)
 v_mfma_f32_16x16x32_bf16 v[232:235], a[200:203], a[128:131], v[232:235]
 ds_read_b128 a[128:131], v1 offset:2048
 v_mfma_f32_16x16x32_bf16 v[232:235], a[204:207], a[132:135], v[232:235]
 global_load_dwordx4 a[196:199], v0, s[70:71] offset:-3072 sc1
 ds_read_b128 a[132:135], v1 offset:3072
 v_mfma_f32_16x16x32_bf16 v[236:239], a[204:207], a[140:143], v[236:239]
 ds_read_b128 a[140:143], v1 offset:7168
 v_mfma_f32_16x16x32_bf16 v[236:239], a[200:203], a[136:139], v[236:239]
 global_load_dwordx4 a[192:195], v0, s[70:71] offset:-4096 sc1
 ds_read_b128 a[136:139], v1 offset:6144
 v_mfma_f32_16x16x32_bf16 v[240:243], a[200:203], a[144:147], v[240:243]
 ds_read_b128 a[144:147], v1 offset:10240
 v_mfma_f32_16x16x32_bf16 v[240:243], a[204:207], a[148:151], v[240:243]
 ds_read_b128 a[148:151], v1 offset:11264
 v_mfma_f32_16x16x32_bf16 v[244:247], a[204:207], a[156:159], v[244:247]
 ds_read_b128 a[156:159], v1 offset:15360
 v_mfma_f32_16x16x32_bf16 v[244:247], a[200:203], a[152:155], v[244:247]
 ds_read_b128 a[152:155], v1 offset:14336
 v_mfma_f32_16x16x32_bf16 v[248:251], a[200:203], a[160:163], v[248:251]
 ds_read_b128 a[160:163], v1 offset:18432
 v_mfma_f32_16x16x32_bf16 v[248:251], a[204:207], a[164:167], v[248:251]
 ds_read_b128 a[164:167], v1 offset:19456
 v_mfma_f32_16x16x32_bf16 v[252:255], a[204:207], a[172:175], v[252:255]
 ds_read_b128 a[172:175], v1 offset:23552
 v_mfma_f32_16x16x32_bf16 v[252:255], a[200:203], a[168:171], v[252:255]
 ds_read_b128 a[168:171], v1 offset:22528
 v_mfma_f32_16x16x32_bf16 a[248:251], a[200:203], a[176:179], a[248:251]
 ds_read_b128 a[176:179], v1 offset:26624
 v_mfma_f32_16x16x32_bf16 a[248:251], a[204:207], a[180:183], a[248:251]
 ds_read_b128 a[180:183], v1 offset:27648
 v_mfma_f32_16x16x32_bf16 a[252:255], a[204:207], a[188:191], a[252:255]
 global_load_dwordx4 a[204:207], v0, s[70:71] offset:-1024 sc1
 ds_read_b128 a[188:191], v1 offset:31744
 v_mfma_f32_16x16x32_bf16 a[252:255], a[200:203], a[184:187], a[252:255]
 global_load_dwordx4 a[200:203], v0, s[70:71] offset:-2048 sc1
 ds_read_b128 a[184:187], v1 offset:30720
 s_waitcnt vmcnt(10) lgkmcnt(8)
 s_branch Lloop
Llast:
 v_mfma_f32_16x16x32_bf16 v[136:139], a[208:211], a[128:131], v[136:139]
 v_accvgpr_read_b32 v5, a0
 v_lshlrev_b32 v6, 16, v5
 v_mfma_f32_16x16x32_bf16 v[136:139], a[212:215], a[132:135], v[136:139]
 v_and_b32 v5, s26, v5
 v_mul_f32 v6, v6, v16
 v_mfma_f32_16x16x32_bf16 v[140:143], a[212:215], a[140:143], v[140:143]
 v_mul_f32 v5, v5, v17
 v_cvt_pk_bf16_f32 v8, v6, v5
 v_mfma_f32_16x16x32_bf16 v[140:143], a[208:211], a[136:139], v[140:143]
 v_accvgpr_read_b32 v5, a1
 v_lshlrev_b32 v6, 16, v5
 v_mfma_f32_16x16x32_bf16 v[144:147], a[208:211], a[144:147], v[144:147]
 v_and_b32 v5, s26, v5
 v_mul_f32 v6, v6, v18
 v_mfma_f32_16x16x32_bf16 v[144:147], a[212:215], a[148:151], v[144:147]
 v_mul_f32 v5, v5, v19
 v_cvt_pk_bf16_f32 v9, v6, v5
 v_mfma_f32_16x16x32_bf16 v[148:151], a[212:215], a[156:159], v[148:151]
 v_accvgpr_read_b32 v5, a2
 v_lshlrev_b32 v6, 16, v5
 v_mfma_f32_16x16x32_bf16 v[148:151], a[208:211], a[152:155], v[148:151]
 v_and_b32 v5, s26, v5
 v_mul_f32 v6, v6, v48
 s_waitcnt lgkmcnt(0)
 v_mfma_f32_16x16x32_bf16 v[152:155], a[208:211], a[160:163], v[152:155]
 v_mul_f32 v5, v5, v49
 v_cvt_pk_bf16_f32 v10, v6, v5
 v_mfma_f32_16x16x32_bf16 v[152:155], a[212:215], a[164:167], v[152:155]
 v_accvgpr_read_b32 v5, a3
 v_lshlrev_b32 v6, 16, v5
 v_mfma_f32_16x16x32_bf16 v[156:159], a[212:215], a[172:175], v[156:159]
 v_and_b32 v5, s26, v5
 v_mul_f32 v6, v6, v50
 v_mfma_f32_16x16x32_bf16 v[156:159], a[208:211], a[168:171], v[156:159]
 v_mul_f32 v5, v5, v51
 v_cvt_pk_bf16_f32 v11, v6, v5
 v_mfma_f32_16x16x32_bf16 v[160:163], a[208:211], a[176:179], v[160:163]
 v_lshrrev_b32 v5, 7, v1
 v_lshlrev_b32 v6, 4, v5
 v_mfma_f32_16x16x32_bf16 v[160:163], a[212:215], a[180:183], v[160:163]
 v_xor_b32 v6, v6, v1
 v_and_b32 v6, 112, v6
 v_mfma_f32_16x16x32_bf16 v[164:167], a[212:215], a[188:191], v[164:167]
 v_lshl_add_u32 v16, v5, 11, v6
 v_lshrrev_b32 v5, 4, v1
 v_mfma_f32_16x16x32_bf16 v[164:167], a[208:211], a[184:187], v[164:167]
 v_and_b32 v5, 48, v5
 v_xor_b32 v5, v5, v1
 s_waitcnt vmcnt(8)
 v_mfma_f32_16x16x32_bf16 v[196:199], a[216:219], a[184:187], v[196:199]
 v_and_b32 v5, 112, v5
 v_and_b32 v6, 240, v1
 v_mfma_f32_16x16x32_bf16 v[196:199], a[220:223], a[188:191], v[196:199]
 global_load_dwordx4 a[212:215], v0, s[70:71] offset:1024 sc1
 v_lshl_add_u32 v5, v6, 3, v5
 v_mfma_f32_16x16x32_bf16 v[192:195], a[220:223], a[180:183], v[192:195]
 v_add_u32 v17, s50, v5
 v_xor_b32 v18, 64, v17
 v_mfma_f32_16x16x32_bf16 v[192:195], a[216:219], a[176:179], v[192:195]
 global_load_dwordx4 a[208:211], v0, s[70:71] offset:0 sc1
 ds_write_b128 v17, v[8:11]
 v_mfma_f32_16x16x32_bf16 v[188:191], a[216:219], a[168:171], v[188:191]
 v_accvgpr_read_b32 v5, a32
 v_lshlrev_b32 v6, 16, v5
 v_mfma_f32_16x16x32_bf16 v[188:191], a[220:223], a[172:175], v[188:191]
 v_and_b32 v5, s26, v5
 v_mul_f32 v6, v6, v80
 v_mfma_f32_16x16x32_bf16 v[184:187], a[220:223], a[164:167], v[184:187]
 v_mul_f32 v5, v5, v81
 v_cvt_pk_bf16_f32 v12, v6, v5
 v_mfma_f32_16x16x32_bf16 v[184:187], a[216:219], a[160:163], v[184:187]
 v_accvgpr_read_b32 v5, a33
 v_lshlrev_b32 v6, 16, v5
 v_mfma_f32_16x16x32_bf16 v[180:183], a[216:219], a[152:155], v[180:183]
 v_and_b32 v5, s26, v5
 v_mul_f32 v6, v6, v82
 v_mfma_f32_16x16x32_bf16 v[180:183], a[220:223], a[156:159], v[180:183]
 v_mul_f32 v5, v5, v83
 v_cvt_pk_bf16_f32 v13, v6, v5
 v_mfma_f32_16x16x32_bf16 v[176:179], a[220:223], a[148:151], v[176:179]
 v_accvgpr_read_b32 v5, a34
 v_lshlrev_b32 v6, 16, v5
 v_mfma_f32_16x16x32_bf16 v[176:179], a[216:219], a[144:147], v[176:179]
 v_and_b32 v5, s26, v5
 v_mul_f32 v6, v6, v112
 v_mfma_f32_16x16x32_bf16 v[172:175], a[216:219], a[136:139], v[172:175]
 v_mul_f32 v5, v5, v113
 v_cvt_pk_bf16_f32 v14, v6, v5
 v_mfma_f32_16x16x32_bf16 v[172:175], a[220:223], a[140:143], v[172:175]
 v_accvgpr_read_b32 v5, a35
 v_lshlrev_b32 v6, 16, v5
 v_mfma_f32_16x16x32_bf16 v[168:171], a[220:223], a[132:135], v[168:171]
 v_and_b32 v5, s26, v5
 v_mul_f32 v6, v6, v114
 v_mfma_f32_16x16x32_bf16 v[168:171], a[216:219], a[128:131], v[168:171]
 v_mul_f32 v5, v5, v115
 v_cvt_pk_bf16_f32 v15, v6, v5
 s_waitcnt vmcnt(8)
 v_mfma_f32_16x16x32_bf16 v[200:203], a[224:227], a[128:131], v[200:203]
 ds_write_b128 v18, v[12:15]
 v_mfma_f32_16x16x32_bf16 v[200:203], a[228:231], a[132:135], v[200:203]
 global_load_dwordx4 a[220:223], v0, s[70:71] offset:3072 sc1
 ds_read_b128 v[48:51], v3
 v_mfma_f32_16x16x32_bf16 v[204:207], a[228:231], a[140:143], v[204:207]
 ds_read_b128 v[80:83], v3 offset:1024
 v_accvgpr_read_b32 v5, a4
 v_mfma_f32_16x16x32_bf16 v[204:207], a[224:227], a[136:139], v[204:207]
 global_load_dwordx4 a[216:219], v0, s[70:71] offset:2048 sc1
 v_lshlrev_b32 v6, 16, v5
 v_mfma_f32_16x16x32_bf16 v[208:211], a[224:227], a[144:147], v[208:211]
 v_and_b32 v5, s26, v5
 v_mul_f32 v6, v6, v20
 s_add_u32 s70, s70, 8192
 s_addc_u32 s71, s71, 0
 v_mfma_f32_16x16x32_bf16 v[208:211], a[228:231], a[148:151], v[208:211]
 v_mul_f32 v5, v5, v21
 v_cvt_pk_bf16_f32 v8, v6, v5
 v_mfma_f32_16x16x32_bf16 v[212:215], a[228:231], a[156:159], v[212:215]
 v_accvgpr_read_b32 v5, a5
 v_lshlrev_b32 v6, 16, v5
 v_mfma_f32_16x16x32_bf16 v[212:215], a[224:227], a[152:155], v[212:215]
 v_and_b32 v5, s26, v5
 v_mul_f32 v6, v6, v22
 v_mfma_f32_16x16x32_bf16 v[216:219], a[224:227], a[160:163], v[216:219]
 v_mul_f32 v5, v5, v23
 v_cvt_pk_bf16_f32 v9, v6, v5
 s_waitcnt lgkmcnt(1)
 s_add_u32 s3, s28, 0
 v_mfma_f32_16x16x32_bf16 v[216:219], a[228:231], a[164:167], v[216:219]
 buffer_store_dwordx4 v[48:51], v16, s[16:19], s3 offen nt
 s_waitcnt lgkmcnt(0)
 s_add_u32 s3, s28, 16384
 buffer_store_dwordx4 v[80:83], v16, s[16:19], s3 offen nt
 v_accvgpr_read_b32 v5, a6
 v_lshlrev_b32 v6, 16, v5
 v_and_b32 v5, s26, v5
 v_mul_f32 v6, v6, v52
 v_mfma_f32_16x16x32_bf16 v[220:223], a[228:231], a[172:175], v[220:223]
 v_mul_f32 v5, v5, v53
 v_cvt_pk_bf16_f32 v10, v6, v5
 v_mfma_f32_16x16x32_bf16 v[220:223], a[224:227], a[168:171], v[220:223]
 v_accvgpr_read_b32 v5, a7
 v_lshlrev_b32 v6, 16, v5
 v_mfma_f32_16x16x32_bf16 v[224:227], a[224:227], a[176:179], v[224:227]
 v_and_b32 v5, s26, v5
 v_mul_f32 v6, v6, v54
 v_mul_f32 v5, v5, v55
 v_cvt_pk_bf16_f32 v11, v6, v5
 v_mfma_f32_16x16x32_bf16 v[224:227], a[228:231], a[180:183], v[224:227]
 ds_write_b128 v17, v[8:11] offset:4096
 v_mfma_f32_16x16x32_bf16 v[228:231], a[228:231], a[188:191], v[228:231]
 v_accvgpr_read_b32 v5, a36
 v_lshlrev_b32 v6, 16, v5
 v_mfma_f32_16x16x32_bf16 v[228:231], a[224:227], a[184:187], v[228:231]
 v_and_b32 v5, s26, v5
 v_mul_f32 v6, v6, v84
 s_waitcnt vmcnt(10)
 v_mfma_f32_16x16x32_bf16 a[252:255], a[232:235], a[184:187], a[252:255]
 ds_read_b128 a[184:187], v1 offset:63488
 v_mul_f32 v5, v5, v85
 v_mfma_f32_16x16x32_bf16 a[252:255], a[236:239], a[188:191], a[252:255]
 global_load_dwordx4 a[228:231], v0, s[70:71] offset:-3072 sc1
 ds_read_b128 a[188:191], v1 offset:64512
 v_mfma_f32_16x16x32_bf16 a[248:251], a[236:239], a[180:183], a[248:251]
 ds_read_b128 a[180:183], v1 offset:60416
 v_cvt_pk_bf16_f32 v12, v6, v5
 v_mfma_f32_16x16x32_bf16 a[248:251], a[232:235], a[176:179], a[248:251]
 global_load_dwordx4 a[224:227], v0, s[70:71] offset:-4096 sc1
 ds_read_b128 a[176:179], v1 offset:59392
 v_mfma_f32_16x16x32_bf16 v[252:255], a[232:235], a[168:171], v[252:255]
 ds_read_b128 a[168:171], v1 offset:55296
 v_accvgpr_read_b32 v5, a37
 v_mfma_f32_16x16x32_bf16 v[252:255], a[236:239], a[172:175], v[252:255]
 ds_read_b128 a[172:175], v1 offset:56320
 v_lshlrev_b32 v6, 16, v5
 v_mfma_f32_16x16x32_bf16 v[248:251], a[236:239], a[164:167], v[248:251]
 ds_read_b128 a[164:167], v1 offset:52224
 v_and_b32 v5, s26, v5
 v_mfma_f32_16x16x32_bf16 v[248:251], a[232:235], a[160:163], v[248:251]
 ds_read_b128 a[160:163], v1 offset:51200
 v_mul_f32 v6, v6, v86
 v_mul_f32 v5, v5, v87
 v_mfma_f32_16x16x32_bf16 v[244:247], a[232:235], a[152:155], v[244:247]
 ds_read_b128 a[152:155], v1 offset:47104
 v_cvt_pk_bf16_f32 v13, v6, v5
 v_mfma_f32_16x16x32_bf16 v[244:247], a[236:239], a[156:159], v[244:247]
 ds_read_b128 a[156:159], v1 offset:48128
 v_accvgpr_read_b32 v5, a38
 v_lshlrev_b32 v6, 16, v5
 v_mfma_f32_16x16x32_bf16 v[240:243], a[236:239], a[148:151], v[240:243]
 ds_read_b128 a[148:151], v1 offset:44032
 v_and_b32 v5, s26, v5
 v_mul_f32 v6, v6, v116
 v_mfma_f32_16x16x32_bf16 v[240:243], a[232:235], a[144:147], v[240:243]
 ds_read_b128 a[144:147], v1 offset:43008
 v_mul_f32 v5, v5, v117
 v_mfma_f32_16x16x32_bf16 v[236:239], a[232:235], a[136:139], v[236:239]
 ds_read_b128 a[136:139], v1 offset:38912
 v_cvt_pk_bf16_f32 v14, v6, v5
 v_mfma_f32_16x16x32_bf16 v[236:239], a[236:239], a[140:143], v[236:239]
 ds_read_b128 a[140:143], v1 offset:39936
 v_accvgpr_read_b32 v5, a39
 v_mfma_f32_16x16x32_bf16 v[232:235], a[236:239], a[132:135], v[232:235]
 ds_read_b128 a[132:135], v1 offset:35840
 v_lshlrev_b32 v6, 16, v5
 v_mfma_f32_16x16x32_bf16 v[232:235], a[232:235], a[128:131], v[232:235]
 ds_read_b128 a[128:131], v1 offset:34816
 v_and_b32 v5, s26, v5
 s_waitcnt vmcnt(10) lgkmcnt(8)
 v_mfma_f32_16x16x32_bf16 v[164:167], a[192:195], a[184:187], v[164:167]
 v_mul_f32 v6, v6, v118
 v_mul_f32 v5, v5, v119
 v_mfma_f32_16x16x32_bf16 v[164:167], a[196:199], a[188:191], v[164:167]
 global_load_dwordx4 a[236:239], v0, s[70:71] offset:-1024 sc1
 v_cvt_pk_bf16_f32 v15, v6, v5
 v_mfma_f32_16x16x32_bf16 v[160:163], a[196:199], a[180:183], v[160:163]
 ds_write_b128 v18, v[12:15] offset:4096
 ds_read_b128 v[48:51], v3 offset:4096
 v_mfma_f32_16x16x32_bf16 v[160:163], a[192:195], a[176:179], v[160:163]
 global_load_dwordx4 a[232:235], v0, s[70:71] offset:-2048 sc1
 ds_read_b128 v[80:83], v3 offset:5120
 v_mfma_f32_16x16x32_bf16 v[156:159], a[192:195], a[168:171], v[156:159]
 v_accvgpr_read_b32 v5, a8
 v_lshlrev_b32 v6, 16, v5
 v_mfma_f32_16x16x32_bf16 v[156:159], a[196:199], a[172:175], v[156:159]
 v_and_b32 v5, s26, v5
 v_mul_f32 v6, v6, v24
 v_mfma_f32_16x16x32_bf16 v[152:155], a[196:199], a[164:167], v[152:155]
 v_mul_f32 v5, v5, v25
 v_cvt_pk_bf16_f32 v8, v6, v5
 v_mfma_f32_16x16x32_bf16 v[152:155], a[192:195], a[160:163], v[152:155]
 v_accvgpr_read_b32 v5, a9
 v_lshlrev_b32 v6, 16, v5
 s_waitcnt lgkmcnt(3)
 v_mfma_f32_16x16x32_bf16 v[148:151], a[192:195], a[152:155], v[148:151]
 v_and_b32 v5, s26, v5
 v_mul_f32 v6, v6, v26
 v_mfma_f32_16x16x32_bf16 v[148:151], a[196:199], a[156:159], v[148:151]
 v_mul_f32 v5, v5, v27
 v_cvt_pk_bf16_f32 v9, v6, v5
 s_waitcnt lgkmcnt(1)
 s_add_u32 s3, s28, 32768
 v_mfma_f32_16x16x32_bf16 v[144:147], a[196:199], a[148:151], v[144:147]
 buffer_store_dwordx4 v[48:51], v16, s[16:19], s3 offen nt
 s_waitcnt lgkmcnt(0)
 s_add_u32 s3, s28, 49152
 buffer_store_dwordx4 v[80:83], v16, s[16:19], s3 offen nt
 v_accvgpr_read_b32 v5, a10
 v_lshlrev_b32 v6, 16, v5
 v_and_b32 v5, s26, v5
 v_mul_f32 v6, v6, v56
 v_mfma_f32_16x16x32_bf16 v[144:147], a[192:195], a[144:147], v[144:147]
 v_mul_f32 v5, v5, v57
 v_cvt_pk_bf16_f32 v10, v6, v5
 v_mfma_f32_16x16x32_bf16 v[140:143], a[192:195], a[136:139], v[140:143]
 v_accvgpr_read_b32 v5, a11
 v_lshlrev_b32 v6, 16, v5
 v_mfma_f32_16x16x32_bf16 v[140:143], a[196:199], a[140:143], v[140:143]
 v_and_b32 v5, s26, v5
 v_mul_f32 v6, v6, v58
 v_mfma_f32_16x16x32_bf16 v[136:139], a[196:199], a[132:135], v[136:139]
 v_mul_f32 v5, v5, v59
 v_cvt_pk_bf16_f32 v11, v6, v5
 v_mfma_f32_16x16x32_bf16 v[136:139], a[192:195], a[128:131], v[136:139]
 ds_write_b128 v17, v[8:11] offset:8192
 s_waitcnt vmcnt(12)
 v_mfma_f32_16x16x32_bf16 v[168:171], a[200:203], a[128:131], v[168:171]
 v_accvgpr_read_b32 v5, a40
 v_lshlrev_b32 v6, 16, v5
 v_mfma_f32_16x16x32_bf16 v[168:171], a[204:207], a[132:135], v[168:171]
 global_load_dwordx4 a[196:199], v0, s[70:71] offset:1024 sc1
 v_and_b32 v5, s26, v5
 v_mfma_f32_16x16x32_bf16 v[172:175], a[204:207], a[140:143], v[172:175]
 v_mul_f32 v6, v6, v88
 v_mul_f32 v5, v5, v89
 v_mfma_f32_16x16x32_bf16 v[172:175], a[200:203], a[136:139], v[172:175]
 global_load_dwordx4 a[192:195], v0, s[70:71] offset:0 sc1
 v_cvt_pk_bf16_f32 v12, v6, v5
 v_mfma_f32_16x16x32_bf16 v[176:179], a[200:203], a[144:147], v[176:179]
 v_accvgpr_read_b32 v5, a41
 v_lshlrev_b32 v6, 16, v5
 v_mfma_f32_16x16x32_bf16 v[176:179], a[204:207], a[148:151], v[176:179]
 v_and_b32 v5, s26, v5
 v_mul_f32 v6, v6, v90
 v_mfma_f32_16x16x32_bf16 v[180:183], a[204:207], a[156:159], v[180:183]
 v_mul_f32 v5, v5, v91
 v_cvt_pk_bf16_f32 v13, v6, v5
 v_mfma_f32_16x16x32_bf16 v[180:183], a[200:203], a[152:155], v[180:183]
 v_accvgpr_read_b32 v5, a42
 v_lshlrev_b32 v6, 16, v5
 v_mfma_f32_16x16x32_bf16 v[184:187], a[200:203], a[160:163], v[184:187]
 v_and_b32 v5, s26, v5
 v_mul_f32 v6, v6, v120
 v_mfma_f32_16x16x32_bf16 v[184:187], a[204:207], a[164:167], v[184:187]
 v_mul_f32 v5, v5, v121
 v_cvt_pk_bf16_f32 v14, v6, v5
 v_mfma_f32_16x16x32_bf16 v[188:191], a[204:207], a[172:175], v[188:191]
 v_accvgpr_read_b32 v5, a43
 v_lshlrev_b32 v6, 16, v5
 v_mfma_f32_16x16x32_bf16 v[188:191], a[200:203], a[168:171], v[188:191]
 v_and_b32 v5, s26, v5
 v_mul_f32 v6, v6, v122
 v_mfma_f32_16x16x32_bf16 v[192:195], a[200:203], a[176:179], v[192:195]
 v_mul_f32 v5, v5, v123
 v_cvt_pk_bf16_f32 v15, v6, v5
 v_mfma_f32_16x16x32_bf16 v[192:195], a[204:207], a[180:183], v[192:195]
 ds_write_b128 v18, v[12:15] offset:8192
 v_mfma_f32_16x16x32_bf16 v[196:199], a[204:207], a[188:191], v[196:199]
 ds_read_b128 v[48:51], v3 offset:8192
 ds_read_b128 v[80:83], v3 offset:9216
 v_mfma_f32_16x16x32_bf16 v[196:199], a[200:203], a[184:187], v[196:199]
 v_accvgpr_read_b32 v5, a12
 v_lshlrev_b32 v6, 16, v5
 s_waitcnt vmcnt(12)
 v_mfma_f32_16x16x32_bf16 v[228:231], a[208:211], a[184:187], v[228:231]
 v_and_b32 v5, s26, v5
 v_mul_f32 v6, v6, v28
 v_mfma_f32_16x16x32_bf16 v[228:231], a[212:215], a[188:191], v[228:231]
 global_load_dwordx4 a[204:207], v0, s[70:71] offset:3072 sc1
 v_mul_f32 v5, v5, v29
 v_mfma_f32_16x16x32_bf16 v[224:227], a[212:215], a[180:183], v[224:227]
 v_cvt_pk_bf16_f32 v8, v6, v5
 v_accvgpr_read_b32 v5, a13
 v_mfma_f32_16x16x32_bf16 v[224:227], a[208:211], a[176:179], v[224:227]
 global_load_dwordx4 a[200:203], v0, s[70:71] offset:2048 sc1
 v_lshlrev_b32 v6, 16, v5
 v_mfma_f32_16x16x32_bf16 v[220:223], a[208:211], a[168:171], v[220:223]
 v_and_b32 v5, s26, v5
 v_mul_f32 v6, v6, v30
 s_add_u32 s70, s70, 8192
 s_addc_u32 s71, s71, 0
 v_mfma_f32_16x16x32_bf16 v[220:223], a[212:215], a[172:175], v[220:223]
 v_mul_f32 v5, v5, v31
 v_cvt_pk_bf16_f32 v9, v6, v5
 s_waitcnt lgkmcnt(1)
 v_mfma_f32_16x16x32_bf16 v[216:219], a[212:215], a[164:167], v[216:219]
 s_add_u32 s3, s28, 65536
 buffer_store_dwordx4 v[48:51], v16, s[16:19], s3 offen nt
 s_waitcnt lgkmcnt(0)
 v_mfma_f32_16x16x32_bf16 v[216:219], a[208:211], a[160:163], v[216:219]
 s_add_u32 s3, s28, 81920
 buffer_store_dwordx4 v[80:83], v16, s[16:19], s3 offen nt
 v_accvgpr_read_b32 v5, a14
 v_lshlrev_b32 v6, 16, v5
 v_and_b32 v5, s26, v5
 v_mul_f32 v6, v6, v60
 v_mfma_f32_16x16x32_bf16 v[212:215], a[208:211], a[152:155], v[212:215]
 v_mul_f32 v5, v5, v61
 v_cvt_pk_bf16_f32 v10, v6, v5
 v_mfma_f32_16x16x32_bf16 v[212:215], a[212:215], a[156:159], v[212:215]
 v_accvgpr_read_b32 v5, a15
 v_lshlrev_b32 v6, 16, v5
 v_mfma_f32_16x16x32_bf16 v[208:211], a[212:215], a[148:151], v[208:211]
 v_and_b32 v5, s26, v5
 v_mul_f32 v6, v6, v62
 v_mfma_f32_16x16x32_bf16 v[208:211], a[208:211], a[144:147], v[208:211]
 v_mul_f32 v5, v5, v63
 v_cvt_pk_bf16_f32 v11, v6, v5
 v_mfma_f32_16x16x32_bf16 v[204:207], a[208:211], a[136:139], v[204:207]
 ds_write_b128 v17, v[8:11] offset:12288
 v_mfma_f32_16x16x32_bf16 v[204:207], a[212:215], a[140:143], v[204:207]
 v_accvgpr_read_b32 v5, a44
 v_lshlrev_b32 v6, 16, v5
 v_mfma_f32_16x16x32_bf16 v[200:203], a[212:215], a[132:135], v[200:203]
 v_and_b32 v5, s26, v5
 v_mul_f32 v6, v6, v92
 v_mfma_f32_16x16x32_bf16 v[200:203], a[208:211], a[128:131], v[200:203]
 v_mul_f32 v5, v5, v93
 v_cvt_pk_bf16_f32 v12, v6, v5
 s_waitcnt vmcnt(14)
 v_mfma_f32_16x16x32_bf16 v[232:235], a[216:219], a[128:131], v[232:235]
 ds_read_b128 a[128:131], v2 offset:2048
 v_accvgpr_read_b32 v5, a45
 v_mfma_f32_16x16x32_bf16 v[232:235], a[220:223], a[132:135], v[232:235]
 global_load_dwordx4 a[212:215], v0, s[70:71] offset:-3072 sc1
 ds_read_b128 a[132:135], v2 offset:3072
 v_mfma_f32_16x16x32_bf16 v[236:239], a[220:223], a[140:143], v[236:239]
 ds_read_b128 a[140:143], v2 offset:7168
 v_lshlrev_b32 v6, 16, v5
 v_mfma_f32_16x16x32_bf16 v[236:239], a[216:219], a[136:139], v[236:239]
 global_load_dwordx4 a[208:211], v0, s[70:71] offset:-4096 sc1
 ds_read_b128 a[136:139], v2 offset:6144
 v_and_b32 v5, s26, v5
 v_mfma_f32_16x16x32_bf16 v[240:243], a[216:219], a[144:147], v[240:243]
 ds_read_b128 a[144:147], v2 offset:10240
 v_mul_f32 v6, v6, v94
 v_mul_f32 v5, v5, v95
 v_mfma_f32_16x16x32_bf16 v[240:243], a[220:223], a[148:151], v[240:243]
 ds_read_b128 a[148:151], v2 offset:11264
 v_cvt_pk_bf16_f32 v13, v6, v5
 v_mfma_f32_16x16x32_bf16 v[244:247], a[220:223], a[156:159], v[244:247]
 ds_read_b128 a[156:159], v2 offset:15360
 v_accvgpr_read_b32 v5, a46
 v_lshlrev_b32 v6, 16, v5
 v_mfma_f32_16x16x32_bf16 v[244:247], a[216:219], a[152:155], v[244:247]
 ds_read_b128 a[152:155], v2 offset:14336
 v_and_b32 v5, s26, v5
 v_mul_f32 v6, v6, v124
 v_mfma_f32_16x16x32_bf16 v[248:251], a[216:219], a[160:163], v[248:251]
 ds_read_b128 a[160:163], v2 offset:18432
 v_mul_f32 v5, v5, v125
 v_mfma_f32_16x16x32_bf16 v[248:251], a[220:223], a[164:167], v[248:251]
 ds_read_b128 a[164:167], v2 offset:19456
 v_cvt_pk_bf16_f32 v14, v6, v5
 v_mfma_f32_16x16x32_bf16 v[252:255], a[220:223], a[172:175], v[252:255]
 ds_read_b128 a[172:175], v2 offset:23552
 v_accvgpr_read_b32 v5, a47
 v_mfma_f32_16x16x32_bf16 v[252:255], a[216:219], a[168:171], v[252:255]
 ds_read_b128 a[168:171], v2 offset:22528
 v_lshlrev_b32 v6, 16, v5
 v_mfma_f32_16x16x32_bf16 a[248:251], a[216:219], a[176:179], a[248:251]
 ds_read_b128 a[176:179], v2 offset:26624
 v_and_b32 v5, s26, v5
 v_mfma_f32_16x16x32_bf16 a[248:251], a[220:223], a[180:183], a[248:251]
 ds_read_b128 a[180:183], v2 offset:27648
 v_mul_f32 v6, v6, v126
 v_mfma_f32_16x16x32_bf16 a[252:255], a[220:223], a[188:191], a[252:255]
 ds_read_b128 a[188:191], v2 offset:31744
 v_mul_f32 v5, v5, v127
 v_mfma_f32_16x16x32_bf16 a[252:255], a[216:219], a[184:187], a[252:255]
 ds_read_b128 a[184:187], v2 offset:30720
 v_cvt_pk_bf16_f32 v15, v6, v5
 s_waitcnt vmcnt(12) lgkmcnt(8)
 v_mfma_f32_16x16x32_bf16 v[136:139], a[224:227], a[128:131], v[136:139]
 ds_write_b128 v18, v[12:15] offset:12288
 ds_read_b128 v[48:51], v3 offset:12288
 ds_read_b128 v[80:83], v3 offset:13312
 v_mfma_f32_16x16x32_bf16 v[136:139], a[228:231], a[132:135], v[136:139]
 global_load_dwordx4 a[220:223], v0, s[70:71] offset:-1024 sc1
 v_accvgpr_read_b32 v5, a16
 v_mfma_f32_16x16x32_bf16 v[140:143], a[228:231], a[140:143], v[140:143]
 v_lshlrev_b32 v6, 16, v5
 v_and_b32 v5, s26, v5
 v_mfma_f32_16x16x32_bf16 v[140:143], a[224:227], a[136:139], v[140:143]
 global_load_dwordx4 a[216:219], v0, s[70:71] offset:-2048 sc1
 v_mul_f32 v6, v6, v32
 v_mfma_f32_16x16x32_bf16 v[144:147], a[224:227], a[144:147], v[144:147]
 v_mul_f32 v5, v5, v33
 v_cvt_pk_bf16_f32 v8, v6, v5
 v_mfma_f32_16x16x32_bf16 v[144:147], a[228:231], a[148:151], v[144:147]
 v_accvgpr_read_b32 v5, a17
 v_lshlrev_b32 v6, 16, v5
 v_mfma_f32_16x16x32_bf16 v[148:151], a[228:231], a[156:159], v[148:151]
 v_and_b32 v5, s26, v5
 v_mul_f32 v6, v6, v34
 v_mfma_f32_16x16x32_bf16 v[148:151], a[224:227], a[152:155], v[148:151]
 v_mul_f32 v5, v5, v35
 v_cvt_pk_bf16_f32 v9, v6, v5
 s_waitcnt lgkmcnt(1)
 s_add_u32 s3, s28, 98304
 v_mfma_f32_16x16x32_bf16 v[152:155], a[224:227], a[160:163], v[152:155]
 buffer_store_dwordx4 v[48:51], v16, s[16:19], s3 offen nt
 s_waitcnt lgkmcnt(0)
 s_add_u32 s3, s28, 114688
 buffer_store_dwordx4 v[80:83], v16, s[16:19], s3 offen nt
 v_accvgpr_read_b32 v5, a18
 v_lshlrev_b32 v6, 16, v5
 v_and_b32 v5, s26, v5
 v_mul_f32 v6, v6, v64
 v_mfma_f32_16x16x32_bf16 v[152:155], a[228:231], a[164:167], v[152:155]
 v_mul_f32 v5, v5, v65
 v_cvt_pk_bf16_f32 v10, v6, v5
 v_mfma_f32_16x16x32_bf16 v[156:159], a[228:231], a[172:175], v[156:159]
 v_accvgpr_read_b32 v5, a19
 v_lshlrev_b32 v6, 16, v5
 v_mfma_f32_16x16x32_bf16 v[156:159], a[224:227], a[168:171], v[156:159]
 v_and_b32 v5, s26, v5
 v_mul_f32 v6, v6, v66
 v_mfma_f32_16x16x32_bf16 v[160:163], a[224:227], a[176:179], v[160:163]
 v_mul_f32 v5, v5, v67
 v_cvt_pk_bf16_f32 v11, v6, v5
 v_mfma_f32_16x16x32_bf16 v[160:163], a[228:231], a[180:183], v[160:163]
 ds_write_b128 v17, v[8:11] offset:16384
 v_mfma_f32_16x16x32_bf16 v[164:167], a[228:231], a[188:191], v[164:167]
 v_accvgpr_read_b32 v5, a48
 v_lshlrev_b32 v6, 16, v5
 v_mfma_f32_16x16x32_bf16 v[164:167], a[224:227], a[184:187], v[164:167]
 v_and_b32 v5, s26, v5
 v_mul_f32 v6, v6, v96
 s_waitcnt vmcnt(14)
 v_mfma_f32_16x16x32_bf16 v[196:199], a[232:235], a[184:187], v[196:199]
 v_mul_f32 v5, v5, v97
 v_cvt_pk_bf16_f32 v12, v6, v5
 v_mfma_f32_16x16x32_bf16 v[196:199], a[236:239], a[188:191], v[196:199]
 global_load_dwordx4 a[228:231], v0, s[70:71] offset:1024 sc1
 v_accvgpr_read_b32 v5, a49
 v_mfma_f32_16x16x32_bf16 v[192:195], a[236:239], a[180:183], v[192:195]
 v_lshlrev_b32 v6, 16, v5
 v_and_b32 v5, s26, v5
 v_mfma_f32_16x16x32_bf16 v[192:195], a[232:235], a[176:179], v[192:195]
 global_load_dwordx4 a[224:227], v0, s[70:71] offset:0 sc1
 v_mul_f32 v6, v6, v98
 v_mfma_f32_16x16x32_bf16 v[188:191], a[232:235], a[168:171], v[188:191]
 v_mul_f32 v5, v5, v99
 v_cvt_pk_bf16_f32 v13, v6, v5
 v_mfma_f32_16x16x32_bf16 v[188:191], a[236:239], a[172:175], v[188:191]
 v_accvgpr_read_b32 v5, a50
 v_lshlrev_b32 v6, 16, v5
 v_mfma_f32_16x16x32_bf16 v[184:187], a[236:239], a[164:167], v[184:187]
 v_and_b32 v5, s26, v5
 v_mul_f32 v6, v6, v128
 v_mfma_f32_16x16x32_bf16 v[184:187], a[232:235], a[160:163], v[184:187]
 v_mul_f32 v5, v5, v129
 v_cvt_pk_bf16_f32 v14, v6, v5
 v_mfma_f32_16x16x32_bf16 v[180:183], a[232:235], a[152:155], v[180:183]
 v_accvgpr_read_b32 v5, a51
 v_lshlrev_b32 v6, 16, v5
 v_mfma_f32_16x16x32_bf16 v[180:183], a[236:239], a[156:159], v[180:183]
 v_and_b32 v5, s26, v5
 v_mul_f32 v6, v6, v130
 v_mfma_f32_16x16x32_bf16 v[176:179], a[236:239], a[148:151], v[176:179]
 v_mul_f32 v5, v5, v131
 v_cvt_pk_bf16_f32 v15, v6, v5
 v_mfma_f32_16x16x32_bf16 v[176:179], a[232:235], a[144:147], v[176:179]
 ds_write_b128 v18, v[12:15] offset:16384
 v_mfma_f32_16x16x32_bf16 v[172:175], a[232:235], a[136:139], v[172:175]
 ds_read_b128 v[48:51], v3 offset:16384
 ds_read_b128 v[80:83], v3 offset:17408
 v_mfma_f32_16x16x32_bf16 v[172:175], a[236:239], a[140:143], v[172:175]
 v_accvgpr_read_b32 v5, a20
 v_lshlrev_b32 v6, 16, v5
 v_mfma_f32_16x16x32_bf16 v[168:171], a[236:239], a[132:135], v[168:171]
 v_and_b32 v5, s26, v5
 v_mul_f32 v6, v6, v36
 v_mfma_f32_16x16x32_bf16 v[168:171], a[232:235], a[128:131], v[168:171]
 v_mul_f32 v5, v5, v37
 v_cvt_pk_bf16_f32 v8, v6, v5
 s_waitcnt vmcnt(12)
 v_mfma_f32_16x16x32_bf16 v[200:203], a[192:195], a[128:131], v[200:203]
 v_accvgpr_read_b32 v5, a21
 v_lshlrev_b32 v6, 16, v5
 v_mfma_f32_16x16x32_bf16 v[200:203], a[196:199], a[132:135], v[200:203]
 global_load_dwordx4 a[236:239], v0, s[70:71] offset:3072 sc1
 v_and_b32 v5, s26, v5
 v_mfma_f32_16x16x32_bf16 v[204:207], a[196:199], a[140:143], v[204:207]
 v_mul_f32 v6, v6, v38
 v_mul_f32 v5, v5, v39
 v_mfma_f32_16x16x32_bf16 v[204:207], a[192:195], a[136:139], v[204:207]
 global_load_dwordx4 a[232:235], v0, s[70:71] offset:2048 sc1
 v_cvt_pk_bf16_f32 v9, v6, v5
 s_waitcnt lgkmcnt(1)
 s_add_u32 s3, s28, 131072
 v_mfma_f32_16x16x32_bf16 v[208:211], a[192:195], a[144:147], v[208:211]
 buffer_store_dwordx4 v[48:51], v16, s[16:19], s3 offen nt
 s_waitcnt lgkmcnt(0)
 s_add_u32 s3, s28, 147456
 s_add_u32 s70, s70, 1843200
 s_addc_u32 s71, s71, 0
 v_mfma_f32_16x16x32_bf16 v[208:211], a[196:199], a[148:151], v[208:211]
 buffer_store_dwordx4 v[80:83], v16, s[16:19], s3 offen nt
 v_accvgpr_read_b32 v5, a22
 v_lshlrev_b32 v6, 16, v5
 v_and_b32 v5, s26, v5
 v_mul_f32 v6, v6, v68
 v_mfma_f32_16x16x32_bf16 v[212:215], a[196:199], a[156:159], v[212:215]
 v_mul_f32 v5, v5, v69
 v_cvt_pk_bf16_f32 v10, v6, v5
 v_mfma_f32_16x16x32_bf16 v[212:215], a[192:195], a[152:155], v[212:215]
 v_accvgpr_read_b32 v5, a23
 v_lshlrev_b32 v6, 16, v5
 v_mfma_f32_16x16x32_bf16 v[216:219], a[192:195], a[160:163], v[216:219]
 v_and_b32 v5, s26, v5
 v_mul_f32 v6, v6, v70
 v_mfma_f32_16x16x32_bf16 v[216:219], a[196:199], a[164:167], v[216:219]
 v_mul_f32 v5, v5, v71
 v_cvt_pk_bf16_f32 v11, v6, v5
 v_mfma_f32_16x16x32_bf16 v[220:223], a[196:199], a[172:175], v[220:223]
 ds_write_b128 v17, v[8:11] offset:20480
 v_mfma_f32_16x16x32_bf16 v[220:223], a[192:195], a[168:171], v[220:223]
 v_accvgpr_read_b32 v5, a52
 v_lshlrev_b32 v6, 16, v5
 v_mfma_f32_16x16x32_bf16 v[224:227], a[192:195], a[176:179], v[224:227]
 v_and_b32 v5, s26, v5
 v_mul_f32 v6, v6, v100
 v_mfma_f32_16x16x32_bf16 v[224:227], a[196:199], a[180:183], v[224:227]
 v_mul_f32 v5, v5, v101
 v_cvt_pk_bf16_f32 v12, v6, v5
 v_mfma_f32_16x16x32_bf16 v[228:231], a[196:199], a[188:191], v[228:231]
 v_accvgpr_read_b32 v5, a53
 v_lshlrev_b32 v6, 16, v5
 v_mfma_f32_16x16x32_bf16 v[228:231], a[192:195], a[184:187], v[228:231]
 v_and_b32 v5, s26, v5
 v_mul_f32 v6, v6, v102
 s_waitcnt vmcnt(14)
 v_mfma_f32_16x16x32_bf16 a[252:255], a[200:203], a[184:187], a[252:255]
 ds_read_b128 a[184:187], v2 offset:63488
 v_mul_f32 v5, v5, v103
 v_mfma_f32_16x16x32_bf16 a[252:255], a[204:207], a[188:191], a[252:255]
 ds_read_b128 a[188:191], v2 offset:64512
 v_cvt_pk_bf16_f32 v13, v6, v5
 v_mfma_f32_16x16x32_bf16 a[248:251], a[204:207], a[180:183], a[248:251]
 ds_read_b128 a[180:183], v2 offset:60416
 v_accvgpr_read_b32 v5, a54
 v_mfma_f32_16x16x32_bf16 a[248:251], a[200:203], a[176:179], a[248:251]
 ds_read_b128 a[176:179], v2 offset:59392
 v_lshlrev_b32 v6, 16, v5
 v_mfma_f32_16x16x32_bf16 v[252:255], a[200:203], a[168:171], v[252:255]
 ds_read_b128 a[168:171], v2 offset:55296
 v_and_b32 v5, s26, v5
 v_mfma_f32_16x16x32_bf16 v[252:255], a[204:207], a[172:175], v[252:255]
 ds_read_b128 a[172:175], v2 offset:56320
 v_mul_f32 v6, v6, v132
 v_mfma_f32_16x16x32_bf16 v[248:251], a[204:207], a[164:167], v[248:251]
 ds_read_b128 a[164:167], v2 offset:52224
 v_mul_f32 v5, v5, v133
 v_mfma_f32_16x16x32_bf16 v[248:251], a[200:203], a[160:163], v[248:251]
 ds_read_b128 a[160:163], v2 offset:51200
 v_cvt_pk_bf16_f32 v14, v6, v5
 v_mfma_f32_16x16x32_bf16 v[244:247], a[200:203], a[152:155], v[244:247]
 ds_read_b128 a[152:155], v2 offset:47104
 v_accvgpr_read_b32 v5, a55
 v_mfma_f32_16x16x32_bf16 v[244:247], a[204:207], a[156:159], v[244:247]
 ds_read_b128 a[156:159], v2 offset:48128
 v_lshlrev_b32 v6, 16, v5
 v_mfma_f32_16x16x32_bf16 v[240:243], a[204:207], a[148:151], v[240:243]
 ds_read_b128 a[148:151], v2 offset:44032
 v_and_b32 v5, s26, v5
 v_mfma_f32_16x16x32_bf16 v[240:243], a[200:203], a[144:147], v[240:243]
 ds_read_b128 a[144:147], v2 offset:43008
 v_mul_f32 v6, v6, v134
 v_mfma_f32_16x16x32_bf16 v[236:239], a[200:203], a[136:139], v[236:239]
 ds_read_b128 a[136:139], v2 offset:38912
 v_mul_f32 v5, v5, v135
 v_mfma_f32_16x16x32_bf16 v[236:239], a[204:207], a[140:143], v[236:239]
 ds_read_b128 a[140:143], v2 offset:39936
 v_cvt_pk_bf16_f32 v15, v6, v5
 v_mfma_f32_16x16x32_bf16 v[232:235], a[204:207], a[132:135], v[232:235]
 ds_read_b128 a[132:135], v2 offset:35840
 v_mfma_f32_16x16x32_bf16 v[232:235], a[200:203], a[128:131], v[232:235]
 ds_read_b128 a[128:131], v2 offset:34816
 ds_write_b128 v18, v[12:15] offset:20480
 ds_read_b128 v[48:51], v3 offset:20480
 ds_read_b128 v[80:83], v3 offset:21504
 v_accvgpr_read_b32 v5, a24
 v_lshlrev_b32 v6, 16, v5
 s_waitcnt vmcnt(10) lgkmcnt(11)
 v_mfma_f32_16x16x32_bf16 v[164:167], a[208:211], a[184:187], v[164:167]
 v_and_b32 v5, s26, v5
 v_mul_f32 v6, v6, v40
 v_mfma_f32_16x16x32_bf16 v[164:167], a[212:215], a[188:191], v[164:167]
 v_mul_f32 v5, v5, v41
 v_cvt_pk_bf16_f32 v8, v6, v5
 v_mfma_f32_16x16x32_bf16 v[160:163], a[212:215], a[180:183], v[160:163]
 v_accvgpr_read_b32 v5, a25
 v_lshlrev_b32 v6, 16, v5
 v_mfma_f32_16x16x32_bf16 v[160:163], a[208:211], a[176:179], v[160:163]
 v_and_b32 v5, s26, v5
 v_mul_f32 v6, v6, v42
 v_mfma_f32_16x16x32_bf16 v[156:159], a[208:211], a[168:171], v[156:159]
 v_mul_f32 v5, v5, v43
 v_cvt_pk_bf16_f32 v9, v6, v5
 s_waitcnt lgkmcnt(1)
 s_add_u32 s3, s28, 163840
 v_mfma_f32_16x16x32_bf16 v[156:159], a[212:215], a[172:175], v[156:159]
 buffer_store_dwordx4 v[48:51], v16, s[16:19], s3 offen nt
 s_waitcnt lgkmcnt(0)
 s_add_u32 s3, s28, 180224
 buffer_store_dwordx4 v[80:83], v16, s[16:19], s3 offen nt
 v_accvgpr_read_b32 v5, a26
 v_lshlrev_b32 v6, 16, v5
 v_and_b32 v5, s26, v5
 v_mul_f32 v6, v6, v72
 v_mfma_f32_16x16x32_bf16 v[152:155], a[212:215], a[164:167], v[152:155]
 v_mul_f32 v5, v5, v73
 v_cvt_pk_bf16_f32 v10, v6, v5
 v_mfma_f32_16x16x32_bf16 v[152:155], a[208:211], a[160:163], v[152:155]
 v_accvgpr_read_b32 v5, a27
 v_lshlrev_b32 v6, 16, v5
 v_mfma_f32_16x16x32_bf16 v[148:151], a[208:211], a[152:155], v[148:151]
 v_and_b32 v5, s26, v5
 v_mul_f32 v6, v6, v74
 v_mfma_f32_16x16x32_bf16 v[148:151], a[212:215], a[156:159], v[148:151]
 v_mul_f32 v5, v5, v75
 v_cvt_pk_bf16_f32 v11, v6, v5
 v_mfma_f32_16x16x32_bf16 v[144:147], a[212:215], a[148:151], v[144:147]
 ds_write_b128 v17, v[8:11] offset:24576
 v_mfma_f32_16x16x32_bf16 v[144:147], a[208:211], a[144:147], v[144:147]
 v_accvgpr_read_b32 v5, a56
 v_lshlrev_b32 v6, 16, v5
 v_mfma_f32_16x16x32_bf16 v[140:143], a[208:211], a[136:139], v[140:143]
 v_and_b32 v5, s26, v5
 v_mul_f32 v6, v6, v104
 v_mfma_f32_16x16x32_bf16 v[140:143], a[212:215], a[140:143], v[140:143]
 v_mul_f32 v5, v5, v105
 v_cvt_pk_bf16_f32 v12, v6, v5
 v_mfma_f32_16x16x32_bf16 v[136:139], a[212:215], a[132:135], v[136:139]
 v_accvgpr_read_b32 v5, a57
 v_lshlrev_b32 v6, 16, v5
 v_mfma_f32_16x16x32_bf16 v[136:139], a[208:211], a[128:131], v[136:139]
 v_and_b32 v5, s26, v5
 v_mul_f32 v6, v6, v106
 s_waitcnt vmcnt(10)
 v_mfma_f32_16x16x32_bf16 v[168:171], a[216:219], a[128:131], v[168:171]
 v_mul_f32 v5, v5, v107
 v_cvt_pk_bf16_f32 v13, v6, v5
 v_mfma_f32_16x16x32_bf16 v[168:171], a[220:223], a[132:135], v[168:171]
 v_accvgpr_read_b32 v5, a58
 v_accvgpr_read_b32 v7, a240
 v_mfma_f32_16x16x32_bf16 v[172:175], a[220:223], a[140:143], v[172:175]
 v_lshlrev_b32 v6, 16, v5
 v_and_b32 v5, s26, v5
 v_mfma_f32_16x16x32_bf16 v[172:175], a[216:219], a[136:139], v[172:175]
 v_mul_f32 v6, v6, v7
 v_accvgpr_read_b32 v7, a241
 v_mfma_f32_16x16x32_bf16 v[176:179], a[216:219], a[144:147], v[176:179]
 v_mul_f32 v5, v5, v7
 v_cvt_pk_bf16_f32 v14, v6, v5
 v_mfma_f32_16x16x32_bf16 v[176:179], a[220:223], a[148:151], v[176:179]
 v_accvgpr_read_b32 v5, a59
 v_accvgpr_read_b32 v7, a242
 v_mfma_f32_16x16x32_bf16 v[180:183], a[220:223], a[156:159], v[180:183]
 v_lshlrev_b32 v6, 16, v5
 v_and_b32 v5, s26, v5
 v_mfma_f32_16x16x32_bf16 v[180:183], a[216:219], a[152:155], v[180:183]
 v_mul_f32 v6, v6, v7
 v_accvgpr_read_b32 v7, a243
 v_mfma_f32_16x16x32_bf16 v[184:187], a[216:219], a[160:163], v[184:187]
 v_mul_f32 v5, v5, v7
 v_cvt_pk_bf16_f32 v15, v6, v5
 v_mfma_f32_16x16x32_bf16 v[184:187], a[220:223], a[164:167], v[184:187]
 ds_write_b128 v18, v[12:15] offset:24576
 v_mfma_f32_16x16x32_bf16 v[188:191], a[220:223], a[172:175], v[188:191]
 ds_read_b128 v[48:51], v3 offset:24576
 ds_read_b128 v[80:83], v3 offset:25600
 v_mfma_f32_16x16x32_bf16 v[188:191], a[216:219], a[168:171], v[188:191]
 v_accvgpr_read_b32 v5, a28
 v_mfma_f32_16x16x32_bf16 v[192:195], a[216:219], a[176:179], v[192:195]
 v_lshlrev_b32 v6, 16, v5
 v_and_b32 v5, s26, v5
 v_mfma_f32_16x16x32_bf16 v[192:195], a[220:223], a[180:183], v[192:195]
 v_mul_f32 v6, v6, v44
 v_mul_f32 v5, v5, v45
 v_mfma_f32_16x16x32_bf16 v[196:199], a[220:223], a[188:191], v[196:199]
 v_cvt_pk_bf16_f32 v8, v6, v5
 v_accvgpr_read_b32 v5, a29
 v_mfma_f32_16x16x32_bf16 v[196:199], a[216:219], a[184:187], v[196:199]
 v_lshlrev_b32 v6, 16, v5
 v_and_b32 v5, s26, v5
 s_waitcnt vmcnt(6)
 v_mfma_f32_16x16x32_bf16 v[228:231], a[224:227], a[184:187], v[228:231]
 v_mul_f32 v6, v6, v46
 v_mul_f32 v5, v5, v47
 v_mfma_f32_16x16x32_bf16 v[228:231], a[228:231], a[188:191], v[228:231]
 v_cvt_pk_bf16_f32 v9, v6, v5
 s_waitcnt lgkmcnt(1)
 v_mfma_f32_16x16x32_bf16 v[224:227], a[228:231], a[180:183], v[224:227]
 s_add_u32 s3, s28, 196608
 buffer_store_dwordx4 v[48:51], v16, s[16:19], s3 offen nt
 v_mfma_f32_16x16x32_bf16 v[224:227], a[224:227], a[176:179], v[224:227]
 s_waitcnt lgkmcnt(0)
 s_add_u32 s3, s28, 212992
 v_mfma_f32_16x16x32_bf16 v[220:223], a[224:227], a[168:171], v[220:223]
 buffer_store_dwordx4 v[80:83], v16, s[16:19], s3 offen nt
 v_accvgpr_read_b32 v5, a30
 v_mfma_f32_16x16x32_bf16 v[220:223], a[228:231], a[172:175], v[220:223]
 v_lshlrev_b32 v6, 16, v5
 v_mfma_f32_16x16x32_bf16 v[216:219], a[228:231], a[164:167], v[216:219]
 v_and_b32 v5, s26, v5
 v_mul_f32 v6, v6, v76
 v_mfma_f32_16x16x32_bf16 v[216:219], a[224:227], a[160:163], v[216:219]
 v_mul_f32 v5, v5, v77
 v_cvt_pk_bf16_f32 v10, v6, v5
 v_mfma_f32_16x16x32_bf16 v[212:215], a[224:227], a[152:155], v[212:215]
 v_accvgpr_read_b32 v5, a31
 v_lshlrev_b32 v6, 16, v5
 v_mfma_f32_16x16x32_bf16 v[212:215], a[228:231], a[156:159], v[212:215]
 v_and_b32 v5, s26, v5
 v_mul_f32 v6, v6, v78
 v_mfma_f32_16x16x32_bf16 v[208:211], a[228:231], a[148:151], v[208:211]
 v_mul_f32 v5, v5, v79
 v_cvt_pk_bf16_f32 v11, v6, v5
 v_mfma_f32_16x16x32_bf16 v[208:211], a[224:227], a[144:147], v[208:211]
 ds_write_b128 v17, v[8:11] offset:28672
 v_mfma_f32_16x16x32_bf16 v[204:207], a[224:227], a[136:139], v[204:207]
 v_accvgpr_read_b32 v5, a60
 v_lshlrev_b32 v6, 16, v5
 v_mfma_f32_16x16x32_bf16 v[204:207], a[228:231], a[140:143], v[204:207]
 v_and_b32 v5, s26, v5
 v_mul_f32 v6, v6, v108
 v_mfma_f32_16x16x32_bf16 v[200:203], a[228:231], a[132:135], v[200:203]
 v_mul_f32 v5, v5, v109
 v_cvt_pk_bf16_f32 v12, v6, v5
 v_mfma_f32_16x16x32_bf16 v[200:203], a[224:227], a[128:131], v[200:203]
 v_accvgpr_read_b32 v5, a61
 v_lshlrev_b32 v6, 16, v5
 s_waitcnt vmcnt(6)
 v_mfma_f32_16x16x32_bf16 v[232:235], a[232:235], a[128:131], v[232:235]
 v_and_b32 v5, s26, v5
 v_mul_f32 v6, v6, v110
 v_mfma_f32_16x16x32_bf16 v[232:235], a[236:239], a[132:135], v[232:235]
 v_mul_f32 v5, v5, v111
 v_cvt_pk_bf16_f32 v13, v6, v5
 v_mfma_f32_16x16x32_bf16 v[236:239], a[236:239], a[140:143], v[236:239]
 v_accvgpr_read_b32 v5, a62
 v_accvgpr_read_b32 v7, a244
 v_mfma_f32_16x16x32_bf16 v[236:239], a[232:235], a[136:139], v[236:239]
 v_lshlrev_b32 v6, 16, v5
 v_and_b32 v5, s26, v5
 v_mfma_f32_16x16x32_bf16 v[240:243], a[232:235], a[144:147], v[240:243]
 v_mul_f32 v6, v6, v7
 v_accvgpr_read_b32 v7, a245
 v_mfma_f32_16x16x32_bf16 v[240:243], a[236:239], a[148:151], v[240:243]
 v_mul_f32 v5, v5, v7
 v_cvt_pk_bf16_f32 v14, v6, v5
 v_mfma_f32_16x16x32_bf16 v[244:247], a[236:239], a[156:159], v[244:247]
 v_accvgpr_read_b32 v5, a63
 v_accvgpr_read_b32 v7, a246
 v_mfma_f32_16x16x32_bf16 v[244:247], a[232:235], a[152:155], v[244:247]
 v_lshlrev_b32 v6, 16, v5
 v_and_b32 v5, s26, v5
 v_mfma_f32_16x16x32_bf16 v[248:251], a[232:235], a[160:163], v[248:251]
 v_mul_f32 v6, v6, v7
 v_accvgpr_read_b32 v7, a247
 v_mfma_f32_16x16x32_bf16 v[248:251], a[236:239], a[164:167], v[248:251]
 v_mul_f32 v5, v5, v7
 v_cvt_pk_bf16_f32 v15, v6, v5
 v_mfma_f32_16x16x32_bf16 v[252:255], a[236:239], a[172:175], v[252:255]
 ds_write_b128 v18, v[12:15] offset:28672
 v_mfma_f32_16x16x32_bf16 v[252:255], a[232:235], a[168:171], v[252:255]
 ds_read_b128 v[48:51], v3 offset:28672
 ds_read_b128 v[80:83], v3 offset:29696
 v_mfma_f32_16x16x32_bf16 a[248:251], a[232:235], a[176:179], a[248:251]
 s_waitcnt lgkmcnt(1)
 s_add_u32 s3, s28, 229376
 v_mfma_f32_16x16x32_bf16 a[248:251], a[236:239], a[180:183], a[248:251]
 buffer_store_dwordx4 v[48:51], v16, s[16:19], s3 offen nt
 s_waitcnt lgkmcnt(0)
 v_mfma_f32_16x16x32_bf16 a[252:255], a[236:239], a[188:191], a[252:255]
 s_add_u32 s3, s28, 245760
 buffer_store_dwordx4 v[80:83], v16, s[16:19], s3 offen nt
 v_mfma_f32_16x16x32_bf16 a[252:255], a[232:235], a[184:187], a[252:255]
 s_nop 7
 v_accvgpr_read_b32 v7, a64
 v_lshlrev_b32 v6, 16, v7
 v_and_b32 v7, s26, v7
 v_pk_mul_f32 v[6:7], v[6:7], v[136:137]
 v_cvt_pk_bf16_f32 v8, v6, v7
 v_accvgpr_read_b32 v7, a65
 v_lshlrev_b32 v6, 16, v7
 v_and_b32 v7, s26, v7
 v_pk_mul_f32 v[6:7], v[6:7], v[138:139]
 v_cvt_pk_bf16_f32 v9, v6, v7
 v_accvgpr_read_b32 v7, a66
 v_lshlrev_b32 v6, 16, v7
 v_and_b32 v7, s26, v7
 v_pk_mul_f32 v[6:7], v[6:7], v[168:169]
 v_cvt_pk_bf16_f32 v10, v6, v7
 v_accvgpr_read_b32 v7, a67
 v_lshlrev_b32 v6, 16, v7
 v_and_b32 v7, s26, v7
 v_pk_mul_f32 v[6:7], v[6:7], v[170:171]
 v_cvt_pk_bf16_f32 v11, v6, v7
 ds_write_b128 v17, v[8:11]
 v_accvgpr_read_b32 v7, a96
 v_lshlrev_b32 v6, 16, v7
 v_and_b32 v7, s26, v7
 v_pk_mul_f32 v[6:7], v[6:7], v[200:201]
 v_cvt_pk_bf16_f32 v12, v6, v7
 v_accvgpr_read_b32 v7, a97
 v_lshlrev_b32 v6, 16, v7
 v_and_b32 v7, s26, v7
 v_pk_mul_f32 v[6:7], v[6:7], v[202:203]
 v_cvt_pk_bf16_f32 v13, v6, v7
 v_accvgpr_read_b32 v7, a98
 v_lshlrev_b32 v6, 16, v7
 v_and_b32 v7, s26, v7
 v_pk_mul_f32 v[6:7], v[6:7], v[232:233]
 v_cvt_pk_bf16_f32 v14, v6, v7
 v_accvgpr_read_b32 v7, a99
 v_lshlrev_b32 v6, 16, v7
 v_and_b32 v7, s26, v7
 v_pk_mul_f32 v[6:7], v[6:7], v[234:235]
 v_cvt_pk_bf16_f32 v15, v6, v7
 ds_write_b128 v18, v[12:15]
 ds_read_b128 v[48:51], v3
 ds_read_b128 v[80:83], v3 offset:1024
 v_accvgpr_read_b32 v7, a68
 v_lshlrev_b32 v6, 16, v7
 v_and_b32 v7, s26, v7
 v_pk_mul_f32 v[6:7], v[6:7], v[140:141]
 v_cvt_pk_bf16_f32 v8, v6, v7
 v_accvgpr_read_b32 v7, a69
 v_lshlrev_b32 v6, 16, v7
 v_and_b32 v7, s26, v7
 v_pk_mul_f32 v[6:7], v[6:7], v[142:143]
 v_cvt_pk_bf16_f32 v9, v6, v7
 v_accvgpr_read_b32 v7, a70
 v_lshlrev_b32 v6, 16, v7
 s_waitcnt lgkmcnt(1)
 s_add_u32 s3, s28, 0
 buffer_store_dwordx4 v[48:51], v16, s[16:19], s3 offen offset:128 nt
 s_waitcnt lgkmcnt(0)
 s_add_u32 s3, s28, 16384
 buffer_store_dwordx4 v[80:83], v16, s[16:19], s3 offen offset:128 nt
 v_and_b32 v7, s26, v7
 v_pk_mul_f32 v[6:7], v[6:7], v[172:173]
 v_cvt_pk_bf16_f32 v10, v6, v7
 v_accvgpr_read_b32 v7, a71
 v_lshlrev_b32 v6, 16, v7
 v_and_b32 v7, s26, v7
 v_pk_mul_f32 v[6:7], v[6:7], v[174:175]
 v_cvt_pk_bf16_f32 v11, v6, v7
 ds_write_b128 v17, v[8:11] offset:4096
 v_accvgpr_read_b32 v7, a100
 v_lshlrev_b32 v6, 16, v7
 v_and_b32 v7, s26, v7
 v_pk_mul_f32 v[6:7], v[6:7], v[204:205]
 v_cvt_pk_bf16_f32 v12, v6, v7
 v_accvgpr_read_b32 v7, a101
 v_lshlrev_b32 v6, 16, v7
 v_and_b32 v7, s26, v7
 v_pk_mul_f32 v[6:7], v[6:7], v[206:207]
 v_cvt_pk_bf16_f32 v13, v6, v7
 v_accvgpr_read_b32 v7, a102
 v_lshlrev_b32 v6, 16, v7
 v_and_b32 v7, s26, v7
 v_pk_mul_f32 v[6:7], v[6:7], v[236:237]
 v_cvt_pk_bf16_f32 v14, v6, v7
 v_accvgpr_read_b32 v7, a103
 v_lshlrev_b32 v6, 16, v7
 v_and_b32 v7, s26, v7
 v_pk_mul_f32 v[6:7], v[6:7], v[238:239]
 v_cvt_pk_bf16_f32 v15, v6, v7
 ds_write_b128 v18, v[12:15] offset:4096
 ds_read_b128 v[48:51], v3 offset:4096
 ds_read_b128 v[80:83], v3 offset:5120
 v_accvgpr_read_b32 v7, a72
 v_lshlrev_b32 v6, 16, v7
 v_and_b32 v7, s26, v7
 v_pk_mul_f32 v[6:7], v[6:7], v[144:145]
 v_cvt_pk_bf16_f32 v8, v6, v7
 v_accvgpr_read_b32 v7, a73
 v_lshlrev_b32 v6, 16, v7
 v_and_b32 v7, s26, v7
 v_pk_mul_f32 v[6:7], v[6:7], v[146:147]
 v_cvt_pk_bf16_f32 v9, v6, v7
 v_accvgpr_read_b32 v7, a74
 v_lshlrev_b32 v6, 16, v7
 s_waitcnt lgkmcnt(1)
 s_add_u32 s3, s28, 32768
 buffer_store_dwordx4 v[48:51], v16, s[16:19], s3 offen offset:128 nt
 s_waitcnt lgkmcnt(0)
 s_add_u32 s3, s28, 49152
 buffer_store_dwordx4 v[80:83], v16, s[16:19], s3 offen offset:128 nt
 v_and_b32 v7, s26, v7
 v_pk_mul_f32 v[6:7], v[6:7], v[176:177]
 v_cvt_pk_bf16_f32 v10, v6, v7
 v_accvgpr_read_b32 v7, a75
 v_lshlrev_b32 v6, 16, v7
 v_and_b32 v7, s26, v7
 v_pk_mul_f32 v[6:7], v[6:7], v[178:179]
 v_cvt_pk_bf16_f32 v11, v6, v7
 ds_write_b128 v17, v[8:11] offset:8192
 v_accvgpr_read_b32 v7, a104
 v_lshlrev_b32 v6, 16, v7
 v_and_b32 v7, s26, v7
 v_pk_mul_f32 v[6:7], v[6:7], v[208:209]
 v_cvt_pk_bf16_f32 v12, v6, v7
 v_accvgpr_read_b32 v7, a105
 v_lshlrev_b32 v6, 16, v7
 v_and_b32 v7, s26, v7
 v_pk_mul_f32 v[6:7], v[6:7], v[210:211]
 v_cvt_pk_bf16_f32 v13, v6, v7
 v_accvgpr_read_b32 v7, a106
 v_lshlrev_b32 v6, 16, v7
 v_and_b32 v7, s26, v7
 v_pk_mul_f32 v[6:7], v[6:7], v[240:241]
 v_cvt_pk_bf16_f32 v14, v6, v7
 v_accvgpr_read_b32 v7, a107
 v_lshlrev_b32 v6, 16, v7
 v_and_b32 v7, s26, v7
 v_pk_mul_f32 v[6:7], v[6:7], v[242:243]
 v_cvt_pk_bf16_f32 v15, v6, v7
 ds_write_b128 v18, v[12:15] offset:8192
 ds_read_b128 v[48:51], v3 offset:8192
 ds_read_b128 v[80:83], v3 offset:9216
 v_accvgpr_read_b32 v7, a76
 v_lshlrev_b32 v6, 16, v7
 v_and_b32 v7, s26, v7
 v_pk_mul_f32 v[6:7], v[6:7], v[148:149]
 v_cvt_pk_bf16_f32 v8, v6, v7
 v_accvgpr_read_b32 v7, a77
 v_lshlrev_b32 v6, 16, v7
 v_and_b32 v7, s26, v7
 v_pk_mul_f32 v[6:7], v[6:7], v[150:151]
 v_cvt_pk_bf16_f32 v9, v6, v7
 v_accvgpr_read_b32 v7, a78
 v_lshlrev_b32 v6, 16, v7
 s_waitcnt lgkmcnt(1)
 s_add_u32 s3, s28, 65536
 buffer_store_dwordx4 v[48:51], v16, s[16:19], s3 offen offset:128 nt
 s_waitcnt lgkmcnt(0)
 s_add_u32 s3, s28, 81920
 buffer_store_dwordx4 v[80:83], v16, s[16:19], s3 offen offset:128 nt
 v_and_b32 v7, s26, v7
 v_pk_mul_f32 v[6:7], v[6:7], v[180:181]
 v_cvt_pk_bf16_f32 v10, v6, v7
 v_accvgpr_read_b32 v7, a79
 v_lshlrev_b32 v6, 16, v7
 v_and_b32 v7, s26, v7
 v_pk_mul_f32 v[6:7], v[6:7], v[182:183]
 v_cvt_pk_bf16_f32 v11, v6, v7
 ds_write_b128 v17, v[8:11] offset:12288
 v_accvgpr_read_b32 v7, a108
 v_lshlrev_b32 v6, 16, v7
 v_and_b32 v7, s26, v7
 v_pk_mul_f32 v[6:7], v[6:7], v[212:213]
 v_cvt_pk_bf16_f32 v12, v6, v7
 v_accvgpr_read_b32 v7, a109
 v_lshlrev_b32 v6, 16, v7
 v_and_b32 v7, s26, v7
 v_pk_mul_f32 v[6:7], v[6:7], v[214:215]
 v_cvt_pk_bf16_f32 v13, v6, v7
 v_accvgpr_read_b32 v7, a110
 v_lshlrev_b32 v6, 16, v7
 v_and_b32 v7, s26, v7
 v_pk_mul_f32 v[6:7], v[6:7], v[244:245]
 v_cvt_pk_bf16_f32 v14, v6, v7
 v_accvgpr_read_b32 v7, a111
 v_lshlrev_b32 v6, 16, v7
 v_and_b32 v7, s26, v7
 v_pk_mul_f32 v[6:7], v[6:7], v[246:247]
 v_cvt_pk_bf16_f32 v15, v6, v7
 ds_write_b128 v18, v[12:15] offset:12288
 ds_read_b128 v[48:51], v3 offset:12288
 ds_read_b128 v[80:83], v3 offset:13312
 v_accvgpr_read_b32 v7, a80
 v_lshlrev_b32 v6, 16, v7
 v_and_b32 v7, s26, v7
 v_pk_mul_f32 v[6:7], v[6:7], v[152:153]
 v_cvt_pk_bf16_f32 v8, v6, v7
 v_accvgpr_read_b32 v7, a81
 v_lshlrev_b32 v6, 16, v7
 v_and_b32 v7, s26, v7
 v_pk_mul_f32 v[6:7], v[6:7], v[154:155]
 v_cvt_pk_bf16_f32 v9, v6, v7
 v_accvgpr_read_b32 v7, a82
 v_lshlrev_b32 v6, 16, v7
 s_waitcnt lgkmcnt(1)
 s_add_u32 s3, s28, 98304
 buffer_store_dwordx4 v[48:51], v16, s[16:19], s3 offen offset:128 nt
 s_waitcnt lgkmcnt(0)
 s_add_u32 s3, s28, 114688
 buffer_store_dwordx4 v[80:83], v16, s[16:19], s3 offen offset:128 nt
 v_and_b32 v7, s26, v7
 v_pk_mul_f32 v[6:7], v[6:7], v[184:185]
 v_cvt_pk_bf16_f32 v10, v6, v7
 v_accvgpr_read_b32 v7, a83
 v_lshlrev_b32 v6, 16, v7
 v_and_b32 v7, s26, v7
 v_pk_mul_f32 v[6:7], v[6:7], v[186:187]
 v_cvt_pk_bf16_f32 v11, v6, v7
 ds_write_b128 v17, v[8:11] offset:16384
 v_accvgpr_read_b32 v7, a112
 v_lshlrev_b32 v6, 16, v7
 v_and_b32 v7, s26, v7
 v_pk_mul_f32 v[6:7], v[6:7], v[216:217]
 v_cvt_pk_bf16_f32 v12, v6, v7
 v_accvgpr_read_b32 v7, a113
 v_lshlrev_b32 v6, 16, v7
 v_and_b32 v7, s26, v7
 v_pk_mul_f32 v[6:7], v[6:7], v[218:219]
 v_cvt_pk_bf16_f32 v13, v6, v7
 v_accvgpr_read_b32 v7, a114
 v_lshlrev_b32 v6, 16, v7
 v_and_b32 v7, s26, v7
 v_pk_mul_f32 v[6:7], v[6:7], v[248:249]
 v_cvt_pk_bf16_f32 v14, v6, v7
 v_accvgpr_read_b32 v7, a115
 v_lshlrev_b32 v6, 16, v7
 v_and_b32 v7, s26, v7
 v_pk_mul_f32 v[6:7], v[6:7], v[250:251]
 v_cvt_pk_bf16_f32 v15, v6, v7
 ds_write_b128 v18, v[12:15] offset:16384
 ds_read_b128 v[48:51], v3 offset:16384
 ds_read_b128 v[80:83], v3 offset:17408
 v_accvgpr_read_b32 v7, a84
 v_lshlrev_b32 v6, 16, v7
 v_and_b32 v7, s26, v7
 v_pk_mul_f32 v[6:7], v[6:7], v[156:157]
 v_cvt_pk_bf16_f32 v8, v6, v7
 v_accvgpr_read_b32 v7, a85
 v_lshlrev_b32 v6, 16, v7
 v_and_b32 v7, s26, v7
 v_pk_mul_f32 v[6:7], v[6:7], v[158:159]
 v_cvt_pk_bf16_f32 v9, v6, v7
 v_accvgpr_read_b32 v7, a86
 v_lshlrev_b32 v6, 16, v7
 s_waitcnt lgkmcnt(1)
 s_add_u32 s3, s28, 131072
 buffer_store_dwordx4 v[48:51], v16, s[16:19], s3 offen offset:128 nt
 s_waitcnt lgkmcnt(0)
 s_add_u32 s3, s28, 147456
 buffer_store_dwordx4 v[80:83], v16, s[16:19], s3 offen offset:128 nt
 v_and_b32 v7, s26, v7
 v_pk_mul_f32 v[6:7], v[6:7], v[188:189]
 v_cvt_pk_bf16_f32 v10, v6, v7
 v_accvgpr_read_b32 v7, a87
 v_lshlrev_b32 v6, 16, v7
 v_and_b32 v7, s26, v7
 v_pk_mul_f32 v[6:7], v[6:7], v[190:191]
 v_cvt_pk_bf16_f32 v11, v6, v7
 ds_write_b128 v17, v[8:11] offset:20480
 v_accvgpr_read_b32 v7, a116
 v_lshlrev_b32 v6, 16, v7
 v_and_b32 v7, s26, v7
 v_pk_mul_f32 v[6:7], v[6:7], v[220:221]
 v_cvt_pk_bf16_f32 v12, v6, v7
 v_accvgpr_read_b32 v7, a117
 v_lshlrev_b32 v6, 16, v7
 v_and_b32 v7, s26, v7
 v_pk_mul_f32 v[6:7], v[6:7], v[222:223]
 v_cvt_pk_bf16_f32 v13, v6, v7
 v_accvgpr_read_b32 v7, a118
 v_lshlrev_b32 v6, 16, v7
 v_and_b32 v7, s26, v7
 v_pk_mul_f32 v[6:7], v[6:7], v[252:253]
 v_cvt_pk_bf16_f32 v14, v6, v7
 v_accvgpr_read_b32 v7, a119
 v_lshlrev_b32 v6, 16, v7
 v_and_b32 v7, s26, v7
 v_pk_mul_f32 v[6:7], v[6:7], v[254:255]
 v_cvt_pk_bf16_f32 v15, v6, v7
 ds_write_b128 v18, v[12:15] offset:20480
 ds_read_b128 v[48:51], v3 offset:20480
 ds_read_b128 v[80:83], v3 offset:21504
 v_accvgpr_read_b32 v7, a88
 v_lshlrev_b32 v6, 16, v7
 v_and_b32 v7, s26, v7
 v_pk_mul_f32 v[6:7], v[6:7], v[160:161]
 v_cvt_pk_bf16_f32 v8, v6, v7
 v_accvgpr_read_b32 v7, a89
 v_lshlrev_b32 v6, 16, v7
 v_and_b32 v7, s26, v7
 v_pk_mul_f32 v[6:7], v[6:7], v[162:163]
 v_cvt_pk_bf16_f32 v9, v6, v7
 v_accvgpr_read_b32 v7, a90
 v_lshlrev_b32 v6, 16, v7
 s_waitcnt lgkmcnt(1)
 s_add_u32 s3, s28, 163840
 buffer_store_dwordx4 v[48:51], v16, s[16:19], s3 offen offset:128 nt
 s_waitcnt lgkmcnt(0)
 s_add_u32 s3, s28, 180224
 buffer_store_dwordx4 v[80:83], v16, s[16:19], s3 offen offset:128 nt
 v_and_b32 v7, s26, v7
 v_pk_mul_f32 v[6:7], v[6:7], v[192:193]
 v_cvt_pk_bf16_f32 v10, v6, v7
 v_accvgpr_read_b32 v7, a91
 v_lshlrev_b32 v6, 16, v7
 v_and_b32 v7, s26, v7
 v_pk_mul_f32 v[6:7], v[6:7], v[194:195]
 v_cvt_pk_bf16_f32 v11, v6, v7
 ds_write_b128 v17, v[8:11] offset:24576
 v_accvgpr_read_b32 v7, a120
 v_lshlrev_b32 v6, 16, v7
 v_and_b32 v7, s26, v7
 v_pk_mul_f32 v[6:7], v[6:7], v[224:225]
 v_cvt_pk_bf16_f32 v12, v6, v7
 v_accvgpr_read_b32 v7, a121
 v_lshlrev_b32 v6, 16, v7
 v_and_b32 v7, s26, v7
 v_pk_mul_f32 v[6:7], v[6:7], v[226:227]
 v_cvt_pk_bf16_f32 v13, v6, v7
 v_accvgpr_read_b32 v7, a122
 v_accvgpr_read_b32 v112, a248
 v_accvgpr_read_b32 v113, a249
 v_lshlrev_b32 v6, 16, v7
 v_and_b32 v7, s26, v7
 v_pk_mul_f32 v[6:7], v[6:7], v[112:113]
 v_cvt_pk_bf16_f32 v14, v6, v7
 v_accvgpr_read_b32 v7, a123
 v_accvgpr_read_b32 v112, a250
 v_accvgpr_read_b32 v113, a251
 v_lshlrev_b32 v6, 16, v7
 v_and_b32 v7, s26, v7
 v_pk_mul_f32 v[6:7], v[6:7], v[112:113]
 v_cvt_pk_bf16_f32 v15, v6, v7
 ds_write_b128 v18, v[12:15] offset:24576
 ds_read_b128 v[48:51], v3 offset:24576
 ds_read_b128 v[80:83], v3 offset:25600
 v_accvgpr_read_b32 v7, a92
 v_lshlrev_b32 v6, 16, v7
 v_and_b32 v7, s26, v7
 v_pk_mul_f32 v[6:7], v[6:7], v[164:165]
 v_cvt_pk_bf16_f32 v8, v6, v7
 v_accvgpr_read_b32 v7, a93
 v_lshlrev_b32 v6, 16, v7
 v_and_b32 v7, s26, v7
 v_pk_mul_f32 v[6:7], v[6:7], v[166:167]
 v_cvt_pk_bf16_f32 v9, v6, v7
 v_accvgpr_read_b32 v7, a94
 v_lshlrev_b32 v6, 16, v7
 s_waitcnt lgkmcnt(1)
 s_add_u32 s3, s28, 196608
 buffer_store_dwordx4 v[48:51], v16, s[16:19], s3 offen offset:128 nt
 s_waitcnt lgkmcnt(0)
 s_add_u32 s3, s28, 212992
 buffer_store_dwordx4 v[80:83], v16, s[16:19], s3 offen offset:128 nt
 v_and_b32 v7, s26, v7
 v_pk_mul_f32 v[6:7], v[6:7], v[196:197]
 v_cvt_pk_bf16_f32 v10, v6, v7
 v_accvgpr_read_b32 v7, a95
 v_lshlrev_b32 v6, 16, v7
 v_and_b32 v7, s26, v7
 v_pk_mul_f32 v[6:7], v[6:7], v[198:199]
 v_cvt_pk_bf16_f32 v11, v6, v7
 ds_write_b128 v17, v[8:11] offset:28672
 v_accvgpr_read_b32 v7, a124
 v_lshlrev_b32 v6, 16, v7
 v_and_b32 v7, s26, v7
 v_pk_mul_f32 v[6:7], v[6:7], v[228:229]
 v_cvt_pk_bf16_f32 v12, v6, v7
 v_accvgpr_read_b32 v7, a125
 v_lshlrev_b32 v6, 16, v7
 v_and_b32 v7, s26, v7
 v_pk_mul_f32 v[6:7], v[6:7], v[230:231]
 v_cvt_pk_bf16_f32 v13, v6, v7
 v_accvgpr_read_b32 v7, a126
 v_accvgpr_read_b32 v112, a252
 v_accvgpr_read_b32 v113, a253
 v_lshlrev_b32 v6, 16, v7
 v_and_b32 v7, s26, v7
 v_pk_mul_f32 v[6:7], v[6:7], v[112:113]
 v_cvt_pk_bf16_f32 v14, v6, v7
 v_accvgpr_read_b32 v7, a127
 v_accvgpr_read_b32 v112, a254
 v_accvgpr_read_b32 v113, a255
 v_lshlrev_b32 v6, 16, v7
 v_and_b32 v7, s26, v7
 v_pk_mul_f32 v[6:7], v[6:7], v[112:113]
 v_cvt_pk_bf16_f32 v15, v6, v7
 ds_write_b128 v18, v[12:15] offset:28672
 ds_read_b128 v[48:51], v3 offset:28672
 ds_read_b128 v[80:83], v3 offset:29696
 s_waitcnt lgkmcnt(1)
 s_add_u32 s3, s28, 229376
 buffer_store_dwordx4 v[48:51], v16, s[16:19], s3 offen offset:128 nt
 s_waitcnt lgkmcnt(0)
 s_add_u32 s3, s28, 245760
 buffer_store_dwordx4 v[80:83], v16, s[16:19], s3 offen offset:128 nt
Lend:
 s_endpgm
Lspin_pro:
 s_add_u32 s53, s53, 1
 v_lshlrev_b32 v4, 2, v3
 v_and_b32 v4, 192, v4
 buffer_load_dword v4, v4, s[44:47], 0 offen sc1
 s_cmp_ge_u32 s53, 0x100000
 s_cbranch_scc1 Lgiveup_pro
 s_waitcnt vmcnt(0)
 v_cmp_gt_i32 vcc, s27, v4
 s_and_b64 vcc, exec, vcc
 s_cbranch_vccnz Lspin_pro
Lgiveup_pro:
 s_waitcnt vmcnt(0)
 s_branch Lok_pro
Lspin_pa:
 s_add_u32 s53, s53, 1
 buffer_load_dword v4, off, s[64:67], 0 sc1
 s_cmp_ge_u32 s53, 0x100000
 s_cbranch_scc1 Lgiveup_pa
 s_waitcnt vmcnt(0)
 v_cmp_gt_i32 vcc, s55, v4
 s_and_b64 vcc, exec, vcc
 s_cbranch_vccnz Lspin_pa
Lgiveup_pa:
 s_waitcnt vmcnt(0)
 s_branch Lok_pa
Lgat0:
 v_lshrrev_b32 v5, 4, v3
 v_and_b32 v5, 0x20, v5
 v_xor_b32 v5, v5, v3
 v_and_b32 v5, 0x30, v5
 v_bfe_u32 v6, v3, 6, 4
 v_lshl_add_u32 v6, v6, 11, v5
 s_branch Lgatr0
Lxrg:
 v_lshrrev_b32 v5, 2, v3
 v_and_b32 v5, 0x20, v5
 v_lshrrev_b32 v2, 4, v3
 v_xor_b32 v5, v5, v2
 v_and_b32 v5, 0x30, v5
 v_bfe_u32 v1, v3, 4, 4
 v_lshl_add_u32 v1, v1, 6, v5
 v_add_u32 v2, 0x10000, v1
 s_branch Lxrgr
Lspin_pb:
 s_add_u32 s53, s53, 1
 buffer_load_dword v4, off, s[64:67], 0 sc1
 s_cmp_ge_u32 s53, 0x100000
 s_cbranch_scc1 Lgiveup_pb
 s_waitcnt vmcnt(0)
 v_cmp_gt_i32 vcc, s55, v4
 s_and_b64 vcc, exec, vcc
 s_cbranch_vccnz Lspin_pb
Lgiveup_pb:
 s_waitcnt vmcnt(0)
 s_branch Lok_pb
Lgat1:
 v_lshrrev_b32 v5, 4, v3
 v_and_b32 v5, 0x20, v5
 v_xor_b32 v5, v5, v3
 v_and_b32 v5, 0x30, v5
 v_bfe_u32 v6, v3, 6, 4
 v_lshl_add_u32 v6, v6, 11, v5
 s_branch Lgatr1
Lspin_w:
 s_add_u32 s53, s53, 1
 v_lshlrev_b32 v4, 2, v3
 v_and_b32 v4, 192, v4
 buffer_load_dword v4, v4, s[44:47], 0 offen sc1
 s_cmp_ge_u32 s53, 0x100000
 s_cbranch_scc1 Lgiveup_w
 s_waitcnt vmcnt(0)
 v_cmp_gt_i32 vcc, s27, v4
 s_and_b64 vcc, exec, vcc
 s_cbranch_vccnz Lspin_w
Lgiveup_w:
 s_waitcnt vmcnt(0)
 s_branch Lok_w
.section .rodata,"a"
.p2align 6
.amdhsa_kernel standalone__cross_network_dcn__recsys_kernel
  .amdhsa_next_free_vgpr 512
  .amdhsa_next_free_sgpr 102
  .amdhsa_accum_offset 256
  .amdhsa_group_segment_fixed_size 0
  .amdhsa_kernarg_size 48
  .amdhsa_user_sgpr_count 2
  .amdhsa_user_sgpr_kernarg_segment_ptr 1
  .amdhsa_system_sgpr_workgroup_id_x 1
  .amdhsa_float_denorm_mode_32 3
.end_amdhsa_kernel
```

```asm
; @launch grid=(256,1,1) block=(256,1,1) lds=151552
.amdgcn_target "amdgcn-amd-amdhsa--gfx950"
.text
.globl standalone__cross_network_dcn__recsys_kernel
.p2align 8
.type standalone__cross_network_dcn__recsys_kernel,@function
standalone__cross_network_dcn__recsys_kernel:
 s_cmp_ge_u32 s2, 256
 s_cbranch_scc1 Lend
 s_load_dwordx4 s[56:59], s[0:1], 0
 s_load_dwordx4 s[60:63], s[0:1], 16
 s_load_dwordx4 s[64:67], s[0:1], 32
 v_lshrrev_b32 v9, 6, v0
 v_and_b32 v10, 63, v0
 v_readfirstlane_b32 s54, v9
 v_lshlrev_b32 v1, 4, v10
 s_getpc_b64 s[4:5]
Lpc:
 v_lshlrev_b32 v11, 6, v0
 s_bfe_u32 s3, s2, 0x20003
 s_lshl_b32 s3, s3, 14
 v_add_u32 v11, s3, v11
 v_min_u32 v12, Lend-Lpc, v11
 global_load_dword v60, v12, s[4:5]
 v_add_u32 v11, 16384, v11
 v_lshrrev_b32 v11, 7, v0
 v_and_b32 v12, 127, v0
 v_lshlrev_b32 v12, 3, v12
 v_lshl_add_u32 v30, v11, 11, v12
 v_lshlrev_b32 v31, 4, v0
 v_add_u32 v31, 131072, v31
 v_add_u32 v2, 65536, v1
 v_lshl_add_u32 v3, v9, 15, v1
 v_lshl_add_u32 v0, v9, 18, v1
 s_and_b32 s7, s2, 1
 s_lshr_b32 s28, s2, 1
 s_lshl_b32 s28, s28, 18
 s_lshl_b32 s6, s7, 10
 s_add_u32 s28, s28, s6
 s_lshl_b32 s6, s54, 8
 s_add_u32 s28, s28, s6
 s_mov_b32 s26, 0xffff0000
 s_lshl_b32 s24, s7, 20
 s_mov_b32 s25, 0
 s_mov_b32 s53, 0
 s_mov_b32 s31, -1
 s_mov_b32 s27, 64
 s_mov_b32 s55, -1
 s_lshl_b32 s50, s54, 15
 s_lshl_b32 s29, s2, 17
 s_add_u32 s29, s29, 33554432
 s_xor_b32 s30, s29, 131072
 s_lshr_b32 s4, s2, 3
 s_and_b32 s5, s2, 7
 s_lshl_b32 s48, s4, 16
 s_lshl_b32 s6, s5, 8
 s_add_u32 s48, s48, s6
 s_lshl_b32 s6, s54, 6
 s_add_u32 s48, s48, s6
 s_lshl_b32 s49, s5, 18
 s_and_b32 s6, s4, 1
 s_lshl_b32 s6, s6, 10
 s_add_u32 s49, s49, s6
 s_lshr_b32 s6, s4, 4
 s_lshr_b32 s5, s5, 2
 s_xor_b32 s5, s5, s6
 s_bfe_u32 s6, s4, 0x10001
 s_lshl_b32 s3, s5, 1
 s_add_u32 s3, s3, s6
 s_lshl_b32 s3, s3, 16
 s_add_u32 s49, s49, s3
 s_bfe_u32 s4, s4, 0x20002
 s_xor_b32 s5, s5, s6
 s_lshr_b32 s3, s54, 1
 s_lshl_b32 s3, s3, 4
 s_lshr_b32 s6, s54, 1
 s_mul_i32 s6, s6, 3
 s_xor_b32 s6, s6, s4
 s_lshl_b32 s6, s6, 2
 s_add_u32 s3, s3, s6
 s_and_b32 s6, s54, 1
 s_lshl_b32 s6, s6, 1
 s_add_u32 s3, s3, s6
 s_lshl_b32 s4, s4, 3
 s_lshl_b32 s6, s54, 1
 s_add_u32 s4, s4, s6
 s_cmp_eq_u32 s5, 0
 s_cselect_b32 s3, s3, s4
 s_lshl_b32 s3, s3, 11
 s_add_u32 s49, s49, s3
 s_lshl_b32 s52, s54, 11
 s_add_u32 s52, s52, 143360
 s_lshl_b32 s51, s54, 9
 s_add_u32 s51, s51, 131072
 s_waitcnt lgkmcnt(0)
 s_mov_b32 s40, s58
 s_mov_b32 s41, s59
 s_mov_b32 s42, 0xc00000
 s_mov_b32 s43, 0x20000
 v_lshrrev_b32 v5, 6, v1
 v_and_b32 v6, 48, v1
 v_lshl_add_u32 v5, v5, 11, v6
 s_mov_b32 m0, s52
 s_add_u32 s3, s48, 31744
 buffer_load_dwordx4 v5, s[40:43], s48 offen lds
 buffer_load_dwordx4 v5, s[40:43], s3 offen offset:1024 lds
 s_add_u32 s48, s48, 2097152
 s_mov_b32 s20, s60
 s_mov_b32 s21, s61
 s_mov_b32 s22, 0x3000
 s_mov_b32 s23, 0x20000
 s_lshl_b32 s3, s7, 10
 buffer_load_dwordx2 v[32:33], v30, s[20:23], s3 offen
 s_add_u32 s3, s3, 4096
 buffer_load_dwordx2 v[34:35], v30, s[20:23], s3 offen
 s_add_u32 s3, s3, 4096
 buffer_load_dwordx2 v[36:37], v30, s[20:23], s3 offen
 s_add_u32 s3, s3, 4096
 s_mov_b32 s8, s56
 s_mov_b32 s9, s57
 s_mov_b32 s10, 0x2000000
 s_mov_b32 s11, 0x20000
 s_mov_b32 s16, s62
 s_mov_b32 s17, s63
 s_mov_b32 s18, 0x2000000
 s_mov_b32 s19, 0x20000
 s_mov_b32 s12, s66
 s_mov_b32 s13, s67
 s_mov_b32 s14, 0xc00000
 s_mov_b32 s15, 0x20000
 s_mov_b32 s32, s66
 s_mov_b32 s33, s67
 s_mov_b32 s34, 0x10000000
 s_mov_b32 s35, 0x20000
 s_mov_b32 s44, s64
 s_mov_b32 s45, s65
 s_mov_b32 s46, 0x100
 s_mov_b32 s47, 0x20000
 s_add_u32 s24, s24, 4096
 s_add_u32 s70, s66, s24
 s_addc_u32 s71, s67, 0
 s_sub_u32 s24, s24, 4096
 s_and_b32 s3, s2, 3
 s_lshl_b32 s3, s3, 6
 s_add_u32 s56, s44, s3
 s_addc_u32 s57, s45, 0
 s_mov_b32 s58, 0x4
 s_mov_b32 s59, 0x20000
 s_lshl_b32 s3, s2, 2
 s_add_u32 s3, s3, s54
 s_lshl_b32 s3, s3, 7
 s_add_u32 s3, s3, 15728640
 s_add_u32 s60, s32, s3
 s_addc_u32 s61, s33, 0
 s_mov_b32 s62, 0x4
 s_mov_b32 s63, 0x20000
 s_xor_b32 s3, s3, 512
 s_add_u32 s64, s32, s3
 s_addc_u32 s65, s33, 0
 s_mov_b32 s66, 0x4
 s_mov_b32 s67, 0x20000
 v_lshrrev_b32 v5, 2, v1
 v_and_b32 v5, 64, v5
 v_xor_b32 v5, v5, v1
 v_and_b32 v5, 112, v5
 v_lshrrev_b32 v6, 7, v1
 v_lshl_add_u32 v23, v6, 11, v5
 s_and_b32 s69, s28, 2047
 s_lshl_b32 s3, s7, 20
 s_add_u32 s69, s69, s3
 s_add_u32 m0, s50, 0
 s_add_u32 s3, s69, 0
 buffer_load_dwordx4 v23, s[40:43], s3 offen lds
 s_add_u32 m0, s50, 1024
 s_add_u32 s3, s69, 16384
 buffer_load_dwordx4 v23, s[40:43], s3 offen lds
 s_add_u32 m0, s50, 4096
 s_add_u32 s3, s69, 32768
 buffer_load_dwordx4 v23, s[40:43], s3 offen lds
 s_add_u32 m0, s50, 5120
 s_add_u32 s3, s69, 49152
 buffer_load_dwordx4 v23, s[40:43], s3 offen lds
 s_add_u32 m0, s50, 8192
 s_add_u32 s3, s69, 65536
 buffer_load_dwordx4 v23, s[40:43], s3 offen lds
 s_add_u32 m0, s50, 9216
 s_add_u32 s3, s69, 81920
 buffer_load_dwordx4 v23, s[40:43], s3 offen lds
 s_add_u32 m0, s50, 12288
 s_add_u32 s3, s69, 98304
 buffer_load_dwordx4 v23, s[40:43], s3 offen lds
 s_add_u32 m0, s50, 13312
 s_add_u32 s3, s69, 114688
 buffer_load_dwordx4 v23, s[40:43], s3 offen lds
 s_add_u32 m0, s50, 16384
 s_add_u32 s3, s69, 262144
 buffer_load_dwordx4 v23, s[40:43], s3 offen lds
 s_add_u32 m0, s50, 17408
 s_add_u32 s3, s69, 278528
 buffer_load_dwordx4 v23, s[40:43], s3 offen lds
 s_add_u32 m0, s50, 20480
 s_add_u32 s3, s69, 294912
 buffer_load_dwordx4 v23, s[40:43], s3 offen lds
 s_add_u32 m0, s50, 21504
 s_add_u32 s3, s69, 311296
 buffer_load_dwordx4 v23, s[40:43], s3 offen lds
 s_add_u32 m0, s50, 24576
 s_add_u32 s3, s69, 327680
 buffer_load_dwordx4 v23, s[40:43], s3 offen lds
 s_add_u32 m0, s50, 25600
 s_add_u32 s3, s69, 344064
 buffer_load_dwordx4 v23, s[40:43], s3 offen lds
 s_add_u32 m0, s50, 28672
 s_add_u32 s3, s69, 360448
 buffer_load_dwordx4 v23, s[40:43], s3 offen lds
 s_add_u32 m0, s50, 29696
 s_add_u32 s3, s69, 376832
 buffer_load_dwordx4 v23, s[40:43], s3 offen lds
 v_mov_b32 v7, 0
 buffer_store_dword v7, v1, s[60:63], 0 offen sc1
 v_lshrrev_b32 v5, 7, v1
 v_lshlrev_b32 v6, 4, v5
 v_xor_b32 v6, v6, v1
 v_and_b32 v6, 112, v6
 v_lshl_add_u32 v20, v5, 11, v6
 v_lshrrev_b32 v5, 4, v1
 v_and_b32 v5, 48, v5
 v_xor_b32 v5, v5, v1
 v_and_b32 v5, 112, v5
 v_and_b32 v6, 240, v1
 v_lshl_add_u32 v5, v6, 3, v5
 v_add_u32 v21, s50, v5
 v_xor_b32 v22, 64, v21
 v_lshrrev_b32 v5, 1, v1
 v_and_b32 v5, 64, v5
 v_and_b32 v6, 48, v1
 v_or_b32 v5, v5, v6
 v_and_b32 v6, 192, v1
 v_lshl_add_u32 v5, v6, 1, v5
 v_and_b32 v6, 256, v1
 v_lshl_add_u32 v5, v6, 2, v5
 v_and_b32 v6, 512, v1
 v_lshl_add_u32 v5, v6, 3, v5
 v_add_u32 v24, s50, v5
 v_xor_b32 v25, 64, v24
 v_mov_b32 v64, 1.0
 v_mov_b32 v65, 1.0
 v_mov_b32 v66, 1.0
 v_mov_b32 v67, 1.0
 v_mov_b32 v68, 1.0
 v_mov_b32 v69, 1.0
 v_mov_b32 v70, 1.0
 v_mov_b32 v71, 1.0
 v_mov_b32 v72, 1.0
 v_mov_b32 v73, 1.0
 v_mov_b32 v74, 1.0
 v_mov_b32 v75, 1.0
 v_mov_b32 v76, 1.0
 v_mov_b32 v77, 1.0
 v_mov_b32 v78, 1.0
 v_mov_b32 v79, 1.0
 v_mov_b32 v80, 1.0
 v_mov_b32 v81, 1.0
 v_mov_b32 v82, 1.0
 v_mov_b32 v83, 1.0
 v_mov_b32 v84, 1.0
 v_mov_b32 v85, 1.0
 v_mov_b32 v86, 1.0
 v_mov_b32 v87, 1.0
 v_mov_b32 v88, 1.0
 v_mov_b32 v89, 1.0
 v_mov_b32 v90, 1.0
 v_mov_b32 v91, 1.0
 v_mov_b32 v92, 1.0
 v_mov_b32 v93, 1.0
 v_mov_b32 v94, 1.0
 v_mov_b32 v95, 1.0
 v_mov_b32 v96, 1.0
 v_mov_b32 v97, 1.0
 v_mov_b32 v98, 1.0
 v_mov_b32 v99, 1.0
 v_mov_b32 v100, 1.0
 v_mov_b32 v101, 1.0
 v_mov_b32 v102, 1.0
 v_mov_b32 v103, 1.0
 v_mov_b32 v104, 1.0
 v_mov_b32 v105, 1.0
 v_mov_b32 v106, 1.0
 v_mov_b32 v107, 1.0
 v_mov_b32 v108, 1.0
 v_mov_b32 v109, 1.0
 v_mov_b32 v110, 1.0
 v_mov_b32 v111, 1.0
 v_mov_b32 v112, 1.0
 v_mov_b32 v113, 1.0
 v_mov_b32 v114, 1.0
 v_mov_b32 v115, 1.0
 v_mov_b32 v116, 1.0
 v_mov_b32 v117, 1.0
 v_mov_b32 v118, 1.0
 v_mov_b32 v119, 1.0
 v_mov_b32 v120, 1.0
 v_mov_b32 v121, 1.0
 v_mov_b32 v122, 1.0
 v_mov_b32 v123, 1.0
 v_mov_b32 v124, 1.0
 v_mov_b32 v125, 1.0
 v_mov_b32 v126, 1.0
 v_mov_b32 v127, 1.0
 v_mov_b32 v128, 1.0
 v_mov_b32 v129, 1.0
 v_mov_b32 v130, 1.0
 v_mov_b32 v131, 1.0
 v_mov_b32 v132, 1.0
 v_mov_b32 v133, 1.0
 v_mov_b32 v134, 1.0
 v_mov_b32 v135, 1.0
 v_accvgpr_write_b32 a240, 1.0
 v_accvgpr_write_b32 a241, 1.0
 v_accvgpr_write_b32 a242, 1.0
 v_accvgpr_write_b32 a243, 1.0
 v_accvgpr_write_b32 a244, 1.0
 v_accvgpr_write_b32 a245, 1.0
 v_accvgpr_write_b32 a246, 1.0
 v_accvgpr_write_b32 a247, 1.0
 v_mov_b32 v216, 1.0
 v_mov_b32 v217, 1.0
 v_mov_b32 v218, 1.0
 v_mov_b32 v219, 1.0
 v_mov_b32 v220, 1.0
 v_mov_b32 v221, 1.0
 v_mov_b32 v222, 1.0
 v_mov_b32 v223, 1.0
 v_mov_b32 v224, 1.0
 v_mov_b32 v225, 1.0
 v_mov_b32 v226, 1.0
 v_mov_b32 v227, 1.0
 v_mov_b32 v228, 1.0
 v_mov_b32 v229, 1.0
 v_mov_b32 v230, 1.0
 v_mov_b32 v231, 1.0
 v_mov_b32 v232, 1.0
 v_mov_b32 v233, 1.0
 v_mov_b32 v234, 1.0
 v_mov_b32 v235, 1.0
 v_mov_b32 v236, 1.0
 v_mov_b32 v237, 1.0
 v_mov_b32 v238, 1.0
 v_mov_b32 v239, 1.0
 v_mov_b32 v240, 1.0
 v_mov_b32 v241, 1.0
 v_mov_b32 v242, 1.0
 v_mov_b32 v243, 1.0
 v_mov_b32 v244, 1.0
 v_mov_b32 v245, 1.0
 v_mov_b32 v246, 1.0
 v_mov_b32 v247, 1.0
 v_mov_b32 v248, 1.0
 v_mov_b32 v249, 1.0
 v_mov_b32 v250, 1.0
 v_mov_b32 v251, 1.0
 v_mov_b32 v252, 1.0
 v_mov_b32 v253, 1.0
 v_mov_b32 v254, 1.0
 v_mov_b32 v255, 1.0
 v_accvgpr_write_b32 a248, 1.0
 v_accvgpr_write_b32 a249, 1.0
 v_accvgpr_write_b32 a250, 1.0
 v_accvgpr_write_b32 a251, 1.0
 v_accvgpr_write_b32 a252, 1.0
 v_accvgpr_write_b32 a253, 1.0
 v_accvgpr_write_b32 a254, 1.0
 v_accvgpr_write_b32 a255, 1.0
 v_and_b32 v5, 768, v3
 v_and_b32 v7, 1023, v3
 v_add3_u32 v5, v5, v7, s52
 s_waitcnt vmcnt(20)
 ds_read_b64_tr_b16 v[8:9], v5 offset:0
 ds_read_b64_tr_b16 v[10:11], v5 offset:256
 ds_read_b64_tr_b16 v[12:13], v5 offset:8
 ds_read_b64_tr_b16 v[14:15], v5 offset:264
 s_waitcnt lgkmcnt(2)
 buffer_store_dwordx4 v[8:11], v7, s[12:15], s49 offen sc1
 s_waitcnt lgkmcnt(0)
 buffer_store_dwordx4 v[12:15], v7, s[12:15], s49 offen offset:2048 sc1
 s_add_u32 s49, s49, 2097152
 s_add_u32 m0, s50, 2048
 s_add_u32 s3, s69, 524288
 buffer_load_dwordx4 v23, s[40:43], s3 offen lds
 s_add_u32 m0, s50, 3072
 s_add_u32 s3, s69, 540672
 buffer_load_dwordx4 v23, s[40:43], s3 offen lds
 s_add_u32 m0, s50, 6144
 s_add_u32 s3, s69, 557056
 buffer_load_dwordx4 v23, s[40:43], s3 offen lds
 s_add_u32 m0, s50, 7168
 s_add_u32 s3, s69, 573440
 buffer_load_dwordx4 v23, s[40:43], s3 offen lds
 s_add_u32 m0, s50, 10240
 s_add_u32 s3, s69, 589824
 buffer_load_dwordx4 v23, s[40:43], s3 offen lds
 s_add_u32 m0, s50, 11264
 s_add_u32 s3, s69, 606208
 buffer_load_dwordx4 v23, s[40:43], s3 offen lds
 s_add_u32 m0, s50, 14336
 s_add_u32 s3, s69, 622592
 buffer_load_dwordx4 v23, s[40:43], s3 offen lds
 s_add_u32 m0, s50, 15360
 s_add_u32 s3, s69, 638976
 buffer_load_dwordx4 v23, s[40:43], s3 offen lds
 s_waitcnt vmcnt(29)
 v_lshlrev_b32 v40, 16, v32
 v_and_b32 v41, s26, v32
 v_lshlrev_b32 v42, 16, v33
 v_and_b32 v43, s26, v33
 ds_write_b128 v31, v[40:43]
 s_waitcnt vmcnt(28)
 v_lshlrev_b32 v44, 16, v34
 v_and_b32 v45, s26, v34
 v_lshlrev_b32 v46, 16, v35
 v_and_b32 v47, s26, v35
 ds_write_b128 v31, v[44:47] offset:4096
 s_waitcnt vmcnt(27)
 v_lshlrev_b32 v48, 16, v36
 v_and_b32 v49, s26, v36
 v_lshlrev_b32 v50, 16, v37
 v_and_b32 v51, s26, v37
 ds_write_b128 v31, v[48:51] offset:8192
 s_waitcnt lgkmcnt(0)
 v_mov_b32 v32, 1.0
 v_mov_b32 v33, 1.0
 v_mov_b32 v34, 1.0
 v_mov_b32 v35, 1.0
 v_mov_b32 v36, 1.0
 v_mov_b32 v37, 1.0
 v_mov_b32 v38, 1.0
 v_mov_b32 v39, 1.0
 v_mov_b32 v40, 1.0
 v_mov_b32 v41, 1.0
 v_mov_b32 v42, 1.0
 v_mov_b32 v43, 1.0
 v_mov_b32 v44, 1.0
 v_mov_b32 v45, 1.0
 v_mov_b32 v46, 1.0
 v_mov_b32 v47, 1.0
 v_mov_b32 v48, 1.0
 v_mov_b32 v49, 1.0
 v_mov_b32 v50, 1.0
 v_mov_b32 v51, 1.0
 v_mov_b32 v52, 1.0
 v_mov_b32 v53, 1.0
 v_mov_b32 v54, 1.0
 v_mov_b32 v55, 1.0
 v_mov_b32 v56, 1.0
 v_mov_b32 v57, 1.0
 v_mov_b32 v58, 1.0
 v_mov_b32 v59, 1.0
 v_mov_b32 v60, 1.0
 v_mov_b32 v61, 1.0
 v_mov_b32 v62, 1.0
 v_mov_b32 v63, 1.0
 s_waitcnt vmcnt(23)
 ds_read_b64_tr_b16 v[136:137], v24 offset:0
 ds_read_b64_tr_b16 v[138:139], v24 offset:512
 ds_read_b64_tr_b16 v[144:145], v24 offset:8
 ds_read_b64_tr_b16 v[146:147], v24 offset:520
 ds_read_b64_tr_b16 v[152:153], v25 offset:0
 ds_read_b64_tr_b16 v[154:155], v25 offset:512
 ds_read_b64_tr_b16 v[160:161], v25 offset:8
 ds_read_b64_tr_b16 v[162:163], v25 offset:520
 s_waitcnt vmcnt(19)
 ds_read_b64_tr_b16 v[140:141], v24 offset:8192
 ds_read_b64_tr_b16 v[142:143], v24 offset:8704
 ds_read_b64_tr_b16 v[148:149], v24 offset:8200
 ds_read_b64_tr_b16 v[150:151], v24 offset:8712
 ds_read_b64_tr_b16 v[156:157], v25 offset:8192
 ds_read_b64_tr_b16 v[158:159], v25 offset:8704
 ds_read_b64_tr_b16 v[164:165], v25 offset:8200
 ds_read_b64_tr_b16 v[166:167], v25 offset:8712
 s_waitcnt lgkmcnt(8)
 s_add_u32 m0, s50, 0
 s_add_u32 s3, s28, 0
 buffer_load_dwordx4 v20, s[8:11], s3 offen lds
 s_add_u32 m0, s50, 1024
 s_add_u32 s3, s28, 16384
 buffer_load_dwordx4 v20, s[8:11], s3 offen lds
 s_add_u32 m0, s50, 4096
 s_add_u32 s3, s28, 32768
 buffer_load_dwordx4 v20, s[8:11], s3 offen lds
 s_add_u32 m0, s50, 5120
 s_add_u32 s3, s28, 49152
 buffer_load_dwordx4 v20, s[8:11], s3 offen lds
 s_waitcnt vmcnt(19)
 ds_read_b64_tr_b16 v[168:169], v24 offset:16384
 ds_read_b64_tr_b16 v[170:171], v24 offset:16896
 ds_read_b64_tr_b16 v[176:177], v24 offset:16392
 ds_read_b64_tr_b16 v[178:179], v24 offset:16904
 ds_read_b64_tr_b16 v[184:185], v25 offset:16384
 ds_read_b64_tr_b16 v[186:187], v25 offset:16896
 ds_read_b64_tr_b16 v[192:193], v25 offset:16392
 ds_read_b64_tr_b16 v[194:195], v25 offset:16904
 s_waitcnt lgkmcnt(8)
 s_add_u32 m0, s50, 8192
 s_add_u32 s3, s28, 65536
 buffer_load_dwordx4 v20, s[8:11], s3 offen lds
 s_add_u32 m0, s50, 9216
 s_add_u32 s3, s28, 81920
 buffer_load_dwordx4 v20, s[8:11], s3 offen lds
 s_add_u32 m0, s50, 12288
 s_add_u32 s3, s28, 98304
 buffer_load_dwordx4 v20, s[8:11], s3 offen lds
 s_add_u32 m0, s50, 13312
 s_add_u32 s3, s28, 114688
 buffer_load_dwordx4 v20, s[8:11], s3 offen lds
 s_waitcnt vmcnt(19)
 ds_read_b64_tr_b16 v[172:173], v24 offset:24576
 ds_read_b64_tr_b16 v[174:175], v24 offset:25088
 ds_read_b64_tr_b16 v[180:181], v24 offset:24584
 ds_read_b64_tr_b16 v[182:183], v24 offset:25096
 ds_read_b64_tr_b16 v[188:189], v25 offset:24576
 ds_read_b64_tr_b16 v[190:191], v25 offset:25088
 ds_read_b64_tr_b16 v[196:197], v25 offset:24584
 ds_read_b64_tr_b16 v[198:199], v25 offset:25096
 s_waitcnt vmcnt(16)
 s_barrier
 v_mov_b32 v7, 1
 buffer_atomic_add v7, v0, s[56:59], 0 offen sc1
 s_add_u32 m0, s50, 18432
 s_add_u32 s3, s69, 786432
 buffer_load_dwordx4 v23, s[40:43], s3 offen lds
 s_add_u32 m0, s50, 19456
 s_add_u32 s3, s69, 802816
 buffer_load_dwordx4 v23, s[40:43], s3 offen lds
 s_add_u32 m0, s50, 22528
 s_add_u32 s3, s69, 819200
 buffer_load_dwordx4 v23, s[40:43], s3 offen lds
 s_add_u32 m0, s50, 23552
 s_add_u32 s3, s69, 835584
 buffer_load_dwordx4 v23, s[40:43], s3 offen lds
 s_add_u32 m0, s50, 26624
 s_add_u32 s3, s69, 851968
 buffer_load_dwordx4 v23, s[40:43], s3 offen lds
 s_add_u32 m0, s50, 27648
 s_add_u32 s3, s69, 868352
 buffer_load_dwordx4 v23, s[40:43], s3 offen lds
 s_add_u32 m0, s50, 30720
 s_add_u32 s3, s69, 884736
 buffer_load_dwordx4 v23, s[40:43], s3 offen lds
 s_add_u32 m0, s50, 31744
 s_add_u32 s3, s69, 901120
 buffer_load_dwordx4 v23, s[40:43], s3 offen lds
 s_waitcnt lgkmcnt(0)
 s_add_u32 m0, s50, 16384
 s_add_u32 s3, s28, 131072
 buffer_load_dwordx4 v20, s[8:11], s3 offen lds
 s_add_u32 m0, s50, 17408
 s_add_u32 s3, s28, 147456
 buffer_load_dwordx4 v20, s[8:11], s3 offen lds
 s_add_u32 m0, s50, 20480
 s_add_u32 s3, s28, 163840
 buffer_load_dwordx4 v20, s[8:11], s3 offen lds
 s_add_u32 m0, s50, 21504
 s_add_u32 s3, s28, 180224
 buffer_load_dwordx4 v20, s[8:11], s3 offen lds
 s_add_u32 m0, s50, 24576
 s_add_u32 s3, s28, 196608
 buffer_load_dwordx4 v20, s[8:11], s3 offen lds
 s_add_u32 m0, s50, 25600
 s_add_u32 s3, s28, 212992
 buffer_load_dwordx4 v20, s[8:11], s3 offen lds
 s_add_u32 m0, s50, 28672
 s_add_u32 s3, s28, 229376
 buffer_load_dwordx4 v20, s[8:11], s3 offen lds
 s_add_u32 m0, s50, 29696
 s_add_u32 s3, s28, 245760
 buffer_load_dwordx4 v20, s[8:11], s3 offen lds
 s_waitcnt vmcnt(29)
 ds_read_b64_tr_b16 v[200:201], v24 offset:2048
 ds_read_b64_tr_b16 v[202:203], v24 offset:2560
 ds_read_b64_tr_b16 v[208:209], v24 offset:2056
 ds_read_b64_tr_b16 v[210:211], v24 offset:2568
 ds_read_b64_tr_b16 a[224:225], v25 offset:2048
 ds_read_b64_tr_b16 a[226:227], v25 offset:2560
 ds_read_b64_tr_b16 a[232:233], v25 offset:2056
 ds_read_b64_tr_b16 a[234:235], v25 offset:2568
 s_waitcnt vmcnt(25)
 ds_read_b64_tr_b16 v[204:205], v24 offset:10240
 ds_read_b64_tr_b16 v[206:207], v24 offset:10752
 ds_read_b64_tr_b16 v[212:213], v24 offset:10248
 ds_read_b64_tr_b16 v[214:215], v24 offset:10760
 ds_read_b64_tr_b16 a[228:229], v25 offset:10240
 ds_read_b64_tr_b16 a[230:231], v25 offset:10752
 ds_read_b64_tr_b16 a[236:237], v25 offset:10248
 ds_read_b64_tr_b16 a[238:239], v25 offset:10760
 s_waitcnt vmcnt(12)
 ds_read_b64_tr_b16 a[192:193], v24 offset:18432
 ds_read_b64_tr_b16 a[194:195], v24 offset:18944
 ds_read_b64_tr_b16 a[200:201], v24 offset:18440
 ds_read_b64_tr_b16 a[202:203], v24 offset:18952
 ds_read_b64_tr_b16 a[208:209], v25 offset:18432
 ds_read_b64_tr_b16 a[210:211], v25 offset:18944
 ds_read_b64_tr_b16 a[216:217], v25 offset:18440
 ds_read_b64_tr_b16 a[218:219], v25 offset:18952
 s_waitcnt vmcnt(8)
 ds_read_b64_tr_b16 a[196:197], v24 offset:26624
 ds_read_b64_tr_b16 a[198:199], v24 offset:27136
 ds_read_b64_tr_b16 a[204:205], v24 offset:26632
 ds_read_b64_tr_b16 a[206:207], v24 offset:27144
 ds_read_b64_tr_b16 a[212:213], v25 offset:26624
 ds_read_b64_tr_b16 a[214:215], v25 offset:27136
 ds_read_b64_tr_b16 a[220:221], v25 offset:26632
 ds_read_b64_tr_b16 a[222:223], v25 offset:27144
 ds_read_b128 a[0:3], v21
 ds_read_b128 a[32:35], v22
 ds_read_b128 a[4:7], v21 offset:4096
 ds_read_b128 a[36:39], v22 offset:4096
 s_waitcnt lgkmcnt(2)
 ds_write_b128 v3, a[0:3]
 ds_write_b128 v3, a[32:35] offset:1024
 ds_read_b128 a[8:11], v21 offset:8192
 ds_read_b128 a[40:43], v22 offset:8192
 s_waitcnt lgkmcnt(4)
 ds_write_b128 v3, a[4:7] offset:4096
 ds_write_b128 v3, a[36:39] offset:5120
 ds_read_b128 a[12:15], v21 offset:12288
 ds_read_b128 a[44:47], v22 offset:12288
 s_waitcnt lgkmcnt(4)
 ds_write_b128 v3, a[8:11] offset:8192
 ds_write_b128 v3, a[40:43] offset:9216
 s_waitcnt vmcnt(6)
 ds_read_b128 a[16:19], v21 offset:16384
 ds_read_b128 a[48:51], v22 offset:16384
 s_waitcnt lgkmcnt(4)
 ds_write_b128 v3, a[12:15] offset:12288
 ds_write_b128 v3, a[44:47] offset:13312
 s_waitcnt vmcnt(4)
 ds_read_b128 a[20:23], v21 offset:20480
 ds_read_b128 a[52:55], v22 offset:20480
 s_waitcnt lgkmcnt(4)
 ds_write_b128 v3, a[16:19] offset:16384
 ds_write_b128 v3, a[48:51] offset:17408
 s_waitcnt vmcnt(2)
 ds_read_b128 a[24:27], v21 offset:24576
 ds_read_b128 a[56:59], v22 offset:24576
 s_waitcnt lgkmcnt(4)
 ds_write_b128 v3, a[20:23] offset:20480
 ds_write_b128 v3, a[52:55] offset:21504
 s_waitcnt lgkmcnt(0)
 v_lshlrev_b32 v4, 2, v3
 v_and_b32 v4, 192, v4
 buffer_load_dword v4, v4, s[44:47], 0 offen sc1
 s_add_u32 m0, s50, 2048
 s_add_u32 s3, s28, 128
 buffer_load_dwordx4 v20, s[8:11], s3 offen lds
 s_add_u32 m0, s50, 3072
 s_add_u32 s3, s28, 16512
 buffer_load_dwordx4 v20, s[8:11], s3 offen lds
 s_waitcnt vmcnt(3)
 ds_read_b128 a[28:31], v21 offset:28672
 ds_read_b128 a[60:63], v22 offset:28672
 ds_write_b128 v3, a[24:27] offset:24576
 ds_write_b128 v3, a[56:59] offset:25600
 s_waitcnt lgkmcnt(2)
 ds_write_b128 v3, a[28:31] offset:28672
 ds_write_b128 v3, a[60:63] offset:29696
 s_add_u32 m0, s50, 6144
 s_add_u32 s3, s28, 32896
 buffer_load_dwordx4 v20, s[8:11], s3 offen lds
 s_add_u32 m0, s50, 7168
 s_add_u32 s3, s28, 49280
 buffer_load_dwordx4 v20, s[8:11], s3 offen lds
 s_add_u32 m0, s50, 10240
 s_add_u32 s3, s28, 65664
 buffer_load_dwordx4 v20, s[8:11], s3 offen lds
 s_add_u32 m0, s50, 11264
 s_add_u32 s3, s28, 82048
 buffer_load_dwordx4 v20, s[8:11], s3 offen lds
 v_mov_b32 v8, v20
 v_mov_b32 v16, 1.0
 v_mov_b32 v17, 1.0
 v_mov_b32 v18, 1.0
 v_mov_b32 v19, 1.0
 v_mov_b32 v20, 1.0
 v_mov_b32 v21, 1.0
 v_mov_b32 v22, 1.0
 v_mov_b32 v23, 1.0
 v_mov_b32 v24, 1.0
 v_mov_b32 v25, 1.0
 v_mov_b32 v26, 1.0
 v_mov_b32 v27, 1.0
 v_mov_b32 v28, 1.0
 v_mov_b32 v29, 1.0
 v_mov_b32 v30, 1.0
 v_mov_b32 v31, 1.0
 s_add_u32 s70, s70, 32768
 s_addc_u32 s71, s71, 0
 s_xor_b32 s30, s28, 1024
 s_mov_b32 s20, 64
 s_mov_b32 s21, 32704
 s_mov_b32 s22, 0xfffc8040
 s_waitcnt lgkmcnt(0)
 s_barrier
 ds_read_b128 a[128:131], v1
 ds_read_b128 a[132:135], v1 offset:1024
 ds_read_b128 a[140:143], v1 offset:5120
 ds_read_b128 a[136:139], v1 offset:4096
 ds_read_b128 a[144:147], v1 offset:8192
 ds_read_b128 a[148:151], v1 offset:9216
 ds_read_b128 a[156:159], v1 offset:13312
 ds_read_b128 a[152:155], v1 offset:12288
 ds_read_b128 a[160:163], v1 offset:16384
 ds_read_b128 a[164:167], v1 offset:17408
 ds_read_b128 a[172:175], v1 offset:21504
 ds_read_b128 a[168:171], v1 offset:20480
 ds_read_b128 a[176:179], v1 offset:24576
 ds_read_b128 a[180:183], v1 offset:25600
 ds_read_b128 a[188:191], v1 offset:29696
 ds_read_b128 a[184:187], v1 offset:28672
 s_waitcnt lgkmcnt(8)
 v_mfma_f32_16x16x32_bf16 v[16:19], v[136:139], a[128:131], v[16:19]
 s_add_u32 m0, s50, 14336
 v_mfma_f32_16x16x32_bf16 v[16:19], v[140:143], a[132:135], v[16:19]
 v_mfma_f32_16x16x32_bf16 v[20:23], v[140:143], a[140:143], v[20:23]
 s_add_u32 s3, s28, 98432
 v_mfma_f32_16x16x32_bf16 v[20:23], v[136:139], a[136:139], v[20:23]
 buffer_load_dwordx4 v8, s[8:11], s3 offen lds
 v_mfma_f32_16x16x32_bf16 v[24:27], v[136:139], a[144:147], v[24:27]
 s_add_u32 m0, s50, 15360
 v_mfma_f32_16x16x32_bf16 v[24:27], v[140:143], a[148:151], v[24:27]
 v_mfma_f32_16x16x32_bf16 v[28:31], v[140:143], a[156:159], v[28:31]
 s_add_u32 s3, s28, 114816
 v_mfma_f32_16x16x32_bf16 v[28:31], v[136:139], a[152:155], v[28:31]
 buffer_load_dwordx4 v8, s[8:11], s3 offen lds
 s_waitcnt lgkmcnt(0)
 v_mfma_f32_16x16x32_bf16 v[32:35], v[136:139], a[160:163], v[32:35]
 s_add_u32 m0, s50, 18432
 v_mfma_f32_16x16x32_bf16 v[32:35], v[140:143], a[164:167], v[32:35]
 s_add_u32 s3, s28, 131200
 v_mfma_f32_16x16x32_bf16 v[36:39], v[140:143], a[172:175], v[36:39]
 v_mfma_f32_16x16x32_bf16 v[36:39], v[136:139], a[168:171], v[36:39]
 buffer_load_dwordx4 v8, s[8:11], s3 offen lds
 v_mfma_f32_16x16x32_bf16 v[40:43], v[136:139], a[176:179], v[40:43]
 s_add_u32 m0, s50, 19456
 v_mfma_f32_16x16x32_bf16 v[40:43], v[140:143], a[180:183], v[40:43]
 s_add_u32 s3, s28, 147584
 v_mfma_f32_16x16x32_bf16 v[44:47], v[140:143], a[188:191], v[44:47]
 v_mfma_f32_16x16x32_bf16 v[44:47], v[136:139], a[184:187], v[44:47]
 buffer_load_dwordx4 v8, s[8:11], s3 offen lds
 v_mfma_f32_16x16x32_bf16 v[76:79], v[144:147], a[184:187], v[76:79]
 s_add_u32 m0, s50, 22528
 v_mfma_f32_16x16x32_bf16 v[76:79], v[148:151], a[188:191], v[76:79]
 s_add_u32 s3, s28, 163968
 v_mfma_f32_16x16x32_bf16 v[72:75], v[148:151], a[180:183], v[72:75]
 v_mov_b32 v136, 1.0
 v_mfma_f32_16x16x32_bf16 v[72:75], v[144:147], a[176:179], v[72:75]
 buffer_load_dwordx4 v8, s[8:11], s3 offen lds
 v_mfma_f32_16x16x32_bf16 v[68:71], v[144:147], a[168:171], v[68:71]
 s_add_u32 m0, s50, 23552
 v_mov_b32 v137, 1.0
 v_mfma_f32_16x16x32_bf16 v[68:71], v[148:151], a[172:175], v[68:71]
 s_add_u32 s3, s28, 180352
 v_mov_b32 v138, 1.0
 v_mfma_f32_16x16x32_bf16 v[64:67], v[148:151], a[164:167], v[64:67]
 buffer_load_dwordx4 v8, s[8:11], s3 offen lds
 v_mfma_f32_16x16x32_bf16 v[64:67], v[144:147], a[160:163], v[64:67]
 v_mov_b32 v139, 1.0
 v_mfma_f32_16x16x32_bf16 v[60:63], v[144:147], a[152:155], v[60:63]
 s_add_u32 m0, s50, 26624
 v_mov_b32 v140, 1.0
 v_mfma_f32_16x16x32_bf16 v[60:63], v[148:151], a[156:159], v[60:63]
 v_mfma_f32_16x16x32_bf16 v[56:59], v[148:151], a[148:151], v[56:59]
 s_add_u32 s3, s28, 196736
 v_mov_b32 v141, 1.0
 v_mfma_f32_16x16x32_bf16 v[56:59], v[144:147], a[144:147], v[56:59]
 v_mov_b32 v142, 1.0
 v_mfma_f32_16x16x32_bf16 v[52:55], v[144:147], a[136:139], v[52:55]
 buffer_load_dwordx4 v8, s[8:11], s3 offen lds
 s_add_u32 m0, s50, 27648
 v_mfma_f32_16x16x32_bf16 v[52:55], v[148:151], a[140:143], v[52:55]
 v_mov_b32 v143, 1.0
 v_mfma_f32_16x16x32_bf16 v[48:51], v[148:151], a[132:135], v[48:51]
 s_add_u32 s3, s28, 213120
 v_mfma_f32_16x16x32_bf16 v[48:51], v[144:147], a[128:131], v[48:51]
 buffer_load_dwordx4 v8, s[8:11], s3 offen lds
 v_mfma_f32_16x16x32_bf16 v[80:83], v[152:155], a[128:131], v[80:83]
 s_add_u32 m0, s50, 30720
 v_mfma_f32_16x16x32_bf16 v[80:83], v[156:159], a[132:135], v[80:83]
 v_mfma_f32_16x16x32_bf16 v[84:87], v[156:159], a[140:143], v[84:87]
 s_add_u32 s3, s28, 229504
 v_mov_b32 v144, 1.0
 v_mfma_f32_16x16x32_bf16 v[84:87], v[152:155], a[136:139], v[84:87]
 buffer_load_dwordx4 v8, s[8:11], s3 offen lds
 v_mfma_f32_16x16x32_bf16 v[88:91], v[152:155], a[144:147], v[88:91]
 s_add_u32 m0, s50, 31744
 v_mov_b32 v145, 1.0
 v_mfma_f32_16x16x32_bf16 v[88:91], v[156:159], a[148:151], v[88:91]
 s_add_u32 s3, s28, 245888
 v_mov_b32 v146, 1.0
 v_mfma_f32_16x16x32_bf16 v[92:95], v[156:159], a[156:159], v[92:95]
 buffer_load_dwordx4 v8, s[8:11], s3 offen lds
 v_mfma_f32_16x16x32_bf16 v[92:95], v[152:155], a[152:155], v[92:95]
 v_mov_b32 v147, 1.0
 v_mfma_f32_16x16x32_bf16 v[96:99], v[152:155], a[160:163], v[96:99]
 v_mov_b32 v148, 1.0
 v_mfma_f32_16x16x32_bf16 v[96:99], v[156:159], a[164:167], v[96:99]
 v_mfma_f32_16x16x32_bf16 v[100:103], v[156:159], a[172:175], v[100:103]
 v_mov_b32 v149, 1.0
 v_mfma_f32_16x16x32_bf16 v[100:103], v[152:155], a[168:171], v[100:103]
 v_mov_b32 v150, 1.0
 v_mfma_f32_16x16x32_bf16 v[104:107], v[152:155], a[176:179], v[104:107]
 v_mfma_f32_16x16x32_bf16 v[104:107], v[156:159], a[180:183], v[104:107]
 v_mov_b32 v151, 1.0
 v_mfma_f32_16x16x32_bf16 v[108:111], v[156:159], a[188:191], v[108:111]
 v_mfma_f32_16x16x32_bf16 v[108:111], v[152:155], a[184:187], v[108:111]
 v_mfma_f32_16x16x32_bf16 a[244:247], v[160:163], a[184:187], a[244:247]
 ds_read_b128 a[184:187], v1 offset:61440
 v_mfma_f32_16x16x32_bf16 a[244:247], v[164:167], a[188:191], a[244:247]
 ds_read_b128 a[188:191], v1 offset:62464
 v_mfma_f32_16x16x32_bf16 a[240:243], v[164:167], a[180:183], a[240:243]
 ds_read_b128 a[180:183], v1 offset:58368
 v_mov_b32 v152, 1.0
 v_mfma_f32_16x16x32_bf16 a[240:243], v[160:163], a[176:179], a[240:243]
 ds_read_b128 a[176:179], v1 offset:57344
 v_mfma_f32_16x16x32_bf16 v[132:135], v[160:163], a[168:171], v[132:135]
 ds_read_b128 a[168:171], v1 offset:53248
 v_mov_b32 v153, 1.0
 v_mfma_f32_16x16x32_bf16 v[132:135], v[164:167], a[172:175], v[132:135]
 ds_read_b128 a[172:175], v1 offset:54272
 v_mov_b32 v154, 1.0
 v_mfma_f32_16x16x32_bf16 v[128:131], v[164:167], a[164:167], v[128:131]
 ds_read_b128 a[164:167], v1 offset:50176
 v_mfma_f32_16x16x32_bf16 v[128:131], v[160:163], a[160:163], v[128:131]
 ds_read_b128 a[160:163], v1 offset:49152
 v_mov_b32 v155, 1.0
 v_mfma_f32_16x16x32_bf16 v[124:127], v[160:163], a[152:155], v[124:127]
 ds_read_b128 a[152:155], v1 offset:45056
 v_mov_b32 v156, 1.0
 v_mfma_f32_16x16x32_bf16 v[124:127], v[164:167], a[156:159], v[124:127]
 ds_read_b128 a[156:159], v1 offset:46080
 v_mfma_f32_16x16x32_bf16 v[120:123], v[164:167], a[148:151], v[120:123]
 ds_read_b128 a[148:151], v1 offset:41984
 v_mov_b32 v157, 1.0
 v_mfma_f32_16x16x32_bf16 v[120:123], v[160:163], a[144:147], v[120:123]
 ds_read_b128 a[144:147], v1 offset:40960
 v_mov_b32 v158, 1.0
 v_mfma_f32_16x16x32_bf16 v[116:119], v[160:163], a[136:139], v[116:119]
 ds_read_b128 a[136:139], v1 offset:36864
 v_mfma_f32_16x16x32_bf16 v[116:119], v[164:167], a[140:143], v[116:119]
 ds_read_b128 a[140:143], v1 offset:37888
 v_mov_b32 v159, 1.0
 v_mfma_f32_16x16x32_bf16 v[112:115], v[164:167], a[132:135], v[112:115]
 ds_read_b128 a[132:135], v1 offset:33792
 v_mfma_f32_16x16x32_bf16 v[112:115], v[160:163], a[128:131], v[112:115]
 ds_read_b128 a[128:131], v1 offset:32768
 s_waitcnt lgkmcnt(8)
 v_mfma_f32_16x16x32_bf16 v[44:47], v[168:171], a[184:187], v[44:47]
 v_mfma_f32_16x16x32_bf16 v[44:47], v[172:175], a[188:191], v[44:47]
 v_mfma_f32_16x16x32_bf16 v[40:43], v[172:175], a[180:183], v[40:43]
 v_mov_b32 v160, 1.0
 v_mfma_f32_16x16x32_bf16 v[40:43], v[168:171], a[176:179], v[40:43]
 v_mfma_f32_16x16x32_bf16 v[36:39], v[168:171], a[168:171], v[36:39]
 v_mov_b32 v161, 1.0
 v_mfma_f32_16x16x32_bf16 v[36:39], v[172:175], a[172:175], v[36:39]
 v_mov_b32 v162, 1.0
 v_mfma_f32_16x16x32_bf16 v[32:35], v[172:175], a[164:167], v[32:35]
 v_mfma_f32_16x16x32_bf16 v[32:35], v[168:171], a[160:163], v[32:35]
 v_mov_b32 v163, 1.0
 s_waitcnt lgkmcnt(0)
 v_mfma_f32_16x16x32_bf16 v[28:31], v[168:171], a[152:155], v[28:31]
 v_mov_b32 v164, 1.0
 v_mfma_f32_16x16x32_bf16 v[28:31], v[172:175], a[156:159], v[28:31]
 v_mfma_f32_16x16x32_bf16 v[24:27], v[172:175], a[148:151], v[24:27]
 v_mov_b32 v165, 1.0
 v_mfma_f32_16x16x32_bf16 v[24:27], v[168:171], a[144:147], v[24:27]
 v_mov_b32 v166, 1.0
 v_mfma_f32_16x16x32_bf16 v[20:23], v[168:171], a[136:139], v[20:23]
 v_mfma_f32_16x16x32_bf16 v[20:23], v[172:175], a[140:143], v[20:23]
 v_mov_b32 v167, 1.0
 v_mfma_f32_16x16x32_bf16 v[16:19], v[172:175], a[132:135], v[16:19]
 v_mfma_f32_16x16x32_bf16 v[16:19], v[168:171], a[128:131], v[16:19]
 v_mfma_f32_16x16x32_bf16 v[48:51], v[176:179], a[128:131], v[48:51]
 v_mfma_f32_16x16x32_bf16 v[48:51], v[180:183], a[132:135], v[48:51]
 v_mfma_f32_16x16x32_bf16 v[52:55], v[180:183], a[140:143], v[52:55]
 v_mov_b32 v168, 1.0
 v_mfma_f32_16x16x32_bf16 v[52:55], v[176:179], a[136:139], v[52:55]
 v_mfma_f32_16x16x32_bf16 v[56:59], v[176:179], a[144:147], v[56:59]
 v_mov_b32 v169, 1.0
 v_mfma_f32_16x16x32_bf16 v[56:59], v[180:183], a[148:151], v[56:59]
 v_mov_b32 v170, 1.0
 v_mfma_f32_16x16x32_bf16 v[60:63], v[180:183], a[156:159], v[60:63]
 v_mfma_f32_16x16x32_bf16 v[60:63], v[176:179], a[152:155], v[60:63]
 v_mov_b32 v171, 1.0
 v_mfma_f32_16x16x32_bf16 v[64:67], v[176:179], a[160:163], v[64:67]
 v_mov_b32 v172, 1.0
 v_mfma_f32_16x16x32_bf16 v[64:67], v[180:183], a[164:167], v[64:67]
 v_mfma_f32_16x16x32_bf16 v[68:71], v[180:183], a[172:175], v[68:71]
 v_mov_b32 v173, 1.0
 v_mfma_f32_16x16x32_bf16 v[68:71], v[176:179], a[168:171], v[68:71]
 v_mov_b32 v174, 1.0
 v_mfma_f32_16x16x32_bf16 v[72:75], v[176:179], a[176:179], v[72:75]
 v_mfma_f32_16x16x32_bf16 v[72:75], v[180:183], a[180:183], v[72:75]
 v_mov_b32 v175, 1.0
 v_mfma_f32_16x16x32_bf16 v[76:79], v[180:183], a[188:191], v[76:79]
 v_mfma_f32_16x16x32_bf16 v[76:79], v[176:179], a[184:187], v[76:79]
 v_mfma_f32_16x16x32_bf16 v[108:111], v[184:187], a[184:187], v[108:111]
 v_mfma_f32_16x16x32_bf16 v[108:111], v[188:191], a[188:191], v[108:111]
 v_mfma_f32_16x16x32_bf16 v[104:107], v[188:191], a[180:183], v[104:107]
 v_mov_b32 v176, 1.0
 v_mfma_f32_16x16x32_bf16 v[104:107], v[184:187], a[176:179], v[104:107]
 v_mfma_f32_16x16x32_bf16 v[100:103], v[184:187], a[168:171], v[100:103]
 v_mov_b32 v177, 1.0
 v_mfma_f32_16x16x32_bf16 v[100:103], v[188:191], a[172:175], v[100:103]
 v_mov_b32 v178, 1.0
 v_mfma_f32_16x16x32_bf16 v[96:99], v[188:191], a[164:167], v[96:99]
 v_mfma_f32_16x16x32_bf16 v[96:99], v[184:187], a[160:163], v[96:99]
 v_mov_b32 v179, 1.0
 v_mfma_f32_16x16x32_bf16 v[92:95], v[184:187], a[152:155], v[92:95]
 v_mov_b32 v180, 1.0
 v_mfma_f32_16x16x32_bf16 v[92:95], v[188:191], a[156:159], v[92:95]
 v_mfma_f32_16x16x32_bf16 v[88:91], v[188:191], a[148:151], v[88:91]
 v_mov_b32 v181, 1.0
 v_mfma_f32_16x16x32_bf16 v[88:91], v[184:187], a[144:147], v[88:91]
 v_mov_b32 v182, 1.0
 v_mfma_f32_16x16x32_bf16 v[84:87], v[184:187], a[136:139], v[84:87]
 v_mfma_f32_16x16x32_bf16 v[84:87], v[188:191], a[140:143], v[84:87]
 v_mov_b32 v183, 1.0
 v_mfma_f32_16x16x32_bf16 v[80:83], v[188:191], a[132:135], v[80:83]
 v_mfma_f32_16x16x32_bf16 v[80:83], v[184:187], a[128:131], v[80:83]
 v_mfma_f32_16x16x32_bf16 v[112:115], v[192:195], a[128:131], v[112:115]
 ds_read_b128 a[128:131], v2
 v_mfma_f32_16x16x32_bf16 v[112:115], v[196:199], a[132:135], v[112:115]
 ds_read_b128 a[132:135], v2 offset:1024
 v_mfma_f32_16x16x32_bf16 v[116:119], v[196:199], a[140:143], v[116:119]
 ds_read_b128 a[140:143], v2 offset:5120
 v_mov_b32 v184, 1.0
 v_mfma_f32_16x16x32_bf16 v[116:119], v[192:195], a[136:139], v[116:119]
 ds_read_b128 a[136:139], v2 offset:4096
 v_mfma_f32_16x16x32_bf16 v[120:123], v[192:195], a[144:147], v[120:123]
 ds_read_b128 a[144:147], v2 offset:8192
 v_mov_b32 v185, 1.0
 v_mfma_f32_16x16x32_bf16 v[120:123], v[196:199], a[148:151], v[120:123]
 ds_read_b128 a[148:151], v2 offset:9216
 v_mov_b32 v186, 1.0
 v_mfma_f32_16x16x32_bf16 v[124:127], v[196:199], a[156:159], v[124:127]
 ds_read_b128 a[156:159], v2 offset:13312
 v_mfma_f32_16x16x32_bf16 v[124:127], v[192:195], a[152:155], v[124:127]
 ds_read_b128 a[152:155], v2 offset:12288
 v_mov_b32 v187, 1.0
 v_mfma_f32_16x16x32_bf16 v[128:131], v[192:195], a[160:163], v[128:131]
 ds_read_b128 a[160:163], v2 offset:16384
 v_mov_b32 v188, 1.0
 v_mfma_f32_16x16x32_bf16 v[128:131], v[196:199], a[164:167], v[128:131]
 ds_read_b128 a[164:167], v2 offset:17408
 v_mfma_f32_16x16x32_bf16 v[132:135], v[196:199], a[172:175], v[132:135]
 ds_read_b128 a[172:175], v2 offset:21504
 v_mov_b32 v189, 1.0
 v_mfma_f32_16x16x32_bf16 v[132:135], v[192:195], a[168:171], v[132:135]
 ds_read_b128 a[168:171], v2 offset:20480
 v_mov_b32 v190, 1.0
 v_mfma_f32_16x16x32_bf16 a[240:243], v[192:195], a[176:179], a[240:243]
 ds_read_b128 a[176:179], v2 offset:24576
 v_mfma_f32_16x16x32_bf16 a[240:243], v[196:199], a[180:183], a[240:243]
 ds_read_b128 a[180:183], v2 offset:25600
 v_mov_b32 v191, 1.0
 v_mfma_f32_16x16x32_bf16 a[244:247], v[196:199], a[188:191], a[244:247]
 ds_read_b128 a[188:191], v2 offset:29696
 v_mfma_f32_16x16x32_bf16 a[244:247], v[192:195], a[184:187], a[244:247]
 ds_read_b128 a[184:187], v2 offset:28672
 s_waitcnt lgkmcnt(8)
 v_mfma_f32_16x16x32_bf16 v[16:19], v[200:203], a[128:131], v[16:19]
 v_mfma_f32_16x16x32_bf16 v[16:19], v[204:207], a[132:135], v[16:19]
 v_mfma_f32_16x16x32_bf16 v[20:23], v[204:207], a[140:143], v[20:23]
 v_mov_b32 v192, 1.0
 v_mfma_f32_16x16x32_bf16 v[20:23], v[200:203], a[136:139], v[20:23]
 v_mfma_f32_16x16x32_bf16 v[24:27], v[200:203], a[144:147], v[24:27]
 v_mov_b32 v193, 1.0
 v_mfma_f32_16x16x32_bf16 v[24:27], v[204:207], a[148:151], v[24:27]
 v_mov_b32 v194, 1.0
 v_mfma_f32_16x16x32_bf16 v[28:31], v[204:207], a[156:159], v[28:31]
 v_mfma_f32_16x16x32_bf16 v[28:31], v[200:203], a[152:155], v[28:31]
 v_mov_b32 v195, 1.0
 s_waitcnt lgkmcnt(0)
 v_mfma_f32_16x16x32_bf16 v[32:35], v[200:203], a[160:163], v[32:35]
 v_mov_b32 v196, 1.0
 v_mfma_f32_16x16x32_bf16 v[32:35], v[204:207], a[164:167], v[32:35]
 v_mfma_f32_16x16x32_bf16 v[36:39], v[204:207], a[172:175], v[36:39]
 v_mov_b32 v197, 1.0
 v_mfma_f32_16x16x32_bf16 v[36:39], v[200:203], a[168:171], v[36:39]
 v_mov_b32 v198, 1.0
 v_mfma_f32_16x16x32_bf16 v[40:43], v[200:203], a[176:179], v[40:43]
 v_mfma_f32_16x16x32_bf16 v[40:43], v[204:207], a[180:183], v[40:43]
 v_mov_b32 v199, 1.0
 v_mfma_f32_16x16x32_bf16 v[44:47], v[204:207], a[188:191], v[44:47]
 v_mfma_f32_16x16x32_bf16 v[44:47], v[200:203], a[184:187], v[44:47]
 v_mfma_f32_16x16x32_bf16 v[76:79], v[208:211], a[184:187], v[76:79]
 v_mfma_f32_16x16x32_bf16 v[76:79], v[212:215], a[188:191], v[76:79]
 v_mfma_f32_16x16x32_bf16 v[72:75], v[212:215], a[180:183], v[72:75]
 v_mov_b32 v200, 1.0
 v_mfma_f32_16x16x32_bf16 v[72:75], v[208:211], a[176:179], v[72:75]
 v_mfma_f32_16x16x32_bf16 v[68:71], v[208:211], a[168:171], v[68:71]
 v_mov_b32 v201, 1.0
 v_mfma_f32_16x16x32_bf16 v[68:71], v[212:215], a[172:175], v[68:71]
 v_mov_b32 v202, 1.0
 v_mfma_f32_16x16x32_bf16 v[64:67], v[212:215], a[164:167], v[64:67]
 v_mfma_f32_16x16x32_bf16 v[64:67], v[208:211], a[160:163], v[64:67]
 v_mov_b32 v203, 1.0
 v_mfma_f32_16x16x32_bf16 v[60:63], v[208:211], a[152:155], v[60:63]
 v_mov_b32 v204, 1.0
 v_mfma_f32_16x16x32_bf16 v[60:63], v[212:215], a[156:159], v[60:63]
 v_mfma_f32_16x16x32_bf16 v[56:59], v[212:215], a[148:151], v[56:59]
 v_mov_b32 v205, 1.0
 v_mfma_f32_16x16x32_bf16 v[56:59], v[208:211], a[144:147], v[56:59]
 v_mov_b32 v206, 1.0
 v_mfma_f32_16x16x32_bf16 v[52:55], v[208:211], a[136:139], v[52:55]
 v_mfma_f32_16x16x32_bf16 v[52:55], v[212:215], a[140:143], v[52:55]
 v_mov_b32 v207, 1.0
 v_mfma_f32_16x16x32_bf16 v[48:51], v[212:215], a[132:135], v[48:51]
 v_mfma_f32_16x16x32_bf16 v[48:51], v[208:211], a[128:131], v[48:51]
 v_mfma_f32_16x16x32_bf16 v[80:83], a[224:227], a[128:131], v[80:83]
 v_mfma_f32_16x16x32_bf16 v[80:83], a[228:231], a[132:135], v[80:83]
 v_mfma_f32_16x16x32_bf16 v[84:87], a[228:231], a[140:143], v[84:87]
 v_mov_b32 v208, 1.0
 s_waitcnt vmcnt(16)
 v_cmp_gt_i32 vcc, s27, v4
 s_and_b64 vcc, exec, vcc
 s_cbranch_vccnz Lspin_pro
Lok_pro:
 s_add_u32 s27, s27, 64
 v_mfma_f32_16x16x32_bf16 v[84:87], a[224:227], a[136:139], v[84:87]
 v_mfma_f32_16x16x32_bf16 v[88:91], a[224:227], a[144:147], v[88:91]
 v_mov_b32 v209, 1.0
 v_mfma_f32_16x16x32_bf16 v[88:91], a[228:231], a[148:151], v[88:91]
 v_mov_b32 v210, 1.0
 v_mfma_f32_16x16x32_bf16 v[92:95], a[228:231], a[156:159], v[92:95]
 v_mfma_f32_16x16x32_bf16 v[92:95], a[224:227], a[152:155], v[92:95]
 v_mov_b32 v211, 1.0
 v_mfma_f32_16x16x32_bf16 v[96:99], a[224:227], a[160:163], v[96:99]
 v_mov_b32 v212, 1.0
 v_mfma_f32_16x16x32_bf16 v[96:99], a[228:231], a[164:167], v[96:99]
 v_mfma_f32_16x16x32_bf16 v[100:103], a[228:231], a[172:175], v[100:103]
 v_mov_b32 v213, 1.0
 v_mfma_f32_16x16x32_bf16 v[100:103], a[224:227], a[168:171], v[100:103]
 v_mov_b32 v214, 1.0
 v_mfma_f32_16x16x32_bf16 v[104:107], a[224:227], a[176:179], v[104:107]
 v_mfma_f32_16x16x32_bf16 v[104:107], a[228:231], a[180:183], v[104:107]
 v_mov_b32 v215, 1.0
 v_mfma_f32_16x16x32_bf16 v[108:111], a[228:231], a[188:191], v[108:111]
 v_mfma_f32_16x16x32_bf16 v[108:111], a[224:227], a[184:187], v[108:111]
 v_mfma_f32_16x16x32_bf16 a[244:247], a[232:235], a[184:187], a[244:247]
 ds_read_b128 a[184:187], v2 offset:61440
 v_mfma_f32_16x16x32_bf16 a[244:247], a[236:239], a[188:191], a[244:247]
 global_load_dwordx4 a[228:231], v0, s[70:71] offset:-3072 sc1
 ds_read_b128 a[188:191], v2 offset:62464
 v_mfma_f32_16x16x32_bf16 a[240:243], a[236:239], a[180:183], a[240:243]
 ds_read_b128 a[180:183], v2 offset:58368
 v_mfma_f32_16x16x32_bf16 a[240:243], a[232:235], a[176:179], a[240:243]
 global_load_dwordx4 a[224:227], v0, s[70:71] offset:-4096 sc1
 ds_read_b128 a[176:179], v2 offset:57344
 v_mfma_f32_16x16x32_bf16 v[132:135], a[232:235], a[168:171], v[132:135]
 ds_read_b128 a[168:171], v2 offset:53248
 v_mfma_f32_16x16x32_bf16 v[132:135], a[236:239], a[172:175], v[132:135]
 ds_read_b128 a[172:175], v2 offset:54272
 v_mfma_f32_16x16x32_bf16 v[128:131], a[236:239], a[164:167], v[128:131]
 ds_read_b128 a[164:167], v2 offset:50176
 v_mfma_f32_16x16x32_bf16 v[128:131], a[232:235], a[160:163], v[128:131]
 ds_read_b128 a[160:163], v2 offset:49152
 v_mfma_f32_16x16x32_bf16 v[124:127], a[232:235], a[152:155], v[124:127]
 ds_read_b128 a[152:155], v2 offset:45056
 v_mfma_f32_16x16x32_bf16 v[124:127], a[236:239], a[156:159], v[124:127]
 ds_read_b128 a[156:159], v2 offset:46080
 v_mfma_f32_16x16x32_bf16 v[120:123], a[236:239], a[148:151], v[120:123]
 ds_read_b128 a[148:151], v2 offset:41984
 v_mfma_f32_16x16x32_bf16 v[120:123], a[232:235], a[144:147], v[120:123]
 ds_read_b128 a[144:147], v2 offset:40960
 v_mfma_f32_16x16x32_bf16 v[116:119], a[232:235], a[136:139], v[116:119]
 ds_read_b128 a[136:139], v2 offset:36864
 v_mfma_f32_16x16x32_bf16 v[116:119], a[236:239], a[140:143], v[116:119]
 ds_read_b128 a[140:143], v2 offset:37888
 v_mfma_f32_16x16x32_bf16 v[112:115], a[236:239], a[132:135], v[112:115]
 ds_read_b128 a[132:135], v2 offset:33792
 v_mfma_f32_16x16x32_bf16 v[112:115], a[232:235], a[128:131], v[112:115]
 ds_read_b128 a[128:131], v2 offset:32768
 s_waitcnt lgkmcnt(8)
 v_mfma_f32_16x16x32_bf16 v[44:47], a[192:195], a[184:187], v[44:47]
 v_mfma_f32_16x16x32_bf16 v[44:47], a[196:199], a[188:191], v[44:47]
 global_load_dwordx4 a[236:239], v0, s[70:71] offset:-1024 sc1
 v_mfma_f32_16x16x32_bf16 v[40:43], a[196:199], a[180:183], v[40:43]
 v_mfma_f32_16x16x32_bf16 v[40:43], a[192:195], a[176:179], v[40:43]
 global_load_dwordx4 a[232:235], v0, s[70:71] offset:-2048 sc1
 v_mfma_f32_16x16x32_bf16 v[36:39], a[192:195], a[168:171], v[36:39]
 v_mfma_f32_16x16x32_bf16 v[36:39], a[196:199], a[172:175], v[36:39]
 v_mfma_f32_16x16x32_bf16 v[32:35], a[196:199], a[164:167], v[32:35]
 v_mfma_f32_16x16x32_bf16 v[32:35], a[192:195], a[160:163], v[32:35]
 s_waitcnt lgkmcnt(0)
 v_mfma_f32_16x16x32_bf16 v[28:31], a[192:195], a[152:155], v[28:31]
 v_mfma_f32_16x16x32_bf16 v[28:31], a[196:199], a[156:159], v[28:31]
 v_mfma_f32_16x16x32_bf16 v[24:27], a[196:199], a[148:151], v[24:27]
 v_mfma_f32_16x16x32_bf16 v[24:27], a[192:195], a[144:147], v[24:27]
 v_mfma_f32_16x16x32_bf16 v[20:23], a[192:195], a[136:139], v[20:23]
 v_mfma_f32_16x16x32_bf16 v[20:23], a[196:199], a[140:143], v[20:23]
 v_mfma_f32_16x16x32_bf16 v[16:19], a[196:199], a[132:135], v[16:19]
 v_mfma_f32_16x16x32_bf16 v[16:19], a[192:195], a[128:131], v[16:19]
 v_mfma_f32_16x16x32_bf16 v[48:51], a[200:203], a[128:131], v[48:51]
 v_mfma_f32_16x16x32_bf16 v[48:51], a[204:207], a[132:135], v[48:51]
 global_load_dwordx4 a[196:199], v0, s[70:71] offset:1024 sc1
 v_mfma_f32_16x16x32_bf16 v[52:55], a[204:207], a[140:143], v[52:55]
 v_mfma_f32_16x16x32_bf16 v[52:55], a[200:203], a[136:139], v[52:55]
 global_load_dwordx4 a[192:195], v0, s[70:71] offset:0 sc1
 v_mfma_f32_16x16x32_bf16 v[56:59], a[200:203], a[144:147], v[56:59]
 v_mfma_f32_16x16x32_bf16 v[56:59], a[204:207], a[148:151], v[56:59]
 v_mfma_f32_16x16x32_bf16 v[60:63], a[204:207], a[156:159], v[60:63]
 v_mfma_f32_16x16x32_bf16 v[60:63], a[200:203], a[152:155], v[60:63]
 v_mfma_f32_16x16x32_bf16 v[64:67], a[200:203], a[160:163], v[64:67]
 v_mfma_f32_16x16x32_bf16 v[64:67], a[204:207], a[164:167], v[64:67]
 v_mfma_f32_16x16x32_bf16 v[68:71], a[204:207], a[172:175], v[68:71]
 v_mfma_f32_16x16x32_bf16 v[68:71], a[200:203], a[168:171], v[68:71]
 v_mfma_f32_16x16x32_bf16 v[72:75], a[200:203], a[176:179], v[72:75]
 v_mfma_f32_16x16x32_bf16 v[72:75], a[204:207], a[180:183], v[72:75]
 v_mfma_f32_16x16x32_bf16 v[76:79], a[204:207], a[188:191], v[76:79]
 v_mfma_f32_16x16x32_bf16 v[76:79], a[200:203], a[184:187], v[76:79]
 v_mfma_f32_16x16x32_bf16 v[108:111], a[208:211], a[184:187], v[108:111]
 v_mfma_f32_16x16x32_bf16 v[108:111], a[212:215], a[188:191], v[108:111]
 global_load_dwordx4 a[204:207], v0, s[70:71] offset:3072 sc1
 v_mfma_f32_16x16x32_bf16 v[104:107], a[212:215], a[180:183], v[104:107]
 v_mfma_f32_16x16x32_bf16 v[104:107], a[208:211], a[176:179], v[104:107]
 global_load_dwordx4 a[200:203], v0, s[70:71] offset:2048 sc1
 v_mfma_f32_16x16x32_bf16 v[100:103], a[208:211], a[168:171], v[100:103]
 s_add_u32 s70, s70, 8192
 s_addc_u32 s71, s71, 0
 v_mfma_f32_16x16x32_bf16 v[100:103], a[212:215], a[172:175], v[100:103]
 v_mfma_f32_16x16x32_bf16 v[96:99], a[212:215], a[164:167], v[96:99]
 v_mfma_f32_16x16x32_bf16 v[96:99], a[208:211], a[160:163], v[96:99]
 v_mfma_f32_16x16x32_bf16 v[92:95], a[208:211], a[152:155], v[92:95]
 v_mfma_f32_16x16x32_bf16 v[92:95], a[212:215], a[156:159], v[92:95]
 v_mfma_f32_16x16x32_bf16 v[88:91], a[212:215], a[148:151], v[88:91]
 v_mfma_f32_16x16x32_bf16 v[88:91], a[208:211], a[144:147], v[88:91]
 v_mfma_f32_16x16x32_bf16 v[84:87], a[208:211], a[136:139], v[84:87]
 v_mfma_f32_16x16x32_bf16 v[84:87], a[212:215], a[140:143], v[84:87]
 v_mfma_f32_16x16x32_bf16 v[80:83], a[212:215], a[132:135], v[80:83]
 v_mfma_f32_16x16x32_bf16 v[80:83], a[208:211], a[128:131], v[80:83]
 v_mfma_f32_16x16x32_bf16 v[112:115], a[216:219], a[128:131], v[112:115]
 v_mfma_f32_16x16x32_bf16 v[112:115], a[220:223], a[132:135], v[112:115]
 global_load_dwordx4 a[212:215], v0, s[70:71] offset:-3072 sc1
 v_mfma_f32_16x16x32_bf16 v[116:119], a[220:223], a[140:143], v[116:119]
 v_mfma_f32_16x16x32_bf16 v[116:119], a[216:219], a[136:139], v[116:119]
 global_load_dwordx4 a[208:211], v0, s[70:71] offset:-4096 sc1
 v_mfma_f32_16x16x32_bf16 v[120:123], a[216:219], a[144:147], v[120:123]
 v_mfma_f32_16x16x32_bf16 v[120:123], a[220:223], a[148:151], v[120:123]
 v_mfma_f32_16x16x32_bf16 v[124:127], a[220:223], a[156:159], v[124:127]
 v_mfma_f32_16x16x32_bf16 v[124:127], a[216:219], a[152:155], v[124:127]
 v_mfma_f32_16x16x32_bf16 v[128:131], a[216:219], a[160:163], v[128:131]
 v_mfma_f32_16x16x32_bf16 v[128:131], a[220:223], a[164:167], v[128:131]
 v_mfma_f32_16x16x32_bf16 v[132:135], a[220:223], a[172:175], v[132:135]
 v_mfma_f32_16x16x32_bf16 v[132:135], a[216:219], a[168:171], v[132:135]
 v_mfma_f32_16x16x32_bf16 a[240:243], a[216:219], a[176:179], a[240:243]
 v_mfma_f32_16x16x32_bf16 a[240:243], a[220:223], a[180:183], a[240:243]
 v_mfma_f32_16x16x32_bf16 a[244:247], a[220:223], a[188:191], a[244:247]
 global_load_dwordx4 a[220:223], v0, s[70:71] offset:-1024 sc1
 v_mfma_f32_16x16x32_bf16 a[244:247], a[216:219], a[184:187], a[244:247]
 global_load_dwordx4 a[216:219], v0, s[70:71] offset:-2048 sc1
 s_waitcnt vmcnt(10)
 v_mfma_f32_16x16x32_bf16 v[164:167], a[224:227], a[184:187], v[164:167]
 v_lshrrev_b32 v5, 4, v1
 v_mfma_f32_16x16x32_bf16 v[164:167], a[228:231], a[188:191], v[164:167]
 v_and_b32 v5, 48, v5
 v_mfma_f32_16x16x32_bf16 v[160:163], a[228:231], a[180:183], v[160:163]
 v_xor_b32 v5, v5, v1
 v_mfma_f32_16x16x32_bf16 v[160:163], a[224:227], a[176:179], v[160:163]
 v_and_b32 v5, 112, v5
 v_mfma_f32_16x16x32_bf16 v[156:159], a[224:227], a[168:171], v[156:159]
 v_and_b32 v6, 240, v1
 v_mfma_f32_16x16x32_bf16 v[156:159], a[228:231], a[172:175], v[156:159]
 v_lshl_add_u32 v5, v6, 3, v5
 v_mfma_f32_16x16x32_bf16 v[152:155], a[228:231], a[164:167], v[152:155]
 v_add_u32 v8, s50, v5
 v_mfma_f32_16x16x32_bf16 v[152:155], a[224:227], a[160:163], v[152:155]
 v_xor_b32 v9, 64, v8
 v_mfma_f32_16x16x32_bf16 v[148:151], a[224:227], a[152:155], v[148:151]
 v_mfma_f32_16x16x32_bf16 v[148:151], a[228:231], a[156:159], v[148:151]
 ds_read_b128 a[64:67], v8 offset:2048
 ds_read_b128 a[96:99], v9 offset:2048
 v_mfma_f32_16x16x32_bf16 v[144:147], a[228:231], a[148:151], v[144:147]
 v_mfma_f32_16x16x32_bf16 v[144:147], a[224:227], a[144:147], v[144:147]
 v_mfma_f32_16x16x32_bf16 v[140:143], a[224:227], a[136:139], v[140:143]
 v_mfma_f32_16x16x32_bf16 v[140:143], a[228:231], a[140:143], v[140:143]
 v_mfma_f32_16x16x32_bf16 v[136:139], a[228:231], a[132:135], v[136:139]
 ds_read_b128 a[68:71], v8 offset:6144
 v_mfma_f32_16x16x32_bf16 v[136:139], a[224:227], a[128:131], v[136:139]
 ds_read_b128 a[100:103], v9 offset:6144
 s_waitcnt vmcnt(8)
 v_mfma_f32_16x16x32_bf16 v[168:171], a[232:235], a[128:131], v[168:171]
 v_mfma_f32_16x16x32_bf16 v[168:171], a[236:239], a[132:135], v[168:171]
 global_load_dwordx4 a[228:231], v0, s[70:71] offset:1024 sc1
 v_mfma_f32_16x16x32_bf16 v[172:175], a[236:239], a[140:143], v[172:175]
 v_mfma_f32_16x16x32_bf16 v[172:175], a[232:235], a[136:139], v[172:175]
 global_load_dwordx4 a[224:227], v0, s[70:71] offset:0 sc1
 s_waitcnt lgkmcnt(2)
 v_mfma_f32_16x16x32_bf16 v[176:179], a[232:235], a[144:147], v[176:179]
 ds_write_b128 v3, a[64:67] offset:2048
 v_mfma_f32_16x16x32_bf16 v[176:179], a[236:239], a[148:151], v[176:179]
 ds_write_b128 v3, a[96:99] offset:3072
 v_mfma_f32_16x16x32_bf16 v[180:183], a[236:239], a[156:159], v[180:183]
 v_mfma_f32_16x16x32_bf16 v[180:183], a[232:235], a[152:155], v[180:183]
 ds_read_b128 a[72:75], v8 offset:10240
 v_mfma_f32_16x16x32_bf16 v[184:187], a[232:235], a[160:163], v[184:187]
 ds_read_b128 a[104:107], v9 offset:10240
 v_mfma_f32_16x16x32_bf16 v[184:187], a[236:239], a[164:167], v[184:187]
 v_mfma_f32_16x16x32_bf16 v[188:191], a[236:239], a[172:175], v[188:191]
 v_mfma_f32_16x16x32_bf16 v[188:191], a[232:235], a[168:171], v[188:191]
 v_mfma_f32_16x16x32_bf16 v[192:195], a[232:235], a[176:179], v[192:195]
 s_waitcnt lgkmcnt(4)
 v_mfma_f32_16x16x32_bf16 v[192:195], a[236:239], a[180:183], v[192:195]
 ds_write_b128 v3, a[68:71] offset:6144
 ds_write_b128 v3, a[100:103] offset:7168
 v_mfma_f32_16x16x32_bf16 v[196:199], a[236:239], a[188:191], v[196:199]
 v_mfma_f32_16x16x32_bf16 v[196:199], a[232:235], a[184:187], v[196:199]
 ds_read_b128 a[76:79], v8 offset:14336
 s_waitcnt vmcnt(8)
 v_mfma_f32_16x16x32_bf16 v[228:231], a[192:195], a[184:187], v[228:231]
 ds_read_b128 a[108:111], v9 offset:14336
 v_mfma_f32_16x16x32_bf16 v[228:231], a[196:199], a[188:191], v[228:231]
 global_load_dwordx4 a[236:239], v0, s[70:71] offset:3072 sc1
 v_mfma_f32_16x16x32_bf16 v[224:227], a[196:199], a[180:183], v[224:227]
 v_mfma_f32_16x16x32_bf16 v[224:227], a[192:195], a[176:179], v[224:227]
 global_load_dwordx4 a[232:235], v0, s[70:71] offset:2048 sc1
 v_mfma_f32_16x16x32_bf16 v[220:223], a[192:195], a[168:171], v[220:223]
 s_waitcnt lgkmcnt(4)
 s_add_u32 s70, s70, 8192
 s_addc_u32 s71, s71, 0
 v_mfma_f32_16x16x32_bf16 v[220:223], a[196:199], a[172:175], v[220:223]
 ds_write_b128 v3, a[72:75] offset:10240
 v_mfma_f32_16x16x32_bf16 v[216:219], a[196:199], a[164:167], v[216:219]
 ds_write_b128 v3, a[104:107] offset:11264
 v_mfma_f32_16x16x32_bf16 v[216:219], a[192:195], a[160:163], v[216:219]
 v_mfma_f32_16x16x32_bf16 v[212:215], a[192:195], a[152:155], v[212:215]
 ds_read_b128 a[80:83], v8 offset:18432
 v_mfma_f32_16x16x32_bf16 v[212:215], a[196:199], a[156:159], v[212:215]
 ds_read_b128 a[112:115], v9 offset:18432
 v_mfma_f32_16x16x32_bf16 v[208:211], a[196:199], a[148:151], v[208:211]
 v_mfma_f32_16x16x32_bf16 v[208:211], a[192:195], a[144:147], v[208:211]
 v_mfma_f32_16x16x32_bf16 v[204:207], a[192:195], a[136:139], v[204:207]
 s_waitcnt lgkmcnt(4)
 ds_write_b128 v3, a[76:79] offset:14336
 ds_write_b128 v3, a[108:111] offset:15360
 v_mfma_f32_16x16x32_bf16 v[204:207], a[196:199], a[140:143], v[204:207]
 v_mfma_f32_16x16x32_bf16 v[200:203], a[196:199], a[132:135], v[200:203]
 v_mfma_f32_16x16x32_bf16 v[200:203], a[192:195], a[128:131], v[200:203]
 s_waitcnt vmcnt(8)
 v_mfma_f32_16x16x32_bf16 v[232:235], a[200:203], a[128:131], v[232:235]
 ds_read_b128 a[128:131], v2
 ds_read_b128 a[84:87], v8 offset:22528
 v_mfma_f32_16x16x32_bf16 v[232:235], a[204:207], a[132:135], v[232:235]
 global_load_dwordx4 a[196:199], v0, s[70:71] offset:-3072 sc1
 ds_read_b128 a[132:135], v2 offset:1024
 v_mfma_f32_16x16x32_bf16 v[236:239], a[204:207], a[140:143], v[236:239]
 ds_read_b128 a[140:143], v2 offset:5120
 ds_read_b128 a[116:119], v9 offset:22528
 v_mfma_f32_16x16x32_bf16 v[236:239], a[200:203], a[136:139], v[236:239]
 global_load_dwordx4 a[192:195], v0, s[70:71] offset:-4096 sc1
 ds_read_b128 a[136:139], v2 offset:4096
 v_mfma_f32_16x16x32_bf16 v[240:243], a[200:203], a[144:147], v[240:243]
 ds_read_b128 a[144:147], v2 offset:8192
 v_mfma_f32_16x16x32_bf16 v[240:243], a[204:207], a[148:151], v[240:243]
 ds_read_b128 a[148:151], v2 offset:9216
 s_waitcnt lgkmcnt(10)
 v_mfma_f32_16x16x32_bf16 v[244:247], a[204:207], a[156:159], v[244:247]
 ds_read_b128 a[156:159], v2 offset:13312
 v_mfma_f32_16x16x32_bf16 v[244:247], a[200:203], a[152:155], v[244:247]
 ds_read_b128 a[152:155], v2 offset:12288
 v_mfma_f32_16x16x32_bf16 v[248:251], a[200:203], a[160:163], v[248:251]
 ds_read_b128 a[160:163], v2 offset:16384
 v_mfma_f32_16x16x32_bf16 v[248:251], a[204:207], a[164:167], v[248:251]
 ds_read_b128 a[164:167], v2 offset:17408
 v_mfma_f32_16x16x32_bf16 v[252:255], a[204:207], a[172:175], v[252:255]
 ds_read_b128 a[172:175], v2 offset:21504
 v_mfma_f32_16x16x32_bf16 v[252:255], a[200:203], a[168:171], v[252:255]
 ds_read_b128 a[168:171], v2 offset:20480
 v_mfma_f32_16x16x32_bf16 a[248:251], a[200:203], a[176:179], a[248:251]
 ds_read_b128 a[176:179], v2 offset:24576
 v_mfma_f32_16x16x32_bf16 a[248:251], a[204:207], a[180:183], a[248:251]
 ds_read_b128 a[180:183], v2 offset:25600
 v_mfma_f32_16x16x32_bf16 a[252:255], a[204:207], a[188:191], a[252:255]
 ds_read_b128 a[188:191], v2 offset:29696
 v_mfma_f32_16x16x32_bf16 a[252:255], a[200:203], a[184:187], a[252:255]
 ds_read_b128 a[184:187], v2 offset:28672
 ds_write_b128 v3, a[80:83] offset:18432
 ds_write_b128 v3, a[112:115] offset:19456
 ds_read_b128 a[88:91], v8 offset:26624
 ds_read_b128 a[120:123], v9 offset:26624
 s_waitcnt vmcnt(8) lgkmcnt(12)
 v_mfma_f32_16x16x32_bf16 v[136:139], a[208:211], a[128:131], v[136:139]
 v_mfma_f32_16x16x32_bf16 v[136:139], a[212:215], a[132:135], v[136:139]
 global_load_dwordx4 a[204:207], v0, s[70:71] offset:-1024 sc1
 v_mfma_f32_16x16x32_bf16 v[140:143], a[212:215], a[140:143], v[140:143]
 ds_write_b128 v3, a[84:87] offset:22528
 ds_write_b128 v3, a[116:119] offset:23552
 v_mfma_f32_16x16x32_bf16 v[140:143], a[208:211], a[136:139], v[140:143]
 global_load_dwordx4 a[200:203], v0, s[70:71] offset:-2048 sc1
 ds_read_b128 a[92:95], v8 offset:30720
 v_mfma_f32_16x16x32_bf16 v[144:147], a[208:211], a[144:147], v[144:147]
 ds_read_b128 a[124:127], v9 offset:30720
 v_mfma_f32_16x16x32_bf16 v[144:147], a[212:215], a[148:151], v[144:147]
 v_mfma_f32_16x16x32_bf16 v[148:151], a[212:215], a[156:159], v[148:151]
 v_mfma_f32_16x16x32_bf16 v[148:151], a[208:211], a[152:155], v[148:151]
 s_waitcnt lgkmcnt(4)
 ds_write_b128 v3, a[88:91] offset:26624
 v_mfma_f32_16x16x32_bf16 v[152:155], a[208:211], a[160:163], v[152:155]
 ds_write_b128 v3, a[120:123] offset:27648
 v_mfma_f32_16x16x32_bf16 v[152:155], a[212:215], a[164:167], v[152:155]
 v_mfma_f32_16x16x32_bf16 v[156:159], a[212:215], a[172:175], v[156:159]
 v_mfma_f32_16x16x32_bf16 v[156:159], a[208:211], a[168:171], v[156:159]
 v_mfma_f32_16x16x32_bf16 v[160:163], a[208:211], a[176:179], v[160:163]
 v_mfma_f32_16x16x32_bf16 v[160:163], a[212:215], a[180:183], v[160:163]
 s_waitcnt lgkmcnt(2)
 v_mfma_f32_16x16x32_bf16 v[164:167], a[212:215], a[188:191], v[164:167]
 ds_write_b128 v3, a[92:95] offset:30720
 v_mfma_f32_16x16x32_bf16 v[164:167], a[208:211], a[184:187], v[164:167]
 ds_write_b128 v3, a[124:127] offset:31744
 s_waitcnt vmcnt(8)
 v_mfma_f32_16x16x32_bf16 v[196:199], a[216:219], a[184:187], v[196:199]
 v_bfe_u32 v4, v3, 8, 2
 v_mfma_f32_16x16x32_bf16 v[196:199], a[220:223], a[188:191], v[196:199]
 global_load_dwordx4 a[212:215], v0, s[70:71] offset:1024 sc1
 v_lshl_add_u32 v4, v4, 5, s51
 v_mfma_f32_16x16x32_bf16 v[192:195], a[220:223], a[180:183], v[192:195]
 ds_read_b128 v[8:11], v4
 v_mfma_f32_16x16x32_bf16 v[192:195], a[216:219], a[176:179], v[192:195]
 global_load_dwordx4 a[208:211], v0, s[70:71] offset:0 sc1
 v_mfma_f32_16x16x32_bf16 v[188:191], a[216:219], a[168:171], v[188:191]
 v_mfma_f32_16x16x32_bf16 v[188:191], a[220:223], a[172:175], v[188:191]
 v_mfma_f32_16x16x32_bf16 v[184:187], a[220:223], a[164:167], v[184:187]
 v_mfma_f32_16x16x32_bf16 v[184:187], a[216:219], a[160:163], v[184:187]
 v_mfma_f32_16x16x32_bf16 v[180:183], a[216:219], a[152:155], v[180:183]
 v_mfma_f32_16x16x32_bf16 v[180:183], a[220:223], a[156:159], v[180:183]
 v_mfma_f32_16x16x32_bf16 v[176:179], a[220:223], a[148:151], v[176:179]
 v_mfma_f32_16x16x32_bf16 v[176:179], a[216:219], a[144:147], v[176:179]
 s_waitcnt lgkmcnt(0)
 v_add_f32 v16, v16, v8
 v_mfma_f32_16x16x32_bf16 v[172:175], a[216:219], a[136:139], v[172:175]
 ds_read_b128 v[12:15], v4 offset:16
 v_mfma_f32_16x16x32_bf16 v[172:175], a[220:223], a[140:143], v[172:175]
 v_add_f32 v17, v17, v9
 v_mfma_f32_16x16x32_bf16 v[168:171], a[220:223], a[132:135], v[168:171]
 v_add_f32 v18, v18, v10
 v_mfma_f32_16x16x32_bf16 v[168:171], a[216:219], a[128:131], v[168:171]
 v_add_f32 v19, v19, v11
 s_waitcnt vmcnt(8)
 v_mfma_f32_16x16x32_bf16 v[200:203], a[224:227], a[128:131], v[200:203]
 v_add_f32 v20, v20, v8
 v_mfma_f32_16x16x32_bf16 v[200:203], a[228:231], a[132:135], v[200:203]
 global_load_dwordx4 a[220:223], v0, s[70:71] offset:3072 sc1
 v_add_f32 v21, v21, v9
 v_mfma_f32_16x16x32_bf16 v[204:207], a[228:231], a[140:143], v[204:207]
 v_add_f32 v22, v22, v10
 v_mfma_f32_16x16x32_bf16 v[204:207], a[224:227], a[136:139], v[204:207]
 global_load_dwordx4 a[216:219], v0, s[70:71] offset:2048 sc1
 v_add_f32 v23, v23, v11
 v_mfma_f32_16x16x32_bf16 v[208:211], a[224:227], a[144:147], v[208:211]
 v_add_f32 v24, v24, v8
 s_add_u32 s70, s70, 8192
 s_addc_u32 s71, s71, 0
 v_mfma_f32_16x16x32_bf16 v[208:211], a[228:231], a[148:151], v[208:211]
 v_add_f32 v25, v25, v9
 v_mfma_f32_16x16x32_bf16 v[212:215], a[228:231], a[156:159], v[212:215]
 v_add_f32 v26, v26, v10
 v_mfma_f32_16x16x32_bf16 v[212:215], a[224:227], a[152:155], v[212:215]
 v_add_f32 v27, v27, v11
 v_mfma_f32_16x16x32_bf16 v[216:219], a[224:227], a[160:163], v[216:219]
 v_add_f32 v28, v28, v8
 v_mfma_f32_16x16x32_bf16 v[216:219], a[228:231], a[164:167], v[216:219]
 v_add_f32 v29, v29, v9
 v_mfma_f32_16x16x32_bf16 v[220:223], a[228:231], a[172:175], v[220:223]
 v_add_f32 v30, v30, v10
 v_mfma_f32_16x16x32_bf16 v[220:223], a[224:227], a[168:171], v[220:223]
 v_add_f32 v31, v31, v11
 v_add_f32 v32, v32, v8
 v_mfma_f32_16x16x32_bf16 v[224:227], a[224:227], a[176:179], v[224:227]
 v_add_f32 v33, v33, v9
 v_mfma_f32_16x16x32_bf16 v[224:227], a[228:231], a[180:183], v[224:227]
 v_add_f32 v34, v34, v10
 v_mfma_f32_16x16x32_bf16 v[228:231], a[228:231], a[188:191], v[228:231]
 v_add_f32 v35, v35, v11
 v_mfma_f32_16x16x32_bf16 v[228:231], a[224:227], a[184:187], v[228:231]
 v_add_f32 v36, v36, v8
 v_add_f32 v37, v37, v9
 s_waitcnt vmcnt(8)
 v_mfma_f32_16x16x32_bf16 a[252:255], a[232:235], a[184:187], a[252:255]
 ds_read_b128 a[184:187], v1 offset:61440
 v_add_f32 v38, v38, v10
 v_mfma_f32_16x16x32_bf16 a[252:255], a[236:239], a[188:191], a[252:255]
 global_load_dwordx4 a[228:231], v0, s[70:71] offset:-3072 sc1
 ds_read_b128 a[188:191], v1 offset:62464
 v_mfma_f32_16x16x32_bf16 a[248:251], a[236:239], a[180:183], a[248:251]
 ds_read_b128 a[180:183], v1 offset:58368
 v_add_f32 v39, v39, v11
 v_mfma_f32_16x16x32_bf16 a[248:251], a[232:235], a[176:179], a[248:251]
 global_load_dwordx4 a[224:227], v0, s[70:71] offset:-4096 sc1
 ds_read_b128 a[176:179], v1 offset:57344
 v_mfma_f32_16x16x32_bf16 v[252:255], a[232:235], a[168:171], v[252:255]
 ds_read_b128 a[168:171], v1 offset:53248
 v_add_f32 v40, v40, v8
 v_mfma_f32_16x16x32_bf16 v[252:255], a[236:239], a[172:175], v[252:255]
 ds_read_b128 a[172:175], v1 offset:54272
 v_add_f32 v41, v41, v9
 v_mfma_f32_16x16x32_bf16 v[248:251], a[236:239], a[164:167], v[248:251]
 ds_read_b128 a[164:167], v1 offset:50176
 v_add_f32 v42, v42, v10
 v_mfma_f32_16x16x32_bf16 v[248:251], a[232:235], a[160:163], v[248:251]
 ds_read_b128 a[160:163], v1 offset:49152
 v_add_f32 v43, v43, v11
 v_mfma_f32_16x16x32_bf16 v[244:247], a[232:235], a[152:155], v[244:247]
 ds_read_b128 a[152:155], v1 offset:45056
 v_add_f32 v44, v44, v8
 v_mfma_f32_16x16x32_bf16 v[244:247], a[236:239], a[156:159], v[244:247]
 ds_read_b128 a[156:159], v1 offset:46080
 v_add_f32 v45, v45, v9
 v_mfma_f32_16x16x32_bf16 v[240:243], a[236:239], a[148:151], v[240:243]
 ds_read_b128 a[148:151], v1 offset:41984
 v_add_f32 v46, v46, v10
 v_mfma_f32_16x16x32_bf16 v[240:243], a[232:235], a[144:147], v[240:243]
 ds_read_b128 a[144:147], v1 offset:40960
 v_add_f32 v47, v47, v11
 s_waitcnt lgkmcnt(12)
 v_mfma_f32_16x16x32_bf16 v[236:239], a[232:235], a[136:139], v[236:239]
 ds_read_b128 a[136:139], v1 offset:36864
 v_add_f32 v48, v48, v12
 v_mfma_f32_16x16x32_bf16 v[236:239], a[236:239], a[140:143], v[236:239]
 ds_read_b128 a[140:143], v1 offset:37888
 ds_read_b128 v[8:11], v4 offset:128
 v_mfma_f32_16x16x32_bf16 v[232:235], a[236:239], a[132:135], v[232:235]
 ds_read_b128 a[132:135], v1 offset:33792
 v_add_f32 v49, v49, v13
 v_mfma_f32_16x16x32_bf16 v[232:235], a[232:235], a[128:131], v[232:235]
 ds_read_b128 a[128:131], v1 offset:32768
 v_add_f32 v50, v50, v14
 s_waitcnt vmcnt(8) lgkmcnt(9)
 v_mfma_f32_16x16x32_bf16 v[164:167], a[192:195], a[184:187], v[164:167]
 v_add_f32 v51, v51, v15
 v_add_f32 v52, v52, v12
 v_mfma_f32_16x16x32_bf16 v[164:167], a[196:199], a[188:191], v[164:167]
 global_load_dwordx4 a[236:239], v0, s[70:71] offset:-1024 sc1
 v_add_f32 v53, v53, v13
 v_mfma_f32_16x16x32_bf16 v[160:163], a[196:199], a[180:183], v[160:163]
 v_add_f32 v54, v54, v14
 v_mfma_f32_16x16x32_bf16 v[160:163], a[192:195], a[176:179], v[160:163]
 global_load_dwordx4 a[232:235], v0, s[70:71] offset:-2048 sc1
 v_add_f32 v55, v55, v15
 v_mfma_f32_16x16x32_bf16 v[156:159], a[192:195], a[168:171], v[156:159]
 v_add_f32 v56, v56, v12
 v_mfma_f32_16x16x32_bf16 v[156:159], a[196:199], a[172:175], v[156:159]
 v_add_f32 v57, v57, v13
 v_mfma_f32_16x16x32_bf16 v[152:155], a[196:199], a[164:167], v[152:155]
 v_add_f32 v58, v58, v14
 v_mfma_f32_16x16x32_bf16 v[152:155], a[192:195], a[160:163], v[152:155]
 v_add_f32 v59, v59, v15
 s_waitcnt lgkmcnt(0)
 v_mfma_f32_16x16x32_bf16 v[148:151], a[192:195], a[152:155], v[148:151]
 v_add_f32 v60, v60, v12
 v_mfma_f32_16x16x32_bf16 v[148:151], a[196:199], a[156:159], v[148:151]
 v_add_f32 v61, v61, v13
 v_mfma_f32_16x16x32_bf16 v[144:147], a[196:199], a[148:151], v[144:147]
 v_add_f32 v62, v62, v14
 v_mfma_f32_16x16x32_bf16 v[144:147], a[192:195], a[144:147], v[144:147]
 v_add_f32 v63, v63, v15
 v_mfma_f32_16x16x32_bf16 v[140:143], a[192:195], a[136:139], v[140:143]
 v_add_f32 v64, v64, v12
 v_mfma_f32_16x16x32_bf16 v[140:143], a[196:199], a[140:143], v[140:143]
 v_add_f32 v65, v65, v13
 v_mfma_f32_16x16x32_bf16 v[136:139], a[196:199], a[132:135], v[136:139]
 v_add_f32 v66, v66, v14
 v_mfma_f32_16x16x32_bf16 v[136:139], a[192:195], a[128:131], v[136:139]
 v_add_f32 v67, v67, v15
 s_waitcnt vmcnt(8)
 v_mfma_f32_16x16x32_bf16 v[168:171], a[200:203], a[128:131], v[168:171]
 v_add_f32 v68, v68, v12
 v_mfma_f32_16x16x32_bf16 v[168:171], a[204:207], a[132:135], v[168:171]
 global_load_dwordx4 a[196:199], v0, s[70:71] offset:1024 sc1
 v_add_f32 v69, v69, v13
 v_mfma_f32_16x16x32_bf16 v[172:175], a[204:207], a[140:143], v[172:175]
 v_add_f32 v70, v70, v14
 v_add_f32 v71, v71, v15
 v_mfma_f32_16x16x32_bf16 v[172:175], a[200:203], a[136:139], v[172:175]
 global_load_dwordx4 a[192:195], v0, s[70:71] offset:0 sc1
 v_add_f32 v72, v72, v12
 v_mfma_f32_16x16x32_bf16 v[176:179], a[200:203], a[144:147], v[176:179]
 v_add_f32 v73, v73, v13
 v_mfma_f32_16x16x32_bf16 v[176:179], a[204:207], a[148:151], v[176:179]
 v_add_f32 v74, v74, v14
 v_mfma_f32_16x16x32_bf16 v[180:183], a[204:207], a[156:159], v[180:183]
 v_add_f32 v75, v75, v15
 v_mfma_f32_16x16x32_bf16 v[180:183], a[200:203], a[152:155], v[180:183]
 v_add_f32 v76, v76, v12
 v_mfma_f32_16x16x32_bf16 v[184:187], a[200:203], a[160:163], v[184:187]
 v_add_f32 v77, v77, v13
 v_mfma_f32_16x16x32_bf16 v[184:187], a[204:207], a[164:167], v[184:187]
 v_add_f32 v78, v78, v14
 v_mfma_f32_16x16x32_bf16 v[188:191], a[204:207], a[172:175], v[188:191]
 v_add_f32 v79, v79, v15
 v_mfma_f32_16x16x32_bf16 v[188:191], a[200:203], a[168:171], v[188:191]
 v_mfma_f32_16x16x32_bf16 v[192:195], a[200:203], a[176:179], v[192:195]
 v_add_f32 v80, v80, v8
 v_mfma_f32_16x16x32_bf16 v[192:195], a[204:207], a[180:183], v[192:195]
 ds_read_b128 v[12:15], v4 offset:144
 v_mfma_f32_16x16x32_bf16 v[196:199], a[204:207], a[188:191], v[196:199]
 v_add_f32 v81, v81, v9
 v_mfma_f32_16x16x32_bf16 v[196:199], a[200:203], a[184:187], v[196:199]
 v_add_f32 v82, v82, v10
 s_waitcnt vmcnt(8)
 v_mfma_f32_16x16x32_bf16 v[228:231], a[208:211], a[184:187], v[228:231]
 v_add_f32 v83, v83, v11
 v_mfma_f32_16x16x32_bf16 v[228:231], a[212:215], a[188:191], v[228:231]
 global_load_dwordx4 a[204:207], v0, s[70:71] offset:3072 sc1
 v_add_f32 v84, v84, v8
 v_mfma_f32_16x16x32_bf16 v[224:227], a[212:215], a[180:183], v[224:227]
 v_add_f32 v85, v85, v9
 v_mfma_f32_16x16x32_bf16 v[224:227], a[208:211], a[176:179], v[224:227]
 global_load_dwordx4 a[200:203], v0, s[70:71] offset:2048 sc1
 v_add_f32 v86, v86, v10
 v_mfma_f32_16x16x32_bf16 v[220:223], a[208:211], a[168:171], v[220:223]
 v_add_f32 v87, v87, v11
 s_add_u32 s70, s70, 8192
 s_addc_u32 s71, s71, 0
 v_mfma_f32_16x16x32_bf16 v[220:223], a[212:215], a[172:175], v[220:223]
 v_add_f32 v88, v88, v8
 v_add_f32 v89, v89, v9
 v_mfma_f32_16x16x32_bf16 v[216:219], a[212:215], a[164:167], v[216:219]
 v_add_f32 v90, v90, v10
 v_mfma_f32_16x16x32_bf16 v[216:219], a[208:211], a[160:163], v[216:219]
 v_add_f32 v91, v91, v11
 v_mfma_f32_16x16x32_bf16 v[212:215], a[208:211], a[152:155], v[212:215]
 v_add_f32 v92, v92, v8
 v_mfma_f32_16x16x32_bf16 v[212:215], a[212:215], a[156:159], v[212:215]
 v_add_f32 v93, v93, v9
 v_mfma_f32_16x16x32_bf16 v[208:211], a[212:215], a[148:151], v[208:211]
 v_add_f32 v94, v94, v10
 v_mfma_f32_16x16x32_bf16 v[208:211], a[208:211], a[144:147], v[208:211]
 v_add_f32 v95, v95, v11
 v_mfma_f32_16x16x32_bf16 v[204:207], a[208:211], a[136:139], v[204:207]
 v_add_f32 v96, v96, v8
 v_mfma_f32_16x16x32_bf16 v[204:207], a[212:215], a[140:143], v[204:207]
 v_add_f32 v97, v97, v9
 v_mfma_f32_16x16x32_bf16 v[200:203], a[212:215], a[132:135], v[200:203]
 v_add_f32 v98, v98, v10
 v_add_f32 v99, v99, v11
 v_mfma_f32_16x16x32_bf16 v[200:203], a[208:211], a[128:131], v[200:203]
 v_add_f32 v100, v100, v8
 v_add_f32 v101, v101, v9
 s_waitcnt vmcnt(8)
 v_mfma_f32_16x16x32_bf16 v[232:235], a[216:219], a[128:131], v[232:235]
 ds_read_b128 a[128:131], v1
 v_add_f32 v102, v102, v10
 v_mfma_f32_16x16x32_bf16 v[232:235], a[220:223], a[132:135], v[232:235]
 global_load_dwordx4 a[212:215], v0, s[70:71] offset:-3072 sc1
 ds_read_b128 a[132:135], v1 offset:1024
 v_mfma_f32_16x16x32_bf16 v[236:239], a[220:223], a[140:143], v[236:239]
 ds_read_b128 a[140:143], v1 offset:5120
 v_add_f32 v103, v103, v11
 v_mfma_f32_16x16x32_bf16 v[236:239], a[216:219], a[136:139], v[236:239]
 global_load_dwordx4 a[208:211], v0, s[70:71] offset:-4096 sc1
 ds_read_b128 a[136:139], v1 offset:4096
 v_mfma_f32_16x16x32_bf16 v[240:243], a[216:219], a[144:147], v[240:243]
 ds_read_b128 a[144:147], v1 offset:8192
 v_add_f32 v104, v104, v8
 v_mfma_f32_16x16x32_bf16 v[240:243], a[220:223], a[148:151], v[240:243]
 ds_read_b128 a[148:151], v1 offset:9216
 v_add_f32 v105, v105, v9
 v_mfma_f32_16x16x32_bf16 v[244:247], a[220:223], a[156:159], v[244:247]
 ds_read_b128 a[156:159], v1 offset:13312
 v_add_f32 v106, v106, v10
 v_mfma_f32_16x16x32_bf16 v[244:247], a[216:219], a[152:155], v[244:247]
 ds_read_b128 a[152:155], v1 offset:12288
 v_add_f32 v107, v107, v11
 v_mfma_f32_16x16x32_bf16 v[248:251], a[216:219], a[160:163], v[248:251]
 ds_read_b128 a[160:163], v1 offset:16384
 v_add_f32 v108, v108, v8
 v_mfma_f32_16x16x32_bf16 v[248:251], a[220:223], a[164:167], v[248:251]
 ds_read_b128 a[164:167], v1 offset:17408
 v_add_f32 v109, v109, v9
 v_mfma_f32_16x16x32_bf16 v[252:255], a[220:223], a[172:175], v[252:255]
 ds_read_b128 a[172:175], v1 offset:21504
 v_add_f32 v110, v110, v10
 v_mfma_f32_16x16x32_bf16 v[252:255], a[216:219], a[168:171], v[252:255]
 ds_read_b128 a[168:171], v1 offset:20480
 v_add_f32 v111, v111, v11
 s_waitcnt lgkmcnt(12)
 v_mfma_f32_16x16x32_bf16 a[248:251], a[216:219], a[176:179], a[248:251]
 ds_read_b128 a[176:179], v1 offset:24576
 v_add_f32 v112, v112, v12
 v_mfma_f32_16x16x32_bf16 a[248:251], a[220:223], a[180:183], a[248:251]
 ds_read_b128 a[180:183], v1 offset:25600
 v_add_f32 v113, v113, v13
 v_mfma_f32_16x16x32_bf16 a[252:255], a[220:223], a[188:191], a[252:255]
 ds_read_b128 a[188:191], v1 offset:29696
 v_add_f32 v114, v114, v14
 v_mfma_f32_16x16x32_bf16 a[252:255], a[216:219], a[184:187], a[252:255]
 ds_read_b128 a[184:187], v1 offset:28672
 v_add_f32 v115, v115, v15
 s_waitcnt vmcnt(8) lgkmcnt(8)
 v_mfma_f32_16x16x32_bf16 v[136:139], a[224:227], a[128:131], v[136:139]
 v_add_f32 v116, v116, v12
 v_mfma_f32_16x16x32_bf16 v[136:139], a[228:231], a[132:135], v[136:139]
 global_load_dwordx4 a[220:223], v0, s[70:71] offset:-1024 sc1
 v_add_f32 v117, v117, v13
 v_mfma_f32_16x16x32_bf16 v[140:143], a[228:231], a[140:143], v[140:143]
 v_add_f32 v118, v118, v14
 v_mfma_f32_16x16x32_bf16 v[140:143], a[224:227], a[136:139], v[140:143]
 global_load_dwordx4 a[216:219], v0, s[70:71] offset:-2048 sc1
 v_add_f32 v119, v119, v15
 v_mfma_f32_16x16x32_bf16 v[144:147], a[224:227], a[144:147], v[144:147]
 v_add_f32 v120, v120, v12
 v_mfma_f32_16x16x32_bf16 v[144:147], a[228:231], a[148:151], v[144:147]
 v_add_f32 v121, v121, v13
 v_mfma_f32_16x16x32_bf16 v[148:151], a[228:231], a[156:159], v[148:151]
 v_add_f32 v122, v122, v14
 v_mfma_f32_16x16x32_bf16 v[148:151], a[224:227], a[152:155], v[148:151]
 v_add_f32 v123, v123, v15
 s_waitcnt lgkmcnt(0)
 v_mfma_f32_16x16x32_bf16 v[152:155], a[224:227], a[160:163], v[152:155]
 v_add_f32 v124, v124, v12
 v_mfma_f32_16x16x32_bf16 v[152:155], a[228:231], a[164:167], v[152:155]
 v_add_f32 v125, v125, v13
 v_mfma_f32_16x16x32_bf16 v[156:159], a[228:231], a[172:175], v[156:159]
 v_add_f32 v126, v126, v14
 v_mfma_f32_16x16x32_bf16 v[156:159], a[224:227], a[168:171], v[156:159]
 v_add_f32 v127, v127, v15
 v_mfma_f32_16x16x32_bf16 v[160:163], a[224:227], a[176:179], v[160:163]
 v_add_f32 v128, v128, v12
 v_add_f32 v129, v129, v13
 v_mfma_f32_16x16x32_bf16 v[160:163], a[228:231], a[180:183], v[160:163]
 v_add_f32 v130, v130, v14
 v_mfma_f32_16x16x32_bf16 v[164:167], a[228:231], a[188:191], v[164:167]
 v_add_f32 v131, v131, v15
 v_mfma_f32_16x16x32_bf16 v[164:167], a[224:227], a[184:187], v[164:167]
 v_add_f32 v132, v132, v12
 s_waitcnt vmcnt(8)
 v_mfma_f32_16x16x32_bf16 v[196:199], a[232:235], a[184:187], v[196:199]
 v_add_f32 v133, v133, v13
 v_mfma_f32_16x16x32_bf16 v[196:199], a[236:239], a[188:191], v[196:199]
 global_load_dwordx4 a[228:231], v0, s[70:71] offset:1024 sc1
 v_add_f32 v134, v134, v14
 v_mfma_f32_16x16x32_bf16 v[192:195], a[236:239], a[180:183], v[192:195]
 v_add_f32 v135, v135, v15
 v_mfma_f32_16x16x32_bf16 v[192:195], a[232:235], a[176:179], v[192:195]
 global_load_dwordx4 a[224:227], v0, s[70:71] offset:0 sc1
 v_accvgpr_read_b32 v5, a240
 v_mfma_f32_16x16x32_bf16 v[188:191], a[232:235], a[168:171], v[188:191]
 v_add_f32 v5, v5, v12
 v_mfma_f32_16x16x32_bf16 v[188:191], a[236:239], a[172:175], v[188:191]
 v_accvgpr_write_b32 a240, v5
 v_mfma_f32_16x16x32_bf16 v[184:187], a[236:239], a[164:167], v[184:187]
 v_accvgpr_read_b32 v6, a241
 v_mfma_f32_16x16x32_bf16 v[184:187], a[232:235], a[160:163], v[184:187]
 v_add_f32 v6, v6, v13
 v_mfma_f32_16x16x32_bf16 v[180:183], a[232:235], a[152:155], v[180:183]
 v_accvgpr_write_b32 a241, v6
 v_mfma_f32_16x16x32_bf16 v[180:183], a[236:239], a[156:159], v[180:183]
 v_accvgpr_read_b32 v5, a242
 v_mfma_f32_16x16x32_bf16 v[176:179], a[236:239], a[148:151], v[176:179]
 v_add_f32 v5, v5, v14
 v_mfma_f32_16x16x32_bf16 v[176:179], a[232:235], a[144:147], v[176:179]
 v_accvgpr_write_b32 a242, v5
 v_mfma_f32_16x16x32_bf16 v[172:175], a[232:235], a[136:139], v[172:175]
 v_accvgpr_read_b32 v6, a243
 v_mfma_f32_16x16x32_bf16 v[172:175], a[236:239], a[140:143], v[172:175]
 v_add_f32 v6, v6, v15
 v_mfma_f32_16x16x32_bf16 v[168:171], a[236:239], a[132:135], v[168:171]
 v_accvgpr_write_b32 a243, v6
 v_mfma_f32_16x16x32_bf16 v[168:171], a[232:235], a[128:131], v[168:171]
 v_accvgpr_read_b32 v5, a244
 s_waitcnt vmcnt(8)
 v_mfma_f32_16x16x32_bf16 v[200:203], a[192:195], a[128:131], v[200:203]
 v_add_f32 v5, v5, v12
 v_accvgpr_write_b32 a244, v5
 v_mfma_f32_16x16x32_bf16 v[200:203], a[196:199], a[132:135], v[200:203]
 global_load_dwordx4 a[236:239], v0, s[70:71] offset:3072 sc1
 v_accvgpr_read_b32 v6, a245
 v_mfma_f32_16x16x32_bf16 v[204:207], a[196:199], a[140:143], v[204:207]
 v_add_f32 v6, v6, v13
 v_mfma_f32_16x16x32_bf16 v[204:207], a[192:195], a[136:139], v[204:207]
 global_load_dwordx4 a[232:235], v0, s[70:71] offset:2048 sc1
 v_accvgpr_write_b32 a245, v6
 v_mfma_f32_16x16x32_bf16 v[208:211], a[192:195], a[144:147], v[208:211]
 v_accvgpr_read_b32 v5, a246
 s_add_u32 s70, s70, 8192
 s_addc_u32 s71, s71, 0
 v_mfma_f32_16x16x32_bf16 v[208:211], a[196:199], a[148:151], v[208:211]
 v_add_f32 v5, v5, v14
 v_mfma_f32_16x16x32_bf16 v[212:215], a[196:199], a[156:159], v[212:215]
 v_accvgpr_write_b32 a246, v5
 v_mfma_f32_16x16x32_bf16 v[212:215], a[192:195], a[152:155], v[212:215]
 v_accvgpr_read_b32 v6, a247
 v_mfma_f32_16x16x32_bf16 v[216:219], a[192:195], a[160:163], v[216:219]
 v_add_f32 v6, v6, v15
 v_mfma_f32_16x16x32_bf16 v[216:219], a[196:199], a[164:167], v[216:219]
 v_accvgpr_write_b32 a247, v6
 v_mfma_f32_16x16x32_bf16 v[220:223], a[196:199], a[172:175], v[220:223]
 s_add_u32 s55, s55, 1
 s_waitcnt lgkmcnt(0)
 s_barrier
 v_mfma_f32_16x16x32_bf16 v[220:223], a[192:195], a[168:171], v[220:223]
 v_mfma_f32_16x16x32_bf16 v[224:227], a[192:195], a[176:179], v[224:227]
 v_mfma_f32_16x16x32_bf16 v[224:227], a[196:199], a[180:183], v[224:227]
 v_mfma_f32_16x16x32_bf16 v[228:231], a[196:199], a[188:191], v[228:231]
 v_mfma_f32_16x16x32_bf16 v[228:231], a[192:195], a[184:187], v[228:231]
 s_waitcnt vmcnt(8)
 v_mfma_f32_16x16x32_bf16 a[252:255], a[200:203], a[184:187], a[252:255]
 ds_read_b128 a[184:187], v1 offset:30720
 v_mfma_f32_16x16x32_bf16 a[252:255], a[204:207], a[188:191], a[252:255]
 global_load_dwordx4 a[196:199], v0, s[70:71] offset:-3072 sc1
 ds_read_b128 a[188:191], v1 offset:31744
 v_mfma_f32_16x16x32_bf16 a[248:251], a[204:207], a[180:183], a[248:251]
 ds_read_b128 a[180:183], v1 offset:27648
 v_mfma_f32_16x16x32_bf16 a[248:251], a[200:203], a[176:179], a[248:251]
 global_load_dwordx4 a[192:195], v0, s[70:71] offset:-4096 sc1
 ds_read_b128 a[176:179], v1 offset:26624
 v_mfma_f32_16x16x32_bf16 v[252:255], a[200:203], a[168:171], v[252:255]
 ds_read_b128 a[168:171], v1 offset:22528
 v_mfma_f32_16x16x32_bf16 v[252:255], a[204:207], a[172:175], v[252:255]
 ds_read_b128 a[172:175], v1 offset:23552
 v_mfma_f32_16x16x32_bf16 v[248:251], a[204:207], a[164:167], v[248:251]
 ds_read_b128 a[164:167], v1 offset:19456
 v_mfma_f32_16x16x32_bf16 v[248:251], a[200:203], a[160:163], v[248:251]
 ds_read_b128 a[160:163], v1 offset:18432
 v_mfma_f32_16x16x32_bf16 v[244:247], a[200:203], a[152:155], v[244:247]
 ds_read_b128 a[152:155], v1 offset:14336
 v_mfma_f32_16x16x32_bf16 v[244:247], a[204:207], a[156:159], v[244:247]
 ds_read_b128 a[156:159], v1 offset:15360
 v_mfma_f32_16x16x32_bf16 v[240:243], a[204:207], a[148:151], v[240:243]
 ds_read_b128 a[148:151], v1 offset:11264
 v_mfma_f32_16x16x32_bf16 v[240:243], a[200:203], a[144:147], v[240:243]
 ds_read_b128 a[144:147], v1 offset:10240
 v_mfma_f32_16x16x32_bf16 v[236:239], a[200:203], a[136:139], v[236:239]
 ds_read_b128 a[136:139], v1 offset:6144
 v_mfma_f32_16x16x32_bf16 v[236:239], a[204:207], a[140:143], v[236:239]
 ds_read_b128 a[140:143], v1 offset:7168
 v_mfma_f32_16x16x32_bf16 v[232:235], a[204:207], a[132:135], v[232:235]
 global_load_dwordx4 a[204:207], v0, s[70:71] offset:-1024 sc1
 ds_read_b128 a[132:135], v1 offset:3072
 v_mfma_f32_16x16x32_bf16 v[232:235], a[200:203], a[128:131], v[232:235]
 global_load_dwordx4 a[200:203], v0, s[70:71] offset:-2048 sc1
 ds_read_b128 a[128:131], v1 offset:2048
 s_waitcnt vmcnt(10) lgkmcnt(8)
Lloop:
 v_mfma_f32_16x16x32_bf16 v[44:47], a[208:211], a[184:187], v[44:47]
 v_mfma_f32_16x16x32_bf16 v[44:47], a[212:215], a[188:191], v[44:47]
 v_mov_b32 v6, v3
 s_cmp_eq_u32 s25, 0
 s_cbranch_scc1 Lgat0
Lgatr0:
 s_add_u32 s29, s29, 0x2000000
 v_mfma_f32_16x16x32_bf16 v[40:43], a[212:215], a[180:183], v[40:43]
 v_mfma_f32_16x16x32_bf16 v[40:43], a[208:211], a[176:179], v[40:43]
 v_mfma_f32_16x16x32_bf16 v[36:39], a[208:211], a[168:171], v[36:39]
 s_add_u32 m0, s50, 0
 v_mfma_f32_16x16x32_bf16 v[36:39], a[212:215], a[172:175], v[36:39]
 v_mfma_f32_16x16x32_bf16 v[32:35], a[212:215], a[164:167], v[32:35]
 v_mfma_f32_16x16x32_bf16 v[32:35], a[208:211], a[160:163], v[32:35]
 s_waitcnt lgkmcnt(0)
 v_mfma_f32_16x16x32_bf16 v[28:31], a[208:211], a[152:155], v[28:31]
 v_mfma_f32_16x16x32_bf16 v[28:31], a[212:215], a[156:159], v[28:31]
 v_mfma_f32_16x16x32_bf16 v[24:27], a[212:215], a[148:151], v[24:27]
 v_mfma_f32_16x16x32_bf16 v[24:27], a[208:211], a[144:147], v[24:27]
 buffer_load_dwordx4 v6, s[8:11], s30 offen lds
 v_mfma_f32_16x16x32_bf16 v[20:23], a[208:211], a[136:139], v[20:23]
 v_mfma_f32_16x16x32_bf16 v[20:23], a[212:215], a[140:143], v[20:23]
 v_mfma_f32_16x16x32_bf16 v[16:19], a[212:215], a[132:135], v[16:19]
 s_add_u32 m0, m0, 1024
 v_mfma_f32_16x16x32_bf16 v[16:19], a[208:211], a[128:131], v[16:19]
 s_waitcnt vmcnt(9)
 v_mfma_f32_16x16x32_bf16 v[48:51], a[216:219], a[128:131], v[48:51]
 v_mfma_f32_16x16x32_bf16 v[48:51], a[220:223], a[132:135], v[48:51]
 global_load_dwordx4 a[212:215], v0, s[70:71] offset:1024 sc1
 s_add_u32 s30, s30, s20
 v_mfma_f32_16x16x32_bf16 v[52:55], a[220:223], a[140:143], v[52:55]
 v_mfma_f32_16x16x32_bf16 v[52:55], a[216:219], a[136:139], v[52:55]
 global_load_dwordx4 a[208:211], v0, s[70:71] offset:0 sc1
 v_mfma_f32_16x16x32_bf16 v[56:59], a[216:219], a[144:147], v[56:59]
 buffer_load_dwordx4 v6, s[8:11], s30 offen lds
 v_mfma_f32_16x16x32_bf16 v[56:59], a[220:223], a[148:151], v[56:59]
 v_mfma_f32_16x16x32_bf16 v[60:63], a[220:223], a[156:159], v[60:63]
 v_mfma_f32_16x16x32_bf16 v[60:63], a[216:219], a[152:155], v[60:63]
 v_mfma_f32_16x16x32_bf16 v[64:67], a[216:219], a[160:163], v[64:67]
 s_add_u32 m0, m0, 3072
 v_mfma_f32_16x16x32_bf16 v[64:67], a[220:223], a[164:167], v[64:67]
 v_mfma_f32_16x16x32_bf16 v[68:71], a[220:223], a[172:175], v[68:71]
 v_mfma_f32_16x16x32_bf16 v[68:71], a[216:219], a[168:171], v[68:71]
 s_add_u32 s30, s30, s21
 v_mfma_f32_16x16x32_bf16 v[72:75], a[216:219], a[176:179], v[72:75]
 v_mfma_f32_16x16x32_bf16 v[72:75], a[220:223], a[180:183], v[72:75]
 v_mfma_f32_16x16x32_bf16 v[76:79], a[220:223], a[188:191], v[76:79]
 v_mfma_f32_16x16x32_bf16 v[76:79], a[216:219], a[184:187], v[76:79]
 s_waitcnt vmcnt(10)
 v_mfma_f32_16x16x32_bf16 v[108:111], a[224:227], a[184:187], v[108:111]
 v_mfma_f32_16x16x32_bf16 v[108:111], a[228:231], a[188:191], v[108:111]
 global_load_dwordx4 a[220:223], v0, s[70:71] offset:3072 sc1
 v_mfma_f32_16x16x32_bf16 v[104:107], a[228:231], a[180:183], v[104:107]
 v_mfma_f32_16x16x32_bf16 v[104:107], a[224:227], a[176:179], v[104:107]
 global_load_dwordx4 a[216:219], v0, s[70:71] offset:2048 sc1
 v_mfma_f32_16x16x32_bf16 v[100:103], a[224:227], a[168:171], v[100:103]
 s_add_u32 s70, s70, 8192
 s_addc_u32 s71, s71, 0
 v_mfma_f32_16x16x32_bf16 v[100:103], a[228:231], a[172:175], v[100:103]
 v_mfma_f32_16x16x32_bf16 v[96:99], a[228:231], a[164:167], v[96:99]
 v_mfma_f32_16x16x32_bf16 v[96:99], a[224:227], a[160:163], v[96:99]
 v_mfma_f32_16x16x32_bf16 v[92:95], a[224:227], a[152:155], v[92:95]
 v_mfma_f32_16x16x32_bf16 v[92:95], a[228:231], a[156:159], v[92:95]
 v_mfma_f32_16x16x32_bf16 v[88:91], a[228:231], a[148:151], v[88:91]
 v_mfma_f32_16x16x32_bf16 v[88:91], a[224:227], a[144:147], v[88:91]
 v_mfma_f32_16x16x32_bf16 v[84:87], a[224:227], a[136:139], v[84:87]
 v_mfma_f32_16x16x32_bf16 v[84:87], a[228:231], a[140:143], v[84:87]
 v_mfma_f32_16x16x32_bf16 v[80:83], a[228:231], a[132:135], v[80:83]
 v_mfma_f32_16x16x32_bf16 v[80:83], a[224:227], a[128:131], v[80:83]
 s_waitcnt vmcnt(10)
 v_mfma_f32_16x16x32_bf16 v[112:115], a[232:235], a[128:131], v[112:115]
 v_mfma_f32_16x16x32_bf16 v[112:115], a[236:239], a[132:135], v[112:115]
 global_load_dwordx4 a[228:231], v0, s[70:71] offset:-3072 sc1
 v_mfma_f32_16x16x32_bf16 v[116:119], a[236:239], a[140:143], v[116:119]
 v_mfma_f32_16x16x32_bf16 v[116:119], a[232:235], a[136:139], v[116:119]
 global_load_dwordx4 a[224:227], v0, s[70:71] offset:-4096 sc1
 v_mfma_f32_16x16x32_bf16 v[120:123], a[232:235], a[144:147], v[120:123]
 v_mfma_f32_16x16x32_bf16 v[120:123], a[236:239], a[148:151], v[120:123]
 v_mfma_f32_16x16x32_bf16 v[124:127], a[236:239], a[156:159], v[124:127]
 v_mfma_f32_16x16x32_bf16 v[124:127], a[232:235], a[152:155], v[124:127]
 v_mfma_f32_16x16x32_bf16 v[128:131], a[232:235], a[160:163], v[128:131]
 v_mfma_f32_16x16x32_bf16 v[128:131], a[236:239], a[164:167], v[128:131]
 v_mfma_f32_16x16x32_bf16 v[132:135], a[236:239], a[172:175], v[132:135]
 v_mfma_f32_16x16x32_bf16 v[132:135], a[232:235], a[168:171], v[132:135]
 v_mfma_f32_16x16x32_bf16 a[240:243], a[232:235], a[176:179], a[240:243]
 v_mfma_f32_16x16x32_bf16 a[240:243], a[236:239], a[180:183], a[240:243]
 v_mfma_f32_16x16x32_bf16 a[244:247], a[236:239], a[188:191], a[244:247]
 buffer_load_dwordx4 v6, s[8:11], s30 offen lds
 v_mfma_f32_16x16x32_bf16 a[244:247], a[232:235], a[184:187], a[244:247]
 s_waitcnt vmcnt(11)
 v_mfma_f32_16x16x32_bf16 v[164:167], a[192:195], a[184:187], v[164:167]
 v_mfma_f32_16x16x32_bf16 v[164:167], a[196:199], a[188:191], v[164:167]
 global_load_dwordx4 a[236:239], v0, s[70:71] offset:-1024 sc1
 v_mfma_f32_16x16x32_bf16 v[160:163], a[196:199], a[180:183], v[160:163]
 s_add_u32 m0, m0, 1024
 v_mfma_f32_16x16x32_bf16 v[160:163], a[192:195], a[176:179], v[160:163]
 global_load_dwordx4 a[232:235], v0, s[70:71] offset:-2048 sc1
 v_mfma_f32_16x16x32_bf16 v[156:159], a[192:195], a[168:171], v[156:159]
 v_mfma_f32_16x16x32_bf16 v[156:159], a[196:199], a[172:175], v[156:159]
 s_add_u32 s30, s30, s20
 v_mfma_f32_16x16x32_bf16 v[152:155], a[196:199], a[164:167], v[152:155]
 v_mfma_f32_16x16x32_bf16 v[152:155], a[192:195], a[160:163], v[152:155]
 v_mfma_f32_16x16x32_bf16 v[148:151], a[192:195], a[152:155], v[148:151]
 buffer_load_dwordx4 v6, s[8:11], s30 offen lds
 v_mfma_f32_16x16x32_bf16 v[148:151], a[196:199], a[156:159], v[148:151]
 v_mfma_f32_16x16x32_bf16 v[144:147], a[196:199], a[148:151], v[144:147]
 v_mfma_f32_16x16x32_bf16 v[144:147], a[192:195], a[144:147], v[144:147]
 s_add_u32 m0, m0, 3072
 v_mfma_f32_16x16x32_bf16 v[140:143], a[192:195], a[136:139], v[140:143]
 v_mfma_f32_16x16x32_bf16 v[140:143], a[196:199], a[140:143], v[140:143]
 v_mfma_f32_16x16x32_bf16 v[136:139], a[196:199], a[132:135], v[136:139]
 s_add_u32 s30, s30, s21
 v_mfma_f32_16x16x32_bf16 v[136:139], a[192:195], a[128:131], v[136:139]
 s_waitcnt vmcnt(12)
 v_mfma_f32_16x16x32_bf16 v[168:171], a[200:203], a[128:131], v[168:171]
 v_mfma_f32_16x16x32_bf16 v[168:171], a[204:207], a[132:135], v[168:171]
 global_load_dwordx4 a[196:199], v0, s[70:71] offset:1024 sc1
 v_mfma_f32_16x16x32_bf16 v[172:175], a[204:207], a[140:143], v[172:175]
 s_add_u32 s31, s31, 1
 v_mov_b32 v7, s31
 buffer_store_dword v7, v1, s[60:63], 0 offen sc1
 v_mfma_f32_16x16x32_bf16 v[172:175], a[200:203], a[136:139], v[172:175]
 global_load_dwordx4 a[192:195], v0, s[70:71] offset:0 sc1
 v_mfma_f32_16x16x32_bf16 v[176:179], a[200:203], a[144:147], v[176:179]
 v_mfma_f32_16x16x32_bf16 v[176:179], a[204:207], a[148:151], v[176:179]
 v_mfma_f32_16x16x32_bf16 v[180:183], a[204:207], a[156:159], v[180:183]
 v_mfma_f32_16x16x32_bf16 v[180:183], a[200:203], a[152:155], v[180:183]
 v_mfma_f32_16x16x32_bf16 v[184:187], a[200:203], a[160:163], v[184:187]
 v_mfma_f32_16x16x32_bf16 v[184:187], a[204:207], a[164:167], v[184:187]
 v_mfma_f32_16x16x32_bf16 v[188:191], a[204:207], a[172:175], v[188:191]
 v_mfma_f32_16x16x32_bf16 v[188:191], a[200:203], a[168:171], v[188:191]
 v_mfma_f32_16x16x32_bf16 v[192:195], a[200:203], a[176:179], v[192:195]
 v_mfma_f32_16x16x32_bf16 v[192:195], a[204:207], a[180:183], v[192:195]
 v_mfma_f32_16x16x32_bf16 v[196:199], a[204:207], a[188:191], v[196:199]
 v_mfma_f32_16x16x32_bf16 v[196:199], a[200:203], a[184:187], v[196:199]
 s_waitcnt vmcnt(12)
 v_mfma_f32_16x16x32_bf16 v[228:231], a[208:211], a[184:187], v[228:231]
 v_mfma_f32_16x16x32_bf16 v[228:231], a[212:215], a[188:191], v[228:231]
 global_load_dwordx4 a[204:207], v0, s[70:71] offset:3072 sc1
 v_mfma_f32_16x16x32_bf16 v[224:227], a[212:215], a[180:183], v[224:227]
 v_mfma_f32_16x16x32_bf16 v[224:227], a[208:211], a[176:179], v[224:227]
 global_load_dwordx4 a[200:203], v0, s[70:71] offset:2048 sc1
 v_mfma_f32_16x16x32_bf16 v[220:223], a[208:211], a[168:171], v[220:223]
 s_add_u32 s70, s70, 8192
 s_addc_u32 s71, s71, 0
 v_mfma_f32_16x16x32_bf16 v[220:223], a[212:215], a[172:175], v[220:223]
 v_mfma_f32_16x16x32_bf16 v[216:219], a[212:215], a[164:167], v[216:219]
 v_mfma_f32_16x16x32_bf16 v[216:219], a[208:211], a[160:163], v[216:219]
 v_mfma_f32_16x16x32_bf16 v[212:215], a[208:211], a[152:155], v[212:215]
 v_mfma_f32_16x16x32_bf16 v[212:215], a[212:215], a[156:159], v[212:215]
 v_mfma_f32_16x16x32_bf16 v[208:211], a[212:215], a[148:151], v[208:211]
 v_mfma_f32_16x16x32_bf16 v[208:211], a[208:211], a[144:147], v[208:211]
 v_mfma_f32_16x16x32_bf16 v[204:207], a[208:211], a[136:139], v[204:207]
 v_mfma_f32_16x16x32_bf16 v[204:207], a[212:215], a[140:143], v[204:207]
 v_mfma_f32_16x16x32_bf16 v[200:203], a[212:215], a[132:135], v[200:203]
 v_mfma_f32_16x16x32_bf16 v[200:203], a[208:211], a[128:131], v[200:203]
 buffer_load_dwordx4 v6, s[8:11], s30 offen lds
 s_waitcnt vmcnt(12)
 v_mfma_f32_16x16x32_bf16 v[232:235], a[216:219], a[128:131], v[232:235]
 ds_read_b128 a[128:131], v1 offset:34816
 v_mfma_f32_16x16x32_bf16 v[232:235], a[220:223], a[132:135], v[232:235]
 global_load_dwordx4 a[212:215], v0, s[70:71] offset:-3072 sc1
 ds_read_b128 a[132:135], v1 offset:35840
 v_mfma_f32_16x16x32_bf16 v[236:239], a[220:223], a[140:143], v[236:239]
 ds_read_b128 a[140:143], v1 offset:39936
 v_mfma_f32_16x16x32_bf16 v[236:239], a[216:219], a[136:139], v[236:239]
 global_load_dwordx4 a[208:211], v0, s[70:71] offset:-4096 sc1
 ds_read_b128 a[136:139], v1 offset:38912
 v_mfma_f32_16x16x32_bf16 v[240:243], a[216:219], a[144:147], v[240:243]
 ds_read_b128 a[144:147], v1 offset:43008
 v_mfma_f32_16x16x32_bf16 v[240:243], a[220:223], a[148:151], v[240:243]
 ds_read_b128 a[148:151], v1 offset:44032
 s_add_u32 m0, m0, 1024
 v_mfma_f32_16x16x32_bf16 v[244:247], a[220:223], a[156:159], v[244:247]
 ds_read_b128 a[156:159], v1 offset:48128
 v_mfma_f32_16x16x32_bf16 v[244:247], a[216:219], a[152:155], v[244:247]
 ds_read_b128 a[152:155], v1 offset:47104
 v_mfma_f32_16x16x32_bf16 v[248:251], a[216:219], a[160:163], v[248:251]
 ds_read_b128 a[160:163], v1 offset:51200
 s_add_u32 s30, s30, s20
 v_mfma_f32_16x16x32_bf16 v[248:251], a[220:223], a[164:167], v[248:251]
 ds_read_b128 a[164:167], v1 offset:52224
 v_mfma_f32_16x16x32_bf16 v[252:255], a[220:223], a[172:175], v[252:255]
 ds_read_b128 a[172:175], v1 offset:56320
 v_mfma_f32_16x16x32_bf16 v[252:255], a[216:219], a[168:171], v[252:255]
 ds_read_b128 a[168:171], v1 offset:55296
 v_mfma_f32_16x16x32_bf16 a[248:251], a[216:219], a[176:179], a[248:251]
 ds_read_b128 a[176:179], v1 offset:59392
 v_mfma_f32_16x16x32_bf16 a[248:251], a[220:223], a[180:183], a[248:251]
 ds_read_b128 a[180:183], v1 offset:60416
 v_mfma_f32_16x16x32_bf16 a[252:255], a[220:223], a[188:191], a[252:255]
 ds_read_b128 a[188:191], v1 offset:64512
 v_mfma_f32_16x16x32_bf16 a[252:255], a[216:219], a[184:187], a[252:255]
 ds_read_b128 a[184:187], v1 offset:63488
 s_waitcnt vmcnt(12) lgkmcnt(8)
 v_mfma_f32_16x16x32_bf16 v[16:19], a[224:227], a[128:131], v[16:19]
 buffer_load_dwordx4 v6, s[8:11], s30 offen lds
 s_add_u32 m0, m0, 3072
 v_mfma_f32_16x16x32_bf16 v[16:19], a[228:231], a[132:135], v[16:19]
 global_load_dwordx4 a[220:223], v0, s[70:71] offset:-1024 sc1
 v_mfma_f32_16x16x32_bf16 v[20:23], a[228:231], a[140:143], v[20:23]
 s_add_u32 s30, s30, s21
 v_mfma_f32_16x16x32_bf16 v[20:23], a[224:227], a[136:139], v[20:23]
 global_load_dwordx4 a[216:219], v0, s[70:71] offset:-2048 sc1
 v_mfma_f32_16x16x32_bf16 v[24:27], a[224:227], a[144:147], v[24:27]
 v_mfma_f32_16x16x32_bf16 v[24:27], a[228:231], a[148:151], v[24:27]
 v_mfma_f32_16x16x32_bf16 v[28:31], a[228:231], a[156:159], v[28:31]
 v_mfma_f32_16x16x32_bf16 v[28:31], a[224:227], a[152:155], v[28:31]
 s_waitcnt lgkmcnt(0)
 v_mfma_f32_16x16x32_bf16 v[32:35], a[224:227], a[160:163], v[32:35]
 v_mfma_f32_16x16x32_bf16 v[32:35], a[228:231], a[164:167], v[32:35]
 v_mfma_f32_16x16x32_bf16 v[36:39], a[228:231], a[172:175], v[36:39]
 v_mfma_f32_16x16x32_bf16 v[36:39], a[224:227], a[168:171], v[36:39]
 v_mfma_f32_16x16x32_bf16 v[40:43], a[224:227], a[176:179], v[40:43]
 v_mfma_f32_16x16x32_bf16 v[40:43], a[228:231], a[180:183], v[40:43]
 v_mfma_f32_16x16x32_bf16 v[44:47], a[228:231], a[188:191], v[44:47]
 v_mfma_f32_16x16x32_bf16 v[44:47], a[224:227], a[184:187], v[44:47]
 s_waitcnt vmcnt(12)
 v_mfma_f32_16x16x32_bf16 v[76:79], a[232:235], a[184:187], v[76:79]
 v_mfma_f32_16x16x32_bf16 v[76:79], a[236:239], a[188:191], v[76:79]
 global_load_dwordx4 a[228:231], v0, s[70:71] offset:1024 sc1
 v_mfma_f32_16x16x32_bf16 v[72:75], a[236:239], a[180:183], v[72:75]
 v_mfma_f32_16x16x32_bf16 v[72:75], a[232:235], a[176:179], v[72:75]
 global_load_dwordx4 a[224:227], v0, s[70:71] offset:0 sc1
 v_mfma_f32_16x16x32_bf16 v[68:71], a[232:235], a[168:171], v[68:71]
 v_mfma_f32_16x16x32_bf16 v[68:71], a[236:239], a[172:175], v[68:71]
 v_mfma_f32_16x16x32_bf16 v[64:67], a[236:239], a[164:167], v[64:67]
 v_mfma_f32_16x16x32_bf16 v[64:67], a[232:235], a[160:163], v[64:67]
 v_mfma_f32_16x16x32_bf16 v[60:63], a[232:235], a[152:155], v[60:63]
 v_mfma_f32_16x16x32_bf16 v[60:63], a[236:239], a[156:159], v[60:63]
 v_mfma_f32_16x16x32_bf16 v[56:59], a[236:239], a[148:151], v[56:59]
 v_mfma_f32_16x16x32_bf16 v[56:59], a[232:235], a[144:147], v[56:59]
 v_mfma_f32_16x16x32_bf16 v[52:55], a[232:235], a[136:139], v[52:55]
 v_mfma_f32_16x16x32_bf16 v[52:55], a[236:239], a[140:143], v[52:55]
 v_mfma_f32_16x16x32_bf16 v[48:51], a[236:239], a[132:135], v[48:51]
 v_mfma_f32_16x16x32_bf16 v[48:51], a[232:235], a[128:131], v[48:51]
 s_waitcnt vmcnt(10)
 v_mfma_f32_16x16x32_bf16 v[80:83], a[192:195], a[128:131], v[80:83]
 v_mfma_f32_16x16x32_bf16 v[80:83], a[196:199], a[132:135], v[80:83]
 global_load_dwordx4 a[236:239], v0, s[70:71] offset:3072 sc1
 v_mfma_f32_16x16x32_bf16 v[84:87], a[196:199], a[140:143], v[84:87]
 v_mfma_f32_16x16x32_bf16 v[84:87], a[192:195], a[136:139], v[84:87]
 global_load_dwordx4 a[232:235], v0, s[70:71] offset:2048 sc1
 v_mfma_f32_16x16x32_bf16 v[88:91], a[192:195], a[144:147], v[88:91]
 s_add_u32 s70, s70, 8192
 s_addc_u32 s71, s71, 0
 v_mfma_f32_16x16x32_bf16 v[88:91], a[196:199], a[148:151], v[88:91]
 buffer_load_dwordx4 v6, s[8:11], s30 offen lds
 v_mfma_f32_16x16x32_bf16 v[92:95], a[196:199], a[156:159], v[92:95]
 v_mfma_f32_16x16x32_bf16 v[92:95], a[192:195], a[152:155], v[92:95]
 v_mfma_f32_16x16x32_bf16 v[96:99], a[192:195], a[160:163], v[96:99]
 v_mfma_f32_16x16x32_bf16 v[96:99], a[196:199], a[164:167], v[96:99]
 s_add_u32 m0, m0, 1024
 v_mfma_f32_16x16x32_bf16 v[100:103], a[196:199], a[172:175], v[100:103]
 v_mfma_f32_16x16x32_bf16 v[100:103], a[192:195], a[168:171], v[100:103]
 v_mfma_f32_16x16x32_bf16 v[104:107], a[192:195], a[176:179], v[104:107]
 s_add_u32 s30, s30, s20
 v_mfma_f32_16x16x32_bf16 v[104:107], a[196:199], a[180:183], v[104:107]
 v_mfma_f32_16x16x32_bf16 v[108:111], a[196:199], a[188:191], v[108:111]
 v_mfma_f32_16x16x32_bf16 v[108:111], a[192:195], a[184:187], v[108:111]
 buffer_load_dwordx4 v6, s[8:11], s30 offen lds
 s_waitcnt vmcnt(12)
 v_mfma_f32_16x16x32_bf16 a[244:247], a[200:203], a[184:187], a[244:247]
 v_mfma_f32_16x16x32_bf16 a[244:247], a[204:207], a[188:191], a[244:247]
 global_load_dwordx4 a[196:199], v0, s[70:71] offset:-3072 sc1
 v_mfma_f32_16x16x32_bf16 a[240:243], a[204:207], a[180:183], a[240:243]
 s_add_u32 m0, m0, 3072
 v_mfma_f32_16x16x32_bf16 a[240:243], a[200:203], a[176:179], a[240:243]
 global_load_dwordx4 a[192:195], v0, s[70:71] offset:-4096 sc1
 v_mfma_f32_16x16x32_bf16 v[132:135], a[200:203], a[168:171], v[132:135]
 v_mfma_f32_16x16x32_bf16 v[132:135], a[204:207], a[172:175], v[132:135]
 v_mfma_f32_16x16x32_bf16 v[128:131], a[204:207], a[164:167], v[128:131]
 s_add_u32 s30, s30, s21
 v_mfma_f32_16x16x32_bf16 v[128:131], a[200:203], a[160:163], v[128:131]
 v_mfma_f32_16x16x32_bf16 v[124:127], a[200:203], a[152:155], v[124:127]
 v_mfma_f32_16x16x32_bf16 v[124:127], a[204:207], a[156:159], v[124:127]
 v_mfma_f32_16x16x32_bf16 v[120:123], a[204:207], a[148:151], v[120:123]
 v_mfma_f32_16x16x32_bf16 v[120:123], a[200:203], a[144:147], v[120:123]
 v_mfma_f32_16x16x32_bf16 v[116:119], a[200:203], a[136:139], v[116:119]
 v_mfma_f32_16x16x32_bf16 v[116:119], a[204:207], a[140:143], v[116:119]
 v_mfma_f32_16x16x32_bf16 v[112:115], a[204:207], a[132:135], v[112:115]
 v_mfma_f32_16x16x32_bf16 v[112:115], a[200:203], a[128:131], v[112:115]
 s_waitcnt vmcnt(11)
 v_mfma_f32_16x16x32_bf16 v[136:139], a[208:211], a[128:131], v[136:139]
 v_mfma_f32_16x16x32_bf16 v[136:139], a[212:215], a[132:135], v[136:139]
 global_load_dwordx4 a[204:207], v0, s[70:71] offset:-1024 sc1
 v_mfma_f32_16x16x32_bf16 v[140:143], a[212:215], a[140:143], v[140:143]
 v_mfma_f32_16x16x32_bf16 v[140:143], a[208:211], a[136:139], v[140:143]
 global_load_dwordx4 a[200:203], v0, s[70:71] offset:-2048 sc1
 v_mfma_f32_16x16x32_bf16 v[144:147], a[208:211], a[144:147], v[144:147]
 v_mfma_f32_16x16x32_bf16 v[144:147], a[212:215], a[148:151], v[144:147]
 v_mfma_f32_16x16x32_bf16 v[148:151], a[212:215], a[156:159], v[148:151]
 v_mfma_f32_16x16x32_bf16 v[148:151], a[208:211], a[152:155], v[148:151]
 v_mfma_f32_16x16x32_bf16 v[152:155], a[208:211], a[160:163], v[152:155]
 v_mfma_f32_16x16x32_bf16 v[152:155], a[212:215], a[164:167], v[152:155]
 v_mfma_f32_16x16x32_bf16 v[156:159], a[212:215], a[172:175], v[156:159]
 v_mfma_f32_16x16x32_bf16 v[156:159], a[208:211], a[168:171], v[156:159]
 v_mfma_f32_16x16x32_bf16 v[160:163], a[208:211], a[176:179], v[160:163]
 v_mfma_f32_16x16x32_bf16 v[160:163], a[212:215], a[180:183], v[160:163]
 v_mfma_f32_16x16x32_bf16 v[164:167], a[212:215], a[188:191], v[164:167]
 v_mfma_f32_16x16x32_bf16 v[164:167], a[208:211], a[184:187], v[164:167]
 s_waitcnt vmcnt(10)
 v_mfma_f32_16x16x32_bf16 v[196:199], a[216:219], a[184:187], v[196:199]
 v_mfma_f32_16x16x32_bf16 v[196:199], a[220:223], a[188:191], v[196:199]
 global_load_dwordx4 a[212:215], v0, s[70:71] offset:1024 sc1
 v_mfma_f32_16x16x32_bf16 v[192:195], a[220:223], a[180:183], v[192:195]
 v_mfma_f32_16x16x32_bf16 v[192:195], a[216:219], a[176:179], v[192:195]
 global_load_dwordx4 a[208:211], v0, s[70:71] offset:0 sc1
 v_mfma_f32_16x16x32_bf16 v[188:191], a[216:219], a[168:171], v[188:191]
 v_mfma_f32_16x16x32_bf16 v[188:191], a[220:223], a[172:175], v[188:191]
 v_mfma_f32_16x16x32_bf16 v[184:187], a[220:223], a[164:167], v[184:187]
 v_mfma_f32_16x16x32_bf16 v[184:187], a[216:219], a[160:163], v[184:187]
 v_mfma_f32_16x16x32_bf16 v[180:183], a[216:219], a[152:155], v[180:183]
 v_mfma_f32_16x16x32_bf16 v[180:183], a[220:223], a[156:159], v[180:183]
 buffer_load_dwordx4 v6, s[8:11], s30 offen lds
 v_mfma_f32_16x16x32_bf16 v[176:179], a[220:223], a[148:151], v[176:179]
 v_mfma_f32_16x16x32_bf16 v[176:179], a[216:219], a[144:147], v[176:179]
 v_mfma_f32_16x16x32_bf16 v[172:175], a[216:219], a[136:139], v[172:175]
 s_add_u32 m0, m0, 1024
 v_mfma_f32_16x16x32_bf16 v[172:175], a[220:223], a[140:143], v[172:175]
 v_mfma_f32_16x16x32_bf16 v[168:171], a[220:223], a[132:135], v[168:171]
 v_mfma_f32_16x16x32_bf16 v[168:171], a[216:219], a[128:131], v[168:171]
 s_waitcnt vmcnt(11)
 v_mfma_f32_16x16x32_bf16 v[200:203], a[224:227], a[128:131], v[200:203]
 s_add_u32 s30, s30, s20
 v_mfma_f32_16x16x32_bf16 v[200:203], a[228:231], a[132:135], v[200:203]
 global_load_dwordx4 a[220:223], v0, s[70:71] offset:3072 sc1
 v_mfma_f32_16x16x32_bf16 v[204:207], a[228:231], a[140:143], v[204:207]
 buffer_load_dwordx4 v6, s[8:11], s30 offen lds
 v_mfma_f32_16x16x32_bf16 v[204:207], a[224:227], a[136:139], v[204:207]
 global_load_dwordx4 a[216:219], v0, s[70:71] offset:2048 sc1
 v_mfma_f32_16x16x32_bf16 v[208:211], a[224:227], a[144:147], v[208:211]
 s_add_u32 s70, s70, 8192
 s_addc_u32 s71, s71, 0
 v_mfma_f32_16x16x32_bf16 v[208:211], a[228:231], a[148:151], v[208:211]
 v_mfma_f32_16x16x32_bf16 v[212:215], a[228:231], a[156:159], v[212:215]
 s_add_u32 m0, m0, 3072
 v_mfma_f32_16x16x32_bf16 v[212:215], a[224:227], a[152:155], v[212:215]
 v_mfma_f32_16x16x32_bf16 v[216:219], a[224:227], a[160:163], v[216:219]
 v_mfma_f32_16x16x32_bf16 v[216:219], a[228:231], a[164:167], v[216:219]
 s_add_u32 s30, s30, s21
 v_mfma_f32_16x16x32_bf16 v[220:223], a[228:231], a[172:175], v[220:223]
 v_mfma_f32_16x16x32_bf16 v[220:223], a[224:227], a[168:171], v[220:223]
 v_mfma_f32_16x16x32_bf16 v[224:227], a[224:227], a[176:179], v[224:227]
 v_mfma_f32_16x16x32_bf16 v[224:227], a[228:231], a[180:183], v[224:227]
 v_mfma_f32_16x16x32_bf16 v[228:231], a[228:231], a[188:191], v[228:231]
 v_mfma_f32_16x16x32_bf16 v[228:231], a[224:227], a[184:187], v[228:231]
 s_waitcnt vmcnt(12)
 v_mfma_f32_16x16x32_bf16 a[252:255], a[232:235], a[184:187], a[252:255]
 ds_read_b128 a[184:187], v2 offset:30720
 v_mfma_f32_16x16x32_bf16 a[252:255], a[236:239], a[188:191], a[252:255]
 global_load_dwordx4 a[228:231], v0, s[70:71] offset:-3072 sc1
 ds_read_b128 a[188:191], v2 offset:31744
 v_mfma_f32_16x16x32_bf16 a[248:251], a[236:239], a[180:183], a[248:251]
 ds_read_b128 a[180:183], v2 offset:27648
 v_mfma_f32_16x16x32_bf16 a[248:251], a[232:235], a[176:179], a[248:251]
 global_load_dwordx4 a[224:227], v0, s[70:71] offset:-4096 sc1
 ds_read_b128 a[176:179], v2 offset:26624
 v_mfma_f32_16x16x32_bf16 v[252:255], a[232:235], a[168:171], v[252:255]
 ds_read_b128 a[168:171], v2 offset:22528
 v_mfma_f32_16x16x32_bf16 v[252:255], a[236:239], a[172:175], v[252:255]
 ds_read_b128 a[172:175], v2 offset:23552
 v_mfma_f32_16x16x32_bf16 v[248:251], a[236:239], a[164:167], v[248:251]
 ds_read_b128 a[164:167], v2 offset:19456
 v_mfma_f32_16x16x32_bf16 v[248:251], a[232:235], a[160:163], v[248:251]
 ds_read_b128 a[160:163], v2 offset:18432
 v_mfma_f32_16x16x32_bf16 v[244:247], a[232:235], a[152:155], v[244:247]
 ds_read_b128 a[152:155], v2 offset:14336
 v_mfma_f32_16x16x32_bf16 v[244:247], a[236:239], a[156:159], v[244:247]
 ds_read_b128 a[156:159], v2 offset:15360
 v_mfma_f32_16x16x32_bf16 v[240:243], a[236:239], a[148:151], v[240:243]
 ds_read_b128 a[148:151], v2 offset:11264
 v_mfma_f32_16x16x32_bf16 v[240:243], a[232:235], a[144:147], v[240:243]
 ds_read_b128 a[144:147], v2 offset:10240
 v_mfma_f32_16x16x32_bf16 v[236:239], a[232:235], a[136:139], v[236:239]
 ds_read_b128 a[136:139], v2 offset:6144
 v_mfma_f32_16x16x32_bf16 v[236:239], a[236:239], a[140:143], v[236:239]
 ds_read_b128 a[140:143], v2 offset:7168
 v_mfma_f32_16x16x32_bf16 v[232:235], a[236:239], a[132:135], v[232:235]
 ds_read_b128 a[132:135], v2 offset:3072
 v_mfma_f32_16x16x32_bf16 v[232:235], a[232:235], a[128:131], v[232:235]
 ds_read_b128 a[128:131], v2 offset:2048
 s_waitcnt vmcnt(10) lgkmcnt(8)
 v_mfma_f32_16x16x32_bf16 v[44:47], a[192:195], a[184:187], v[44:47]
 v_mfma_f32_16x16x32_bf16 v[44:47], a[196:199], a[188:191], v[44:47]
 global_load_dwordx4 a[236:239], v0, s[70:71] offset:-1024 sc1
 v_mfma_f32_16x16x32_bf16 v[40:43], a[196:199], a[180:183], v[40:43]
 v_mfma_f32_16x16x32_bf16 v[40:43], a[192:195], a[176:179], v[40:43]
 global_load_dwordx4 a[232:235], v0, s[70:71] offset:-2048 sc1
 v_mfma_f32_16x16x32_bf16 v[36:39], a[192:195], a[168:171], v[36:39]
 v_mfma_f32_16x16x32_bf16 v[36:39], a[196:199], a[172:175], v[36:39]
 v_mfma_f32_16x16x32_bf16 v[32:35], a[196:199], a[164:167], v[32:35]
 v_mfma_f32_16x16x32_bf16 v[32:35], a[192:195], a[160:163], v[32:35]
 s_waitcnt lgkmcnt(0)
 v_mfma_f32_16x16x32_bf16 v[28:31], a[192:195], a[152:155], v[28:31]
 v_mfma_f32_16x16x32_bf16 v[28:31], a[196:199], a[156:159], v[28:31]
 v_mfma_f32_16x16x32_bf16 v[24:27], a[196:199], a[148:151], v[24:27]
 v_mfma_f32_16x16x32_bf16 v[24:27], a[192:195], a[144:147], v[24:27]
 v_mfma_f32_16x16x32_bf16 v[20:23], a[192:195], a[136:139], v[20:23]
 v_mfma_f32_16x16x32_bf16 v[20:23], a[196:199], a[140:143], v[20:23]
 buffer_load_dwordx4 v6, s[8:11], s30 offen lds
 v_mfma_f32_16x16x32_bf16 v[16:19], a[196:199], a[132:135], v[16:19]
 v_mfma_f32_16x16x32_bf16 v[16:19], a[192:195], a[128:131], v[16:19]
 s_waitcnt vmcnt(11)
 v_mfma_f32_16x16x32_bf16 v[48:51], a[200:203], a[128:131], v[48:51]
 s_add_u32 m0, m0, 1024
 v_mfma_f32_16x16x32_bf16 v[48:51], a[204:207], a[132:135], v[48:51]
 global_load_dwordx4 a[196:199], v0, s[70:71] offset:1024 sc1
 v_mfma_f32_16x16x32_bf16 v[52:55], a[204:207], a[140:143], v[52:55]
 v_mfma_f32_16x16x32_bf16 v[52:55], a[200:203], a[136:139], v[52:55]
 global_load_dwordx4 a[192:195], v0, s[70:71] offset:0 sc1
 s_add_u32 s30, s30, s20
 v_mfma_f32_16x16x32_bf16 v[56:59], a[200:203], a[144:147], v[56:59]
 v_mfma_f32_16x16x32_bf16 v[56:59], a[204:207], a[148:151], v[56:59]
 v_mfma_f32_16x16x32_bf16 v[60:63], a[204:207], a[156:159], v[60:63]
 buffer_load_dwordx4 v6, s[8:11], s30 offen lds
 v_mfma_f32_16x16x32_bf16 v[60:63], a[200:203], a[152:155], v[60:63]
 v_mfma_f32_16x16x32_bf16 v[64:67], a[200:203], a[160:163], v[64:67]
 v_mfma_f32_16x16x32_bf16 v[64:67], a[204:207], a[164:167], v[64:67]
 v_mfma_f32_16x16x32_bf16 v[68:71], a[204:207], a[172:175], v[68:71]
 s_add_u32 m0, m0, 3072
 v_mfma_f32_16x16x32_bf16 v[68:71], a[200:203], a[168:171], v[68:71]
 v_mfma_f32_16x16x32_bf16 v[72:75], a[200:203], a[176:179], v[72:75]
 v_mfma_f32_16x16x32_bf16 v[72:75], a[204:207], a[180:183], v[72:75]
 s_add_u32 s30, s30, s21
 v_mfma_f32_16x16x32_bf16 v[76:79], a[204:207], a[188:191], v[76:79]
 v_mfma_f32_16x16x32_bf16 v[76:79], a[200:203], a[184:187], v[76:79]
 s_waitcnt vmcnt(12)
 v_mfma_f32_16x16x32_bf16 v[108:111], a[208:211], a[184:187], v[108:111]
 v_mfma_f32_16x16x32_bf16 v[108:111], a[212:215], a[188:191], v[108:111]
 global_load_dwordx4 a[204:207], v0, s[70:71] offset:3072 sc1
 v_mfma_f32_16x16x32_bf16 v[104:107], a[212:215], a[180:183], v[104:107]
 v_mfma_f32_16x16x32_bf16 v[104:107], a[208:211], a[176:179], v[104:107]
 global_load_dwordx4 a[200:203], v0, s[70:71] offset:2048 sc1
 v_mfma_f32_16x16x32_bf16 v[100:103], a[208:211], a[168:171], v[100:103]
 s_add_u32 s70, s70, 8192
 s_addc_u32 s71, s71, 0
 v_mfma_f32_16x16x32_bf16 v[100:103], a[212:215], a[172:175], v[100:103]
 v_mfma_f32_16x16x32_bf16 v[96:99], a[212:215], a[164:167], v[96:99]
 v_mfma_f32_16x16x32_bf16 v[96:99], a[208:211], a[160:163], v[96:99]
 v_mfma_f32_16x16x32_bf16 v[92:95], a[208:211], a[152:155], v[92:95]
 v_mfma_f32_16x16x32_bf16 v[92:95], a[212:215], a[156:159], v[92:95]
 v_mfma_f32_16x16x32_bf16 v[88:91], a[212:215], a[148:151], v[88:91]
 v_mfma_f32_16x16x32_bf16 v[88:91], a[208:211], a[144:147], v[88:91]
 v_mfma_f32_16x16x32_bf16 v[84:87], a[208:211], a[136:139], v[84:87]
 v_mfma_f32_16x16x32_bf16 v[84:87], a[212:215], a[140:143], v[84:87]
 v_mfma_f32_16x16x32_bf16 v[80:83], a[212:215], a[132:135], v[80:83]
 v_mfma_f32_16x16x32_bf16 v[80:83], a[208:211], a[128:131], v[80:83]
 s_waitcnt vmcnt(10)
 v_mfma_f32_16x16x32_bf16 v[112:115], a[216:219], a[128:131], v[112:115]
 v_mfma_f32_16x16x32_bf16 v[112:115], a[220:223], a[132:135], v[112:115]
 global_load_dwordx4 a[212:215], v0, s[70:71] offset:-3072 sc1
 v_mfma_f32_16x16x32_bf16 v[116:119], a[220:223], a[140:143], v[116:119]
 v_mfma_f32_16x16x32_bf16 v[116:119], a[216:219], a[136:139], v[116:119]
 global_load_dwordx4 a[208:211], v0, s[70:71] offset:-4096 sc1
 v_mfma_f32_16x16x32_bf16 v[120:123], a[216:219], a[144:147], v[120:123]
 v_mfma_f32_16x16x32_bf16 v[120:123], a[220:223], a[148:151], v[120:123]
 v_mfma_f32_16x16x32_bf16 v[124:127], a[220:223], a[156:159], v[124:127]
 v_mfma_f32_16x16x32_bf16 v[124:127], a[216:219], a[152:155], v[124:127]
 v_mfma_f32_16x16x32_bf16 v[128:131], a[216:219], a[160:163], v[128:131]
 v_mfma_f32_16x16x32_bf16 v[128:131], a[220:223], a[164:167], v[128:131]
 v_mfma_f32_16x16x32_bf16 v[132:135], a[220:223], a[172:175], v[132:135]
 v_mfma_f32_16x16x32_bf16 v[132:135], a[216:219], a[168:171], v[132:135]
 v_mfma_f32_16x16x32_bf16 a[240:243], a[216:219], a[176:179], a[240:243]
 v_mfma_f32_16x16x32_bf16 a[240:243], a[220:223], a[180:183], a[240:243]
 v_mfma_f32_16x16x32_bf16 a[244:247], a[220:223], a[188:191], a[244:247]
 v_mfma_f32_16x16x32_bf16 a[244:247], a[216:219], a[184:187], a[244:247]
 s_waitcnt vmcnt(10)
 v_mfma_f32_16x16x32_bf16 v[164:167], a[224:227], a[184:187], v[164:167]
 buffer_load_dwordx4 v6, s[8:11], s30 offen lds
 v_mfma_f32_16x16x32_bf16 v[164:167], a[228:231], a[188:191], v[164:167]
 global_load_dwordx4 a[220:223], v0, s[70:71] offset:-1024 sc1
 v_mfma_f32_16x16x32_bf16 v[160:163], a[228:231], a[180:183], v[160:163]
 v_mfma_f32_16x16x32_bf16 v[160:163], a[224:227], a[176:179], v[160:163]
 global_load_dwordx4 a[216:219], v0, s[70:71] offset:-2048 sc1
 s_add_u32 m0, m0, 1024
 v_mfma_f32_16x16x32_bf16 v[156:159], a[224:227], a[168:171], v[156:159]
 v_mfma_f32_16x16x32_bf16 v[156:159], a[228:231], a[172:175], v[156:159]
 v_mfma_f32_16x16x32_bf16 v[152:155], a[228:231], a[164:167], v[152:155]
 v_mfma_f32_16x16x32_bf16 v[152:155], a[224:227], a[160:163], v[152:155]
 s_add_u32 s30, s30, s20
 v_mfma_f32_16x16x32_bf16 v[148:151], a[224:227], a[152:155], v[148:151]
 v_mfma_f32_16x16x32_bf16 v[148:151], a[228:231], a[156:159], v[148:151]
 v_mfma_f32_16x16x32_bf16 v[144:147], a[228:231], a[148:151], v[144:147]
 buffer_load_dwordx4 v6, s[8:11], s30 offen lds
 v_mfma_f32_16x16x32_bf16 v[144:147], a[224:227], a[144:147], v[144:147]
 v_mfma_f32_16x16x32_bf16 v[140:143], a[224:227], a[136:139], v[140:143]
 v_mfma_f32_16x16x32_bf16 v[140:143], a[228:231], a[140:143], v[140:143]
 s_add_u32 m0, m0, 3072
 v_mfma_f32_16x16x32_bf16 v[136:139], a[228:231], a[132:135], v[136:139]
 v_mfma_f32_16x16x32_bf16 v[136:139], a[224:227], a[128:131], v[136:139]
 s_waitcnt vmcnt(12)
 v_mfma_f32_16x16x32_bf16 v[168:171], a[232:235], a[128:131], v[168:171]
 s_add_u32 s30, s30, s21
 v_mfma_f32_16x16x32_bf16 v[168:171], a[236:239], a[132:135], v[168:171]
 global_load_dwordx4 a[228:231], v0, s[70:71] offset:1024 sc1
 v_mfma_f32_16x16x32_bf16 v[172:175], a[236:239], a[140:143], v[172:175]
 v_mfma_f32_16x16x32_bf16 v[172:175], a[232:235], a[136:139], v[172:175]
 global_load_dwordx4 a[224:227], v0, s[70:71] offset:0 sc1
 v_mfma_f32_16x16x32_bf16 v[176:179], a[232:235], a[144:147], v[176:179]
 v_mfma_f32_16x16x32_bf16 v[176:179], a[236:239], a[148:151], v[176:179]
 v_mfma_f32_16x16x32_bf16 v[180:183], a[236:239], a[156:159], v[180:183]
 v_mfma_f32_16x16x32_bf16 v[180:183], a[232:235], a[152:155], v[180:183]
 v_mfma_f32_16x16x32_bf16 v[184:187], a[232:235], a[160:163], v[184:187]
 v_mfma_f32_16x16x32_bf16 v[184:187], a[236:239], a[164:167], v[184:187]
 v_mfma_f32_16x16x32_bf16 v[188:191], a[236:239], a[172:175], v[188:191]
 v_mfma_f32_16x16x32_bf16 v[188:191], a[232:235], a[168:171], v[188:191]
 v_mfma_f32_16x16x32_bf16 v[192:195], a[232:235], a[176:179], v[192:195]
 v_mfma_f32_16x16x32_bf16 v[192:195], a[236:239], a[180:183], v[192:195]
 v_mfma_f32_16x16x32_bf16 v[196:199], a[236:239], a[188:191], v[196:199]
 v_mfma_f32_16x16x32_bf16 v[196:199], a[232:235], a[184:187], v[196:199]
 s_waitcnt vmcnt(11)
 v_mfma_f32_16x16x32_bf16 v[228:231], a[192:195], a[184:187], v[228:231]
 v_mfma_f32_16x16x32_bf16 v[228:231], a[196:199], a[188:191], v[228:231]
 global_load_dwordx4 a[236:239], v0, s[70:71] offset:3072 sc1
 v_mfma_f32_16x16x32_bf16 v[224:227], a[196:199], a[180:183], v[224:227]
 v_mfma_f32_16x16x32_bf16 v[224:227], a[192:195], a[176:179], v[224:227]
 global_load_dwordx4 a[232:235], v0, s[70:71] offset:2048 sc1
 v_mfma_f32_16x16x32_bf16 v[220:223], a[192:195], a[168:171], v[220:223]
 s_add_u32 s70, s70, 8192
 s_addc_u32 s71, s71, 0
 v_mfma_f32_16x16x32_bf16 v[220:223], a[196:199], a[172:175], v[220:223]
 v_mfma_f32_16x16x32_bf16 v[216:219], a[196:199], a[164:167], v[216:219]
 v_mfma_f32_16x16x32_bf16 v[216:219], a[192:195], a[160:163], v[216:219]
 v_mfma_f32_16x16x32_bf16 v[212:215], a[192:195], a[152:155], v[212:215]
 v_mfma_f32_16x16x32_bf16 v[212:215], a[196:199], a[156:159], v[212:215]
 v_mfma_f32_16x16x32_bf16 v[208:211], a[196:199], a[148:151], v[208:211]
 v_mfma_f32_16x16x32_bf16 v[208:211], a[192:195], a[144:147], v[208:211]
 v_mfma_f32_16x16x32_bf16 v[204:207], a[192:195], a[136:139], v[204:207]
 v_mfma_f32_16x16x32_bf16 v[204:207], a[196:199], a[140:143], v[204:207]
 v_mfma_f32_16x16x32_bf16 v[200:203], a[196:199], a[132:135], v[200:203]
 v_mfma_f32_16x16x32_bf16 v[200:203], a[192:195], a[128:131], v[200:203]
 buffer_load_dwordx4 v6, s[8:11], s30 offen lds
 s_waitcnt vmcnt(11)
 v_mfma_f32_16x16x32_bf16 v[232:235], a[200:203], a[128:131], v[232:235]
 ds_read_b128 a[128:131], v2 offset:34816
 v_mfma_f32_16x16x32_bf16 v[232:235], a[204:207], a[132:135], v[232:235]
 global_load_dwordx4 a[196:199], v0, s[70:71] offset:-3072 sc1
 ds_read_b128 a[132:135], v2 offset:35840
 v_mfma_f32_16x16x32_bf16 v[236:239], a[204:207], a[140:143], v[236:239]
 ds_read_b128 a[140:143], v2 offset:39936
 v_mfma_f32_16x16x32_bf16 v[236:239], a[200:203], a[136:139], v[236:239]
 global_load_dwordx4 a[192:195], v0, s[70:71] offset:-4096 sc1
 ds_read_b128 a[136:139], v2 offset:38912
 v_mfma_f32_16x16x32_bf16 v[240:243], a[200:203], a[144:147], v[240:243]
 ds_read_b128 a[144:147], v2 offset:43008
 v_mfma_f32_16x16x32_bf16 v[240:243], a[204:207], a[148:151], v[240:243]
 ds_read_b128 a[148:151], v2 offset:44032
 v_mfma_f32_16x16x32_bf16 v[244:247], a[204:207], a[156:159], v[244:247]
 ds_read_b128 a[156:159], v2 offset:48128
 v_mfma_f32_16x16x32_bf16 v[244:247], a[200:203], a[152:155], v[244:247]
 ds_read_b128 a[152:155], v2 offset:47104
 s_add_u32 m0, m0, 1024
 v_mfma_f32_16x16x32_bf16 v[248:251], a[200:203], a[160:163], v[248:251]
 ds_read_b128 a[160:163], v2 offset:51200
 v_mfma_f32_16x16x32_bf16 v[248:251], a[204:207], a[164:167], v[248:251]
 ds_read_b128 a[164:167], v2 offset:52224
 v_mfma_f32_16x16x32_bf16 v[252:255], a[204:207], a[172:175], v[252:255]
 ds_read_b128 a[172:175], v2 offset:56320
 s_add_u32 s30, s30, s20
 v_mfma_f32_16x16x32_bf16 v[252:255], a[200:203], a[168:171], v[252:255]
 ds_read_b128 a[168:171], v2 offset:55296
 v_mfma_f32_16x16x32_bf16 a[248:251], a[200:203], a[176:179], a[248:251]
 ds_read_b128 a[176:179], v2 offset:59392
 v_mfma_f32_16x16x32_bf16 a[248:251], a[204:207], a[180:183], a[248:251]
 ds_read_b128 a[180:183], v2 offset:60416
 v_mfma_f32_16x16x32_bf16 a[252:255], a[204:207], a[188:191], a[252:255]
 ds_read_b128 a[188:191], v2 offset:64512
 v_mfma_f32_16x16x32_bf16 a[252:255], a[200:203], a[184:187], a[252:255]
 ds_read_b128 a[184:187], v2 offset:63488
 s_waitcnt vmcnt(11) lgkmcnt(8)
 v_mfma_f32_16x16x32_bf16 v[16:19], a[208:211], a[128:131], v[16:19]
 buffer_load_dwordx4 v6, s[8:11], s30 offen lds
 v_mfma_f32_16x16x32_bf16 v[16:19], a[212:215], a[132:135], v[16:19]
 global_load_dwordx4 a[204:207], v0, s[70:71] offset:-1024 sc1
 s_add_u32 m0, m0, 3072
 v_mfma_f32_16x16x32_bf16 v[20:23], a[212:215], a[140:143], v[20:23]
 buffer_load_dword v4, off, s[64:67], 0 sc1
 v_mfma_f32_16x16x32_bf16 v[20:23], a[208:211], a[136:139], v[20:23]
 global_load_dwordx4 a[200:203], v0, s[70:71] offset:-2048 sc1
 v_mfma_f32_16x16x32_bf16 v[24:27], a[208:211], a[144:147], v[24:27]
 s_add_u32 s30, s30, s22
 v_mfma_f32_16x16x32_bf16 v[24:27], a[212:215], a[148:151], v[24:27]
 v_mfma_f32_16x16x32_bf16 v[28:31], a[212:215], a[156:159], v[28:31]
 v_mfma_f32_16x16x32_bf16 v[28:31], a[208:211], a[152:155], v[28:31]
 s_waitcnt lgkmcnt(0)
 v_mfma_f32_16x16x32_bf16 v[32:35], a[208:211], a[160:163], v[32:35]
 v_mfma_f32_16x16x32_bf16 v[32:35], a[212:215], a[164:167], v[32:35]
 v_mfma_f32_16x16x32_bf16 v[36:39], a[212:215], a[172:175], v[36:39]
 v_mfma_f32_16x16x32_bf16 v[36:39], a[208:211], a[168:171], v[36:39]
 v_mfma_f32_16x16x32_bf16 v[40:43], a[208:211], a[176:179], v[40:43]
 v_mfma_f32_16x16x32_bf16 v[40:43], a[212:215], a[180:183], v[40:43]
 v_mfma_f32_16x16x32_bf16 v[44:47], a[212:215], a[188:191], v[44:47]
 v_mfma_f32_16x16x32_bf16 v[44:47], a[208:211], a[184:187], v[44:47]
 s_waitcnt vmcnt(12)
 v_mfma_f32_16x16x32_bf16 v[76:79], a[216:219], a[184:187], v[76:79]
 v_lshrrev_b32 v5, 6, v1
 v_mfma_f32_16x16x32_bf16 v[76:79], a[220:223], a[188:191], v[76:79]
 global_load_dwordx4 a[212:215], v0, s[70:71] offset:1024 sc1
 v_mfma_f32_16x16x32_bf16 v[72:75], a[220:223], a[180:183], v[72:75]
 v_and_b32 v6, 48, v1
 v_mfma_f32_16x16x32_bf16 v[72:75], a[216:219], a[176:179], v[72:75]
 global_load_dwordx4 a[208:211], v0, s[70:71] offset:0 sc1
 v_lshl_add_u32 v5, v5, 11, v6
 v_mfma_f32_16x16x32_bf16 v[68:71], a[216:219], a[168:171], v[68:71]
 v_mfma_f32_16x16x32_bf16 v[68:71], a[220:223], a[172:175], v[68:71]
 s_mov_b32 m0, s52
 v_mfma_f32_16x16x32_bf16 v[64:67], a[220:223], a[164:167], v[64:67]
 s_add_u32 s3, s48, 31744
 v_mfma_f32_16x16x32_bf16 v[64:67], a[216:219], a[160:163], v[64:67]
 v_mfma_f32_16x16x32_bf16 v[60:63], a[216:219], a[152:155], v[60:63]
 buffer_load_dwordx4 v5, s[40:43], s48 offen lds
 v_mfma_f32_16x16x32_bf16 v[60:63], a[220:223], a[156:159], v[60:63]
 buffer_load_dwordx4 v5, s[40:43], s3 offen offset:1024 lds
 v_mfma_f32_16x16x32_bf16 v[56:59], a[220:223], a[148:151], v[56:59]
 v_mfma_f32_16x16x32_bf16 v[56:59], a[216:219], a[144:147], v[56:59]
 s_add_u32 s48, s48, 2097152
 v_mfma_f32_16x16x32_bf16 v[52:55], a[216:219], a[136:139], v[52:55]
 v_mfma_f32_16x16x32_bf16 v[52:55], a[220:223], a[140:143], v[52:55]
 v_mfma_f32_16x16x32_bf16 v[48:51], a[220:223], a[132:135], v[48:51]
 v_mfma_f32_16x16x32_bf16 v[48:51], a[216:219], a[128:131], v[48:51]
 s_waitcnt vmcnt(13)
 v_mfma_f32_16x16x32_bf16 v[80:83], a[224:227], a[128:131], v[80:83]
 v_mfma_f32_16x16x32_bf16 v[80:83], a[228:231], a[132:135], v[80:83]
 global_load_dwordx4 a[220:223], v0, s[70:71] offset:3072 sc1
 v_mfma_f32_16x16x32_bf16 v[84:87], a[228:231], a[140:143], v[84:87]
 v_mfma_f32_16x16x32_bf16 v[84:87], a[224:227], a[136:139], v[84:87]
 global_load_dwordx4 a[216:219], v0, s[70:71] offset:2048 sc1
 v_mfma_f32_16x16x32_bf16 v[88:91], a[224:227], a[144:147], v[88:91]
 s_add_u32 s70, s70, 8192
 s_addc_u32 s71, s71, 0
 v_mfma_f32_16x16x32_bf16 v[88:91], a[228:231], a[148:151], v[88:91]
 v_mfma_f32_16x16x32_bf16 v[92:95], a[228:231], a[156:159], v[92:95]
 v_mfma_f32_16x16x32_bf16 v[92:95], a[224:227], a[152:155], v[92:95]
 v_mfma_f32_16x16x32_bf16 v[96:99], a[224:227], a[160:163], v[96:99]
 v_mfma_f32_16x16x32_bf16 v[96:99], a[228:231], a[164:167], v[96:99]
 v_mfma_f32_16x16x32_bf16 v[100:103], a[228:231], a[172:175], v[100:103]
 v_mfma_f32_16x16x32_bf16 v[100:103], a[224:227], a[168:171], v[100:103]
 v_mfma_f32_16x16x32_bf16 v[104:107], a[224:227], a[176:179], v[104:107]
 v_mfma_f32_16x16x32_bf16 v[104:107], a[228:231], a[180:183], v[104:107]
 v_mfma_f32_16x16x32_bf16 v[108:111], a[228:231], a[188:191], v[108:111]
 v_mfma_f32_16x16x32_bf16 v[108:111], a[224:227], a[184:187], v[108:111]
 s_waitcnt vmcnt(13)
 v_mfma_f32_16x16x32_bf16 a[244:247], a[232:235], a[184:187], a[244:247]
 v_mfma_f32_16x16x32_bf16 a[244:247], a[236:239], a[188:191], a[244:247]
 global_load_dwordx4 a[228:231], v0, s[70:71] offset:-3072 sc1
 v_mfma_f32_16x16x32_bf16 a[240:243], a[236:239], a[180:183], a[240:243]
 v_mfma_f32_16x16x32_bf16 a[240:243], a[232:235], a[176:179], a[240:243]
 global_load_dwordx4 a[224:227], v0, s[70:71] offset:-4096 sc1
 v_mfma_f32_16x16x32_bf16 v[132:135], a[232:235], a[168:171], v[132:135]
 v_mfma_f32_16x16x32_bf16 v[132:135], a[236:239], a[172:175], v[132:135]
 v_mfma_f32_16x16x32_bf16 v[128:131], a[236:239], a[164:167], v[128:131]
 v_mfma_f32_16x16x32_bf16 v[128:131], a[232:235], a[160:163], v[128:131]
 v_mfma_f32_16x16x32_bf16 v[124:127], a[232:235], a[152:155], v[124:127]
 v_mfma_f32_16x16x32_bf16 v[124:127], a[236:239], a[156:159], v[124:127]
 v_mfma_f32_16x16x32_bf16 v[120:123], a[236:239], a[148:151], v[120:123]
 v_mfma_f32_16x16x32_bf16 v[120:123], a[232:235], a[144:147], v[120:123]
 v_mfma_f32_16x16x32_bf16 v[116:119], a[232:235], a[136:139], v[116:119]
 v_mfma_f32_16x16x32_bf16 v[116:119], a[236:239], a[140:143], v[116:119]
 v_mfma_f32_16x16x32_bf16 v[112:115], a[236:239], a[132:135], v[112:115]
 v_mfma_f32_16x16x32_bf16 v[112:115], a[232:235], a[128:131], v[112:115]
 s_waitcnt vmcnt(12)
 v_mfma_f32_16x16x32_bf16 v[136:139], a[192:195], a[128:131], v[136:139]
 v_mfma_f32_16x16x32_bf16 v[136:139], a[196:199], a[132:135], v[136:139]
 global_load_dwordx4 a[236:239], v0, s[70:71] offset:-1024 sc1
 v_mfma_f32_16x16x32_bf16 v[140:143], a[196:199], a[140:143], v[140:143]
 v_mfma_f32_16x16x32_bf16 v[140:143], a[192:195], a[136:139], v[140:143]
 global_load_dwordx4 a[232:235], v0, s[70:71] offset:-2048 sc1
 v_mfma_f32_16x16x32_bf16 v[144:147], a[192:195], a[144:147], v[144:147]
 v_mfma_f32_16x16x32_bf16 v[144:147], a[196:199], a[148:151], v[144:147]
 v_mfma_f32_16x16x32_bf16 v[148:151], a[196:199], a[156:159], v[148:151]
 v_mfma_f32_16x16x32_bf16 v[148:151], a[192:195], a[152:155], v[148:151]
 v_mfma_f32_16x16x32_bf16 v[152:155], a[192:195], a[160:163], v[152:155]
 v_mfma_f32_16x16x32_bf16 v[152:155], a[196:199], a[164:167], v[152:155]
 v_mfma_f32_16x16x32_bf16 v[156:159], a[196:199], a[172:175], v[156:159]
 v_mfma_f32_16x16x32_bf16 v[156:159], a[192:195], a[168:171], v[156:159]
 v_mfma_f32_16x16x32_bf16 v[160:163], a[192:195], a[176:179], v[160:163]
 v_mfma_f32_16x16x32_bf16 v[160:163], a[196:199], a[180:183], v[160:163]
 v_mfma_f32_16x16x32_bf16 v[164:167], a[196:199], a[188:191], v[164:167]
 v_mfma_f32_16x16x32_bf16 v[164:167], a[192:195], a[184:187], v[164:167]
 s_waitcnt vmcnt(10)
 v_mfma_f32_16x16x32_bf16 v[196:199], a[200:203], a[184:187], v[196:199]
 v_mfma_f32_16x16x32_bf16 v[196:199], a[204:207], a[188:191], v[196:199]
 global_load_dwordx4 a[196:199], v0, s[70:71] offset:1024 sc1
 v_mfma_f32_16x16x32_bf16 v[192:195], a[204:207], a[180:183], v[192:195]
 v_mfma_f32_16x16x32_bf16 v[192:195], a[200:203], a[176:179], v[192:195]
 global_load_dwordx4 a[192:195], v0, s[70:71] offset:0 sc1
 v_mfma_f32_16x16x32_bf16 v[188:191], a[200:203], a[168:171], v[188:191]
 v_mfma_f32_16x16x32_bf16 v[188:191], a[204:207], a[172:175], v[188:191]
 v_mfma_f32_16x16x32_bf16 v[184:187], a[204:207], a[164:167], v[184:187]
 v_mfma_f32_16x16x32_bf16 v[184:187], a[200:203], a[160:163], v[184:187]
 v_mfma_f32_16x16x32_bf16 v[180:183], a[200:203], a[152:155], v[180:183]
 v_mfma_f32_16x16x32_bf16 v[180:183], a[204:207], a[156:159], v[180:183]
 v_mfma_f32_16x16x32_bf16 v[176:179], a[204:207], a[148:151], v[176:179]
 v_mfma_f32_16x16x32_bf16 v[176:179], a[200:203], a[144:147], v[176:179]
 v_mfma_f32_16x16x32_bf16 v[172:175], a[200:203], a[136:139], v[172:175]
 v_mfma_f32_16x16x32_bf16 v[172:175], a[204:207], a[140:143], v[172:175]
 v_mfma_f32_16x16x32_bf16 v[168:171], a[204:207], a[132:135], v[168:171]
 v_mfma_f32_16x16x32_bf16 v[168:171], a[200:203], a[128:131], v[168:171]
 s_waitcnt vmcnt(10)
 v_mfma_f32_16x16x32_bf16 v[200:203], a[208:211], a[128:131], v[200:203]
 v_mfma_f32_16x16x32_bf16 v[200:203], a[212:215], a[132:135], v[200:203]
 global_load_dwordx4 a[204:207], v0, s[70:71] offset:3072 sc1
 v_mfma_f32_16x16x32_bf16 v[204:207], a[212:215], a[140:143], v[204:207]
 v_mfma_f32_16x16x32_bf16 v[204:207], a[208:211], a[136:139], v[204:207]
 global_load_dwordx4 a[200:203], v0, s[70:71] offset:2048 sc1
 v_mfma_f32_16x16x32_bf16 v[208:211], a[208:211], a[144:147], v[208:211]
 s_add_u32 s70, s70, 8192
 s_addc_u32 s71, s71, 0
 v_mfma_f32_16x16x32_bf16 v[208:211], a[212:215], a[148:151], v[208:211]
 v_mfma_f32_16x16x32_bf16 v[212:215], a[212:215], a[156:159], v[212:215]
 v_mfma_f32_16x16x32_bf16 v[212:215], a[208:211], a[152:155], v[212:215]
 v_mfma_f32_16x16x32_bf16 v[216:219], a[208:211], a[160:163], v[216:219]
 v_mfma_f32_16x16x32_bf16 v[216:219], a[212:215], a[164:167], v[216:219]
 v_mfma_f32_16x16x32_bf16 v[220:223], a[212:215], a[172:175], v[220:223]
 v_cmp_gt_i32 vcc, s55, v4
 s_and_b64 vcc, exec, vcc
 s_cbranch_vccnz Lspin_pb
Lok_pb:
 s_add_u32 s55, s55, 1
 s_waitcnt lgkmcnt(0)
 s_barrier
 v_mfma_f32_16x16x32_bf16 v[220:223], a[208:211], a[168:171], v[220:223]
 s_cmp_eq_u32 s25, 0
 s_cbranch_scc1 Lxrg
Lxrgr:
 v_mfma_f32_16x16x32_bf16 v[224:227], a[208:211], a[176:179], v[224:227]
 v_mfma_f32_16x16x32_bf16 v[224:227], a[212:215], a[180:183], v[224:227]
 v_mfma_f32_16x16x32_bf16 v[228:231], a[212:215], a[188:191], v[228:231]
 v_mfma_f32_16x16x32_bf16 v[228:231], a[208:211], a[184:187], v[228:231]
 s_waitcnt vmcnt(8)
 v_mfma_f32_16x16x32_bf16 a[252:255], a[216:219], a[184:187], a[252:255]
 ds_read_b128 a[184:187], v1 offset:28672
 v_mfma_f32_16x16x32_bf16 a[252:255], a[220:223], a[188:191], a[252:255]
 global_load_dwordx4 a[212:215], v0, s[70:71] offset:-3072 sc1
 ds_read_b128 a[188:191], v1 offset:29696
 v_mfma_f32_16x16x32_bf16 a[248:251], a[220:223], a[180:183], a[248:251]
 ds_read_b128 a[180:183], v1 offset:25600
 v_mfma_f32_16x16x32_bf16 a[248:251], a[216:219], a[176:179], a[248:251]
 global_load_dwordx4 a[208:211], v0, s[70:71] offset:-4096 sc1
 ds_read_b128 a[176:179], v1 offset:24576
 v_mfma_f32_16x16x32_bf16 v[252:255], a[216:219], a[168:171], v[252:255]
 ds_read_b128 a[168:171], v1 offset:20480
 v_mfma_f32_16x16x32_bf16 v[252:255], a[220:223], a[172:175], v[252:255]
 ds_read_b128 a[172:175], v1 offset:21504
 v_mfma_f32_16x16x32_bf16 v[248:251], a[220:223], a[164:167], v[248:251]
 ds_read_b128 a[164:167], v1 offset:17408
 v_mfma_f32_16x16x32_bf16 v[248:251], a[216:219], a[160:163], v[248:251]
 ds_read_b128 a[160:163], v1 offset:16384
 v_mfma_f32_16x16x32_bf16 v[244:247], a[216:219], a[152:155], v[244:247]
 ds_read_b128 a[152:155], v1 offset:12288
 v_mfma_f32_16x16x32_bf16 v[244:247], a[220:223], a[156:159], v[244:247]
 ds_read_b128 a[156:159], v1 offset:13312
 v_mfma_f32_16x16x32_bf16 v[240:243], a[220:223], a[148:151], v[240:243]
 ds_read_b128 a[148:151], v1 offset:9216
 v_mfma_f32_16x16x32_bf16 v[240:243], a[216:219], a[144:147], v[240:243]
 ds_read_b128 a[144:147], v1 offset:8192
 v_mfma_f32_16x16x32_bf16 v[236:239], a[216:219], a[136:139], v[236:239]
 ds_read_b128 a[136:139], v1 offset:4096
 v_mfma_f32_16x16x32_bf16 v[236:239], a[220:223], a[140:143], v[236:239]
 ds_read_b128 a[140:143], v1 offset:5120
 v_mfma_f32_16x16x32_bf16 v[232:235], a[220:223], a[132:135], v[232:235]
 global_load_dwordx4 a[220:223], v0, s[70:71] offset:-1024 sc1
 ds_read_b128 a[132:135], v1 offset:1024
 v_mfma_f32_16x16x32_bf16 v[232:235], a[216:219], a[128:131], v[232:235]
 global_load_dwordx4 a[216:219], v0, s[70:71] offset:-2048 sc1
 ds_read_b128 a[128:131], v1
 s_waitcnt vmcnt(10) lgkmcnt(8)
 v_mfma_f32_16x16x32_bf16 v[44:47], a[224:227], a[184:187], v[44:47]
 v_mfma_f32_16x16x32_bf16 v[44:47], a[228:231], a[188:191], v[44:47]
 v_mov_b32 v6, v3
 s_cmp_eq_u32 s25, 0
 s_cbranch_scc1 Lgat1
Lgatr1:
 v_mfma_f32_16x16x32_bf16 v[40:43], a[228:231], a[180:183], v[40:43]
 v_mfma_f32_16x16x32_bf16 v[40:43], a[224:227], a[176:179], v[40:43]
 v_mfma_f32_16x16x32_bf16 v[36:39], a[224:227], a[168:171], v[36:39]
 v_mfma_f32_16x16x32_bf16 v[36:39], a[228:231], a[172:175], v[36:39]
 s_add_u32 m0, s50, 2048
 v_mfma_f32_16x16x32_bf16 v[32:35], a[228:231], a[164:167], v[32:35]
 v_mfma_f32_16x16x32_bf16 v[32:35], a[224:227], a[160:163], v[32:35]
 s_waitcnt lgkmcnt(0)
 v_mfma_f32_16x16x32_bf16 v[28:31], a[224:227], a[152:155], v[28:31]
 v_mfma_f32_16x16x32_bf16 v[28:31], a[228:231], a[156:159], v[28:31]
 v_mfma_f32_16x16x32_bf16 v[24:27], a[228:231], a[148:151], v[24:27]
 v_mfma_f32_16x16x32_bf16 v[24:27], a[224:227], a[144:147], v[24:27]
 v_mfma_f32_16x16x32_bf16 v[20:23], a[224:227], a[136:139], v[20:23]
 buffer_load_dwordx4 v6, s[8:11], s30 offen lds
 v_mfma_f32_16x16x32_bf16 v[20:23], a[228:231], a[140:143], v[20:23]
 v_mfma_f32_16x16x32_bf16 v[16:19], a[228:231], a[132:135], v[16:19]
 v_mfma_f32_16x16x32_bf16 v[16:19], a[224:227], a[128:131], v[16:19]
 s_waitcnt vmcnt(9)
 v_mfma_f32_16x16x32_bf16 v[48:51], a[232:235], a[128:131], v[48:51]
 s_add_u32 m0, m0, 1024
 v_mfma_f32_16x16x32_bf16 v[48:51], a[236:239], a[132:135], v[48:51]
 global_load_dwordx4 a[228:231], v0, s[70:71] offset:1024 sc1
 v_mfma_f32_16x16x32_bf16 v[52:55], a[236:239], a[140:143], v[52:55]
 v_mfma_f32_16x16x32_bf16 v[52:55], a[232:235], a[136:139], v[52:55]
 global_load_dwordx4 a[224:227], v0, s[70:71] offset:0 sc1
 s_add_u32 s30, s30, s20
 v_mfma_f32_16x16x32_bf16 v[56:59], a[232:235], a[144:147], v[56:59]
 v_mfma_f32_16x16x32_bf16 v[56:59], a[236:239], a[148:151], v[56:59]
 v_mfma_f32_16x16x32_bf16 v[60:63], a[236:239], a[156:159], v[60:63]
 v_mfma_f32_16x16x32_bf16 v[60:63], a[232:235], a[152:155], v[60:63]
 buffer_load_dwordx4 v6, s[8:11], s30 offen lds
 v_mfma_f32_16x16x32_bf16 v[64:67], a[232:235], a[160:163], v[64:67]
 v_mfma_f32_16x16x32_bf16 v[64:67], a[236:239], a[164:167], v[64:67]
 v_mfma_f32_16x16x32_bf16 v[68:71], a[236:239], a[172:175], v[68:71]
 v_mfma_f32_16x16x32_bf16 v[68:71], a[232:235], a[168:171], v[68:71]
 s_add_u32 m0, m0, 3072
 v_mfma_f32_16x16x32_bf16 v[72:75], a[232:235], a[176:179], v[72:75]
 v_mfma_f32_16x16x32_bf16 v[72:75], a[236:239], a[180:183], v[72:75]
 v_mfma_f32_16x16x32_bf16 v[76:79], a[236:239], a[188:191], v[76:79]
 s_add_u32 s30, s30, s21
 v_mfma_f32_16x16x32_bf16 v[76:79], a[232:235], a[184:187], v[76:79]
 s_waitcnt vmcnt(10)
 v_mfma_f32_16x16x32_bf16 v[108:111], a[192:195], a[184:187], v[108:111]
 v_mfma_f32_16x16x32_bf16 v[108:111], a[196:199], a[188:191], v[108:111]
 global_load_dwordx4 a[236:239], v0, s[70:71] offset:3072 sc1
 v_mfma_f32_16x16x32_bf16 v[104:107], a[196:199], a[180:183], v[104:107]
 v_mfma_f32_16x16x32_bf16 v[104:107], a[192:195], a[176:179], v[104:107]
 global_load_dwordx4 a[232:235], v0, s[70:71] offset:2048 sc1
 v_mfma_f32_16x16x32_bf16 v[100:103], a[192:195], a[168:171], v[100:103]
 s_add_u32 s70, s70, 8192
 s_addc_u32 s71, s71, 0
 v_mfma_f32_16x16x32_bf16 v[100:103], a[196:199], a[172:175], v[100:103]
 v_mfma_f32_16x16x32_bf16 v[96:99], a[196:199], a[164:167], v[96:99]
 v_mfma_f32_16x16x32_bf16 v[96:99], a[192:195], a[160:163], v[96:99]
 v_mfma_f32_16x16x32_bf16 v[92:95], a[192:195], a[152:155], v[92:95]
 v_mfma_f32_16x16x32_bf16 v[92:95], a[196:199], a[156:159], v[92:95]
 v_mfma_f32_16x16x32_bf16 v[88:91], a[196:199], a[148:151], v[88:91]
 v_mfma_f32_16x16x32_bf16 v[88:91], a[192:195], a[144:147], v[88:91]
 v_mfma_f32_16x16x32_bf16 v[84:87], a[192:195], a[136:139], v[84:87]
 v_mfma_f32_16x16x32_bf16 v[84:87], a[196:199], a[140:143], v[84:87]
 v_mfma_f32_16x16x32_bf16 v[80:83], a[196:199], a[132:135], v[80:83]
 v_mfma_f32_16x16x32_bf16 v[80:83], a[192:195], a[128:131], v[80:83]
 s_waitcnt vmcnt(10)
 v_mfma_f32_16x16x32_bf16 v[112:115], a[200:203], a[128:131], v[112:115]
 v_mfma_f32_16x16x32_bf16 v[112:115], a[204:207], a[132:135], v[112:115]
 global_load_dwordx4 a[196:199], v0, s[70:71] offset:-3072 sc1
 v_mfma_f32_16x16x32_bf16 v[116:119], a[204:207], a[140:143], v[116:119]
 v_mfma_f32_16x16x32_bf16 v[116:119], a[200:203], a[136:139], v[116:119]
 global_load_dwordx4 a[192:195], v0, s[70:71] offset:-4096 sc1
 v_mfma_f32_16x16x32_bf16 v[120:123], a[200:203], a[144:147], v[120:123]
 v_mfma_f32_16x16x32_bf16 v[120:123], a[204:207], a[148:151], v[120:123]
 v_mfma_f32_16x16x32_bf16 v[124:127], a[204:207], a[156:159], v[124:127]
 v_mfma_f32_16x16x32_bf16 v[124:127], a[200:203], a[152:155], v[124:127]
 v_mfma_f32_16x16x32_bf16 v[128:131], a[200:203], a[160:163], v[128:131]
 v_mfma_f32_16x16x32_bf16 v[128:131], a[204:207], a[164:167], v[128:131]
 v_mfma_f32_16x16x32_bf16 v[132:135], a[204:207], a[172:175], v[132:135]
 v_mfma_f32_16x16x32_bf16 v[132:135], a[200:203], a[168:171], v[132:135]
 v_mfma_f32_16x16x32_bf16 a[240:243], a[200:203], a[176:179], a[240:243]
 v_mfma_f32_16x16x32_bf16 a[240:243], a[204:207], a[180:183], a[240:243]
 v_mfma_f32_16x16x32_bf16 a[244:247], a[204:207], a[188:191], a[244:247]
 v_mfma_f32_16x16x32_bf16 a[244:247], a[200:203], a[184:187], a[244:247]
 s_waitcnt vmcnt(10)
 v_mfma_f32_16x16x32_bf16 v[164:167], a[208:211], a[184:187], v[164:167]
 v_mfma_f32_16x16x32_bf16 v[164:167], a[212:215], a[188:191], v[164:167]
 global_load_dwordx4 a[204:207], v0, s[70:71] offset:-1024 sc1
 v_mfma_f32_16x16x32_bf16 v[160:163], a[212:215], a[180:183], v[160:163]
 v_mfma_f32_16x16x32_bf16 v[160:163], a[208:211], a[176:179], v[160:163]
 global_load_dwordx4 a[200:203], v0, s[70:71] offset:-2048 sc1
 v_mfma_f32_16x16x32_bf16 v[156:159], a[208:211], a[168:171], v[156:159]
 v_mfma_f32_16x16x32_bf16 v[156:159], a[212:215], a[172:175], v[156:159]
 v_mfma_f32_16x16x32_bf16 v[152:155], a[212:215], a[164:167], v[152:155]
 buffer_load_dwordx4 v6, s[8:11], s30 offen lds
 v_mfma_f32_16x16x32_bf16 v[152:155], a[208:211], a[160:163], v[152:155]
 v_mfma_f32_16x16x32_bf16 v[148:151], a[208:211], a[152:155], v[148:151]
 v_mfma_f32_16x16x32_bf16 v[148:151], a[212:215], a[156:159], v[148:151]
 v_mfma_f32_16x16x32_bf16 v[144:147], a[212:215], a[148:151], v[144:147]
 s_add_u32 m0, m0, 1024
 v_mfma_f32_16x16x32_bf16 v[144:147], a[208:211], a[144:147], v[144:147]
 v_mfma_f32_16x16x32_bf16 v[140:143], a[208:211], a[136:139], v[140:143]
 v_mfma_f32_16x16x32_bf16 v[140:143], a[212:215], a[140:143], v[140:143]
 v_mfma_f32_16x16x32_bf16 v[136:139], a[212:215], a[132:135], v[136:139]
 s_add_u32 s30, s30, s20
 v_mfma_f32_16x16x32_bf16 v[136:139], a[208:211], a[128:131], v[136:139]
 s_waitcnt vmcnt(11)
 v_mfma_f32_16x16x32_bf16 v[168:171], a[216:219], a[128:131], v[168:171]
 v_mfma_f32_16x16x32_bf16 v[168:171], a[220:223], a[132:135], v[168:171]
 global_load_dwordx4 a[212:215], v0, s[70:71] offset:1024 sc1
 v_mfma_f32_16x16x32_bf16 v[172:175], a[220:223], a[140:143], v[172:175]
 buffer_load_dwordx4 v6, s[8:11], s30 offen lds
 v_mfma_f32_16x16x32_bf16 v[172:175], a[216:219], a[136:139], v[172:175]
 global_load_dwordx4 a[208:211], v0, s[70:71] offset:0 sc1
 v_mfma_f32_16x16x32_bf16 v[176:179], a[216:219], a[144:147], v[176:179]
 v_mfma_f32_16x16x32_bf16 v[176:179], a[220:223], a[148:151], v[176:179]
 s_add_u32 m0, m0, 3072
 v_mfma_f32_16x16x32_bf16 v[180:183], a[220:223], a[156:159], v[180:183]
 v_mfma_f32_16x16x32_bf16 v[180:183], a[216:219], a[152:155], v[180:183]
 v_mfma_f32_16x16x32_bf16 v[184:187], a[216:219], a[160:163], v[184:187]
 v_mfma_f32_16x16x32_bf16 v[184:187], a[220:223], a[164:167], v[184:187]
 s_add_u32 s30, s30, s21
 v_mfma_f32_16x16x32_bf16 v[188:191], a[220:223], a[172:175], v[188:191]
 v_mfma_f32_16x16x32_bf16 v[188:191], a[216:219], a[168:171], v[188:191]
 v_mfma_f32_16x16x32_bf16 v[192:195], a[216:219], a[176:179], v[192:195]
 v_mfma_f32_16x16x32_bf16 v[192:195], a[220:223], a[180:183], v[192:195]
 v_mfma_f32_16x16x32_bf16 v[196:199], a[220:223], a[188:191], v[196:199]
 v_mfma_f32_16x16x32_bf16 v[196:199], a[216:219], a[184:187], v[196:199]
 s_waitcnt vmcnt(11)
 v_mfma_f32_16x16x32_bf16 v[228:231], a[224:227], a[184:187], v[228:231]
 v_mfma_f32_16x16x32_bf16 v[228:231], a[228:231], a[188:191], v[228:231]
 global_load_dwordx4 a[220:223], v0, s[70:71] offset:3072 sc1
 v_mfma_f32_16x16x32_bf16 v[224:227], a[228:231], a[180:183], v[224:227]
 v_mfma_f32_16x16x32_bf16 v[224:227], a[224:227], a[176:179], v[224:227]
 global_load_dwordx4 a[216:219], v0, s[70:71] offset:2048 sc1
 v_mfma_f32_16x16x32_bf16 v[220:223], a[224:227], a[168:171], v[220:223]
 s_add_u32 s70, s70, 8192
 s_addc_u32 s71, s71, 0
 v_mfma_f32_16x16x32_bf16 v[220:223], a[228:231], a[172:175], v[220:223]
 v_mfma_f32_16x16x32_bf16 v[216:219], a[228:231], a[164:167], v[216:219]
 v_mfma_f32_16x16x32_bf16 v[216:219], a[224:227], a[160:163], v[216:219]
 v_mfma_f32_16x16x32_bf16 v[212:215], a[224:227], a[152:155], v[212:215]
 v_mfma_f32_16x16x32_bf16 v[212:215], a[228:231], a[156:159], v[212:215]
 v_mfma_f32_16x16x32_bf16 v[208:211], a[228:231], a[148:151], v[208:211]
 v_mfma_f32_16x16x32_bf16 v[208:211], a[224:227], a[144:147], v[208:211]
 v_mfma_f32_16x16x32_bf16 v[204:207], a[224:227], a[136:139], v[204:207]
 v_mfma_f32_16x16x32_bf16 v[204:207], a[228:231], a[140:143], v[204:207]
 v_mfma_f32_16x16x32_bf16 v[200:203], a[228:231], a[132:135], v[200:203]
 v_mfma_f32_16x16x32_bf16 v[200:203], a[224:227], a[128:131], v[200:203]
 s_waitcnt vmcnt(10)
 v_mfma_f32_16x16x32_bf16 v[232:235], a[232:235], a[128:131], v[232:235]
 ds_read_b128 a[128:131], v1 offset:32768
 v_mfma_f32_16x16x32_bf16 v[232:235], a[236:239], a[132:135], v[232:235]
 global_load_dwordx4 a[228:231], v0, s[70:71] offset:-3072 sc1
 ds_read_b128 a[132:135], v1 offset:33792
 v_mfma_f32_16x16x32_bf16 v[236:239], a[236:239], a[140:143], v[236:239]
 ds_read_b128 a[140:143], v1 offset:37888
 v_mfma_f32_16x16x32_bf16 v[236:239], a[232:235], a[136:139], v[236:239]
 global_load_dwordx4 a[224:227], v0, s[70:71] offset:-4096 sc1
 ds_read_b128 a[136:139], v1 offset:36864
 v_mfma_f32_16x16x32_bf16 v[240:243], a[232:235], a[144:147], v[240:243]
 ds_read_b128 a[144:147], v1 offset:40960
 v_mfma_f32_16x16x32_bf16 v[240:243], a[236:239], a[148:151], v[240:243]
 ds_read_b128 a[148:151], v1 offset:41984
 v_mfma_f32_16x16x32_bf16 v[244:247], a[236:239], a[156:159], v[244:247]
 ds_read_b128 a[156:159], v1 offset:46080
 v_mfma_f32_16x16x32_bf16 v[244:247], a[232:235], a[152:155], v[244:247]
 ds_read_b128 a[152:155], v1 offset:45056
 v_mfma_f32_16x16x32_bf16 v[248:251], a[232:235], a[160:163], v[248:251]
 ds_read_b128 a[160:163], v1 offset:49152
 v_mfma_f32_16x16x32_bf16 v[248:251], a[236:239], a[164:167], v[248:251]
 ds_read_b128 a[164:167], v1 offset:50176
 v_mfma_f32_16x16x32_bf16 v[252:255], a[236:239], a[172:175], v[252:255]
 ds_read_b128 a[172:175], v1 offset:54272
 v_mfma_f32_16x16x32_bf16 v[252:255], a[232:235], a[168:171], v[252:255]
 ds_read_b128 a[168:171], v1 offset:53248
 v_mfma_f32_16x16x32_bf16 a[248:251], a[232:235], a[176:179], a[248:251]
 ds_read_b128 a[176:179], v1 offset:57344
 v_mfma_f32_16x16x32_bf16 a[248:251], a[236:239], a[180:183], a[248:251]
 ds_read_b128 a[180:183], v1 offset:58368
 v_mfma_f32_16x16x32_bf16 a[252:255], a[236:239], a[188:191], a[252:255]
 ds_read_b128 a[188:191], v1 offset:62464
 v_mfma_f32_16x16x32_bf16 a[252:255], a[232:235], a[184:187], a[252:255]
 ds_read_b128 a[184:187], v1 offset:61440
 s_waitcnt vmcnt(10) lgkmcnt(8)
 v_mfma_f32_16x16x32_bf16 v[16:19], a[192:195], a[128:131], v[16:19]
 v_mfma_f32_16x16x32_bf16 v[16:19], a[196:199], a[132:135], v[16:19]
 buffer_load_dwordx4 v6, s[8:11], s30 offen lds
 v_mfma_f32_16x16x32_bf16 v[20:23], a[196:199], a[140:143], v[20:23]
 v_mfma_f32_16x16x32_bf16 v[20:23], a[192:195], a[136:139], v[20:23]
 v_mfma_f32_16x16x32_bf16 v[24:27], a[192:195], a[144:147], v[24:27]
 s_add_u32 m0, m0, 1024
 v_mfma_f32_16x16x32_bf16 v[24:27], a[196:199], a[148:151], v[24:27]
 v_mfma_f32_16x16x32_bf16 v[28:31], a[196:199], a[156:159], v[28:31]
 v_mfma_f32_16x16x32_bf16 v[28:31], a[192:195], a[152:155], v[28:31]
 s_waitcnt lgkmcnt(0)
 v_mfma_f32_16x16x32_bf16 v[32:35], a[192:195], a[160:163], v[32:35]
 s_add_u32 s30, s30, s20
 v_mfma_f32_16x16x32_bf16 v[32:35], a[196:199], a[164:167], v[32:35]
 v_mfma_f32_16x16x32_bf16 v[36:39], a[196:199], a[172:175], v[36:39]
 v_mfma_f32_16x16x32_bf16 v[36:39], a[192:195], a[168:171], v[36:39]
 v_mfma_f32_16x16x32_bf16 v[40:43], a[192:195], a[176:179], v[40:43]
 buffer_load_dwordx4 v6, s[8:11], s30 offen lds
 v_mfma_f32_16x16x32_bf16 v[40:43], a[196:199], a[180:183], v[40:43]
 v_mfma_f32_16x16x32_bf16 v[44:47], a[196:199], a[188:191], v[44:47]
 v_mfma_f32_16x16x32_bf16 v[44:47], a[192:195], a[184:187], v[44:47]
 s_add_u32 m0, m0, 3072
 s_waitcnt vmcnt(10)
 v_mfma_f32_16x16x32_bf16 v[76:79], a[200:203], a[184:187], v[76:79]
 v_mfma_f32_16x16x32_bf16 v[76:79], a[204:207], a[188:191], v[76:79]
 global_load_dwordx4 a[196:199], v0, s[70:71] offset:-1024 sc1
 v_mfma_f32_16x16x32_bf16 v[72:75], a[204:207], a[180:183], v[72:75]
 v_mfma_f32_16x16x32_bf16 v[72:75], a[200:203], a[176:179], v[72:75]
 global_load_dwordx4 a[192:195], v0, s[70:71] offset:-2048 sc1
 s_add_u32 s30, s30, s21
 v_mfma_f32_16x16x32_bf16 v[68:71], a[200:203], a[168:171], v[68:71]
 v_mfma_f32_16x16x32_bf16 v[68:71], a[204:207], a[172:175], v[68:71]
 v_mfma_f32_16x16x32_bf16 v[64:67], a[204:207], a[164:167], v[64:67]
 v_mfma_f32_16x16x32_bf16 v[64:67], a[200:203], a[160:163], v[64:67]
 v_mfma_f32_16x16x32_bf16 v[60:63], a[200:203], a[152:155], v[60:63]
 v_mfma_f32_16x16x32_bf16 v[60:63], a[204:207], a[156:159], v[60:63]
 v_mfma_f32_16x16x32_bf16 v[56:59], a[204:207], a[148:151], v[56:59]
 v_mfma_f32_16x16x32_bf16 v[56:59], a[200:203], a[144:147], v[56:59]
 v_mfma_f32_16x16x32_bf16 v[52:55], a[200:203], a[136:139], v[52:55]
 v_mfma_f32_16x16x32_bf16 v[52:55], a[204:207], a[140:143], v[52:55]
 v_mfma_f32_16x16x32_bf16 v[48:51], a[204:207], a[132:135], v[48:51]
 v_mfma_f32_16x16x32_bf16 v[48:51], a[200:203], a[128:131], v[48:51]
 s_waitcnt vmcnt(8)
 v_mfma_f32_16x16x32_bf16 v[80:83], a[208:211], a[128:131], v[80:83]
 v_mfma_f32_16x16x32_bf16 v[80:83], a[212:215], a[132:135], v[80:83]
 global_load_dwordx4 a[204:207], v0, s[70:71] offset:1024 sc1
 v_mfma_f32_16x16x32_bf16 v[84:87], a[212:215], a[140:143], v[84:87]
 v_mfma_f32_16x16x32_bf16 v[84:87], a[208:211], a[136:139], v[84:87]
 global_load_dwordx4 a[200:203], v0, s[70:71] offset:0 sc1
 v_mfma_f32_16x16x32_bf16 v[88:91], a[208:211], a[144:147], v[88:91]
 v_mfma_f32_16x16x32_bf16 v[88:91], a[212:215], a[148:151], v[88:91]
 v_mfma_f32_16x16x32_bf16 v[92:95], a[212:215], a[156:159], v[92:95]
 v_mfma_f32_16x16x32_bf16 v[92:95], a[208:211], a[152:155], v[92:95]
 v_mfma_f32_16x16x32_bf16 v[96:99], a[208:211], a[160:163], v[96:99]
 v_mfma_f32_16x16x32_bf16 v[96:99], a[212:215], a[164:167], v[96:99]
 v_mfma_f32_16x16x32_bf16 v[100:103], a[212:215], a[172:175], v[100:103]
 v_mfma_f32_16x16x32_bf16 v[100:103], a[208:211], a[168:171], v[100:103]
 v_mfma_f32_16x16x32_bf16 v[104:107], a[208:211], a[176:179], v[104:107]
 v_mfma_f32_16x16x32_bf16 v[104:107], a[212:215], a[180:183], v[104:107]
 v_mfma_f32_16x16x32_bf16 v[108:111], a[212:215], a[188:191], v[108:111]
 v_mfma_f32_16x16x32_bf16 v[108:111], a[208:211], a[184:187], v[108:111]
 s_waitcnt vmcnt(8)
 v_mfma_f32_16x16x32_bf16 a[244:247], a[216:219], a[184:187], a[244:247]
 v_mfma_f32_16x16x32_bf16 a[244:247], a[220:223], a[188:191], a[244:247]
 global_load_dwordx4 a[212:215], v0, s[70:71] offset:3072 sc1
 v_mfma_f32_16x16x32_bf16 a[240:243], a[220:223], a[180:183], a[240:243]
 v_mfma_f32_16x16x32_bf16 a[240:243], a[216:219], a[176:179], a[240:243]
 global_load_dwordx4 a[208:211], v0, s[70:71] offset:2048 sc1
 v_mfma_f32_16x16x32_bf16 v[132:135], a[216:219], a[168:171], v[132:135]
 s_add_u32 s70, s70, 8192
 s_addc_u32 s71, s71, 0
 v_mfma_f32_16x16x32_bf16 v[132:135], a[220:223], a[172:175], v[132:135]
 v_mfma_f32_16x16x32_bf16 v[128:131], a[220:223], a[164:167], v[128:131]
 v_mfma_f32_16x16x32_bf16 v[128:131], a[216:219], a[160:163], v[128:131]
 v_mfma_f32_16x16x32_bf16 v[124:127], a[216:219], a[152:155], v[124:127]
 v_mfma_f32_16x16x32_bf16 v[124:127], a[220:223], a[156:159], v[124:127]
 v_mfma_f32_16x16x32_bf16 v[120:123], a[220:223], a[148:151], v[120:123]
 v_mfma_f32_16x16x32_bf16 v[120:123], a[216:219], a[144:147], v[120:123]
 buffer_load_dwordx4 v6, s[8:11], s30 offen lds
 v_mfma_f32_16x16x32_bf16 v[116:119], a[216:219], a[136:139], v[116:119]
 v_mfma_f32_16x16x32_bf16 v[116:119], a[220:223], a[140:143], v[116:119]
 v_mfma_f32_16x16x32_bf16 v[112:115], a[220:223], a[132:135], v[112:115]
 s_add_u32 m0, m0, 1024
 v_mfma_f32_16x16x32_bf16 v[112:115], a[216:219], a[128:131], v[112:115]
 s_waitcnt vmcnt(9)
 v_mfma_f32_16x16x32_bf16 v[136:139], a[224:227], a[128:131], v[136:139]
 v_mfma_f32_16x16x32_bf16 v[136:139], a[228:231], a[132:135], v[136:139]
 global_load_dwordx4 a[220:223], v0, s[70:71] offset:-3072 sc1
 v_mfma_f32_16x16x32_bf16 v[140:143], a[228:231], a[140:143], v[140:143]
 s_add_u32 s30, s30, s20
 v_mfma_f32_16x16x32_bf16 v[140:143], a[224:227], a[136:139], v[140:143]
 global_load_dwordx4 a[216:219], v0, s[70:71] offset:-4096 sc1
 v_mfma_f32_16x16x32_bf16 v[144:147], a[224:227], a[144:147], v[144:147]
 v_mfma_f32_16x16x32_bf16 v[144:147], a[228:231], a[148:151], v[144:147]
 v_mfma_f32_16x16x32_bf16 v[148:151], a[228:231], a[156:159], v[148:151]
 buffer_load_dwordx4 v6, s[8:11], s30 offen lds
 v_mfma_f32_16x16x32_bf16 v[148:151], a[224:227], a[152:155], v[148:151]
 v_mfma_f32_16x16x32_bf16 v[152:155], a[224:227], a[160:163], v[152:155]
 v_mfma_f32_16x16x32_bf16 v[152:155], a[228:231], a[164:167], v[152:155]
 s_add_u32 m0, m0, 3072
 v_mfma_f32_16x16x32_bf16 v[156:159], a[228:231], a[172:175], v[156:159]
 v_mfma_f32_16x16x32_bf16 v[156:159], a[224:227], a[168:171], v[156:159]
 v_mfma_f32_16x16x32_bf16 v[160:163], a[224:227], a[176:179], v[160:163]
 v_mfma_f32_16x16x32_bf16 v[160:163], a[228:231], a[180:183], v[160:163]
 s_add_u32 s30, s30, s21
 v_mfma_f32_16x16x32_bf16 v[164:167], a[228:231], a[188:191], v[164:167]
 v_mfma_f32_16x16x32_bf16 v[164:167], a[224:227], a[184:187], v[164:167]
 s_waitcnt vmcnt(8)
 v_mfma_f32_16x16x32_bf16 v[196:199], a[192:195], a[184:187], v[196:199]
 v_mfma_f32_16x16x32_bf16 v[196:199], a[196:199], a[188:191], v[196:199]
 global_load_dwordx4 a[228:231], v0, s[70:71] offset:-1024 sc1
 v_mfma_f32_16x16x32_bf16 v[192:195], a[196:199], a[180:183], v[192:195]
 v_mfma_f32_16x16x32_bf16 v[192:195], a[192:195], a[176:179], v[192:195]
 global_load_dwordx4 a[224:227], v0, s[70:71] offset:-2048 sc1
 v_mfma_f32_16x16x32_bf16 v[188:191], a[192:195], a[168:171], v[188:191]
 v_mfma_f32_16x16x32_bf16 v[188:191], a[196:199], a[172:175], v[188:191]
 v_mfma_f32_16x16x32_bf16 v[184:187], a[196:199], a[164:167], v[184:187]
 v_mfma_f32_16x16x32_bf16 v[184:187], a[192:195], a[160:163], v[184:187]
 v_mfma_f32_16x16x32_bf16 v[180:183], a[192:195], a[152:155], v[180:183]
 v_mfma_f32_16x16x32_bf16 v[180:183], a[196:199], a[156:159], v[180:183]
 v_mfma_f32_16x16x32_bf16 v[176:179], a[196:199], a[148:151], v[176:179]
 v_mfma_f32_16x16x32_bf16 v[176:179], a[192:195], a[144:147], v[176:179]
 v_mfma_f32_16x16x32_bf16 v[172:175], a[192:195], a[136:139], v[172:175]
 v_mfma_f32_16x16x32_bf16 v[172:175], a[196:199], a[140:143], v[172:175]
 v_mfma_f32_16x16x32_bf16 v[168:171], a[196:199], a[132:135], v[168:171]
 v_mfma_f32_16x16x32_bf16 v[168:171], a[192:195], a[128:131], v[168:171]
 s_waitcnt vmcnt(8)
 v_mfma_f32_16x16x32_bf16 v[200:203], a[200:203], a[128:131], v[200:203]
 v_mfma_f32_16x16x32_bf16 v[200:203], a[204:207], a[132:135], v[200:203]
 global_load_dwordx4 a[196:199], v0, s[70:71] offset:1024 sc1
 v_mfma_f32_16x16x32_bf16 v[204:207], a[204:207], a[140:143], v[204:207]
 v_mfma_f32_16x16x32_bf16 v[204:207], a[200:203], a[136:139], v[204:207]
 global_load_dwordx4 a[192:195], v0, s[70:71] offset:0 sc1
 v_mfma_f32_16x16x32_bf16 v[208:211], a[200:203], a[144:147], v[208:211]
 v_mfma_f32_16x16x32_bf16 v[208:211], a[204:207], a[148:151], v[208:211]
 v_mfma_f32_16x16x32_bf16 v[212:215], a[204:207], a[156:159], v[212:215]
 v_mfma_f32_16x16x32_bf16 v[212:215], a[200:203], a[152:155], v[212:215]
 v_mfma_f32_16x16x32_bf16 v[216:219], a[200:203], a[160:163], v[216:219]
 v_mfma_f32_16x16x32_bf16 v[216:219], a[204:207], a[164:167], v[216:219]
 v_mfma_f32_16x16x32_bf16 v[220:223], a[204:207], a[172:175], v[220:223]
 v_mfma_f32_16x16x32_bf16 v[220:223], a[200:203], a[168:171], v[220:223]
 v_mfma_f32_16x16x32_bf16 v[224:227], a[200:203], a[176:179], v[224:227]
 v_mfma_f32_16x16x32_bf16 v[224:227], a[204:207], a[180:183], v[224:227]
 v_mfma_f32_16x16x32_bf16 v[228:231], a[204:207], a[188:191], v[228:231]
 v_mfma_f32_16x16x32_bf16 v[228:231], a[200:203], a[184:187], v[228:231]
 buffer_load_dwordx4 v6, s[8:11], s30 offen lds
 s_waitcnt vmcnt(9)
 v_mfma_f32_16x16x32_bf16 a[252:255], a[208:211], a[184:187], a[252:255]
 ds_read_b128 a[184:187], v2 offset:28672
 v_mfma_f32_16x16x32_bf16 a[252:255], a[212:215], a[188:191], a[252:255]
 global_load_dwordx4 a[204:207], v0, s[70:71] offset:3072 sc1
 ds_read_b128 a[188:191], v2 offset:29696
 v_mfma_f32_16x16x32_bf16 a[248:251], a[212:215], a[180:183], a[248:251]
 ds_read_b128 a[180:183], v2 offset:25600
 v_mfma_f32_16x16x32_bf16 a[248:251], a[208:211], a[176:179], a[248:251]
 global_load_dwordx4 a[200:203], v0, s[70:71] offset:2048 sc1
 ds_read_b128 a[176:179], v2 offset:24576
 v_mfma_f32_16x16x32_bf16 v[252:255], a[208:211], a[168:171], v[252:255]
 s_add_u32 s70, s70, 8192
 s_addc_u32 s71, s71, 0
 ds_read_b128 a[168:171], v2 offset:20480
 v_mfma_f32_16x16x32_bf16 v[252:255], a[212:215], a[172:175], v[252:255]
 ds_read_b128 a[172:175], v2 offset:21504
 v_mfma_f32_16x16x32_bf16 v[248:251], a[212:215], a[164:167], v[248:251]
 ds_read_b128 a[164:167], v2 offset:17408
 v_mfma_f32_16x16x32_bf16 v[248:251], a[208:211], a[160:163], v[248:251]
 ds_read_b128 a[160:163], v2 offset:16384
 v_mfma_f32_16x16x32_bf16 v[244:247], a[208:211], a[152:155], v[244:247]
 ds_read_b128 a[152:155], v2 offset:12288
 v_mfma_f32_16x16x32_bf16 v[244:247], a[212:215], a[156:159], v[244:247]
 ds_read_b128 a[156:159], v2 offset:13312
 s_add_u32 m0, m0, 1024
 v_mfma_f32_16x16x32_bf16 v[240:243], a[212:215], a[148:151], v[240:243]
 ds_read_b128 a[148:151], v2 offset:9216
 v_mfma_f32_16x16x32_bf16 v[240:243], a[208:211], a[144:147], v[240:243]
 ds_read_b128 a[144:147], v2 offset:8192
 v_mfma_f32_16x16x32_bf16 v[236:239], a[208:211], a[136:139], v[236:239]
 ds_read_b128 a[136:139], v2 offset:4096
 s_add_u32 s30, s30, s20
 v_mfma_f32_16x16x32_bf16 v[236:239], a[212:215], a[140:143], v[236:239]
 ds_read_b128 a[140:143], v2 offset:5120
 v_mfma_f32_16x16x32_bf16 v[232:235], a[212:215], a[132:135], v[232:235]
 ds_read_b128 a[132:135], v2 offset:1024
 v_mfma_f32_16x16x32_bf16 v[232:235], a[208:211], a[128:131], v[232:235]
 ds_read_b128 a[128:131], v2
 s_waitcnt vmcnt(8) lgkmcnt(8)
 v_mfma_f32_16x16x32_bf16 v[44:47], a[216:219], a[184:187], v[44:47]
 buffer_load_dwordx4 v6, s[8:11], s30 offen lds
 v_mfma_f32_16x16x32_bf16 v[44:47], a[220:223], a[188:191], v[44:47]
 global_load_dwordx4 a[212:215], v0, s[70:71] offset:-3072 sc1
 v_mfma_f32_16x16x32_bf16 v[40:43], a[220:223], a[180:183], v[40:43]
 v_mfma_f32_16x16x32_bf16 v[40:43], a[216:219], a[176:179], v[40:43]
 global_load_dwordx4 a[208:211], v0, s[70:71] offset:-4096 sc1
 s_add_u32 m0, m0, 3072
 v_mfma_f32_16x16x32_bf16 v[36:39], a[216:219], a[168:171], v[36:39]
 v_mfma_f32_16x16x32_bf16 v[36:39], a[220:223], a[172:175], v[36:39]
 v_mfma_f32_16x16x32_bf16 v[32:35], a[220:223], a[164:167], v[32:35]
 v_mfma_f32_16x16x32_bf16 v[32:35], a[216:219], a[160:163], v[32:35]
 s_add_u32 s30, s30, s21
 s_waitcnt lgkmcnt(0)
 v_mfma_f32_16x16x32_bf16 v[28:31], a[216:219], a[152:155], v[28:31]
 v_mfma_f32_16x16x32_bf16 v[28:31], a[220:223], a[156:159], v[28:31]
 v_mfma_f32_16x16x32_bf16 v[24:27], a[220:223], a[148:151], v[24:27]
 v_mfma_f32_16x16x32_bf16 v[24:27], a[216:219], a[144:147], v[24:27]
 v_mfma_f32_16x16x32_bf16 v[20:23], a[216:219], a[136:139], v[20:23]
 v_mfma_f32_16x16x32_bf16 v[20:23], a[220:223], a[140:143], v[20:23]
 v_mfma_f32_16x16x32_bf16 v[16:19], a[220:223], a[132:135], v[16:19]
 v_mfma_f32_16x16x32_bf16 v[16:19], a[216:219], a[128:131], v[16:19]
 s_waitcnt vmcnt(8)
 v_mfma_f32_16x16x32_bf16 v[48:51], a[224:227], a[128:131], v[48:51]
 v_mfma_f32_16x16x32_bf16 v[48:51], a[228:231], a[132:135], v[48:51]
 global_load_dwordx4 a[220:223], v0, s[70:71] offset:-1024 sc1
 v_mfma_f32_16x16x32_bf16 v[52:55], a[228:231], a[140:143], v[52:55]
 v_mfma_f32_16x16x32_bf16 v[52:55], a[224:227], a[136:139], v[52:55]
 global_load_dwordx4 a[216:219], v0, s[70:71] offset:-2048 sc1
 v_mfma_f32_16x16x32_bf16 v[56:59], a[224:227], a[144:147], v[56:59]
 v_mfma_f32_16x16x32_bf16 v[56:59], a[228:231], a[148:151], v[56:59]
 v_mfma_f32_16x16x32_bf16 v[60:63], a[228:231], a[156:159], v[60:63]
 v_mfma_f32_16x16x32_bf16 v[60:63], a[224:227], a[152:155], v[60:63]
 v_mfma_f32_16x16x32_bf16 v[64:67], a[224:227], a[160:163], v[64:67]
 v_mfma_f32_16x16x32_bf16 v[64:67], a[228:231], a[164:167], v[64:67]
 v_mfma_f32_16x16x32_bf16 v[68:71], a[228:231], a[172:175], v[68:71]
 v_mfma_f32_16x16x32_bf16 v[68:71], a[224:227], a[168:171], v[68:71]
 v_mfma_f32_16x16x32_bf16 v[72:75], a[224:227], a[176:179], v[72:75]
 v_mfma_f32_16x16x32_bf16 v[72:75], a[228:231], a[180:183], v[72:75]
 v_mfma_f32_16x16x32_bf16 v[76:79], a[228:231], a[188:191], v[76:79]
 v_mfma_f32_16x16x32_bf16 v[76:79], a[224:227], a[184:187], v[76:79]
 s_waitcnt vmcnt(8)
 v_mfma_f32_16x16x32_bf16 v[108:111], a[192:195], a[184:187], v[108:111]
 v_mfma_f32_16x16x32_bf16 v[108:111], a[196:199], a[188:191], v[108:111]
 global_load_dwordx4 a[228:231], v0, s[70:71] offset:1024 sc1
 v_mfma_f32_16x16x32_bf16 v[104:107], a[196:199], a[180:183], v[104:107]
 v_mfma_f32_16x16x32_bf16 v[104:107], a[192:195], a[176:179], v[104:107]
 global_load_dwordx4 a[224:227], v0, s[70:71] offset:0 sc1
 v_mfma_f32_16x16x32_bf16 v[100:103], a[192:195], a[168:171], v[100:103]
 v_mfma_f32_16x16x32_bf16 v[100:103], a[196:199], a[172:175], v[100:103]
 v_mfma_f32_16x16x32_bf16 v[96:99], a[196:199], a[164:167], v[96:99]
 v_mfma_f32_16x16x32_bf16 v[96:99], a[192:195], a[160:163], v[96:99]
 v_mfma_f32_16x16x32_bf16 v[92:95], a[192:195], a[152:155], v[92:95]
 v_mfma_f32_16x16x32_bf16 v[92:95], a[196:199], a[156:159], v[92:95]
 v_mfma_f32_16x16x32_bf16 v[88:91], a[196:199], a[148:151], v[88:91]
 v_mfma_f32_16x16x32_bf16 v[88:91], a[192:195], a[144:147], v[88:91]
 v_mfma_f32_16x16x32_bf16 v[84:87], a[192:195], a[136:139], v[84:87]
 v_mfma_f32_16x16x32_bf16 v[84:87], a[196:199], a[140:143], v[84:87]
 v_mfma_f32_16x16x32_bf16 v[80:83], a[196:199], a[132:135], v[80:83]
 v_mfma_f32_16x16x32_bf16 v[80:83], a[192:195], a[128:131], v[80:83]
 buffer_load_dwordx4 v6, s[8:11], s30 offen lds
 s_waitcnt vmcnt(8)
 v_mfma_f32_16x16x32_bf16 v[112:115], a[200:203], a[128:131], v[112:115]
 v_mfma_f32_16x16x32_bf16 v[112:115], a[204:207], a[132:135], v[112:115]
 global_load_dwordx4 a[196:199], v0, s[70:71] offset:3072 sc1
 v_mfma_f32_16x16x32_bf16 v[116:119], a[204:207], a[140:143], v[116:119]
 v_mfma_f32_16x16x32_bf16 v[116:119], a[200:203], a[136:139], v[116:119]
 global_load_dwordx4 a[192:195], v0, s[70:71] offset:2048 sc1
 s_add_u32 m0, m0, 1024
 v_mfma_f32_16x16x32_bf16 v[120:123], a[200:203], a[144:147], v[120:123]
 s_add_u32 s70, s70, 8192
 s_addc_u32 s71, s71, 0
 v_mfma_f32_16x16x32_bf16 v[120:123], a[204:207], a[148:151], v[120:123]
 v_mfma_f32_16x16x32_bf16 v[124:127], a[204:207], a[156:159], v[124:127]
 s_add_u32 s30, s30, s20
 v_mfma_f32_16x16x32_bf16 v[124:127], a[200:203], a[152:155], v[124:127]
 v_mfma_f32_16x16x32_bf16 v[128:131], a[200:203], a[160:163], v[128:131]
 v_mfma_f32_16x16x32_bf16 v[128:131], a[204:207], a[164:167], v[128:131]
 v_mfma_f32_16x16x32_bf16 v[132:135], a[204:207], a[172:175], v[132:135]
 buffer_load_dwordx4 v6, s[8:11], s30 offen lds
 v_mfma_f32_16x16x32_bf16 v[132:135], a[200:203], a[168:171], v[132:135]
 v_mfma_f32_16x16x32_bf16 a[240:243], a[200:203], a[176:179], a[240:243]
 v_mfma_f32_16x16x32_bf16 a[240:243], a[204:207], a[180:183], a[240:243]
 v_mfma_f32_16x16x32_bf16 a[244:247], a[204:207], a[188:191], a[244:247]
 s_add_u32 m0, m0, 3072
 v_mfma_f32_16x16x32_bf16 a[244:247], a[200:203], a[184:187], a[244:247]
 s_waitcnt vmcnt(8)
 v_mfma_f32_16x16x32_bf16 v[164:167], a[208:211], a[184:187], v[164:167]
 v_mfma_f32_16x16x32_bf16 v[164:167], a[212:215], a[188:191], v[164:167]
 global_load_dwordx4 a[204:207], v0, s[70:71] offset:-3072 sc1
 s_add_u32 s30, s30, s21
 v_mfma_f32_16x16x32_bf16 v[160:163], a[212:215], a[180:183], v[160:163]
 v_mfma_f32_16x16x32_bf16 v[160:163], a[208:211], a[176:179], v[160:163]
 global_load_dwordx4 a[200:203], v0, s[70:71] offset:-4096 sc1
 v_mfma_f32_16x16x32_bf16 v[156:159], a[208:211], a[168:171], v[156:159]
 v_mfma_f32_16x16x32_bf16 v[156:159], a[212:215], a[172:175], v[156:159]
 v_mfma_f32_16x16x32_bf16 v[152:155], a[212:215], a[164:167], v[152:155]
 v_mfma_f32_16x16x32_bf16 v[152:155], a[208:211], a[160:163], v[152:155]
 v_mfma_f32_16x16x32_bf16 v[148:151], a[208:211], a[152:155], v[148:151]
 v_mfma_f32_16x16x32_bf16 v[148:151], a[212:215], a[156:159], v[148:151]
 v_mfma_f32_16x16x32_bf16 v[144:147], a[212:215], a[148:151], v[144:147]
 v_and_b32 v5, 768, v3
 v_mfma_f32_16x16x32_bf16 v[144:147], a[208:211], a[144:147], v[144:147]
 v_and_b32 v7, 1023, v3
 v_mfma_f32_16x16x32_bf16 v[140:143], a[208:211], a[136:139], v[140:143]
 v_mfma_f32_16x16x32_bf16 v[140:143], a[212:215], a[140:143], v[140:143]
 v_add3_u32 v5, v5, v7, s52
 v_mfma_f32_16x16x32_bf16 v[136:139], a[212:215], a[132:135], v[136:139]
 v_mfma_f32_16x16x32_bf16 v[136:139], a[208:211], a[128:131], v[136:139]
 ds_read_b64_tr_b16 v[8:9], v5 offset:0
 s_waitcnt vmcnt(8)
 v_mfma_f32_16x16x32_bf16 v[168:171], a[216:219], a[128:131], v[168:171]
 v_mfma_f32_16x16x32_bf16 v[168:171], a[220:223], a[132:135], v[168:171]
 global_load_dwordx4 a[212:215], v0, s[70:71] offset:-1024 sc1
 ds_read_b64_tr_b16 v[10:11], v5 offset:256
 v_mfma_f32_16x16x32_bf16 v[172:175], a[220:223], a[140:143], v[172:175]
 ds_read_b64_tr_b16 v[12:13], v5 offset:8
 v_mfma_f32_16x16x32_bf16 v[172:175], a[216:219], a[136:139], v[172:175]
 global_load_dwordx4 a[208:211], v0, s[70:71] offset:-2048 sc1
 ds_read_b64_tr_b16 v[14:15], v5 offset:264
 v_mfma_f32_16x16x32_bf16 v[176:179], a[216:219], a[144:147], v[176:179]
 v_mfma_f32_16x16x32_bf16 v[176:179], a[220:223], a[148:151], v[176:179]
 v_mfma_f32_16x16x32_bf16 v[180:183], a[220:223], a[156:159], v[180:183]
 v_mfma_f32_16x16x32_bf16 v[180:183], a[216:219], a[152:155], v[180:183]
 v_mfma_f32_16x16x32_bf16 v[184:187], a[216:219], a[160:163], v[184:187]
 v_mfma_f32_16x16x32_bf16 v[184:187], a[220:223], a[164:167], v[184:187]
 v_mfma_f32_16x16x32_bf16 v[188:191], a[220:223], a[172:175], v[188:191]
 v_mfma_f32_16x16x32_bf16 v[188:191], a[216:219], a[168:171], v[188:191]
 v_mfma_f32_16x16x32_bf16 v[192:195], a[216:219], a[176:179], v[192:195]
 v_mfma_f32_16x16x32_bf16 v[192:195], a[220:223], a[180:183], v[192:195]
 v_mfma_f32_16x16x32_bf16 v[196:199], a[220:223], a[188:191], v[196:199]
 v_mfma_f32_16x16x32_bf16 v[196:199], a[216:219], a[184:187], v[196:199]
 s_waitcnt vmcnt(8)
 v_mfma_f32_16x16x32_bf16 v[228:231], a[224:227], a[184:187], v[228:231]
 v_mfma_f32_16x16x32_bf16 v[228:231], a[228:231], a[188:191], v[228:231]
 global_load_dwordx4 a[220:223], v0, s[70:71] offset:1024 sc1
 v_mfma_f32_16x16x32_bf16 v[224:227], a[228:231], a[180:183], v[224:227]
 s_waitcnt lgkmcnt(2)
 v_mfma_f32_16x16x32_bf16 v[224:227], a[224:227], a[176:179], v[224:227]
 global_load_dwordx4 a[216:219], v0, s[70:71] offset:0 sc1
 v_mfma_f32_16x16x32_bf16 v[220:223], a[224:227], a[168:171], v[220:223]
 buffer_store_dwordx4 v[8:11], v7, s[12:15], s49 offen sc1
 v_mfma_f32_16x16x32_bf16 v[220:223], a[228:231], a[172:175], v[220:223]
 s_waitcnt lgkmcnt(0)
 v_mfma_f32_16x16x32_bf16 v[216:219], a[228:231], a[164:167], v[216:219]
 buffer_store_dwordx4 v[12:15], v7, s[12:15], s49 offen offset:2048 sc1
 v_mfma_f32_16x16x32_bf16 v[216:219], a[224:227], a[160:163], v[216:219]
 s_add_u32 s49, s49, 2097152
 v_mfma_f32_16x16x32_bf16 v[212:215], a[224:227], a[152:155], v[212:215]
 v_mfma_f32_16x16x32_bf16 v[212:215], a[228:231], a[156:159], v[212:215]
 buffer_load_dwordx4 v6, s[8:11], s30 offen lds
 v_mfma_f32_16x16x32_bf16 v[208:211], a[228:231], a[148:151], v[208:211]
 v_mfma_f32_16x16x32_bf16 v[208:211], a[224:227], a[144:147], v[208:211]
 v_mfma_f32_16x16x32_bf16 v[204:207], a[224:227], a[136:139], v[204:207]
 v_mfma_f32_16x16x32_bf16 v[204:207], a[228:231], a[140:143], v[204:207]
 s_add_u32 m0, m0, 1024
 v_mfma_f32_16x16x32_bf16 v[200:203], a[228:231], a[132:135], v[200:203]
 v_mfma_f32_16x16x32_bf16 v[200:203], a[224:227], a[128:131], v[200:203]
 s_add_u32 s30, s30, s20
 buffer_load_dwordx4 v6, s[8:11], s30 offen lds
 s_waitcnt vmcnt(11)
 v_mfma_f32_16x16x32_bf16 v[232:235], a[192:195], a[128:131], v[232:235]
 ds_read_b128 a[128:131], v2 offset:32768
 v_mfma_f32_16x16x32_bf16 v[232:235], a[196:199], a[132:135], v[232:235]
 global_load_dwordx4 a[228:231], v0, s[70:71] offset:3072 sc1
 ds_read_b128 a[132:135], v2 offset:33792
 v_mfma_f32_16x16x32_bf16 v[236:239], a[196:199], a[140:143], v[236:239]
 ds_read_b128 a[140:143], v2 offset:37888
 v_mfma_f32_16x16x32_bf16 v[236:239], a[192:195], a[136:139], v[236:239]
 global_load_dwordx4 a[224:227], v0, s[70:71] offset:2048 sc1
 ds_read_b128 a[136:139], v2 offset:36864
 v_mfma_f32_16x16x32_bf16 v[240:243], a[192:195], a[144:147], v[240:243]
 s_add_u32 s70, s70, 8192
 s_addc_u32 s71, s71, 0
 ds_read_b128 a[144:147], v2 offset:40960
 v_mfma_f32_16x16x32_bf16 v[240:243], a[196:199], a[148:151], v[240:243]
 ds_read_b128 a[148:151], v2 offset:41984
 v_mfma_f32_16x16x32_bf16 v[244:247], a[196:199], a[156:159], v[244:247]
 ds_read_b128 a[156:159], v2 offset:46080
 v_mfma_f32_16x16x32_bf16 v[244:247], a[192:195], a[152:155], v[244:247]
 ds_read_b128 a[152:155], v2 offset:45056
 v_mfma_f32_16x16x32_bf16 v[248:251], a[192:195], a[160:163], v[248:251]
 ds_read_b128 a[160:163], v2 offset:49152
 s_add_u32 m0, m0, 3072
 v_mfma_f32_16x16x32_bf16 v[248:251], a[196:199], a[164:167], v[248:251]
 ds_read_b128 a[164:167], v2 offset:50176
 v_mfma_f32_16x16x32_bf16 v[252:255], a[196:199], a[172:175], v[252:255]
 ds_read_b128 a[172:175], v2 offset:54272
 v_mfma_f32_16x16x32_bf16 v[252:255], a[192:195], a[168:171], v[252:255]
 ds_read_b128 a[168:171], v2 offset:53248
 s_add_u32 s30, s30, s21
 v_mfma_f32_16x16x32_bf16 a[248:251], a[192:195], a[176:179], a[248:251]
 ds_read_b128 a[176:179], v2 offset:57344
 v_mfma_f32_16x16x32_bf16 a[248:251], a[196:199], a[180:183], a[248:251]
 ds_read_b128 a[180:183], v2 offset:58368
 v_mfma_f32_16x16x32_bf16 a[252:255], a[196:199], a[188:191], a[252:255]
 ds_read_b128 a[188:191], v2 offset:62464
 v_mfma_f32_16x16x32_bf16 a[252:255], a[192:195], a[184:187], a[252:255]
 ds_read_b128 a[184:187], v2 offset:61440
 s_waitcnt vmcnt(10) lgkmcnt(8)
 v_mfma_f32_16x16x32_bf16 v[16:19], a[200:203], a[128:131], v[16:19]
 v_mfma_f32_16x16x32_bf16 v[16:19], a[204:207], a[132:135], v[16:19]
 global_load_dwordx4 a[196:199], v0, s[70:71] offset:-3072 sc1
 v_mfma_f32_16x16x32_bf16 v[20:23], a[204:207], a[140:143], v[20:23]
 v_mfma_f32_16x16x32_bf16 v[20:23], a[200:203], a[136:139], v[20:23]
 global_load_dwordx4 a[192:195], v0, s[70:71] offset:-4096 sc1
 v_mfma_f32_16x16x32_bf16 v[24:27], a[200:203], a[144:147], v[24:27]
 v_mfma_f32_16x16x32_bf16 v[24:27], a[204:207], a[148:151], v[24:27]
 v_mfma_f32_16x16x32_bf16 v[28:31], a[204:207], a[156:159], v[28:31]
 v_mfma_f32_16x16x32_bf16 v[28:31], a[200:203], a[152:155], v[28:31]
 s_waitcnt lgkmcnt(0)
 v_mfma_f32_16x16x32_bf16 v[32:35], a[200:203], a[160:163], v[32:35]
 v_mfma_f32_16x16x32_bf16 v[32:35], a[204:207], a[164:167], v[32:35]
 v_mfma_f32_16x16x32_bf16 v[36:39], a[204:207], a[172:175], v[36:39]
 v_mfma_f32_16x16x32_bf16 v[36:39], a[200:203], a[168:171], v[36:39]
 v_mfma_f32_16x16x32_bf16 v[40:43], a[200:203], a[176:179], v[40:43]
 v_mfma_f32_16x16x32_bf16 v[40:43], a[204:207], a[180:183], v[40:43]
 v_mfma_f32_16x16x32_bf16 v[44:47], a[204:207], a[188:191], v[44:47]
 v_mfma_f32_16x16x32_bf16 v[44:47], a[200:203], a[184:187], v[44:47]
 s_waitcnt vmcnt(10)
 v_mfma_f32_16x16x32_bf16 v[76:79], a[208:211], a[184:187], v[76:79]
 v_mfma_f32_16x16x32_bf16 v[76:79], a[212:215], a[188:191], v[76:79]
 global_load_dwordx4 a[204:207], v0, s[70:71] offset:-1024 sc1
 v_mfma_f32_16x16x32_bf16 v[72:75], a[212:215], a[180:183], v[72:75]
 v_mfma_f32_16x16x32_bf16 v[72:75], a[208:211], a[176:179], v[72:75]
 global_load_dwordx4 a[200:203], v0, s[70:71] offset:-2048 sc1
 v_mfma_f32_16x16x32_bf16 v[68:71], a[208:211], a[168:171], v[68:71]
 v_mfma_f32_16x16x32_bf16 v[68:71], a[212:215], a[172:175], v[68:71]
 v_mfma_f32_16x16x32_bf16 v[64:67], a[212:215], a[164:167], v[64:67]
 v_mfma_f32_16x16x32_bf16 v[64:67], a[208:211], a[160:163], v[64:67]
 v_mfma_f32_16x16x32_bf16 v[60:63], a[208:211], a[152:155], v[60:63]
 v_mfma_f32_16x16x32_bf16 v[60:63], a[212:215], a[156:159], v[60:63]
 v_mfma_f32_16x16x32_bf16 v[56:59], a[212:215], a[148:151], v[56:59]
 v_mfma_f32_16x16x32_bf16 v[56:59], a[208:211], a[144:147], v[56:59]
 v_mfma_f32_16x16x32_bf16 v[52:55], a[208:211], a[136:139], v[52:55]
 v_mfma_f32_16x16x32_bf16 v[52:55], a[212:215], a[140:143], v[52:55]
 v_mfma_f32_16x16x32_bf16 v[48:51], a[212:215], a[132:135], v[48:51]
 v_mfma_f32_16x16x32_bf16 v[48:51], a[208:211], a[128:131], v[48:51]
 s_waitcnt vmcnt(10)
 v_mfma_f32_16x16x32_bf16 v[80:83], a[216:219], a[128:131], v[80:83]
 v_mfma_f32_16x16x32_bf16 v[80:83], a[220:223], a[132:135], v[80:83]
 global_load_dwordx4 a[212:215], v0, s[70:71] offset:1024 sc1
 v_mfma_f32_16x16x32_bf16 v[84:87], a[220:223], a[140:143], v[84:87]
 v_mfma_f32_16x16x32_bf16 v[84:87], a[216:219], a[136:139], v[84:87]
 global_load_dwordx4 a[208:211], v0, s[70:71] offset:0 sc1
 v_mfma_f32_16x16x32_bf16 v[88:91], a[216:219], a[144:147], v[88:91]
 buffer_load_dwordx4 v6, s[8:11], s30 offen lds
 v_mfma_f32_16x16x32_bf16 v[88:91], a[220:223], a[148:151], v[88:91]
 v_mfma_f32_16x16x32_bf16 v[92:95], a[220:223], a[156:159], v[92:95]
 v_mfma_f32_16x16x32_bf16 v[92:95], a[216:219], a[152:155], v[92:95]
 s_add_u32 m0, m0, 1024
 v_mfma_f32_16x16x32_bf16 v[96:99], a[216:219], a[160:163], v[96:99]
 v_mfma_f32_16x16x32_bf16 v[96:99], a[220:223], a[164:167], v[96:99]
 v_mfma_f32_16x16x32_bf16 v[100:103], a[220:223], a[172:175], v[100:103]
 v_mfma_f32_16x16x32_bf16 v[100:103], a[216:219], a[168:171], v[100:103]
 s_add_u32 s30, s30, s20
 v_mfma_f32_16x16x32_bf16 v[104:107], a[216:219], a[176:179], v[104:107]
 v_mfma_f32_16x16x32_bf16 v[104:107], a[220:223], a[180:183], v[104:107]
 v_mfma_f32_16x16x32_bf16 v[108:111], a[220:223], a[188:191], v[108:111]
 buffer_load_dwordx4 v6, s[8:11], s30 offen lds
 v_mfma_f32_16x16x32_bf16 v[108:111], a[216:219], a[184:187], v[108:111]
 s_waitcnt vmcnt(8)
 v_mfma_f32_16x16x32_bf16 a[244:247], a[224:227], a[184:187], a[244:247]
 v_mfma_f32_16x16x32_bf16 a[244:247], a[228:231], a[188:191], a[244:247]
 global_load_dwordx4 a[220:223], v0, s[70:71] offset:3072 sc1
 v_mfma_f32_16x16x32_bf16 a[240:243], a[228:231], a[180:183], a[240:243]
 s_add_u32 m0, m0, 3072
 v_mfma_f32_16x16x32_bf16 a[240:243], a[224:227], a[176:179], a[240:243]
 global_load_dwordx4 a[216:219], v0, s[70:71] offset:2048 sc1
 v_mfma_f32_16x16x32_bf16 v[132:135], a[224:227], a[168:171], v[132:135]
 s_add_u32 s70, s70, 8192
 s_addc_u32 s71, s71, 0
 v_mfma_f32_16x16x32_bf16 v[132:135], a[228:231], a[172:175], v[132:135]
 v_mfma_f32_16x16x32_bf16 v[128:131], a[228:231], a[164:167], v[128:131]
 s_add_u32 s30, s30, s22
 v_mfma_f32_16x16x32_bf16 v[128:131], a[224:227], a[160:163], v[128:131]
 v_mfma_f32_16x16x32_bf16 v[124:127], a[224:227], a[152:155], v[124:127]
 v_mfma_f32_16x16x32_bf16 v[124:127], a[228:231], a[156:159], v[124:127]
 v_mfma_f32_16x16x32_bf16 v[120:123], a[228:231], a[148:151], v[120:123]
 v_mfma_f32_16x16x32_bf16 v[120:123], a[224:227], a[144:147], v[120:123]
 v_mfma_f32_16x16x32_bf16 v[116:119], a[224:227], a[136:139], v[116:119]
 v_mfma_f32_16x16x32_bf16 v[116:119], a[228:231], a[140:143], v[116:119]
 v_mfma_f32_16x16x32_bf16 v[112:115], a[228:231], a[132:135], v[112:115]
 v_mfma_f32_16x16x32_bf16 v[112:115], a[224:227], a[128:131], v[112:115]
 s_waitcnt vmcnt(8)
 v_mfma_f32_16x16x32_bf16 v[136:139], a[192:195], a[128:131], v[136:139]
 v_mfma_f32_16x16x32_bf16 v[136:139], a[196:199], a[132:135], v[136:139]
 global_load_dwordx4 a[228:231], v0, s[70:71] offset:-3072 sc1
 v_mfma_f32_16x16x32_bf16 v[140:143], a[196:199], a[140:143], v[140:143]
 v_mfma_f32_16x16x32_bf16 v[140:143], a[192:195], a[136:139], v[140:143]
 global_load_dwordx4 a[224:227], v0, s[70:71] offset:-4096 sc1
 v_mfma_f32_16x16x32_bf16 v[144:147], a[192:195], a[144:147], v[144:147]
 v_mfma_f32_16x16x32_bf16 v[144:147], a[196:199], a[148:151], v[144:147]
 global_load_dwordx4 a[236:239], v0, s[70:71] offset:-1024 sc1
 v_mfma_f32_16x16x32_bf16 v[148:151], a[196:199], a[156:159], v[148:151]
 v_mfma_f32_16x16x32_bf16 v[148:151], a[192:195], a[152:155], v[148:151]
 global_load_dwordx4 a[232:235], v0, s[70:71] offset:-2048 sc1
 v_mfma_f32_16x16x32_bf16 v[152:155], a[192:195], a[160:163], v[152:155]
 v_mfma_f32_16x16x32_bf16 v[152:155], a[196:199], a[164:167], v[152:155]
 v_mfma_f32_16x16x32_bf16 v[156:159], a[196:199], a[172:175], v[156:159]
 v_mfma_f32_16x16x32_bf16 v[156:159], a[192:195], a[168:171], v[156:159]
 v_mfma_f32_16x16x32_bf16 v[160:163], a[192:195], a[176:179], v[160:163]
 v_mfma_f32_16x16x32_bf16 v[160:163], a[196:199], a[180:183], v[160:163]
 v_mfma_f32_16x16x32_bf16 v[164:167], a[196:199], a[188:191], v[164:167]
 v_mfma_f32_16x16x32_bf16 v[164:167], a[192:195], a[184:187], v[164:167]
 s_waitcnt vmcnt(10)
 v_mfma_f32_16x16x32_bf16 v[196:199], a[200:203], a[184:187], v[196:199]
 v_mfma_f32_16x16x32_bf16 v[196:199], a[204:207], a[188:191], v[196:199]
 global_load_dwordx4 a[196:199], v0, s[70:71] offset:1024 sc1
 v_mfma_f32_16x16x32_bf16 v[192:195], a[204:207], a[180:183], v[192:195]
 v_mfma_f32_16x16x32_bf16 v[192:195], a[200:203], a[176:179], v[192:195]
 global_load_dwordx4 a[192:195], v0, s[70:71] offset:0 sc1
 v_mfma_f32_16x16x32_bf16 v[188:191], a[200:203], a[168:171], v[188:191]
 v_mfma_f32_16x16x32_bf16 v[188:191], a[204:207], a[172:175], v[188:191]
 v_mfma_f32_16x16x32_bf16 v[184:187], a[204:207], a[164:167], v[184:187]
 v_mfma_f32_16x16x32_bf16 v[184:187], a[200:203], a[160:163], v[184:187]
 v_mfma_f32_16x16x32_bf16 v[180:183], a[200:203], a[152:155], v[180:183]
 v_mfma_f32_16x16x32_bf16 v[180:183], a[204:207], a[156:159], v[180:183]
 v_mfma_f32_16x16x32_bf16 v[176:179], a[204:207], a[148:151], v[176:179]
 v_mfma_f32_16x16x32_bf16 v[176:179], a[200:203], a[144:147], v[176:179]
 v_mfma_f32_16x16x32_bf16 v[172:175], a[200:203], a[136:139], v[172:175]
 v_mfma_f32_16x16x32_bf16 v[172:175], a[204:207], a[140:143], v[172:175]
 v_mfma_f32_16x16x32_bf16 v[168:171], a[204:207], a[132:135], v[168:171]
 v_mfma_f32_16x16x32_bf16 v[168:171], a[200:203], a[128:131], v[168:171]
 s_waitcnt vmcnt(10)
 v_mfma_f32_16x16x32_bf16 v[200:203], a[208:211], a[128:131], v[200:203]
 v_mfma_f32_16x16x32_bf16 v[200:203], a[212:215], a[132:135], v[200:203]
 global_load_dwordx4 a[204:207], v0, s[70:71] offset:3072 sc1
 v_mfma_f32_16x16x32_bf16 v[204:207], a[212:215], a[140:143], v[204:207]
 v_mfma_f32_16x16x32_bf16 v[204:207], a[208:211], a[136:139], v[204:207]
 global_load_dwordx4 a[200:203], v0, s[70:71] offset:2048 sc1
 v_mfma_f32_16x16x32_bf16 v[208:211], a[208:211], a[144:147], v[208:211]
 s_add_u32 s70, s70, 8192
 s_addc_u32 s71, s71, 0
 v_mfma_f32_16x16x32_bf16 v[208:211], a[212:215], a[148:151], v[208:211]
 v_mfma_f32_16x16x32_bf16 v[212:215], a[212:215], a[156:159], v[212:215]
 v_mfma_f32_16x16x32_bf16 v[212:215], a[208:211], a[152:155], v[212:215]
 v_mfma_f32_16x16x32_bf16 v[216:219], a[208:211], a[160:163], v[216:219]
 v_mfma_f32_16x16x32_bf16 v[216:219], a[212:215], a[164:167], v[216:219]
 v_mfma_f32_16x16x32_bf16 v[220:223], a[212:215], a[172:175], v[220:223]
 s_waitcnt vmcnt(10)
 s_waitcnt lgkmcnt(0)
 s_barrier
 v_mfma_f32_16x16x32_bf16 v[220:223], a[208:211], a[168:171], v[220:223]
 v_mfma_f32_16x16x32_bf16 v[224:227], a[208:211], a[176:179], v[224:227]
 v_mfma_f32_16x16x32_bf16 v[224:227], a[212:215], a[180:183], v[224:227]
 v_mfma_f32_16x16x32_bf16 v[228:231], a[212:215], a[188:191], v[228:231]
 v_mfma_f32_16x16x32_bf16 v[228:231], a[208:211], a[184:187], v[228:231]
 s_waitcnt vmcnt(8)
 v_mfma_f32_16x16x32_bf16 a[252:255], a[216:219], a[184:187], a[252:255]
 ds_read_b128 a[184:187], v1 offset:30720
 v_mfma_f32_16x16x32_bf16 a[252:255], a[220:223], a[188:191], a[252:255]
 global_load_dwordx4 a[212:215], v0, s[70:71] offset:-3072 sc1
 ds_read_b128 a[188:191], v1 offset:31744
 v_mfma_f32_16x16x32_bf16 a[248:251], a[220:223], a[180:183], a[248:251]
 ds_read_b128 a[180:183], v1 offset:27648
 v_mfma_f32_16x16x32_bf16 a[248:251], a[216:219], a[176:179], a[248:251]
 global_load_dwordx4 a[208:211], v0, s[70:71] offset:-4096 sc1
 ds_read_b128 a[176:179], v1 offset:26624
 v_mfma_f32_16x16x32_bf16 v[252:255], a[216:219], a[168:171], v[252:255]
 ds_read_b128 a[168:171], v1 offset:22528
 v_mfma_f32_16x16x32_bf16 v[252:255], a[220:223], a[172:175], v[252:255]
 ds_read_b128 a[172:175], v1 offset:23552
 v_mfma_f32_16x16x32_bf16 v[248:251], a[220:223], a[164:167], v[248:251]
 ds_read_b128 a[164:167], v1 offset:19456
 v_mfma_f32_16x16x32_bf16 v[248:251], a[216:219], a[160:163], v[248:251]
 ds_read_b128 a[160:163], v1 offset:18432
 v_mfma_f32_16x16x32_bf16 v[244:247], a[216:219], a[152:155], v[244:247]
 ds_read_b128 a[152:155], v1 offset:14336
 v_mfma_f32_16x16x32_bf16 v[244:247], a[220:223], a[156:159], v[244:247]
 ds_read_b128 a[156:159], v1 offset:15360
 v_mfma_f32_16x16x32_bf16 v[240:243], a[220:223], a[148:151], v[240:243]
 ds_read_b128 a[148:151], v1 offset:11264
 v_mfma_f32_16x16x32_bf16 v[240:243], a[216:219], a[144:147], v[240:243]
 ds_read_b128 a[144:147], v1 offset:10240
 v_mfma_f32_16x16x32_bf16 v[236:239], a[216:219], a[136:139], v[236:239]
 ds_read_b128 a[136:139], v1 offset:6144
 v_mfma_f32_16x16x32_bf16 v[236:239], a[220:223], a[140:143], v[236:239]
 ds_read_b128 a[140:143], v1 offset:7168
 v_mfma_f32_16x16x32_bf16 v[232:235], a[220:223], a[132:135], v[232:235]
 global_load_dwordx4 a[220:223], v0, s[70:71] offset:-1024 sc1
 ds_read_b128 a[132:135], v1 offset:3072
 v_mfma_f32_16x16x32_bf16 v[232:235], a[216:219], a[128:131], v[232:235]
 global_load_dwordx4 a[216:219], v0, s[70:71] offset:-2048 sc1
 ds_read_b128 a[128:131], v1 offset:2048
 s_waitcnt vmcnt(10) lgkmcnt(8)
 v_mfma_f32_16x16x32_bf16 v[44:47], a[224:227], a[184:187], v[44:47]
 v_mov_b32 v7, 1
 v_mfma_f32_16x16x32_bf16 v[44:47], a[228:231], a[188:191], v[44:47]
 v_mfma_f32_16x16x32_bf16 v[40:43], a[228:231], a[180:183], v[40:43]
 buffer_atomic_add v7, v0, s[56:59], 0 offen sc1
 v_mfma_f32_16x16x32_bf16 v[40:43], a[224:227], a[176:179], v[40:43]
 v_bfe_u32 v4, v3, 8, 2
 v_mfma_f32_16x16x32_bf16 v[36:39], a[224:227], a[168:171], v[36:39]
 v_mfma_f32_16x16x32_bf16 v[36:39], a[228:231], a[172:175], v[36:39]
 v_lshl_add_u32 v4, v4, 5, s51
 v_mfma_f32_16x16x32_bf16 v[32:35], a[228:231], a[164:167], v[32:35]
 ds_read_b128 v[8:11], v4 offset:256
 v_mfma_f32_16x16x32_bf16 v[32:35], a[224:227], a[160:163], v[32:35]
 s_waitcnt lgkmcnt(1)
 v_mfma_f32_16x16x32_bf16 v[28:31], a[224:227], a[152:155], v[28:31]
 v_mfma_f32_16x16x32_bf16 v[28:31], a[228:231], a[156:159], v[28:31]
 v_mfma_f32_16x16x32_bf16 v[24:27], a[228:231], a[148:151], v[24:27]
 v_mfma_f32_16x16x32_bf16 v[24:27], a[224:227], a[144:147], v[24:27]
 v_mfma_f32_16x16x32_bf16 v[20:23], a[224:227], a[136:139], v[20:23]
 v_mfma_f32_16x16x32_bf16 v[20:23], a[228:231], a[140:143], v[20:23]
 v_mfma_f32_16x16x32_bf16 v[16:19], a[228:231], a[132:135], v[16:19]
 v_mfma_f32_16x16x32_bf16 v[16:19], a[224:227], a[128:131], v[16:19]
 s_waitcnt vmcnt(9)
 v_mfma_f32_16x16x32_bf16 v[48:51], a[232:235], a[128:131], v[48:51]
 v_mfma_f32_16x16x32_bf16 v[48:51], a[236:239], a[132:135], v[48:51]
 global_load_dwordx4 a[228:231], v0, s[70:71] offset:1024 sc1
 v_mfma_f32_16x16x32_bf16 v[52:55], a[236:239], a[140:143], v[52:55]
 v_mfma_f32_16x16x32_bf16 v[52:55], a[232:235], a[136:139], v[52:55]
 global_load_dwordx4 a[224:227], v0, s[70:71] offset:0 sc1
 v_mfma_f32_16x16x32_bf16 v[56:59], a[232:235], a[144:147], v[56:59]
 s_waitcnt lgkmcnt(0)
 v_mfma_f32_16x16x32_bf16 v[56:59], a[236:239], a[148:151], v[56:59]
 v_mfma_f32_16x16x32_bf16 v[60:63], a[236:239], a[156:159], v[60:63]
 v_add_f32 v136, v136, v8
 v_mfma_f32_16x16x32_bf16 v[60:63], a[232:235], a[152:155], v[60:63]
 v_mfma_f32_16x16x32_bf16 v[64:67], a[232:235], a[160:163], v[64:67]
 ds_read_b128 v[12:15], v4 offset:272
 v_mfma_f32_16x16x32_bf16 v[64:67], a[236:239], a[164:167], v[64:67]
 v_add_f32 v137, v137, v9
 v_mfma_f32_16x16x32_bf16 v[68:71], a[236:239], a[172:175], v[68:71]
 v_mfma_f32_16x16x32_bf16 v[68:71], a[232:235], a[168:171], v[68:71]
 v_add_f32 v138, v138, v10
 v_mfma_f32_16x16x32_bf16 v[72:75], a[232:235], a[176:179], v[72:75]
 v_add_f32 v139, v139, v11
 v_mfma_f32_16x16x32_bf16 v[72:75], a[236:239], a[180:183], v[72:75]
 v_mfma_f32_16x16x32_bf16 v[76:79], a[236:239], a[188:191], v[76:79]
 v_add_f32 v140, v140, v8
 v_mfma_f32_16x16x32_bf16 v[76:79], a[232:235], a[184:187], v[76:79]
 v_add_f32 v141, v141, v9
 s_waitcnt vmcnt(9)
 v_mfma_f32_16x16x32_bf16 v[108:111], a[192:195], a[184:187], v[108:111]
 v_mfma_f32_16x16x32_bf16 v[108:111], a[196:199], a[188:191], v[108:111]
 global_load_dwordx4 a[236:239], v0, s[70:71] offset:3072 sc1
 v_add_f32 v142, v142, v10
 v_mfma_f32_16x16x32_bf16 v[104:107], a[196:199], a[180:183], v[104:107]
 v_add_f32 v143, v143, v11
 v_mfma_f32_16x16x32_bf16 v[104:107], a[192:195], a[176:179], v[104:107]
 global_load_dwordx4 a[232:235], v0, s[70:71] offset:2048 sc1
 v_mfma_f32_16x16x32_bf16 v[100:103], a[192:195], a[168:171], v[100:103]
 v_add_f32 v144, v144, v8
 s_add_u32 s70, s70, 8192
 s_addc_u32 s71, s71, 0
 v_mfma_f32_16x16x32_bf16 v[100:103], a[196:199], a[172:175], v[100:103]
 v_mfma_f32_16x16x32_bf16 v[96:99], a[196:199], a[164:167], v[96:99]
 v_add_f32 v145, v145, v9
 v_mfma_f32_16x16x32_bf16 v[96:99], a[192:195], a[160:163], v[96:99]
 v_add_f32 v146, v146, v10
 v_mfma_f32_16x16x32_bf16 v[92:95], a[192:195], a[152:155], v[92:95]
 v_mfma_f32_16x16x32_bf16 v[92:95], a[196:199], a[156:159], v[92:95]
 v_add_f32 v147, v147, v11
 v_mfma_f32_16x16x32_bf16 v[88:91], a[196:199], a[148:151], v[88:91]
 v_add_f32 v148, v148, v8
 v_mfma_f32_16x16x32_bf16 v[88:91], a[192:195], a[144:147], v[88:91]
 v_mfma_f32_16x16x32_bf16 v[84:87], a[192:195], a[136:139], v[84:87]
 v_add_f32 v149, v149, v9
 v_mfma_f32_16x16x32_bf16 v[84:87], a[196:199], a[140:143], v[84:87]
 v_add_f32 v150, v150, v10
 v_mfma_f32_16x16x32_bf16 v[80:83], a[196:199], a[132:135], v[80:83]
 v_mfma_f32_16x16x32_bf16 v[80:83], a[192:195], a[128:131], v[80:83]
 v_add_f32 v151, v151, v11
 s_waitcnt vmcnt(9)
 v_mfma_f32_16x16x32_bf16 v[112:115], a[200:203], a[128:131], v[112:115]
 ds_read_b128 a[128:131], v1 offset:34816
 v_add_f32 v152, v152, v8
 v_mfma_f32_16x16x32_bf16 v[112:115], a[204:207], a[132:135], v[112:115]
 global_load_dwordx4 a[196:199], v0, s[70:71] offset:-3072 sc1
 ds_read_b128 a[132:135], v1 offset:35840
 v_mfma_f32_16x16x32_bf16 v[116:119], a[204:207], a[140:143], v[116:119]
 ds_read_b128 a[140:143], v1 offset:39936
 v_add_f32 v153, v153, v9
 v_mfma_f32_16x16x32_bf16 v[116:119], a[200:203], a[136:139], v[116:119]
 global_load_dwordx4 a[192:195], v0, s[70:71] offset:-4096 sc1
 ds_read_b128 a[136:139], v1 offset:38912
 v_mfma_f32_16x16x32_bf16 v[120:123], a[200:203], a[144:147], v[120:123]
 ds_read_b128 a[144:147], v1 offset:43008
 v_add_f32 v154, v154, v10
 v_mfma_f32_16x16x32_bf16 v[120:123], a[204:207], a[148:151], v[120:123]
 ds_read_b128 a[148:151], v1 offset:44032
 v_add_f32 v155, v155, v11
 v_mfma_f32_16x16x32_bf16 v[124:127], a[204:207], a[156:159], v[124:127]
 ds_read_b128 a[156:159], v1 offset:48128
 v_mfma_f32_16x16x32_bf16 v[124:127], a[200:203], a[152:155], v[124:127]
 ds_read_b128 a[152:155], v1 offset:47104
 v_add_f32 v156, v156, v8
 v_mfma_f32_16x16x32_bf16 v[128:131], a[200:203], a[160:163], v[128:131]
 ds_read_b128 a[160:163], v1 offset:51200
 v_add_f32 v157, v157, v9
 v_mfma_f32_16x16x32_bf16 v[128:131], a[204:207], a[164:167], v[128:131]
 ds_read_b128 a[164:167], v1 offset:52224
 v_mfma_f32_16x16x32_bf16 v[132:135], a[204:207], a[172:175], v[132:135]
 ds_read_b128 a[172:175], v1 offset:56320
 v_add_f32 v158, v158, v10
 v_mfma_f32_16x16x32_bf16 v[132:135], a[200:203], a[168:171], v[132:135]
 ds_read_b128 a[168:171], v1 offset:55296
 v_add_f32 v159, v159, v11
 v_mfma_f32_16x16x32_bf16 a[240:243], a[200:203], a[176:179], a[240:243]
 ds_read_b128 a[176:179], v1 offset:59392
 v_mfma_f32_16x16x32_bf16 a[240:243], a[204:207], a[180:183], a[240:243]
 ds_read_b128 a[180:183], v1 offset:60416
 v_add_f32 v160, v160, v8
 v_mfma_f32_16x16x32_bf16 a[244:247], a[204:207], a[188:191], a[244:247]
 ds_read_b128 a[188:191], v1 offset:64512
 v_add_f32 v161, v161, v9
 v_mfma_f32_16x16x32_bf16 a[244:247], a[200:203], a[184:187], a[244:247]
 ds_read_b128 a[184:187], v1 offset:63488
 s_waitcnt vmcnt(9) lgkmcnt(8)
 v_mfma_f32_16x16x32_bf16 v[16:19], a[208:211], a[128:131], v[16:19]
 v_add_f32 v162, v162, v10
 v_mfma_f32_16x16x32_bf16 v[16:19], a[212:215], a[132:135], v[16:19]
 global_load_dwordx4 a[204:207], v0, s[70:71] offset:-1024 sc1
 v_mfma_f32_16x16x32_bf16 v[20:23], a[212:215], a[140:143], v[20:23]
 v_add_f32 v163, v163, v11
 v_mfma_f32_16x16x32_bf16 v[20:23], a[208:211], a[136:139], v[20:23]
 global_load_dwordx4 a[200:203], v0, s[70:71] offset:-2048 sc1
 v_add_f32 v164, v164, v8
 v_mfma_f32_16x16x32_bf16 v[24:27], a[208:211], a[144:147], v[24:27]
 v_mfma_f32_16x16x32_bf16 v[24:27], a[212:215], a[148:151], v[24:27]
 v_add_f32 v165, v165, v9
 v_mfma_f32_16x16x32_bf16 v[28:31], a[212:215], a[156:159], v[28:31]
 v_add_f32 v166, v166, v10
 v_mfma_f32_16x16x32_bf16 v[28:31], a[208:211], a[152:155], v[28:31]
 s_waitcnt lgkmcnt(0)
 v_mfma_f32_16x16x32_bf16 v[32:35], a[208:211], a[160:163], v[32:35]
 v_add_f32 v167, v167, v11
 v_mfma_f32_16x16x32_bf16 v[32:35], a[212:215], a[164:167], v[32:35]
 v_mfma_f32_16x16x32_bf16 v[36:39], a[212:215], a[172:175], v[36:39]
 v_mfma_f32_16x16x32_bf16 v[36:39], a[208:211], a[168:171], v[36:39]
 v_add_f32 v168, v168, v12
 v_mfma_f32_16x16x32_bf16 v[40:43], a[208:211], a[176:179], v[40:43]
 ds_read_b128 v[8:11], v4 offset:384
 v_mfma_f32_16x16x32_bf16 v[40:43], a[212:215], a[180:183], v[40:43]
 v_mfma_f32_16x16x32_bf16 v[44:47], a[212:215], a[188:191], v[44:47]
 v_add_f32 v169, v169, v13
 v_mfma_f32_16x16x32_bf16 v[44:47], a[208:211], a[184:187], v[44:47]
 s_waitcnt vmcnt(9)
 v_mfma_f32_16x16x32_bf16 v[76:79], a[216:219], a[184:187], v[76:79]
 v_add_f32 v170, v170, v14
 v_mfma_f32_16x16x32_bf16 v[76:79], a[220:223], a[188:191], v[76:79]
 global_load_dwordx4 a[212:215], v0, s[70:71] offset:1024 sc1
 v_add_f32 v171, v171, v15
 v_mfma_f32_16x16x32_bf16 v[72:75], a[220:223], a[180:183], v[72:75]
 v_mfma_f32_16x16x32_bf16 v[72:75], a[216:219], a[176:179], v[72:75]
 global_load_dwordx4 a[208:211], v0, s[70:71] offset:0 sc1
 v_add_f32 v172, v172, v12
 v_mfma_f32_16x16x32_bf16 v[68:71], a[216:219], a[168:171], v[68:71]
 v_add_f32 v173, v173, v13
 v_mfma_f32_16x16x32_bf16 v[68:71], a[220:223], a[172:175], v[68:71]
 v_mfma_f32_16x16x32_bf16 v[64:67], a[220:223], a[164:167], v[64:67]
 v_add_f32 v174, v174, v14
 v_mfma_f32_16x16x32_bf16 v[64:67], a[216:219], a[160:163], v[64:67]
 v_add_f32 v175, v175, v15
 v_mfma_f32_16x16x32_bf16 v[60:63], a[216:219], a[152:155], v[60:63]
 v_mfma_f32_16x16x32_bf16 v[60:63], a[220:223], a[156:159], v[60:63]
 v_add_f32 v176, v176, v12
 v_mfma_f32_16x16x32_bf16 v[56:59], a[220:223], a[148:151], v[56:59]
 v_add_f32 v177, v177, v13
 v_mfma_f32_16x16x32_bf16 v[56:59], a[216:219], a[144:147], v[56:59]
 v_mfma_f32_16x16x32_bf16 v[52:55], a[216:219], a[136:139], v[52:55]
 v_add_f32 v178, v178, v14
 v_mfma_f32_16x16x32_bf16 v[52:55], a[220:223], a[140:143], v[52:55]
 v_mfma_f32_16x16x32_bf16 v[48:51], a[220:223], a[132:135], v[48:51]
 v_add_f32 v179, v179, v15
 v_mfma_f32_16x16x32_bf16 v[48:51], a[216:219], a[128:131], v[48:51]
 v_add_f32 v180, v180, v12
 s_waitcnt vmcnt(8)
 v_mfma_f32_16x16x32_bf16 v[80:83], a[224:227], a[128:131], v[80:83]
 v_mfma_f32_16x16x32_bf16 v[80:83], a[228:231], a[132:135], v[80:83]
 global_load_dwordx4 a[220:223], v0, s[70:71] offset:3072 sc1
 v_add_f32 v181, v181, v13
 v_mfma_f32_16x16x32_bf16 v[84:87], a[228:231], a[140:143], v[84:87]
 v_add_f32 v182, v182, v14
 v_mfma_f32_16x16x32_bf16 v[84:87], a[224:227], a[136:139], v[84:87]
 global_load_dwordx4 a[216:219], v0, s[70:71] offset:2048 sc1
 v_mfma_f32_16x16x32_bf16 v[88:91], a[224:227], a[144:147], v[88:91]
 v_add_f32 v183, v183, v15
 s_add_u32 s70, s70, 8192
 s_addc_u32 s71, s71, 0
 v_mfma_f32_16x16x32_bf16 v[88:91], a[228:231], a[148:151], v[88:91]
 v_add_f32 v184, v184, v12
 v_mfma_f32_16x16x32_bf16 v[92:95], a[228:231], a[156:159], v[92:95]
 v_mfma_f32_16x16x32_bf16 v[92:95], a[224:227], a[152:155], v[92:95]
 v_add_f32 v185, v185, v13
 v_mfma_f32_16x16x32_bf16 v[96:99], a[224:227], a[160:163], v[96:99]
 v_add_f32 v186, v186, v14
 v_mfma_f32_16x16x32_bf16 v[96:99], a[228:231], a[164:167], v[96:99]
 v_mfma_f32_16x16x32_bf16 v[100:103], a[228:231], a[172:175], v[100:103]
 v_add_f32 v187, v187, v15
 v_mfma_f32_16x16x32_bf16 v[100:103], a[224:227], a[168:171], v[100:103]
 v_mfma_f32_16x16x32_bf16 v[104:107], a[224:227], a[176:179], v[104:107]
 v_add_f32 v188, v188, v12
 v_mfma_f32_16x16x32_bf16 v[104:107], a[228:231], a[180:183], v[104:107]
 v_add_f32 v189, v189, v13
 v_mfma_f32_16x16x32_bf16 v[108:111], a[228:231], a[188:191], v[108:111]
 v_mfma_f32_16x16x32_bf16 v[108:111], a[224:227], a[184:187], v[108:111]
 v_add_f32 v190, v190, v14
 s_waitcnt vmcnt(8)
 v_mfma_f32_16x16x32_bf16 a[244:247], a[232:235], a[184:187], a[244:247]
 ds_read_b128 a[184:187], v2 offset:30720
 v_add_f32 v191, v191, v15
 v_mfma_f32_16x16x32_bf16 a[244:247], a[236:239], a[188:191], a[244:247]
 global_load_dwordx4 a[228:231], v0, s[70:71] offset:-3072 sc1
 ds_read_b128 a[188:191], v2 offset:31744
 v_mfma_f32_16x16x32_bf16 a[240:243], a[236:239], a[180:183], a[240:243]
 ds_read_b128 a[180:183], v2 offset:27648
 v_add_f32 v192, v192, v12
 v_mfma_f32_16x16x32_bf16 a[240:243], a[232:235], a[176:179], a[240:243]
 global_load_dwordx4 a[224:227], v0, s[70:71] offset:-4096 sc1
 ds_read_b128 a[176:179], v2 offset:26624
 v_mfma_f32_16x16x32_bf16 v[132:135], a[232:235], a[168:171], v[132:135]
 ds_read_b128 a[168:171], v2 offset:22528
 v_add_f32 v193, v193, v13
 v_mfma_f32_16x16x32_bf16 v[132:135], a[236:239], a[172:175], v[132:135]
 ds_read_b128 a[172:175], v2 offset:23552
 v_add_f32 v194, v194, v14
 v_mfma_f32_16x16x32_bf16 v[128:131], a[236:239], a[164:167], v[128:131]
 ds_read_b128 a[164:167], v2 offset:19456
 v_add_f32 v195, v195, v15
 v_mfma_f32_16x16x32_bf16 v[128:131], a[232:235], a[160:163], v[128:131]
 ds_read_b128 a[160:163], v2 offset:18432
 v_mfma_f32_16x16x32_bf16 v[124:127], a[232:235], a[152:155], v[124:127]
 ds_read_b128 a[152:155], v2 offset:14336
 v_add_f32 v196, v196, v12
 v_mfma_f32_16x16x32_bf16 v[124:127], a[236:239], a[156:159], v[124:127]
 ds_read_b128 a[156:159], v2 offset:15360
 v_mfma_f32_16x16x32_bf16 v[120:123], a[236:239], a[148:151], v[120:123]
 ds_read_b128 a[148:151], v2 offset:11264
 v_add_f32 v197, v197, v13
 v_mfma_f32_16x16x32_bf16 v[120:123], a[232:235], a[144:147], v[120:123]
 ds_read_b128 a[144:147], v2 offset:10240
 v_add_f32 v198, v198, v14
 v_mfma_f32_16x16x32_bf16 v[116:119], a[232:235], a[136:139], v[116:119]
 ds_read_b128 a[136:139], v2 offset:6144
 v_mfma_f32_16x16x32_bf16 v[116:119], a[236:239], a[140:143], v[116:119]
 ds_read_b128 a[140:143], v2 offset:7168
 v_add_f32 v199, v199, v15
 v_mfma_f32_16x16x32_bf16 v[112:115], a[236:239], a[132:135], v[112:115]
 ds_read_b128 a[132:135], v2 offset:3072
 s_waitcnt lgkmcnt(15)
 v_mfma_f32_16x16x32_bf16 v[112:115], a[232:235], a[128:131], v[112:115]
 ds_read_b128 a[128:131], v2 offset:2048
 s_waitcnt vmcnt(8) lgkmcnt(8)
 v_mfma_f32_16x16x32_bf16 v[44:47], a[192:195], a[184:187], v[44:47]
 v_add_f32 v200, v200, v8
 v_mfma_f32_16x16x32_bf16 v[44:47], a[196:199], a[188:191], v[44:47]
 global_load_dwordx4 a[236:239], v0, s[70:71] offset:-1024 sc1
 ds_read_b128 v[12:15], v4 offset:400
 v_mfma_f32_16x16x32_bf16 v[40:43], a[196:199], a[180:183], v[40:43]
 v_mfma_f32_16x16x32_bf16 v[40:43], a[192:195], a[176:179], v[40:43]
 global_load_dwordx4 a[232:235], v0, s[70:71] offset:-2048 sc1
 v_add_f32 v201, v201, v9
 v_mfma_f32_16x16x32_bf16 v[36:39], a[192:195], a[168:171], v[36:39]
 v_add_f32 v202, v202, v10
 v_mfma_f32_16x16x32_bf16 v[36:39], a[196:199], a[172:175], v[36:39]
 v_mfma_f32_16x16x32_bf16 v[32:35], a[196:199], a[164:167], v[32:35]
 v_add_f32 v203, v203, v11
 v_mfma_f32_16x16x32_bf16 v[32:35], a[192:195], a[160:163], v[32:35]
 s_waitcnt lgkmcnt(1)
 v_mfma_f32_16x16x32_bf16 v[28:31], a[192:195], a[152:155], v[28:31]
 v_add_f32 v204, v204, v8
 v_mfma_f32_16x16x32_bf16 v[28:31], a[196:199], a[156:159], v[28:31]
 v_add_f32 v205, v205, v9
 v_mfma_f32_16x16x32_bf16 v[24:27], a[196:199], a[148:151], v[24:27]
 v_mfma_f32_16x16x32_bf16 v[24:27], a[192:195], a[144:147], v[24:27]
 v_add_f32 v206, v206, v10
 v_mfma_f32_16x16x32_bf16 v[20:23], a[192:195], a[136:139], v[20:23]
 v_add_f32 v207, v207, v11
 v_mfma_f32_16x16x32_bf16 v[20:23], a[196:199], a[140:143], v[20:23]
 v_mfma_f32_16x16x32_bf16 v[16:19], a[196:199], a[132:135], v[16:19]
 v_add_f32 v208, v208, v8
 v_mfma_f32_16x16x32_bf16 v[16:19], a[192:195], a[128:131], v[16:19]
 v_add_f32 v209, v209, v9
 s_waitcnt vmcnt(8)
 v_mfma_f32_16x16x32_bf16 v[48:51], a[200:203], a[128:131], v[48:51]
 v_mfma_f32_16x16x32_bf16 v[48:51], a[204:207], a[132:135], v[48:51]
 global_load_dwordx4 a[196:199], v0, s[70:71] offset:1024 sc1
 v_add_f32 v210, v210, v10
 v_mfma_f32_16x16x32_bf16 v[52:55], a[204:207], a[140:143], v[52:55]
 v_add_f32 v211, v211, v11
 v_mfma_f32_16x16x32_bf16 v[52:55], a[200:203], a[136:139], v[52:55]
 global_load_dwordx4 a[192:195], v0, s[70:71] offset:0 sc1
 v_mfma_f32_16x16x32_bf16 v[56:59], a[200:203], a[144:147], v[56:59]
 v_add_f32 v212, v212, v8
 v_mfma_f32_16x16x32_bf16 v[56:59], a[204:207], a[148:151], v[56:59]
 v_mfma_f32_16x16x32_bf16 v[60:63], a[204:207], a[156:159], v[60:63]
 v_add_f32 v213, v213, v9
 v_mfma_f32_16x16x32_bf16 v[60:63], a[200:203], a[152:155], v[60:63]
 v_add_f32 v214, v214, v10
 v_mfma_f32_16x16x32_bf16 v[64:67], a[200:203], a[160:163], v[64:67]
 v_mfma_f32_16x16x32_bf16 v[64:67], a[204:207], a[164:167], v[64:67]
 v_add_f32 v215, v215, v11
 v_mfma_f32_16x16x32_bf16 v[68:71], a[204:207], a[172:175], v[68:71]
 v_add_f32 v216, v216, v8
 v_mfma_f32_16x16x32_bf16 v[68:71], a[200:203], a[168:171], v[68:71]
 v_mfma_f32_16x16x32_bf16 v[72:75], a[200:203], a[176:179], v[72:75]
 v_add_f32 v217, v217, v9
 v_mfma_f32_16x16x32_bf16 v[72:75], a[204:207], a[180:183], v[72:75]
 v_add_f32 v218, v218, v10
 v_mfma_f32_16x16x32_bf16 v[76:79], a[204:207], a[188:191], v[76:79]
 v_mfma_f32_16x16x32_bf16 v[76:79], a[200:203], a[184:187], v[76:79]
 v_add_f32 v219, v219, v11
 s_waitcnt vmcnt(8)
 v_mfma_f32_16x16x32_bf16 v[108:111], a[208:211], a[184:187], v[108:111]
 v_add_f32 v220, v220, v8
 v_mfma_f32_16x16x32_bf16 v[108:111], a[212:215], a[188:191], v[108:111]
 global_load_dwordx4 a[204:207], v0, s[70:71] offset:3072 sc1
 v_mfma_f32_16x16x32_bf16 v[104:107], a[212:215], a[180:183], v[104:107]
 v_add_f32 v221, v221, v9
 v_mfma_f32_16x16x32_bf16 v[104:107], a[208:211], a[176:179], v[104:107]
 global_load_dwordx4 a[200:203], v0, s[70:71] offset:2048 sc1
 v_mfma_f32_16x16x32_bf16 v[100:103], a[208:211], a[168:171], v[100:103]
 v_add_f32 v222, v222, v10
 s_add_u32 s70, s70, 8192
 s_addc_u32 s71, s71, 0
 v_mfma_f32_16x16x32_bf16 v[100:103], a[212:215], a[172:175], v[100:103]
 v_add_f32 v223, v223, v11
 v_mfma_f32_16x16x32_bf16 v[96:99], a[212:215], a[164:167], v[96:99]
 v_mfma_f32_16x16x32_bf16 v[96:99], a[208:211], a[160:163], v[96:99]
 v_add_f32 v224, v224, v8
 v_mfma_f32_16x16x32_bf16 v[92:95], a[208:211], a[152:155], v[92:95]
 v_add_f32 v225, v225, v9
 v_mfma_f32_16x16x32_bf16 v[92:95], a[212:215], a[156:159], v[92:95]
 v_mfma_f32_16x16x32_bf16 v[88:91], a[212:215], a[148:151], v[88:91]
 v_add_f32 v226, v226, v10
 v_mfma_f32_16x16x32_bf16 v[88:91], a[208:211], a[144:147], v[88:91]
 v_add_f32 v227, v227, v11
 v_mfma_f32_16x16x32_bf16 v[84:87], a[208:211], a[136:139], v[84:87]
 v_mfma_f32_16x16x32_bf16 v[84:87], a[212:215], a[140:143], v[84:87]
 v_add_f32 v228, v228, v8
 v_mfma_f32_16x16x32_bf16 v[80:83], a[212:215], a[132:135], v[80:83]
 v_add_f32 v229, v229, v9
 v_mfma_f32_16x16x32_bf16 v[80:83], a[208:211], a[128:131], v[80:83]
 s_waitcnt vmcnt(8)
 v_mfma_f32_16x16x32_bf16 v[112:115], a[216:219], a[128:131], v[112:115]
 ds_read_b128 a[128:131], v2 offset:34816
 v_add_f32 v230, v230, v10
 v_mfma_f32_16x16x32_bf16 v[112:115], a[220:223], a[132:135], v[112:115]
 global_load_dwordx4 a[212:215], v0, s[70:71] offset:-3072 sc1
 ds_read_b128 a[132:135], v2 offset:35840
 v_mfma_f32_16x16x32_bf16 v[116:119], a[220:223], a[140:143], v[116:119]
 ds_read_b128 a[140:143], v2 offset:39936
 v_add_f32 v231, v231, v11
 v_mfma_f32_16x16x32_bf16 v[116:119], a[216:219], a[136:139], v[116:119]
 global_load_dwordx4 a[208:211], v0, s[70:71] offset:-4096 sc1
 ds_read_b128 a[136:139], v2 offset:38912
 s_waitcnt lgkmcnt(4)
 v_mfma_f32_16x16x32_bf16 v[120:123], a[216:219], a[144:147], v[120:123]
 ds_read_b128 a[144:147], v2 offset:43008
 v_mfma_f32_16x16x32_bf16 v[120:123], a[220:223], a[148:151], v[120:123]
 ds_read_b128 a[148:151], v2 offset:44032
 v_add_f32 v232, v232, v12
 v_mfma_f32_16x16x32_bf16 v[124:127], a[220:223], a[156:159], v[124:127]
 ds_read_b128 a[156:159], v2 offset:48128
 v_add_f32 v233, v233, v13
 v_mfma_f32_16x16x32_bf16 v[124:127], a[216:219], a[152:155], v[124:127]
 ds_read_b128 a[152:155], v2 offset:47104
 v_mfma_f32_16x16x32_bf16 v[128:131], a[216:219], a[160:163], v[128:131]
 ds_read_b128 a[160:163], v2 offset:51200
 v_add_f32 v234, v234, v14
 v_mfma_f32_16x16x32_bf16 v[128:131], a[220:223], a[164:167], v[128:131]
 ds_read_b128 a[164:167], v2 offset:52224
 v_add_f32 v235, v235, v15
 v_mfma_f32_16x16x32_bf16 v[132:135], a[220:223], a[172:175], v[132:135]
 ds_read_b128 a[172:175], v2 offset:56320
 v_mfma_f32_16x16x32_bf16 v[132:135], a[216:219], a[168:171], v[132:135]
 ds_read_b128 a[168:171], v2 offset:55296
 v_add_f32 v236, v236, v12
 v_mfma_f32_16x16x32_bf16 a[240:243], a[216:219], a[176:179], a[240:243]
 ds_read_b128 a[176:179], v2 offset:59392
 v_add_f32 v237, v237, v13
 v_mfma_f32_16x16x32_bf16 a[240:243], a[220:223], a[180:183], a[240:243]
 ds_read_b128 a[180:183], v2 offset:60416
 v_mfma_f32_16x16x32_bf16 a[244:247], a[220:223], a[188:191], a[244:247]
 ds_read_b128 a[188:191], v2 offset:64512
 v_add_f32 v238, v238, v14
 v_mfma_f32_16x16x32_bf16 a[244:247], a[216:219], a[184:187], a[244:247]
 ds_read_b128 a[184:187], v2 offset:63488
 s_waitcnt vmcnt(8) lgkmcnt(8)
 v_mfma_f32_16x16x32_bf16 v[16:19], a[224:227], a[128:131], v[16:19]
 v_add_f32 v239, v239, v15
 v_mfma_f32_16x16x32_bf16 v[16:19], a[228:231], a[132:135], v[16:19]
 global_load_dwordx4 a[220:223], v0, s[70:71] offset:-1024 sc1
 v_add_f32 v240, v240, v12
 v_mfma_f32_16x16x32_bf16 v[20:23], a[228:231], a[140:143], v[20:23]
 v_mfma_f32_16x16x32_bf16 v[20:23], a[224:227], a[136:139], v[20:23]
 global_load_dwordx4 a[216:219], v0, s[70:71] offset:-2048 sc1
 v_add_f32 v241, v241, v13
 v_mfma_f32_16x16x32_bf16 v[24:27], a[224:227], a[144:147], v[24:27]
 v_add_f32 v242, v242, v14
 v_mfma_f32_16x16x32_bf16 v[24:27], a[228:231], a[148:151], v[24:27]
 v_mfma_f32_16x16x32_bf16 v[28:31], a[228:231], a[156:159], v[28:31]
 v_add_f32 v243, v243, v15
 v_mfma_f32_16x16x32_bf16 v[28:31], a[224:227], a[152:155], v[28:31]
 v_add_f32 v244, v244, v12
 s_waitcnt lgkmcnt(0)
 v_mfma_f32_16x16x32_bf16 v[32:35], a[224:227], a[160:163], v[32:35]
 v_mfma_f32_16x16x32_bf16 v[32:35], a[228:231], a[164:167], v[32:35]
 v_add_f32 v245, v245, v13
 v_mfma_f32_16x16x32_bf16 v[36:39], a[228:231], a[172:175], v[36:39]
 v_add_f32 v246, v246, v14
 v_mfma_f32_16x16x32_bf16 v[36:39], a[224:227], a[168:171], v[36:39]
 v_mfma_f32_16x16x32_bf16 v[40:43], a[224:227], a[176:179], v[40:43]
 v_add_f32 v247, v247, v15
 v_mfma_f32_16x16x32_bf16 v[40:43], a[228:231], a[180:183], v[40:43]
 v_mfma_f32_16x16x32_bf16 v[44:47], a[228:231], a[188:191], v[44:47]
 v_add_f32 v248, v248, v12
 v_mfma_f32_16x16x32_bf16 v[44:47], a[224:227], a[184:187], v[44:47]
 v_add_f32 v249, v249, v13
 s_waitcnt vmcnt(8)
 v_mfma_f32_16x16x32_bf16 v[76:79], a[232:235], a[184:187], v[76:79]
 v_mfma_f32_16x16x32_bf16 v[76:79], a[236:239], a[188:191], v[76:79]
 global_load_dwordx4 a[228:231], v0, s[70:71] offset:1024 sc1
 v_add_f32 v250, v250, v14
 v_mfma_f32_16x16x32_bf16 v[72:75], a[236:239], a[180:183], v[72:75]
 v_add_f32 v251, v251, v15
 v_mfma_f32_16x16x32_bf16 v[72:75], a[232:235], a[176:179], v[72:75]
 global_load_dwordx4 a[224:227], v0, s[70:71] offset:0 sc1
 v_mfma_f32_16x16x32_bf16 v[68:71], a[232:235], a[168:171], v[68:71]
 v_add_f32 v252, v252, v12
 v_mfma_f32_16x16x32_bf16 v[68:71], a[236:239], a[172:175], v[68:71]
 v_add_f32 v253, v253, v13
 v_mfma_f32_16x16x32_bf16 v[64:67], a[236:239], a[164:167], v[64:67]
 v_mfma_f32_16x16x32_bf16 v[64:67], a[232:235], a[160:163], v[64:67]
 v_add_f32 v254, v254, v14
 v_mfma_f32_16x16x32_bf16 v[60:63], a[232:235], a[152:155], v[60:63]
 v_add_f32 v255, v255, v15
 v_mfma_f32_16x16x32_bf16 v[60:63], a[236:239], a[156:159], v[60:63]
 v_mfma_f32_16x16x32_bf16 v[56:59], a[236:239], a[148:151], v[56:59]
 v_accvgpr_read_b32 v5, a248
 v_mfma_f32_16x16x32_bf16 v[56:59], a[232:235], a[144:147], v[56:59]
 v_mfma_f32_16x16x32_bf16 v[52:55], a[232:235], a[136:139], v[52:55]
 v_add_f32 v5, v5, v12
 v_mfma_f32_16x16x32_bf16 v[52:55], a[236:239], a[140:143], v[52:55]
 v_accvgpr_write_b32 a248, v5
 v_mfma_f32_16x16x32_bf16 v[48:51], a[236:239], a[132:135], v[48:51]
 v_mfma_f32_16x16x32_bf16 v[48:51], a[232:235], a[128:131], v[48:51]
 v_accvgpr_read_b32 v6, a249
 s_waitcnt vmcnt(8)
 v_mfma_f32_16x16x32_bf16 v[80:83], a[192:195], a[128:131], v[80:83]
 v_add_f32 v6, v6, v13
 v_mfma_f32_16x16x32_bf16 v[80:83], a[196:199], a[132:135], v[80:83]
 global_load_dwordx4 a[236:239], v0, s[70:71] offset:3072 sc1
 v_mfma_f32_16x16x32_bf16 v[84:87], a[196:199], a[140:143], v[84:87]
 v_accvgpr_write_b32 a249, v6
 v_mfma_f32_16x16x32_bf16 v[84:87], a[192:195], a[136:139], v[84:87]
 global_load_dwordx4 a[232:235], v0, s[70:71] offset:2048 sc1
 v_accvgpr_read_b32 v5, a250
 v_mfma_f32_16x16x32_bf16 v[88:91], a[192:195], a[144:147], v[88:91]
 s_add_u32 s70, s70, 8192
 s_addc_u32 s71, s71, 0
 v_mfma_f32_16x16x32_bf16 v[88:91], a[196:199], a[148:151], v[88:91]
 v_add_f32 v5, v5, v14
 v_mfma_f32_16x16x32_bf16 v[92:95], a[196:199], a[156:159], v[92:95]
 v_accvgpr_write_b32 a250, v5
 v_mfma_f32_16x16x32_bf16 v[92:95], a[192:195], a[152:155], v[92:95]
 v_mfma_f32_16x16x32_bf16 v[96:99], a[192:195], a[160:163], v[96:99]
 v_accvgpr_read_b32 v6, a251
 v_mfma_f32_16x16x32_bf16 v[96:99], a[196:199], a[164:167], v[96:99]
 v_mfma_f32_16x16x32_bf16 v[100:103], a[196:199], a[172:175], v[100:103]
 v_add_f32 v6, v6, v15
 v_mfma_f32_16x16x32_bf16 v[100:103], a[192:195], a[168:171], v[100:103]
 v_accvgpr_write_b32 a251, v6
 v_mfma_f32_16x16x32_bf16 v[104:107], a[192:195], a[176:179], v[104:107]
 v_mfma_f32_16x16x32_bf16 v[104:107], a[196:199], a[180:183], v[104:107]
 v_accvgpr_read_b32 v5, a252
 v_mfma_f32_16x16x32_bf16 v[108:111], a[196:199], a[188:191], v[108:111]
 v_add_f32 v5, v5, v12
 v_mfma_f32_16x16x32_bf16 v[108:111], a[192:195], a[184:187], v[108:111]
 s_waitcnt vmcnt(8)
 v_mfma_f32_16x16x32_bf16 a[244:247], a[200:203], a[184:187], a[244:247]
 v_accvgpr_write_b32 a252, v5
 v_mfma_f32_16x16x32_bf16 a[244:247], a[204:207], a[188:191], a[244:247]
 global_load_dwordx4 a[196:199], v0, s[70:71] offset:-3072 sc1
 v_accvgpr_read_b32 v6, a253
 v_mfma_f32_16x16x32_bf16 a[240:243], a[204:207], a[180:183], a[240:243]
 v_mfma_f32_16x16x32_bf16 a[240:243], a[200:203], a[176:179], a[240:243]
 global_load_dwordx4 a[192:195], v0, s[70:71] offset:-4096 sc1
 v_add_f32 v6, v6, v13
 v_mfma_f32_16x16x32_bf16 v[132:135], a[200:203], a[168:171], v[132:135]
 v_accvgpr_write_b32 a253, v6
 v_mfma_f32_16x16x32_bf16 v[132:135], a[204:207], a[172:175], v[132:135]
 v_mfma_f32_16x16x32_bf16 v[128:131], a[204:207], a[164:167], v[128:131]
 v_accvgpr_read_b32 v5, a254
 v_mfma_f32_16x16x32_bf16 v[128:131], a[200:203], a[160:163], v[128:131]
 v_mfma_f32_16x16x32_bf16 v[124:127], a[200:203], a[152:155], v[124:127]
 v_add_f32 v5, v5, v14
 v_mfma_f32_16x16x32_bf16 v[124:127], a[204:207], a[156:159], v[124:127]
 v_accvgpr_write_b32 a254, v5
 v_mfma_f32_16x16x32_bf16 v[120:123], a[204:207], a[148:151], v[120:123]
 v_mfma_f32_16x16x32_bf16 v[120:123], a[200:203], a[144:147], v[120:123]
 v_accvgpr_read_b32 v6, a255
 v_mfma_f32_16x16x32_bf16 v[116:119], a[200:203], a[136:139], v[116:119]
 v_add_f32 v6, v6, v15
 v_mfma_f32_16x16x32_bf16 v[116:119], a[204:207], a[140:143], v[116:119]
 v_mfma_f32_16x16x32_bf16 v[112:115], a[204:207], a[132:135], v[112:115]
 global_load_dwordx4 a[204:207], v0, s[70:71] offset:-1024 sc1
 v_accvgpr_write_b32 a255, v6
 v_mfma_f32_16x16x32_bf16 v[112:115], a[200:203], a[128:131], v[112:115]
 global_load_dwordx4 a[200:203], v0, s[70:71] offset:-2048 sc1
 s_waitcnt vmcnt(10)
 s_mov_b32 s8, s32
 s_mov_b32 s9, s33
 s_mov_b32 s10, s34
 s_mov_b32 s20, 1024
 s_mov_b32 s21, 1024
 s_mov_b32 s22, 1024
 s_xor_b32 s30, s29, 131072
 s_add_u32 s51, s51, 2048
 s_add_u32 s25, s25, 1
 s_cmp_eq_u32 s25, 6
 s_cbranch_scc1 Llast
 v_mfma_f32_16x16x32_bf16 v[136:139], a[208:211], a[128:131], v[136:139]
 v_accvgpr_read_b32 v5, a0
 v_lshlrev_b32 v6, 16, v5
 v_mfma_f32_16x16x32_bf16 v[136:139], a[212:215], a[132:135], v[136:139]
 v_and_b32 v5, s26, v5
 v_mul_f32 v6, v6, v16
 v_mfma_f32_16x16x32_bf16 v[140:143], a[212:215], a[140:143], v[140:143]
 v_mul_f32 v5, v5, v17
 v_cvt_pk_bf16_f32 v8, v6, v5
 v_mfma_f32_16x16x32_bf16 v[140:143], a[208:211], a[136:139], v[140:143]
 v_accvgpr_read_b32 v5, a1
 v_mfma_f32_16x16x32_bf16 v[144:147], a[208:211], a[144:147], v[144:147]
 v_lshlrev_b32 v6, 16, v5
 v_and_b32 v5, s26, v5
 v_mfma_f32_16x16x32_bf16 v[144:147], a[212:215], a[148:151], v[144:147]
 v_mul_f32 v6, v6, v18
 v_mul_f32 v5, v5, v19
 v_mfma_f32_16x16x32_bf16 v[148:151], a[212:215], a[156:159], v[148:151]
 v_cvt_pk_bf16_f32 v9, v6, v5
 v_accvgpr_read_b32 v5, a2
 v_mfma_f32_16x16x32_bf16 v[148:151], a[208:211], a[152:155], v[148:151]
 v_lshlrev_b32 v6, 16, v5
 v_and_b32 v5, s26, v5
 v_mfma_f32_16x16x32_bf16 v[152:155], a[208:211], a[160:163], v[152:155]
 v_mul_f32 v6, v6, v48
 v_mul_f32 v5, v5, v49
 v_mfma_f32_16x16x32_bf16 v[152:155], a[212:215], a[164:167], v[152:155]
 v_cvt_pk_bf16_f32 v10, v6, v5
 v_mfma_f32_16x16x32_bf16 v[156:159], a[212:215], a[172:175], v[156:159]
 v_accvgpr_read_b32 v5, a3
 v_lshlrev_b32 v6, 16, v5
 v_mfma_f32_16x16x32_bf16 v[156:159], a[208:211], a[168:171], v[156:159]
 v_and_b32 v5, s26, v5
 v_mul_f32 v6, v6, v50
 v_mfma_f32_16x16x32_bf16 v[160:163], a[208:211], a[176:179], v[160:163]
 v_mul_f32 v5, v5, v51
 v_cvt_pk_bf16_f32 v11, v6, v5
 v_mfma_f32_16x16x32_bf16 v[160:163], a[212:215], a[180:183], v[160:163]
 ds_write_b128 v3, v[8:11]
 s_add_u32 s68, s29, 0
 v_mfma_f32_16x16x32_bf16 v[164:167], a[212:215], a[188:191], v[164:167]
 buffer_store_dwordx4 v[8:11], v3, s[32:35], s68 offen sc1
 v_accvgpr_read_b32 v5, a32
 v_mfma_f32_16x16x32_bf16 v[164:167], a[208:211], a[184:187], v[164:167]
 v_lshlrev_b32 v6, 16, v5
 v_and_b32 v5, s26, v5
 s_waitcnt vmcnt(9)
 v_mfma_f32_16x16x32_bf16 v[196:199], a[216:219], a[184:187], v[196:199]
 v_mul_f32 v6, v6, v80
 v_mul_f32 v5, v5, v81
 v_mfma_f32_16x16x32_bf16 v[196:199], a[220:223], a[188:191], v[196:199]
 global_load_dwordx4 a[212:215], v0, s[70:71] offset:1024 sc1
 v_cvt_pk_bf16_f32 v12, v6, v5
 v_mfma_f32_16x16x32_bf16 v[192:195], a[220:223], a[180:183], v[192:195]
 v_accvgpr_read_b32 v5, a33
 v_lshlrev_b32 v6, 16, v5
 v_mfma_f32_16x16x32_bf16 v[192:195], a[216:219], a[176:179], v[192:195]
 global_load_dwordx4 a[208:211], v0, s[70:71] offset:0 sc1
 v_and_b32 v5, s26, v5
 v_mfma_f32_16x16x32_bf16 v[188:191], a[216:219], a[168:171], v[188:191]
 v_mul_f32 v6, v6, v82
 v_mul_f32 v5, v5, v83
 v_mfma_f32_16x16x32_bf16 v[188:191], a[220:223], a[172:175], v[188:191]
 v_cvt_pk_bf16_f32 v13, v6, v5
 v_accvgpr_read_b32 v5, a34
 v_mfma_f32_16x16x32_bf16 v[184:187], a[220:223], a[164:167], v[184:187]
 v_lshlrev_b32 v6, 16, v5
 v_and_b32 v5, s26, v5
 v_mfma_f32_16x16x32_bf16 v[184:187], a[216:219], a[160:163], v[184:187]
 v_mul_f32 v6, v6, v112
 v_mul_f32 v5, v5, v113
 v_mfma_f32_16x16x32_bf16 v[180:183], a[216:219], a[152:155], v[180:183]
 v_cvt_pk_bf16_f32 v14, v6, v5
 v_accvgpr_read_b32 v5, a35
 v_mfma_f32_16x16x32_bf16 v[180:183], a[220:223], a[156:159], v[180:183]
 v_lshlrev_b32 v6, 16, v5
 v_and_b32 v5, s26, v5
 v_mfma_f32_16x16x32_bf16 v[176:179], a[220:223], a[148:151], v[176:179]
 v_mul_f32 v6, v6, v114
 v_mul_f32 v5, v5, v115
 v_mfma_f32_16x16x32_bf16 v[176:179], a[216:219], a[144:147], v[176:179]
 v_cvt_pk_bf16_f32 v15, v6, v5
 v_mfma_f32_16x16x32_bf16 v[172:175], a[216:219], a[136:139], v[172:175]
 ds_write_b128 v3, v[12:15] offset:1024
 v_mfma_f32_16x16x32_bf16 v[172:175], a[220:223], a[140:143], v[172:175]
 buffer_store_dwordx4 v[12:15], v3, s[32:35], s68 offen offset:1024 sc1
 v_accvgpr_read_b32 v5, a4
 v_lshlrev_b32 v6, 16, v5
 v_and_b32 v5, s26, v5
 v_mul_f32 v6, v6, v20
 v_mfma_f32_16x16x32_bf16 v[168:171], a[220:223], a[132:135], v[168:171]
 v_mul_f32 v5, v5, v21
 v_cvt_pk_bf16_f32 v8, v6, v5
 v_mfma_f32_16x16x32_bf16 v[168:171], a[216:219], a[128:131], v[168:171]
 v_accvgpr_read_b32 v5, a5
 v_lshlrev_b32 v6, 16, v5
 s_waitcnt vmcnt(10)
 v_mfma_f32_16x16x32_bf16 v[200:203], a[224:227], a[128:131], v[200:203]
 v_and_b32 v5, s26, v5
 v_mul_f32 v6, v6, v22
 v_mfma_f32_16x16x32_bf16 v[200:203], a[228:231], a[132:135], v[200:203]
 global_load_dwordx4 a[220:223], v0, s[70:71] offset:3072 sc1
 v_mul_f32 v5, v5, v23
 v_mfma_f32_16x16x32_bf16 v[204:207], a[228:231], a[140:143], v[204:207]
 v_cvt_pk_bf16_f32 v9, v6, v5
 v_accvgpr_read_b32 v5, a6
 v_mfma_f32_16x16x32_bf16 v[204:207], a[224:227], a[136:139], v[204:207]
 global_load_dwordx4 a[216:219], v0, s[70:71] offset:2048 sc1
 v_lshlrev_b32 v6, 16, v5
 v_mfma_f32_16x16x32_bf16 v[208:211], a[224:227], a[144:147], v[208:211]
 v_and_b32 v5, s26, v5
 v_mul_f32 v6, v6, v52
 s_add_u32 s70, s70, 8192
 s_addc_u32 s71, s71, 0
 v_mfma_f32_16x16x32_bf16 v[208:211], a[228:231], a[148:151], v[208:211]
 v_mul_f32 v5, v5, v53
 v_cvt_pk_bf16_f32 v10, v6, v5
 v_mfma_f32_16x16x32_bf16 v[212:215], a[228:231], a[156:159], v[212:215]
 v_accvgpr_read_b32 v5, a7
 v_lshlrev_b32 v6, 16, v5
 v_mfma_f32_16x16x32_bf16 v[212:215], a[224:227], a[152:155], v[212:215]
 v_and_b32 v5, s26, v5
 v_mul_f32 v6, v6, v54
 v_mfma_f32_16x16x32_bf16 v[216:219], a[224:227], a[160:163], v[216:219]
 v_mul_f32 v5, v5, v55
 v_cvt_pk_bf16_f32 v11, v6, v5
 v_mfma_f32_16x16x32_bf16 v[216:219], a[228:231], a[164:167], v[216:219]
 ds_write_b128 v3, v[8:11] offset:4096
 v_mfma_f32_16x16x32_bf16 v[220:223], a[228:231], a[172:175], v[220:223]
 buffer_store_dwordx4 v[8:11], v3, s[32:35], s68 offen offset:2048 sc1
 v_accvgpr_read_b32 v5, a36
 v_lshlrev_b32 v6, 16, v5
 v_and_b32 v5, s26, v5
 v_mul_f32 v6, v6, v84
 v_mfma_f32_16x16x32_bf16 v[220:223], a[224:227], a[168:171], v[220:223]
 v_mul_f32 v5, v5, v85
 v_cvt_pk_bf16_f32 v12, v6, v5
 v_mfma_f32_16x16x32_bf16 v[224:227], a[224:227], a[176:179], v[224:227]
 v_accvgpr_read_b32 v5, a37
 v_lshlrev_b32 v6, 16, v5
 v_mfma_f32_16x16x32_bf16 v[224:227], a[228:231], a[180:183], v[224:227]
 v_and_b32 v5, s26, v5
 v_mul_f32 v6, v6, v86
 v_mfma_f32_16x16x32_bf16 v[228:231], a[228:231], a[188:191], v[228:231]
 v_mul_f32 v5, v5, v87
 v_cvt_pk_bf16_f32 v13, v6, v5
 v_mfma_f32_16x16x32_bf16 v[228:231], a[224:227], a[184:187], v[228:231]
 v_accvgpr_read_b32 v5, a38
 v_lshlrev_b32 v6, 16, v5
 s_waitcnt vmcnt(11)
 v_mfma_f32_16x16x32_bf16 a[252:255], a[232:235], a[184:187], a[252:255]
 ds_read_b128 a[184:187], v2 offset:30720
 v_and_b32 v5, s26, v5
 v_mfma_f32_16x16x32_bf16 a[252:255], a[236:239], a[188:191], a[252:255]
 global_load_dwordx4 a[228:231], v0, s[70:71] offset:-3072 sc1
 ds_read_b128 a[188:191], v2 offset:31744
 v_mfma_f32_16x16x32_bf16 a[248:251], a[236:239], a[180:183], a[248:251]
 ds_read_b128 a[180:183], v2 offset:27648
 v_mul_f32 v6, v6, v116
 v_mfma_f32_16x16x32_bf16 a[248:251], a[232:235], a[176:179], a[248:251]
 global_load_dwordx4 a[224:227], v0, s[70:71] offset:-4096 sc1
 ds_read_b128 a[176:179], v2 offset:26624
 v_mul_f32 v5, v5, v117
 v_mfma_f32_16x16x32_bf16 v[252:255], a[232:235], a[168:171], v[252:255]
 ds_read_b128 a[168:171], v2 offset:22528
 v_cvt_pk_bf16_f32 v14, v6, v5
 v_accvgpr_read_b32 v5, a39
 v_mfma_f32_16x16x32_bf16 v[252:255], a[236:239], a[172:175], v[252:255]
 ds_read_b128 a[172:175], v2 offset:23552
 v_lshlrev_b32 v6, 16, v5
 v_mfma_f32_16x16x32_bf16 v[248:251], a[236:239], a[164:167], v[248:251]
 ds_read_b128 a[164:167], v2 offset:19456
 v_and_b32 v5, s26, v5
 v_mul_f32 v6, v6, v118
 v_mfma_f32_16x16x32_bf16 v[248:251], a[232:235], a[160:163], v[248:251]
 ds_read_b128 a[160:163], v2 offset:18432
 v_mul_f32 v5, v5, v119
 v_cvt_pk_bf16_f32 v15, v6, v5
 v_mfma_f32_16x16x32_bf16 v[244:247], a[232:235], a[152:155], v[244:247]
 ds_read_b128 a[152:155], v2 offset:14336
 ds_write_b128 v3, v[12:15] offset:5120
 v_mfma_f32_16x16x32_bf16 v[244:247], a[236:239], a[156:159], v[244:247]
 buffer_store_dwordx4 v[12:15], v3, s[32:35], s68 offen offset:3072 sc1
 ds_read_b128 a[156:159], v2 offset:15360
 v_accvgpr_read_b32 v5, a8
 v_lshlrev_b32 v6, 16, v5
 v_and_b32 v5, s26, v5
 v_mfma_f32_16x16x32_bf16 v[240:243], a[236:239], a[148:151], v[240:243]
 ds_read_b128 a[148:151], v2 offset:11264
 v_mul_f32 v6, v6, v24
 v_mfma_f32_16x16x32_bf16 v[240:243], a[232:235], a[144:147], v[240:243]
 ds_read_b128 a[144:147], v2 offset:10240
 v_mul_f32 v5, v5, v25
 v_cvt_pk_bf16_f32 v8, v6, v5
 v_mfma_f32_16x16x32_bf16 v[236:239], a[232:235], a[136:139], v[236:239]
 ds_read_b128 a[136:139], v2 offset:6144
 v_accvgpr_read_b32 v5, a9
 v_mfma_f32_16x16x32_bf16 v[236:239], a[236:239], a[140:143], v[236:239]
 ds_read_b128 a[140:143], v2 offset:7168
 v_lshlrev_b32 v6, 16, v5
 v_mfma_f32_16x16x32_bf16 v[232:235], a[236:239], a[132:135], v[232:235]
 ds_read_b128 a[132:135], v2 offset:3072
 v_and_b32 v5, s26, v5
 v_mfma_f32_16x16x32_bf16 v[232:235], a[232:235], a[128:131], v[232:235]
 ds_read_b128 a[128:131], v2 offset:2048
 v_mul_f32 v6, v6, v26
 s_waitcnt vmcnt(12) lgkmcnt(9)
 v_mfma_f32_16x16x32_bf16 v[164:167], a[192:195], a[184:187], v[164:167]
 v_mul_f32 v5, v5, v27
 v_cvt_pk_bf16_f32 v9, v6, v5
 v_mfma_f32_16x16x32_bf16 v[164:167], a[196:199], a[188:191], v[164:167]
 global_load_dwordx4 a[236:239], v0, s[70:71] offset:-1024 sc1
 v_accvgpr_read_b32 v5, a10
 v_mfma_f32_16x16x32_bf16 v[160:163], a[196:199], a[180:183], v[160:163]
 v_lshlrev_b32 v6, 16, v5
 v_and_b32 v5, s26, v5
 v_mfma_f32_16x16x32_bf16 v[160:163], a[192:195], a[176:179], v[160:163]
 global_load_dwordx4 a[232:235], v0, s[70:71] offset:-2048 sc1
 v_mul_f32 v6, v6, v56
 v_mfma_f32_16x16x32_bf16 v[156:159], a[192:195], a[168:171], v[156:159]
 v_mul_f32 v5, v5, v57
 v_cvt_pk_bf16_f32 v10, v6, v5
 v_mfma_f32_16x16x32_bf16 v[156:159], a[196:199], a[172:175], v[156:159]
 v_accvgpr_read_b32 v5, a11
 v_lshlrev_b32 v6, 16, v5
 v_mfma_f32_16x16x32_bf16 v[152:155], a[196:199], a[164:167], v[152:155]
 v_and_b32 v5, s26, v5
 v_mul_f32 v6, v6, v58
 v_mfma_f32_16x16x32_bf16 v[152:155], a[192:195], a[160:163], v[152:155]
 v_mul_f32 v5, v5, v59
 v_cvt_pk_bf16_f32 v11, v6, v5
 s_waitcnt lgkmcnt(0)
 v_mfma_f32_16x16x32_bf16 v[148:151], a[192:195], a[152:155], v[148:151]
 ds_write_b128 v3, v[8:11] offset:8192
 s_add_u32 s68, s29, 4096
 v_mfma_f32_16x16x32_bf16 v[148:151], a[196:199], a[156:159], v[148:151]
 buffer_store_dwordx4 v[8:11], v3, s[32:35], s68 offen sc1
 v_accvgpr_read_b32 v5, a40
 v_lshlrev_b32 v6, 16, v5
 v_and_b32 v5, s26, v5
 v_mul_f32 v6, v6, v88
 v_mfma_f32_16x16x32_bf16 v[144:147], a[196:199], a[148:151], v[144:147]
 v_mul_f32 v5, v5, v89
 v_cvt_pk_bf16_f32 v12, v6, v5
 v_mfma_f32_16x16x32_bf16 v[144:147], a[192:195], a[144:147], v[144:147]
 v_accvgpr_read_b32 v5, a41
 v_lshlrev_b32 v6, 16, v5
 v_mfma_f32_16x16x32_bf16 v[140:143], a[192:195], a[136:139], v[140:143]
 v_and_b32 v5, s26, v5
 v_mul_f32 v6, v6, v90
 v_mfma_f32_16x16x32_bf16 v[140:143], a[196:199], a[140:143], v[140:143]
 v_mul_f32 v5, v5, v91
 v_cvt_pk_bf16_f32 v13, v6, v5
 v_mfma_f32_16x16x32_bf16 v[136:139], a[196:199], a[132:135], v[136:139]
 v_accvgpr_read_b32 v5, a42
 v_lshlrev_b32 v6, 16, v5
 v_mfma_f32_16x16x32_bf16 v[136:139], a[192:195], a[128:131], v[136:139]
 v_and_b32 v5, s26, v5
 v_mul_f32 v6, v6, v120
 s_waitcnt vmcnt(13)
 v_mfma_f32_16x16x32_bf16 v[168:171], a[200:203], a[128:131], v[168:171]
 v_mul_f32 v5, v5, v121
 v_cvt_pk_bf16_f32 v14, v6, v5
 v_mfma_f32_16x16x32_bf16 v[168:171], a[204:207], a[132:135], v[168:171]
 global_load_dwordx4 a[196:199], v0, s[70:71] offset:1024 sc1
 v_accvgpr_read_b32 v5, a43
 v_mfma_f32_16x16x32_bf16 v[172:175], a[204:207], a[140:143], v[172:175]
 v_lshlrev_b32 v6, 16, v5
 v_and_b32 v5, s26, v5
 v_mfma_f32_16x16x32_bf16 v[172:175], a[200:203], a[136:139], v[172:175]
 global_load_dwordx4 a[192:195], v0, s[70:71] offset:0 sc1
 v_mul_f32 v6, v6, v122
 v_mfma_f32_16x16x32_bf16 v[176:179], a[200:203], a[144:147], v[176:179]
 v_mul_f32 v5, v5, v123
 v_cvt_pk_bf16_f32 v15, v6, v5
 v_mfma_f32_16x16x32_bf16 v[176:179], a[204:207], a[148:151], v[176:179]
 ds_write_b128 v3, v[12:15] offset:9216
 v_mfma_f32_16x16x32_bf16 v[180:183], a[204:207], a[156:159], v[180:183]
 v_lshlrev_b32 v4, 2, v3
 v_and_b32 v4, 192, v4
 v_mfma_f32_16x16x32_bf16 v[180:183], a[200:203], a[152:155], v[180:183]
 buffer_load_dword v4, v4, s[44:47], 0 offen sc1
 v_mfma_f32_16x16x32_bf16 v[184:187], a[200:203], a[160:163], v[184:187]
 buffer_store_dwordx4 v[12:15], v3, s[32:35], s68 offen offset:1024 sc1
 v_accvgpr_read_b32 v5, a12
 v_lshlrev_b32 v6, 16, v5
 v_and_b32 v5, s26, v5
 v_mul_f32 v6, v6, v28
 v_mfma_f32_16x16x32_bf16 v[184:187], a[204:207], a[164:167], v[184:187]
 v_mul_f32 v5, v5, v29
 v_cvt_pk_bf16_f32 v8, v6, v5
 v_mfma_f32_16x16x32_bf16 v[188:191], a[204:207], a[172:175], v[188:191]
 v_accvgpr_read_b32 v5, a13
 v_lshlrev_b32 v6, 16, v5
 v_mfma_f32_16x16x32_bf16 v[188:191], a[200:203], a[168:171], v[188:191]
 v_and_b32 v5, s26, v5
 v_mul_f32 v6, v6, v30
 v_mfma_f32_16x16x32_bf16 v[192:195], a[200:203], a[176:179], v[192:195]
 v_mul_f32 v5, v5, v31
 v_cvt_pk_bf16_f32 v9, v6, v5
 v_mfma_f32_16x16x32_bf16 v[192:195], a[204:207], a[180:183], v[192:195]
 v_accvgpr_read_b32 v5, a14
 v_lshlrev_b32 v6, 16, v5
 v_mfma_f32_16x16x32_bf16 v[196:199], a[204:207], a[188:191], v[196:199]
 v_and_b32 v5, s26, v5
 v_mul_f32 v6, v6, v60
 v_mfma_f32_16x16x32_bf16 v[196:199], a[200:203], a[184:187], v[196:199]
 v_mul_f32 v5, v5, v61
 v_cvt_pk_bf16_f32 v10, v6, v5
 s_waitcnt vmcnt(14)
 v_mfma_f32_16x16x32_bf16 v[228:231], a[208:211], a[184:187], v[228:231]
 v_accvgpr_read_b32 v5, a15
 v_lshlrev_b32 v6, 16, v5
 v_mfma_f32_16x16x32_bf16 v[228:231], a[212:215], a[188:191], v[228:231]
 global_load_dwordx4 a[204:207], v0, s[70:71] offset:3072 sc1
 v_and_b32 v5, s26, v5
 v_mfma_f32_16x16x32_bf16 v[224:227], a[212:215], a[180:183], v[224:227]
 v_mul_f32 v6, v6, v62
 v_mul_f32 v5, v5, v63
 v_mfma_f32_16x16x32_bf16 v[224:227], a[208:211], a[176:179], v[224:227]
 global_load_dwordx4 a[200:203], v0, s[70:71] offset:2048 sc1
 v_cvt_pk_bf16_f32 v11, v6, v5
 v_mfma_f32_16x16x32_bf16 v[220:223], a[208:211], a[168:171], v[220:223]
 ds_write_b128 v3, v[8:11] offset:12288
 s_add_u32 s70, s70, 8192
 s_addc_u32 s71, s71, 0
 v_mfma_f32_16x16x32_bf16 v[220:223], a[212:215], a[172:175], v[220:223]
 buffer_store_dwordx4 v[8:11], v3, s[32:35], s68 offen offset:2048 sc1
 v_accvgpr_read_b32 v5, a44
 v_lshlrev_b32 v6, 16, v5
 v_and_b32 v5, s26, v5
 v_mfma_f32_16x16x32_bf16 v[216:219], a[212:215], a[164:167], v[216:219]
 v_mul_f32 v6, v6, v92
 v_mul_f32 v5, v5, v93
 v_mfma_f32_16x16x32_bf16 v[216:219], a[208:211], a[160:163], v[216:219]
 v_cvt_pk_bf16_f32 v12, v6, v5
 v_accvgpr_read_b32 v5, a45
 v_mfma_f32_16x16x32_bf16 v[212:215], a[208:211], a[152:155], v[212:215]
 v_lshlrev_b32 v6, 16, v5
 v_and_b32 v5, s26, v5
 v_mfma_f32_16x16x32_bf16 v[212:215], a[212:215], a[156:159], v[212:215]
 v_mul_f32 v6, v6, v94
 v_mul_f32 v5, v5, v95
 v_mfma_f32_16x16x32_bf16 v[208:211], a[212:215], a[148:151], v[208:211]
 v_cvt_pk_bf16_f32 v13, v6, v5
 v_accvgpr_read_b32 v5, a46
 v_mfma_f32_16x16x32_bf16 v[208:211], a[208:211], a[144:147], v[208:211]
 v_lshlrev_b32 v6, 16, v5
 v_and_b32 v5, s26, v5
 v_mfma_f32_16x16x32_bf16 v[204:207], a[208:211], a[136:139], v[204:207]
 v_mul_f32 v6, v6, v124
 v_mul_f32 v5, v5, v125
 v_mfma_f32_16x16x32_bf16 v[204:207], a[212:215], a[140:143], v[204:207]
 v_cvt_pk_bf16_f32 v14, v6, v5
 v_accvgpr_read_b32 v5, a47
 v_mfma_f32_16x16x32_bf16 v[200:203], a[212:215], a[132:135], v[200:203]
 v_lshlrev_b32 v6, 16, v5
 v_and_b32 v5, s26, v5
 v_mfma_f32_16x16x32_bf16 v[200:203], a[208:211], a[128:131], v[200:203]
 v_mul_f32 v6, v6, v126
 v_mul_f32 v5, v5, v127
 s_waitcnt vmcnt(14)
 v_mfma_f32_16x16x32_bf16 v[232:235], a[216:219], a[128:131], v[232:235]
 ds_read_b128 a[128:131], v1 offset:34816
 v_cvt_pk_bf16_f32 v15, v6, v5
 v_mfma_f32_16x16x32_bf16 v[232:235], a[220:223], a[132:135], v[232:235]
 global_load_dwordx4 a[212:215], v0, s[70:71] offset:-3072 sc1
 ds_read_b128 a[132:135], v1 offset:35840
 v_mfma_f32_16x16x32_bf16 v[236:239], a[220:223], a[140:143], v[236:239]
 ds_read_b128 a[140:143], v1 offset:39936
 ds_write_b128 v3, v[12:15] offset:13312
 v_mfma_f32_16x16x32_bf16 v[236:239], a[216:219], a[136:139], v[236:239]
 global_load_dwordx4 a[208:211], v0, s[70:71] offset:-4096 sc1
 ds_read_b128 a[136:139], v1 offset:38912
 v_mfma_f32_16x16x32_bf16 v[240:243], a[216:219], a[144:147], v[240:243]
 buffer_store_dwordx4 v[12:15], v3, s[32:35], s68 offen offset:3072 sc1
 ds_read_b128 a[144:147], v1 offset:43008
 v_accvgpr_read_b32 v5, a16
 v_lshlrev_b32 v6, 16, v5
 v_and_b32 v5, s26, v5
 v_mfma_f32_16x16x32_bf16 v[240:243], a[220:223], a[148:151], v[240:243]
 ds_read_b128 a[148:151], v1 offset:44032
 v_mul_f32 v6, v6, v32
 v_mfma_f32_16x16x32_bf16 v[244:247], a[220:223], a[156:159], v[244:247]
 ds_read_b128 a[156:159], v1 offset:48128
 v_mul_f32 v5, v5, v33
 v_cvt_pk_bf16_f32 v8, v6, v5
 v_mfma_f32_16x16x32_bf16 v[244:247], a[216:219], a[152:155], v[244:247]
 ds_read_b128 a[152:155], v1 offset:47104
 v_accvgpr_read_b32 v5, a17
 v_lshlrev_b32 v6, 16, v5
 v_mfma_f32_16x16x32_bf16 v[248:251], a[216:219], a[160:163], v[248:251]
 ds_read_b128 a[160:163], v1 offset:51200
 v_and_b32 v5, s26, v5
 v_mul_f32 v6, v6, v34
 v_mfma_f32_16x16x32_bf16 v[248:251], a[220:223], a[164:167], v[248:251]
 ds_read_b128 a[164:167], v1 offset:52224
 v_mul_f32 v5, v5, v35
 v_cvt_pk_bf16_f32 v9, v6, v5
 v_mfma_f32_16x16x32_bf16 v[252:255], a[220:223], a[172:175], v[252:255]
 ds_read_b128 a[172:175], v1 offset:56320
 v_accvgpr_read_b32 v5, a18
 v_mfma_f32_16x16x32_bf16 v[252:255], a[216:219], a[168:171], v[252:255]
 ds_read_b128 a[168:171], v1 offset:55296
 v_lshlrev_b32 v6, 16, v5
 v_mfma_f32_16x16x32_bf16 a[248:251], a[216:219], a[176:179], a[248:251]
 ds_read_b128 a[176:179], v1 offset:59392
 v_and_b32 v5, s26, v5
 v_mfma_f32_16x16x32_bf16 a[248:251], a[220:223], a[180:183], a[248:251]
 ds_read_b128 a[180:183], v1 offset:60416
 v_mul_f32 v6, v6, v64
 v_mfma_f32_16x16x32_bf16 a[252:255], a[220:223], a[188:191], a[252:255]
 ds_read_b128 a[188:191], v1 offset:64512
 v_mul_f32 v5, v5, v65
 v_mfma_f32_16x16x32_bf16 a[252:255], a[216:219], a[184:187], a[252:255]
 ds_read_b128 a[184:187], v1 offset:63488
 v_cvt_pk_bf16_f32 v10, v6, v5
 s_waitcnt vmcnt(14) lgkmcnt(8)
 v_mfma_f32_16x16x32_bf16 v[136:139], a[224:227], a[128:131], v[136:139]
 v_accvgpr_read_b32 v5, a19
 v_lshlrev_b32 v6, 16, v5
 v_mfma_f32_16x16x32_bf16 v[136:139], a[228:231], a[132:135], v[136:139]
 global_load_dwordx4 a[220:223], v0, s[70:71] offset:-1024 sc1
 v_and_b32 v5, s26, v5
 v_mfma_f32_16x16x32_bf16 v[140:143], a[228:231], a[140:143], v[140:143]
 v_mul_f32 v6, v6, v66
 v_mul_f32 v5, v5, v67
 v_mfma_f32_16x16x32_bf16 v[140:143], a[224:227], a[136:139], v[140:143]
 global_load_dwordx4 a[216:219], v0, s[70:71] offset:-2048 sc1
 v_cvt_pk_bf16_f32 v11, v6, v5
 v_mfma_f32_16x16x32_bf16 v[144:147], a[224:227], a[144:147], v[144:147]
 ds_write_b128 v3, v[8:11] offset:16384
 s_add_u32 s68, s29, 8192
 v_mfma_f32_16x16x32_bf16 v[144:147], a[228:231], a[148:151], v[144:147]
 buffer_store_dwordx4 v[8:11], v3, s[32:35], s68 offen sc1
 v_accvgpr_read_b32 v5, a48
 v_lshlrev_b32 v6, 16, v5
 v_and_b32 v5, s26, v5
 v_mul_f32 v6, v6, v96
 v_mfma_f32_16x16x32_bf16 v[148:151], a[228:231], a[156:159], v[148:151]
 v_mul_f32 v5, v5, v97
 v_cvt_pk_bf16_f32 v12, v6, v5
 v_mfma_f32_16x16x32_bf16 v[148:151], a[224:227], a[152:155], v[148:151]
 v_accvgpr_read_b32 v5, a49
 v_lshlrev_b32 v6, 16, v5
 s_waitcnt lgkmcnt(1)
 v_mfma_f32_16x16x32_bf16 v[152:155], a[224:227], a[160:163], v[152:155]
 v_and_b32 v5, s26, v5
 v_mul_f32 v6, v6, v98
 v_mfma_f32_16x16x32_bf16 v[152:155], a[228:231], a[164:167], v[152:155]
 v_mul_f32 v5, v5, v99
 v_cvt_pk_bf16_f32 v13, v6, v5
 v_mfma_f32_16x16x32_bf16 v[156:159], a[228:231], a[172:175], v[156:159]
 v_accvgpr_read_b32 v5, a50
 v_lshlrev_b32 v6, 16, v5
 v_mfma_f32_16x16x32_bf16 v[156:159], a[224:227], a[168:171], v[156:159]
 v_and_b32 v5, s26, v5
 v_mul_f32 v6, v6, v128
 v_mfma_f32_16x16x32_bf16 v[160:163], a[224:227], a[176:179], v[160:163]
 v_mul_f32 v5, v5, v129
 v_cvt_pk_bf16_f32 v14, v6, v5
 v_mfma_f32_16x16x32_bf16 v[160:163], a[228:231], a[180:183], v[160:163]
 v_accvgpr_read_b32 v5, a51
 v_lshlrev_b32 v6, 16, v5
 v_mfma_f32_16x16x32_bf16 v[164:167], a[228:231], a[188:191], v[164:167]
 v_and_b32 v5, s26, v5
 v_mul_f32 v6, v6, v130
 v_mfma_f32_16x16x32_bf16 v[164:167], a[224:227], a[184:187], v[164:167]
 v_mul_f32 v5, v5, v131
 v_cvt_pk_bf16_f32 v15, v6, v5
 s_waitcnt vmcnt(14)
 v_mfma_f32_16x16x32_bf16 v[196:199], a[232:235], a[184:187], v[196:199]
 ds_write_b128 v3, v[12:15] offset:17408
 v_mfma_f32_16x16x32_bf16 v[196:199], a[236:239], a[188:191], v[196:199]
 buffer_store_dwordx4 v[12:15], v3, s[32:35], s68 offen offset:1024 sc1
 global_load_dwordx4 a[228:231], v0, s[70:71] offset:1024 sc1
 v_accvgpr_read_b32 v5, a20
 v_lshlrev_b32 v6, 16, v5
 v_and_b32 v5, s26, v5
 v_mfma_f32_16x16x32_bf16 v[192:195], a[236:239], a[180:183], v[192:195]
 v_mul_f32 v6, v6, v36
 v_mul_f32 v5, v5, v37
 v_mfma_f32_16x16x32_bf16 v[192:195], a[232:235], a[176:179], v[192:195]
 global_load_dwordx4 a[224:227], v0, s[70:71] offset:0 sc1
 v_cvt_pk_bf16_f32 v8, v6, v5
 v_mfma_f32_16x16x32_bf16 v[188:191], a[232:235], a[168:171], v[188:191]
 v_accvgpr_read_b32 v5, a21
 v_lshlrev_b32 v6, 16, v5
 v_mfma_f32_16x16x32_bf16 v[188:191], a[236:239], a[172:175], v[188:191]
 v_and_b32 v5, s26, v5
 v_mul_f32 v6, v6, v38
 v_mfma_f32_16x16x32_bf16 v[184:187], a[236:239], a[164:167], v[184:187]
 v_mul_f32 v5, v5, v39
 v_cvt_pk_bf16_f32 v9, v6, v5
 v_mfma_f32_16x16x32_bf16 v[184:187], a[232:235], a[160:163], v[184:187]
 v_accvgpr_read_b32 v5, a22
 v_lshlrev_b32 v6, 16, v5
 v_mfma_f32_16x16x32_bf16 v[180:183], a[232:235], a[152:155], v[180:183]
 v_and_b32 v5, s26, v5
 v_mul_f32 v6, v6, v68
 v_mfma_f32_16x16x32_bf16 v[180:183], a[236:239], a[156:159], v[180:183]
 v_mul_f32 v5, v5, v69
 v_cvt_pk_bf16_f32 v10, v6, v5
 v_mfma_f32_16x16x32_bf16 v[176:179], a[236:239], a[148:151], v[176:179]
 v_accvgpr_read_b32 v5, a23
 v_lshlrev_b32 v6, 16, v5
 v_mfma_f32_16x16x32_bf16 v[176:179], a[232:235], a[144:147], v[176:179]
 v_and_b32 v5, s26, v5
 v_mul_f32 v6, v6, v70
 v_mfma_f32_16x16x32_bf16 v[172:175], a[232:235], a[136:139], v[172:175]
 v_mul_f32 v5, v5, v71
 v_cvt_pk_bf16_f32 v11, v6, v5
 v_mfma_f32_16x16x32_bf16 v[172:175], a[236:239], a[140:143], v[172:175]
 ds_write_b128 v3, v[8:11] offset:20480
 v_mfma_f32_16x16x32_bf16 v[168:171], a[236:239], a[132:135], v[168:171]
 buffer_store_dwordx4 v[8:11], v3, s[32:35], s68 offen offset:2048 sc1
 v_accvgpr_read_b32 v5, a52
 v_lshlrev_b32 v6, 16, v5
 v_and_b32 v5, s26, v5
 v_mfma_f32_16x16x32_bf16 v[168:171], a[232:235], a[128:131], v[168:171]
 v_mul_f32 v6, v6, v100
 v_mul_f32 v5, v5, v101
 s_waitcnt vmcnt(15)
 v_mfma_f32_16x16x32_bf16 v[200:203], a[192:195], a[128:131], v[200:203]
 v_cvt_pk_bf16_f32 v12, v6, v5
 v_accvgpr_read_b32 v5, a53
 v_mfma_f32_16x16x32_bf16 v[200:203], a[196:199], a[132:135], v[200:203]
 global_load_dwordx4 a[236:239], v0, s[70:71] offset:3072 sc1
 v_lshlrev_b32 v6, 16, v5
 v_mfma_f32_16x16x32_bf16 v[204:207], a[196:199], a[140:143], v[204:207]
 v_and_b32 v5, s26, v5
 s_waitcnt vmcnt(15)
 v_cmp_gt_i32 vcc, s27, v4
 s_and_b64 vcc, exec, vcc
 s_cbranch_vccnz Lspin_w
Lok_w:
 s_add_u32 s27, s27, 64
 v_mfma_f32_16x16x32_bf16 v[204:207], a[192:195], a[136:139], v[204:207]
 global_load_dwordx4 a[232:235], v0, s[70:71] offset:2048 sc1
 v_mul_f32 v6, v6, v102
 v_mfma_f32_16x16x32_bf16 v[208:211], a[192:195], a[144:147], v[208:211]
 v_mul_f32 v5, v5, v103
 v_cvt_pk_bf16_f32 v13, v6, v5
 s_add_u32 s70, s70, 1843200
 s_addc_u32 s71, s71, 0
 v_mfma_f32_16x16x32_bf16 v[208:211], a[196:199], a[148:151], v[208:211]
 v_accvgpr_read_b32 v5, a54
 v_lshlrev_b32 v6, 16, v5
 v_mfma_f32_16x16x32_bf16 v[212:215], a[196:199], a[156:159], v[212:215]
 v_and_b32 v5, s26, v5
 v_mul_f32 v6, v6, v132
 v_mfma_f32_16x16x32_bf16 v[212:215], a[192:195], a[152:155], v[212:215]
 v_mul_f32 v5, v5, v133
 v_cvt_pk_bf16_f32 v14, v6, v5
 v_mfma_f32_16x16x32_bf16 v[216:219], a[192:195], a[160:163], v[216:219]
 v_accvgpr_read_b32 v5, a55
 v_lshlrev_b32 v6, 16, v5
 v_mfma_f32_16x16x32_bf16 v[216:219], a[196:199], a[164:167], v[216:219]
 v_and_b32 v5, s26, v5
 v_mul_f32 v6, v6, v134
 v_mfma_f32_16x16x32_bf16 v[220:223], a[196:199], a[172:175], v[220:223]
 v_mul_f32 v5, v5, v135
 v_cvt_pk_bf16_f32 v15, v6, v5
 v_mfma_f32_16x16x32_bf16 v[220:223], a[192:195], a[168:171], v[220:223]
 ds_write_b128 v3, v[12:15] offset:21504
 v_mfma_f32_16x16x32_bf16 v[224:227], a[192:195], a[176:179], v[224:227]
 buffer_store_dwordx4 v[12:15], v3, s[32:35], s68 offen offset:3072 sc1
 v_accvgpr_read_b32 v5, a24
 v_lshlrev_b32 v6, 16, v5
 v_and_b32 v5, s26, v5
 v_mul_f32 v6, v6, v40
 v_mfma_f32_16x16x32_bf16 v[224:227], a[196:199], a[180:183], v[224:227]
 v_mul_f32 v5, v5, v41
 v_cvt_pk_bf16_f32 v8, v6, v5
 v_mfma_f32_16x16x32_bf16 v[228:231], a[196:199], a[188:191], v[228:231]
 v_accvgpr_read_b32 v5, a25
 v_lshlrev_b32 v6, 16, v5
 v_mfma_f32_16x16x32_bf16 v[228:231], a[192:195], a[184:187], v[228:231]
 v_and_b32 v5, s26, v5
 v_mul_f32 v6, v6, v42
 s_waitcnt vmcnt(14)
 v_mfma_f32_16x16x32_bf16 a[252:255], a[200:203], a[184:187], a[252:255]
 ds_read_b128 a[184:187], v1 offset:30720
 v_mul_f32 v5, v5, v43
 v_mfma_f32_16x16x32_bf16 a[252:255], a[204:207], a[188:191], a[252:255]
 global_load_dwordx4 a[196:199], v0, s[70:71] offset:-3072 sc1
 ds_read_b128 a[188:191], v1 offset:31744
 v_mfma_f32_16x16x32_bf16 a[248:251], a[204:207], a[180:183], a[248:251]
 ds_read_b128 a[180:183], v1 offset:27648
 v_cvt_pk_bf16_f32 v9, v6, v5
 v_mfma_f32_16x16x32_bf16 a[248:251], a[200:203], a[176:179], a[248:251]
 global_load_dwordx4 a[192:195], v0, s[70:71] offset:-4096 sc1
 ds_read_b128 a[176:179], v1 offset:26624
 v_accvgpr_read_b32 v5, a26
 v_lshlrev_b32 v6, 16, v5
 v_mfma_f32_16x16x32_bf16 v[252:255], a[200:203], a[168:171], v[252:255]
 ds_read_b128 a[168:171], v1 offset:22528
 v_and_b32 v5, s26, v5
 v_mfma_f32_16x16x32_bf16 v[252:255], a[204:207], a[172:175], v[252:255]
 ds_read_b128 a[172:175], v1 offset:23552
 v_mul_f32 v6, v6, v72
 v_mfma_f32_16x16x32_bf16 v[248:251], a[204:207], a[164:167], v[248:251]
 ds_read_b128 a[164:167], v1 offset:19456
 v_mul_f32 v5, v5, v73
 v_mfma_f32_16x16x32_bf16 v[248:251], a[200:203], a[160:163], v[248:251]
 ds_read_b128 a[160:163], v1 offset:18432
 v_cvt_pk_bf16_f32 v10, v6, v5
 v_mfma_f32_16x16x32_bf16 v[244:247], a[200:203], a[152:155], v[244:247]
 ds_read_b128 a[152:155], v1 offset:14336
 v_accvgpr_read_b32 v5, a27
 v_mfma_f32_16x16x32_bf16 v[244:247], a[204:207], a[156:159], v[244:247]
 ds_read_b128 a[156:159], v1 offset:15360
 v_lshlrev_b32 v6, 16, v5
 v_mfma_f32_16x16x32_bf16 v[240:243], a[204:207], a[148:151], v[240:243]
 ds_read_b128 a[148:151], v1 offset:11264
 v_and_b32 v5, s26, v5
 v_mfma_f32_16x16x32_bf16 v[240:243], a[200:203], a[144:147], v[240:243]
 ds_read_b128 a[144:147], v1 offset:10240
 v_mul_f32 v6, v6, v74
 v_mfma_f32_16x16x32_bf16 v[236:239], a[200:203], a[136:139], v[236:239]
 ds_read_b128 a[136:139], v1 offset:6144
 v_mul_f32 v5, v5, v75
 v_mfma_f32_16x16x32_bf16 v[236:239], a[204:207], a[140:143], v[236:239]
 ds_read_b128 a[140:143], v1 offset:7168
 v_cvt_pk_bf16_f32 v11, v6, v5
 v_mfma_f32_16x16x32_bf16 v[232:235], a[204:207], a[132:135], v[232:235]
 ds_read_b128 a[132:135], v1 offset:3072
 ds_write_b128 v3, v[8:11] offset:24576
 s_add_u32 s68, s29, 12288
 buffer_store_dwordx4 v[8:11], v3, s[32:35], s68 offen sc1
 v_accvgpr_read_b32 v5, a56
 v_lshlrev_b32 v6, 16, v5
 v_and_b32 v5, s26, v5
 v_mul_f32 v6, v6, v104
 v_mfma_f32_16x16x32_bf16 v[232:235], a[200:203], a[128:131], v[232:235]
 ds_read_b128 a[128:131], v1 offset:2048
 v_mul_f32 v5, v5, v105
 v_cvt_pk_bf16_f32 v12, v6, v5
 s_waitcnt vmcnt(14) lgkmcnt(9)
 v_mfma_f32_16x16x32_bf16 v[164:167], a[208:211], a[184:187], v[164:167]
 v_accvgpr_read_b32 v5, a57
 v_lshlrev_b32 v6, 16, v5
 v_mfma_f32_16x16x32_bf16 v[164:167], a[212:215], a[188:191], v[164:167]
 global_load_dwordx4 a[204:207], v0, s[70:71] offset:-1024 sc1
 v_and_b32 v5, s26, v5
 v_mfma_f32_16x16x32_bf16 v[160:163], a[212:215], a[180:183], v[160:163]
 v_mul_f32 v6, v6, v106
 v_mul_f32 v5, v5, v107
 v_mfma_f32_16x16x32_bf16 v[160:163], a[208:211], a[176:179], v[160:163]
 global_load_dwordx4 a[200:203], v0, s[70:71] offset:-2048 sc1
 v_cvt_pk_bf16_f32 v13, v6, v5
 v_mfma_f32_16x16x32_bf16 v[156:159], a[208:211], a[168:171], v[156:159]
 v_accvgpr_read_b32 v5, a58
 v_accvgpr_read_b32 v7, a240
 v_mfma_f32_16x16x32_bf16 v[156:159], a[212:215], a[172:175], v[156:159]
 v_lshlrev_b32 v6, 16, v5
 v_and_b32 v5, s26, v5
 v_mfma_f32_16x16x32_bf16 v[152:155], a[212:215], a[164:167], v[152:155]
 v_mul_f32 v6, v6, v7
 v_accvgpr_read_b32 v7, a241
 v_mfma_f32_16x16x32_bf16 v[152:155], a[208:211], a[160:163], v[152:155]
 v_mul_f32 v5, v5, v7
 v_cvt_pk_bf16_f32 v14, v6, v5
 s_waitcnt lgkmcnt(0)
 v_mfma_f32_16x16x32_bf16 v[148:151], a[208:211], a[152:155], v[148:151]
 v_accvgpr_read_b32 v5, a59
 v_accvgpr_read_b32 v7, a242
 v_mfma_f32_16x16x32_bf16 v[148:151], a[212:215], a[156:159], v[148:151]
 v_lshlrev_b32 v6, 16, v5
 v_and_b32 v5, s26, v5
 v_mfma_f32_16x16x32_bf16 v[144:147], a[212:215], a[148:151], v[144:147]
 v_mul_f32 v6, v6, v7
 v_accvgpr_read_b32 v7, a243
 v_mfma_f32_16x16x32_bf16 v[144:147], a[208:211], a[144:147], v[144:147]
 v_mul_f32 v5, v5, v7
 v_cvt_pk_bf16_f32 v15, v6, v5
 v_mfma_f32_16x16x32_bf16 v[140:143], a[208:211], a[136:139], v[140:143]
 ds_write_b128 v3, v[12:15] offset:25600
 v_mfma_f32_16x16x32_bf16 v[140:143], a[212:215], a[140:143], v[140:143]
 buffer_store_dwordx4 v[12:15], v3, s[32:35], s68 offen offset:1024 sc1
 v_accvgpr_read_b32 v5, a28
 v_lshlrev_b32 v6, 16, v5
 v_and_b32 v5, s26, v5
 v_mul_f32 v6, v6, v44
 v_mfma_f32_16x16x32_bf16 v[136:139], a[212:215], a[132:135], v[136:139]
 v_mul_f32 v5, v5, v45
 v_cvt_pk_bf16_f32 v8, v6, v5
 v_mfma_f32_16x16x32_bf16 v[136:139], a[208:211], a[128:131], v[136:139]
 v_accvgpr_read_b32 v5, a29
 v_lshlrev_b32 v6, 16, v5
 s_waitcnt vmcnt(14)
 v_mfma_f32_16x16x32_bf16 v[168:171], a[216:219], a[128:131], v[168:171]
 v_and_b32 v5, s26, v5
 v_mul_f32 v6, v6, v46
 v_mfma_f32_16x16x32_bf16 v[168:171], a[220:223], a[132:135], v[168:171]
 global_load_dwordx4 a[212:215], v0, s[70:71] offset:1024 sc1
 v_mul_f32 v5, v5, v47
 v_mfma_f32_16x16x32_bf16 v[172:175], a[220:223], a[140:143], v[172:175]
 v_cvt_pk_bf16_f32 v9, v6, v5
 v_accvgpr_read_b32 v5, a30
 v_mfma_f32_16x16x32_bf16 v[172:175], a[216:219], a[136:139], v[172:175]
 global_load_dwordx4 a[208:211], v0, s[70:71] offset:0 sc1
 v_lshlrev_b32 v6, 16, v5
 v_mfma_f32_16x16x32_bf16 v[176:179], a[216:219], a[144:147], v[176:179]
 v_and_b32 v5, s26, v5
 v_mul_f32 v6, v6, v76
 v_mfma_f32_16x16x32_bf16 v[176:179], a[220:223], a[148:151], v[176:179]
 v_mul_f32 v5, v5, v77
 v_cvt_pk_bf16_f32 v10, v6, v5
 v_mfma_f32_16x16x32_bf16 v[180:183], a[220:223], a[156:159], v[180:183]
 v_accvgpr_read_b32 v5, a31
 v_lshlrev_b32 v6, 16, v5
 v_mfma_f32_16x16x32_bf16 v[180:183], a[216:219], a[152:155], v[180:183]
 v_and_b32 v5, s26, v5
 v_mul_f32 v6, v6, v78
 v_mfma_f32_16x16x32_bf16 v[184:187], a[216:219], a[160:163], v[184:187]
 v_mul_f32 v5, v5, v79
 v_cvt_pk_bf16_f32 v11, v6, v5
 v_mfma_f32_16x16x32_bf16 v[184:187], a[220:223], a[164:167], v[184:187]
 ds_write_b128 v3, v[8:11] offset:28672
 v_mfma_f32_16x16x32_bf16 v[188:191], a[220:223], a[172:175], v[188:191]
 buffer_store_dwordx4 v[8:11], v3, s[32:35], s68 offen offset:2048 sc1
 v_accvgpr_read_b32 v5, a60
 v_lshlrev_b32 v6, 16, v5
 v_and_b32 v5, s26, v5
 v_mul_f32 v6, v6, v108
 v_mfma_f32_16x16x32_bf16 v[188:191], a[216:219], a[168:171], v[188:191]
 v_mul_f32 v5, v5, v109
 v_cvt_pk_bf16_f32 v12, v6, v5
 v_mfma_f32_16x16x32_bf16 v[192:195], a[216:219], a[176:179], v[192:195]
 v_accvgpr_read_b32 v5, a61
 v_lshlrev_b32 v6, 16, v5
 v_mfma_f32_16x16x32_bf16 v[192:195], a[220:223], a[180:183], v[192:195]
 v_and_b32 v5, s26, v5
 v_mul_f32 v6, v6, v110
 v_mfma_f32_16x16x32_bf16 v[196:199], a[220:223], a[188:191], v[196:199]
 v_mul_f32 v5, v5, v111
 v_cvt_pk_bf16_f32 v13, v6, v5
 v_mfma_f32_16x16x32_bf16 v[196:199], a[216:219], a[184:187], v[196:199]
 v_accvgpr_read_b32 v5, a62
 v_accvgpr_read_b32 v7, a244
 s_waitcnt vmcnt(13)
 v_mfma_f32_16x16x32_bf16 v[228:231], a[224:227], a[184:187], v[228:231]
 v_lshlrev_b32 v6, 16, v5
 v_and_b32 v5, s26, v5
 v_mfma_f32_16x16x32_bf16 v[228:231], a[228:231], a[188:191], v[228:231]
 global_load_dwordx4 a[220:223], v0, s[70:71] offset:3072 sc1
 v_mul_f32 v6, v6, v7
 v_mfma_f32_16x16x32_bf16 v[224:227], a[228:231], a[180:183], v[224:227]
 v_accvgpr_read_b32 v7, a245
 v_mul_f32 v5, v5, v7
 v_mfma_f32_16x16x32_bf16 v[224:227], a[224:227], a[176:179], v[224:227]
 global_load_dwordx4 a[216:219], v0, s[70:71] offset:2048 sc1
 v_cvt_pk_bf16_f32 v14, v6, v5
 v_mfma_f32_16x16x32_bf16 v[220:223], a[224:227], a[168:171], v[220:223]
 v_accvgpr_read_b32 v5, a63
 v_accvgpr_read_b32 v7, a246
 s_add_u32 s70, s70, 8192
 s_addc_u32 s71, s71, 0
 v_mfma_f32_16x16x32_bf16 v[220:223], a[228:231], a[172:175], v[220:223]
 v_lshlrev_b32 v6, 16, v5
 v_and_b32 v5, s26, v5
 v_mfma_f32_16x16x32_bf16 v[216:219], a[228:231], a[164:167], v[216:219]
 v_mul_f32 v6, v6, v7
 v_accvgpr_read_b32 v7, a247
 v_mfma_f32_16x16x32_bf16 v[216:219], a[224:227], a[160:163], v[216:219]
 v_mul_f32 v5, v5, v7
 v_cvt_pk_bf16_f32 v15, v6, v5
 v_mfma_f32_16x16x32_bf16 v[212:215], a[224:227], a[152:155], v[212:215]
 ds_write_b128 v3, v[12:15] offset:29696
 v_mfma_f32_16x16x32_bf16 v[212:215], a[228:231], a[156:159], v[212:215]
 buffer_store_dwordx4 v[12:15], v3, s[32:35], s68 offen offset:3072 sc1
 v_mfma_f32_16x16x32_bf16 v[208:211], a[228:231], a[148:151], v[208:211]
 s_waitcnt lgkmcnt(0)
 s_barrier
 v_mfma_f32_16x16x32_bf16 v[208:211], a[224:227], a[144:147], v[208:211]
 v_and_b32 v1, 1023, v3
 v_add_u32 v2, 65536, v1
 v_mfma_f32_16x16x32_bf16 v[204:207], a[224:227], a[136:139], v[204:207]
 v_mfma_f32_16x16x32_bf16 v[204:207], a[228:231], a[140:143], v[204:207]
 v_mfma_f32_16x16x32_bf16 v[200:203], a[228:231], a[132:135], v[200:203]
 v_mfma_f32_16x16x32_bf16 v[200:203], a[224:227], a[128:131], v[200:203]
 s_waitcnt vmcnt(13)
 v_mfma_f32_16x16x32_bf16 v[232:235], a[232:235], a[128:131], v[232:235]
 ds_read_b128 a[128:131], v1
 v_mfma_f32_16x16x32_bf16 v[232:235], a[236:239], a[132:135], v[232:235]
 global_load_dwordx4 a[228:231], v0, s[70:71] offset:-3072 sc1
 ds_read_b128 a[132:135], v1 offset:1024
 v_mfma_f32_16x16x32_bf16 v[236:239], a[236:239], a[140:143], v[236:239]
 ds_read_b128 a[140:143], v1 offset:5120
 v_mfma_f32_16x16x32_bf16 v[236:239], a[232:235], a[136:139], v[236:239]
 global_load_dwordx4 a[224:227], v0, s[70:71] offset:-4096 sc1
 ds_read_b128 a[136:139], v1 offset:4096
 v_mfma_f32_16x16x32_bf16 v[240:243], a[232:235], a[144:147], v[240:243]
 ds_read_b128 a[144:147], v1 offset:8192
 v_mfma_f32_16x16x32_bf16 v[240:243], a[236:239], a[148:151], v[240:243]
 ds_read_b128 a[148:151], v1 offset:9216
 v_mfma_f32_16x16x32_bf16 v[244:247], a[236:239], a[156:159], v[244:247]
 ds_read_b128 a[156:159], v1 offset:13312
 v_mfma_f32_16x16x32_bf16 v[244:247], a[232:235], a[152:155], v[244:247]
 ds_read_b128 a[152:155], v1 offset:12288
 v_mfma_f32_16x16x32_bf16 v[248:251], a[232:235], a[160:163], v[248:251]
 ds_read_b128 a[160:163], v1 offset:16384
 v_mfma_f32_16x16x32_bf16 v[248:251], a[236:239], a[164:167], v[248:251]
 ds_read_b128 a[164:167], v1 offset:17408
 v_mfma_f32_16x16x32_bf16 v[252:255], a[236:239], a[172:175], v[252:255]
 ds_read_b128 a[172:175], v1 offset:21504
 v_mfma_f32_16x16x32_bf16 v[252:255], a[232:235], a[168:171], v[252:255]
 ds_read_b128 a[168:171], v1 offset:20480
 v_mfma_f32_16x16x32_bf16 a[248:251], a[232:235], a[176:179], a[248:251]
 ds_read_b128 a[176:179], v1 offset:24576
 v_mfma_f32_16x16x32_bf16 a[248:251], a[236:239], a[180:183], a[248:251]
 ds_read_b128 a[180:183], v1 offset:25600
 v_mfma_f32_16x16x32_bf16 a[252:255], a[236:239], a[188:191], a[252:255]
 global_load_dwordx4 a[236:239], v0, s[70:71] offset:-1024 sc1
 ds_read_b128 a[188:191], v1 offset:29696
 v_mfma_f32_16x16x32_bf16 a[252:255], a[232:235], a[184:187], a[252:255]
 global_load_dwordx4 a[232:235], v0, s[70:71] offset:-2048 sc1
 ds_read_b128 a[184:187], v1 offset:28672
 s_waitcnt vmcnt(14) lgkmcnt(8)
 v_mfma_f32_16x16x32_bf16 v[16:19], a[192:195], a[128:131], v[16:19]
 v_accvgpr_read_b32 v5, a64
 v_lshlrev_b32 v6, 16, v5
 v_mfma_f32_16x16x32_bf16 v[16:19], a[196:199], a[132:135], v[16:19]
 v_and_b32 v5, s26, v5
 v_mfma_f32_16x16x32_bf16 v[20:23], a[196:199], a[140:143], v[20:23]
 v_mul_f32 v6, v6, v136
 v_mul_f32 v5, v5, v137
 v_mfma_f32_16x16x32_bf16 v[20:23], a[192:195], a[136:139], v[20:23]
 v_cvt_pk_bf16_f32 v8, v6, v5
 v_accvgpr_read_b32 v5, a65
 v_mfma_f32_16x16x32_bf16 v[24:27], a[192:195], a[144:147], v[24:27]
 v_lshlrev_b32 v6, 16, v5
 v_mfma_f32_16x16x32_bf16 v[24:27], a[196:199], a[148:151], v[24:27]
 v_and_b32 v5, s26, v5
 v_mul_f32 v6, v6, v138
 v_mfma_f32_16x16x32_bf16 v[28:31], a[196:199], a[156:159], v[28:31]
 v_mul_f32 v5, v5, v139
 v_cvt_pk_bf16_f32 v9, v6, v5
 v_mfma_f32_16x16x32_bf16 v[28:31], a[192:195], a[152:155], v[28:31]
 v_accvgpr_read_b32 v5, a66
 v_lshlrev_b32 v6, 16, v5
 s_waitcnt lgkmcnt(0)
 v_mfma_f32_16x16x32_bf16 v[32:35], a[192:195], a[160:163], v[32:35]
 v_and_b32 v5, s26, v5
 v_mul_f32 v6, v6, v168
 v_mfma_f32_16x16x32_bf16 v[32:35], a[196:199], a[164:167], v[32:35]
 v_mul_f32 v5, v5, v169
 v_cvt_pk_bf16_f32 v10, v6, v5
 v_mfma_f32_16x16x32_bf16 v[36:39], a[196:199], a[172:175], v[36:39]
 v_accvgpr_read_b32 v5, a67
 v_lshlrev_b32 v6, 16, v5
 v_mfma_f32_16x16x32_bf16 v[36:39], a[192:195], a[168:171], v[36:39]
 v_and_b32 v5, s26, v5
 v_mul_f32 v6, v6, v170
 v_mfma_f32_16x16x32_bf16 v[40:43], a[192:195], a[176:179], v[40:43]
 v_mul_f32 v5, v5, v171
 v_cvt_pk_bf16_f32 v11, v6, v5
 v_mfma_f32_16x16x32_bf16 v[40:43], a[196:199], a[180:183], v[40:43]
 ds_write_b128 v3, v[8:11] offset:2048
 v_mfma_f32_16x16x32_bf16 v[44:47], a[196:199], a[188:191], v[44:47]
 s_add_u32 s68, s29, 16384
 buffer_store_dwordx4 v[8:11], v3, s[32:35], s68 offen sc1
 v_mfma_f32_16x16x32_bf16 v[44:47], a[192:195], a[184:187], v[44:47]
 v_accvgpr_read_b32 v5, a96
 s_waitcnt vmcnt(12)
 v_mfma_f32_16x16x32_bf16 v[76:79], a[200:203], a[184:187], v[76:79]
 v_lshlrev_b32 v6, 16, v5
 v_mfma_f32_16x16x32_bf16 v[76:79], a[204:207], a[188:191], v[76:79]
 global_load_dwordx4 a[196:199], v0, s[70:71] offset:1024 sc1
 v_and_b32 v5, s26, v5
 v_mfma_f32_16x16x32_bf16 v[72:75], a[204:207], a[180:183], v[72:75]
 v_mul_f32 v6, v6, v200
 v_mul_f32 v5, v5, v201
 v_mfma_f32_16x16x32_bf16 v[72:75], a[200:203], a[176:179], v[72:75]
 global_load_dwordx4 a[192:195], v0, s[70:71] offset:0 sc1
 v_cvt_pk_bf16_f32 v12, v6, v5
 v_mfma_f32_16x16x32_bf16 v[68:71], a[200:203], a[168:171], v[68:71]
 v_accvgpr_read_b32 v5, a97
 v_lshlrev_b32 v6, 16, v5
 v_mfma_f32_16x16x32_bf16 v[68:71], a[204:207], a[172:175], v[68:71]
 v_and_b32 v5, s26, v5
 v_mul_f32 v6, v6, v202
 v_mfma_f32_16x16x32_bf16 v[64:67], a[204:207], a[164:167], v[64:67]
 v_mul_f32 v5, v5, v203
 v_cvt_pk_bf16_f32 v13, v6, v5
 v_mfma_f32_16x16x32_bf16 v[64:67], a[200:203], a[160:163], v[64:67]
 v_accvgpr_read_b32 v5, a98
 v_lshlrev_b32 v6, 16, v5
 v_mfma_f32_16x16x32_bf16 v[60:63], a[200:203], a[152:155], v[60:63]
 v_and_b32 v5, s26, v5
 v_mul_f32 v6, v6, v232
 v_mfma_f32_16x16x32_bf16 v[60:63], a[204:207], a[156:159], v[60:63]
 v_mul_f32 v5, v5, v233
 v_cvt_pk_bf16_f32 v14, v6, v5
 v_mfma_f32_16x16x32_bf16 v[56:59], a[204:207], a[148:151], v[56:59]
 v_accvgpr_read_b32 v5, a99
 v_lshlrev_b32 v6, 16, v5
 v_mfma_f32_16x16x32_bf16 v[56:59], a[200:203], a[144:147], v[56:59]
 v_and_b32 v5, s26, v5
 v_mul_f32 v6, v6, v234
 v_mfma_f32_16x16x32_bf16 v[52:55], a[200:203], a[136:139], v[52:55]
 v_mul_f32 v5, v5, v235
 v_cvt_pk_bf16_f32 v15, v6, v5
 v_mfma_f32_16x16x32_bf16 v[52:55], a[204:207], a[140:143], v[52:55]
 ds_write_b128 v3, v[12:15] offset:3072
 v_mfma_f32_16x16x32_bf16 v[48:51], a[204:207], a[132:135], v[48:51]
 buffer_store_dwordx4 v[12:15], v3, s[32:35], s68 offen offset:1024 sc1
 v_mfma_f32_16x16x32_bf16 v[48:51], a[200:203], a[128:131], v[48:51]
 v_accvgpr_read_b32 v5, a68
 v_lshlrev_b32 v6, 16, v5
 s_waitcnt vmcnt(12)
 v_mfma_f32_16x16x32_bf16 v[80:83], a[208:211], a[128:131], v[80:83]
 v_and_b32 v5, s26, v5
 v_mul_f32 v6, v6, v140
 v_mfma_f32_16x16x32_bf16 v[80:83], a[212:215], a[132:135], v[80:83]
 global_load_dwordx4 a[204:207], v0, s[70:71] offset:3072 sc1
 v_mul_f32 v5, v5, v141
 v_mfma_f32_16x16x32_bf16 v[84:87], a[212:215], a[140:143], v[84:87]
 v_cvt_pk_bf16_f32 v8, v6, v5
 v_accvgpr_read_b32 v5, a69
 v_mfma_f32_16x16x32_bf16 v[84:87], a[208:211], a[136:139], v[84:87]
 global_load_dwordx4 a[200:203], v0, s[70:71] offset:2048 sc1
 v_lshlrev_b32 v6, 16, v5
 v_mfma_f32_16x16x32_bf16 v[88:91], a[208:211], a[144:147], v[88:91]
 v_and_b32 v5, s26, v5
 v_mul_f32 v6, v6, v142
 s_add_u32 s70, s70, 8192
 s_addc_u32 s71, s71, 0
 v_mfma_f32_16x16x32_bf16 v[88:91], a[212:215], a[148:151], v[88:91]
 v_mul_f32 v5, v5, v143
 v_cvt_pk_bf16_f32 v9, v6, v5
 v_mfma_f32_16x16x32_bf16 v[92:95], a[212:215], a[156:159], v[92:95]
 v_accvgpr_read_b32 v5, a70
 v_lshlrev_b32 v6, 16, v5
 v_mfma_f32_16x16x32_bf16 v[92:95], a[208:211], a[152:155], v[92:95]
 v_and_b32 v5, s26, v5
 v_mul_f32 v6, v6, v172
 v_mfma_f32_16x16x32_bf16 v[96:99], a[208:211], a[160:163], v[96:99]
 v_mul_f32 v5, v5, v173
 v_cvt_pk_bf16_f32 v10, v6, v5
 v_mfma_f32_16x16x32_bf16 v[96:99], a[212:215], a[164:167], v[96:99]
 v_accvgpr_read_b32 v5, a71
 v_lshlrev_b32 v6, 16, v5
 v_mfma_f32_16x16x32_bf16 v[100:103], a[212:215], a[172:175], v[100:103]
 v_and_b32 v5, s26, v5
 v_mul_f32 v6, v6, v174
 v_mfma_f32_16x16x32_bf16 v[100:103], a[208:211], a[168:171], v[100:103]
 v_mul_f32 v5, v5, v175
 v_cvt_pk_bf16_f32 v11, v6, v5
 v_mfma_f32_16x16x32_bf16 v[104:107], a[208:211], a[176:179], v[104:107]
 ds_write_b128 v3, v[8:11] offset:6144
 v_mfma_f32_16x16x32_bf16 v[104:107], a[212:215], a[180:183], v[104:107]
 buffer_store_dwordx4 v[8:11], v3, s[32:35], s68 offen offset:2048 sc1
 v_accvgpr_read_b32 v5, a100
 v_lshlrev_b32 v6, 16, v5
 v_and_b32 v5, s26, v5
 v_mul_f32 v6, v6, v204
 v_mfma_f32_16x16x32_bf16 v[108:111], a[212:215], a[188:191], v[108:111]
 v_mul_f32 v5, v5, v205
 v_cvt_pk_bf16_f32 v12, v6, v5
 v_mfma_f32_16x16x32_bf16 v[108:111], a[208:211], a[184:187], v[108:111]
 v_accvgpr_read_b32 v5, a101
 v_lshlrev_b32 v6, 16, v5
 s_waitcnt vmcnt(12)
 v_mfma_f32_16x16x32_bf16 a[244:247], a[216:219], a[184:187], a[244:247]
 ds_read_b128 a[184:187], v1 offset:61440
 v_and_b32 v5, s26, v5
 v_mfma_f32_16x16x32_bf16 a[244:247], a[220:223], a[188:191], a[244:247]
 global_load_dwordx4 a[212:215], v0, s[70:71] offset:-3072 sc1
 ds_read_b128 a[188:191], v1 offset:62464
 v_mfma_f32_16x16x32_bf16 a[240:243], a[220:223], a[180:183], a[240:243]
 ds_read_b128 a[180:183], v1 offset:58368
 v_mul_f32 v6, v6, v206
 v_mfma_f32_16x16x32_bf16 a[240:243], a[216:219], a[176:179], a[240:243]
 global_load_dwordx4 a[208:211], v0, s[70:71] offset:-4096 sc1
 ds_read_b128 a[176:179], v1 offset:57344
 v_mfma_f32_16x16x32_bf16 v[132:135], a[216:219], a[168:171], v[132:135]
 ds_read_b128 a[168:171], v1 offset:53248
 v_mul_f32 v5, v5, v207
 v_mfma_f32_16x16x32_bf16 v[132:135], a[220:223], a[172:175], v[132:135]
 ds_read_b128 a[172:175], v1 offset:54272
 v_cvt_pk_bf16_f32 v13, v6, v5
 v_mfma_f32_16x16x32_bf16 v[128:131], a[220:223], a[164:167], v[128:131]
 ds_read_b128 a[164:167], v1 offset:50176
 v_accvgpr_read_b32 v5, a102
 v_lshlrev_b32 v6, 16, v5
 v_mfma_f32_16x16x32_bf16 v[128:131], a[216:219], a[160:163], v[128:131]
 ds_read_b128 a[160:163], v1 offset:49152
 v_and_b32 v5, s26, v5
 v_mul_f32 v6, v6, v236
 v_mfma_f32_16x16x32_bf16 v[124:127], a[216:219], a[152:155], v[124:127]
 ds_read_b128 a[152:155], v1 offset:45056
 v_mul_f32 v5, v5, v237
 v_mfma_f32_16x16x32_bf16 v[124:127], a[220:223], a[156:159], v[124:127]
 ds_read_b128 a[156:159], v1 offset:46080
 v_cvt_pk_bf16_f32 v14, v6, v5
 v_mfma_f32_16x16x32_bf16 v[120:123], a[220:223], a[148:151], v[120:123]
 ds_read_b128 a[148:151], v1 offset:41984
 v_accvgpr_read_b32 v5, a103
 v_mfma_f32_16x16x32_bf16 v[120:123], a[216:219], a[144:147], v[120:123]
 ds_read_b128 a[144:147], v1 offset:40960
 v_lshlrev_b32 v6, 16, v5
 v_mfma_f32_16x16x32_bf16 v[116:119], a[216:219], a[136:139], v[116:119]
 ds_read_b128 a[136:139], v1 offset:36864
 v_and_b32 v5, s26, v5
 v_mfma_f32_16x16x32_bf16 v[116:119], a[220:223], a[140:143], v[116:119]
 ds_read_b128 a[140:143], v1 offset:37888
 v_mul_f32 v6, v6, v238
 v_mfma_f32_16x16x32_bf16 v[112:115], a[220:223], a[132:135], v[112:115]
 ds_read_b128 a[132:135], v1 offset:33792
 v_mul_f32 v5, v5, v239
 v_mfma_f32_16x16x32_bf16 v[112:115], a[216:219], a[128:131], v[112:115]
 ds_read_b128 a[128:131], v1 offset:32768
 v_cvt_pk_bf16_f32 v15, v6, v5
 s_waitcnt vmcnt(11) lgkmcnt(8)
 v_mfma_f32_16x16x32_bf16 v[44:47], a[224:227], a[184:187], v[44:47]
 ds_write_b128 v3, v[12:15] offset:7168
 v_mfma_f32_16x16x32_bf16 v[44:47], a[228:231], a[188:191], v[44:47]
 buffer_store_dwordx4 v[12:15], v3, s[32:35], s68 offen offset:3072 sc1
 global_load_dwordx4 a[220:223], v0, s[70:71] offset:-1024 sc1
 v_accvgpr_read_b32 v5, a72
 v_lshlrev_b32 v6, 16, v5
 v_and_b32 v5, s26, v5
 v_mfma_f32_16x16x32_bf16 v[40:43], a[228:231], a[180:183], v[40:43]
 v_mul_f32 v6, v6, v144
 v_mul_f32 v5, v5, v145
 v_mfma_f32_16x16x32_bf16 v[40:43], a[224:227], a[176:179], v[40:43]
 global_load_dwordx4 a[216:219], v0, s[70:71] offset:-2048 sc1
 v_cvt_pk_bf16_f32 v8, v6, v5
 v_mfma_f32_16x16x32_bf16 v[36:39], a[224:227], a[168:171], v[36:39]
 v_accvgpr_read_b32 v5, a73
 v_lshlrev_b32 v6, 16, v5
 v_mfma_f32_16x16x32_bf16 v[36:39], a[228:231], a[172:175], v[36:39]
 v_and_b32 v5, s26, v5
 v_mul_f32 v6, v6, v146
 v_mfma_f32_16x16x32_bf16 v[32:35], a[228:231], a[164:167], v[32:35]
 v_mul_f32 v5, v5, v147
 v_cvt_pk_bf16_f32 v9, v6, v5
 v_mfma_f32_16x16x32_bf16 v[32:35], a[224:227], a[160:163], v[32:35]
 v_accvgpr_read_b32 v5, a74
 v_lshlrev_b32 v6, 16, v5
 s_waitcnt lgkmcnt(1)
 v_mfma_f32_16x16x32_bf16 v[28:31], a[224:227], a[152:155], v[28:31]
 v_and_b32 v5, s26, v5
 v_mul_f32 v6, v6, v176
 v_mfma_f32_16x16x32_bf16 v[28:31], a[228:231], a[156:159], v[28:31]
 v_mul_f32 v5, v5, v177
 v_cvt_pk_bf16_f32 v10, v6, v5
 v_mfma_f32_16x16x32_bf16 v[24:27], a[228:231], a[148:151], v[24:27]
 v_accvgpr_read_b32 v5, a75
 v_lshlrev_b32 v6, 16, v5
 v_mfma_f32_16x16x32_bf16 v[24:27], a[224:227], a[144:147], v[24:27]
 v_and_b32 v5, s26, v5
 v_mul_f32 v6, v6, v178
 v_mfma_f32_16x16x32_bf16 v[20:23], a[224:227], a[136:139], v[20:23]
 v_mul_f32 v5, v5, v179
 v_cvt_pk_bf16_f32 v11, v6, v5
 v_mfma_f32_16x16x32_bf16 v[20:23], a[228:231], a[140:143], v[20:23]
 ds_write_b128 v3, v[8:11] offset:10240
 s_add_u32 s68, s29, 20480
 v_mfma_f32_16x16x32_bf16 v[16:19], a[228:231], a[132:135], v[16:19]
 buffer_store_dwordx4 v[8:11], v3, s[32:35], s68 offen sc1
 v_accvgpr_read_b32 v5, a104
 v_lshlrev_b32 v6, 16, v5
 v_mfma_f32_16x16x32_bf16 v[16:19], a[224:227], a[128:131], v[16:19]
 v_and_b32 v5, s26, v5
 v_mul_f32 v6, v6, v208
 s_waitcnt vmcnt(13)
 v_mfma_f32_16x16x32_bf16 v[48:51], a[232:235], a[128:131], v[48:51]
 v_mul_f32 v5, v5, v209
 v_cvt_pk_bf16_f32 v12, v6, v5
 v_mfma_f32_16x16x32_bf16 v[48:51], a[236:239], a[132:135], v[48:51]
 global_load_dwordx4 a[228:231], v0, s[70:71] offset:1024 sc1
 v_accvgpr_read_b32 v5, a105
 v_mfma_f32_16x16x32_bf16 v[52:55], a[236:239], a[140:143], v[52:55]
 v_lshlrev_b32 v6, 16, v5
 v_and_b32 v5, s26, v5
 v_mfma_f32_16x16x32_bf16 v[52:55], a[232:235], a[136:139], v[52:55]
 global_load_dwordx4 a[224:227], v0, s[70:71] offset:0 sc1
 v_mul_f32 v6, v6, v210
 v_mfma_f32_16x16x32_bf16 v[56:59], a[232:235], a[144:147], v[56:59]
 v_mul_f32 v5, v5, v211
 v_cvt_pk_bf16_f32 v13, v6, v5
 v_mfma_f32_16x16x32_bf16 v[56:59], a[236:239], a[148:151], v[56:59]
 v_accvgpr_read_b32 v5, a106
 v_lshlrev_b32 v6, 16, v5
 v_mfma_f32_16x16x32_bf16 v[60:63], a[236:239], a[156:159], v[60:63]
 v_and_b32 v5, s26, v5
 v_mfma_f32_16x16x32_bf16 v[60:63], a[232:235], a[152:155], v[60:63]
 v_mul_f32 v6, v6, v240
 v_mul_f32 v5, v5, v241
 v_mfma_f32_16x16x32_bf16 v[64:67], a[232:235], a[160:163], v[64:67]
 v_cvt_pk_bf16_f32 v14, v6, v5
 v_accvgpr_read_b32 v5, a107
 v_mfma_f32_16x16x32_bf16 v[64:67], a[236:239], a[164:167], v[64:67]
 v_lshlrev_b32 v6, 16, v5
 v_mfma_f32_16x16x32_bf16 v[68:71], a[236:239], a[172:175], v[68:71]
 v_and_b32 v5, s26, v5
 v_mul_f32 v6, v6, v242
 v_mfma_f32_16x16x32_bf16 v[68:71], a[232:235], a[168:171], v[68:71]
 v_mul_f32 v5, v5, v243
 v_cvt_pk_bf16_f32 v15, v6, v5
 v_mfma_f32_16x16x32_bf16 v[72:75], a[232:235], a[176:179], v[72:75]
 ds_write_b128 v3, v[12:15] offset:11264
 v_mfma_f32_16x16x32_bf16 v[72:75], a[236:239], a[180:183], v[72:75]
 buffer_store_dwordx4 v[12:15], v3, s[32:35], s68 offen offset:1024 sc1
 v_accvgpr_read_b32 v5, a76
 v_lshlrev_b32 v6, 16, v5
 v_mfma_f32_16x16x32_bf16 v[76:79], a[236:239], a[188:191], v[76:79]
 v_and_b32 v5, s26, v5
 v_mul_f32 v6, v6, v148
 v_mfma_f32_16x16x32_bf16 v[76:79], a[232:235], a[184:187], v[76:79]
 v_mul_f32 v5, v5, v149
 v_cvt_pk_bf16_f32 v8, v6, v5
 s_waitcnt vmcnt(13)
 v_mfma_f32_16x16x32_bf16 v[108:111], a[192:195], a[184:187], v[108:111]
 v_accvgpr_read_b32 v5, a77
 v_lshlrev_b32 v6, 16, v5
 v_mfma_f32_16x16x32_bf16 v[108:111], a[196:199], a[188:191], v[108:111]
 global_load_dwordx4 a[236:239], v0, s[70:71] offset:3072 sc1
 v_and_b32 v5, s26, v5
 v_mfma_f32_16x16x32_bf16 v[104:107], a[196:199], a[180:183], v[104:107]
 v_mul_f32 v6, v6, v150
 v_mul_f32 v5, v5, v151
 v_mfma_f32_16x16x32_bf16 v[104:107], a[192:195], a[176:179], v[104:107]
 global_load_dwordx4 a[232:235], v0, s[70:71] offset:2048 sc1
 v_cvt_pk_bf16_f32 v9, v6, v5
 v_mfma_f32_16x16x32_bf16 v[100:103], a[192:195], a[168:171], v[100:103]
 v_accvgpr_read_b32 v5, a78
 v_lshlrev_b32 v6, 16, v5
 s_add_u32 s70, s70, 8192
 s_addc_u32 s71, s71, 0
 v_mfma_f32_16x16x32_bf16 v[100:103], a[196:199], a[172:175], v[100:103]
 v_and_b32 v5, s26, v5
 v_mul_f32 v6, v6, v180
 v_mfma_f32_16x16x32_bf16 v[96:99], a[196:199], a[164:167], v[96:99]
 v_mul_f32 v5, v5, v181
 v_cvt_pk_bf16_f32 v10, v6, v5
 v_mfma_f32_16x16x32_bf16 v[96:99], a[192:195], a[160:163], v[96:99]
 v_accvgpr_read_b32 v5, a79
 v_lshlrev_b32 v6, 16, v5
 v_mfma_f32_16x16x32_bf16 v[92:95], a[192:195], a[152:155], v[92:95]
 v_and_b32 v5, s26, v5
 v_mul_f32 v6, v6, v182
 v_mfma_f32_16x16x32_bf16 v[92:95], a[196:199], a[156:159], v[92:95]
 v_mul_f32 v5, v5, v183
 v_cvt_pk_bf16_f32 v11, v6, v5
 v_mfma_f32_16x16x32_bf16 v[88:91], a[196:199], a[148:151], v[88:91]
 ds_write_b128 v3, v[8:11] offset:14336
 v_mfma_f32_16x16x32_bf16 v[88:91], a[192:195], a[144:147], v[88:91]
 buffer_store_dwordx4 v[8:11], v3, s[32:35], s68 offen offset:2048 sc1
 v_accvgpr_read_b32 v5, a108
 v_lshlrev_b32 v6, 16, v5
 v_and_b32 v5, s26, v5
 v_mul_f32 v6, v6, v212
 v_mfma_f32_16x16x32_bf16 v[84:87], a[192:195], a[136:139], v[84:87]
 v_mul_f32 v5, v5, v213
 v_cvt_pk_bf16_f32 v12, v6, v5
 v_mfma_f32_16x16x32_bf16 v[84:87], a[196:199], a[140:143], v[84:87]
 v_accvgpr_read_b32 v5, a109
 v_lshlrev_b32 v6, 16, v5
 v_mfma_f32_16x16x32_bf16 v[80:83], a[196:199], a[132:135], v[80:83]
 v_and_b32 v5, s26, v5
 v_mul_f32 v6, v6, v214
 v_mfma_f32_16x16x32_bf16 v[80:83], a[192:195], a[128:131], v[80:83]
 v_mul_f32 v5, v5, v215
 v_cvt_pk_bf16_f32 v13, v6, v5
 s_waitcnt vmcnt(13)
 v_mfma_f32_16x16x32_bf16 v[112:115], a[200:203], a[128:131], v[112:115]
 ds_read_b128 a[128:131], v2
 v_accvgpr_read_b32 v5, a110
 v_mfma_f32_16x16x32_bf16 v[112:115], a[204:207], a[132:135], v[112:115]
 global_load_dwordx4 a[196:199], v0, s[70:71] offset:-3072 sc1
 ds_read_b128 a[132:135], v2 offset:1024
 v_mfma_f32_16x16x32_bf16 v[116:119], a[204:207], a[140:143], v[116:119]
 ds_read_b128 a[140:143], v2 offset:5120
 v_lshlrev_b32 v6, 16, v5
 v_mfma_f32_16x16x32_bf16 v[116:119], a[200:203], a[136:139], v[116:119]
 global_load_dwordx4 a[192:195], v0, s[70:71] offset:-4096 sc1
 ds_read_b128 a[136:139], v2 offset:4096
 v_mfma_f32_16x16x32_bf16 v[120:123], a[200:203], a[144:147], v[120:123]
 ds_read_b128 a[144:147], v2 offset:8192
 v_and_b32 v5, s26, v5
 v_mfma_f32_16x16x32_bf16 v[120:123], a[204:207], a[148:151], v[120:123]
 ds_read_b128 a[148:151], v2 offset:9216
 v_mul_f32 v6, v6, v244
 v_mfma_f32_16x16x32_bf16 v[124:127], a[204:207], a[156:159], v[124:127]
 ds_read_b128 a[156:159], v2 offset:13312
 v_mul_f32 v5, v5, v245
 v_cvt_pk_bf16_f32 v14, v6, v5
 v_mfma_f32_16x16x32_bf16 v[124:127], a[200:203], a[152:155], v[124:127]
 ds_read_b128 a[152:155], v2 offset:12288
 v_accvgpr_read_b32 v5, a111
 v_mfma_f32_16x16x32_bf16 v[128:131], a[200:203], a[160:163], v[128:131]
 ds_read_b128 a[160:163], v2 offset:16384
 v_lshlrev_b32 v6, 16, v5
 v_mfma_f32_16x16x32_bf16 v[128:131], a[204:207], a[164:167], v[128:131]
 ds_read_b128 a[164:167], v2 offset:17408
 v_and_b32 v5, s26, v5
 v_mfma_f32_16x16x32_bf16 v[132:135], a[204:207], a[172:175], v[132:135]
 ds_read_b128 a[172:175], v2 offset:21504
 v_mul_f32 v6, v6, v246
 v_mfma_f32_16x16x32_bf16 v[132:135], a[200:203], a[168:171], v[132:135]
 ds_read_b128 a[168:171], v2 offset:20480
 v_mul_f32 v5, v5, v247
 v_mfma_f32_16x16x32_bf16 a[240:243], a[200:203], a[176:179], a[240:243]
 ds_read_b128 a[176:179], v2 offset:24576
 v_cvt_pk_bf16_f32 v15, v6, v5
 v_mfma_f32_16x16x32_bf16 a[240:243], a[204:207], a[180:183], a[240:243]
 ds_read_b128 a[180:183], v2 offset:25600
 ds_write_b128 v3, v[12:15] offset:15360
 s_add_u32 s31, s31, 1
 v_mov_b32 v7, s31
 v_mfma_f32_16x16x32_bf16 a[244:247], a[204:207], a[188:191], a[244:247]
 buffer_store_dword v7, v1, s[60:63], 0 offen sc1
 ds_read_b128 a[188:191], v2 offset:29696
 v_mfma_f32_16x16x32_bf16 a[244:247], a[200:203], a[184:187], a[244:247]
 buffer_store_dwordx4 v[12:15], v3, s[32:35], s68 offen offset:3072 sc1
 ds_read_b128 a[184:187], v2 offset:28672
 v_accvgpr_read_b32 v5, a80
 v_lshlrev_b32 v6, 16, v5
 v_and_b32 v5, s26, v5
 s_waitcnt vmcnt(14) lgkmcnt(9)
 v_mfma_f32_16x16x32_bf16 v[16:19], a[208:211], a[128:131], v[16:19]
 v_mul_f32 v6, v6, v152
 v_mul_f32 v5, v5, v153
 v_mfma_f32_16x16x32_bf16 v[16:19], a[212:215], a[132:135], v[16:19]
 global_load_dwordx4 a[204:207], v0, s[70:71] offset:-1024 sc1
 v_cvt_pk_bf16_f32 v8, v6, v5
 v_mfma_f32_16x16x32_bf16 v[20:23], a[212:215], a[140:143], v[20:23]
 v_accvgpr_read_b32 v5, a81
 v_lshlrev_b32 v6, 16, v5
 v_mfma_f32_16x16x32_bf16 v[20:23], a[208:211], a[136:139], v[20:23]
 global_load_dwordx4 a[200:203], v0, s[70:71] offset:-2048 sc1
 v_and_b32 v5, s26, v5
 v_mfma_f32_16x16x32_bf16 v[24:27], a[208:211], a[144:147], v[24:27]
 v_mul_f32 v6, v6, v154
 v_mul_f32 v5, v5, v155
 v_mfma_f32_16x16x32_bf16 v[24:27], a[212:215], a[148:151], v[24:27]
 v_cvt_pk_bf16_f32 v9, v6, v5
 v_accvgpr_read_b32 v5, a82
 v_mfma_f32_16x16x32_bf16 v[28:31], a[212:215], a[156:159], v[28:31]
 v_lshlrev_b32 v6, 16, v5
 v_and_b32 v5, s26, v5
 v_mfma_f32_16x16x32_bf16 v[28:31], a[208:211], a[152:155], v[28:31]
 v_mul_f32 v6, v6, v184
 s_waitcnt lgkmcnt(0)
 v_mfma_f32_16x16x32_bf16 v[32:35], a[208:211], a[160:163], v[32:35]
 v_mul_f32 v5, v5, v185
 v_cvt_pk_bf16_f32 v10, v6, v5
 v_mfma_f32_16x16x32_bf16 v[32:35], a[212:215], a[164:167], v[32:35]
 v_accvgpr_read_b32 v5, a83
 v_lshlrev_b32 v6, 16, v5
 v_mfma_f32_16x16x32_bf16 v[36:39], a[212:215], a[172:175], v[36:39]
 v_and_b32 v5, s26, v5
 v_mul_f32 v6, v6, v186
 v_mfma_f32_16x16x32_bf16 v[36:39], a[208:211], a[168:171], v[36:39]
 v_mul_f32 v5, v5, v187
 v_cvt_pk_bf16_f32 v11, v6, v5
 v_mfma_f32_16x16x32_bf16 v[40:43], a[208:211], a[176:179], v[40:43]
 ds_write_b128 v3, v[8:11] offset:18432
 v_mfma_f32_16x16x32_bf16 v[40:43], a[212:215], a[180:183], v[40:43]
 s_add_u32 s68, s29, 24576
 buffer_store_dwordx4 v[8:11], v3, s[32:35], s68 offen sc1
 v_mfma_f32_16x16x32_bf16 v[44:47], a[212:215], a[188:191], v[44:47]
 v_accvgpr_read_b32 v5, a112
 v_mfma_f32_16x16x32_bf16 v[44:47], a[208:211], a[184:187], v[44:47]
 v_lshlrev_b32 v6, 16, v5
 v_and_b32 v5, s26, v5
 s_waitcnt vmcnt(14)
 v_mfma_f32_16x16x32_bf16 v[76:79], a[216:219], a[184:187], v[76:79]
 v_mul_f32 v6, v6, v216
 v_mul_f32 v5, v5, v217
 v_mfma_f32_16x16x32_bf16 v[76:79], a[220:223], a[188:191], v[76:79]
 global_load_dwordx4 a[212:215], v0, s[70:71] offset:1024 sc1
 v_cvt_pk_bf16_f32 v12, v6, v5
 v_mfma_f32_16x16x32_bf16 v[72:75], a[220:223], a[180:183], v[72:75]
 v_accvgpr_read_b32 v5, a113
 v_lshlrev_b32 v6, 16, v5
 v_mfma_f32_16x16x32_bf16 v[72:75], a[216:219], a[176:179], v[72:75]
 global_load_dwordx4 a[208:211], v0, s[70:71] offset:0 sc1
 v_and_b32 v5, s26, v5
 v_mfma_f32_16x16x32_bf16 v[68:71], a[216:219], a[168:171], v[68:71]
 v_mul_f32 v6, v6, v218
 v_mul_f32 v5, v5, v219
 v_mfma_f32_16x16x32_bf16 v[68:71], a[220:223], a[172:175], v[68:71]
 v_cvt_pk_bf16_f32 v13, v6, v5
 v_accvgpr_read_b32 v5, a114
 v_mfma_f32_16x16x32_bf16 v[64:67], a[220:223], a[164:167], v[64:67]
 v_lshlrev_b32 v6, 16, v5
 v_and_b32 v5, s26, v5
 v_mfma_f32_16x16x32_bf16 v[64:67], a[216:219], a[160:163], v[64:67]
 v_mul_f32 v6, v6, v248
 v_mul_f32 v5, v5, v249
 v_mfma_f32_16x16x32_bf16 v[60:63], a[216:219], a[152:155], v[60:63]
 v_cvt_pk_bf16_f32 v14, v6, v5
 v_mfma_f32_16x16x32_bf16 v[60:63], a[220:223], a[156:159], v[60:63]
 v_accvgpr_read_b32 v5, a115
 v_lshlrev_b32 v6, 16, v5
 v_mfma_f32_16x16x32_bf16 v[56:59], a[220:223], a[148:151], v[56:59]
 v_and_b32 v5, s26, v5
 v_mul_f32 v6, v6, v250
 v_mfma_f32_16x16x32_bf16 v[56:59], a[216:219], a[144:147], v[56:59]
 v_mul_f32 v5, v5, v251
 v_cvt_pk_bf16_f32 v15, v6, v5
 v_mfma_f32_16x16x32_bf16 v[52:55], a[216:219], a[136:139], v[52:55]
 ds_write_b128 v3, v[12:15] offset:19456
 v_mfma_f32_16x16x32_bf16 v[52:55], a[220:223], a[140:143], v[52:55]
 buffer_store_dwordx4 v[12:15], v3, s[32:35], s68 offen offset:1024 sc1
 v_accvgpr_read_b32 v5, a84
 v_mfma_f32_16x16x32_bf16 v[48:51], a[220:223], a[132:135], v[48:51]
 v_lshlrev_b32 v6, 16, v5
 v_mfma_f32_16x16x32_bf16 v[48:51], a[216:219], a[128:131], v[48:51]
 v_and_b32 v5, s26, v5
 v_mul_f32 v6, v6, v156
 s_waitcnt vmcnt(14)
 v_mfma_f32_16x16x32_bf16 v[80:83], a[224:227], a[128:131], v[80:83]
 v_mul_f32 v5, v5, v157
 v_cvt_pk_bf16_f32 v8, v6, v5
 v_mfma_f32_16x16x32_bf16 v[80:83], a[228:231], a[132:135], v[80:83]
 global_load_dwordx4 a[220:223], v0, s[70:71] offset:3072 sc1
 v_accvgpr_read_b32 v5, a85
 v_mfma_f32_16x16x32_bf16 v[84:87], a[228:231], a[140:143], v[84:87]
 v_lshlrev_b32 v6, 16, v5
 v_and_b32 v5, s26, v5
 v_mfma_f32_16x16x32_bf16 v[84:87], a[224:227], a[136:139], v[84:87]
 global_load_dwordx4 a[216:219], v0, s[70:71] offset:2048 sc1
 v_mul_f32 v6, v6, v158
 v_mfma_f32_16x16x32_bf16 v[88:91], a[224:227], a[144:147], v[88:91]
 v_mul_f32 v5, v5, v159
 v_cvt_pk_bf16_f32 v9, v6, v5
 s_add_u32 s70, s70, 8192
 s_addc_u32 s71, s71, 0
 v_mfma_f32_16x16x32_bf16 v[88:91], a[228:231], a[148:151], v[88:91]
 v_accvgpr_read_b32 v5, a86
 v_lshlrev_b32 v6, 16, v5
 v_mfma_f32_16x16x32_bf16 v[92:95], a[228:231], a[156:159], v[92:95]
 v_and_b32 v5, s26, v5
 v_mul_f32 v6, v6, v188
 v_mfma_f32_16x16x32_bf16 v[92:95], a[224:227], a[152:155], v[92:95]
 v_mul_f32 v5, v5, v189
 v_cvt_pk_bf16_f32 v10, v6, v5
 v_mfma_f32_16x16x32_bf16 v[96:99], a[224:227], a[160:163], v[96:99]
 v_accvgpr_read_b32 v5, a87
 v_lshlrev_b32 v6, 16, v5
 v_mfma_f32_16x16x32_bf16 v[96:99], a[228:231], a[164:167], v[96:99]
 v_and_b32 v5, s26, v5
 v_mul_f32 v6, v6, v190
 v_mfma_f32_16x16x32_bf16 v[100:103], a[228:231], a[172:175], v[100:103]
 v_mul_f32 v5, v5, v191
 v_cvt_pk_bf16_f32 v11, v6, v5
 v_mfma_f32_16x16x32_bf16 v[100:103], a[224:227], a[168:171], v[100:103]
 ds_write_b128 v3, v[8:11] offset:22528
 v_mfma_f32_16x16x32_bf16 v[104:107], a[224:227], a[176:179], v[104:107]
 buffer_store_dwordx4 v[8:11], v3, s[32:35], s68 offen offset:2048 sc1
 v_accvgpr_read_b32 v5, a116
 v_lshlrev_b32 v6, 16, v5
 v_and_b32 v5, s26, v5
 v_mul_f32 v6, v6, v220
 v_mfma_f32_16x16x32_bf16 v[104:107], a[228:231], a[180:183], v[104:107]
 v_mul_f32 v5, v5, v221
 v_cvt_pk_bf16_f32 v12, v6, v5
 v_mfma_f32_16x16x32_bf16 v[108:111], a[228:231], a[188:191], v[108:111]
 v_accvgpr_read_b32 v5, a117
 v_lshlrev_b32 v6, 16, v5
 v_mfma_f32_16x16x32_bf16 v[108:111], a[224:227], a[184:187], v[108:111]
 v_and_b32 v5, s26, v5
 v_mul_f32 v6, v6, v222
 s_waitcnt vmcnt(14)
 v_mfma_f32_16x16x32_bf16 a[244:247], a[232:235], a[184:187], a[244:247]
 ds_read_b128 a[184:187], v2 offset:61440
 v_mul_f32 v5, v5, v223
 v_mfma_f32_16x16x32_bf16 a[244:247], a[236:239], a[188:191], a[244:247]
 global_load_dwordx4 a[228:231], v0, s[70:71] offset:-3072 sc1
 ds_read_b128 a[188:191], v2 offset:62464
 v_mfma_f32_16x16x32_bf16 a[240:243], a[236:239], a[180:183], a[240:243]
 ds_read_b128 a[180:183], v2 offset:58368
 v_cvt_pk_bf16_f32 v13, v6, v5
 v_mfma_f32_16x16x32_bf16 a[240:243], a[232:235], a[176:179], a[240:243]
 global_load_dwordx4 a[224:227], v0, s[70:71] offset:-4096 sc1
 ds_read_b128 a[176:179], v2 offset:57344
 v_accvgpr_read_b32 v5, a118
 v_mfma_f32_16x16x32_bf16 v[132:135], a[232:235], a[168:171], v[132:135]
 ds_read_b128 a[168:171], v2 offset:53248
 v_lshlrev_b32 v6, 16, v5
 v_mfma_f32_16x16x32_bf16 v[132:135], a[236:239], a[172:175], v[132:135]
 ds_read_b128 a[172:175], v2 offset:54272
 v_and_b32 v5, s26, v5
 v_mfma_f32_16x16x32_bf16 v[128:131], a[236:239], a[164:167], v[128:131]
 ds_read_b128 a[164:167], v2 offset:50176
 v_mul_f32 v6, v6, v252
 v_mfma_f32_16x16x32_bf16 v[128:131], a[232:235], a[160:163], v[128:131]
 ds_read_b128 a[160:163], v2 offset:49152
 v_mul_f32 v5, v5, v253
 v_mfma_f32_16x16x32_bf16 v[124:127], a[232:235], a[152:155], v[124:127]
 ds_read_b128 a[152:155], v2 offset:45056
 v_cvt_pk_bf16_f32 v14, v6, v5
 v_mfma_f32_16x16x32_bf16 v[124:127], a[236:239], a[156:159], v[124:127]
 ds_read_b128 a[156:159], v2 offset:46080
 v_accvgpr_read_b32 v5, a119
 v_mfma_f32_16x16x32_bf16 v[120:123], a[236:239], a[148:151], v[120:123]
 ds_read_b128 a[148:151], v2 offset:41984
 v_lshlrev_b32 v6, 16, v5
 v_mfma_f32_16x16x32_bf16 v[120:123], a[232:235], a[144:147], v[120:123]
 ds_read_b128 a[144:147], v2 offset:40960
 v_and_b32 v5, s26, v5
 v_mfma_f32_16x16x32_bf16 v[116:119], a[232:235], a[136:139], v[116:119]
 ds_read_b128 a[136:139], v2 offset:36864
 v_mul_f32 v6, v6, v254
 v_mfma_f32_16x16x32_bf16 v[116:119], a[236:239], a[140:143], v[116:119]
 ds_read_b128 a[140:143], v2 offset:37888
 v_mul_f32 v5, v5, v255
 v_mfma_f32_16x16x32_bf16 v[112:115], a[236:239], a[132:135], v[112:115]
 ds_read_b128 a[132:135], v2 offset:33792
 v_cvt_pk_bf16_f32 v15, v6, v5
 v_mfma_f32_16x16x32_bf16 v[112:115], a[232:235], a[128:131], v[112:115]
 ds_read_b128 a[128:131], v2 offset:32768
 ds_write_b128 v3, v[12:15] offset:23552
 buffer_store_dwordx4 v[12:15], v3, s[32:35], s68 offen offset:3072 sc1
 v_accvgpr_read_b32 v5, a88
 v_lshlrev_b32 v6, 16, v5
 v_and_b32 v5, s26, v5
 s_waitcnt vmcnt(14) lgkmcnt(9)
 v_mfma_f32_16x16x32_bf16 v[44:47], a[192:195], a[184:187], v[44:47]
 v_mul_f32 v6, v6, v160
 v_mul_f32 v5, v5, v161
 v_mfma_f32_16x16x32_bf16 v[44:47], a[196:199], a[188:191], v[44:47]
 global_load_dwordx4 a[236:239], v0, s[70:71] offset:-1024 sc1
 v_cvt_pk_bf16_f32 v8, v6, v5
 v_mfma_f32_16x16x32_bf16 v[40:43], a[196:199], a[180:183], v[40:43]
 v_accvgpr_read_b32 v5, a89
 v_lshlrev_b32 v6, 16, v5
 v_mfma_f32_16x16x32_bf16 v[40:43], a[192:195], a[176:179], v[40:43]
 global_load_dwordx4 a[232:235], v0, s[70:71] offset:-2048 sc1
 v_and_b32 v5, s26, v5
 v_mfma_f32_16x16x32_bf16 v[36:39], a[192:195], a[168:171], v[36:39]
 v_mul_f32 v6, v6, v162
 v_mul_f32 v5, v5, v163
 v_mfma_f32_16x16x32_bf16 v[36:39], a[196:199], a[172:175], v[36:39]
 v_cvt_pk_bf16_f32 v9, v6, v5
 v_accvgpr_read_b32 v5, a90
 v_mfma_f32_16x16x32_bf16 v[32:35], a[196:199], a[164:167], v[32:35]
 v_lshlrev_b32 v6, 16, v5
 v_and_b32 v5, s26, v5
 v_mfma_f32_16x16x32_bf16 v[32:35], a[192:195], a[160:163], v[32:35]
 v_mul_f32 v6, v6, v192
 v_mul_f32 v5, v5, v193
 s_waitcnt lgkmcnt(1)
 v_mfma_f32_16x16x32_bf16 v[28:31], a[192:195], a[152:155], v[28:31]
 v_cvt_pk_bf16_f32 v10, v6, v5
 v_accvgpr_read_b32 v5, a91
 v_mfma_f32_16x16x32_bf16 v[28:31], a[196:199], a[156:159], v[28:31]
 v_lshlrev_b32 v6, 16, v5
 v_and_b32 v5, s26, v5
 v_mfma_f32_16x16x32_bf16 v[24:27], a[196:199], a[148:151], v[24:27]
 v_mul_f32 v6, v6, v194
 v_mul_f32 v5, v5, v195
 v_mfma_f32_16x16x32_bf16 v[24:27], a[192:195], a[144:147], v[24:27]
 v_cvt_pk_bf16_f32 v11, v6, v5
 v_mfma_f32_16x16x32_bf16 v[20:23], a[192:195], a[136:139], v[20:23]
 ds_write_b128 v3, v[8:11] offset:26624
 s_add_u32 s68, s29, 28672
 v_mfma_f32_16x16x32_bf16 v[20:23], a[196:199], a[140:143], v[20:23]
 buffer_store_dwordx4 v[8:11], v3, s[32:35], s68 offen sc1
 v_accvgpr_read_b32 v5, a120
 v_lshlrev_b32 v6, 16, v5
 v_and_b32 v5, s26, v5
 v_mfma_f32_16x16x32_bf16 v[16:19], a[196:199], a[132:135], v[16:19]
 v_mul_f32 v6, v6, v224
 v_mul_f32 v5, v5, v225
 v_mfma_f32_16x16x32_bf16 v[16:19], a[192:195], a[128:131], v[16:19]
 v_cvt_pk_bf16_f32 v12, v6, v5
 v_accvgpr_read_b32 v5, a121
 s_waitcnt vmcnt(13)
 v_mfma_f32_16x16x32_bf16 v[48:51], a[200:203], a[128:131], v[48:51]
 v_lshlrev_b32 v6, 16, v5
 v_and_b32 v5, s26, v5
 v_mfma_f32_16x16x32_bf16 v[48:51], a[204:207], a[132:135], v[48:51]
 global_load_dwordx4 a[196:199], v0, s[70:71] offset:1024 sc1
 v_mul_f32 v6, v6, v226
 v_mfma_f32_16x16x32_bf16 v[52:55], a[204:207], a[140:143], v[52:55]
 v_mul_f32 v5, v5, v227
 v_cvt_pk_bf16_f32 v13, v6, v5
 v_mfma_f32_16x16x32_bf16 v[52:55], a[200:203], a[136:139], v[52:55]
 global_load_dwordx4 a[192:195], v0, s[70:71] offset:0 sc1
 v_accvgpr_read_b32 v5, a122
 v_mfma_f32_16x16x32_bf16 v[56:59], a[200:203], a[144:147], v[56:59]
 v_accvgpr_read_b32 v7, a248
 v_lshlrev_b32 v6, 16, v5
 v_mfma_f32_16x16x32_bf16 v[56:59], a[204:207], a[148:151], v[56:59]
 v_and_b32 v5, s26, v5
 v_mul_f32 v6, v6, v7
 v_mfma_f32_16x16x32_bf16 v[60:63], a[204:207], a[156:159], v[60:63]
 v_accvgpr_read_b32 v7, a249
 v_mfma_f32_16x16x32_bf16 v[60:63], a[200:203], a[152:155], v[60:63]
 v_mul_f32 v5, v5, v7
 v_cvt_pk_bf16_f32 v14, v6, v5
 v_mfma_f32_16x16x32_bf16 v[64:67], a[200:203], a[160:163], v[64:67]
 v_accvgpr_read_b32 v5, a123
 v_accvgpr_read_b32 v7, a250
 v_mfma_f32_16x16x32_bf16 v[64:67], a[204:207], a[164:167], v[64:67]
 v_lshlrev_b32 v6, 16, v5
 v_mfma_f32_16x16x32_bf16 v[68:71], a[204:207], a[172:175], v[68:71]
 v_and_b32 v5, s26, v5
 v_mul_f32 v6, v6, v7
 v_mfma_f32_16x16x32_bf16 v[68:71], a[200:203], a[168:171], v[68:71]
 v_accvgpr_read_b32 v7, a251
 v_mul_f32 v5, v5, v7
 v_mfma_f32_16x16x32_bf16 v[72:75], a[200:203], a[176:179], v[72:75]
 v_cvt_pk_bf16_f32 v15, v6, v5
 v_mfma_f32_16x16x32_bf16 v[72:75], a[204:207], a[180:183], v[72:75]
 ds_write_b128 v3, v[12:15] offset:27648
 v_mfma_f32_16x16x32_bf16 v[76:79], a[204:207], a[188:191], v[76:79]
 buffer_store_dwordx4 v[12:15], v3, s[32:35], s68 offen offset:1024 sc1
 v_accvgpr_read_b32 v5, a92
 v_lshlrev_b32 v6, 16, v5
 v_mfma_f32_16x16x32_bf16 v[76:79], a[200:203], a[184:187], v[76:79]
 v_and_b32 v5, s26, v5
 v_mul_f32 v6, v6, v164
 s_waitcnt vmcnt(13)
 v_mfma_f32_16x16x32_bf16 v[108:111], a[208:211], a[184:187], v[108:111]
 v_mul_f32 v5, v5, v165
 v_cvt_pk_bf16_f32 v8, v6, v5
 v_mfma_f32_16x16x32_bf16 v[108:111], a[212:215], a[188:191], v[108:111]
 global_load_dwordx4 a[204:207], v0, s[70:71] offset:3072 sc1
 v_accvgpr_read_b32 v5, a93
 v_mfma_f32_16x16x32_bf16 v[104:107], a[212:215], a[180:183], v[104:107]
 v_lshlrev_b32 v6, 16, v5
 v_and_b32 v5, s26, v5
 v_mfma_f32_16x16x32_bf16 v[104:107], a[208:211], a[176:179], v[104:107]
 global_load_dwordx4 a[200:203], v0, s[70:71] offset:2048 sc1
 v_mul_f32 v6, v6, v166
 v_mfma_f32_16x16x32_bf16 v[100:103], a[208:211], a[168:171], v[100:103]
 v_mul_f32 v5, v5, v167
 v_cvt_pk_bf16_f32 v9, v6, v5
 s_add_u32 s70, s70, 8192
 s_addc_u32 s71, s71, 0
 v_mfma_f32_16x16x32_bf16 v[100:103], a[212:215], a[172:175], v[100:103]
 v_accvgpr_read_b32 v5, a94
 v_lshlrev_b32 v6, 16, v5
 v_mfma_f32_16x16x32_bf16 v[96:99], a[212:215], a[164:167], v[96:99]
 v_and_b32 v5, s26, v5
 v_mfma_f32_16x16x32_bf16 v[96:99], a[208:211], a[160:163], v[96:99]
 v_mul_f32 v6, v6, v196
 v_mul_f32 v5, v5, v197
 v_mfma_f32_16x16x32_bf16 v[92:95], a[208:211], a[152:155], v[92:95]
 v_cvt_pk_bf16_f32 v10, v6, v5
 v_accvgpr_read_b32 v5, a95
 v_mfma_f32_16x16x32_bf16 v[92:95], a[212:215], a[156:159], v[92:95]
 v_lshlrev_b32 v6, 16, v5
 v_mfma_f32_16x16x32_bf16 v[88:91], a[212:215], a[148:151], v[88:91]
 v_and_b32 v5, s26, v5
 v_mul_f32 v6, v6, v198
 v_mfma_f32_16x16x32_bf16 v[88:91], a[208:211], a[144:147], v[88:91]
 v_mul_f32 v5, v5, v199
 v_cvt_pk_bf16_f32 v11, v6, v5
 v_mfma_f32_16x16x32_bf16 v[84:87], a[208:211], a[136:139], v[84:87]
 ds_write_b128 v3, v[8:11] offset:30720
 v_mfma_f32_16x16x32_bf16 v[84:87], a[212:215], a[140:143], v[84:87]
 buffer_store_dwordx4 v[8:11], v3, s[32:35], s68 offen offset:2048 sc1
 v_accvgpr_read_b32 v5, a124
 v_lshlrev_b32 v6, 16, v5
 v_and_b32 v5, s26, v5
 v_mul_f32 v6, v6, v228
 v_mfma_f32_16x16x32_bf16 v[80:83], a[212:215], a[132:135], v[80:83]
 v_mul_f32 v5, v5, v229
 v_cvt_pk_bf16_f32 v12, v6, v5
 v_mfma_f32_16x16x32_bf16 v[80:83], a[208:211], a[128:131], v[80:83]
 v_accvgpr_read_b32 v5, a125
 v_lshlrev_b32 v6, 16, v5
 s_waitcnt vmcnt(13)
 v_mfma_f32_16x16x32_bf16 v[112:115], a[216:219], a[128:131], v[112:115]
 v_and_b32 v5, s26, v5
 v_mul_f32 v6, v6, v230
 v_mfma_f32_16x16x32_bf16 v[112:115], a[220:223], a[132:135], v[112:115]
 global_load_dwordx4 a[212:215], v0, s[70:71] offset:-3072 sc1
 v_mul_f32 v5, v5, v231
 v_mfma_f32_16x16x32_bf16 v[116:119], a[220:223], a[140:143], v[116:119]
 v_cvt_pk_bf16_f32 v13, v6, v5
 v_accvgpr_read_b32 v5, a126
 v_mfma_f32_16x16x32_bf16 v[116:119], a[216:219], a[136:139], v[116:119]
 global_load_dwordx4 a[208:211], v0, s[70:71] offset:-4096 sc1
 v_accvgpr_read_b32 v7, a252
 v_mfma_f32_16x16x32_bf16 v[120:123], a[216:219], a[144:147], v[120:123]
 v_lshlrev_b32 v6, 16, v5
 v_and_b32 v5, s26, v5
 v_mfma_f32_16x16x32_bf16 v[120:123], a[220:223], a[148:151], v[120:123]
 v_mul_f32 v6, v6, v7
 v_accvgpr_read_b32 v7, a253
 v_mfma_f32_16x16x32_bf16 v[124:127], a[220:223], a[156:159], v[124:127]
 v_mul_f32 v5, v5, v7
 v_cvt_pk_bf16_f32 v14, v6, v5
 v_mfma_f32_16x16x32_bf16 v[124:127], a[216:219], a[152:155], v[124:127]
 v_accvgpr_read_b32 v5, a127
 v_accvgpr_read_b32 v7, a254
 v_mfma_f32_16x16x32_bf16 v[128:131], a[216:219], a[160:163], v[128:131]
 v_lshlrev_b32 v6, 16, v5
 v_and_b32 v5, s26, v5
 v_mfma_f32_16x16x32_bf16 v[128:131], a[220:223], a[164:167], v[128:131]
 v_mul_f32 v6, v6, v7
 v_accvgpr_read_b32 v7, a255
 v_mfma_f32_16x16x32_bf16 v[132:135], a[220:223], a[172:175], v[132:135]
 v_mul_f32 v5, v5, v7
 v_cvt_pk_bf16_f32 v15, v6, v5
 v_mfma_f32_16x16x32_bf16 v[132:135], a[216:219], a[168:171], v[132:135]
 ds_write_b128 v3, v[12:15] offset:31744
 v_mfma_f32_16x16x32_bf16 a[240:243], a[216:219], a[176:179], a[240:243]
 buffer_store_dwordx4 v[12:15], v3, s[32:35], s68 offen offset:3072 sc1
 v_mfma_f32_16x16x32_bf16 a[240:243], a[220:223], a[180:183], a[240:243]
 v_mfma_f32_16x16x32_bf16 a[244:247], a[220:223], a[188:191], a[244:247]
 global_load_dwordx4 a[220:223], v0, s[70:71] offset:-1024 sc1
 v_mfma_f32_16x16x32_bf16 a[244:247], a[216:219], a[184:187], a[244:247]
 global_load_dwordx4 a[216:219], v0, s[70:71] offset:-2048 sc1
 s_waitcnt vmcnt(15)
Ls1b:
 v_mfma_f32_16x16x32_bf16 v[164:167], a[224:227], a[184:187], v[164:167]
 v_bfe_u32 v4, v3, 8, 2
 v_mfma_f32_16x16x32_bf16 v[164:167], a[228:231], a[188:191], v[164:167]
 v_mfma_f32_16x16x32_bf16 v[160:163], a[228:231], a[180:183], v[160:163]
 v_lshl_add_u32 v4, v4, 5, s51
 v_mfma_f32_16x16x32_bf16 v[160:163], a[224:227], a[176:179], v[160:163]
 ds_read_b128 v[8:11], v4
 v_mfma_f32_16x16x32_bf16 v[156:159], a[224:227], a[168:171], v[156:159]
 v_mfma_f32_16x16x32_bf16 v[156:159], a[228:231], a[172:175], v[156:159]
 v_mfma_f32_16x16x32_bf16 v[152:155], a[228:231], a[164:167], v[152:155]
 v_mfma_f32_16x16x32_bf16 v[152:155], a[224:227], a[160:163], v[152:155]
 v_mfma_f32_16x16x32_bf16 v[148:151], a[224:227], a[152:155], v[148:151]
 v_mfma_f32_16x16x32_bf16 v[148:151], a[228:231], a[156:159], v[148:151]
 v_mfma_f32_16x16x32_bf16 v[144:147], a[228:231], a[148:151], v[144:147]
 v_mfma_f32_16x16x32_bf16 v[144:147], a[224:227], a[144:147], v[144:147]
 v_mfma_f32_16x16x32_bf16 v[140:143], a[224:227], a[136:139], v[140:143]
 v_mfma_f32_16x16x32_bf16 v[140:143], a[228:231], a[140:143], v[140:143]
 v_mfma_f32_16x16x32_bf16 v[136:139], a[228:231], a[132:135], v[136:139]
 v_mfma_f32_16x16x32_bf16 v[136:139], a[224:227], a[128:131], v[136:139]
 s_waitcnt vmcnt(12)
 v_mfma_f32_16x16x32_bf16 v[168:171], a[232:235], a[128:131], v[168:171]
 s_waitcnt lgkmcnt(0)
 v_mfma_f32_16x16x32_bf16 v[168:171], a[236:239], a[132:135], v[168:171]
 global_load_dwordx4 a[228:231], v0, s[70:71] offset:1024 sc1
 v_add_f32 v16, v16, v8
 v_mfma_f32_16x16x32_bf16 v[172:175], a[236:239], a[140:143], v[172:175]
 v_mfma_f32_16x16x32_bf16 v[172:175], a[232:235], a[136:139], v[172:175]
 global_load_dwordx4 a[224:227], v0, s[70:71] offset:0 sc1
 ds_read_b128 v[12:15], v4 offset:16
 v_mfma_f32_16x16x32_bf16 v[176:179], a[232:235], a[144:147], v[176:179]
 v_add_f32 v17, v17, v9
 v_mfma_f32_16x16x32_bf16 v[176:179], a[236:239], a[148:151], v[176:179]
 v_mfma_f32_16x16x32_bf16 v[180:183], a[236:239], a[156:159], v[180:183]
 v_add_f32 v18, v18, v10
 v_mfma_f32_16x16x32_bf16 v[180:183], a[232:235], a[152:155], v[180:183]
 v_add_f32 v19, v19, v11
 v_mfma_f32_16x16x32_bf16 v[184:187], a[232:235], a[160:163], v[184:187]
 v_mfma_f32_16x16x32_bf16 v[184:187], a[236:239], a[164:167], v[184:187]
 v_add_f32 v20, v20, v8
 v_mfma_f32_16x16x32_bf16 v[188:191], a[236:239], a[172:175], v[188:191]
 v_add_f32 v21, v21, v9
 v_mfma_f32_16x16x32_bf16 v[188:191], a[232:235], a[168:171], v[188:191]
 v_add_f32 v22, v22, v10
 v_mfma_f32_16x16x32_bf16 v[192:195], a[232:235], a[176:179], v[192:195]
 v_mfma_f32_16x16x32_bf16 v[192:195], a[236:239], a[180:183], v[192:195]
 v_add_f32 v23, v23, v11
 v_mfma_f32_16x16x32_bf16 v[196:199], a[236:239], a[188:191], v[196:199]
 v_add_f32 v24, v24, v8
 v_mfma_f32_16x16x32_bf16 v[196:199], a[232:235], a[184:187], v[196:199]
 s_waitcnt vmcnt(11)
 v_mfma_f32_16x16x32_bf16 v[228:231], a[192:195], a[184:187], v[228:231]
 v_add_f32 v25, v25, v9
 v_mfma_f32_16x16x32_bf16 v[228:231], a[196:199], a[188:191], v[228:231]
 global_load_dwordx4 a[236:239], v0, s[70:71] offset:3072 sc1
 v_add_f32 v26, v26, v10
 v_mfma_f32_16x16x32_bf16 v[224:227], a[196:199], a[180:183], v[224:227]
 v_mfma_f32_16x16x32_bf16 v[224:227], a[192:195], a[176:179], v[224:227]
 global_load_dwordx4 a[232:235], v0, s[70:71] offset:2048 sc1
 v_add_f32 v27, v27, v11
 v_mfma_f32_16x16x32_bf16 v[220:223], a[192:195], a[168:171], v[220:223]
 v_add_f32 v28, v28, v8
 s_add_u32 s70, s70, 8192
 s_addc_u32 s71, s71, 0
 v_mfma_f32_16x16x32_bf16 v[220:223], a[196:199], a[172:175], v[220:223]
 v_mfma_f32_16x16x32_bf16 v[216:219], a[196:199], a[164:167], v[216:219]
 v_add_f32 v29, v29, v9
 v_mfma_f32_16x16x32_bf16 v[216:219], a[192:195], a[160:163], v[216:219]
 v_add_f32 v30, v30, v10
 v_mfma_f32_16x16x32_bf16 v[212:215], a[192:195], a[152:155], v[212:215]
 v_add_f32 v31, v31, v11
 v_mfma_f32_16x16x32_bf16 v[212:215], a[196:199], a[156:159], v[212:215]
 v_mfma_f32_16x16x32_bf16 v[208:211], a[196:199], a[148:151], v[208:211]
 v_add_f32 v32, v32, v8
 v_mfma_f32_16x16x32_bf16 v[208:211], a[192:195], a[144:147], v[208:211]
 v_add_f32 v33, v33, v9
 v_mfma_f32_16x16x32_bf16 v[204:207], a[192:195], a[136:139], v[204:207]
 v_mfma_f32_16x16x32_bf16 v[204:207], a[196:199], a[140:143], v[204:207]
 v_add_f32 v34, v34, v10
 v_mfma_f32_16x16x32_bf16 v[200:203], a[196:199], a[132:135], v[200:203]
 v_add_f32 v35, v35, v11
 v_mfma_f32_16x16x32_bf16 v[200:203], a[192:195], a[128:131], v[200:203]
 v_add_f32 v36, v36, v8
 s_waitcnt vmcnt(10)
 v_mfma_f32_16x16x32_bf16 v[232:235], a[200:203], a[128:131], v[232:235]
 ds_read_b128 a[128:131], v2
 v_add_f32 v37, v37, v9
 v_mfma_f32_16x16x32_bf16 v[232:235], a[204:207], a[132:135], v[232:235]
 global_load_dwordx4 a[196:199], v0, s[70:71] offset:-3072 sc1
 ds_read_b128 a[132:135], v2 offset:1024
 v_mfma_f32_16x16x32_bf16 v[236:239], a[204:207], a[140:143], v[236:239]
 ds_read_b128 a[140:143], v2 offset:5120
 v_add_f32 v38, v38, v10
 v_mfma_f32_16x16x32_bf16 v[236:239], a[200:203], a[136:139], v[236:239]
 global_load_dwordx4 a[192:195], v0, s[70:71] offset:-4096 sc1
 ds_read_b128 a[136:139], v2 offset:4096
 v_mfma_f32_16x16x32_bf16 v[240:243], a[200:203], a[144:147], v[240:243]
 ds_read_b128 a[144:147], v2 offset:8192
 v_add_f32 v39, v39, v11
 v_mfma_f32_16x16x32_bf16 v[240:243], a[204:207], a[148:151], v[240:243]
 ds_read_b128 a[148:151], v2 offset:9216
 v_add_f32 v40, v40, v8
 v_mfma_f32_16x16x32_bf16 v[244:247], a[204:207], a[156:159], v[244:247]
 ds_read_b128 a[156:159], v2 offset:13312
 v_mfma_f32_16x16x32_bf16 v[244:247], a[200:203], a[152:155], v[244:247]
 ds_read_b128 a[152:155], v2 offset:12288
 v_add_f32 v41, v41, v9
 v_mfma_f32_16x16x32_bf16 v[248:251], a[200:203], a[160:163], v[248:251]
 ds_read_b128 a[160:163], v2 offset:16384
 v_add_f32 v42, v42, v10
 v_mfma_f32_16x16x32_bf16 v[248:251], a[204:207], a[164:167], v[248:251]
 ds_read_b128 a[164:167], v2 offset:17408
 v_mfma_f32_16x16x32_bf16 v[252:255], a[204:207], a[172:175], v[252:255]
 ds_read_b128 a[172:175], v2 offset:21504
 v_add_f32 v43, v43, v11
 v_mfma_f32_16x16x32_bf16 v[252:255], a[200:203], a[168:171], v[252:255]
 ds_read_b128 a[168:171], v2 offset:20480
 v_add_f32 v44, v44, v8
 v_mfma_f32_16x16x32_bf16 a[248:251], a[200:203], a[176:179], a[248:251]
 ds_read_b128 a[176:179], v2 offset:24576
 v_mfma_f32_16x16x32_bf16 a[248:251], a[204:207], a[180:183], a[248:251]
 ds_read_b128 a[180:183], v2 offset:25600
 v_add_f32 v45, v45, v9
 v_mfma_f32_16x16x32_bf16 a[252:255], a[204:207], a[188:191], a[252:255]
 ds_read_b128 a[188:191], v2 offset:29696
 v_add_f32 v46, v46, v10
 v_mfma_f32_16x16x32_bf16 a[252:255], a[200:203], a[184:187], a[252:255]
 ds_read_b128 a[184:187], v2 offset:28672
 v_add_f32 v47, v47, v11
 s_waitcnt vmcnt(9) lgkmcnt(8)
 v_mfma_f32_16x16x32_bf16 v[136:139], a[208:211], a[128:131], v[136:139]
 v_mfma_f32_16x16x32_bf16 v[136:139], a[212:215], a[132:135], v[136:139]
 global_load_dwordx4 a[204:207], v0, s[70:71] offset:-1024 sc1
 v_mfma_f32_16x16x32_bf16 v[140:143], a[212:215], a[140:143], v[140:143]
 v_add_f32 v48, v48, v12
 v_mfma_f32_16x16x32_bf16 v[140:143], a[208:211], a[136:139], v[140:143]
 global_load_dwordx4 a[200:203], v0, s[70:71] offset:-2048 sc1
 v_mfma_f32_16x16x32_bf16 v[144:147], a[208:211], a[144:147], v[144:147]
 ds_read_b128 v[8:11], v4 offset:128
 v_mfma_f32_16x16x32_bf16 v[144:147], a[212:215], a[148:151], v[144:147]
 v_add_f32 v49, v49, v13
 v_mfma_f32_16x16x32_bf16 v[148:151], a[212:215], a[156:159], v[148:151]
 v_mfma_f32_16x16x32_bf16 v[148:151], a[208:211], a[152:155], v[148:151]
 v_add_f32 v50, v50, v14
 s_waitcnt lgkmcnt(1)
 v_mfma_f32_16x16x32_bf16 v[152:155], a[208:211], a[160:163], v[152:155]
 v_add_f32 v51, v51, v15
 v_mfma_f32_16x16x32_bf16 v[152:155], a[212:215], a[164:167], v[152:155]
 v_add_f32 v52, v52, v12
 v_mfma_f32_16x16x32_bf16 v[156:159], a[212:215], a[172:175], v[156:159]
 v_mfma_f32_16x16x32_bf16 v[156:159], a[208:211], a[168:171], v[156:159]
 v_add_f32 v53, v53, v13
 v_mfma_f32_16x16x32_bf16 v[160:163], a[208:211], a[176:179], v[160:163]
 v_add_f32 v54, v54, v14
 v_mfma_f32_16x16x32_bf16 v[160:163], a[212:215], a[180:183], v[160:163]
 v_mfma_f32_16x16x32_bf16 v[164:167], a[212:215], a[188:191], v[164:167]
 v_add_f32 v55, v55, v15
 v_mfma_f32_16x16x32_bf16 v[164:167], a[208:211], a[184:187], v[164:167]
 v_add_f32 v56, v56, v12
 s_waitcnt vmcnt(8)
 v_mfma_f32_16x16x32_bf16 v[196:199], a[216:219], a[184:187], v[196:199]
 v_mfma_f32_16x16x32_bf16 v[196:199], a[220:223], a[188:191], v[196:199]
 global_load_dwordx4 a[212:215], v0, s[70:71] offset:1024 sc1
 v_add_f32 v57, v57, v13
 v_mfma_f32_16x16x32_bf16 v[192:195], a[220:223], a[180:183], v[192:195]
 v_add_f32 v58, v58, v14
 v_mfma_f32_16x16x32_bf16 v[192:195], a[216:219], a[176:179], v[192:195]
 global_load_dwordx4 a[208:211], v0, s[70:71] offset:0 sc1
 v_add_f32 v59, v59, v15
 v_mfma_f32_16x16x32_bf16 v[188:191], a[216:219], a[168:171], v[188:191]
 v_mfma_f32_16x16x32_bf16 v[188:191], a[220:223], a[172:175], v[188:191]
 v_add_f32 v60, v60, v12
 v_mfma_f32_16x16x32_bf16 v[184:187], a[220:223], a[164:167], v[184:187]
 v_add_f32 v61, v61, v13
 v_mfma_f32_16x16x32_bf16 v[184:187], a[216:219], a[160:163], v[184:187]
 v_mfma_f32_16x16x32_bf16 v[180:183], a[216:219], a[152:155], v[180:183]
 v_add_f32 v62, v62, v14
 v_mfma_f32_16x16x32_bf16 v[180:183], a[220:223], a[156:159], v[180:183]
 v_add_f32 v63, v63, v15
 v_mfma_f32_16x16x32_bf16 v[176:179], a[220:223], a[148:151], v[176:179]
 v_mfma_f32_16x16x32_bf16 v[176:179], a[216:219], a[144:147], v[176:179]
 v_add_f32 v64, v64, v12
 v_mfma_f32_16x16x32_bf16 v[172:175], a[216:219], a[136:139], v[172:175]
 v_add_f32 v65, v65, v13
 v_mfma_f32_16x16x32_bf16 v[172:175], a[220:223], a[140:143], v[172:175]
 v_mfma_f32_16x16x32_bf16 v[168:171], a[220:223], a[132:135], v[168:171]
 v_add_f32 v66, v66, v14
 v_mfma_f32_16x16x32_bf16 v[168:171], a[216:219], a[128:131], v[168:171]
 v_add_f32 v67, v67, v15
 s_waitcnt vmcnt(8)
 v_mfma_f32_16x16x32_bf16 v[200:203], a[224:227], a[128:131], v[200:203]
 v_add_f32 v68, v68, v12
 v_mfma_f32_16x16x32_bf16 v[200:203], a[228:231], a[132:135], v[200:203]
 global_load_dwordx4 a[220:223], v0, s[70:71] offset:3072 sc1
 v_mfma_f32_16x16x32_bf16 v[204:207], a[228:231], a[140:143], v[204:207]
 v_add_f32 v69, v69, v13
 v_mfma_f32_16x16x32_bf16 v[204:207], a[224:227], a[136:139], v[204:207]
 global_load_dwordx4 a[216:219], v0, s[70:71] offset:2048 sc1
 v_add_f32 v70, v70, v14
 v_mfma_f32_16x16x32_bf16 v[208:211], a[224:227], a[144:147], v[208:211]
 s_add_u32 s70, s70, 8192
 s_addc_u32 s71, s71, 0
 v_mfma_f32_16x16x32_bf16 v[208:211], a[228:231], a[148:151], v[208:211]
 v_add_f32 v71, v71, v15
 v_mfma_f32_16x16x32_bf16 v[212:215], a[228:231], a[156:159], v[212:215]
 v_add_f32 v72, v72, v12
 v_mfma_f32_16x16x32_bf16 v[212:215], a[224:227], a[152:155], v[212:215]
 v_mfma_f32_16x16x32_bf16 v[216:219], a[224:227], a[160:163], v[216:219]
 v_add_f32 v73, v73, v13
 v_mfma_f32_16x16x32_bf16 v[216:219], a[228:231], a[164:167], v[216:219]
 v_add_f32 v74, v74, v14
 v_mfma_f32_16x16x32_bf16 v[220:223], a[228:231], a[172:175], v[220:223]
 v_add_f32 v75, v75, v15
 v_mfma_f32_16x16x32_bf16 v[220:223], a[224:227], a[168:171], v[220:223]
 v_mfma_f32_16x16x32_bf16 v[224:227], a[224:227], a[176:179], v[224:227]
 v_add_f32 v76, v76, v12
 v_mfma_f32_16x16x32_bf16 v[224:227], a[228:231], a[180:183], v[224:227]
 v_add_f32 v77, v77, v13
 v_mfma_f32_16x16x32_bf16 v[228:231], a[228:231], a[188:191], v[228:231]
 v_mfma_f32_16x16x32_bf16 v[228:231], a[224:227], a[184:187], v[228:231]
 v_add_f32 v78, v78, v14
 s_waitcnt vmcnt(8)
 v_mfma_f32_16x16x32_bf16 a[252:255], a[232:235], a[184:187], a[252:255]
 ds_read_b128 a[184:187], v1 offset:61440
 v_add_f32 v79, v79, v15
 v_mfma_f32_16x16x32_bf16 a[252:255], a[236:239], a[188:191], a[252:255]
 global_load_dwordx4 a[228:231], v0, s[70:71] offset:-3072 sc1
 ds_read_b128 a[188:191], v1 offset:62464
 v_mfma_f32_16x16x32_bf16 a[248:251], a[236:239], a[180:183], a[248:251]
 ds_read_b128 a[180:183], v1 offset:58368
 s_waitcnt lgkmcnt(3)
 v_mfma_f32_16x16x32_bf16 a[248:251], a[232:235], a[176:179], a[248:251]
 global_load_dwordx4 a[224:227], v0, s[70:71] offset:-4096 sc1
 ds_read_b128 a[176:179], v1 offset:57344
 v_mfma_f32_16x16x32_bf16 v[252:255], a[232:235], a[168:171], v[252:255]
 ds_read_b128 a[168:171], v1 offset:53248
 v_add_f32 v80, v80, v8
 v_mfma_f32_16x16x32_bf16 v[252:255], a[236:239], a[172:175], v[252:255]
 ds_read_b128 a[172:175], v1 offset:54272
 ds_read_b128 v[12:15], v4 offset:144
 v_mfma_f32_16x16x32_bf16 v[248:251], a[236:239], a[164:167], v[248:251]
 ds_read_b128 a[164:167], v1 offset:50176
 v_add_f32 v81, v81, v9
 v_mfma_f32_16x16x32_bf16 v[248:251], a[232:235], a[160:163], v[248:251]
 ds_read_b128 a[160:163], v1 offset:49152
 v_add_f32 v82, v82, v10
 v_mfma_f32_16x16x32_bf16 v[244:247], a[232:235], a[152:155], v[244:247]
 ds_read_b128 a[152:155], v1 offset:45056
 v_mfma_f32_16x16x32_bf16 v[244:247], a[236:239], a[156:159], v[244:247]
 ds_read_b128 a[156:159], v1 offset:46080
 v_add_f32 v83, v83, v11
 v_mfma_f32_16x16x32_bf16 v[240:243], a[236:239], a[148:151], v[240:243]
 ds_read_b128 a[148:151], v1 offset:41984
 v_add_f32 v84, v84, v8
 v_mfma_f32_16x16x32_bf16 v[240:243], a[232:235], a[144:147], v[240:243]
 ds_read_b128 a[144:147], v1 offset:40960
 v_mfma_f32_16x16x32_bf16 v[236:239], a[232:235], a[136:139], v[236:239]
 ds_read_b128 a[136:139], v1 offset:36864
 v_add_f32 v85, v85, v9
 v_mfma_f32_16x16x32_bf16 v[236:239], a[236:239], a[140:143], v[236:239]
 ds_read_b128 a[140:143], v1 offset:37888
 v_add_f32 v86, v86, v10
 v_mfma_f32_16x16x32_bf16 v[232:235], a[236:239], a[132:135], v[232:235]
 ds_read_b128 a[132:135], v1 offset:33792
 v_mfma_f32_16x16x32_bf16 v[232:235], a[232:235], a[128:131], v[232:235]
 ds_read_b128 a[128:131], v1 offset:32768
 v_add_f32 v87, v87, v11
 s_waitcnt vmcnt(8) lgkmcnt(8)
 v_mfma_f32_16x16x32_bf16 v[164:167], a[192:195], a[184:187], v[164:167]
 v_add_f32 v88, v88, v8
 v_mfma_f32_16x16x32_bf16 v[164:167], a[196:199], a[188:191], v[164:167]
 global_load_dwordx4 a[236:239], v0, s[70:71] offset:-1024 sc1
 v_add_f32 v89, v89, v9
 v_mfma_f32_16x16x32_bf16 v[160:163], a[196:199], a[180:183], v[160:163]
 v_mfma_f32_16x16x32_bf16 v[160:163], a[192:195], a[176:179], v[160:163]
 global_load_dwordx4 a[232:235], v0, s[70:71] offset:-2048 sc1
 v_add_f32 v90, v90, v10
 v_mfma_f32_16x16x32_bf16 v[156:159], a[192:195], a[168:171], v[156:159]
 v_add_f32 v91, v91, v11
 v_mfma_f32_16x16x32_bf16 v[156:159], a[196:199], a[172:175], v[156:159]
 v_mfma_f32_16x16x32_bf16 v[152:155], a[196:199], a[164:167], v[152:155]
 v_add_f32 v92, v92, v8
 v_mfma_f32_16x16x32_bf16 v[152:155], a[192:195], a[160:163], v[152:155]
 v_add_f32 v93, v93, v9
 s_waitcnt lgkmcnt(0)
 v_mfma_f32_16x16x32_bf16 v[148:151], a[192:195], a[152:155], v[148:151]
 v_mfma_f32_16x16x32_bf16 v[148:151], a[196:199], a[156:159], v[148:151]
 v_add_f32 v94, v94, v10
 v_mfma_f32_16x16x32_bf16 v[144:147], a[196:199], a[148:151], v[144:147]
 v_add_f32 v95, v95, v11
 v_mfma_f32_16x16x32_bf16 v[144:147], a[192:195], a[144:147], v[144:147]
 buffer_load_dword v4, off, s[64:67], 0 sc1
 v_mfma_f32_16x16x32_bf16 v[140:143], a[192:195], a[136:139], v[140:143]
 v_mfma_f32_16x16x32_bf16 v[140:143], a[196:199], a[140:143], v[140:143]
 v_add_f32 v96, v96, v8
 v_mfma_f32_16x16x32_bf16 v[136:139], a[196:199], a[132:135], v[136:139]
 v_add_f32 v97, v97, v9
 v_mfma_f32_16x16x32_bf16 v[136:139], a[192:195], a[128:131], v[136:139]
 s_waitcnt vmcnt(9)
 v_mfma_f32_16x16x32_bf16 v[168:171], a[200:203], a[128:131], v[168:171]
 v_add_f32 v98, v98, v10
 v_mfma_f32_16x16x32_bf16 v[168:171], a[204:207], a[132:135], v[168:171]
 global_load_dwordx4 a[196:199], v0, s[70:71] offset:1024 sc1
 v_add_f32 v99, v99, v11
 v_mfma_f32_16x16x32_bf16 v[172:175], a[204:207], a[140:143], v[172:175]
 v_mfma_f32_16x16x32_bf16 v[172:175], a[200:203], a[136:139], v[172:175]
 global_load_dwordx4 a[192:195], v0, s[70:71] offset:0 sc1
 v_add_f32 v100, v100, v8
 v_mfma_f32_16x16x32_bf16 v[176:179], a[200:203], a[144:147], v[176:179]
 v_add_f32 v101, v101, v9
 v_mfma_f32_16x16x32_bf16 v[176:179], a[204:207], a[148:151], v[176:179]
 v_mfma_f32_16x16x32_bf16 v[180:183], a[204:207], a[156:159], v[180:183]
 v_add_f32 v102, v102, v10
 v_mfma_f32_16x16x32_bf16 v[180:183], a[200:203], a[152:155], v[180:183]
 v_add_f32 v103, v103, v11
 v_mfma_f32_16x16x32_bf16 v[184:187], a[200:203], a[160:163], v[184:187]
 v_add_f32 v104, v104, v8
 v_mfma_f32_16x16x32_bf16 v[184:187], a[204:207], a[164:167], v[184:187]
 v_mfma_f32_16x16x32_bf16 v[188:191], a[204:207], a[172:175], v[188:191]
 v_add_f32 v105, v105, v9
 v_mfma_f32_16x16x32_bf16 v[188:191], a[200:203], a[168:171], v[188:191]
 v_add_f32 v106, v106, v10
 v_mfma_f32_16x16x32_bf16 v[192:195], a[200:203], a[176:179], v[192:195]
 v_mfma_f32_16x16x32_bf16 v[192:195], a[204:207], a[180:183], v[192:195]
 v_add_f32 v107, v107, v11
 v_mfma_f32_16x16x32_bf16 v[196:199], a[204:207], a[188:191], v[196:199]
 v_add_f32 v108, v108, v8
 v_mfma_f32_16x16x32_bf16 v[196:199], a[200:203], a[184:187], v[196:199]
 s_waitcnt vmcnt(9)
 v_mfma_f32_16x16x32_bf16 v[228:231], a[208:211], a[184:187], v[228:231]
 v_add_f32 v109, v109, v9
 v_mfma_f32_16x16x32_bf16 v[228:231], a[212:215], a[188:191], v[228:231]
 global_load_dwordx4 a[204:207], v0, s[70:71] offset:3072 sc1
 v_add_f32 v110, v110, v10
 v_mfma_f32_16x16x32_bf16 v[224:227], a[212:215], a[180:183], v[224:227]
 v_add_f32 v111, v111, v11
 v_mfma_f32_16x16x32_bf16 v[224:227], a[208:211], a[176:179], v[224:227]
 global_load_dwordx4 a[200:203], v0, s[70:71] offset:2048 sc1
 v_mfma_f32_16x16x32_bf16 v[220:223], a[208:211], a[168:171], v[220:223]
 s_add_u32 s70, s70, 8192
 s_addc_u32 s71, s71, 0
 v_mfma_f32_16x16x32_bf16 v[220:223], a[212:215], a[172:175], v[220:223]
 v_add_f32 v112, v112, v12
 v_mfma_f32_16x16x32_bf16 v[216:219], a[212:215], a[164:167], v[216:219]
 v_mfma_f32_16x16x32_bf16 v[216:219], a[208:211], a[160:163], v[216:219]
 v_add_f32 v113, v113, v13
 v_mfma_f32_16x16x32_bf16 v[212:215], a[208:211], a[152:155], v[212:215]
 v_add_f32 v114, v114, v14
 v_mfma_f32_16x16x32_bf16 v[212:215], a[212:215], a[156:159], v[212:215]
 v_mfma_f32_16x16x32_bf16 v[208:211], a[212:215], a[148:151], v[208:211]
 v_add_f32 v115, v115, v15
 v_mfma_f32_16x16x32_bf16 v[208:211], a[208:211], a[144:147], v[208:211]
 v_add_f32 v116, v116, v12
 v_mfma_f32_16x16x32_bf16 v[204:207], a[208:211], a[136:139], v[204:207]
 v_add_f32 v117, v117, v13
 v_mfma_f32_16x16x32_bf16 v[204:207], a[212:215], a[140:143], v[204:207]
 v_mfma_f32_16x16x32_bf16 v[200:203], a[212:215], a[132:135], v[200:203]
 v_add_f32 v118, v118, v14
 v_mfma_f32_16x16x32_bf16 v[200:203], a[208:211], a[128:131], v[200:203]
 v_add_f32 v119, v119, v15
 s_waitcnt vmcnt(9)
 v_mfma_f32_16x16x32_bf16 v[232:235], a[216:219], a[128:131], v[232:235]
 ds_read_b128 a[128:131], v1
 v_add_f32 v120, v120, v12
 v_mfma_f32_16x16x32_bf16 v[232:235], a[220:223], a[132:135], v[232:235]
 global_load_dwordx4 a[212:215], v0, s[70:71] offset:-3072 sc1
 ds_read_b128 a[132:135], v1 offset:1024
 v_mfma_f32_16x16x32_bf16 v[236:239], a[220:223], a[140:143], v[236:239]
 ds_read_b128 a[140:143], v1 offset:5120
 v_add_f32 v121, v121, v13
 v_mfma_f32_16x16x32_bf16 v[236:239], a[216:219], a[136:139], v[236:239]
 global_load_dwordx4 a[208:211], v0, s[70:71] offset:-4096 sc1
 ds_read_b128 a[136:139], v1 offset:4096
 v_mfma_f32_16x16x32_bf16 v[240:243], a[216:219], a[144:147], v[240:243]
 ds_read_b128 a[144:147], v1 offset:8192
 v_add_f32 v122, v122, v14
 v_mfma_f32_16x16x32_bf16 v[240:243], a[220:223], a[148:151], v[240:243]
 ds_read_b128 a[148:151], v1 offset:9216
 v_add_f32 v123, v123, v15
 v_mfma_f32_16x16x32_bf16 v[244:247], a[220:223], a[156:159], v[244:247]
 ds_read_b128 a[156:159], v1 offset:13312
 v_mfma_f32_16x16x32_bf16 v[244:247], a[216:219], a[152:155], v[244:247]
 ds_read_b128 a[152:155], v1 offset:12288
 v_add_f32 v124, v124, v12
 v_mfma_f32_16x16x32_bf16 v[248:251], a[216:219], a[160:163], v[248:251]
 ds_read_b128 a[160:163], v1 offset:16384
 v_add_f32 v125, v125, v13
 v_mfma_f32_16x16x32_bf16 v[248:251], a[220:223], a[164:167], v[248:251]
 ds_read_b128 a[164:167], v1 offset:17408
 v_add_f32 v126, v126, v14
 v_mfma_f32_16x16x32_bf16 v[252:255], a[220:223], a[172:175], v[252:255]
 ds_read_b128 a[172:175], v1 offset:21504
 v_mfma_f32_16x16x32_bf16 v[252:255], a[216:219], a[168:171], v[252:255]
 ds_read_b128 a[168:171], v1 offset:20480
 v_add_f32 v127, v127, v15
 v_mfma_f32_16x16x32_bf16 a[248:251], a[216:219], a[176:179], a[248:251]
 ds_read_b128 a[176:179], v1 offset:24576
 v_add_f32 v128, v128, v12
 v_mfma_f32_16x16x32_bf16 a[248:251], a[220:223], a[180:183], a[248:251]
 ds_read_b128 a[180:183], v1 offset:25600
 v_mfma_f32_16x16x32_bf16 a[252:255], a[220:223], a[188:191], a[252:255]
 ds_read_b128 a[188:191], v1 offset:29696
 v_add_f32 v129, v129, v13
 v_mfma_f32_16x16x32_bf16 a[252:255], a[216:219], a[184:187], a[252:255]
 ds_read_b128 a[184:187], v1 offset:28672
 v_add_f32 v130, v130, v14
 s_waitcnt vmcnt(9) lgkmcnt(8)
 v_mfma_f32_16x16x32_bf16 v[136:139], a[224:227], a[128:131], v[136:139]
 v_mfma_f32_16x16x32_bf16 v[136:139], a[228:231], a[132:135], v[136:139]
 global_load_dwordx4 a[220:223], v0, s[70:71] offset:-1024 sc1
 v_add_f32 v131, v131, v15
 v_mfma_f32_16x16x32_bf16 v[140:143], a[228:231], a[140:143], v[140:143]
 v_add_f32 v132, v132, v12
 v_mfma_f32_16x16x32_bf16 v[140:143], a[224:227], a[136:139], v[140:143]
 global_load_dwordx4 a[216:219], v0, s[70:71] offset:-2048 sc1
 v_add_f32 v133, v133, v13
 v_mfma_f32_16x16x32_bf16 v[144:147], a[224:227], a[144:147], v[144:147]
 v_mfma_f32_16x16x32_bf16 v[144:147], a[228:231], a[148:151], v[144:147]
 v_add_f32 v134, v134, v14
 v_mfma_f32_16x16x32_bf16 v[148:151], a[228:231], a[156:159], v[148:151]
 v_add_f32 v135, v135, v15
 v_mfma_f32_16x16x32_bf16 v[148:151], a[224:227], a[152:155], v[148:151]
 s_waitcnt lgkmcnt(0)
 v_mfma_f32_16x16x32_bf16 v[152:155], a[224:227], a[160:163], v[152:155]
 v_accvgpr_read_b32 v5, a240
 v_mfma_f32_16x16x32_bf16 v[152:155], a[228:231], a[164:167], v[152:155]
 v_add_f32 v5, v5, v12
 v_mfma_f32_16x16x32_bf16 v[156:159], a[228:231], a[172:175], v[156:159]
 v_mfma_f32_16x16x32_bf16 v[156:159], a[224:227], a[168:171], v[156:159]
 v_accvgpr_write_b32 a240, v5
 v_mfma_f32_16x16x32_bf16 v[160:163], a[224:227], a[176:179], v[160:163]
 v_accvgpr_read_b32 v6, a241
 v_mfma_f32_16x16x32_bf16 v[160:163], a[228:231], a[180:183], v[160:163]
 v_mfma_f32_16x16x32_bf16 v[164:167], a[228:231], a[188:191], v[164:167]
 v_add_f32 v6, v6, v13
 v_mfma_f32_16x16x32_bf16 v[164:167], a[224:227], a[184:187], v[164:167]
 v_accvgpr_write_b32 a241, v6
 s_waitcnt vmcnt(9)
 v_mfma_f32_16x16x32_bf16 v[196:199], a[232:235], a[184:187], v[196:199]
 v_accvgpr_read_b32 v5, a242
 v_mfma_f32_16x16x32_bf16 v[196:199], a[236:239], a[188:191], v[196:199]
 global_load_dwordx4 a[228:231], v0, s[70:71] offset:1024 sc1
 v_mfma_f32_16x16x32_bf16 v[192:195], a[236:239], a[180:183], v[192:195]
 v_add_f32 v5, v5, v14
 v_mfma_f32_16x16x32_bf16 v[192:195], a[232:235], a[176:179], v[192:195]
 global_load_dwordx4 a[224:227], v0, s[70:71] offset:0 sc1
 v_accvgpr_write_b32 a242, v5
 v_mfma_f32_16x16x32_bf16 v[188:191], a[232:235], a[168:171], v[188:191]
 v_mfma_f32_16x16x32_bf16 v[188:191], a[236:239], a[172:175], v[188:191]
 v_accvgpr_read_b32 v6, a243
 v_mfma_f32_16x16x32_bf16 v[184:187], a[236:239], a[164:167], v[184:187]
 v_add_f32 v6, v6, v15
 v_mfma_f32_16x16x32_bf16 v[184:187], a[232:235], a[160:163], v[184:187]
 v_mfma_f32_16x16x32_bf16 v[180:183], a[232:235], a[152:155], v[180:183]
 v_accvgpr_write_b32 a243, v6
 v_mfma_f32_16x16x32_bf16 v[180:183], a[236:239], a[156:159], v[180:183]
 v_accvgpr_read_b32 v5, a244
 v_mfma_f32_16x16x32_bf16 v[176:179], a[236:239], a[148:151], v[176:179]
 v_add_f32 v5, v5, v12
 v_mfma_f32_16x16x32_bf16 v[176:179], a[232:235], a[144:147], v[176:179]
 v_mfma_f32_16x16x32_bf16 v[172:175], a[232:235], a[136:139], v[172:175]
 v_accvgpr_write_b32 a244, v5
 v_mfma_f32_16x16x32_bf16 v[172:175], a[236:239], a[140:143], v[172:175]
 v_accvgpr_read_b32 v6, a245
 v_mfma_f32_16x16x32_bf16 v[168:171], a[236:239], a[132:135], v[168:171]
 v_mfma_f32_16x16x32_bf16 v[168:171], a[232:235], a[128:131], v[168:171]
 v_add_f32 v6, v6, v13
 s_waitcnt vmcnt(8)
 v_mfma_f32_16x16x32_bf16 v[200:203], a[192:195], a[128:131], v[200:203]
 v_accvgpr_write_b32 a245, v6
 v_mfma_f32_16x16x32_bf16 v[200:203], a[196:199], a[132:135], v[200:203]
 global_load_dwordx4 a[236:239], v0, s[70:71] offset:3072 sc1
 v_mfma_f32_16x16x32_bf16 v[204:207], a[196:199], a[140:143], v[204:207]
 v_accvgpr_read_b32 v5, a246
 v_mfma_f32_16x16x32_bf16 v[204:207], a[192:195], a[136:139], v[204:207]
 global_load_dwordx4 a[232:235], v0, s[70:71] offset:2048 sc1
 v_add_f32 v5, v5, v14
 v_mfma_f32_16x16x32_bf16 v[208:211], a[192:195], a[144:147], v[208:211]
 v_accvgpr_write_b32 a246, v5
 s_add_u32 s70, s70, 8192
 s_addc_u32 s71, s71, 0
 v_mfma_f32_16x16x32_bf16 v[208:211], a[196:199], a[148:151], v[208:211]
 v_mfma_f32_16x16x32_bf16 v[212:215], a[196:199], a[156:159], v[212:215]
 v_accvgpr_read_b32 v6, a247
 v_mfma_f32_16x16x32_bf16 v[212:215], a[192:195], a[152:155], v[212:215]
 v_add_f32 v6, v6, v15
 v_mfma_f32_16x16x32_bf16 v[216:219], a[192:195], a[160:163], v[216:219]
 v_mfma_f32_16x16x32_bf16 v[216:219], a[196:199], a[164:167], v[216:219]
 v_accvgpr_write_b32 a247, v6
 v_mfma_f32_16x16x32_bf16 v[220:223], a[196:199], a[172:175], v[220:223]
 v_cmp_gt_i32 vcc, s55, v4
 s_and_b64 vcc, exec, vcc
 s_cbranch_vccnz Lspin_pa
Lok_pa:
 s_add_u32 s55, s55, 1
 s_waitcnt lgkmcnt(0)
 s_barrier
 v_mfma_f32_16x16x32_bf16 v[220:223], a[192:195], a[168:171], v[220:223]
 v_mfma_f32_16x16x32_bf16 v[224:227], a[192:195], a[176:179], v[224:227]
 v_mfma_f32_16x16x32_bf16 v[224:227], a[196:199], a[180:183], v[224:227]
 v_mfma_f32_16x16x32_bf16 v[228:231], a[196:199], a[188:191], v[228:231]
 v_mfma_f32_16x16x32_bf16 v[228:231], a[192:195], a[184:187], v[228:231]
 s_waitcnt vmcnt(8)
 v_mfma_f32_16x16x32_bf16 a[252:255], a[200:203], a[184:187], a[252:255]
 ds_read_b128 a[184:187], v1 offset:30720
 v_mfma_f32_16x16x32_bf16 a[252:255], a[204:207], a[188:191], a[252:255]
 global_load_dwordx4 a[196:199], v0, s[70:71] offset:-3072 sc1
 ds_read_b128 a[188:191], v1 offset:31744
 v_mfma_f32_16x16x32_bf16 a[248:251], a[204:207], a[180:183], a[248:251]
 ds_read_b128 a[180:183], v1 offset:27648
 v_mfma_f32_16x16x32_bf16 a[248:251], a[200:203], a[176:179], a[248:251]
 global_load_dwordx4 a[192:195], v0, s[70:71] offset:-4096 sc1
 ds_read_b128 a[176:179], v1 offset:26624
 v_mfma_f32_16x16x32_bf16 v[252:255], a[200:203], a[168:171], v[252:255]
 ds_read_b128 a[168:171], v1 offset:22528
 v_mfma_f32_16x16x32_bf16 v[252:255], a[204:207], a[172:175], v[252:255]
 ds_read_b128 a[172:175], v1 offset:23552
 v_mfma_f32_16x16x32_bf16 v[248:251], a[204:207], a[164:167], v[248:251]
 ds_read_b128 a[164:167], v1 offset:19456
 v_mfma_f32_16x16x32_bf16 v[248:251], a[200:203], a[160:163], v[248:251]
 ds_read_b128 a[160:163], v1 offset:18432
 v_mfma_f32_16x16x32_bf16 v[244:247], a[200:203], a[152:155], v[244:247]
 ds_read_b128 a[152:155], v1 offset:14336
 v_mfma_f32_16x16x32_bf16 v[244:247], a[204:207], a[156:159], v[244:247]
 ds_read_b128 a[156:159], v1 offset:15360
 v_mfma_f32_16x16x32_bf16 v[240:243], a[204:207], a[148:151], v[240:243]
 ds_read_b128 a[148:151], v1 offset:11264
 v_mfma_f32_16x16x32_bf16 v[240:243], a[200:203], a[144:147], v[240:243]
 ds_read_b128 a[144:147], v1 offset:10240
 v_mfma_f32_16x16x32_bf16 v[236:239], a[200:203], a[136:139], v[236:239]
 ds_read_b128 a[136:139], v1 offset:6144
 v_mfma_f32_16x16x32_bf16 v[236:239], a[204:207], a[140:143], v[236:239]
 ds_read_b128 a[140:143], v1 offset:7168
 v_mfma_f32_16x16x32_bf16 v[232:235], a[204:207], a[132:135], v[232:235]
 global_load_dwordx4 a[204:207], v0, s[70:71] offset:-1024 sc1
 ds_read_b128 a[132:135], v1 offset:3072
 v_mfma_f32_16x16x32_bf16 v[232:235], a[200:203], a[128:131], v[232:235]
 global_load_dwordx4 a[200:203], v0, s[70:71] offset:-2048 sc1
 ds_read_b128 a[128:131], v1 offset:2048
 s_waitcnt vmcnt(10) lgkmcnt(8)
 s_branch Lloop
Llast:
 v_mfma_f32_16x16x32_bf16 v[136:139], a[208:211], a[128:131], v[136:139]
 v_accvgpr_read_b32 v5, a0
 v_lshlrev_b32 v6, 16, v5
 v_mfma_f32_16x16x32_bf16 v[136:139], a[212:215], a[132:135], v[136:139]
 v_and_b32 v5, s26, v5
 v_mul_f32 v6, v6, v16
 v_mfma_f32_16x16x32_bf16 v[140:143], a[212:215], a[140:143], v[140:143]
 v_mul_f32 v5, v5, v17
 v_cvt_pk_bf16_f32 v8, v6, v5
 v_mfma_f32_16x16x32_bf16 v[140:143], a[208:211], a[136:139], v[140:143]
 v_accvgpr_read_b32 v5, a1
 v_lshlrev_b32 v6, 16, v5
 v_mfma_f32_16x16x32_bf16 v[144:147], a[208:211], a[144:147], v[144:147]
 v_and_b32 v5, s26, v5
 v_mul_f32 v6, v6, v18
 v_mfma_f32_16x16x32_bf16 v[144:147], a[212:215], a[148:151], v[144:147]
 v_mul_f32 v5, v5, v19
 v_cvt_pk_bf16_f32 v9, v6, v5
 v_mfma_f32_16x16x32_bf16 v[148:151], a[212:215], a[156:159], v[148:151]
 v_accvgpr_read_b32 v5, a2
 v_lshlrev_b32 v6, 16, v5
 v_mfma_f32_16x16x32_bf16 v[148:151], a[208:211], a[152:155], v[148:151]
 v_and_b32 v5, s26, v5
 v_mul_f32 v6, v6, v48
 v_mfma_f32_16x16x32_bf16 v[152:155], a[208:211], a[160:163], v[152:155]
 v_mul_f32 v5, v5, v49
 v_cvt_pk_bf16_f32 v10, v6, v5
 v_mfma_f32_16x16x32_bf16 v[152:155], a[212:215], a[164:167], v[152:155]
 v_accvgpr_read_b32 v5, a3
 v_lshlrev_b32 v6, 16, v5
 v_mfma_f32_16x16x32_bf16 v[156:159], a[212:215], a[172:175], v[156:159]
 v_and_b32 v5, s26, v5
 v_mul_f32 v6, v6, v50
 v_mfma_f32_16x16x32_bf16 v[156:159], a[208:211], a[168:171], v[156:159]
 v_mul_f32 v5, v5, v51
 v_cvt_pk_bf16_f32 v11, v6, v5
 v_mfma_f32_16x16x32_bf16 v[160:163], a[208:211], a[176:179], v[160:163]
 v_lshrrev_b32 v5, 7, v1
 v_lshlrev_b32 v6, 4, v5
 v_mfma_f32_16x16x32_bf16 v[160:163], a[212:215], a[180:183], v[160:163]
 v_xor_b32 v6, v6, v1
 v_and_b32 v6, 112, v6
 v_mfma_f32_16x16x32_bf16 v[164:167], a[212:215], a[188:191], v[164:167]
 v_lshl_add_u32 v16, v5, 11, v6
 v_lshrrev_b32 v5, 4, v1
 v_mfma_f32_16x16x32_bf16 v[164:167], a[208:211], a[184:187], v[164:167]
 v_and_b32 v5, 48, v5
 v_xor_b32 v5, v5, v1
 s_waitcnt vmcnt(8)
 v_mfma_f32_16x16x32_bf16 v[196:199], a[216:219], a[184:187], v[196:199]
 v_and_b32 v5, 112, v5
 v_and_b32 v6, 240, v1
 v_mfma_f32_16x16x32_bf16 v[196:199], a[220:223], a[188:191], v[196:199]
 global_load_dwordx4 a[212:215], v0, s[70:71] offset:1024 sc1
 v_lshl_add_u32 v5, v6, 3, v5
 v_mfma_f32_16x16x32_bf16 v[192:195], a[220:223], a[180:183], v[192:195]
 v_add_u32 v17, s50, v5
 v_xor_b32 v18, 64, v17
 v_mfma_f32_16x16x32_bf16 v[192:195], a[216:219], a[176:179], v[192:195]
 global_load_dwordx4 a[208:211], v0, s[70:71] offset:0 sc1
 ds_write_b128 v17, v[8:11]
 v_mfma_f32_16x16x32_bf16 v[188:191], a[216:219], a[168:171], v[188:191]
 v_accvgpr_read_b32 v5, a32
 v_lshlrev_b32 v6, 16, v5
 v_mfma_f32_16x16x32_bf16 v[188:191], a[220:223], a[172:175], v[188:191]
 v_and_b32 v5, s26, v5
 v_mul_f32 v6, v6, v80
 v_mfma_f32_16x16x32_bf16 v[184:187], a[220:223], a[164:167], v[184:187]
 v_mul_f32 v5, v5, v81
 v_cvt_pk_bf16_f32 v12, v6, v5
 v_mfma_f32_16x16x32_bf16 v[184:187], a[216:219], a[160:163], v[184:187]
 v_accvgpr_read_b32 v5, a33
 v_lshlrev_b32 v6, 16, v5
 v_mfma_f32_16x16x32_bf16 v[180:183], a[216:219], a[152:155], v[180:183]
 v_and_b32 v5, s26, v5
 v_mul_f32 v6, v6, v82
 v_mfma_f32_16x16x32_bf16 v[180:183], a[220:223], a[156:159], v[180:183]
 v_mul_f32 v5, v5, v83
 v_cvt_pk_bf16_f32 v13, v6, v5
 v_mfma_f32_16x16x32_bf16 v[176:179], a[220:223], a[148:151], v[176:179]
 v_accvgpr_read_b32 v5, a34
 v_lshlrev_b32 v6, 16, v5
 v_mfma_f32_16x16x32_bf16 v[176:179], a[216:219], a[144:147], v[176:179]
 v_and_b32 v5, s26, v5
 v_mul_f32 v6, v6, v112
 v_mfma_f32_16x16x32_bf16 v[172:175], a[216:219], a[136:139], v[172:175]
 v_mul_f32 v5, v5, v113
 v_cvt_pk_bf16_f32 v14, v6, v5
 v_mfma_f32_16x16x32_bf16 v[172:175], a[220:223], a[140:143], v[172:175]
 v_accvgpr_read_b32 v5, a35
 v_lshlrev_b32 v6, 16, v5
 v_mfma_f32_16x16x32_bf16 v[168:171], a[220:223], a[132:135], v[168:171]
 v_and_b32 v5, s26, v5
 v_mul_f32 v6, v6, v114
 v_mfma_f32_16x16x32_bf16 v[168:171], a[216:219], a[128:131], v[168:171]
 v_mul_f32 v5, v5, v115
 v_cvt_pk_bf16_f32 v15, v6, v5
 s_waitcnt vmcnt(8)
 v_mfma_f32_16x16x32_bf16 v[200:203], a[224:227], a[128:131], v[200:203]
 ds_write_b128 v18, v[12:15]
 v_mfma_f32_16x16x32_bf16 v[200:203], a[228:231], a[132:135], v[200:203]
 global_load_dwordx4 a[220:223], v0, s[70:71] offset:3072 sc1
 ds_read_b128 v[48:51], v3
 v_mfma_f32_16x16x32_bf16 v[204:207], a[228:231], a[140:143], v[204:207]
 ds_read_b128 v[80:83], v3 offset:1024
 v_accvgpr_read_b32 v5, a4
 v_mfma_f32_16x16x32_bf16 v[204:207], a[224:227], a[136:139], v[204:207]
 global_load_dwordx4 a[216:219], v0, s[70:71] offset:2048 sc1
 v_lshlrev_b32 v6, 16, v5
 v_mfma_f32_16x16x32_bf16 v[208:211], a[224:227], a[144:147], v[208:211]
 v_and_b32 v5, s26, v5
 v_mul_f32 v6, v6, v20
 s_add_u32 s70, s70, 8192
 s_addc_u32 s71, s71, 0
 v_mfma_f32_16x16x32_bf16 v[208:211], a[228:231], a[148:151], v[208:211]
 v_mul_f32 v5, v5, v21
 v_cvt_pk_bf16_f32 v8, v6, v5
 v_mfma_f32_16x16x32_bf16 v[212:215], a[228:231], a[156:159], v[212:215]
 v_accvgpr_read_b32 v5, a5
 v_lshlrev_b32 v6, 16, v5
 v_mfma_f32_16x16x32_bf16 v[212:215], a[224:227], a[152:155], v[212:215]
 v_and_b32 v5, s26, v5
 v_mul_f32 v6, v6, v22
 v_mfma_f32_16x16x32_bf16 v[216:219], a[224:227], a[160:163], v[216:219]
 v_mul_f32 v5, v5, v23
 v_cvt_pk_bf16_f32 v9, v6, v5
 s_waitcnt lgkmcnt(1)
 s_add_u32 s3, s28, 0
 v_mfma_f32_16x16x32_bf16 v[216:219], a[228:231], a[164:167], v[216:219]
 buffer_store_dwordx4 v[48:51], v16, s[16:19], s3 offen nt
 s_waitcnt lgkmcnt(0)
 s_add_u32 s3, s28, 16384
 buffer_store_dwordx4 v[80:83], v16, s[16:19], s3 offen nt
 v_accvgpr_read_b32 v5, a6
 v_lshlrev_b32 v6, 16, v5
 v_and_b32 v5, s26, v5
 v_mul_f32 v6, v6, v52
 v_mfma_f32_16x16x32_bf16 v[220:223], a[228:231], a[172:175], v[220:223]
 v_mul_f32 v5, v5, v53
 v_cvt_pk_bf16_f32 v10, v6, v5
 v_mfma_f32_16x16x32_bf16 v[220:223], a[224:227], a[168:171], v[220:223]
 v_accvgpr_read_b32 v5, a7
 v_lshlrev_b32 v6, 16, v5
 v_mfma_f32_16x16x32_bf16 v[224:227], a[224:227], a[176:179], v[224:227]
 v_and_b32 v5, s26, v5
 v_mul_f32 v6, v6, v54
 v_mul_f32 v5, v5, v55
 v_cvt_pk_bf16_f32 v11, v6, v5
 v_mfma_f32_16x16x32_bf16 v[224:227], a[228:231], a[180:183], v[224:227]
 ds_write_b128 v17, v[8:11] offset:4096
 v_mfma_f32_16x16x32_bf16 v[228:231], a[228:231], a[188:191], v[228:231]
 v_accvgpr_read_b32 v5, a36
 v_lshlrev_b32 v6, 16, v5
 v_mfma_f32_16x16x32_bf16 v[228:231], a[224:227], a[184:187], v[228:231]
 v_and_b32 v5, s26, v5
 v_mul_f32 v6, v6, v84
 s_waitcnt vmcnt(10)
 v_mfma_f32_16x16x32_bf16 a[252:255], a[232:235], a[184:187], a[252:255]
 ds_read_b128 a[184:187], v2 offset:30720
 v_mul_f32 v5, v5, v85
 v_mfma_f32_16x16x32_bf16 a[252:255], a[236:239], a[188:191], a[252:255]
 global_load_dwordx4 a[228:231], v0, s[70:71] offset:-3072 sc1
 ds_read_b128 a[188:191], v2 offset:31744
 v_mfma_f32_16x16x32_bf16 a[248:251], a[236:239], a[180:183], a[248:251]
 ds_read_b128 a[180:183], v2 offset:27648
 v_cvt_pk_bf16_f32 v12, v6, v5
 v_mfma_f32_16x16x32_bf16 a[248:251], a[232:235], a[176:179], a[248:251]
 global_load_dwordx4 a[224:227], v0, s[70:71] offset:-4096 sc1
 ds_read_b128 a[176:179], v2 offset:26624
 v_mfma_f32_16x16x32_bf16 v[252:255], a[232:235], a[168:171], v[252:255]
 ds_read_b128 a[168:171], v2 offset:22528
 v_accvgpr_read_b32 v5, a37
 v_mfma_f32_16x16x32_bf16 v[252:255], a[236:239], a[172:175], v[252:255]
 ds_read_b128 a[172:175], v2 offset:23552
 v_lshlrev_b32 v6, 16, v5
 v_mfma_f32_16x16x32_bf16 v[248:251], a[236:239], a[164:167], v[248:251]
 ds_read_b128 a[164:167], v2 offset:19456
 v_and_b32 v5, s26, v5
 v_mfma_f32_16x16x32_bf16 v[248:251], a[232:235], a[160:163], v[248:251]
 ds_read_b128 a[160:163], v2 offset:18432
 v_mul_f32 v6, v6, v86
 v_mul_f32 v5, v5, v87
 v_mfma_f32_16x16x32_bf16 v[244:247], a[232:235], a[152:155], v[244:247]
 ds_read_b128 a[152:155], v2 offset:14336
 v_cvt_pk_bf16_f32 v13, v6, v5
 v_mfma_f32_16x16x32_bf16 v[244:247], a[236:239], a[156:159], v[244:247]
 ds_read_b128 a[156:159], v2 offset:15360
 v_accvgpr_read_b32 v5, a38
 v_lshlrev_b32 v6, 16, v5
 v_mfma_f32_16x16x32_bf16 v[240:243], a[236:239], a[148:151], v[240:243]
 ds_read_b128 a[148:151], v2 offset:11264
 v_and_b32 v5, s26, v5
 v_mul_f32 v6, v6, v116
 v_mfma_f32_16x16x32_bf16 v[240:243], a[232:235], a[144:147], v[240:243]
 ds_read_b128 a[144:147], v2 offset:10240
 v_mul_f32 v5, v5, v117
 v_mfma_f32_16x16x32_bf16 v[236:239], a[232:235], a[136:139], v[236:239]
 ds_read_b128 a[136:139], v2 offset:6144
 v_cvt_pk_bf16_f32 v14, v6, v5
 v_mfma_f32_16x16x32_bf16 v[236:239], a[236:239], a[140:143], v[236:239]
 ds_read_b128 a[140:143], v2 offset:7168
 v_accvgpr_read_b32 v5, a39
 v_mfma_f32_16x16x32_bf16 v[232:235], a[236:239], a[132:135], v[232:235]
 ds_read_b128 a[132:135], v2 offset:3072
 v_lshlrev_b32 v6, 16, v5
 v_mfma_f32_16x16x32_bf16 v[232:235], a[232:235], a[128:131], v[232:235]
 ds_read_b128 a[128:131], v2 offset:2048
 v_and_b32 v5, s26, v5
 s_waitcnt vmcnt(10) lgkmcnt(8)
 v_mfma_f32_16x16x32_bf16 v[164:167], a[192:195], a[184:187], v[164:167]
 v_mul_f32 v6, v6, v118
 v_mul_f32 v5, v5, v119
 v_mfma_f32_16x16x32_bf16 v[164:167], a[196:199], a[188:191], v[164:167]
 global_load_dwordx4 a[236:239], v0, s[70:71] offset:-1024 sc1
 v_cvt_pk_bf16_f32 v15, v6, v5
 v_mfma_f32_16x16x32_bf16 v[160:163], a[196:199], a[180:183], v[160:163]
 ds_write_b128 v18, v[12:15] offset:4096
 ds_read_b128 v[48:51], v3 offset:4096
 v_mfma_f32_16x16x32_bf16 v[160:163], a[192:195], a[176:179], v[160:163]
 global_load_dwordx4 a[232:235], v0, s[70:71] offset:-2048 sc1
 ds_read_b128 v[80:83], v3 offset:5120
 v_mfma_f32_16x16x32_bf16 v[156:159], a[192:195], a[168:171], v[156:159]
 v_accvgpr_read_b32 v5, a8
 v_lshlrev_b32 v6, 16, v5
 v_mfma_f32_16x16x32_bf16 v[156:159], a[196:199], a[172:175], v[156:159]
 v_and_b32 v5, s26, v5
 v_mul_f32 v6, v6, v24
 v_mfma_f32_16x16x32_bf16 v[152:155], a[196:199], a[164:167], v[152:155]
 v_mul_f32 v5, v5, v25
 v_cvt_pk_bf16_f32 v8, v6, v5
 v_mfma_f32_16x16x32_bf16 v[152:155], a[192:195], a[160:163], v[152:155]
 v_accvgpr_read_b32 v5, a9
 v_lshlrev_b32 v6, 16, v5
 s_waitcnt lgkmcnt(3)
 v_mfma_f32_16x16x32_bf16 v[148:151], a[192:195], a[152:155], v[148:151]
 v_and_b32 v5, s26, v5
 v_mul_f32 v6, v6, v26
 v_mfma_f32_16x16x32_bf16 v[148:151], a[196:199], a[156:159], v[148:151]
 v_mul_f32 v5, v5, v27
 v_cvt_pk_bf16_f32 v9, v6, v5
 s_waitcnt lgkmcnt(1)
 s_add_u32 s3, s28, 32768
 v_mfma_f32_16x16x32_bf16 v[144:147], a[196:199], a[148:151], v[144:147]
 buffer_store_dwordx4 v[48:51], v16, s[16:19], s3 offen nt
 s_waitcnt lgkmcnt(0)
 s_add_u32 s3, s28, 49152
 buffer_store_dwordx4 v[80:83], v16, s[16:19], s3 offen nt
 v_accvgpr_read_b32 v5, a10
 v_lshlrev_b32 v6, 16, v5
 v_and_b32 v5, s26, v5
 v_mul_f32 v6, v6, v56
 v_mfma_f32_16x16x32_bf16 v[144:147], a[192:195], a[144:147], v[144:147]
 v_mul_f32 v5, v5, v57
 v_cvt_pk_bf16_f32 v10, v6, v5
 v_mfma_f32_16x16x32_bf16 v[140:143], a[192:195], a[136:139], v[140:143]
 v_accvgpr_read_b32 v5, a11
 v_lshlrev_b32 v6, 16, v5
 v_mfma_f32_16x16x32_bf16 v[140:143], a[196:199], a[140:143], v[140:143]
 v_and_b32 v5, s26, v5
 v_mul_f32 v6, v6, v58
 v_mfma_f32_16x16x32_bf16 v[136:139], a[196:199], a[132:135], v[136:139]
 v_mul_f32 v5, v5, v59
 v_cvt_pk_bf16_f32 v11, v6, v5
 v_mfma_f32_16x16x32_bf16 v[136:139], a[192:195], a[128:131], v[136:139]
 ds_write_b128 v17, v[8:11] offset:8192
 s_waitcnt vmcnt(12)
 v_mfma_f32_16x16x32_bf16 v[168:171], a[200:203], a[128:131], v[168:171]
 v_accvgpr_read_b32 v5, a40
 v_lshlrev_b32 v6, 16, v5
 v_mfma_f32_16x16x32_bf16 v[168:171], a[204:207], a[132:135], v[168:171]
 global_load_dwordx4 a[196:199], v0, s[70:71] offset:1024 sc1
 v_and_b32 v5, s26, v5
 v_mfma_f32_16x16x32_bf16 v[172:175], a[204:207], a[140:143], v[172:175]
 v_mul_f32 v6, v6, v88
 v_mul_f32 v5, v5, v89
 v_mfma_f32_16x16x32_bf16 v[172:175], a[200:203], a[136:139], v[172:175]
 global_load_dwordx4 a[192:195], v0, s[70:71] offset:0 sc1
 v_cvt_pk_bf16_f32 v12, v6, v5
 v_mfma_f32_16x16x32_bf16 v[176:179], a[200:203], a[144:147], v[176:179]
 v_accvgpr_read_b32 v5, a41
 v_lshlrev_b32 v6, 16, v5
 v_mfma_f32_16x16x32_bf16 v[176:179], a[204:207], a[148:151], v[176:179]
 v_and_b32 v5, s26, v5
 v_mul_f32 v6, v6, v90
 v_mfma_f32_16x16x32_bf16 v[180:183], a[204:207], a[156:159], v[180:183]
 v_mul_f32 v5, v5, v91
 v_cvt_pk_bf16_f32 v13, v6, v5
 v_mfma_f32_16x16x32_bf16 v[180:183], a[200:203], a[152:155], v[180:183]
 v_accvgpr_read_b32 v5, a42
 v_lshlrev_b32 v6, 16, v5
 v_mfma_f32_16x16x32_bf16 v[184:187], a[200:203], a[160:163], v[184:187]
 v_and_b32 v5, s26, v5
 v_mul_f32 v6, v6, v120
 v_mfma_f32_16x16x32_bf16 v[184:187], a[204:207], a[164:167], v[184:187]
 v_mul_f32 v5, v5, v121
 v_cvt_pk_bf16_f32 v14, v6, v5
 v_mfma_f32_16x16x32_bf16 v[188:191], a[204:207], a[172:175], v[188:191]
 v_accvgpr_read_b32 v5, a43
 v_lshlrev_b32 v6, 16, v5
 v_mfma_f32_16x16x32_bf16 v[188:191], a[200:203], a[168:171], v[188:191]
 v_and_b32 v5, s26, v5
 v_mul_f32 v6, v6, v122
 v_mfma_f32_16x16x32_bf16 v[192:195], a[200:203], a[176:179], v[192:195]
 v_mul_f32 v5, v5, v123
 v_cvt_pk_bf16_f32 v15, v6, v5
 v_mfma_f32_16x16x32_bf16 v[192:195], a[204:207], a[180:183], v[192:195]
 ds_write_b128 v18, v[12:15] offset:8192
 v_mfma_f32_16x16x32_bf16 v[196:199], a[204:207], a[188:191], v[196:199]
 ds_read_b128 v[48:51], v3 offset:8192
 ds_read_b128 v[80:83], v3 offset:9216
 v_mfma_f32_16x16x32_bf16 v[196:199], a[200:203], a[184:187], v[196:199]
 v_accvgpr_read_b32 v5, a12
 v_lshlrev_b32 v6, 16, v5
 s_waitcnt vmcnt(12)
 v_mfma_f32_16x16x32_bf16 v[228:231], a[208:211], a[184:187], v[228:231]
 v_and_b32 v5, s26, v5
 v_mul_f32 v6, v6, v28
 v_mfma_f32_16x16x32_bf16 v[228:231], a[212:215], a[188:191], v[228:231]
 global_load_dwordx4 a[204:207], v0, s[70:71] offset:3072 sc1
 v_mul_f32 v5, v5, v29
 v_mfma_f32_16x16x32_bf16 v[224:227], a[212:215], a[180:183], v[224:227]
 v_cvt_pk_bf16_f32 v8, v6, v5
 v_accvgpr_read_b32 v5, a13
 v_mfma_f32_16x16x32_bf16 v[224:227], a[208:211], a[176:179], v[224:227]
 global_load_dwordx4 a[200:203], v0, s[70:71] offset:2048 sc1
 v_lshlrev_b32 v6, 16, v5
 v_mfma_f32_16x16x32_bf16 v[220:223], a[208:211], a[168:171], v[220:223]
 v_and_b32 v5, s26, v5
 v_mul_f32 v6, v6, v30
 s_add_u32 s70, s70, 8192
 s_addc_u32 s71, s71, 0
 v_mfma_f32_16x16x32_bf16 v[220:223], a[212:215], a[172:175], v[220:223]
 v_mul_f32 v5, v5, v31
 v_cvt_pk_bf16_f32 v9, v6, v5
 s_waitcnt lgkmcnt(1)
 v_mfma_f32_16x16x32_bf16 v[216:219], a[212:215], a[164:167], v[216:219]
 s_add_u32 s3, s28, 65536
 buffer_store_dwordx4 v[48:51], v16, s[16:19], s3 offen nt
 s_waitcnt lgkmcnt(0)
 v_mfma_f32_16x16x32_bf16 v[216:219], a[208:211], a[160:163], v[216:219]
 s_add_u32 s3, s28, 81920
 buffer_store_dwordx4 v[80:83], v16, s[16:19], s3 offen nt
 v_accvgpr_read_b32 v5, a14
 v_lshlrev_b32 v6, 16, v5
 v_and_b32 v5, s26, v5
 v_mul_f32 v6, v6, v60
 v_mfma_f32_16x16x32_bf16 v[212:215], a[208:211], a[152:155], v[212:215]
 v_mul_f32 v5, v5, v61
 v_cvt_pk_bf16_f32 v10, v6, v5
 v_mfma_f32_16x16x32_bf16 v[212:215], a[212:215], a[156:159], v[212:215]
 v_accvgpr_read_b32 v5, a15
 v_lshlrev_b32 v6, 16, v5
 v_mfma_f32_16x16x32_bf16 v[208:211], a[212:215], a[148:151], v[208:211]
 v_and_b32 v5, s26, v5
 v_mul_f32 v6, v6, v62
 v_mfma_f32_16x16x32_bf16 v[208:211], a[208:211], a[144:147], v[208:211]
 v_mul_f32 v5, v5, v63
 v_cvt_pk_bf16_f32 v11, v6, v5
 v_mfma_f32_16x16x32_bf16 v[204:207], a[208:211], a[136:139], v[204:207]
 ds_write_b128 v17, v[8:11] offset:12288
 v_mfma_f32_16x16x32_bf16 v[204:207], a[212:215], a[140:143], v[204:207]
 v_accvgpr_read_b32 v5, a44
 v_lshlrev_b32 v6, 16, v5
 v_mfma_f32_16x16x32_bf16 v[200:203], a[212:215], a[132:135], v[200:203]
 v_and_b32 v5, s26, v5
 v_mul_f32 v6, v6, v92
 v_mfma_f32_16x16x32_bf16 v[200:203], a[208:211], a[128:131], v[200:203]
 v_mul_f32 v5, v5, v93
 v_cvt_pk_bf16_f32 v12, v6, v5
 s_waitcnt vmcnt(14)
 v_mfma_f32_16x16x32_bf16 v[232:235], a[216:219], a[128:131], v[232:235]
 ds_read_b128 a[128:131], v1 offset:34816
 v_accvgpr_read_b32 v5, a45
 v_mfma_f32_16x16x32_bf16 v[232:235], a[220:223], a[132:135], v[232:235]
 global_load_dwordx4 a[212:215], v0, s[70:71] offset:-3072 sc1
 ds_read_b128 a[132:135], v1 offset:35840
 v_mfma_f32_16x16x32_bf16 v[236:239], a[220:223], a[140:143], v[236:239]
 ds_read_b128 a[140:143], v1 offset:39936
 v_lshlrev_b32 v6, 16, v5
 v_mfma_f32_16x16x32_bf16 v[236:239], a[216:219], a[136:139], v[236:239]
 global_load_dwordx4 a[208:211], v0, s[70:71] offset:-4096 sc1
 ds_read_b128 a[136:139], v1 offset:38912
 v_and_b32 v5, s26, v5
 v_mfma_f32_16x16x32_bf16 v[240:243], a[216:219], a[144:147], v[240:243]
 ds_read_b128 a[144:147], v1 offset:43008
 v_mul_f32 v6, v6, v94
 v_mul_f32 v5, v5, v95
 v_mfma_f32_16x16x32_bf16 v[240:243], a[220:223], a[148:151], v[240:243]
 ds_read_b128 a[148:151], v1 offset:44032
 v_cvt_pk_bf16_f32 v13, v6, v5
 v_mfma_f32_16x16x32_bf16 v[244:247], a[220:223], a[156:159], v[244:247]
 ds_read_b128 a[156:159], v1 offset:48128
 v_accvgpr_read_b32 v5, a46
 v_lshlrev_b32 v6, 16, v5
 v_mfma_f32_16x16x32_bf16 v[244:247], a[216:219], a[152:155], v[244:247]
 ds_read_b128 a[152:155], v1 offset:47104
 v_and_b32 v5, s26, v5
 v_mul_f32 v6, v6, v124
 v_mfma_f32_16x16x32_bf16 v[248:251], a[216:219], a[160:163], v[248:251]
 ds_read_b128 a[160:163], v1 offset:51200
 v_mul_f32 v5, v5, v125
 v_mfma_f32_16x16x32_bf16 v[248:251], a[220:223], a[164:167], v[248:251]
 ds_read_b128 a[164:167], v1 offset:52224
 v_cvt_pk_bf16_f32 v14, v6, v5
 v_mfma_f32_16x16x32_bf16 v[252:255], a[220:223], a[172:175], v[252:255]
 ds_read_b128 a[172:175], v1 offset:56320
 v_accvgpr_read_b32 v5, a47
 v_mfma_f32_16x16x32_bf16 v[252:255], a[216:219], a[168:171], v[252:255]
 ds_read_b128 a[168:171], v1 offset:55296
 v_lshlrev_b32 v6, 16, v5
 v_mfma_f32_16x16x32_bf16 a[248:251], a[216:219], a[176:179], a[248:251]
 ds_read_b128 a[176:179], v1 offset:59392
 v_and_b32 v5, s26, v5
 v_mfma_f32_16x16x32_bf16 a[248:251], a[220:223], a[180:183], a[248:251]
 ds_read_b128 a[180:183], v1 offset:60416
 v_mul_f32 v6, v6, v126
 v_mfma_f32_16x16x32_bf16 a[252:255], a[220:223], a[188:191], a[252:255]
 ds_read_b128 a[188:191], v1 offset:64512
 v_mul_f32 v5, v5, v127
 v_mfma_f32_16x16x32_bf16 a[252:255], a[216:219], a[184:187], a[252:255]
 ds_read_b128 a[184:187], v1 offset:63488
 v_cvt_pk_bf16_f32 v15, v6, v5
 s_waitcnt vmcnt(12) lgkmcnt(8)
 v_mfma_f32_16x16x32_bf16 v[136:139], a[224:227], a[128:131], v[136:139]
 ds_write_b128 v18, v[12:15] offset:12288
 ds_read_b128 v[48:51], v3 offset:12288
 ds_read_b128 v[80:83], v3 offset:13312
 v_mfma_f32_16x16x32_bf16 v[136:139], a[228:231], a[132:135], v[136:139]
 global_load_dwordx4 a[220:223], v0, s[70:71] offset:-1024 sc1
 v_accvgpr_read_b32 v5, a16
 v_mfma_f32_16x16x32_bf16 v[140:143], a[228:231], a[140:143], v[140:143]
 v_lshlrev_b32 v6, 16, v5
 v_and_b32 v5, s26, v5
 v_mfma_f32_16x16x32_bf16 v[140:143], a[224:227], a[136:139], v[140:143]
 global_load_dwordx4 a[216:219], v0, s[70:71] offset:-2048 sc1
 v_mul_f32 v6, v6, v32
 v_mfma_f32_16x16x32_bf16 v[144:147], a[224:227], a[144:147], v[144:147]
 v_mul_f32 v5, v5, v33
 v_cvt_pk_bf16_f32 v8, v6, v5
 v_mfma_f32_16x16x32_bf16 v[144:147], a[228:231], a[148:151], v[144:147]
 v_accvgpr_read_b32 v5, a17
 v_lshlrev_b32 v6, 16, v5
 v_mfma_f32_16x16x32_bf16 v[148:151], a[228:231], a[156:159], v[148:151]
 v_and_b32 v5, s26, v5
 v_mul_f32 v6, v6, v34
 v_mfma_f32_16x16x32_bf16 v[148:151], a[224:227], a[152:155], v[148:151]
 v_mul_f32 v5, v5, v35
 v_cvt_pk_bf16_f32 v9, v6, v5
 s_waitcnt lgkmcnt(1)
 s_add_u32 s3, s28, 98304
 v_mfma_f32_16x16x32_bf16 v[152:155], a[224:227], a[160:163], v[152:155]
 buffer_store_dwordx4 v[48:51], v16, s[16:19], s3 offen nt
 s_waitcnt lgkmcnt(0)
 s_add_u32 s3, s28, 114688
 buffer_store_dwordx4 v[80:83], v16, s[16:19], s3 offen nt
 v_accvgpr_read_b32 v5, a18
 v_lshlrev_b32 v6, 16, v5
 v_and_b32 v5, s26, v5
 v_mul_f32 v6, v6, v64
 v_mfma_f32_16x16x32_bf16 v[152:155], a[228:231], a[164:167], v[152:155]
 v_mul_f32 v5, v5, v65
 v_cvt_pk_bf16_f32 v10, v6, v5
 v_mfma_f32_16x16x32_bf16 v[156:159], a[228:231], a[172:175], v[156:159]
 v_accvgpr_read_b32 v5, a19
 v_lshlrev_b32 v6, 16, v5
 v_mfma_f32_16x16x32_bf16 v[156:159], a[224:227], a[168:171], v[156:159]
 v_and_b32 v5, s26, v5
 v_mul_f32 v6, v6, v66
 v_mfma_f32_16x16x32_bf16 v[160:163], a[224:227], a[176:179], v[160:163]
 v_mul_f32 v5, v5, v67
 v_cvt_pk_bf16_f32 v11, v6, v5
 v_mfma_f32_16x16x32_bf16 v[160:163], a[228:231], a[180:183], v[160:163]
 ds_write_b128 v17, v[8:11] offset:16384
 v_mfma_f32_16x16x32_bf16 v[164:167], a[228:231], a[188:191], v[164:167]
 v_accvgpr_read_b32 v5, a48
 v_lshlrev_b32 v6, 16, v5
 v_mfma_f32_16x16x32_bf16 v[164:167], a[224:227], a[184:187], v[164:167]
 v_and_b32 v5, s26, v5
 v_mul_f32 v6, v6, v96
 s_waitcnt vmcnt(14)
 v_mfma_f32_16x16x32_bf16 v[196:199], a[232:235], a[184:187], v[196:199]
 v_mul_f32 v5, v5, v97
 v_cvt_pk_bf16_f32 v12, v6, v5
 v_mfma_f32_16x16x32_bf16 v[196:199], a[236:239], a[188:191], v[196:199]
 global_load_dwordx4 a[228:231], v0, s[70:71] offset:1024 sc1
 v_accvgpr_read_b32 v5, a49
 v_mfma_f32_16x16x32_bf16 v[192:195], a[236:239], a[180:183], v[192:195]
 v_lshlrev_b32 v6, 16, v5
 v_and_b32 v5, s26, v5
 v_mfma_f32_16x16x32_bf16 v[192:195], a[232:235], a[176:179], v[192:195]
 global_load_dwordx4 a[224:227], v0, s[70:71] offset:0 sc1
 v_mul_f32 v6, v6, v98
 v_mfma_f32_16x16x32_bf16 v[188:191], a[232:235], a[168:171], v[188:191]
 v_mul_f32 v5, v5, v99
 v_cvt_pk_bf16_f32 v13, v6, v5
 v_mfma_f32_16x16x32_bf16 v[188:191], a[236:239], a[172:175], v[188:191]
 v_accvgpr_read_b32 v5, a50
 v_lshlrev_b32 v6, 16, v5
 v_mfma_f32_16x16x32_bf16 v[184:187], a[236:239], a[164:167], v[184:187]
 v_and_b32 v5, s26, v5
 v_mul_f32 v6, v6, v128
 v_mfma_f32_16x16x32_bf16 v[184:187], a[232:235], a[160:163], v[184:187]
 v_mul_f32 v5, v5, v129
 v_cvt_pk_bf16_f32 v14, v6, v5
 v_mfma_f32_16x16x32_bf16 v[180:183], a[232:235], a[152:155], v[180:183]
 v_accvgpr_read_b32 v5, a51
 v_lshlrev_b32 v6, 16, v5
 v_mfma_f32_16x16x32_bf16 v[180:183], a[236:239], a[156:159], v[180:183]
 v_and_b32 v5, s26, v5
 v_mul_f32 v6, v6, v130
 v_mfma_f32_16x16x32_bf16 v[176:179], a[236:239], a[148:151], v[176:179]
 v_mul_f32 v5, v5, v131
 v_cvt_pk_bf16_f32 v15, v6, v5
 v_mfma_f32_16x16x32_bf16 v[176:179], a[232:235], a[144:147], v[176:179]
 ds_write_b128 v18, v[12:15] offset:16384
 v_mfma_f32_16x16x32_bf16 v[172:175], a[232:235], a[136:139], v[172:175]
 ds_read_b128 v[48:51], v3 offset:16384
 ds_read_b128 v[80:83], v3 offset:17408
 v_mfma_f32_16x16x32_bf16 v[172:175], a[236:239], a[140:143], v[172:175]
 v_accvgpr_read_b32 v5, a20
 v_lshlrev_b32 v6, 16, v5
 v_mfma_f32_16x16x32_bf16 v[168:171], a[236:239], a[132:135], v[168:171]
 v_and_b32 v5, s26, v5
 v_mul_f32 v6, v6, v36
 v_mfma_f32_16x16x32_bf16 v[168:171], a[232:235], a[128:131], v[168:171]
 v_mul_f32 v5, v5, v37
 v_cvt_pk_bf16_f32 v8, v6, v5
 s_waitcnt vmcnt(12)
 v_mfma_f32_16x16x32_bf16 v[200:203], a[192:195], a[128:131], v[200:203]
 v_accvgpr_read_b32 v5, a21
 v_lshlrev_b32 v6, 16, v5
 v_mfma_f32_16x16x32_bf16 v[200:203], a[196:199], a[132:135], v[200:203]
 global_load_dwordx4 a[236:239], v0, s[70:71] offset:3072 sc1
 v_and_b32 v5, s26, v5
 v_mfma_f32_16x16x32_bf16 v[204:207], a[196:199], a[140:143], v[204:207]
 v_mul_f32 v6, v6, v38
 v_mul_f32 v5, v5, v39
 v_mfma_f32_16x16x32_bf16 v[204:207], a[192:195], a[136:139], v[204:207]
 global_load_dwordx4 a[232:235], v0, s[70:71] offset:2048 sc1
 v_cvt_pk_bf16_f32 v9, v6, v5
 s_waitcnt lgkmcnt(1)
 s_add_u32 s3, s28, 131072
 v_mfma_f32_16x16x32_bf16 v[208:211], a[192:195], a[144:147], v[208:211]
 buffer_store_dwordx4 v[48:51], v16, s[16:19], s3 offen nt
 s_waitcnt lgkmcnt(0)
 s_add_u32 s3, s28, 147456
 s_add_u32 s70, s70, 1843200
 s_addc_u32 s71, s71, 0
 v_mfma_f32_16x16x32_bf16 v[208:211], a[196:199], a[148:151], v[208:211]
 buffer_store_dwordx4 v[80:83], v16, s[16:19], s3 offen nt
 v_accvgpr_read_b32 v5, a22
 v_lshlrev_b32 v6, 16, v5
 v_and_b32 v5, s26, v5
 v_mul_f32 v6, v6, v68
 v_mfma_f32_16x16x32_bf16 v[212:215], a[196:199], a[156:159], v[212:215]
 v_mul_f32 v5, v5, v69
 v_cvt_pk_bf16_f32 v10, v6, v5
 v_mfma_f32_16x16x32_bf16 v[212:215], a[192:195], a[152:155], v[212:215]
 v_accvgpr_read_b32 v5, a23
 v_lshlrev_b32 v6, 16, v5
 v_mfma_f32_16x16x32_bf16 v[216:219], a[192:195], a[160:163], v[216:219]
 v_and_b32 v5, s26, v5
 v_mul_f32 v6, v6, v70
 v_mfma_f32_16x16x32_bf16 v[216:219], a[196:199], a[164:167], v[216:219]
 v_mul_f32 v5, v5, v71
 v_cvt_pk_bf16_f32 v11, v6, v5
 v_mfma_f32_16x16x32_bf16 v[220:223], a[196:199], a[172:175], v[220:223]
 ds_write_b128 v17, v[8:11] offset:20480
 v_mfma_f32_16x16x32_bf16 v[220:223], a[192:195], a[168:171], v[220:223]
 v_accvgpr_read_b32 v5, a52
 v_lshlrev_b32 v6, 16, v5
 v_mfma_f32_16x16x32_bf16 v[224:227], a[192:195], a[176:179], v[224:227]
 v_and_b32 v5, s26, v5
 v_mul_f32 v6, v6, v100
 v_mfma_f32_16x16x32_bf16 v[224:227], a[196:199], a[180:183], v[224:227]
 v_mul_f32 v5, v5, v101
 v_cvt_pk_bf16_f32 v12, v6, v5
 v_mfma_f32_16x16x32_bf16 v[228:231], a[196:199], a[188:191], v[228:231]
 v_accvgpr_read_b32 v5, a53
 v_lshlrev_b32 v6, 16, v5
 v_mfma_f32_16x16x32_bf16 v[228:231], a[192:195], a[184:187], v[228:231]
 v_and_b32 v5, s26, v5
 v_mul_f32 v6, v6, v102
 s_waitcnt vmcnt(14)
 v_mfma_f32_16x16x32_bf16 a[252:255], a[200:203], a[184:187], a[252:255]
 ds_read_b128 a[184:187], v1 offset:30720
 v_mul_f32 v5, v5, v103
 v_mfma_f32_16x16x32_bf16 a[252:255], a[204:207], a[188:191], a[252:255]
 ds_read_b128 a[188:191], v1 offset:31744
 v_cvt_pk_bf16_f32 v13, v6, v5
 v_mfma_f32_16x16x32_bf16 a[248:251], a[204:207], a[180:183], a[248:251]
 ds_read_b128 a[180:183], v1 offset:27648
 v_accvgpr_read_b32 v5, a54
 v_mfma_f32_16x16x32_bf16 a[248:251], a[200:203], a[176:179], a[248:251]
 ds_read_b128 a[176:179], v1 offset:26624
 v_lshlrev_b32 v6, 16, v5
 v_mfma_f32_16x16x32_bf16 v[252:255], a[200:203], a[168:171], v[252:255]
 ds_read_b128 a[168:171], v1 offset:22528
 v_and_b32 v5, s26, v5
 v_mfma_f32_16x16x32_bf16 v[252:255], a[204:207], a[172:175], v[252:255]
 ds_read_b128 a[172:175], v1 offset:23552
 v_mul_f32 v6, v6, v132
 v_mfma_f32_16x16x32_bf16 v[248:251], a[204:207], a[164:167], v[248:251]
 ds_read_b128 a[164:167], v1 offset:19456
 v_mul_f32 v5, v5, v133
 v_mfma_f32_16x16x32_bf16 v[248:251], a[200:203], a[160:163], v[248:251]
 ds_read_b128 a[160:163], v1 offset:18432
 v_cvt_pk_bf16_f32 v14, v6, v5
 v_mfma_f32_16x16x32_bf16 v[244:247], a[200:203], a[152:155], v[244:247]
 ds_read_b128 a[152:155], v1 offset:14336
 v_accvgpr_read_b32 v5, a55
 v_mfma_f32_16x16x32_bf16 v[244:247], a[204:207], a[156:159], v[244:247]
 ds_read_b128 a[156:159], v1 offset:15360
 v_lshlrev_b32 v6, 16, v5
 v_mfma_f32_16x16x32_bf16 v[240:243], a[204:207], a[148:151], v[240:243]
 ds_read_b128 a[148:151], v1 offset:11264
 v_and_b32 v5, s26, v5
 v_mfma_f32_16x16x32_bf16 v[240:243], a[200:203], a[144:147], v[240:243]
 ds_read_b128 a[144:147], v1 offset:10240
 v_mul_f32 v6, v6, v134
 v_mfma_f32_16x16x32_bf16 v[236:239], a[200:203], a[136:139], v[236:239]
 ds_read_b128 a[136:139], v1 offset:6144
 v_mul_f32 v5, v5, v135
 v_mfma_f32_16x16x32_bf16 v[236:239], a[204:207], a[140:143], v[236:239]
 ds_read_b128 a[140:143], v1 offset:7168
 v_cvt_pk_bf16_f32 v15, v6, v5
 v_mfma_f32_16x16x32_bf16 v[232:235], a[204:207], a[132:135], v[232:235]
 ds_read_b128 a[132:135], v1 offset:3072
 v_mfma_f32_16x16x32_bf16 v[232:235], a[200:203], a[128:131], v[232:235]
 ds_read_b128 a[128:131], v1 offset:2048
 ds_write_b128 v18, v[12:15] offset:20480
 ds_read_b128 v[48:51], v3 offset:20480
 ds_read_b128 v[80:83], v3 offset:21504
 v_accvgpr_read_b32 v5, a24
 v_lshlrev_b32 v6, 16, v5
 s_waitcnt vmcnt(10) lgkmcnt(11)
 v_mfma_f32_16x16x32_bf16 v[164:167], a[208:211], a[184:187], v[164:167]
 v_and_b32 v5, s26, v5
 v_mul_f32 v6, v6, v40
 v_mfma_f32_16x16x32_bf16 v[164:167], a[212:215], a[188:191], v[164:167]
 v_mul_f32 v5, v5, v41
 v_cvt_pk_bf16_f32 v8, v6, v5
 v_mfma_f32_16x16x32_bf16 v[160:163], a[212:215], a[180:183], v[160:163]
 v_accvgpr_read_b32 v5, a25
 v_lshlrev_b32 v6, 16, v5
 v_mfma_f32_16x16x32_bf16 v[160:163], a[208:211], a[176:179], v[160:163]
 v_and_b32 v5, s26, v5
 v_mul_f32 v6, v6, v42
 v_mfma_f32_16x16x32_bf16 v[156:159], a[208:211], a[168:171], v[156:159]
 v_mul_f32 v5, v5, v43
 v_cvt_pk_bf16_f32 v9, v6, v5
 s_waitcnt lgkmcnt(1)
 s_add_u32 s3, s28, 163840
 v_mfma_f32_16x16x32_bf16 v[156:159], a[212:215], a[172:175], v[156:159]
 buffer_store_dwordx4 v[48:51], v16, s[16:19], s3 offen nt
 s_waitcnt lgkmcnt(0)
 s_add_u32 s3, s28, 180224
 buffer_store_dwordx4 v[80:83], v16, s[16:19], s3 offen nt
 v_accvgpr_read_b32 v5, a26
 v_lshlrev_b32 v6, 16, v5
 v_and_b32 v5, s26, v5
 v_mul_f32 v6, v6, v72
 v_mfma_f32_16x16x32_bf16 v[152:155], a[212:215], a[164:167], v[152:155]
 v_mul_f32 v5, v5, v73
 v_cvt_pk_bf16_f32 v10, v6, v5
 v_mfma_f32_16x16x32_bf16 v[152:155], a[208:211], a[160:163], v[152:155]
 v_accvgpr_read_b32 v5, a27
 v_lshlrev_b32 v6, 16, v5
 v_mfma_f32_16x16x32_bf16 v[148:151], a[208:211], a[152:155], v[148:151]
 v_and_b32 v5, s26, v5
 v_mul_f32 v6, v6, v74
 v_mfma_f32_16x16x32_bf16 v[148:151], a[212:215], a[156:159], v[148:151]
 v_mul_f32 v5, v5, v75
 v_cvt_pk_bf16_f32 v11, v6, v5
 v_mfma_f32_16x16x32_bf16 v[144:147], a[212:215], a[148:151], v[144:147]
 ds_write_b128 v17, v[8:11] offset:24576
 v_mfma_f32_16x16x32_bf16 v[144:147], a[208:211], a[144:147], v[144:147]
 v_accvgpr_read_b32 v5, a56
 v_lshlrev_b32 v6, 16, v5
 v_mfma_f32_16x16x32_bf16 v[140:143], a[208:211], a[136:139], v[140:143]
 v_and_b32 v5, s26, v5
 v_mul_f32 v6, v6, v104
 v_mfma_f32_16x16x32_bf16 v[140:143], a[212:215], a[140:143], v[140:143]
 v_mul_f32 v5, v5, v105
 v_cvt_pk_bf16_f32 v12, v6, v5
 v_mfma_f32_16x16x32_bf16 v[136:139], a[212:215], a[132:135], v[136:139]
 v_accvgpr_read_b32 v5, a57
 v_lshlrev_b32 v6, 16, v5
 v_mfma_f32_16x16x32_bf16 v[136:139], a[208:211], a[128:131], v[136:139]
 v_and_b32 v5, s26, v5
 v_mul_f32 v6, v6, v106
 s_waitcnt vmcnt(10)
 v_mfma_f32_16x16x32_bf16 v[168:171], a[216:219], a[128:131], v[168:171]
 v_mul_f32 v5, v5, v107
 v_cvt_pk_bf16_f32 v13, v6, v5
 v_mfma_f32_16x16x32_bf16 v[168:171], a[220:223], a[132:135], v[168:171]
 v_accvgpr_read_b32 v5, a58
 v_accvgpr_read_b32 v7, a240
 v_mfma_f32_16x16x32_bf16 v[172:175], a[220:223], a[140:143], v[172:175]
 v_lshlrev_b32 v6, 16, v5
 v_and_b32 v5, s26, v5
 v_mfma_f32_16x16x32_bf16 v[172:175], a[216:219], a[136:139], v[172:175]
 v_mul_f32 v6, v6, v7
 v_accvgpr_read_b32 v7, a241
 v_mfma_f32_16x16x32_bf16 v[176:179], a[216:219], a[144:147], v[176:179]
 v_mul_f32 v5, v5, v7
 v_cvt_pk_bf16_f32 v14, v6, v5
 v_mfma_f32_16x16x32_bf16 v[176:179], a[220:223], a[148:151], v[176:179]
 v_accvgpr_read_b32 v5, a59
 v_accvgpr_read_b32 v7, a242
 v_mfma_f32_16x16x32_bf16 v[180:183], a[220:223], a[156:159], v[180:183]
 v_lshlrev_b32 v6, 16, v5
 v_and_b32 v5, s26, v5
 v_mfma_f32_16x16x32_bf16 v[180:183], a[216:219], a[152:155], v[180:183]
 v_mul_f32 v6, v6, v7
 v_accvgpr_read_b32 v7, a243
 v_mfma_f32_16x16x32_bf16 v[184:187], a[216:219], a[160:163], v[184:187]
 v_mul_f32 v5, v5, v7
 v_cvt_pk_bf16_f32 v15, v6, v5
 v_mfma_f32_16x16x32_bf16 v[184:187], a[220:223], a[164:167], v[184:187]
 ds_write_b128 v18, v[12:15] offset:24576
 v_mfma_f32_16x16x32_bf16 v[188:191], a[220:223], a[172:175], v[188:191]
 ds_read_b128 v[48:51], v3 offset:24576
 ds_read_b128 v[80:83], v3 offset:25600
 v_mfma_f32_16x16x32_bf16 v[188:191], a[216:219], a[168:171], v[188:191]
 v_accvgpr_read_b32 v5, a28
 v_mfma_f32_16x16x32_bf16 v[192:195], a[216:219], a[176:179], v[192:195]
 v_lshlrev_b32 v6, 16, v5
 v_and_b32 v5, s26, v5
 v_mfma_f32_16x16x32_bf16 v[192:195], a[220:223], a[180:183], v[192:195]
 v_mul_f32 v6, v6, v44
 v_mul_f32 v5, v5, v45
 v_mfma_f32_16x16x32_bf16 v[196:199], a[220:223], a[188:191], v[196:199]
 v_cvt_pk_bf16_f32 v8, v6, v5
 v_accvgpr_read_b32 v5, a29
 v_mfma_f32_16x16x32_bf16 v[196:199], a[216:219], a[184:187], v[196:199]
 v_lshlrev_b32 v6, 16, v5
 v_and_b32 v5, s26, v5
 s_waitcnt vmcnt(6)
 v_mfma_f32_16x16x32_bf16 v[228:231], a[224:227], a[184:187], v[228:231]
 v_mul_f32 v6, v6, v46
 v_mul_f32 v5, v5, v47
 v_mfma_f32_16x16x32_bf16 v[228:231], a[228:231], a[188:191], v[228:231]
 v_cvt_pk_bf16_f32 v9, v6, v5
 s_waitcnt lgkmcnt(1)
 v_mfma_f32_16x16x32_bf16 v[224:227], a[228:231], a[180:183], v[224:227]
 s_add_u32 s3, s28, 196608
 buffer_store_dwordx4 v[48:51], v16, s[16:19], s3 offen nt
 v_mfma_f32_16x16x32_bf16 v[224:227], a[224:227], a[176:179], v[224:227]
 s_waitcnt lgkmcnt(0)
 s_add_u32 s3, s28, 212992
 v_mfma_f32_16x16x32_bf16 v[220:223], a[224:227], a[168:171], v[220:223]
 buffer_store_dwordx4 v[80:83], v16, s[16:19], s3 offen nt
 v_accvgpr_read_b32 v5, a30
 v_mfma_f32_16x16x32_bf16 v[220:223], a[228:231], a[172:175], v[220:223]
 v_lshlrev_b32 v6, 16, v5
 v_mfma_f32_16x16x32_bf16 v[216:219], a[228:231], a[164:167], v[216:219]
 v_and_b32 v5, s26, v5
 v_mul_f32 v6, v6, v76
 v_mfma_f32_16x16x32_bf16 v[216:219], a[224:227], a[160:163], v[216:219]
 v_mul_f32 v5, v5, v77
 v_cvt_pk_bf16_f32 v10, v6, v5
 v_mfma_f32_16x16x32_bf16 v[212:215], a[224:227], a[152:155], v[212:215]
 v_accvgpr_read_b32 v5, a31
 v_lshlrev_b32 v6, 16, v5
 v_mfma_f32_16x16x32_bf16 v[212:215], a[228:231], a[156:159], v[212:215]
 v_and_b32 v5, s26, v5
 v_mul_f32 v6, v6, v78
 v_mfma_f32_16x16x32_bf16 v[208:211], a[228:231], a[148:151], v[208:211]
 v_mul_f32 v5, v5, v79
 v_cvt_pk_bf16_f32 v11, v6, v5
 v_mfma_f32_16x16x32_bf16 v[208:211], a[224:227], a[144:147], v[208:211]
 ds_write_b128 v17, v[8:11] offset:28672
 v_mfma_f32_16x16x32_bf16 v[204:207], a[224:227], a[136:139], v[204:207]
 v_accvgpr_read_b32 v5, a60
 v_lshlrev_b32 v6, 16, v5
 v_mfma_f32_16x16x32_bf16 v[204:207], a[228:231], a[140:143], v[204:207]
 v_and_b32 v5, s26, v5
 v_mul_f32 v6, v6, v108
 v_mfma_f32_16x16x32_bf16 v[200:203], a[228:231], a[132:135], v[200:203]
 v_mul_f32 v5, v5, v109
 v_cvt_pk_bf16_f32 v12, v6, v5
 v_mfma_f32_16x16x32_bf16 v[200:203], a[224:227], a[128:131], v[200:203]
 v_accvgpr_read_b32 v5, a61
 v_lshlrev_b32 v6, 16, v5
 s_waitcnt vmcnt(6)
 v_mfma_f32_16x16x32_bf16 v[232:235], a[232:235], a[128:131], v[232:235]
 v_and_b32 v5, s26, v5
 v_mul_f32 v6, v6, v110
 v_mfma_f32_16x16x32_bf16 v[232:235], a[236:239], a[132:135], v[232:235]
 v_mul_f32 v5, v5, v111
 v_cvt_pk_bf16_f32 v13, v6, v5
 v_mfma_f32_16x16x32_bf16 v[236:239], a[236:239], a[140:143], v[236:239]
 v_accvgpr_read_b32 v5, a62
 v_accvgpr_read_b32 v7, a244
 v_mfma_f32_16x16x32_bf16 v[236:239], a[232:235], a[136:139], v[236:239]
 v_lshlrev_b32 v6, 16, v5
 v_and_b32 v5, s26, v5
 v_mfma_f32_16x16x32_bf16 v[240:243], a[232:235], a[144:147], v[240:243]
 v_mul_f32 v6, v6, v7
 v_accvgpr_read_b32 v7, a245
 v_mfma_f32_16x16x32_bf16 v[240:243], a[236:239], a[148:151], v[240:243]
 v_mul_f32 v5, v5, v7
 v_cvt_pk_bf16_f32 v14, v6, v5
 v_mfma_f32_16x16x32_bf16 v[244:247], a[236:239], a[156:159], v[244:247]
 v_accvgpr_read_b32 v5, a63
 v_accvgpr_read_b32 v7, a246
 v_mfma_f32_16x16x32_bf16 v[244:247], a[232:235], a[152:155], v[244:247]
 v_lshlrev_b32 v6, 16, v5
 v_and_b32 v5, s26, v5
 v_mfma_f32_16x16x32_bf16 v[248:251], a[232:235], a[160:163], v[248:251]
 v_mul_f32 v6, v6, v7
 v_accvgpr_read_b32 v7, a247
 v_mfma_f32_16x16x32_bf16 v[248:251], a[236:239], a[164:167], v[248:251]
 v_mul_f32 v5, v5, v7
 v_cvt_pk_bf16_f32 v15, v6, v5
 v_mfma_f32_16x16x32_bf16 v[252:255], a[236:239], a[172:175], v[252:255]
 ds_write_b128 v18, v[12:15] offset:28672
 v_mfma_f32_16x16x32_bf16 v[252:255], a[232:235], a[168:171], v[252:255]
 ds_read_b128 v[48:51], v3 offset:28672
 ds_read_b128 v[80:83], v3 offset:29696
 v_mfma_f32_16x16x32_bf16 a[248:251], a[232:235], a[176:179], a[248:251]
 s_waitcnt lgkmcnt(1)
 s_add_u32 s3, s28, 229376
 v_mfma_f32_16x16x32_bf16 a[248:251], a[236:239], a[180:183], a[248:251]
 buffer_store_dwordx4 v[48:51], v16, s[16:19], s3 offen nt
 s_waitcnt lgkmcnt(0)
 v_mfma_f32_16x16x32_bf16 a[252:255], a[236:239], a[188:191], a[252:255]
 s_add_u32 s3, s28, 245760
 buffer_store_dwordx4 v[80:83], v16, s[16:19], s3 offen nt
 v_mfma_f32_16x16x32_bf16 a[252:255], a[232:235], a[184:187], a[252:255]
 s_nop 7
 v_accvgpr_read_b32 v7, a64
 v_lshlrev_b32 v6, 16, v7
 v_and_b32 v7, s26, v7
 v_pk_mul_f32 v[6:7], v[6:7], v[136:137]
 v_cvt_pk_bf16_f32 v8, v6, v7
 v_accvgpr_read_b32 v7, a65
 v_lshlrev_b32 v6, 16, v7
 v_and_b32 v7, s26, v7
 v_pk_mul_f32 v[6:7], v[6:7], v[138:139]
 v_cvt_pk_bf16_f32 v9, v6, v7
 v_accvgpr_read_b32 v7, a66
 v_lshlrev_b32 v6, 16, v7
 v_and_b32 v7, s26, v7
 v_pk_mul_f32 v[6:7], v[6:7], v[168:169]
 v_cvt_pk_bf16_f32 v10, v6, v7
 v_accvgpr_read_b32 v7, a67
 v_lshlrev_b32 v6, 16, v7
 v_and_b32 v7, s26, v7
 v_pk_mul_f32 v[6:7], v[6:7], v[170:171]
 v_cvt_pk_bf16_f32 v11, v6, v7
 ds_write_b128 v17, v[8:11]
 v_accvgpr_read_b32 v7, a96
 v_lshlrev_b32 v6, 16, v7
 v_and_b32 v7, s26, v7
 v_pk_mul_f32 v[6:7], v[6:7], v[200:201]
 v_cvt_pk_bf16_f32 v12, v6, v7
 v_accvgpr_read_b32 v7, a97
 v_lshlrev_b32 v6, 16, v7
 v_and_b32 v7, s26, v7
 v_pk_mul_f32 v[6:7], v[6:7], v[202:203]
 v_cvt_pk_bf16_f32 v13, v6, v7
 v_accvgpr_read_b32 v7, a98
 v_lshlrev_b32 v6, 16, v7
 v_and_b32 v7, s26, v7
 v_pk_mul_f32 v[6:7], v[6:7], v[232:233]
 v_cvt_pk_bf16_f32 v14, v6, v7
 v_accvgpr_read_b32 v7, a99
 v_lshlrev_b32 v6, 16, v7
 v_and_b32 v7, s26, v7
 v_pk_mul_f32 v[6:7], v[6:7], v[234:235]
 v_cvt_pk_bf16_f32 v15, v6, v7
 ds_write_b128 v18, v[12:15]
 ds_read_b128 v[48:51], v3
 ds_read_b128 v[80:83], v3 offset:1024
 v_accvgpr_read_b32 v7, a68
 v_lshlrev_b32 v6, 16, v7
 v_and_b32 v7, s26, v7
 v_pk_mul_f32 v[6:7], v[6:7], v[140:141]
 v_cvt_pk_bf16_f32 v8, v6, v7
 v_accvgpr_read_b32 v7, a69
 v_lshlrev_b32 v6, 16, v7
 v_and_b32 v7, s26, v7
 v_pk_mul_f32 v[6:7], v[6:7], v[142:143]
 v_cvt_pk_bf16_f32 v9, v6, v7
 v_accvgpr_read_b32 v7, a70
 v_lshlrev_b32 v6, 16, v7
 s_waitcnt lgkmcnt(1)
 s_add_u32 s3, s28, 0
 buffer_store_dwordx4 v[48:51], v16, s[16:19], s3 offen offset:128 nt
 s_waitcnt lgkmcnt(0)
 s_add_u32 s3, s28, 16384
 buffer_store_dwordx4 v[80:83], v16, s[16:19], s3 offen offset:128 nt
 v_and_b32 v7, s26, v7
 v_pk_mul_f32 v[6:7], v[6:7], v[172:173]
 v_cvt_pk_bf16_f32 v10, v6, v7
 v_accvgpr_read_b32 v7, a71
 v_lshlrev_b32 v6, 16, v7
 v_and_b32 v7, s26, v7
 v_pk_mul_f32 v[6:7], v[6:7], v[174:175]
 v_cvt_pk_bf16_f32 v11, v6, v7
 ds_write_b128 v17, v[8:11] offset:4096
 v_accvgpr_read_b32 v7, a100
 v_lshlrev_b32 v6, 16, v7
 v_and_b32 v7, s26, v7
 v_pk_mul_f32 v[6:7], v[6:7], v[204:205]
 v_cvt_pk_bf16_f32 v12, v6, v7
 v_accvgpr_read_b32 v7, a101
 v_lshlrev_b32 v6, 16, v7
 v_and_b32 v7, s26, v7
 v_pk_mul_f32 v[6:7], v[6:7], v[206:207]
 v_cvt_pk_bf16_f32 v13, v6, v7
 v_accvgpr_read_b32 v7, a102
 v_lshlrev_b32 v6, 16, v7
 v_and_b32 v7, s26, v7
 v_pk_mul_f32 v[6:7], v[6:7], v[236:237]
 v_cvt_pk_bf16_f32 v14, v6, v7
 v_accvgpr_read_b32 v7, a103
 v_lshlrev_b32 v6, 16, v7
 v_and_b32 v7, s26, v7
 v_pk_mul_f32 v[6:7], v[6:7], v[238:239]
 v_cvt_pk_bf16_f32 v15, v6, v7
 ds_write_b128 v18, v[12:15] offset:4096
 ds_read_b128 v[48:51], v3 offset:4096
 ds_read_b128 v[80:83], v3 offset:5120
 v_accvgpr_read_b32 v7, a72
 v_lshlrev_b32 v6, 16, v7
 v_and_b32 v7, s26, v7
 v_pk_mul_f32 v[6:7], v[6:7], v[144:145]
 v_cvt_pk_bf16_f32 v8, v6, v7
 v_accvgpr_read_b32 v7, a73
 v_lshlrev_b32 v6, 16, v7
 v_and_b32 v7, s26, v7
 v_pk_mul_f32 v[6:7], v[6:7], v[146:147]
 v_cvt_pk_bf16_f32 v9, v6, v7
 v_accvgpr_read_b32 v7, a74
 v_lshlrev_b32 v6, 16, v7
 s_waitcnt lgkmcnt(1)
 s_add_u32 s3, s28, 32768
 buffer_store_dwordx4 v[48:51], v16, s[16:19], s3 offen offset:128 nt
 s_waitcnt lgkmcnt(0)
 s_add_u32 s3, s28, 49152
 buffer_store_dwordx4 v[80:83], v16, s[16:19], s3 offen offset:128 nt
 v_and_b32 v7, s26, v7
 v_pk_mul_f32 v[6:7], v[6:7], v[176:177]
 v_cvt_pk_bf16_f32 v10, v6, v7
 v_accvgpr_read_b32 v7, a75
 v_lshlrev_b32 v6, 16, v7
 v_and_b32 v7, s26, v7
 v_pk_mul_f32 v[6:7], v[6:7], v[178:179]
 v_cvt_pk_bf16_f32 v11, v6, v7
 ds_write_b128 v17, v[8:11] offset:8192
 v_accvgpr_read_b32 v7, a104
 v_lshlrev_b32 v6, 16, v7
 v_and_b32 v7, s26, v7
 v_pk_mul_f32 v[6:7], v[6:7], v[208:209]
 v_cvt_pk_bf16_f32 v12, v6, v7
 v_accvgpr_read_b32 v7, a105
 v_lshlrev_b32 v6, 16, v7
 v_and_b32 v7, s26, v7
 v_pk_mul_f32 v[6:7], v[6:7], v[210:211]
 v_cvt_pk_bf16_f32 v13, v6, v7
 v_accvgpr_read_b32 v7, a106
 v_lshlrev_b32 v6, 16, v7
 v_and_b32 v7, s26, v7
 v_pk_mul_f32 v[6:7], v[6:7], v[240:241]
 v_cvt_pk_bf16_f32 v14, v6, v7
 v_accvgpr_read_b32 v7, a107
 v_lshlrev_b32 v6, 16, v7
 v_and_b32 v7, s26, v7
 v_pk_mul_f32 v[6:7], v[6:7], v[242:243]
 v_cvt_pk_bf16_f32 v15, v6, v7
 ds_write_b128 v18, v[12:15] offset:8192
 ds_read_b128 v[48:51], v3 offset:8192
 ds_read_b128 v[80:83], v3 offset:9216
 v_accvgpr_read_b32 v7, a76
 v_lshlrev_b32 v6, 16, v7
 v_and_b32 v7, s26, v7
 v_pk_mul_f32 v[6:7], v[6:7], v[148:149]
 v_cvt_pk_bf16_f32 v8, v6, v7
 v_accvgpr_read_b32 v7, a77
 v_lshlrev_b32 v6, 16, v7
 v_and_b32 v7, s26, v7
 v_pk_mul_f32 v[6:7], v[6:7], v[150:151]
 v_cvt_pk_bf16_f32 v9, v6, v7
 v_accvgpr_read_b32 v7, a78
 v_lshlrev_b32 v6, 16, v7
 s_waitcnt lgkmcnt(1)
 s_add_u32 s3, s28, 65536
 buffer_store_dwordx4 v[48:51], v16, s[16:19], s3 offen offset:128 nt
 s_waitcnt lgkmcnt(0)
 s_add_u32 s3, s28, 81920
 buffer_store_dwordx4 v[80:83], v16, s[16:19], s3 offen offset:128 nt
 v_and_b32 v7, s26, v7
 v_pk_mul_f32 v[6:7], v[6:7], v[180:181]
 v_cvt_pk_bf16_f32 v10, v6, v7
 v_accvgpr_read_b32 v7, a79
 v_lshlrev_b32 v6, 16, v7
 v_and_b32 v7, s26, v7
 v_pk_mul_f32 v[6:7], v[6:7], v[182:183]
 v_cvt_pk_bf16_f32 v11, v6, v7
 ds_write_b128 v17, v[8:11] offset:12288
 v_accvgpr_read_b32 v7, a108
 v_lshlrev_b32 v6, 16, v7
 v_and_b32 v7, s26, v7
 v_pk_mul_f32 v[6:7], v[6:7], v[212:213]
 v_cvt_pk_bf16_f32 v12, v6, v7
 v_accvgpr_read_b32 v7, a109
 v_lshlrev_b32 v6, 16, v7
 v_and_b32 v7, s26, v7
 v_pk_mul_f32 v[6:7], v[6:7], v[214:215]
 v_cvt_pk_bf16_f32 v13, v6, v7
 v_accvgpr_read_b32 v7, a110
 v_lshlrev_b32 v6, 16, v7
 v_and_b32 v7, s26, v7
 v_pk_mul_f32 v[6:7], v[6:7], v[244:245]
 v_cvt_pk_bf16_f32 v14, v6, v7
 v_accvgpr_read_b32 v7, a111
 v_lshlrev_b32 v6, 16, v7
 v_and_b32 v7, s26, v7
 v_pk_mul_f32 v[6:7], v[6:7], v[246:247]
 v_cvt_pk_bf16_f32 v15, v6, v7
 ds_write_b128 v18, v[12:15] offset:12288
 ds_read_b128 v[48:51], v3 offset:12288
 ds_read_b128 v[80:83], v3 offset:13312
 v_accvgpr_read_b32 v7, a80
 v_lshlrev_b32 v6, 16, v7
 v_and_b32 v7, s26, v7
 v_pk_mul_f32 v[6:7], v[6:7], v[152:153]
 v_cvt_pk_bf16_f32 v8, v6, v7
 v_accvgpr_read_b32 v7, a81
 v_lshlrev_b32 v6, 16, v7
 v_and_b32 v7, s26, v7
 v_pk_mul_f32 v[6:7], v[6:7], v[154:155]
 v_cvt_pk_bf16_f32 v9, v6, v7
 v_accvgpr_read_b32 v7, a82
 v_lshlrev_b32 v6, 16, v7
 s_waitcnt lgkmcnt(1)
 s_add_u32 s3, s28, 98304
 buffer_store_dwordx4 v[48:51], v16, s[16:19], s3 offen offset:128 nt
 s_waitcnt lgkmcnt(0)
 s_add_u32 s3, s28, 114688
 buffer_store_dwordx4 v[80:83], v16, s[16:19], s3 offen offset:128 nt
 v_and_b32 v7, s26, v7
 v_pk_mul_f32 v[6:7], v[6:7], v[184:185]
 v_cvt_pk_bf16_f32 v10, v6, v7
 v_accvgpr_read_b32 v7, a83
 v_lshlrev_b32 v6, 16, v7
 v_and_b32 v7, s26, v7
 v_pk_mul_f32 v[6:7], v[6:7], v[186:187]
 v_cvt_pk_bf16_f32 v11, v6, v7
 ds_write_b128 v17, v[8:11] offset:16384
 v_accvgpr_read_b32 v7, a112
 v_lshlrev_b32 v6, 16, v7
 v_and_b32 v7, s26, v7
 v_pk_mul_f32 v[6:7], v[6:7], v[216:217]
 v_cvt_pk_bf16_f32 v12, v6, v7
 v_accvgpr_read_b32 v7, a113
 v_lshlrev_b32 v6, 16, v7
 v_and_b32 v7, s26, v7
 v_pk_mul_f32 v[6:7], v[6:7], v[218:219]
 v_cvt_pk_bf16_f32 v13, v6, v7
 v_accvgpr_read_b32 v7, a114
 v_lshlrev_b32 v6, 16, v7
 v_and_b32 v7, s26, v7
 v_pk_mul_f32 v[6:7], v[6:7], v[248:249]
 v_cvt_pk_bf16_f32 v14, v6, v7
 v_accvgpr_read_b32 v7, a115
 v_lshlrev_b32 v6, 16, v7
 v_and_b32 v7, s26, v7
 v_pk_mul_f32 v[6:7], v[6:7], v[250:251]
 v_cvt_pk_bf16_f32 v15, v6, v7
 ds_write_b128 v18, v[12:15] offset:16384
 ds_read_b128 v[48:51], v3 offset:16384
 ds_read_b128 v[80:83], v3 offset:17408
 v_accvgpr_read_b32 v7, a84
 v_lshlrev_b32 v6, 16, v7
 v_and_b32 v7, s26, v7
 v_pk_mul_f32 v[6:7], v[6:7], v[156:157]
 v_cvt_pk_bf16_f32 v8, v6, v7
 v_accvgpr_read_b32 v7, a85
 v_lshlrev_b32 v6, 16, v7
 v_and_b32 v7, s26, v7
 v_pk_mul_f32 v[6:7], v[6:7], v[158:159]
 v_cvt_pk_bf16_f32 v9, v6, v7
 v_accvgpr_read_b32 v7, a86
 v_lshlrev_b32 v6, 16, v7
 s_waitcnt lgkmcnt(1)
 s_add_u32 s3, s28, 131072
 buffer_store_dwordx4 v[48:51], v16, s[16:19], s3 offen offset:128 nt
 s_waitcnt lgkmcnt(0)
 s_add_u32 s3, s28, 147456
 buffer_store_dwordx4 v[80:83], v16, s[16:19], s3 offen offset:128 nt
 v_and_b32 v7, s26, v7
 v_pk_mul_f32 v[6:7], v[6:7], v[188:189]
 v_cvt_pk_bf16_f32 v10, v6, v7
 v_accvgpr_read_b32 v7, a87
 v_lshlrev_b32 v6, 16, v7
 v_and_b32 v7, s26, v7
 v_pk_mul_f32 v[6:7], v[6:7], v[190:191]
 v_cvt_pk_bf16_f32 v11, v6, v7
 ds_write_b128 v17, v[8:11] offset:20480
 v_accvgpr_read_b32 v7, a116
 v_lshlrev_b32 v6, 16, v7
 v_and_b32 v7, s26, v7
 v_pk_mul_f32 v[6:7], v[6:7], v[220:221]
 v_cvt_pk_bf16_f32 v12, v6, v7
 v_accvgpr_read_b32 v7, a117
 v_lshlrev_b32 v6, 16, v7
 v_and_b32 v7, s26, v7
 v_pk_mul_f32 v[6:7], v[6:7], v[222:223]
 v_cvt_pk_bf16_f32 v13, v6, v7
 v_accvgpr_read_b32 v7, a118
 v_lshlrev_b32 v6, 16, v7
 v_and_b32 v7, s26, v7
 v_pk_mul_f32 v[6:7], v[6:7], v[252:253]
 v_cvt_pk_bf16_f32 v14, v6, v7
 v_accvgpr_read_b32 v7, a119
 v_lshlrev_b32 v6, 16, v7
 v_and_b32 v7, s26, v7
 v_pk_mul_f32 v[6:7], v[6:7], v[254:255]
 v_cvt_pk_bf16_f32 v15, v6, v7
 ds_write_b128 v18, v[12:15] offset:20480
 ds_read_b128 v[48:51], v3 offset:20480
 ds_read_b128 v[80:83], v3 offset:21504
 v_accvgpr_read_b32 v7, a88
 v_lshlrev_b32 v6, 16, v7
 v_and_b32 v7, s26, v7
 v_pk_mul_f32 v[6:7], v[6:7], v[160:161]
 v_cvt_pk_bf16_f32 v8, v6, v7
 v_accvgpr_read_b32 v7, a89
 v_lshlrev_b32 v6, 16, v7
 v_and_b32 v7, s26, v7
 v_pk_mul_f32 v[6:7], v[6:7], v[162:163]
 v_cvt_pk_bf16_f32 v9, v6, v7
 v_accvgpr_read_b32 v7, a90
 v_lshlrev_b32 v6, 16, v7
 s_waitcnt lgkmcnt(1)
 s_add_u32 s3, s28, 163840
 buffer_store_dwordx4 v[48:51], v16, s[16:19], s3 offen offset:128 nt
 s_waitcnt lgkmcnt(0)
 s_add_u32 s3, s28, 180224
 buffer_store_dwordx4 v[80:83], v16, s[16:19], s3 offen offset:128 nt
 v_and_b32 v7, s26, v7
 v_pk_mul_f32 v[6:7], v[6:7], v[192:193]
 v_cvt_pk_bf16_f32 v10, v6, v7
 v_accvgpr_read_b32 v7, a91
 v_lshlrev_b32 v6, 16, v7
 v_and_b32 v7, s26, v7
 v_pk_mul_f32 v[6:7], v[6:7], v[194:195]
 v_cvt_pk_bf16_f32 v11, v6, v7
 ds_write_b128 v17, v[8:11] offset:24576
 v_accvgpr_read_b32 v7, a120
 v_lshlrev_b32 v6, 16, v7
 v_and_b32 v7, s26, v7
 v_pk_mul_f32 v[6:7], v[6:7], v[224:225]
 v_cvt_pk_bf16_f32 v12, v6, v7
 v_accvgpr_read_b32 v7, a121
 v_lshlrev_b32 v6, 16, v7
 v_and_b32 v7, s26, v7
 v_pk_mul_f32 v[6:7], v[6:7], v[226:227]
 v_cvt_pk_bf16_f32 v13, v6, v7
 v_accvgpr_read_b32 v7, a122
 v_accvgpr_read_b32 v112, a248
 v_accvgpr_read_b32 v113, a249
 v_lshlrev_b32 v6, 16, v7
 v_and_b32 v7, s26, v7
 v_pk_mul_f32 v[6:7], v[6:7], v[112:113]
 v_cvt_pk_bf16_f32 v14, v6, v7
 v_accvgpr_read_b32 v7, a123
 v_accvgpr_read_b32 v112, a250
 v_accvgpr_read_b32 v113, a251
 v_lshlrev_b32 v6, 16, v7
 v_and_b32 v7, s26, v7
 v_pk_mul_f32 v[6:7], v[6:7], v[112:113]
 v_cvt_pk_bf16_f32 v15, v6, v7
 ds_write_b128 v18, v[12:15] offset:24576
 ds_read_b128 v[48:51], v3 offset:24576
 ds_read_b128 v[80:83], v3 offset:25600
 v_accvgpr_read_b32 v7, a92
 v_lshlrev_b32 v6, 16, v7
 v_and_b32 v7, s26, v7
 v_pk_mul_f32 v[6:7], v[6:7], v[164:165]
 v_cvt_pk_bf16_f32 v8, v6, v7
 v_accvgpr_read_b32 v7, a93
 v_lshlrev_b32 v6, 16, v7
 v_and_b32 v7, s26, v7
 v_pk_mul_f32 v[6:7], v[6:7], v[166:167]
 v_cvt_pk_bf16_f32 v9, v6, v7
 v_accvgpr_read_b32 v7, a94
 v_lshlrev_b32 v6, 16, v7
 s_waitcnt lgkmcnt(1)
 s_add_u32 s3, s28, 196608
 buffer_store_dwordx4 v[48:51], v16, s[16:19], s3 offen offset:128 nt
 s_waitcnt lgkmcnt(0)
 s_add_u32 s3, s28, 212992
 buffer_store_dwordx4 v[80:83], v16, s[16:19], s3 offen offset:128 nt
 v_and_b32 v7, s26, v7
 v_pk_mul_f32 v[6:7], v[6:7], v[196:197]
 v_cvt_pk_bf16_f32 v10, v6, v7
 v_accvgpr_read_b32 v7, a95
 v_lshlrev_b32 v6, 16, v7
 v_and_b32 v7, s26, v7
 v_pk_mul_f32 v[6:7], v[6:7], v[198:199]
 v_cvt_pk_bf16_f32 v11, v6, v7
 ds_write_b128 v17, v[8:11] offset:28672
 v_accvgpr_read_b32 v7, a124
 v_lshlrev_b32 v6, 16, v7
 v_and_b32 v7, s26, v7
 v_pk_mul_f32 v[6:7], v[6:7], v[228:229]
 v_cvt_pk_bf16_f32 v12, v6, v7
 v_accvgpr_read_b32 v7, a125
 v_lshlrev_b32 v6, 16, v7
 v_and_b32 v7, s26, v7
 v_pk_mul_f32 v[6:7], v[6:7], v[230:231]
 v_cvt_pk_bf16_f32 v13, v6, v7
 v_accvgpr_read_b32 v7, a126
 v_accvgpr_read_b32 v112, a252
 v_accvgpr_read_b32 v113, a253
 v_lshlrev_b32 v6, 16, v7
 v_and_b32 v7, s26, v7
 v_pk_mul_f32 v[6:7], v[6:7], v[112:113]
 v_cvt_pk_bf16_f32 v14, v6, v7
 v_accvgpr_read_b32 v7, a127
 v_accvgpr_read_b32 v112, a254
 v_accvgpr_read_b32 v113, a255
 v_lshlrev_b32 v6, 16, v7
 v_and_b32 v7, s26, v7
 v_pk_mul_f32 v[6:7], v[6:7], v[112:113]
 v_cvt_pk_bf16_f32 v15, v6, v7
 ds_write_b128 v18, v[12:15] offset:28672
 ds_read_b128 v[48:51], v3 offset:28672
 ds_read_b128 v[80:83], v3 offset:29696
 s_waitcnt lgkmcnt(1)
 s_add_u32 s3, s28, 229376
 buffer_store_dwordx4 v[48:51], v16, s[16:19], s3 offen offset:128 nt
 s_waitcnt lgkmcnt(0)
 s_add_u32 s3, s28, 245760
 buffer_store_dwordx4 v[80:83], v16, s[16:19], s3 offen offset:128 nt
Lend:
 s_endpgm
Lspin_pro:
 s_add_u32 s53, s53, 1
 v_lshlrev_b32 v4, 2, v3
 v_and_b32 v4, 192, v4
 buffer_load_dword v4, v4, s[44:47], 0 offen sc1
 s_cmp_ge_u32 s53, 0x100000
 s_cbranch_scc1 Lgiveup_pro
 s_waitcnt vmcnt(0)
 v_cmp_gt_i32 vcc, s27, v4
 s_and_b64 vcc, exec, vcc
 s_cbranch_vccnz Lspin_pro
Lgiveup_pro:
 s_waitcnt vmcnt(0)
 s_branch Lok_pro
Lspin_pa:
 s_add_u32 s53, s53, 1
 buffer_load_dword v4, off, s[64:67], 0 sc1
 s_cmp_ge_u32 s53, 0x100000
 s_cbranch_scc1 Lgiveup_pa
 s_waitcnt vmcnt(0)
 v_cmp_gt_i32 vcc, s55, v4
 s_and_b64 vcc, exec, vcc
 s_cbranch_vccnz Lspin_pa
Lgiveup_pa:
 s_waitcnt vmcnt(0)
 s_branch Lok_pa
Lgat0:
 v_lshrrev_b32 v5, 4, v3
 v_and_b32 v5, 0x20, v5
 v_xor_b32 v5, v5, v3
 v_and_b32 v5, 0x30, v5
 v_bfe_u32 v6, v3, 6, 4
 v_lshl_add_u32 v6, v6, 11, v5
 s_branch Lgatr0
Lxrg:
 v_lshrrev_b32 v5, 2, v3
 v_and_b32 v5, 0x20, v5
 v_lshrrev_b32 v2, 4, v3
 v_xor_b32 v5, v5, v2
 v_and_b32 v5, 0x30, v5
 v_bfe_u32 v1, v3, 4, 4
 v_lshl_add_u32 v1, v1, 6, v5
 v_add_u32 v2, 0x10000, v1
 s_branch Lxrgr
Lspin_pb:
 s_add_u32 s53, s53, 1
 buffer_load_dword v4, off, s[64:67], 0 sc1
 s_cmp_ge_u32 s53, 0x100000
 s_cbranch_scc1 Lgiveup_pb
 s_waitcnt vmcnt(0)
 v_cmp_gt_i32 vcc, s55, v4
 s_and_b64 vcc, exec, vcc
 s_cbranch_vccnz Lspin_pb
Lgiveup_pb:
 s_waitcnt vmcnt(0)
 s_branch Lok_pb
Lgat1:
 v_lshrrev_b32 v5, 4, v3
 v_and_b32 v5, 0x20, v5
 v_xor_b32 v5, v5, v3
 v_and_b32 v5, 0x30, v5
 v_bfe_u32 v6, v3, 6, 4
 v_lshl_add_u32 v6, v6, 11, v5
 s_branch Lgatr1
Lspin_w:
 s_add_u32 s53, s53, 1
 v_lshlrev_b32 v4, 2, v3
 v_and_b32 v4, 192, v4
 buffer_load_dword v4, v4, s[44:47], 0 offen sc1
 s_cmp_ge_u32 s53, 0x100000
 s_cbranch_scc1 Lgiveup_w
 s_waitcnt vmcnt(0)
 v_cmp_gt_i32 vcc, s27, v4
 s_and_b64 vcc, exec, vcc
 s_cbranch_vccnz Lspin_w
Lgiveup_w:
 s_waitcnt vmcnt(0)
 s_branch Lok_w
.section .rodata,"a"
.p2align 6
.amdhsa_kernel standalone__cross_network_dcn__recsys_kernel
  .amdhsa_next_free_vgpr 512
  .amdhsa_next_free_sgpr 102
  .amdhsa_accum_offset 256
  .amdhsa_group_segment_fixed_size 0
  .amdhsa_kernarg_size 48
  .amdhsa_user_sgpr_count 2
  .amdhsa_user_sgpr_kernarg_segment_ptr 1
  .amdhsa_system_sgpr_workgroup_id_x 1
  .amdhsa_float_denorm_mode_32 3
.end_amdhsa_kernel
```

```asm
; @launch grid=(256,1,1) block=(256,1,1) lds=151552
.amdgcn_target "amdgcn-amd-amdhsa--gfx950"
.text
.globl standalone__cross_network_dcn__recsys_kernel
.p2align 8
.type standalone__cross_network_dcn__recsys_kernel,@function
standalone__cross_network_dcn__recsys_kernel:
 s_cmp_ge_u32 s2, 256
 s_cbranch_scc1 Lend
 s_load_dwordx4 s[56:59], s[0:1], 0
 s_load_dwordx4 s[60:63], s[0:1], 16
 s_load_dwordx4 s[64:67], s[0:1], 32
 v_lshrrev_b32 v9, 6, v0
 v_and_b32 v10, 63, v0
 v_readfirstlane_b32 s54, v9
 v_lshlrev_b32 v1, 4, v10
 s_getpc_b64 s[4:5]
Lpc:
 v_lshlrev_b32 v11, 6, v0
 s_bfe_u32 s3, s2, 0x20003
 s_lshl_b32 s3, s3, 14
 v_add_u32 v11, s3, v11
 v_min_u32 v12, Lend-Lpc, v11
 global_load_dword v60, v12, s[4:5]
 v_add_u32 v11, 16384, v11
 v_lshrrev_b32 v11, 7, v0
 v_and_b32 v12, 127, v0
 v_lshlrev_b32 v12, 3, v12
 v_lshl_add_u32 v30, v11, 11, v12
 v_lshlrev_b32 v31, 4, v0
 v_add_u32 v31, 131072, v31
 v_add_u32 v2, 65536, v1
 v_lshl_add_u32 v3, v9, 15, v1
 v_lshl_add_u32 v0, v9, 18, v1
 s_and_b32 s7, s2, 1
 s_lshr_b32 s28, s2, 1
 s_lshl_b32 s28, s28, 18
 s_lshl_b32 s6, s7, 10
 s_add_u32 s28, s28, s6
 s_lshl_b32 s6, s54, 8
 s_add_u32 s28, s28, s6
 s_mov_b32 s26, 0xffff0000
 s_lshl_b32 s24, s7, 20
 s_mov_b32 s25, 0
 s_mov_b32 s53, 0
 s_mov_b32 s31, -1
 s_mov_b32 s27, 64
 s_mov_b32 s55, -1
 s_lshl_b32 s50, s54, 15
 s_lshl_b32 s29, s2, 17
 s_add_u32 s29, s29, 33554432
 s_xor_b32 s30, s29, 131072
 s_lshr_b32 s4, s2, 3
 s_and_b32 s5, s2, 7
 s_lshl_b32 s48, s4, 16
 s_lshl_b32 s6, s5, 8
 s_add_u32 s48, s48, s6
 s_lshl_b32 s6, s54, 6
 s_add_u32 s48, s48, s6
 s_lshl_b32 s49, s5, 18
 s_and_b32 s6, s4, 1
 s_lshl_b32 s6, s6, 10
 s_add_u32 s49, s49, s6
 s_lshr_b32 s6, s4, 4
 s_lshr_b32 s5, s5, 2
 s_xor_b32 s5, s5, s6
 s_bfe_u32 s6, s4, 0x10001
 s_lshl_b32 s3, s5, 1
 s_add_u32 s3, s3, s6
 s_lshl_b32 s3, s3, 16
 s_add_u32 s49, s49, s3
 s_bfe_u32 s4, s4, 0x20002
 s_xor_b32 s5, s5, s6
 s_lshr_b32 s3, s54, 1
 s_lshl_b32 s3, s3, 4
 s_lshr_b32 s6, s54, 1
 s_mul_i32 s6, s6, 3
 s_xor_b32 s6, s6, s4
 s_lshl_b32 s6, s6, 2
 s_add_u32 s3, s3, s6
 s_and_b32 s6, s54, 1
 s_lshl_b32 s6, s6, 1
 s_add_u32 s3, s3, s6
 s_lshl_b32 s4, s4, 3
 s_lshl_b32 s6, s54, 1
 s_add_u32 s4, s4, s6
 s_cmp_eq_u32 s5, 0
 s_cselect_b32 s3, s3, s4
 s_lshl_b32 s3, s3, 11
 s_add_u32 s49, s49, s3
 s_lshl_b32 s52, s54, 11
 s_add_u32 s52, s52, 143360
 s_lshl_b32 s51, s54, 9
 s_add_u32 s51, s51, 131072
 s_waitcnt lgkmcnt(0)
 s_mov_b32 s40, s58
 s_mov_b32 s41, s59
 s_mov_b32 s42, 0xc00000
 s_mov_b32 s43, 0x20000
 v_lshrrev_b32 v5, 6, v1
 v_and_b32 v6, 48, v1
 v_lshl_add_u32 v5, v5, 11, v6
 s_mov_b32 m0, s52
 s_add_u32 s3, s48, 31744
 buffer_load_dwordx4 v5, s[40:43], s48 offen lds
 buffer_load_dwordx4 v5, s[40:43], s3 offen offset:1024 lds
 s_add_u32 s48, s48, 2097152
 s_mov_b32 s20, s60
 s_mov_b32 s21, s61
 s_mov_b32 s22, 0x3000
 s_mov_b32 s23, 0x20000
 s_lshl_b32 s3, s7, 10
 buffer_load_dwordx2 v[32:33], v30, s[20:23], s3 offen
 s_add_u32 s3, s3, 4096
 buffer_load_dwordx2 v[34:35], v30, s[20:23], s3 offen
 s_add_u32 s3, s3, 4096
 buffer_load_dwordx2 v[36:37], v30, s[20:23], s3 offen
 s_add_u32 s3, s3, 4096
 s_mov_b32 s8, s56
 s_mov_b32 s9, s57
 s_mov_b32 s10, 0x2000000
 s_mov_b32 s11, 0x20000
 s_mov_b32 s16, s62
 s_mov_b32 s17, s63
 s_mov_b32 s18, 0x2000000
 s_mov_b32 s19, 0x20000
 s_mov_b32 s12, s66
 s_mov_b32 s13, s67
 s_mov_b32 s14, 0xc00000
 s_mov_b32 s15, 0x20000
 s_mov_b32 s32, s66
 s_mov_b32 s33, s67
 s_mov_b32 s34, 0x0
 s_mov_b32 s35, 0x20000
 s_mov_b32 s44, s64
 s_mov_b32 s45, s65
 s_mov_b32 s46, 0x100
 s_mov_b32 s47, 0x20000
 s_add_u32 s24, s24, 4096
 s_add_u32 s70, s66, s24
 s_addc_u32 s71, s67, 0
 s_sub_u32 s24, s24, 4096
 s_and_b32 s3, s2, 3
 s_lshl_b32 s3, s3, 6
 s_add_u32 s56, s44, s3
 s_addc_u32 s57, s45, 0
 s_mov_b32 s58, 0x4
 s_mov_b32 s59, 0x20000
 s_lshl_b32 s3, s2, 2
 s_add_u32 s3, s3, s54
 s_lshl_b32 s3, s3, 7
 s_add_u32 s3, s3, 15728640
 s_add_u32 s60, s32, s3
 s_addc_u32 s61, s33, 0
 s_mov_b32 s62, 0x4
 s_mov_b32 s63, 0x20000
 s_xor_b32 s3, s3, 512
 s_add_u32 s64, s32, s3
 s_addc_u32 s65, s33, 0
 s_mov_b32 s66, 0x4
 s_mov_b32 s67, 0x20000
 v_lshrrev_b32 v5, 2, v1
 v_and_b32 v5, 64, v5
 v_xor_b32 v5, v5, v1
 v_and_b32 v5, 112, v5
 v_lshrrev_b32 v6, 7, v1
 v_lshl_add_u32 v23, v6, 11, v5
 s_and_b32 s69, s28, 2047
 s_lshl_b32 s3, s7, 20
 s_add_u32 s69, s69, s3
 s_add_u32 m0, s50, 0
 s_add_u32 s3, s69, 0
 buffer_load_dwordx4 v23, s[40:43], s3 offen lds
 s_add_u32 m0, s50, 1024
 s_add_u32 s3, s69, 16384
 buffer_load_dwordx4 v23, s[40:43], s3 offen lds
 s_add_u32 m0, s50, 4096
 s_add_u32 s3, s69, 32768
 buffer_load_dwordx4 v23, s[40:43], s3 offen lds
 s_add_u32 m0, s50, 5120
 s_add_u32 s3, s69, 49152
 buffer_load_dwordx4 v23, s[40:43], s3 offen lds
 s_add_u32 m0, s50, 8192
 s_add_u32 s3, s69, 65536
 buffer_load_dwordx4 v23, s[40:43], s3 offen lds
 s_add_u32 m0, s50, 9216
 s_add_u32 s3, s69, 81920
 buffer_load_dwordx4 v23, s[40:43], s3 offen lds
 s_add_u32 m0, s50, 12288
 s_add_u32 s3, s69, 98304
 buffer_load_dwordx4 v23, s[40:43], s3 offen lds
 s_add_u32 m0, s50, 13312
 s_add_u32 s3, s69, 114688
 buffer_load_dwordx4 v23, s[40:43], s3 offen lds
 s_add_u32 m0, s50, 16384
 s_add_u32 s3, s69, 262144
 buffer_load_dwordx4 v23, s[40:43], s3 offen lds
 s_add_u32 m0, s50, 17408
 s_add_u32 s3, s69, 278528
 buffer_load_dwordx4 v23, s[40:43], s3 offen lds
 s_add_u32 m0, s50, 20480
 s_add_u32 s3, s69, 294912
 buffer_load_dwordx4 v23, s[40:43], s3 offen lds
 s_add_u32 m0, s50, 21504
 s_add_u32 s3, s69, 311296
 buffer_load_dwordx4 v23, s[40:43], s3 offen lds
 s_add_u32 m0, s50, 24576
 s_add_u32 s3, s69, 327680
 buffer_load_dwordx4 v23, s[40:43], s3 offen lds
 s_add_u32 m0, s50, 25600
 s_add_u32 s3, s69, 344064
 buffer_load_dwordx4 v23, s[40:43], s3 offen lds
 s_add_u32 m0, s50, 28672
 s_add_u32 s3, s69, 360448
 buffer_load_dwordx4 v23, s[40:43], s3 offen lds
 s_add_u32 m0, s50, 29696
 s_add_u32 s3, s69, 376832
 buffer_load_dwordx4 v23, s[40:43], s3 offen lds
 v_mov_b32 v7, 0
 buffer_store_dword v7, v1, s[60:63], 0 offen sc1
 v_lshrrev_b32 v5, 7, v1
 v_lshlrev_b32 v6, 4, v5
 v_xor_b32 v6, v6, v1
 v_and_b32 v6, 112, v6
 v_lshl_add_u32 v20, v5, 11, v6
 v_lshrrev_b32 v5, 4, v1
 v_and_b32 v5, 48, v5
 v_xor_b32 v5, v5, v1
 v_and_b32 v5, 112, v5
 v_and_b32 v6, 240, v1
 v_lshl_add_u32 v5, v6, 3, v5
 v_add_u32 v21, s50, v5
 v_xor_b32 v22, 64, v21
 v_lshrrev_b32 v5, 1, v1
 v_and_b32 v5, 64, v5
 v_and_b32 v6, 48, v1
 v_or_b32 v5, v5, v6
 v_and_b32 v6, 192, v1
 v_lshl_add_u32 v5, v6, 1, v5
 v_and_b32 v6, 256, v1
 v_lshl_add_u32 v5, v6, 2, v5
 v_and_b32 v6, 512, v1
 v_lshl_add_u32 v5, v6, 3, v5
 v_add_u32 v24, s50, v5
 v_xor_b32 v25, 64, v24
 v_mov_b32 v64, 1.0
 v_mov_b32 v65, 1.0
 v_mov_b32 v66, 1.0
 v_mov_b32 v67, 1.0
 v_mov_b32 v68, 1.0
 v_mov_b32 v69, 1.0
 v_mov_b32 v70, 1.0
 v_mov_b32 v71, 1.0
 v_mov_b32 v72, 1.0
 v_mov_b32 v73, 1.0
 v_mov_b32 v74, 1.0
 v_mov_b32 v75, 1.0
 v_mov_b32 v76, 1.0
 v_mov_b32 v77, 1.0
 v_mov_b32 v78, 1.0
 v_mov_b32 v79, 1.0
 v_mov_b32 v80, 1.0
 v_mov_b32 v81, 1.0
 v_mov_b32 v82, 1.0
 v_mov_b32 v83, 1.0
 v_mov_b32 v84, 1.0
 v_mov_b32 v85, 1.0
 v_mov_b32 v86, 1.0
 v_mov_b32 v87, 1.0
 v_mov_b32 v88, 1.0
 v_mov_b32 v89, 1.0
 v_mov_b32 v90, 1.0
 v_mov_b32 v91, 1.0
 v_mov_b32 v92, 1.0
 v_mov_b32 v93, 1.0
 v_mov_b32 v94, 1.0
 v_mov_b32 v95, 1.0
 v_mov_b32 v96, 1.0
 v_mov_b32 v97, 1.0
 v_mov_b32 v98, 1.0
 v_mov_b32 v99, 1.0
 v_mov_b32 v100, 1.0
 v_mov_b32 v101, 1.0
 v_mov_b32 v102, 1.0
 v_mov_b32 v103, 1.0
 v_mov_b32 v104, 1.0
 v_mov_b32 v105, 1.0
 v_mov_b32 v106, 1.0
 v_mov_b32 v107, 1.0
 v_mov_b32 v108, 1.0
 v_mov_b32 v109, 1.0
 v_mov_b32 v110, 1.0
 v_mov_b32 v111, 1.0
 v_mov_b32 v112, 1.0
 v_mov_b32 v113, 1.0
 v_mov_b32 v114, 1.0
 v_mov_b32 v115, 1.0
 v_mov_b32 v116, 1.0
 v_mov_b32 v117, 1.0
 v_mov_b32 v118, 1.0
 v_mov_b32 v119, 1.0
 v_mov_b32 v120, 1.0
 v_mov_b32 v121, 1.0
 v_mov_b32 v122, 1.0
 v_mov_b32 v123, 1.0
 v_mov_b32 v124, 1.0
 v_mov_b32 v125, 1.0
 v_mov_b32 v126, 1.0
 v_mov_b32 v127, 1.0
 v_mov_b32 v128, 1.0
 v_mov_b32 v129, 1.0
 v_mov_b32 v130, 1.0
 v_mov_b32 v131, 1.0
 v_mov_b32 v132, 1.0
 v_mov_b32 v133, 1.0
 v_mov_b32 v134, 1.0
 v_mov_b32 v135, 1.0
 v_accvgpr_write_b32 a240, 1.0
 v_accvgpr_write_b32 a241, 1.0
 v_accvgpr_write_b32 a242, 1.0
 v_accvgpr_write_b32 a243, 1.0
 v_accvgpr_write_b32 a244, 1.0
 v_accvgpr_write_b32 a245, 1.0
 v_accvgpr_write_b32 a246, 1.0
 v_accvgpr_write_b32 a247, 1.0
 v_mov_b32 v216, 1.0
 v_mov_b32 v217, 1.0
 v_mov_b32 v218, 1.0
 v_mov_b32 v219, 1.0
 v_mov_b32 v220, 1.0
 v_mov_b32 v221, 1.0
 v_mov_b32 v222, 1.0
 v_mov_b32 v223, 1.0
 v_mov_b32 v224, 1.0
 v_mov_b32 v225, 1.0
 v_mov_b32 v226, 1.0
 v_mov_b32 v227, 1.0
 v_mov_b32 v228, 1.0
 v_mov_b32 v229, 1.0
 v_mov_b32 v230, 1.0
 v_mov_b32 v231, 1.0
 v_mov_b32 v232, 1.0
 v_mov_b32 v233, 1.0
 v_mov_b32 v234, 1.0
 v_mov_b32 v235, 1.0
 v_mov_b32 v236, 1.0
 v_mov_b32 v237, 1.0
 v_mov_b32 v238, 1.0
 v_mov_b32 v239, 1.0
 v_mov_b32 v240, 1.0
 v_mov_b32 v241, 1.0
 v_mov_b32 v242, 1.0
 v_mov_b32 v243, 1.0
 v_mov_b32 v244, 1.0
 v_mov_b32 v245, 1.0
 v_mov_b32 v246, 1.0
 v_mov_b32 v247, 1.0
 v_mov_b32 v248, 1.0
 v_mov_b32 v249, 1.0
 v_mov_b32 v250, 1.0
 v_mov_b32 v251, 1.0
 v_mov_b32 v252, 1.0
 v_mov_b32 v253, 1.0
 v_mov_b32 v254, 1.0
 v_mov_b32 v255, 1.0
 v_accvgpr_write_b32 a248, 1.0
 v_accvgpr_write_b32 a249, 1.0
 v_accvgpr_write_b32 a250, 1.0
 v_accvgpr_write_b32 a251, 1.0
 v_accvgpr_write_b32 a252, 1.0
 v_accvgpr_write_b32 a253, 1.0
 v_accvgpr_write_b32 a254, 1.0
 v_accvgpr_write_b32 a255, 1.0
 v_and_b32 v5, 768, v3
 v_and_b32 v7, 1023, v3
 v_add3_u32 v5, v5, v7, s52
 s_waitcnt vmcnt(20)
 ds_read_b64_tr_b16 v[8:9], v5 offset:0
 ds_read_b64_tr_b16 v[10:11], v5 offset:256
 ds_read_b64_tr_b16 v[12:13], v5 offset:8
 ds_read_b64_tr_b16 v[14:15], v5 offset:264
 s_waitcnt lgkmcnt(2)
 buffer_store_dwordx4 v[8:11], v7, s[12:15], s49 offen sc1
 s_waitcnt lgkmcnt(0)
 buffer_store_dwordx4 v[12:15], v7, s[12:15], s49 offen offset:2048 sc1
 s_add_u32 s49, s49, 2097152
 s_add_u32 m0, s50, 2048
 s_add_u32 s3, s69, 524288
 buffer_load_dwordx4 v23, s[40:43], s3 offen lds
 s_add_u32 m0, s50, 3072
 s_add_u32 s3, s69, 540672
 buffer_load_dwordx4 v23, s[40:43], s3 offen lds
 s_add_u32 m0, s50, 6144
 s_add_u32 s3, s69, 557056
 buffer_load_dwordx4 v23, s[40:43], s3 offen lds
 s_add_u32 m0, s50, 7168
 s_add_u32 s3, s69, 573440
 buffer_load_dwordx4 v23, s[40:43], s3 offen lds
 s_add_u32 m0, s50, 10240
 s_add_u32 s3, s69, 589824
 buffer_load_dwordx4 v23, s[40:43], s3 offen lds
 s_add_u32 m0, s50, 11264
 s_add_u32 s3, s69, 606208
 buffer_load_dwordx4 v23, s[40:43], s3 offen lds
 s_add_u32 m0, s50, 14336
 s_add_u32 s3, s69, 622592
 buffer_load_dwordx4 v23, s[40:43], s3 offen lds
 s_add_u32 m0, s50, 15360
 s_add_u32 s3, s69, 638976
 buffer_load_dwordx4 v23, s[40:43], s3 offen lds
 s_waitcnt vmcnt(29)
 v_lshlrev_b32 v40, 16, v32
 v_and_b32 v41, s26, v32
 v_lshlrev_b32 v42, 16, v33
 v_and_b32 v43, s26, v33
 ds_write_b128 v31, v[40:43]
 s_waitcnt vmcnt(28)
 v_lshlrev_b32 v44, 16, v34
 v_and_b32 v45, s26, v34
 v_lshlrev_b32 v46, 16, v35
 v_and_b32 v47, s26, v35
 ds_write_b128 v31, v[44:47] offset:4096
 s_waitcnt vmcnt(27)
 v_lshlrev_b32 v48, 16, v36
 v_and_b32 v49, s26, v36
 v_lshlrev_b32 v50, 16, v37
 v_and_b32 v51, s26, v37
 ds_write_b128 v31, v[48:51] offset:8192
 s_waitcnt lgkmcnt(0)
 v_mov_b32 v32, 1.0
 v_mov_b32 v33, 1.0
 v_mov_b32 v34, 1.0
 v_mov_b32 v35, 1.0
 v_mov_b32 v36, 1.0
 v_mov_b32 v37, 1.0
 v_mov_b32 v38, 1.0
 v_mov_b32 v39, 1.0
 v_mov_b32 v40, 1.0
 v_mov_b32 v41, 1.0
 v_mov_b32 v42, 1.0
 v_mov_b32 v43, 1.0
 v_mov_b32 v44, 1.0
 v_mov_b32 v45, 1.0
 v_mov_b32 v46, 1.0
 v_mov_b32 v47, 1.0
 v_mov_b32 v48, 1.0
 v_mov_b32 v49, 1.0
 v_mov_b32 v50, 1.0
 v_mov_b32 v51, 1.0
 v_mov_b32 v52, 1.0
 v_mov_b32 v53, 1.0
 v_mov_b32 v54, 1.0
 v_mov_b32 v55, 1.0
 v_mov_b32 v56, 1.0
 v_mov_b32 v57, 1.0
 v_mov_b32 v58, 1.0
 v_mov_b32 v59, 1.0
 v_mov_b32 v60, 1.0
 v_mov_b32 v61, 1.0
 v_mov_b32 v62, 1.0
 v_mov_b32 v63, 1.0
 s_waitcnt vmcnt(23)
 ds_read_b64_tr_b16 v[136:137], v24 offset:0
 ds_read_b64_tr_b16 v[138:139], v24 offset:512
 ds_read_b64_tr_b16 v[144:145], v24 offset:8
 ds_read_b64_tr_b16 v[146:147], v24 offset:520
 ds_read_b64_tr_b16 v[152:153], v25 offset:0
 ds_read_b64_tr_b16 v[154:155], v25 offset:512
 ds_read_b64_tr_b16 v[160:161], v25 offset:8
 ds_read_b64_tr_b16 v[162:163], v25 offset:520
 s_waitcnt vmcnt(19)
 ds_read_b64_tr_b16 v[140:141], v24 offset:8192
 ds_read_b64_tr_b16 v[142:143], v24 offset:8704
 ds_read_b64_tr_b16 v[148:149], v24 offset:8200
 ds_read_b64_tr_b16 v[150:151], v24 offset:8712
 ds_read_b64_tr_b16 v[156:157], v25 offset:8192
 ds_read_b64_tr_b16 v[158:159], v25 offset:8704
 ds_read_b64_tr_b16 v[164:165], v25 offset:8200
 ds_read_b64_tr_b16 v[166:167], v25 offset:8712
 s_waitcnt lgkmcnt(8)
 s_add_u32 m0, s50, 0
 s_add_u32 s3, s28, 0
 buffer_load_dwordx4 v20, s[8:11], s3 offen lds
 s_add_u32 m0, s50, 1024
 s_add_u32 s3, s28, 16384
 buffer_load_dwordx4 v20, s[8:11], s3 offen lds
 s_add_u32 m0, s50, 4096
 s_add_u32 s3, s28, 32768
 buffer_load_dwordx4 v20, s[8:11], s3 offen lds
 s_add_u32 m0, s50, 5120
 s_add_u32 s3, s28, 49152
 buffer_load_dwordx4 v20, s[8:11], s3 offen lds
 s_waitcnt vmcnt(19)
 ds_read_b64_tr_b16 v[168:169], v24 offset:16384
 ds_read_b64_tr_b16 v[170:171], v24 offset:16896
 ds_read_b64_tr_b16 v[176:177], v24 offset:16392
 ds_read_b64_tr_b16 v[178:179], v24 offset:16904
 ds_read_b64_tr_b16 v[184:185], v25 offset:16384
 ds_read_b64_tr_b16 v[186:187], v25 offset:16896
 ds_read_b64_tr_b16 v[192:193], v25 offset:16392
 ds_read_b64_tr_b16 v[194:195], v25 offset:16904
 s_waitcnt lgkmcnt(8)
 s_add_u32 m0, s50, 8192
 s_add_u32 s3, s28, 65536
 buffer_load_dwordx4 v20, s[8:11], s3 offen lds
 s_add_u32 m0, s50, 9216
 s_add_u32 s3, s28, 81920
 buffer_load_dwordx4 v20, s[8:11], s3 offen lds
 s_add_u32 m0, s50, 12288
 s_add_u32 s3, s28, 98304
 buffer_load_dwordx4 v20, s[8:11], s3 offen lds
 s_add_u32 m0, s50, 13312
 s_add_u32 s3, s28, 114688
 buffer_load_dwordx4 v20, s[8:11], s3 offen lds
 s_waitcnt vmcnt(19)
 ds_read_b64_tr_b16 v[172:173], v24 offset:24576
 ds_read_b64_tr_b16 v[174:175], v24 offset:25088
 ds_read_b64_tr_b16 v[180:181], v24 offset:24584
 ds_read_b64_tr_b16 v[182:183], v24 offset:25096
 ds_read_b64_tr_b16 v[188:189], v25 offset:24576
 ds_read_b64_tr_b16 v[190:191], v25 offset:25088
 ds_read_b64_tr_b16 v[196:197], v25 offset:24584
 ds_read_b64_tr_b16 v[198:199], v25 offset:25096
 s_waitcnt vmcnt(16)
 s_barrier
 v_mov_b32 v7, 1
 buffer_atomic_add v7, v0, s[56:59], 0 offen sc1
 s_add_u32 m0, s50, 18432
 s_add_u32 s3, s69, 786432
 buffer_load_dwordx4 v23, s[40:43], s3 offen lds
 s_add_u32 m0, s50, 19456
 s_add_u32 s3, s69, 802816
 buffer_load_dwordx4 v23, s[40:43], s3 offen lds
 s_add_u32 m0, s50, 22528
 s_add_u32 s3, s69, 819200
 buffer_load_dwordx4 v23, s[40:43], s3 offen lds
 s_add_u32 m0, s50, 23552
 s_add_u32 s3, s69, 835584
 buffer_load_dwordx4 v23, s[40:43], s3 offen lds
 s_add_u32 m0, s50, 26624
 s_add_u32 s3, s69, 851968
 buffer_load_dwordx4 v23, s[40:43], s3 offen lds
 s_add_u32 m0, s50, 27648
 s_add_u32 s3, s69, 868352
 buffer_load_dwordx4 v23, s[40:43], s3 offen lds
 s_add_u32 m0, s50, 30720
 s_add_u32 s3, s69, 884736
 buffer_load_dwordx4 v23, s[40:43], s3 offen lds
 s_add_u32 m0, s50, 31744
 s_add_u32 s3, s69, 901120
 buffer_load_dwordx4 v23, s[40:43], s3 offen lds
 s_waitcnt lgkmcnt(0)
 s_add_u32 m0, s50, 16384
 s_add_u32 s3, s28, 131072
 buffer_load_dwordx4 v20, s[8:11], s3 offen lds
 s_add_u32 m0, s50, 17408
 s_add_u32 s3, s28, 147456
 buffer_load_dwordx4 v20, s[8:11], s3 offen lds
 s_add_u32 m0, s50, 20480
 s_add_u32 s3, s28, 163840
 buffer_load_dwordx4 v20, s[8:11], s3 offen lds
 s_add_u32 m0, s50, 21504
 s_add_u32 s3, s28, 180224
 buffer_load_dwordx4 v20, s[8:11], s3 offen lds
 s_add_u32 m0, s50, 24576
 s_add_u32 s3, s28, 196608
 buffer_load_dwordx4 v20, s[8:11], s3 offen lds
 s_add_u32 m0, s50, 25600
 s_add_u32 s3, s28, 212992
 buffer_load_dwordx4 v20, s[8:11], s3 offen lds
 s_add_u32 m0, s50, 28672
 s_add_u32 s3, s28, 229376
 buffer_load_dwordx4 v20, s[8:11], s3 offen lds
 s_add_u32 m0, s50, 29696
 s_add_u32 s3, s28, 245760
 buffer_load_dwordx4 v20, s[8:11], s3 offen lds
 s_waitcnt vmcnt(29)
 ds_read_b64_tr_b16 v[200:201], v24 offset:2048
 ds_read_b64_tr_b16 v[202:203], v24 offset:2560
 ds_read_b64_tr_b16 v[208:209], v24 offset:2056
 ds_read_b64_tr_b16 v[210:211], v24 offset:2568
 ds_read_b64_tr_b16 a[224:225], v25 offset:2048
 ds_read_b64_tr_b16 a[226:227], v25 offset:2560
 ds_read_b64_tr_b16 a[232:233], v25 offset:2056
 ds_read_b64_tr_b16 a[234:235], v25 offset:2568
 s_waitcnt vmcnt(25)
 ds_read_b64_tr_b16 v[204:205], v24 offset:10240
 ds_read_b64_tr_b16 v[206:207], v24 offset:10752
 ds_read_b64_tr_b16 v[212:213], v24 offset:10248
 ds_read_b64_tr_b16 v[214:215], v24 offset:10760
 ds_read_b64_tr_b16 a[228:229], v25 offset:10240
 ds_read_b64_tr_b16 a[230:231], v25 offset:10752
 ds_read_b64_tr_b16 a[236:237], v25 offset:10248
 ds_read_b64_tr_b16 a[238:239], v25 offset:10760
 s_waitcnt vmcnt(12)
 ds_read_b64_tr_b16 a[192:193], v24 offset:18432
 ds_read_b64_tr_b16 a[194:195], v24 offset:18944
 ds_read_b64_tr_b16 a[200:201], v24 offset:18440
 ds_read_b64_tr_b16 a[202:203], v24 offset:18952
 ds_read_b64_tr_b16 a[208:209], v25 offset:18432
 ds_read_b64_tr_b16 a[210:211], v25 offset:18944
 ds_read_b64_tr_b16 a[216:217], v25 offset:18440
 ds_read_b64_tr_b16 a[218:219], v25 offset:18952
 s_waitcnt vmcnt(8)
 ds_read_b64_tr_b16 a[196:197], v24 offset:26624
 ds_read_b64_tr_b16 a[198:199], v24 offset:27136
 ds_read_b64_tr_b16 a[204:205], v24 offset:26632
 ds_read_b64_tr_b16 a[206:207], v24 offset:27144
 ds_read_b64_tr_b16 a[212:213], v25 offset:26624
 ds_read_b64_tr_b16 a[214:215], v25 offset:27136
 ds_read_b64_tr_b16 a[220:221], v25 offset:26632
 ds_read_b64_tr_b16 a[222:223], v25 offset:27144
 ds_read_b128 a[0:3], v21
 ds_read_b128 a[32:35], v22
 ds_read_b128 a[4:7], v21 offset:4096
 ds_read_b128 a[36:39], v22 offset:4096
 s_waitcnt lgkmcnt(2)
 ds_write_b128 v3, a[0:3]
 ds_write_b128 v3, a[32:35] offset:1024
 ds_read_b128 a[8:11], v21 offset:8192
 ds_read_b128 a[40:43], v22 offset:8192
 s_waitcnt lgkmcnt(4)
 ds_write_b128 v3, a[4:7] offset:4096
 ds_write_b128 v3, a[36:39] offset:5120
 ds_read_b128 a[12:15], v21 offset:12288
 ds_read_b128 a[44:47], v22 offset:12288
 s_waitcnt lgkmcnt(4)
 ds_write_b128 v3, a[8:11] offset:8192
 ds_write_b128 v3, a[40:43] offset:9216
 s_waitcnt vmcnt(6)
 ds_read_b128 a[16:19], v21 offset:16384
 ds_read_b128 a[48:51], v22 offset:16384
 s_waitcnt lgkmcnt(4)
 ds_write_b128 v3, a[12:15] offset:12288
 ds_write_b128 v3, a[44:47] offset:13312
 s_waitcnt vmcnt(4)
 ds_read_b128 a[20:23], v21 offset:20480
 ds_read_b128 a[52:55], v22 offset:20480
 s_waitcnt lgkmcnt(4)
 ds_write_b128 v3, a[16:19] offset:16384
 ds_write_b128 v3, a[48:51] offset:17408
 s_waitcnt vmcnt(2)
 ds_read_b128 a[24:27], v21 offset:24576
 ds_read_b128 a[56:59], v22 offset:24576
 s_waitcnt lgkmcnt(4)
 ds_write_b128 v3, a[20:23] offset:20480
 ds_write_b128 v3, a[52:55] offset:21504
 s_waitcnt lgkmcnt(0)
 v_lshlrev_b32 v4, 2, v3
 v_and_b32 v4, 192, v4
 buffer_load_dword v4, v4, s[44:47], 0 offen sc1
 s_add_u32 m0, s50, 2048
 s_add_u32 s3, s28, 128
 buffer_load_dwordx4 v20, s[8:11], s3 offen lds
 s_add_u32 m0, s50, 3072
 s_add_u32 s3, s28, 16512
 buffer_load_dwordx4 v20, s[8:11], s3 offen lds
 s_waitcnt vmcnt(3)
 ds_read_b128 a[28:31], v21 offset:28672
 ds_read_b128 a[60:63], v22 offset:28672
 ds_write_b128 v3, a[24:27] offset:24576
 ds_write_b128 v3, a[56:59] offset:25600
 s_waitcnt lgkmcnt(2)
 ds_write_b128 v3, a[28:31] offset:28672
 ds_write_b128 v3, a[60:63] offset:29696
 s_add_u32 m0, s50, 6144
 s_add_u32 s3, s28, 32896
 buffer_load_dwordx4 v20, s[8:11], s3 offen lds
 s_add_u32 m0, s50, 7168
 s_add_u32 s3, s28, 49280
 buffer_load_dwordx4 v20, s[8:11], s3 offen lds
 s_add_u32 m0, s50, 10240
 s_add_u32 s3, s28, 65664
 buffer_load_dwordx4 v20, s[8:11], s3 offen lds
 s_add_u32 m0, s50, 11264
 s_add_u32 s3, s28, 82048
 buffer_load_dwordx4 v20, s[8:11], s3 offen lds
 v_mov_b32 v8, v20
 v_mov_b32 v16, 1.0
 v_mov_b32 v17, 1.0
 v_mov_b32 v18, 1.0
 v_mov_b32 v19, 1.0
 v_mov_b32 v20, 1.0
 v_mov_b32 v21, 1.0
 v_mov_b32 v22, 1.0
 v_mov_b32 v23, 1.0
 v_mov_b32 v24, 1.0
 v_mov_b32 v25, 1.0
 v_mov_b32 v26, 1.0
 v_mov_b32 v27, 1.0
 v_mov_b32 v28, 1.0
 v_mov_b32 v29, 1.0
 v_mov_b32 v30, 1.0
 v_mov_b32 v31, 1.0
 s_add_u32 s70, s70, 32768
 s_addc_u32 s71, s71, 0
 s_xor_b32 s30, s28, 1024
 s_mov_b32 s20, 64
 s_mov_b32 s21, 32704
 s_mov_b32 s22, 0xfffc8040
 s_waitcnt lgkmcnt(0)
 s_barrier
 ds_read_b128 a[128:131], v1
 ds_read_b128 a[132:135], v1 offset:1024
 ds_read_b128 a[140:143], v1 offset:5120
 ds_read_b128 a[136:139], v1 offset:4096
 ds_read_b128 a[144:147], v1 offset:8192
 ds_read_b128 a[148:151], v1 offset:9216
 ds_read_b128 a[156:159], v1 offset:13312
 ds_read_b128 a[152:155], v1 offset:12288
 ds_read_b128 a[160:163], v1 offset:16384
 ds_read_b128 a[164:167], v1 offset:17408
 ds_read_b128 a[172:175], v1 offset:21504
 ds_read_b128 a[168:171], v1 offset:20480
 ds_read_b128 a[176:179], v1 offset:24576
 ds_read_b128 a[180:183], v1 offset:25600
 ds_read_b128 a[188:191], v1 offset:29696
 ds_read_b128 a[184:187], v1 offset:28672
 s_waitcnt lgkmcnt(8)
 v_mfma_f32_16x16x32_bf16 v[16:19], v[136:139], a[128:131], v[16:19]
 s_add_u32 m0, s50, 14336
 v_mfma_f32_16x16x32_bf16 v[16:19], v[140:143], a[132:135], v[16:19]
 v_mfma_f32_16x16x32_bf16 v[20:23], v[140:143], a[140:143], v[20:23]
 s_add_u32 s3, s28, 98432
 v_mfma_f32_16x16x32_bf16 v[20:23], v[136:139], a[136:139], v[20:23]
 buffer_load_dwordx4 v8, s[8:11], s3 offen lds
 v_mfma_f32_16x16x32_bf16 v[24:27], v[136:139], a[144:147], v[24:27]
 s_add_u32 m0, s50, 15360
 v_mfma_f32_16x16x32_bf16 v[24:27], v[140:143], a[148:151], v[24:27]
 v_mfma_f32_16x16x32_bf16 v[28:31], v[140:143], a[156:159], v[28:31]
 s_add_u32 s3, s28, 114816
 v_mfma_f32_16x16x32_bf16 v[28:31], v[136:139], a[152:155], v[28:31]
 buffer_load_dwordx4 v8, s[8:11], s3 offen lds
 s_waitcnt lgkmcnt(0)
 v_mfma_f32_16x16x32_bf16 v[32:35], v[136:139], a[160:163], v[32:35]
 s_add_u32 m0, s50, 18432
 v_mfma_f32_16x16x32_bf16 v[32:35], v[140:143], a[164:167], v[32:35]
 s_add_u32 s3, s28, 131200
 v_mfma_f32_16x16x32_bf16 v[36:39], v[140:143], a[172:175], v[36:39]
 v_mfma_f32_16x16x32_bf16 v[36:39], v[136:139], a[168:171], v[36:39]
 buffer_load_dwordx4 v8, s[8:11], s3 offen lds
 v_mfma_f32_16x16x32_bf16 v[40:43], v[136:139], a[176:179], v[40:43]
 s_add_u32 m0, s50, 19456
 v_mfma_f32_16x16x32_bf16 v[40:43], v[140:143], a[180:183], v[40:43]
 s_add_u32 s3, s28, 147584
 v_mfma_f32_16x16x32_bf16 v[44:47], v[140:143], a[188:191], v[44:47]
 v_mfma_f32_16x16x32_bf16 v[44:47], v[136:139], a[184:187], v[44:47]
 buffer_load_dwordx4 v8, s[8:11], s3 offen lds
 v_mfma_f32_16x16x32_bf16 v[76:79], v[144:147], a[184:187], v[76:79]
 s_add_u32 m0, s50, 22528
 v_mfma_f32_16x16x32_bf16 v[76:79], v[148:151], a[188:191], v[76:79]
 s_add_u32 s3, s28, 163968
 v_mfma_f32_16x16x32_bf16 v[72:75], v[148:151], a[180:183], v[72:75]
 v_mov_b32 v136, 1.0
 v_mfma_f32_16x16x32_bf16 v[72:75], v[144:147], a[176:179], v[72:75]
 buffer_load_dwordx4 v8, s[8:11], s3 offen lds
 v_mfma_f32_16x16x32_bf16 v[68:71], v[144:147], a[168:171], v[68:71]
 s_add_u32 m0, s50, 23552
 v_mov_b32 v137, 1.0
 v_mfma_f32_16x16x32_bf16 v[68:71], v[148:151], a[172:175], v[68:71]
 s_add_u32 s3, s28, 180352
 v_mov_b32 v138, 1.0
 v_mfma_f32_16x16x32_bf16 v[64:67], v[148:151], a[164:167], v[64:67]
 buffer_load_dwordx4 v8, s[8:11], s3 offen lds
 v_mfma_f32_16x16x32_bf16 v[64:67], v[144:147], a[160:163], v[64:67]
 v_mov_b32 v139, 1.0
 v_mfma_f32_16x16x32_bf16 v[60:63], v[144:147], a[152:155], v[60:63]
 s_add_u32 m0, s50, 26624
 v_mov_b32 v140, 1.0
 v_mfma_f32_16x16x32_bf16 v[60:63], v[148:151], a[156:159], v[60:63]
 v_mfma_f32_16x16x32_bf16 v[56:59], v[148:151], a[148:151], v[56:59]
 s_add_u32 s3, s28, 196736
 v_mov_b32 v141, 1.0
 v_mfma_f32_16x16x32_bf16 v[56:59], v[144:147], a[144:147], v[56:59]
 v_mov_b32 v142, 1.0
 v_mfma_f32_16x16x32_bf16 v[52:55], v[144:147], a[136:139], v[52:55]
 buffer_load_dwordx4 v8, s[8:11], s3 offen lds
 s_add_u32 m0, s50, 27648
 v_mfma_f32_16x16x32_bf16 v[52:55], v[148:151], a[140:143], v[52:55]
 v_mov_b32 v143, 1.0
 v_mfma_f32_16x16x32_bf16 v[48:51], v[148:151], a[132:135], v[48:51]
 s_add_u32 s3, s28, 213120
 v_mfma_f32_16x16x32_bf16 v[48:51], v[144:147], a[128:131], v[48:51]
 buffer_load_dwordx4 v8, s[8:11], s3 offen lds
 v_mfma_f32_16x16x32_bf16 v[80:83], v[152:155], a[128:131], v[80:83]
 s_add_u32 m0, s50, 30720
 v_mfma_f32_16x16x32_bf16 v[80:83], v[156:159], a[132:135], v[80:83]
 v_mfma_f32_16x16x32_bf16 v[84:87], v[156:159], a[140:143], v[84:87]
 s_add_u32 s3, s28, 229504
 v_mov_b32 v144, 1.0
 v_mfma_f32_16x16x32_bf16 v[84:87], v[152:155], a[136:139], v[84:87]
 buffer_load_dwordx4 v8, s[8:11], s3 offen lds
 v_mfma_f32_16x16x32_bf16 v[88:91], v[152:155], a[144:147], v[88:91]
 s_add_u32 m0, s50, 31744
 v_mov_b32 v145, 1.0
 v_mfma_f32_16x16x32_bf16 v[88:91], v[156:159], a[148:151], v[88:91]
 s_add_u32 s3, s28, 245888
 v_mov_b32 v146, 1.0
 v_mfma_f32_16x16x32_bf16 v[92:95], v[156:159], a[156:159], v[92:95]
 buffer_load_dwordx4 v8, s[8:11], s3 offen lds
 v_mfma_f32_16x16x32_bf16 v[92:95], v[152:155], a[152:155], v[92:95]
 v_mov_b32 v147, 1.0
 v_mfma_f32_16x16x32_bf16 v[96:99], v[152:155], a[160:163], v[96:99]
 v_mov_b32 v148, 1.0
 v_mfma_f32_16x16x32_bf16 v[96:99], v[156:159], a[164:167], v[96:99]
 v_mfma_f32_16x16x32_bf16 v[100:103], v[156:159], a[172:175], v[100:103]
 v_mov_b32 v149, 1.0
 v_mfma_f32_16x16x32_bf16 v[100:103], v[152:155], a[168:171], v[100:103]
 v_mov_b32 v150, 1.0
 v_mfma_f32_16x16x32_bf16 v[104:107], v[152:155], a[176:179], v[104:107]
 v_mfma_f32_16x16x32_bf16 v[104:107], v[156:159], a[180:183], v[104:107]
 v_mov_b32 v151, 1.0
 v_mfma_f32_16x16x32_bf16 v[108:111], v[156:159], a[188:191], v[108:111]
 v_mfma_f32_16x16x32_bf16 v[108:111], v[152:155], a[184:187], v[108:111]
 v_mfma_f32_16x16x32_bf16 a[244:247], v[160:163], a[184:187], a[244:247]
 ds_read_b128 a[184:187], v1 offset:61440
 v_mfma_f32_16x16x32_bf16 a[244:247], v[164:167], a[188:191], a[244:247]
 ds_read_b128 a[188:191], v1 offset:62464
 v_mfma_f32_16x16x32_bf16 a[240:243], v[164:167], a[180:183], a[240:243]
 ds_read_b128 a[180:183], v1 offset:58368
 v_mov_b32 v152, 1.0
 v_mfma_f32_16x16x32_bf16 a[240:243], v[160:163], a[176:179], a[240:243]
 ds_read_b128 a[176:179], v1 offset:57344
 v_mfma_f32_16x16x32_bf16 v[132:135], v[160:163], a[168:171], v[132:135]
 ds_read_b128 a[168:171], v1 offset:53248
 v_mov_b32 v153, 1.0
 v_mfma_f32_16x16x32_bf16 v[132:135], v[164:167], a[172:175], v[132:135]
 ds_read_b128 a[172:175], v1 offset:54272
 v_mov_b32 v154, 1.0
 v_mfma_f32_16x16x32_bf16 v[128:131], v[164:167], a[164:167], v[128:131]
 ds_read_b128 a[164:167], v1 offset:50176
 v_mfma_f32_16x16x32_bf16 v[128:131], v[160:163], a[160:163], v[128:131]
 ds_read_b128 a[160:163], v1 offset:49152
 v_mov_b32 v155, 1.0
 v_mfma_f32_16x16x32_bf16 v[124:127], v[160:163], a[152:155], v[124:127]
 ds_read_b128 a[152:155], v1 offset:45056
 v_mov_b32 v156, 1.0
 v_mfma_f32_16x16x32_bf16 v[124:127], v[164:167], a[156:159], v[124:127]
 ds_read_b128 a[156:159], v1 offset:46080
 v_mfma_f32_16x16x32_bf16 v[120:123], v[164:167], a[148:151], v[120:123]
 ds_read_b128 a[148:151], v1 offset:41984
 v_mov_b32 v157, 1.0
 v_mfma_f32_16x16x32_bf16 v[120:123], v[160:163], a[144:147], v[120:123]
 ds_read_b128 a[144:147], v1 offset:40960
 v_mov_b32 v158, 1.0
 v_mfma_f32_16x16x32_bf16 v[116:119], v[160:163], a[136:139], v[116:119]
 ds_read_b128 a[136:139], v1 offset:36864
 v_mfma_f32_16x16x32_bf16 v[116:119], v[164:167], a[140:143], v[116:119]
 ds_read_b128 a[140:143], v1 offset:37888
 v_mov_b32 v159, 1.0
 v_mfma_f32_16x16x32_bf16 v[112:115], v[164:167], a[132:135], v[112:115]
 ds_read_b128 a[132:135], v1 offset:33792
 v_mfma_f32_16x16x32_bf16 v[112:115], v[160:163], a[128:131], v[112:115]
 ds_read_b128 a[128:131], v1 offset:32768
 s_waitcnt lgkmcnt(8)
 v_mfma_f32_16x16x32_bf16 v[44:47], v[168:171], a[184:187], v[44:47]
 v_mfma_f32_16x16x32_bf16 v[44:47], v[172:175], a[188:191], v[44:47]
 v_mfma_f32_16x16x32_bf16 v[40:43], v[172:175], a[180:183], v[40:43]
 v_mov_b32 v160, 1.0
 v_mfma_f32_16x16x32_bf16 v[40:43], v[168:171], a[176:179], v[40:43]
 v_mfma_f32_16x16x32_bf16 v[36:39], v[168:171], a[168:171], v[36:39]
 v_mov_b32 v161, 1.0
 v_mfma_f32_16x16x32_bf16 v[36:39], v[172:175], a[172:175], v[36:39]
 v_mov_b32 v162, 1.0
 v_mfma_f32_16x16x32_bf16 v[32:35], v[172:175], a[164:167], v[32:35]
 v_mfma_f32_16x16x32_bf16 v[32:35], v[168:171], a[160:163], v[32:35]
 v_mov_b32 v163, 1.0
 s_waitcnt lgkmcnt(0)
 v_mfma_f32_16x16x32_bf16 v[28:31], v[168:171], a[152:155], v[28:31]
 v_mov_b32 v164, 1.0
 v_mfma_f32_16x16x32_bf16 v[28:31], v[172:175], a[156:159], v[28:31]
 v_mfma_f32_16x16x32_bf16 v[24:27], v[172:175], a[148:151], v[24:27]
 v_mov_b32 v165, 1.0
 v_mfma_f32_16x16x32_bf16 v[24:27], v[168:171], a[144:147], v[24:27]
 v_mov_b32 v166, 1.0
 v_mfma_f32_16x16x32_bf16 v[20:23], v[168:171], a[136:139], v[20:23]
 v_mfma_f32_16x16x32_bf16 v[20:23], v[172:175], a[140:143], v[20:23]
 v_mov_b32 v167, 1.0
 v_mfma_f32_16x16x32_bf16 v[16:19], v[172:175], a[132:135], v[16:19]
 v_mfma_f32_16x16x32_bf16 v[16:19], v[168:171], a[128:131], v[16:19]
 v_mfma_f32_16x16x32_bf16 v[48:51], v[176:179], a[128:131], v[48:51]
 v_mfma_f32_16x16x32_bf16 v[48:51], v[180:183], a[132:135], v[48:51]
 v_mfma_f32_16x16x32_bf16 v[52:55], v[180:183], a[140:143], v[52:55]
 v_mov_b32 v168, 1.0
 v_mfma_f32_16x16x32_bf16 v[52:55], v[176:179], a[136:139], v[52:55]
 v_mfma_f32_16x16x32_bf16 v[56:59], v[176:179], a[144:147], v[56:59]
 v_mov_b32 v169, 1.0
 v_mfma_f32_16x16x32_bf16 v[56:59], v[180:183], a[148:151], v[56:59]
 v_mov_b32 v170, 1.0
 v_mfma_f32_16x16x32_bf16 v[60:63], v[180:183], a[156:159], v[60:63]
 v_mfma_f32_16x16x32_bf16 v[60:63], v[176:179], a[152:155], v[60:63]
 v_mov_b32 v171, 1.0
 v_mfma_f32_16x16x32_bf16 v[64:67], v[176:179], a[160:163], v[64:67]
 v_mov_b32 v172, 1.0
 v_mfma_f32_16x16x32_bf16 v[64:67], v[180:183], a[164:167], v[64:67]
 v_mfma_f32_16x16x32_bf16 v[68:71], v[180:183], a[172:175], v[68:71]
 v_mov_b32 v173, 1.0
 v_mfma_f32_16x16x32_bf16 v[68:71], v[176:179], a[168:171], v[68:71]
 v_mov_b32 v174, 1.0
 v_mfma_f32_16x16x32_bf16 v[72:75], v[176:179], a[176:179], v[72:75]
 v_mfma_f32_16x16x32_bf16 v[72:75], v[180:183], a[180:183], v[72:75]
 v_mov_b32 v175, 1.0
 v_mfma_f32_16x16x32_bf16 v[76:79], v[180:183], a[188:191], v[76:79]
 v_mfma_f32_16x16x32_bf16 v[76:79], v[176:179], a[184:187], v[76:79]
 v_mfma_f32_16x16x32_bf16 v[108:111], v[184:187], a[184:187], v[108:111]
 v_mfma_f32_16x16x32_bf16 v[108:111], v[188:191], a[188:191], v[108:111]
 v_mfma_f32_16x16x32_bf16 v[104:107], v[188:191], a[180:183], v[104:107]
 v_mov_b32 v176, 1.0
 v_mfma_f32_16x16x32_bf16 v[104:107], v[184:187], a[176:179], v[104:107]
 v_mfma_f32_16x16x32_bf16 v[100:103], v[184:187], a[168:171], v[100:103]
 v_mov_b32 v177, 1.0
 v_mfma_f32_16x16x32_bf16 v[100:103], v[188:191], a[172:175], v[100:103]
 v_mov_b32 v178, 1.0
 v_mfma_f32_16x16x32_bf16 v[96:99], v[188:191], a[164:167], v[96:99]
 v_mfma_f32_16x16x32_bf16 v[96:99], v[184:187], a[160:163], v[96:99]
 v_mov_b32 v179, 1.0
 v_mfma_f32_16x16x32_bf16 v[92:95], v[184:187], a[152:155], v[92:95]
 v_mov_b32 v180, 1.0
 v_mfma_f32_16x16x32_bf16 v[92:95], v[188:191], a[156:159], v[92:95]
 v_mfma_f32_16x16x32_bf16 v[88:91], v[188:191], a[148:151], v[88:91]
 v_mov_b32 v181, 1.0
 v_mfma_f32_16x16x32_bf16 v[88:91], v[184:187], a[144:147], v[88:91]
 v_mov_b32 v182, 1.0
 v_mfma_f32_16x16x32_bf16 v[84:87], v[184:187], a[136:139], v[84:87]
 v_mfma_f32_16x16x32_bf16 v[84:87], v[188:191], a[140:143], v[84:87]
 v_mov_b32 v183, 1.0
 v_mfma_f32_16x16x32_bf16 v[80:83], v[188:191], a[132:135], v[80:83]
 v_mfma_f32_16x16x32_bf16 v[80:83], v[184:187], a[128:131], v[80:83]
 v_mfma_f32_16x16x32_bf16 v[112:115], v[192:195], a[128:131], v[112:115]
 ds_read_b128 a[128:131], v2
 v_mfma_f32_16x16x32_bf16 v[112:115], v[196:199], a[132:135], v[112:115]
 ds_read_b128 a[132:135], v2 offset:1024
 v_mfma_f32_16x16x32_bf16 v[116:119], v[196:199], a[140:143], v[116:119]
 ds_read_b128 a[140:143], v2 offset:5120
 v_mov_b32 v184, 1.0
 v_mfma_f32_16x16x32_bf16 v[116:119], v[192:195], a[136:139], v[116:119]
 ds_read_b128 a[136:139], v2 offset:4096
 v_mfma_f32_16x16x32_bf16 v[120:123], v[192:195], a[144:147], v[120:123]
 ds_read_b128 a[144:147], v2 offset:8192
 v_mov_b32 v185, 1.0
 v_mfma_f32_16x16x32_bf16 v[120:123], v[196:199], a[148:151], v[120:123]
 ds_read_b128 a[148:151], v2 offset:9216
 v_mov_b32 v186, 1.0
 v_mfma_f32_16x16x32_bf16 v[124:127], v[196:199], a[156:159], v[124:127]
 ds_read_b128 a[156:159], v2 offset:13312
 v_mfma_f32_16x16x32_bf16 v[124:127], v[192:195], a[152:155], v[124:127]
 ds_read_b128 a[152:155], v2 offset:12288
 v_mov_b32 v187, 1.0
 v_mfma_f32_16x16x32_bf16 v[128:131], v[192:195], a[160:163], v[128:131]
 ds_read_b128 a[160:163], v2 offset:16384
 v_mov_b32 v188, 1.0
 v_mfma_f32_16x16x32_bf16 v[128:131], v[196:199], a[164:167], v[128:131]
 ds_read_b128 a[164:167], v2 offset:17408
 v_mfma_f32_16x16x32_bf16 v[132:135], v[196:199], a[172:175], v[132:135]
 ds_read_b128 a[172:175], v2 offset:21504
 v_mov_b32 v189, 1.0
 v_mfma_f32_16x16x32_bf16 v[132:135], v[192:195], a[168:171], v[132:135]
 ds_read_b128 a[168:171], v2 offset:20480
 v_mov_b32 v190, 1.0
 v_mfma_f32_16x16x32_bf16 a[240:243], v[192:195], a[176:179], a[240:243]
 ds_read_b128 a[176:179], v2 offset:24576
 v_mfma_f32_16x16x32_bf16 a[240:243], v[196:199], a[180:183], a[240:243]
 ds_read_b128 a[180:183], v2 offset:25600
 v_mov_b32 v191, 1.0
 v_mfma_f32_16x16x32_bf16 a[244:247], v[196:199], a[188:191], a[244:247]
 ds_read_b128 a[188:191], v2 offset:29696
 v_mfma_f32_16x16x32_bf16 a[244:247], v[192:195], a[184:187], a[244:247]
 ds_read_b128 a[184:187], v2 offset:28672
 s_waitcnt lgkmcnt(8)
 v_mfma_f32_16x16x32_bf16 v[16:19], v[200:203], a[128:131], v[16:19]
 v_mfma_f32_16x16x32_bf16 v[16:19], v[204:207], a[132:135], v[16:19]
 v_mfma_f32_16x16x32_bf16 v[20:23], v[204:207], a[140:143], v[20:23]
 v_mov_b32 v192, 1.0
 v_mfma_f32_16x16x32_bf16 v[20:23], v[200:203], a[136:139], v[20:23]
 v_mfma_f32_16x16x32_bf16 v[24:27], v[200:203], a[144:147], v[24:27]
 v_mov_b32 v193, 1.0
 v_mfma_f32_16x16x32_bf16 v[24:27], v[204:207], a[148:151], v[24:27]
 v_mov_b32 v194, 1.0
 v_mfma_f32_16x16x32_bf16 v[28:31], v[204:207], a[156:159], v[28:31]
 v_mfma_f32_16x16x32_bf16 v[28:31], v[200:203], a[152:155], v[28:31]
 v_mov_b32 v195, 1.0
 s_waitcnt lgkmcnt(0)
 v_mfma_f32_16x16x32_bf16 v[32:35], v[200:203], a[160:163], v[32:35]
 v_mov_b32 v196, 1.0
 v_mfma_f32_16x16x32_bf16 v[32:35], v[204:207], a[164:167], v[32:35]
 v_mfma_f32_16x16x32_bf16 v[36:39], v[204:207], a[172:175], v[36:39]
 v_mov_b32 v197, 1.0
 v_mfma_f32_16x16x32_bf16 v[36:39], v[200:203], a[168:171], v[36:39]
 v_mov_b32 v198, 1.0
 v_mfma_f32_16x16x32_bf16 v[40:43], v[200:203], a[176:179], v[40:43]
 v_mfma_f32_16x16x32_bf16 v[40:43], v[204:207], a[180:183], v[40:43]
 v_mov_b32 v199, 1.0
 v_mfma_f32_16x16x32_bf16 v[44:47], v[204:207], a[188:191], v[44:47]
 v_mfma_f32_16x16x32_bf16 v[44:47], v[200:203], a[184:187], v[44:47]
 v_mfma_f32_16x16x32_bf16 v[76:79], v[208:211], a[184:187], v[76:79]
 v_mfma_f32_16x16x32_bf16 v[76:79], v[212:215], a[188:191], v[76:79]
 v_mfma_f32_16x16x32_bf16 v[72:75], v[212:215], a[180:183], v[72:75]
 v_mov_b32 v200, 1.0
 v_mfma_f32_16x16x32_bf16 v[72:75], v[208:211], a[176:179], v[72:75]
 v_mfma_f32_16x16x32_bf16 v[68:71], v[208:211], a[168:171], v[68:71]
 v_mov_b32 v201, 1.0
 v_mfma_f32_16x16x32_bf16 v[68:71], v[212:215], a[172:175], v[68:71]
 v_mov_b32 v202, 1.0
 v_mfma_f32_16x16x32_bf16 v[64:67], v[212:215], a[164:167], v[64:67]
 v_mfma_f32_16x16x32_bf16 v[64:67], v[208:211], a[160:163], v[64:67]
 v_mov_b32 v203, 1.0
 v_mfma_f32_16x16x32_bf16 v[60:63], v[208:211], a[152:155], v[60:63]
 v_mov_b32 v204, 1.0
 v_mfma_f32_16x16x32_bf16 v[60:63], v[212:215], a[156:159], v[60:63]
 v_mfma_f32_16x16x32_bf16 v[56:59], v[212:215], a[148:151], v[56:59]
 v_mov_b32 v205, 1.0
 v_mfma_f32_16x16x32_bf16 v[56:59], v[208:211], a[144:147], v[56:59]
 v_mov_b32 v206, 1.0
 v_mfma_f32_16x16x32_bf16 v[52:55], v[208:211], a[136:139], v[52:55]
 v_mfma_f32_16x16x32_bf16 v[52:55], v[212:215], a[140:143], v[52:55]
 v_mov_b32 v207, 1.0
 v_mfma_f32_16x16x32_bf16 v[48:51], v[212:215], a[132:135], v[48:51]
 v_mfma_f32_16x16x32_bf16 v[48:51], v[208:211], a[128:131], v[48:51]
 v_mfma_f32_16x16x32_bf16 v[80:83], a[224:227], a[128:131], v[80:83]
 v_mfma_f32_16x16x32_bf16 v[80:83], a[228:231], a[132:135], v[80:83]
 v_mfma_f32_16x16x32_bf16 v[84:87], a[228:231], a[140:143], v[84:87]
 v_mov_b32 v208, 1.0
 s_waitcnt vmcnt(16)
 v_cmp_gt_i32 vcc, s27, v4
 s_and_b64 vcc, exec, vcc
 s_cbranch_vccnz Lspin_pro
Lok_pro:
 s_add_u32 s27, s27, 64
 v_mfma_f32_16x16x32_bf16 v[84:87], a[224:227], a[136:139], v[84:87]
 v_mfma_f32_16x16x32_bf16 v[88:91], a[224:227], a[144:147], v[88:91]
 v_mov_b32 v209, 1.0
 v_mfma_f32_16x16x32_bf16 v[88:91], a[228:231], a[148:151], v[88:91]
 v_mov_b32 v210, 1.0
 v_mfma_f32_16x16x32_bf16 v[92:95], a[228:231], a[156:159], v[92:95]
 v_mfma_f32_16x16x32_bf16 v[92:95], a[224:227], a[152:155], v[92:95]
 v_mov_b32 v211, 1.0
 v_mfma_f32_16x16x32_bf16 v[96:99], a[224:227], a[160:163], v[96:99]
 v_mov_b32 v212, 1.0
 v_mfma_f32_16x16x32_bf16 v[96:99], a[228:231], a[164:167], v[96:99]
 v_mfma_f32_16x16x32_bf16 v[100:103], a[228:231], a[172:175], v[100:103]
 v_mov_b32 v213, 1.0
 v_mfma_f32_16x16x32_bf16 v[100:103], a[224:227], a[168:171], v[100:103]
 v_mov_b32 v214, 1.0
 v_mfma_f32_16x16x32_bf16 v[104:107], a[224:227], a[176:179], v[104:107]
 v_mfma_f32_16x16x32_bf16 v[104:107], a[228:231], a[180:183], v[104:107]
 v_mov_b32 v215, 1.0
 v_mfma_f32_16x16x32_bf16 v[108:111], a[228:231], a[188:191], v[108:111]
 v_mfma_f32_16x16x32_bf16 v[108:111], a[224:227], a[184:187], v[108:111]
 v_mfma_f32_16x16x32_bf16 a[244:247], a[232:235], a[184:187], a[244:247]
 ds_read_b128 a[184:187], v2 offset:61440
 v_mfma_f32_16x16x32_bf16 a[244:247], a[236:239], a[188:191], a[244:247]
 global_load_dwordx4 a[228:231], v0, s[70:71] offset:-3072 sc1
 ds_read_b128 a[188:191], v2 offset:62464
 v_mfma_f32_16x16x32_bf16 a[240:243], a[236:239], a[180:183], a[240:243]
 ds_read_b128 a[180:183], v2 offset:58368
 v_mfma_f32_16x16x32_bf16 a[240:243], a[232:235], a[176:179], a[240:243]
 global_load_dwordx4 a[224:227], v0, s[70:71] offset:-4096 sc1
 ds_read_b128 a[176:179], v2 offset:57344
 v_mfma_f32_16x16x32_bf16 v[132:135], a[232:235], a[168:171], v[132:135]
 ds_read_b128 a[168:171], v2 offset:53248
 v_mfma_f32_16x16x32_bf16 v[132:135], a[236:239], a[172:175], v[132:135]
 ds_read_b128 a[172:175], v2 offset:54272
 v_mfma_f32_16x16x32_bf16 v[128:131], a[236:239], a[164:167], v[128:131]
 ds_read_b128 a[164:167], v2 offset:50176
 v_mfma_f32_16x16x32_bf16 v[128:131], a[232:235], a[160:163], v[128:131]
 ds_read_b128 a[160:163], v2 offset:49152
 v_mfma_f32_16x16x32_bf16 v[124:127], a[232:235], a[152:155], v[124:127]
 ds_read_b128 a[152:155], v2 offset:45056
 v_mfma_f32_16x16x32_bf16 v[124:127], a[236:239], a[156:159], v[124:127]
 ds_read_b128 a[156:159], v2 offset:46080
 v_mfma_f32_16x16x32_bf16 v[120:123], a[236:239], a[148:151], v[120:123]
 ds_read_b128 a[148:151], v2 offset:41984
 v_mfma_f32_16x16x32_bf16 v[120:123], a[232:235], a[144:147], v[120:123]
 ds_read_b128 a[144:147], v2 offset:40960
 v_mfma_f32_16x16x32_bf16 v[116:119], a[232:235], a[136:139], v[116:119]
 ds_read_b128 a[136:139], v2 offset:36864
 v_mfma_f32_16x16x32_bf16 v[116:119], a[236:239], a[140:143], v[116:119]
 ds_read_b128 a[140:143], v2 offset:37888
 v_mfma_f32_16x16x32_bf16 v[112:115], a[236:239], a[132:135], v[112:115]
 ds_read_b128 a[132:135], v2 offset:33792
 v_mfma_f32_16x16x32_bf16 v[112:115], a[232:235], a[128:131], v[112:115]
 ds_read_b128 a[128:131], v2 offset:32768
 s_waitcnt lgkmcnt(8)
 v_mfma_f32_16x16x32_bf16 v[44:47], a[192:195], a[184:187], v[44:47]
 v_mfma_f32_16x16x32_bf16 v[44:47], a[196:199], a[188:191], v[44:47]
 global_load_dwordx4 a[236:239], v0, s[70:71] offset:-1024 sc1
 v_mfma_f32_16x16x32_bf16 v[40:43], a[196:199], a[180:183], v[40:43]
 v_mfma_f32_16x16x32_bf16 v[40:43], a[192:195], a[176:179], v[40:43]
 global_load_dwordx4 a[232:235], v0, s[70:71] offset:-2048 sc1
 v_mfma_f32_16x16x32_bf16 v[36:39], a[192:195], a[168:171], v[36:39]
 v_mfma_f32_16x16x32_bf16 v[36:39], a[196:199], a[172:175], v[36:39]
 v_mfma_f32_16x16x32_bf16 v[32:35], a[196:199], a[164:167], v[32:35]
 v_mfma_f32_16x16x32_bf16 v[32:35], a[192:195], a[160:163], v[32:35]
 s_waitcnt lgkmcnt(0)
 v_mfma_f32_16x16x32_bf16 v[28:31], a[192:195], a[152:155], v[28:31]
 v_mfma_f32_16x16x32_bf16 v[28:31], a[196:199], a[156:159], v[28:31]
 v_mfma_f32_16x16x32_bf16 v[24:27], a[196:199], a[148:151], v[24:27]
 v_mfma_f32_16x16x32_bf16 v[24:27], a[192:195], a[144:147], v[24:27]
 v_mfma_f32_16x16x32_bf16 v[20:23], a[192:195], a[136:139], v[20:23]
 v_mfma_f32_16x16x32_bf16 v[20:23], a[196:199], a[140:143], v[20:23]
 v_mfma_f32_16x16x32_bf16 v[16:19], a[196:199], a[132:135], v[16:19]
 v_mfma_f32_16x16x32_bf16 v[16:19], a[192:195], a[128:131], v[16:19]
 v_mfma_f32_16x16x32_bf16 v[48:51], a[200:203], a[128:131], v[48:51]
 v_mfma_f32_16x16x32_bf16 v[48:51], a[204:207], a[132:135], v[48:51]
 global_load_dwordx4 a[196:199], v0, s[70:71] offset:1024 sc1
 v_mfma_f32_16x16x32_bf16 v[52:55], a[204:207], a[140:143], v[52:55]
 v_mfma_f32_16x16x32_bf16 v[52:55], a[200:203], a[136:139], v[52:55]
 global_load_dwordx4 a[192:195], v0, s[70:71] offset:0 sc1
 v_mfma_f32_16x16x32_bf16 v[56:59], a[200:203], a[144:147], v[56:59]
 v_mfma_f32_16x16x32_bf16 v[56:59], a[204:207], a[148:151], v[56:59]
 v_mfma_f32_16x16x32_bf16 v[60:63], a[204:207], a[156:159], v[60:63]
 v_mfma_f32_16x16x32_bf16 v[60:63], a[200:203], a[152:155], v[60:63]
 v_mfma_f32_16x16x32_bf16 v[64:67], a[200:203], a[160:163], v[64:67]
 v_mfma_f32_16x16x32_bf16 v[64:67], a[204:207], a[164:167], v[64:67]
 v_mfma_f32_16x16x32_bf16 v[68:71], a[204:207], a[172:175], v[68:71]
 v_mfma_f32_16x16x32_bf16 v[68:71], a[200:203], a[168:171], v[68:71]
 v_mfma_f32_16x16x32_bf16 v[72:75], a[200:203], a[176:179], v[72:75]
 v_mfma_f32_16x16x32_bf16 v[72:75], a[204:207], a[180:183], v[72:75]
 v_mfma_f32_16x16x32_bf16 v[76:79], a[204:207], a[188:191], v[76:79]
 v_mfma_f32_16x16x32_bf16 v[76:79], a[200:203], a[184:187], v[76:79]
 v_mfma_f32_16x16x32_bf16 v[108:111], a[208:211], a[184:187], v[108:111]
 v_mfma_f32_16x16x32_bf16 v[108:111], a[212:215], a[188:191], v[108:111]
 global_load_dwordx4 a[204:207], v0, s[70:71] offset:3072 sc1
 v_mfma_f32_16x16x32_bf16 v[104:107], a[212:215], a[180:183], v[104:107]
 v_mfma_f32_16x16x32_bf16 v[104:107], a[208:211], a[176:179], v[104:107]
 global_load_dwordx4 a[200:203], v0, s[70:71] offset:2048 sc1
 v_mfma_f32_16x16x32_bf16 v[100:103], a[208:211], a[168:171], v[100:103]
 s_add_u32 s70, s70, 8192
 s_addc_u32 s71, s71, 0
 v_mfma_f32_16x16x32_bf16 v[100:103], a[212:215], a[172:175], v[100:103]
 v_mfma_f32_16x16x32_bf16 v[96:99], a[212:215], a[164:167], v[96:99]
 v_mfma_f32_16x16x32_bf16 v[96:99], a[208:211], a[160:163], v[96:99]
 v_mfma_f32_16x16x32_bf16 v[92:95], a[208:211], a[152:155], v[92:95]
 v_mfma_f32_16x16x32_bf16 v[92:95], a[212:215], a[156:159], v[92:95]
 v_mfma_f32_16x16x32_bf16 v[88:91], a[212:215], a[148:151], v[88:91]
 v_mfma_f32_16x16x32_bf16 v[88:91], a[208:211], a[144:147], v[88:91]
 v_mfma_f32_16x16x32_bf16 v[84:87], a[208:211], a[136:139], v[84:87]
 v_mfma_f32_16x16x32_bf16 v[84:87], a[212:215], a[140:143], v[84:87]
 v_mfma_f32_16x16x32_bf16 v[80:83], a[212:215], a[132:135], v[80:83]
 v_mfma_f32_16x16x32_bf16 v[80:83], a[208:211], a[128:131], v[80:83]
 v_mfma_f32_16x16x32_bf16 v[112:115], a[216:219], a[128:131], v[112:115]
 v_mfma_f32_16x16x32_bf16 v[112:115], a[220:223], a[132:135], v[112:115]
 global_load_dwordx4 a[212:215], v0, s[70:71] offset:-3072 sc1
 v_mfma_f32_16x16x32_bf16 v[116:119], a[220:223], a[140:143], v[116:119]
 v_mfma_f32_16x16x32_bf16 v[116:119], a[216:219], a[136:139], v[116:119]
 global_load_dwordx4 a[208:211], v0, s[70:71] offset:-4096 sc1
 v_mfma_f32_16x16x32_bf16 v[120:123], a[216:219], a[144:147], v[120:123]
 v_mfma_f32_16x16x32_bf16 v[120:123], a[220:223], a[148:151], v[120:123]
 v_mfma_f32_16x16x32_bf16 v[124:127], a[220:223], a[156:159], v[124:127]
 v_mfma_f32_16x16x32_bf16 v[124:127], a[216:219], a[152:155], v[124:127]
 v_mfma_f32_16x16x32_bf16 v[128:131], a[216:219], a[160:163], v[128:131]
 v_mfma_f32_16x16x32_bf16 v[128:131], a[220:223], a[164:167], v[128:131]
 v_mfma_f32_16x16x32_bf16 v[132:135], a[220:223], a[172:175], v[132:135]
 v_mfma_f32_16x16x32_bf16 v[132:135], a[216:219], a[168:171], v[132:135]
 v_mfma_f32_16x16x32_bf16 a[240:243], a[216:219], a[176:179], a[240:243]
 v_mfma_f32_16x16x32_bf16 a[240:243], a[220:223], a[180:183], a[240:243]
 v_mfma_f32_16x16x32_bf16 a[244:247], a[220:223], a[188:191], a[244:247]
 global_load_dwordx4 a[220:223], v0, s[70:71] offset:-1024 sc1
 v_mfma_f32_16x16x32_bf16 a[244:247], a[216:219], a[184:187], a[244:247]
 global_load_dwordx4 a[216:219], v0, s[70:71] offset:-2048 sc1
 s_waitcnt vmcnt(10)
 v_mfma_f32_16x16x32_bf16 v[164:167], a[224:227], a[184:187], v[164:167]
 v_lshrrev_b32 v5, 4, v1
 v_mfma_f32_16x16x32_bf16 v[164:167], a[228:231], a[188:191], v[164:167]
 v_and_b32 v5, 48, v5
 v_mfma_f32_16x16x32_bf16 v[160:163], a[228:231], a[180:183], v[160:163]
 v_xor_b32 v5, v5, v1
 v_mfma_f32_16x16x32_bf16 v[160:163], a[224:227], a[176:179], v[160:163]
 v_and_b32 v5, 112, v5
 v_mfma_f32_16x16x32_bf16 v[156:159], a[224:227], a[168:171], v[156:159]
 v_and_b32 v6, 240, v1
 v_mfma_f32_16x16x32_bf16 v[156:159], a[228:231], a[172:175], v[156:159]
 v_lshl_add_u32 v5, v6, 3, v5
 v_mfma_f32_16x16x32_bf16 v[152:155], a[228:231], a[164:167], v[152:155]
 v_add_u32 v8, s50, v5
 v_mfma_f32_16x16x32_bf16 v[152:155], a[224:227], a[160:163], v[152:155]
 v_xor_b32 v9, 64, v8
 v_mfma_f32_16x16x32_bf16 v[148:151], a[224:227], a[152:155], v[148:151]
 v_mfma_f32_16x16x32_bf16 v[148:151], a[228:231], a[156:159], v[148:151]
 ds_read_b128 a[64:67], v8 offset:2048
 ds_read_b128 a[96:99], v9 offset:2048
 v_mfma_f32_16x16x32_bf16 v[144:147], a[228:231], a[148:151], v[144:147]
 v_mfma_f32_16x16x32_bf16 v[144:147], a[224:227], a[144:147], v[144:147]
 v_mfma_f32_16x16x32_bf16 v[140:143], a[224:227], a[136:139], v[140:143]
 v_mfma_f32_16x16x32_bf16 v[140:143], a[228:231], a[140:143], v[140:143]
 v_mfma_f32_16x16x32_bf16 v[136:139], a[228:231], a[132:135], v[136:139]
 ds_read_b128 a[68:71], v8 offset:6144
 v_mfma_f32_16x16x32_bf16 v[136:139], a[224:227], a[128:131], v[136:139]
 ds_read_b128 a[100:103], v9 offset:6144
 s_waitcnt vmcnt(8)
 v_mfma_f32_16x16x32_bf16 v[168:171], a[232:235], a[128:131], v[168:171]
 v_mfma_f32_16x16x32_bf16 v[168:171], a[236:239], a[132:135], v[168:171]
 global_load_dwordx4 a[228:231], v0, s[70:71] offset:1024 sc1
 v_mfma_f32_16x16x32_bf16 v[172:175], a[236:239], a[140:143], v[172:175]
 v_mfma_f32_16x16x32_bf16 v[172:175], a[232:235], a[136:139], v[172:175]
 global_load_dwordx4 a[224:227], v0, s[70:71] offset:0 sc1
 s_waitcnt lgkmcnt(2)
 v_mfma_f32_16x16x32_bf16 v[176:179], a[232:235], a[144:147], v[176:179]
 ds_write_b128 v3, a[64:67] offset:2048
 v_mfma_f32_16x16x32_bf16 v[176:179], a[236:239], a[148:151], v[176:179]
 ds_write_b128 v3, a[96:99] offset:3072
 v_mfma_f32_16x16x32_bf16 v[180:183], a[236:239], a[156:159], v[180:183]
 v_mfma_f32_16x16x32_bf16 v[180:183], a[232:235], a[152:155], v[180:183]
 ds_read_b128 a[72:75], v8 offset:10240
 v_mfma_f32_16x16x32_bf16 v[184:187], a[232:235], a[160:163], v[184:187]
 ds_read_b128 a[104:107], v9 offset:10240
 v_mfma_f32_16x16x32_bf16 v[184:187], a[236:239], a[164:167], v[184:187]
 v_mfma_f32_16x16x32_bf16 v[188:191], a[236:239], a[172:175], v[188:191]
 v_mfma_f32_16x16x32_bf16 v[188:191], a[232:235], a[168:171], v[188:191]
 v_mfma_f32_16x16x32_bf16 v[192:195], a[232:235], a[176:179], v[192:195]
 s_waitcnt lgkmcnt(4)
 v_mfma_f32_16x16x32_bf16 v[192:195], a[236:239], a[180:183], v[192:195]
 ds_write_b128 v3, a[68:71] offset:6144
 ds_write_b128 v3, a[100:103] offset:7168
 v_mfma_f32_16x16x32_bf16 v[196:199], a[236:239], a[188:191], v[196:199]
 v_mfma_f32_16x16x32_bf16 v[196:199], a[232:235], a[184:187], v[196:199]
 ds_read_b128 a[76:79], v8 offset:14336
 s_waitcnt vmcnt(8)
 v_mfma_f32_16x16x32_bf16 v[228:231], a[192:195], a[184:187], v[228:231]
 ds_read_b128 a[108:111], v9 offset:14336
 v_mfma_f32_16x16x32_bf16 v[228:231], a[196:199], a[188:191], v[228:231]
 global_load_dwordx4 a[236:239], v0, s[70:71] offset:3072 sc1
 v_mfma_f32_16x16x32_bf16 v[224:227], a[196:199], a[180:183], v[224:227]
 v_mfma_f32_16x16x32_bf16 v[224:227], a[192:195], a[176:179], v[224:227]
 global_load_dwordx4 a[232:235], v0, s[70:71] offset:2048 sc1
 v_mfma_f32_16x16x32_bf16 v[220:223], a[192:195], a[168:171], v[220:223]
 s_waitcnt lgkmcnt(4)
 s_add_u32 s70, s70, 8192
 s_addc_u32 s71, s71, 0
 v_mfma_f32_16x16x32_bf16 v[220:223], a[196:199], a[172:175], v[220:223]
 ds_write_b128 v3, a[72:75] offset:10240
 v_mfma_f32_16x16x32_bf16 v[216:219], a[196:199], a[164:167], v[216:219]
 ds_write_b128 v3, a[104:107] offset:11264
 v_mfma_f32_16x16x32_bf16 v[216:219], a[192:195], a[160:163], v[216:219]
 v_mfma_f32_16x16x32_bf16 v[212:215], a[192:195], a[152:155], v[212:215]
 ds_read_b128 a[80:83], v8 offset:18432
 v_mfma_f32_16x16x32_bf16 v[212:215], a[196:199], a[156:159], v[212:215]
 ds_read_b128 a[112:115], v9 offset:18432
 v_mfma_f32_16x16x32_bf16 v[208:211], a[196:199], a[148:151], v[208:211]
 v_mfma_f32_16x16x32_bf16 v[208:211], a[192:195], a[144:147], v[208:211]
 v_mfma_f32_16x16x32_bf16 v[204:207], a[192:195], a[136:139], v[204:207]
 s_waitcnt lgkmcnt(4)
 ds_write_b128 v3, a[76:79] offset:14336
 ds_write_b128 v3, a[108:111] offset:15360
 v_mfma_f32_16x16x32_bf16 v[204:207], a[196:199], a[140:143], v[204:207]
 v_mfma_f32_16x16x32_bf16 v[200:203], a[196:199], a[132:135], v[200:203]
 v_mfma_f32_16x16x32_bf16 v[200:203], a[192:195], a[128:131], v[200:203]
 s_waitcnt vmcnt(8)
 v_mfma_f32_16x16x32_bf16 v[232:235], a[200:203], a[128:131], v[232:235]
 ds_read_b128 a[128:131], v2
 ds_read_b128 a[84:87], v8 offset:22528
 v_mfma_f32_16x16x32_bf16 v[232:235], a[204:207], a[132:135], v[232:235]
 global_load_dwordx4 a[196:199], v0, s[70:71] offset:-3072 sc1
 ds_read_b128 a[132:135], v2 offset:1024
 v_mfma_f32_16x16x32_bf16 v[236:239], a[204:207], a[140:143], v[236:239]
 ds_read_b128 a[140:143], v2 offset:5120
 ds_read_b128 a[116:119], v9 offset:22528
 v_mfma_f32_16x16x32_bf16 v[236:239], a[200:203], a[136:139], v[236:239]
 global_load_dwordx4 a[192:195], v0, s[70:71] offset:-4096 sc1
 ds_read_b128 a[136:139], v2 offset:4096
 v_mfma_f32_16x16x32_bf16 v[240:243], a[200:203], a[144:147], v[240:243]
 ds_read_b128 a[144:147], v2 offset:8192
 v_mfma_f32_16x16x32_bf16 v[240:243], a[204:207], a[148:151], v[240:243]
 ds_read_b128 a[148:151], v2 offset:9216
 s_waitcnt lgkmcnt(10)
 v_mfma_f32_16x16x32_bf16 v[244:247], a[204:207], a[156:159], v[244:247]
 ds_read_b128 a[156:159], v2 offset:13312
 v_mfma_f32_16x16x32_bf16 v[244:247], a[200:203], a[152:155], v[244:247]
 ds_read_b128 a[152:155], v2 offset:12288
 v_mfma_f32_16x16x32_bf16 v[248:251], a[200:203], a[160:163], v[248:251]
 ds_read_b128 a[160:163], v2 offset:16384
 v_mfma_f32_16x16x32_bf16 v[248:251], a[204:207], a[164:167], v[248:251]
 ds_read_b128 a[164:167], v2 offset:17408
 v_mfma_f32_16x16x32_bf16 v[252:255], a[204:207], a[172:175], v[252:255]
 ds_read_b128 a[172:175], v2 offset:21504
 v_mfma_f32_16x16x32_bf16 v[252:255], a[200:203], a[168:171], v[252:255]
 ds_read_b128 a[168:171], v2 offset:20480
 v_mfma_f32_16x16x32_bf16 a[248:251], a[200:203], a[176:179], a[248:251]
 ds_read_b128 a[176:179], v2 offset:24576
 v_mfma_f32_16x16x32_bf16 a[248:251], a[204:207], a[180:183], a[248:251]
 ds_read_b128 a[180:183], v2 offset:25600
 v_mfma_f32_16x16x32_bf16 a[252:255], a[204:207], a[188:191], a[252:255]
 ds_read_b128 a[188:191], v2 offset:29696
 v_mfma_f32_16x16x32_bf16 a[252:255], a[200:203], a[184:187], a[252:255]
 ds_read_b128 a[184:187], v2 offset:28672
 ds_write_b128 v3, a[80:83] offset:18432
 ds_write_b128 v3, a[112:115] offset:19456
 ds_read_b128 a[88:91], v8 offset:26624
 ds_read_b128 a[120:123], v9 offset:26624
 s_waitcnt vmcnt(8) lgkmcnt(12)
 v_mfma_f32_16x16x32_bf16 v[136:139], a[208:211], a[128:131], v[136:139]
 v_mfma_f32_16x16x32_bf16 v[136:139], a[212:215], a[132:135], v[136:139]
 global_load_dwordx4 a[204:207], v0, s[70:71] offset:-1024 sc1
 v_mfma_f32_16x16x32_bf16 v[140:143], a[212:215], a[140:143], v[140:143]
 ds_write_b128 v3, a[84:87] offset:22528
 ds_write_b128 v3, a[116:119] offset:23552
 v_mfma_f32_16x16x32_bf16 v[140:143], a[208:211], a[136:139], v[140:143]
 global_load_dwordx4 a[200:203], v0, s[70:71] offset:-2048 sc1
 ds_read_b128 a[92:95], v8 offset:30720
 v_mfma_f32_16x16x32_bf16 v[144:147], a[208:211], a[144:147], v[144:147]
 ds_read_b128 a[124:127], v9 offset:30720
 v_mfma_f32_16x16x32_bf16 v[144:147], a[212:215], a[148:151], v[144:147]
 v_mfma_f32_16x16x32_bf16 v[148:151], a[212:215], a[156:159], v[148:151]
 v_mfma_f32_16x16x32_bf16 v[148:151], a[208:211], a[152:155], v[148:151]
 s_waitcnt lgkmcnt(4)
 ds_write_b128 v3, a[88:91] offset:26624
 v_mfma_f32_16x16x32_bf16 v[152:155], a[208:211], a[160:163], v[152:155]
 ds_write_b128 v3, a[120:123] offset:27648
 v_mfma_f32_16x16x32_bf16 v[152:155], a[212:215], a[164:167], v[152:155]
 v_mfma_f32_16x16x32_bf16 v[156:159], a[212:215], a[172:175], v[156:159]
 v_mfma_f32_16x16x32_bf16 v[156:159], a[208:211], a[168:171], v[156:159]
 v_mfma_f32_16x16x32_bf16 v[160:163], a[208:211], a[176:179], v[160:163]
 v_mfma_f32_16x16x32_bf16 v[160:163], a[212:215], a[180:183], v[160:163]
 s_waitcnt lgkmcnt(2)
 v_mfma_f32_16x16x32_bf16 v[164:167], a[212:215], a[188:191], v[164:167]
 ds_write_b128 v3, a[92:95] offset:30720
 v_mfma_f32_16x16x32_bf16 v[164:167], a[208:211], a[184:187], v[164:167]
 ds_write_b128 v3, a[124:127] offset:31744
 s_waitcnt vmcnt(8)
 v_mfma_f32_16x16x32_bf16 v[196:199], a[216:219], a[184:187], v[196:199]
 v_bfe_u32 v4, v3, 8, 2
 v_mfma_f32_16x16x32_bf16 v[196:199], a[220:223], a[188:191], v[196:199]
 global_load_dwordx4 a[212:215], v0, s[70:71] offset:1024 sc1
 v_lshl_add_u32 v4, v4, 5, s51
 v_mfma_f32_16x16x32_bf16 v[192:195], a[220:223], a[180:183], v[192:195]
 ds_read_b128 v[8:11], v4
 v_mfma_f32_16x16x32_bf16 v[192:195], a[216:219], a[176:179], v[192:195]
 global_load_dwordx4 a[208:211], v0, s[70:71] offset:0 sc1
 v_mfma_f32_16x16x32_bf16 v[188:191], a[216:219], a[168:171], v[188:191]
 v_mfma_f32_16x16x32_bf16 v[188:191], a[220:223], a[172:175], v[188:191]
 v_mfma_f32_16x16x32_bf16 v[184:187], a[220:223], a[164:167], v[184:187]
 v_mfma_f32_16x16x32_bf16 v[184:187], a[216:219], a[160:163], v[184:187]
 v_mfma_f32_16x16x32_bf16 v[180:183], a[216:219], a[152:155], v[180:183]
 v_mfma_f32_16x16x32_bf16 v[180:183], a[220:223], a[156:159], v[180:183]
 v_mfma_f32_16x16x32_bf16 v[176:179], a[220:223], a[148:151], v[176:179]
 v_mfma_f32_16x16x32_bf16 v[176:179], a[216:219], a[144:147], v[176:179]
 s_waitcnt lgkmcnt(0)
 v_add_f32 v16, v16, v8
 v_mfma_f32_16x16x32_bf16 v[172:175], a[216:219], a[136:139], v[172:175]
 ds_read_b128 v[12:15], v4 offset:16
 v_mfma_f32_16x16x32_bf16 v[172:175], a[220:223], a[140:143], v[172:175]
 v_add_f32 v17, v17, v9
 v_mfma_f32_16x16x32_bf16 v[168:171], a[220:223], a[132:135], v[168:171]
 v_add_f32 v18, v18, v10
 v_mfma_f32_16x16x32_bf16 v[168:171], a[216:219], a[128:131], v[168:171]
 v_add_f32 v19, v19, v11
 s_waitcnt vmcnt(8)
 v_mfma_f32_16x16x32_bf16 v[200:203], a[224:227], a[128:131], v[200:203]
 v_add_f32 v20, v20, v8
 v_mfma_f32_16x16x32_bf16 v[200:203], a[228:231], a[132:135], v[200:203]
 global_load_dwordx4 a[220:223], v0, s[70:71] offset:3072 sc1
 v_add_f32 v21, v21, v9
 v_mfma_f32_16x16x32_bf16 v[204:207], a[228:231], a[140:143], v[204:207]
 v_add_f32 v22, v22, v10
 v_mfma_f32_16x16x32_bf16 v[204:207], a[224:227], a[136:139], v[204:207]
 global_load_dwordx4 a[216:219], v0, s[70:71] offset:2048 sc1
 v_add_f32 v23, v23, v11
 v_mfma_f32_16x16x32_bf16 v[208:211], a[224:227], a[144:147], v[208:211]
 v_add_f32 v24, v24, v8
 s_add_u32 s70, s70, 8192
 s_addc_u32 s71, s71, 0
 v_mfma_f32_16x16x32_bf16 v[208:211], a[228:231], a[148:151], v[208:211]
 v_add_f32 v25, v25, v9
 v_mfma_f32_16x16x32_bf16 v[212:215], a[228:231], a[156:159], v[212:215]
 v_add_f32 v26, v26, v10
 v_mfma_f32_16x16x32_bf16 v[212:215], a[224:227], a[152:155], v[212:215]
 v_add_f32 v27, v27, v11
 v_mfma_f32_16x16x32_bf16 v[216:219], a[224:227], a[160:163], v[216:219]
 v_add_f32 v28, v28, v8
 v_mfma_f32_16x16x32_bf16 v[216:219], a[228:231], a[164:167], v[216:219]
 v_add_f32 v29, v29, v9
 v_mfma_f32_16x16x32_bf16 v[220:223], a[228:231], a[172:175], v[220:223]
 v_add_f32 v30, v30, v10
 v_mfma_f32_16x16x32_bf16 v[220:223], a[224:227], a[168:171], v[220:223]
 v_add_f32 v31, v31, v11
 v_add_f32 v32, v32, v8
 v_mfma_f32_16x16x32_bf16 v[224:227], a[224:227], a[176:179], v[224:227]
 v_add_f32 v33, v33, v9
 v_mfma_f32_16x16x32_bf16 v[224:227], a[228:231], a[180:183], v[224:227]
 v_add_f32 v34, v34, v10
 v_mfma_f32_16x16x32_bf16 v[228:231], a[228:231], a[188:191], v[228:231]
 v_add_f32 v35, v35, v11
 v_mfma_f32_16x16x32_bf16 v[228:231], a[224:227], a[184:187], v[228:231]
 v_add_f32 v36, v36, v8
 v_add_f32 v37, v37, v9
 s_waitcnt vmcnt(8)
 v_mfma_f32_16x16x32_bf16 a[252:255], a[232:235], a[184:187], a[252:255]
 ds_read_b128 a[184:187], v1 offset:61440
 v_add_f32 v38, v38, v10
 v_mfma_f32_16x16x32_bf16 a[252:255], a[236:239], a[188:191], a[252:255]
 global_load_dwordx4 a[228:231], v0, s[70:71] offset:-3072 sc1
 ds_read_b128 a[188:191], v1 offset:62464
 v_mfma_f32_16x16x32_bf16 a[248:251], a[236:239], a[180:183], a[248:251]
 ds_read_b128 a[180:183], v1 offset:58368
 v_add_f32 v39, v39, v11
 v_mfma_f32_16x16x32_bf16 a[248:251], a[232:235], a[176:179], a[248:251]
 global_load_dwordx4 a[224:227], v0, s[70:71] offset:-4096 sc1
 ds_read_b128 a[176:179], v1 offset:57344
 v_mfma_f32_16x16x32_bf16 v[252:255], a[232:235], a[168:171], v[252:255]
 ds_read_b128 a[168:171], v1 offset:53248
 v_add_f32 v40, v40, v8
 v_mfma_f32_16x16x32_bf16 v[252:255], a[236:239], a[172:175], v[252:255]
 ds_read_b128 a[172:175], v1 offset:54272
 v_add_f32 v41, v41, v9
 v_mfma_f32_16x16x32_bf16 v[248:251], a[236:239], a[164:167], v[248:251]
 ds_read_b128 a[164:167], v1 offset:50176
 v_add_f32 v42, v42, v10
 v_mfma_f32_16x16x32_bf16 v[248:251], a[232:235], a[160:163], v[248:251]
 ds_read_b128 a[160:163], v1 offset:49152
 v_add_f32 v43, v43, v11
 v_mfma_f32_16x16x32_bf16 v[244:247], a[232:235], a[152:155], v[244:247]
 ds_read_b128 a[152:155], v1 offset:45056
 v_add_f32 v44, v44, v8
 v_mfma_f32_16x16x32_bf16 v[244:247], a[236:239], a[156:159], v[244:247]
 ds_read_b128 a[156:159], v1 offset:46080
 v_add_f32 v45, v45, v9
 v_mfma_f32_16x16x32_bf16 v[240:243], a[236:239], a[148:151], v[240:243]
 ds_read_b128 a[148:151], v1 offset:41984
 v_add_f32 v46, v46, v10
 v_mfma_f32_16x16x32_bf16 v[240:243], a[232:235], a[144:147], v[240:243]
 ds_read_b128 a[144:147], v1 offset:40960
 v_add_f32 v47, v47, v11
 s_waitcnt lgkmcnt(12)
 v_mfma_f32_16x16x32_bf16 v[236:239], a[232:235], a[136:139], v[236:239]
 ds_read_b128 a[136:139], v1 offset:36864
 v_add_f32 v48, v48, v12
 v_mfma_f32_16x16x32_bf16 v[236:239], a[236:239], a[140:143], v[236:239]
 ds_read_b128 a[140:143], v1 offset:37888
 ds_read_b128 v[8:11], v4 offset:128
 v_mfma_f32_16x16x32_bf16 v[232:235], a[236:239], a[132:135], v[232:235]
 ds_read_b128 a[132:135], v1 offset:33792
 v_add_f32 v49, v49, v13
 v_mfma_f32_16x16x32_bf16 v[232:235], a[232:235], a[128:131], v[232:235]
 ds_read_b128 a[128:131], v1 offset:32768
 v_add_f32 v50, v50, v14
 s_waitcnt vmcnt(8) lgkmcnt(9)
 v_mfma_f32_16x16x32_bf16 v[164:167], a[192:195], a[184:187], v[164:167]
 v_add_f32 v51, v51, v15
 v_add_f32 v52, v52, v12
 v_mfma_f32_16x16x32_bf16 v[164:167], a[196:199], a[188:191], v[164:167]
 global_load_dwordx4 a[236:239], v0, s[70:71] offset:-1024 sc1
 v_add_f32 v53, v53, v13
 v_mfma_f32_16x16x32_bf16 v[160:163], a[196:199], a[180:183], v[160:163]
 v_add_f32 v54, v54, v14
 v_mfma_f32_16x16x32_bf16 v[160:163], a[192:195], a[176:179], v[160:163]
 global_load_dwordx4 a[232:235], v0, s[70:71] offset:-2048 sc1
 v_add_f32 v55, v55, v15
 v_mfma_f32_16x16x32_bf16 v[156:159], a[192:195], a[168:171], v[156:159]
 v_add_f32 v56, v56, v12
 v_mfma_f32_16x16x32_bf16 v[156:159], a[196:199], a[172:175], v[156:159]
 v_add_f32 v57, v57, v13
 v_mfma_f32_16x16x32_bf16 v[152:155], a[196:199], a[164:167], v[152:155]
 v_add_f32 v58, v58, v14
 v_mfma_f32_16x16x32_bf16 v[152:155], a[192:195], a[160:163], v[152:155]
 v_add_f32 v59, v59, v15
 s_waitcnt lgkmcnt(0)
 v_mfma_f32_16x16x32_bf16 v[148:151], a[192:195], a[152:155], v[148:151]
 v_add_f32 v60, v60, v12
 v_mfma_f32_16x16x32_bf16 v[148:151], a[196:199], a[156:159], v[148:151]
 v_add_f32 v61, v61, v13
 v_mfma_f32_16x16x32_bf16 v[144:147], a[196:199], a[148:151], v[144:147]
 v_add_f32 v62, v62, v14
 v_mfma_f32_16x16x32_bf16 v[144:147], a[192:195], a[144:147], v[144:147]
 v_add_f32 v63, v63, v15
 v_mfma_f32_16x16x32_bf16 v[140:143], a[192:195], a[136:139], v[140:143]
 v_add_f32 v64, v64, v12
 v_mfma_f32_16x16x32_bf16 v[140:143], a[196:199], a[140:143], v[140:143]
 v_add_f32 v65, v65, v13
 v_mfma_f32_16x16x32_bf16 v[136:139], a[196:199], a[132:135], v[136:139]
 v_add_f32 v66, v66, v14
 v_mfma_f32_16x16x32_bf16 v[136:139], a[192:195], a[128:131], v[136:139]
 v_add_f32 v67, v67, v15
 s_waitcnt vmcnt(8)
 v_mfma_f32_16x16x32_bf16 v[168:171], a[200:203], a[128:131], v[168:171]
 v_add_f32 v68, v68, v12
 v_mfma_f32_16x16x32_bf16 v[168:171], a[204:207], a[132:135], v[168:171]
 global_load_dwordx4 a[196:199], v0, s[70:71] offset:1024 sc1
 v_add_f32 v69, v69, v13
 v_mfma_f32_16x16x32_bf16 v[172:175], a[204:207], a[140:143], v[172:175]
 v_add_f32 v70, v70, v14
 v_add_f32 v71, v71, v15
 v_mfma_f32_16x16x32_bf16 v[172:175], a[200:203], a[136:139], v[172:175]
 global_load_dwordx4 a[192:195], v0, s[70:71] offset:0 sc1
 v_add_f32 v72, v72, v12
 v_mfma_f32_16x16x32_bf16 v[176:179], a[200:203], a[144:147], v[176:179]
 v_add_f32 v73, v73, v13
 v_mfma_f32_16x16x32_bf16 v[176:179], a[204:207], a[148:151], v[176:179]
 v_add_f32 v74, v74, v14
 v_mfma_f32_16x16x32_bf16 v[180:183], a[204:207], a[156:159], v[180:183]
 v_add_f32 v75, v75, v15
 v_mfma_f32_16x16x32_bf16 v[180:183], a[200:203], a[152:155], v[180:183]
 v_add_f32 v76, v76, v12
 v_mfma_f32_16x16x32_bf16 v[184:187], a[200:203], a[160:163], v[184:187]
 v_add_f32 v77, v77, v13
 v_mfma_f32_16x16x32_bf16 v[184:187], a[204:207], a[164:167], v[184:187]
 v_add_f32 v78, v78, v14
 v_mfma_f32_16x16x32_bf16 v[188:191], a[204:207], a[172:175], v[188:191]
 v_add_f32 v79, v79, v15
 v_mfma_f32_16x16x32_bf16 v[188:191], a[200:203], a[168:171], v[188:191]
 v_mfma_f32_16x16x32_bf16 v[192:195], a[200:203], a[176:179], v[192:195]
 v_add_f32 v80, v80, v8
 v_mfma_f32_16x16x32_bf16 v[192:195], a[204:207], a[180:183], v[192:195]
 ds_read_b128 v[12:15], v4 offset:144
 v_mfma_f32_16x16x32_bf16 v[196:199], a[204:207], a[188:191], v[196:199]
 v_add_f32 v81, v81, v9
 v_mfma_f32_16x16x32_bf16 v[196:199], a[200:203], a[184:187], v[196:199]
 v_add_f32 v82, v82, v10
 s_waitcnt vmcnt(8)
 v_mfma_f32_16x16x32_bf16 v[228:231], a[208:211], a[184:187], v[228:231]
 v_add_f32 v83, v83, v11
 v_mfma_f32_16x16x32_bf16 v[228:231], a[212:215], a[188:191], v[228:231]
 global_load_dwordx4 a[204:207], v0, s[70:71] offset:3072 sc1
 v_add_f32 v84, v84, v8
 v_mfma_f32_16x16x32_bf16 v[224:227], a[212:215], a[180:183], v[224:227]
 v_add_f32 v85, v85, v9
 v_mfma_f32_16x16x32_bf16 v[224:227], a[208:211], a[176:179], v[224:227]
 global_load_dwordx4 a[200:203], v0, s[70:71] offset:2048 sc1
 v_add_f32 v86, v86, v10
 v_mfma_f32_16x16x32_bf16 v[220:223], a[208:211], a[168:171], v[220:223]
 v_add_f32 v87, v87, v11
 s_add_u32 s70, s70, 8192
 s_addc_u32 s71, s71, 0
 v_mfma_f32_16x16x32_bf16 v[220:223], a[212:215], a[172:175], v[220:223]
 v_add_f32 v88, v88, v8
 v_add_f32 v89, v89, v9
 v_mfma_f32_16x16x32_bf16 v[216:219], a[212:215], a[164:167], v[216:219]
 v_add_f32 v90, v90, v10
 v_mfma_f32_16x16x32_bf16 v[216:219], a[208:211], a[160:163], v[216:219]
 v_add_f32 v91, v91, v11
 v_mfma_f32_16x16x32_bf16 v[212:215], a[208:211], a[152:155], v[212:215]
 v_add_f32 v92, v92, v8
 v_mfma_f32_16x16x32_bf16 v[212:215], a[212:215], a[156:159], v[212:215]
 v_add_f32 v93, v93, v9
 v_mfma_f32_16x16x32_bf16 v[208:211], a[212:215], a[148:151], v[208:211]
 v_add_f32 v94, v94, v10
 v_mfma_f32_16x16x32_bf16 v[208:211], a[208:211], a[144:147], v[208:211]
 v_add_f32 v95, v95, v11
 v_mfma_f32_16x16x32_bf16 v[204:207], a[208:211], a[136:139], v[204:207]
 v_add_f32 v96, v96, v8
 v_mfma_f32_16x16x32_bf16 v[204:207], a[212:215], a[140:143], v[204:207]
 v_add_f32 v97, v97, v9
 v_mfma_f32_16x16x32_bf16 v[200:203], a[212:215], a[132:135], v[200:203]
 v_add_f32 v98, v98, v10
 v_add_f32 v99, v99, v11
 v_mfma_f32_16x16x32_bf16 v[200:203], a[208:211], a[128:131], v[200:203]
 v_add_f32 v100, v100, v8
 v_add_f32 v101, v101, v9
 s_waitcnt vmcnt(8)
 v_mfma_f32_16x16x32_bf16 v[232:235], a[216:219], a[128:131], v[232:235]
 ds_read_b128 a[128:131], v1
 v_add_f32 v102, v102, v10
 v_mfma_f32_16x16x32_bf16 v[232:235], a[220:223], a[132:135], v[232:235]
 global_load_dwordx4 a[212:215], v0, s[70:71] offset:-3072 sc1
 ds_read_b128 a[132:135], v1 offset:1024
 v_mfma_f32_16x16x32_bf16 v[236:239], a[220:223], a[140:143], v[236:239]
 ds_read_b128 a[140:143], v1 offset:5120
 v_add_f32 v103, v103, v11
 v_mfma_f32_16x16x32_bf16 v[236:239], a[216:219], a[136:139], v[236:239]
 global_load_dwordx4 a[208:211], v0, s[70:71] offset:-4096 sc1
 ds_read_b128 a[136:139], v1 offset:4096
 v_mfma_f32_16x16x32_bf16 v[240:243], a[216:219], a[144:147], v[240:243]
 ds_read_b128 a[144:147], v1 offset:8192
 v_add_f32 v104, v104, v8
 v_mfma_f32_16x16x32_bf16 v[240:243], a[220:223], a[148:151], v[240:243]
 ds_read_b128 a[148:151], v1 offset:9216
 v_add_f32 v105, v105, v9
 v_mfma_f32_16x16x32_bf16 v[244:247], a[220:223], a[156:159], v[244:247]
 ds_read_b128 a[156:159], v1 offset:13312
 v_add_f32 v106, v106, v10
 v_mfma_f32_16x16x32_bf16 v[244:247], a[216:219], a[152:155], v[244:247]
 ds_read_b128 a[152:155], v1 offset:12288
 v_add_f32 v107, v107, v11
 v_mfma_f32_16x16x32_bf16 v[248:251], a[216:219], a[160:163], v[248:251]
 ds_read_b128 a[160:163], v1 offset:16384
 v_add_f32 v108, v108, v8
 v_mfma_f32_16x16x32_bf16 v[248:251], a[220:223], a[164:167], v[248:251]
 ds_read_b128 a[164:167], v1 offset:17408
 v_add_f32 v109, v109, v9
 v_mfma_f32_16x16x32_bf16 v[252:255], a[220:223], a[172:175], v[252:255]
 ds_read_b128 a[172:175], v1 offset:21504
 v_add_f32 v110, v110, v10
 v_mfma_f32_16x16x32_bf16 v[252:255], a[216:219], a[168:171], v[252:255]
 ds_read_b128 a[168:171], v1 offset:20480
 v_add_f32 v111, v111, v11
 s_waitcnt lgkmcnt(12)
 v_mfma_f32_16x16x32_bf16 a[248:251], a[216:219], a[176:179], a[248:251]
 ds_read_b128 a[176:179], v1 offset:24576
 v_add_f32 v112, v112, v12
 v_mfma_f32_16x16x32_bf16 a[248:251], a[220:223], a[180:183], a[248:251]
 ds_read_b128 a[180:183], v1 offset:25600
 v_add_f32 v113, v113, v13
 v_mfma_f32_16x16x32_bf16 a[252:255], a[220:223], a[188:191], a[252:255]
 ds_read_b128 a[188:191], v1 offset:29696
 v_add_f32 v114, v114, v14
 v_mfma_f32_16x16x32_bf16 a[252:255], a[216:219], a[184:187], a[252:255]
 ds_read_b128 a[184:187], v1 offset:28672
 v_add_f32 v115, v115, v15
 s_waitcnt vmcnt(8) lgkmcnt(8)
 v_mfma_f32_16x16x32_bf16 v[136:139], a[224:227], a[128:131], v[136:139]
 v_add_f32 v116, v116, v12
 v_mfma_f32_16x16x32_bf16 v[136:139], a[228:231], a[132:135], v[136:139]
 global_load_dwordx4 a[220:223], v0, s[70:71] offset:-1024 sc1
 v_add_f32 v117, v117, v13
 v_mfma_f32_16x16x32_bf16 v[140:143], a[228:231], a[140:143], v[140:143]
 v_add_f32 v118, v118, v14
 v_mfma_f32_16x16x32_bf16 v[140:143], a[224:227], a[136:139], v[140:143]
 global_load_dwordx4 a[216:219], v0, s[70:71] offset:-2048 sc1
 v_add_f32 v119, v119, v15
 v_mfma_f32_16x16x32_bf16 v[144:147], a[224:227], a[144:147], v[144:147]
 v_add_f32 v120, v120, v12
 v_mfma_f32_16x16x32_bf16 v[144:147], a[228:231], a[148:151], v[144:147]
 v_add_f32 v121, v121, v13
 v_mfma_f32_16x16x32_bf16 v[148:151], a[228:231], a[156:159], v[148:151]
 v_add_f32 v122, v122, v14
 v_mfma_f32_16x16x32_bf16 v[148:151], a[224:227], a[152:155], v[148:151]
 v_add_f32 v123, v123, v15
 s_waitcnt lgkmcnt(0)
 v_mfma_f32_16x16x32_bf16 v[152:155], a[224:227], a[160:163], v[152:155]
 v_add_f32 v124, v124, v12
 v_mfma_f32_16x16x32_bf16 v[152:155], a[228:231], a[164:167], v[152:155]
 v_add_f32 v125, v125, v13
 v_mfma_f32_16x16x32_bf16 v[156:159], a[228:231], a[172:175], v[156:159]
 v_add_f32 v126, v126, v14
 v_mfma_f32_16x16x32_bf16 v[156:159], a[224:227], a[168:171], v[156:159]
 v_add_f32 v127, v127, v15
 v_mfma_f32_16x16x32_bf16 v[160:163], a[224:227], a[176:179], v[160:163]
 v_add_f32 v128, v128, v12
 v_add_f32 v129, v129, v13
 v_mfma_f32_16x16x32_bf16 v[160:163], a[228:231], a[180:183], v[160:163]
 v_add_f32 v130, v130, v14
 v_mfma_f32_16x16x32_bf16 v[164:167], a[228:231], a[188:191], v[164:167]
 v_add_f32 v131, v131, v15
 v_mfma_f32_16x16x32_bf16 v[164:167], a[224:227], a[184:187], v[164:167]
 v_add_f32 v132, v132, v12
 s_waitcnt vmcnt(8)
 v_mfma_f32_16x16x32_bf16 v[196:199], a[232:235], a[184:187], v[196:199]
 v_add_f32 v133, v133, v13
 v_mfma_f32_16x16x32_bf16 v[196:199], a[236:239], a[188:191], v[196:199]
 global_load_dwordx4 a[228:231], v0, s[70:71] offset:1024 sc1
 v_add_f32 v134, v134, v14
 v_mfma_f32_16x16x32_bf16 v[192:195], a[236:239], a[180:183], v[192:195]
 v_add_f32 v135, v135, v15
 v_mfma_f32_16x16x32_bf16 v[192:195], a[232:235], a[176:179], v[192:195]
 global_load_dwordx4 a[224:227], v0, s[70:71] offset:0 sc1
 v_accvgpr_read_b32 v5, a240
 v_mfma_f32_16x16x32_bf16 v[188:191], a[232:235], a[168:171], v[188:191]
 v_add_f32 v5, v5, v12
 v_mfma_f32_16x16x32_bf16 v[188:191], a[236:239], a[172:175], v[188:191]
 v_accvgpr_write_b32 a240, v5
 v_mfma_f32_16x16x32_bf16 v[184:187], a[236:239], a[164:167], v[184:187]
 v_accvgpr_read_b32 v6, a241
 v_mfma_f32_16x16x32_bf16 v[184:187], a[232:235], a[160:163], v[184:187]
 v_add_f32 v6, v6, v13
 v_mfma_f32_16x16x32_bf16 v[180:183], a[232:235], a[152:155], v[180:183]
 v_accvgpr_write_b32 a241, v6
 v_mfma_f32_16x16x32_bf16 v[180:183], a[236:239], a[156:159], v[180:183]
 v_accvgpr_read_b32 v5, a242
 v_mfma_f32_16x16x32_bf16 v[176:179], a[236:239], a[148:151], v[176:179]
 v_add_f32 v5, v5, v14
 v_mfma_f32_16x16x32_bf16 v[176:179], a[232:235], a[144:147], v[176:179]
 v_accvgpr_write_b32 a242, v5
 v_mfma_f32_16x16x32_bf16 v[172:175], a[232:235], a[136:139], v[172:175]
 v_accvgpr_read_b32 v6, a243
 v_mfma_f32_16x16x32_bf16 v[172:175], a[236:239], a[140:143], v[172:175]
 v_add_f32 v6, v6, v15
 v_mfma_f32_16x16x32_bf16 v[168:171], a[236:239], a[132:135], v[168:171]
 v_accvgpr_write_b32 a243, v6
 v_mfma_f32_16x16x32_bf16 v[168:171], a[232:235], a[128:131], v[168:171]
 v_accvgpr_read_b32 v5, a244
 s_waitcnt vmcnt(8)
 v_mfma_f32_16x16x32_bf16 v[200:203], a[192:195], a[128:131], v[200:203]
 v_add_f32 v5, v5, v12
 v_accvgpr_write_b32 a244, v5
 v_mfma_f32_16x16x32_bf16 v[200:203], a[196:199], a[132:135], v[200:203]
 global_load_dwordx4 a[236:239], v0, s[70:71] offset:3072 sc1
 v_accvgpr_read_b32 v6, a245
 v_mfma_f32_16x16x32_bf16 v[204:207], a[196:199], a[140:143], v[204:207]
 v_add_f32 v6, v6, v13
 v_mfma_f32_16x16x32_bf16 v[204:207], a[192:195], a[136:139], v[204:207]
 global_load_dwordx4 a[232:235], v0, s[70:71] offset:2048 sc1
 v_accvgpr_write_b32 a245, v6
 v_mfma_f32_16x16x32_bf16 v[208:211], a[192:195], a[144:147], v[208:211]
 v_accvgpr_read_b32 v5, a246
 s_add_u32 s70, s70, 8192
 s_addc_u32 s71, s71, 0
 v_mfma_f32_16x16x32_bf16 v[208:211], a[196:199], a[148:151], v[208:211]
 v_add_f32 v5, v5, v14
 v_mfma_f32_16x16x32_bf16 v[212:215], a[196:199], a[156:159], v[212:215]
 v_accvgpr_write_b32 a246, v5
 v_mfma_f32_16x16x32_bf16 v[212:215], a[192:195], a[152:155], v[212:215]
 v_accvgpr_read_b32 v6, a247
 v_mfma_f32_16x16x32_bf16 v[216:219], a[192:195], a[160:163], v[216:219]
 v_add_f32 v6, v6, v15
 v_mfma_f32_16x16x32_bf16 v[216:219], a[196:199], a[164:167], v[216:219]
 v_accvgpr_write_b32 a247, v6
 v_mfma_f32_16x16x32_bf16 v[220:223], a[196:199], a[172:175], v[220:223]
 s_add_u32 s55, s55, 1
 s_waitcnt lgkmcnt(0)
 s_barrier
 v_mfma_f32_16x16x32_bf16 v[220:223], a[192:195], a[168:171], v[220:223]
 v_mfma_f32_16x16x32_bf16 v[224:227], a[192:195], a[176:179], v[224:227]
 v_mfma_f32_16x16x32_bf16 v[224:227], a[196:199], a[180:183], v[224:227]
 v_mfma_f32_16x16x32_bf16 v[228:231], a[196:199], a[188:191], v[228:231]
 v_mfma_f32_16x16x32_bf16 v[228:231], a[192:195], a[184:187], v[228:231]
 s_waitcnt vmcnt(8)
 v_mfma_f32_16x16x32_bf16 a[252:255], a[200:203], a[184:187], a[252:255]
 ds_read_b128 a[184:187], v1 offset:30720
 v_mfma_f32_16x16x32_bf16 a[252:255], a[204:207], a[188:191], a[252:255]
 global_load_dwordx4 a[196:199], v0, s[70:71] offset:-3072 sc1
 ds_read_b128 a[188:191], v1 offset:31744
 v_mfma_f32_16x16x32_bf16 a[248:251], a[204:207], a[180:183], a[248:251]
 ds_read_b128 a[180:183], v1 offset:27648
 v_mfma_f32_16x16x32_bf16 a[248:251], a[200:203], a[176:179], a[248:251]
 global_load_dwordx4 a[192:195], v0, s[70:71] offset:-4096 sc1
 ds_read_b128 a[176:179], v1 offset:26624
 v_mfma_f32_16x16x32_bf16 v[252:255], a[200:203], a[168:171], v[252:255]
 ds_read_b128 a[168:171], v1 offset:22528
 v_mfma_f32_16x16x32_bf16 v[252:255], a[204:207], a[172:175], v[252:255]
 ds_read_b128 a[172:175], v1 offset:23552
 v_mfma_f32_16x16x32_bf16 v[248:251], a[204:207], a[164:167], v[248:251]
 ds_read_b128 a[164:167], v1 offset:19456
 v_mfma_f32_16x16x32_bf16 v[248:251], a[200:203], a[160:163], v[248:251]
 ds_read_b128 a[160:163], v1 offset:18432
 v_mfma_f32_16x16x32_bf16 v[244:247], a[200:203], a[152:155], v[244:247]
 ds_read_b128 a[152:155], v1 offset:14336
 v_mfma_f32_16x16x32_bf16 v[244:247], a[204:207], a[156:159], v[244:247]
 ds_read_b128 a[156:159], v1 offset:15360
 v_mfma_f32_16x16x32_bf16 v[240:243], a[204:207], a[148:151], v[240:243]
 ds_read_b128 a[148:151], v1 offset:11264
 v_mfma_f32_16x16x32_bf16 v[240:243], a[200:203], a[144:147], v[240:243]
 ds_read_b128 a[144:147], v1 offset:10240
 v_mfma_f32_16x16x32_bf16 v[236:239], a[200:203], a[136:139], v[236:239]
 ds_read_b128 a[136:139], v1 offset:6144
 v_mfma_f32_16x16x32_bf16 v[236:239], a[204:207], a[140:143], v[236:239]
 ds_read_b128 a[140:143], v1 offset:7168
 v_mfma_f32_16x16x32_bf16 v[232:235], a[204:207], a[132:135], v[232:235]
 global_load_dwordx4 a[204:207], v0, s[70:71] offset:-1024 sc1
 ds_read_b128 a[132:135], v1 offset:3072
 v_mfma_f32_16x16x32_bf16 v[232:235], a[200:203], a[128:131], v[232:235]
 global_load_dwordx4 a[200:203], v0, s[70:71] offset:-2048 sc1
 ds_read_b128 a[128:131], v1 offset:2048
 s_waitcnt vmcnt(10) lgkmcnt(8)
Lloop:
 v_mfma_f32_16x16x32_bf16 v[44:47], a[208:211], a[184:187], v[44:47]
 v_mfma_f32_16x16x32_bf16 v[44:47], a[212:215], a[188:191], v[44:47]
 v_mov_b32 v6, v3
 s_cmp_eq_u32 s25, 0
 s_cbranch_scc1 Lgat0
Lgatr0:
 v_mfma_f32_16x16x32_bf16 v[40:43], a[212:215], a[180:183], v[40:43]
 v_mfma_f32_16x16x32_bf16 v[40:43], a[208:211], a[176:179], v[40:43]
 ds_read_b128 v[12:15], v3 offset:26624
 v_mfma_f32_16x16x32_bf16 v[36:39], a[208:211], a[168:171], v[36:39]
 s_add_u32 m0, s50, 0
 v_mfma_f32_16x16x32_bf16 v[36:39], a[212:215], a[172:175], v[36:39]
 v_mfma_f32_16x16x32_bf16 v[32:35], a[212:215], a[164:167], v[32:35]
 v_mfma_f32_16x16x32_bf16 v[32:35], a[208:211], a[160:163], v[32:35]
 s_waitcnt lgkmcnt(1)
 v_mfma_f32_16x16x32_bf16 v[28:31], a[208:211], a[152:155], v[28:31]
 v_mfma_f32_16x16x32_bf16 v[28:31], a[212:215], a[156:159], v[28:31]
 v_mfma_f32_16x16x32_bf16 v[24:27], a[212:215], a[148:151], v[24:27]
 v_mfma_f32_16x16x32_bf16 v[24:27], a[208:211], a[144:147], v[24:27]
 buffer_load_dwordx4 v6, s[8:11], s30 offen lds
 v_mfma_f32_16x16x32_bf16 v[20:23], a[208:211], a[136:139], v[20:23]
 v_mfma_f32_16x16x32_bf16 v[20:23], a[212:215], a[140:143], v[20:23]
 v_mfma_f32_16x16x32_bf16 v[16:19], a[212:215], a[132:135], v[16:19]
 s_add_u32 m0, m0, 1024
 v_mfma_f32_16x16x32_bf16 v[16:19], a[208:211], a[128:131], v[16:19]
 s_waitcnt vmcnt(9)
 v_mfma_f32_16x16x32_bf16 v[48:51], a[216:219], a[128:131], v[48:51]
 v_mfma_f32_16x16x32_bf16 v[48:51], a[220:223], a[132:135], v[48:51]
 global_load_dwordx4 a[212:215], v0, s[70:71] offset:1024 sc1
 s_add_u32 s30, s30, s20
 v_mfma_f32_16x16x32_bf16 v[52:55], a[220:223], a[140:143], v[52:55]
 v_mfma_f32_16x16x32_bf16 v[52:55], a[216:219], a[136:139], v[52:55]
 global_load_dwordx4 a[208:211], v0, s[70:71] offset:0 sc1
 v_mfma_f32_16x16x32_bf16 v[56:59], a[216:219], a[144:147], v[56:59]
 buffer_load_dwordx4 v6, s[8:11], s30 offen lds
 s_waitcnt lgkmcnt(0)
 v_mfma_f32_16x16x32_bf16 v[56:59], a[220:223], a[148:151], v[56:59]
 v_mfma_f32_16x16x32_bf16 v[60:63], a[220:223], a[156:159], v[60:63]
 s_add_u32 s69, s29, 28672
 v_mfma_f32_16x16x32_bf16 v[60:63], a[216:219], a[152:155], v[60:63]
 v_mfma_f32_16x16x32_bf16 v[64:67], a[216:219], a[160:163], v[64:67]
 s_add_u32 m0, m0, 3072
 v_mfma_f32_16x16x32_bf16 v[64:67], a[220:223], a[164:167], v[64:67]
 buffer_store_dwordx4 v[12:15], v3, s[32:35], s69 offen sc1
 v_mfma_f32_16x16x32_bf16 v[68:71], a[220:223], a[172:175], v[68:71]
 v_mfma_f32_16x16x32_bf16 v[68:71], a[216:219], a[168:171], v[68:71]
 s_add_u32 s30, s30, s21
 v_mfma_f32_16x16x32_bf16 v[72:75], a[216:219], a[176:179], v[72:75]
 v_mfma_f32_16x16x32_bf16 v[72:75], a[220:223], a[180:183], v[72:75]
 v_mfma_f32_16x16x32_bf16 v[76:79], a[220:223], a[188:191], v[76:79]
 v_mfma_f32_16x16x32_bf16 v[76:79], a[216:219], a[184:187], v[76:79]
 ds_read_b128 v[12:15], v3 offset:27648
 s_waitcnt vmcnt(11)
 v_mfma_f32_16x16x32_bf16 v[108:111], a[224:227], a[184:187], v[108:111]
 v_mfma_f32_16x16x32_bf16 v[108:111], a[228:231], a[188:191], v[108:111]
 global_load_dwordx4 a[220:223], v0, s[70:71] offset:3072 sc1
 v_mfma_f32_16x16x32_bf16 v[104:107], a[228:231], a[180:183], v[104:107]
 v_mfma_f32_16x16x32_bf16 v[104:107], a[224:227], a[176:179], v[104:107]
 global_load_dwordx4 a[216:219], v0, s[70:71] offset:2048 sc1
 v_mfma_f32_16x16x32_bf16 v[100:103], a[224:227], a[168:171], v[100:103]
 s_add_u32 s70, s70, 8192
 s_addc_u32 s71, s71, 0
 v_mfma_f32_16x16x32_bf16 v[100:103], a[228:231], a[172:175], v[100:103]
 v_mfma_f32_16x16x32_bf16 v[96:99], a[228:231], a[164:167], v[96:99]
 v_mfma_f32_16x16x32_bf16 v[96:99], a[224:227], a[160:163], v[96:99]
 v_mfma_f32_16x16x32_bf16 v[92:95], a[224:227], a[152:155], v[92:95]
 v_mfma_f32_16x16x32_bf16 v[92:95], a[228:231], a[156:159], v[92:95]
 v_mfma_f32_16x16x32_bf16 v[88:91], a[228:231], a[148:151], v[88:91]
 v_mfma_f32_16x16x32_bf16 v[88:91], a[224:227], a[144:147], v[88:91]
 v_mfma_f32_16x16x32_bf16 v[84:87], a[224:227], a[136:139], v[84:87]
 v_mfma_f32_16x16x32_bf16 v[84:87], a[228:231], a[140:143], v[84:87]
 v_mfma_f32_16x16x32_bf16 v[80:83], a[228:231], a[132:135], v[80:83]
 v_mfma_f32_16x16x32_bf16 v[80:83], a[224:227], a[128:131], v[80:83]
 s_waitcnt vmcnt(11)
 v_mfma_f32_16x16x32_bf16 v[112:115], a[232:235], a[128:131], v[112:115]
 v_mfma_f32_16x16x32_bf16 v[112:115], a[236:239], a[132:135], v[112:115]
 global_load_dwordx4 a[228:231], v0, s[70:71] offset:-3072 sc1
 s_waitcnt lgkmcnt(0)
 v_mfma_f32_16x16x32_bf16 v[116:119], a[236:239], a[140:143], v[116:119]
 v_mfma_f32_16x16x32_bf16 v[116:119], a[232:235], a[136:139], v[116:119]
 global_load_dwordx4 a[224:227], v0, s[70:71] offset:-4096 sc1
 v_mfma_f32_16x16x32_bf16 v[120:123], a[232:235], a[144:147], v[120:123]
 buffer_store_dwordx4 v[12:15], v3, s[32:35], s69 offen offset:1024 sc1
 v_mfma_f32_16x16x32_bf16 v[120:123], a[236:239], a[148:151], v[120:123]
 v_mfma_f32_16x16x32_bf16 v[124:127], a[236:239], a[156:159], v[124:127]
 v_mfma_f32_16x16x32_bf16 v[124:127], a[232:235], a[152:155], v[124:127]
 v_mfma_f32_16x16x32_bf16 v[128:131], a[232:235], a[160:163], v[128:131]
 v_mfma_f32_16x16x32_bf16 v[128:131], a[236:239], a[164:167], v[128:131]
 v_mfma_f32_16x16x32_bf16 v[132:135], a[236:239], a[172:175], v[132:135]
 ds_read_b128 v[12:15], v3 offset:30720
 v_mfma_f32_16x16x32_bf16 v[132:135], a[232:235], a[168:171], v[132:135]
 v_mfma_f32_16x16x32_bf16 a[240:243], a[232:235], a[176:179], a[240:243]
 v_mfma_f32_16x16x32_bf16 a[240:243], a[236:239], a[180:183], a[240:243]
 v_mfma_f32_16x16x32_bf16 a[244:247], a[236:239], a[188:191], a[244:247]
 buffer_load_dwordx4 v6, s[8:11], s30 offen lds
 v_mfma_f32_16x16x32_bf16 a[244:247], a[232:235], a[184:187], a[244:247]
 s_waitcnt vmcnt(13)
 v_mfma_f32_16x16x32_bf16 v[164:167], a[192:195], a[184:187], v[164:167]
 v_mfma_f32_16x16x32_bf16 v[164:167], a[196:199], a[188:191], v[164:167]
 global_load_dwordx4 a[236:239], v0, s[70:71] offset:-1024 sc1
 v_mfma_f32_16x16x32_bf16 v[160:163], a[196:199], a[180:183], v[160:163]
 s_add_u32 m0, m0, 1024
 v_mfma_f32_16x16x32_bf16 v[160:163], a[192:195], a[176:179], v[160:163]
 global_load_dwordx4 a[232:235], v0, s[70:71] offset:-2048 sc1
 v_mfma_f32_16x16x32_bf16 v[156:159], a[192:195], a[168:171], v[156:159]
 v_mfma_f32_16x16x32_bf16 v[156:159], a[196:199], a[172:175], v[156:159]
 s_add_u32 s30, s30, s20
 v_mfma_f32_16x16x32_bf16 v[152:155], a[196:199], a[164:167], v[152:155]
 v_mfma_f32_16x16x32_bf16 v[152:155], a[192:195], a[160:163], v[152:155]
 v_mfma_f32_16x16x32_bf16 v[148:151], a[192:195], a[152:155], v[148:151]
 buffer_load_dwordx4 v6, s[8:11], s30 offen lds
 v_mfma_f32_16x16x32_bf16 v[148:151], a[196:199], a[156:159], v[148:151]
 v_mfma_f32_16x16x32_bf16 v[144:147], a[196:199], a[148:151], v[144:147]
 v_mfma_f32_16x16x32_bf16 v[144:147], a[192:195], a[144:147], v[144:147]
 s_add_u32 m0, m0, 3072
 s_waitcnt lgkmcnt(0)
 v_mfma_f32_16x16x32_bf16 v[140:143], a[192:195], a[136:139], v[140:143]
 v_mfma_f32_16x16x32_bf16 v[140:143], a[196:199], a[140:143], v[140:143]
 v_mfma_f32_16x16x32_bf16 v[136:139], a[196:199], a[132:135], v[136:139]
 s_add_u32 s30, s30, s21
 buffer_store_dwordx4 v[12:15], v3, s[32:35], s69 offen offset:2048 sc1
 v_mfma_f32_16x16x32_bf16 v[136:139], a[192:195], a[128:131], v[136:139]
 s_waitcnt vmcnt(15)
 v_mfma_f32_16x16x32_bf16 v[168:171], a[200:203], a[128:131], v[168:171]
 v_mfma_f32_16x16x32_bf16 v[168:171], a[204:207], a[132:135], v[168:171]
 global_load_dwordx4 a[196:199], v0, s[70:71] offset:1024 sc1
 v_mfma_f32_16x16x32_bf16 v[172:175], a[204:207], a[140:143], v[172:175]
 v_mfma_f32_16x16x32_bf16 v[172:175], a[200:203], a[136:139], v[172:175]
 global_load_dwordx4 a[192:195], v0, s[70:71] offset:0 sc1
 v_mfma_f32_16x16x32_bf16 v[176:179], a[200:203], a[144:147], v[176:179]
 ds_read_b128 v[12:15], v3 offset:31744
 v_mfma_f32_16x16x32_bf16 v[176:179], a[204:207], a[148:151], v[176:179]
 v_mfma_f32_16x16x32_bf16 v[180:183], a[204:207], a[156:159], v[180:183]
 v_mfma_f32_16x16x32_bf16 v[180:183], a[200:203], a[152:155], v[180:183]
 v_mfma_f32_16x16x32_bf16 v[184:187], a[200:203], a[160:163], v[184:187]
 v_mfma_f32_16x16x32_bf16 v[184:187], a[204:207], a[164:167], v[184:187]
 v_mfma_f32_16x16x32_bf16 v[188:191], a[204:207], a[172:175], v[188:191]
 v_mfma_f32_16x16x32_bf16 v[188:191], a[200:203], a[168:171], v[188:191]
 v_mfma_f32_16x16x32_bf16 v[192:195], a[200:203], a[176:179], v[192:195]
 v_mfma_f32_16x16x32_bf16 v[192:195], a[204:207], a[180:183], v[192:195]
 v_mfma_f32_16x16x32_bf16 v[196:199], a[204:207], a[188:191], v[196:199]
 v_mfma_f32_16x16x32_bf16 v[196:199], a[200:203], a[184:187], v[196:199]
 s_waitcnt vmcnt(14)
 v_mfma_f32_16x16x32_bf16 v[228:231], a[208:211], a[184:187], v[228:231]
 v_mfma_f32_16x16x32_bf16 v[228:231], a[212:215], a[188:191], v[228:231]
 global_load_dwordx4 a[204:207], v0, s[70:71] offset:3072 sc1
 v_mfma_f32_16x16x32_bf16 v[224:227], a[212:215], a[180:183], v[224:227]
 v_mfma_f32_16x16x32_bf16 v[224:227], a[208:211], a[176:179], v[224:227]
 global_load_dwordx4 a[200:203], v0, s[70:71] offset:2048 sc1
 v_mfma_f32_16x16x32_bf16 v[220:223], a[208:211], a[168:171], v[220:223]
 s_add_u32 s70, s70, 8192
 s_addc_u32 s71, s71, 0
 v_mfma_f32_16x16x32_bf16 v[220:223], a[212:215], a[172:175], v[220:223]
 v_mfma_f32_16x16x32_bf16 v[216:219], a[212:215], a[164:167], v[216:219]
 s_waitcnt lgkmcnt(0)
 v_mfma_f32_16x16x32_bf16 v[216:219], a[208:211], a[160:163], v[216:219]
 v_mfma_f32_16x16x32_bf16 v[212:215], a[208:211], a[152:155], v[212:215]
 buffer_store_dwordx4 v[12:15], v3, s[32:35], s69 offen offset:3072 sc1
 v_mfma_f32_16x16x32_bf16 v[212:215], a[212:215], a[156:159], v[212:215]
 v_mfma_f32_16x16x32_bf16 v[208:211], a[212:215], a[148:151], v[208:211]
 v_mfma_f32_16x16x32_bf16 v[208:211], a[208:211], a[144:147], v[208:211]
 v_mfma_f32_16x16x32_bf16 v[204:207], a[208:211], a[136:139], v[204:207]
 v_mfma_f32_16x16x32_bf16 v[204:207], a[212:215], a[140:143], v[204:207]
 v_mfma_f32_16x16x32_bf16 v[200:203], a[212:215], a[132:135], v[200:203]
 v_mfma_f32_16x16x32_bf16 v[200:203], a[208:211], a[128:131], v[200:203]
 buffer_load_dwordx4 v6, s[8:11], s30 offen lds
 s_waitcnt vmcnt(14)
 v_mfma_f32_16x16x32_bf16 v[232:235], a[216:219], a[128:131], v[232:235]
 ds_read_b128 a[128:131], v1 offset:34816
 v_mfma_f32_16x16x32_bf16 v[232:235], a[220:223], a[132:135], v[232:235]
 global_load_dwordx4 a[212:215], v0, s[70:71] offset:-3072 sc1
 ds_read_b128 a[132:135], v1 offset:35840
 v_mfma_f32_16x16x32_bf16 v[236:239], a[220:223], a[140:143], v[236:239]
 ds_read_b128 a[140:143], v1 offset:39936
 v_mfma_f32_16x16x32_bf16 v[236:239], a[216:219], a[136:139], v[236:239]
 global_load_dwordx4 a[208:211], v0, s[70:71] offset:-4096 sc1
 ds_read_b128 a[136:139], v1 offset:38912
 v_mfma_f32_16x16x32_bf16 v[240:243], a[216:219], a[144:147], v[240:243]
 ds_read_b128 a[144:147], v1 offset:43008
 v_mfma_f32_16x16x32_bf16 v[240:243], a[220:223], a[148:151], v[240:243]
 ds_read_b128 a[148:151], v1 offset:44032
 s_add_u32 m0, m0, 1024
 v_mfma_f32_16x16x32_bf16 v[244:247], a[220:223], a[156:159], v[244:247]
 ds_read_b128 a[156:159], v1 offset:48128
 v_mfma_f32_16x16x32_bf16 v[244:247], a[216:219], a[152:155], v[244:247]
 ds_read_b128 a[152:155], v1 offset:47104
 v_mfma_f32_16x16x32_bf16 v[248:251], a[216:219], a[160:163], v[248:251]
 ds_read_b128 a[160:163], v1 offset:51200
 s_add_u32 s30, s30, s20
 v_mfma_f32_16x16x32_bf16 v[248:251], a[220:223], a[164:167], v[248:251]
 ds_read_b128 a[164:167], v1 offset:52224
 v_mfma_f32_16x16x32_bf16 v[252:255], a[220:223], a[172:175], v[252:255]
 ds_read_b128 a[172:175], v1 offset:56320
 v_mfma_f32_16x16x32_bf16 v[252:255], a[216:219], a[168:171], v[252:255]
 ds_read_b128 a[168:171], v1 offset:55296
 v_mfma_f32_16x16x32_bf16 a[248:251], a[216:219], a[176:179], a[248:251]
 ds_read_b128 a[176:179], v1 offset:59392
 v_mfma_f32_16x16x32_bf16 a[248:251], a[220:223], a[180:183], a[248:251]
 ds_read_b128 a[180:183], v1 offset:60416
 v_mfma_f32_16x16x32_bf16 a[252:255], a[220:223], a[188:191], a[252:255]
 ds_read_b128 a[188:191], v1 offset:64512
 v_mfma_f32_16x16x32_bf16 a[252:255], a[216:219], a[184:187], a[252:255]
 ds_read_b128 a[184:187], v1 offset:63488
 s_waitcnt vmcnt(14) lgkmcnt(8)
 v_mfma_f32_16x16x32_bf16 v[16:19], a[224:227], a[128:131], v[16:19]
 buffer_load_dwordx4 v6, s[8:11], s30 offen lds
 s_add_u32 m0, m0, 3072
 v_mfma_f32_16x16x32_bf16 v[16:19], a[228:231], a[132:135], v[16:19]
 global_load_dwordx4 a[220:223], v0, s[70:71] offset:-1024 sc1
 v_mfma_f32_16x16x32_bf16 v[20:23], a[228:231], a[140:143], v[20:23]
 s_add_u32 s30, s30, s21
 v_mfma_f32_16x16x32_bf16 v[20:23], a[224:227], a[136:139], v[20:23]
 global_load_dwordx4 a[216:219], v0, s[70:71] offset:-2048 sc1
 v_mfma_f32_16x16x32_bf16 v[24:27], a[224:227], a[144:147], v[24:27]
 v_mfma_f32_16x16x32_bf16 v[24:27], a[228:231], a[148:151], v[24:27]
 v_mfma_f32_16x16x32_bf16 v[28:31], a[228:231], a[156:159], v[28:31]
 v_mfma_f32_16x16x32_bf16 v[28:31], a[224:227], a[152:155], v[28:31]
 s_waitcnt lgkmcnt(0)
 v_mfma_f32_16x16x32_bf16 v[32:35], a[224:227], a[160:163], v[32:35]
 v_mfma_f32_16x16x32_bf16 v[32:35], a[228:231], a[164:167], v[32:35]
 v_mfma_f32_16x16x32_bf16 v[36:39], a[228:231], a[172:175], v[36:39]
 v_mfma_f32_16x16x32_bf16 v[36:39], a[224:227], a[168:171], v[36:39]
 v_mfma_f32_16x16x32_bf16 v[40:43], a[224:227], a[176:179], v[40:43]
 v_mfma_f32_16x16x32_bf16 v[40:43], a[228:231], a[180:183], v[40:43]
 v_mfma_f32_16x16x32_bf16 v[44:47], a[228:231], a[188:191], v[44:47]
 v_mfma_f32_16x16x32_bf16 v[44:47], a[224:227], a[184:187], v[44:47]
 s_waitcnt vmcnt(13)
 v_mfma_f32_16x16x32_bf16 v[76:79], a[232:235], a[184:187], v[76:79]
 v_mfma_f32_16x16x32_bf16 v[76:79], a[236:239], a[188:191], v[76:79]
 global_load_dwordx4 a[228:231], v0, s[70:71] offset:1024 sc1
 v_mfma_f32_16x16x32_bf16 v[72:75], a[236:239], a[180:183], v[72:75]
 v_mfma_f32_16x16x32_bf16 v[72:75], a[232:235], a[176:179], v[72:75]
 global_load_dwordx4 a[224:227], v0, s[70:71] offset:0 sc1
 v_mfma_f32_16x16x32_bf16 v[68:71], a[232:235], a[168:171], v[68:71]
 v_mfma_f32_16x16x32_bf16 v[68:71], a[236:239], a[172:175], v[68:71]
 v_mfma_f32_16x16x32_bf16 v[64:67], a[236:239], a[164:167], v[64:67]
 s_add_u32 s31, s31, 1
 s_waitcnt vmcnt(8)
 v_mov_b32 v7, s31
 buffer_store_dword v7, v1, s[60:63], 0 offen sc1
 v_mfma_f32_16x16x32_bf16 v[64:67], a[232:235], a[160:163], v[64:67]
 s_add_u32 s29, s29, 0x2000000
 v_mfma_f32_16x16x32_bf16 v[60:63], a[232:235], a[152:155], v[60:63]
 v_mfma_f32_16x16x32_bf16 v[60:63], a[236:239], a[156:159], v[60:63]
 v_mfma_f32_16x16x32_bf16 v[56:59], a[236:239], a[148:151], v[56:59]
 v_mfma_f32_16x16x32_bf16 v[56:59], a[232:235], a[144:147], v[56:59]
 v_mfma_f32_16x16x32_bf16 v[52:55], a[232:235], a[136:139], v[52:55]
 v_mfma_f32_16x16x32_bf16 v[52:55], a[236:239], a[140:143], v[52:55]
 v_mfma_f32_16x16x32_bf16 v[48:51], a[236:239], a[132:135], v[48:51]
 v_mfma_f32_16x16x32_bf16 v[48:51], a[232:235], a[128:131], v[48:51]
 v_mfma_f32_16x16x32_bf16 v[80:83], a[192:195], a[128:131], v[80:83]
 v_mfma_f32_16x16x32_bf16 v[80:83], a[196:199], a[132:135], v[80:83]
 global_load_dwordx4 a[236:239], v0, s[70:71] offset:3072 sc1
 v_mfma_f32_16x16x32_bf16 v[84:87], a[196:199], a[140:143], v[84:87]
 v_mfma_f32_16x16x32_bf16 v[84:87], a[192:195], a[136:139], v[84:87]
 global_load_dwordx4 a[232:235], v0, s[70:71] offset:2048 sc1
 v_mfma_f32_16x16x32_bf16 v[88:91], a[192:195], a[144:147], v[88:91]
 s_add_u32 s70, s70, 8192
 s_addc_u32 s71, s71, 0
 v_mfma_f32_16x16x32_bf16 v[88:91], a[196:199], a[148:151], v[88:91]
 buffer_load_dwordx4 v6, s[8:11], s30 offen lds
 v_mfma_f32_16x16x32_bf16 v[92:95], a[196:199], a[156:159], v[92:95]
 v_mfma_f32_16x16x32_bf16 v[92:95], a[192:195], a[152:155], v[92:95]
 v_mfma_f32_16x16x32_bf16 v[96:99], a[192:195], a[160:163], v[96:99]
 v_mfma_f32_16x16x32_bf16 v[96:99], a[196:199], a[164:167], v[96:99]
 s_add_u32 m0, m0, 1024
 v_mfma_f32_16x16x32_bf16 v[100:103], a[196:199], a[172:175], v[100:103]
 v_mfma_f32_16x16x32_bf16 v[100:103], a[192:195], a[168:171], v[100:103]
 v_mfma_f32_16x16x32_bf16 v[104:107], a[192:195], a[176:179], v[104:107]
 s_add_u32 s30, s30, s20
 v_mfma_f32_16x16x32_bf16 v[104:107], a[196:199], a[180:183], v[104:107]
 v_mfma_f32_16x16x32_bf16 v[108:111], a[196:199], a[188:191], v[108:111]
 v_mfma_f32_16x16x32_bf16 v[108:111], a[192:195], a[184:187], v[108:111]
 buffer_load_dwordx4 v6, s[8:11], s30 offen lds
 v_mfma_f32_16x16x32_bf16 a[244:247], a[200:203], a[184:187], a[244:247]
 v_mfma_f32_16x16x32_bf16 a[244:247], a[204:207], a[188:191], a[244:247]
 global_load_dwordx4 a[196:199], v0, s[70:71] offset:-3072 sc1
 v_mfma_f32_16x16x32_bf16 a[240:243], a[204:207], a[180:183], a[240:243]
 s_add_u32 m0, m0, 3072
 v_mfma_f32_16x16x32_bf16 a[240:243], a[200:203], a[176:179], a[240:243]
 global_load_dwordx4 a[192:195], v0, s[70:71] offset:-4096 sc1
 v_mfma_f32_16x16x32_bf16 v[132:135], a[200:203], a[168:171], v[132:135]
 v_mfma_f32_16x16x32_bf16 v[132:135], a[204:207], a[172:175], v[132:135]
 v_mfma_f32_16x16x32_bf16 v[128:131], a[204:207], a[164:167], v[128:131]
 s_add_u32 s30, s30, s21
 v_mfma_f32_16x16x32_bf16 v[128:131], a[200:203], a[160:163], v[128:131]
 v_mfma_f32_16x16x32_bf16 v[124:127], a[200:203], a[152:155], v[124:127]
 v_mfma_f32_16x16x32_bf16 v[124:127], a[204:207], a[156:159], v[124:127]
 v_mfma_f32_16x16x32_bf16 v[120:123], a[204:207], a[148:151], v[120:123]
 v_mfma_f32_16x16x32_bf16 v[120:123], a[200:203], a[144:147], v[120:123]
 v_mfma_f32_16x16x32_bf16 v[116:119], a[200:203], a[136:139], v[116:119]
 v_mfma_f32_16x16x32_bf16 v[116:119], a[204:207], a[140:143], v[116:119]
 v_mfma_f32_16x16x32_bf16 v[112:115], a[204:207], a[132:135], v[112:115]
 v_mfma_f32_16x16x32_bf16 v[112:115], a[200:203], a[128:131], v[112:115]
 s_waitcnt vmcnt(12)
 v_mfma_f32_16x16x32_bf16 v[136:139], a[208:211], a[128:131], v[136:139]
 v_mfma_f32_16x16x32_bf16 v[136:139], a[212:215], a[132:135], v[136:139]
 global_load_dwordx4 a[204:207], v0, s[70:71] offset:-1024 sc1
 v_mfma_f32_16x16x32_bf16 v[140:143], a[212:215], a[140:143], v[140:143]
 v_mfma_f32_16x16x32_bf16 v[140:143], a[208:211], a[136:139], v[140:143]
 global_load_dwordx4 a[200:203], v0, s[70:71] offset:-2048 sc1
 v_mfma_f32_16x16x32_bf16 v[144:147], a[208:211], a[144:147], v[144:147]
 v_mfma_f32_16x16x32_bf16 v[144:147], a[212:215], a[148:151], v[144:147]
 v_mfma_f32_16x16x32_bf16 v[148:151], a[212:215], a[156:159], v[148:151]
 v_mfma_f32_16x16x32_bf16 v[148:151], a[208:211], a[152:155], v[148:151]
 v_mfma_f32_16x16x32_bf16 v[152:155], a[208:211], a[160:163], v[152:155]
 v_mfma_f32_16x16x32_bf16 v[152:155], a[212:215], a[164:167], v[152:155]
 v_mfma_f32_16x16x32_bf16 v[156:159], a[212:215], a[172:175], v[156:159]
 v_mfma_f32_16x16x32_bf16 v[156:159], a[208:211], a[168:171], v[156:159]
 v_mfma_f32_16x16x32_bf16 v[160:163], a[208:211], a[176:179], v[160:163]
 v_mfma_f32_16x16x32_bf16 v[160:163], a[212:215], a[180:183], v[160:163]
 v_mfma_f32_16x16x32_bf16 v[164:167], a[212:215], a[188:191], v[164:167]
 v_mfma_f32_16x16x32_bf16 v[164:167], a[208:211], a[184:187], v[164:167]
 s_waitcnt vmcnt(11)
 v_mfma_f32_16x16x32_bf16 v[196:199], a[216:219], a[184:187], v[196:199]
 v_mfma_f32_16x16x32_bf16 v[196:199], a[220:223], a[188:191], v[196:199]
 global_load_dwordx4 a[212:215], v0, s[70:71] offset:1024 sc1
 v_mfma_f32_16x16x32_bf16 v[192:195], a[220:223], a[180:183], v[192:195]
 v_mfma_f32_16x16x32_bf16 v[192:195], a[216:219], a[176:179], v[192:195]
 global_load_dwordx4 a[208:211], v0, s[70:71] offset:0 sc1
 v_mfma_f32_16x16x32_bf16 v[188:191], a[216:219], a[168:171], v[188:191]
 v_mfma_f32_16x16x32_bf16 v[188:191], a[220:223], a[172:175], v[188:191]
 v_mfma_f32_16x16x32_bf16 v[184:187], a[220:223], a[164:167], v[184:187]
 v_mfma_f32_16x16x32_bf16 v[184:187], a[216:219], a[160:163], v[184:187]
 v_mfma_f32_16x16x32_bf16 v[180:183], a[216:219], a[152:155], v[180:183]
 v_mfma_f32_16x16x32_bf16 v[180:183], a[220:223], a[156:159], v[180:183]
 buffer_load_dwordx4 v6, s[8:11], s30 offen lds
 v_mfma_f32_16x16x32_bf16 v[176:179], a[220:223], a[148:151], v[176:179]
 v_mfma_f32_16x16x32_bf16 v[176:179], a[216:219], a[144:147], v[176:179]
 v_mfma_f32_16x16x32_bf16 v[172:175], a[216:219], a[136:139], v[172:175]
 s_add_u32 m0, m0, 1024
 v_mfma_f32_16x16x32_bf16 v[172:175], a[220:223], a[140:143], v[172:175]
 v_mfma_f32_16x16x32_bf16 v[168:171], a[220:223], a[132:135], v[168:171]
 v_mfma_f32_16x16x32_bf16 v[168:171], a[216:219], a[128:131], v[168:171]
 s_waitcnt vmcnt(12)
 v_mfma_f32_16x16x32_bf16 v[200:203], a[224:227], a[128:131], v[200:203]
 s_add_u32 s30, s30, s20
 v_mfma_f32_16x16x32_bf16 v[200:203], a[228:231], a[132:135], v[200:203]
 global_load_dwordx4 a[220:223], v0, s[70:71] offset:3072 sc1
 v_mfma_f32_16x16x32_bf16 v[204:207], a[228:231], a[140:143], v[204:207]
 buffer_load_dwordx4 v6, s[8:11], s30 offen lds
 v_mfma_f32_16x16x32_bf16 v[204:207], a[224:227], a[136:139], v[204:207]
 global_load_dwordx4 a[216:219], v0, s[70:71] offset:2048 sc1
 v_mfma_f32_16x16x32_bf16 v[208:211], a[224:227], a[144:147], v[208:211]
 s_add_u32 s70, s70, 8192
 s_addc_u32 s71, s71, 0
 v_mfma_f32_16x16x32_bf16 v[208:211], a[228:231], a[148:151], v[208:211]
 v_mfma_f32_16x16x32_bf16 v[212:215], a[228:231], a[156:159], v[212:215]
 s_add_u32 m0, m0, 3072
 v_mfma_f32_16x16x32_bf16 v[212:215], a[224:227], a[152:155], v[212:215]
 v_mfma_f32_16x16x32_bf16 v[216:219], a[224:227], a[160:163], v[216:219]
 v_mfma_f32_16x16x32_bf16 v[216:219], a[228:231], a[164:167], v[216:219]
 s_add_u32 s30, s30, s21
 v_mfma_f32_16x16x32_bf16 v[220:223], a[228:231], a[172:175], v[220:223]
 v_mfma_f32_16x16x32_bf16 v[220:223], a[224:227], a[168:171], v[220:223]
 v_mfma_f32_16x16x32_bf16 v[224:227], a[224:227], a[176:179], v[224:227]
 v_mfma_f32_16x16x32_bf16 v[224:227], a[228:231], a[180:183], v[224:227]
 v_mfma_f32_16x16x32_bf16 v[228:231], a[228:231], a[188:191], v[228:231]
 v_mfma_f32_16x16x32_bf16 v[228:231], a[224:227], a[184:187], v[228:231]
 s_waitcnt vmcnt(12)
 v_mfma_f32_16x16x32_bf16 a[252:255], a[232:235], a[184:187], a[252:255]
 ds_read_b128 a[184:187], v2 offset:30720
 v_mfma_f32_16x16x32_bf16 a[252:255], a[236:239], a[188:191], a[252:255]
 global_load_dwordx4 a[228:231], v0, s[70:71] offset:-3072 sc1
 ds_read_b128 a[188:191], v2 offset:31744
 v_mfma_f32_16x16x32_bf16 a[248:251], a[236:239], a[180:183], a[248:251]
 ds_read_b128 a[180:183], v2 offset:27648
 v_mfma_f32_16x16x32_bf16 a[248:251], a[232:235], a[176:179], a[248:251]
 global_load_dwordx4 a[224:227], v0, s[70:71] offset:-4096 sc1
 ds_read_b128 a[176:179], v2 offset:26624
 v_mfma_f32_16x16x32_bf16 v[252:255], a[232:235], a[168:171], v[252:255]
 ds_read_b128 a[168:171], v2 offset:22528
 v_mfma_f32_16x16x32_bf16 v[252:255], a[236:239], a[172:175], v[252:255]
 ds_read_b128 a[172:175], v2 offset:23552
 v_mfma_f32_16x16x32_bf16 v[248:251], a[236:239], a[164:167], v[248:251]
 ds_read_b128 a[164:167], v2 offset:19456
 v_mfma_f32_16x16x32_bf16 v[248:251], a[232:235], a[160:163], v[248:251]
 ds_read_b128 a[160:163], v2 offset:18432
 v_mfma_f32_16x16x32_bf16 v[244:247], a[232:235], a[152:155], v[244:247]
 ds_read_b128 a[152:155], v2 offset:14336
 v_mfma_f32_16x16x32_bf16 v[244:247], a[236:239], a[156:159], v[244:247]
 ds_read_b128 a[156:159], v2 offset:15360
 v_mfma_f32_16x16x32_bf16 v[240:243], a[236:239], a[148:151], v[240:243]
 ds_read_b128 a[148:151], v2 offset:11264
 v_mfma_f32_16x16x32_bf16 v[240:243], a[232:235], a[144:147], v[240:243]
 ds_read_b128 a[144:147], v2 offset:10240
 v_mfma_f32_16x16x32_bf16 v[236:239], a[232:235], a[136:139], v[236:239]
 ds_read_b128 a[136:139], v2 offset:6144
 v_mfma_f32_16x16x32_bf16 v[236:239], a[236:239], a[140:143], v[236:239]
 ds_read_b128 a[140:143], v2 offset:7168
 v_mfma_f32_16x16x32_bf16 v[232:235], a[236:239], a[132:135], v[232:235]
 ds_read_b128 a[132:135], v2 offset:3072
 v_mfma_f32_16x16x32_bf16 v[232:235], a[232:235], a[128:131], v[232:235]
 ds_read_b128 a[128:131], v2 offset:2048
 s_waitcnt vmcnt(10) lgkmcnt(8)
 v_mfma_f32_16x16x32_bf16 v[44:47], a[192:195], a[184:187], v[44:47]
 v_mfma_f32_16x16x32_bf16 v[44:47], a[196:199], a[188:191], v[44:47]
 global_load_dwordx4 a[236:239], v0, s[70:71] offset:-1024 sc1
 v_mfma_f32_16x16x32_bf16 v[40:43], a[196:199], a[180:183], v[40:43]
 v_mfma_f32_16x16x32_bf16 v[40:43], a[192:195], a[176:179], v[40:43]
 global_load_dwordx4 a[232:235], v0, s[70:71] offset:-2048 sc1
 v_mfma_f32_16x16x32_bf16 v[36:39], a[192:195], a[168:171], v[36:39]
 v_mfma_f32_16x16x32_bf16 v[36:39], a[196:199], a[172:175], v[36:39]
 v_mfma_f32_16x16x32_bf16 v[32:35], a[196:199], a[164:167], v[32:35]
 v_mfma_f32_16x16x32_bf16 v[32:35], a[192:195], a[160:163], v[32:35]
 s_waitcnt lgkmcnt(0)
 v_mfma_f32_16x16x32_bf16 v[28:31], a[192:195], a[152:155], v[28:31]
 v_mfma_f32_16x16x32_bf16 v[28:31], a[196:199], a[156:159], v[28:31]
 v_mfma_f32_16x16x32_bf16 v[24:27], a[196:199], a[148:151], v[24:27]
 v_mfma_f32_16x16x32_bf16 v[24:27], a[192:195], a[144:147], v[24:27]
 v_mfma_f32_16x16x32_bf16 v[20:23], a[192:195], a[136:139], v[20:23]
 v_mfma_f32_16x16x32_bf16 v[20:23], a[196:199], a[140:143], v[20:23]
 buffer_load_dwordx4 v6, s[8:11], s30 offen lds
 v_mfma_f32_16x16x32_bf16 v[16:19], a[196:199], a[132:135], v[16:19]
 v_mfma_f32_16x16x32_bf16 v[16:19], a[192:195], a[128:131], v[16:19]
 s_waitcnt vmcnt(11)
 v_mfma_f32_16x16x32_bf16 v[48:51], a[200:203], a[128:131], v[48:51]
 s_add_u32 m0, m0, 1024
 v_mfma_f32_16x16x32_bf16 v[48:51], a[204:207], a[132:135], v[48:51]
 global_load_dwordx4 a[196:199], v0, s[70:71] offset:1024 sc1
 v_mfma_f32_16x16x32_bf16 v[52:55], a[204:207], a[140:143], v[52:55]
 v_mfma_f32_16x16x32_bf16 v[52:55], a[200:203], a[136:139], v[52:55]
 global_load_dwordx4 a[192:195], v0, s[70:71] offset:0 sc1
 s_add_u32 s30, s30, s20
 v_mfma_f32_16x16x32_bf16 v[56:59], a[200:203], a[144:147], v[56:59]
 v_mfma_f32_16x16x32_bf16 v[56:59], a[204:207], a[148:151], v[56:59]
 v_mfma_f32_16x16x32_bf16 v[60:63], a[204:207], a[156:159], v[60:63]
 buffer_load_dwordx4 v6, s[8:11], s30 offen lds
 v_mfma_f32_16x16x32_bf16 v[60:63], a[200:203], a[152:155], v[60:63]
 v_mfma_f32_16x16x32_bf16 v[64:67], a[200:203], a[160:163], v[64:67]
 v_mfma_f32_16x16x32_bf16 v[64:67], a[204:207], a[164:167], v[64:67]
 v_mfma_f32_16x16x32_bf16 v[68:71], a[204:207], a[172:175], v[68:71]
 s_add_u32 m0, m0, 3072
 v_mfma_f32_16x16x32_bf16 v[68:71], a[200:203], a[168:171], v[68:71]
 v_mfma_f32_16x16x32_bf16 v[72:75], a[200:203], a[176:179], v[72:75]
 v_mfma_f32_16x16x32_bf16 v[72:75], a[204:207], a[180:183], v[72:75]
 s_add_u32 s30, s30, s21
 v_mfma_f32_16x16x32_bf16 v[76:79], a[204:207], a[188:191], v[76:79]
 v_mfma_f32_16x16x32_bf16 v[76:79], a[200:203], a[184:187], v[76:79]
 s_waitcnt vmcnt(12)
 v_mfma_f32_16x16x32_bf16 v[108:111], a[208:211], a[184:187], v[108:111]
 v_mfma_f32_16x16x32_bf16 v[108:111], a[212:215], a[188:191], v[108:111]
 global_load_dwordx4 a[204:207], v0, s[70:71] offset:3072 sc1
 v_mfma_f32_16x16x32_bf16 v[104:107], a[212:215], a[180:183], v[104:107]
 v_mfma_f32_16x16x32_bf16 v[104:107], a[208:211], a[176:179], v[104:107]
 global_load_dwordx4 a[200:203], v0, s[70:71] offset:2048 sc1
 v_mfma_f32_16x16x32_bf16 v[100:103], a[208:211], a[168:171], v[100:103]
 s_add_u32 s70, s70, 8192
 s_addc_u32 s71, s71, 0
 v_mfma_f32_16x16x32_bf16 v[100:103], a[212:215], a[172:175], v[100:103]
 v_mfma_f32_16x16x32_bf16 v[96:99], a[212:215], a[164:167], v[96:99]
 v_mfma_f32_16x16x32_bf16 v[96:99], a[208:211], a[160:163], v[96:99]
 v_mfma_f32_16x16x32_bf16 v[92:95], a[208:211], a[152:155], v[92:95]
 v_mfma_f32_16x16x32_bf16 v[92:95], a[212:215], a[156:159], v[92:95]
 v_mfma_f32_16x16x32_bf16 v[88:91], a[212:215], a[148:151], v[88:91]
 v_mfma_f32_16x16x32_bf16 v[88:91], a[208:211], a[144:147], v[88:91]
 v_mfma_f32_16x16x32_bf16 v[84:87], a[208:211], a[136:139], v[84:87]
 v_mfma_f32_16x16x32_bf16 v[84:87], a[212:215], a[140:143], v[84:87]
 v_mfma_f32_16x16x32_bf16 v[80:83], a[212:215], a[132:135], v[80:83]
 v_mfma_f32_16x16x32_bf16 v[80:83], a[208:211], a[128:131], v[80:83]
 s_waitcnt vmcnt(10)
 v_mfma_f32_16x16x32_bf16 v[112:115], a[216:219], a[128:131], v[112:115]
 v_mfma_f32_16x16x32_bf16 v[112:115], a[220:223], a[132:135], v[112:115]
 global_load_dwordx4 a[212:215], v0, s[70:71] offset:-3072 sc1
 v_mfma_f32_16x16x32_bf16 v[116:119], a[220:223], a[140:143], v[116:119]
 v_mfma_f32_16x16x32_bf16 v[116:119], a[216:219], a[136:139], v[116:119]
 global_load_dwordx4 a[208:211], v0, s[70:71] offset:-4096 sc1
 v_mfma_f32_16x16x32_bf16 v[120:123], a[216:219], a[144:147], v[120:123]
 v_mfma_f32_16x16x32_bf16 v[120:123], a[220:223], a[148:151], v[120:123]
 v_mfma_f32_16x16x32_bf16 v[124:127], a[220:223], a[156:159], v[124:127]
 v_mfma_f32_16x16x32_bf16 v[124:127], a[216:219], a[152:155], v[124:127]
 v_mfma_f32_16x16x32_bf16 v[128:131], a[216:219], a[160:163], v[128:131]
 v_mfma_f32_16x16x32_bf16 v[128:131], a[220:223], a[164:167], v[128:131]
 v_mfma_f32_16x16x32_bf16 v[132:135], a[220:223], a[172:175], v[132:135]
 v_mfma_f32_16x16x32_bf16 v[132:135], a[216:219], a[168:171], v[132:135]
 v_mfma_f32_16x16x32_bf16 a[240:243], a[216:219], a[176:179], a[240:243]
 v_mfma_f32_16x16x32_bf16 a[240:243], a[220:223], a[180:183], a[240:243]
 v_mfma_f32_16x16x32_bf16 a[244:247], a[220:223], a[188:191], a[244:247]
 v_mfma_f32_16x16x32_bf16 a[244:247], a[216:219], a[184:187], a[244:247]
 s_waitcnt vmcnt(10)
 v_mfma_f32_16x16x32_bf16 v[164:167], a[224:227], a[184:187], v[164:167]
 buffer_load_dwordx4 v6, s[8:11], s30 offen lds
 v_mfma_f32_16x16x32_bf16 v[164:167], a[228:231], a[188:191], v[164:167]
 global_load_dwordx4 a[220:223], v0, s[70:71] offset:-1024 sc1
 v_mfma_f32_16x16x32_bf16 v[160:163], a[228:231], a[180:183], v[160:163]
 v_mfma_f32_16x16x32_bf16 v[160:163], a[224:227], a[176:179], v[160:163]
 global_load_dwordx4 a[216:219], v0, s[70:71] offset:-2048 sc1
 s_add_u32 m0, m0, 1024
 v_mfma_f32_16x16x32_bf16 v[156:159], a[224:227], a[168:171], v[156:159]
 v_mfma_f32_16x16x32_bf16 v[156:159], a[228:231], a[172:175], v[156:159]
 v_mfma_f32_16x16x32_bf16 v[152:155], a[228:231], a[164:167], v[152:155]
 v_mfma_f32_16x16x32_bf16 v[152:155], a[224:227], a[160:163], v[152:155]
 s_add_u32 s30, s30, s20
 v_mfma_f32_16x16x32_bf16 v[148:151], a[224:227], a[152:155], v[148:151]
 v_mfma_f32_16x16x32_bf16 v[148:151], a[228:231], a[156:159], v[148:151]
 v_mfma_f32_16x16x32_bf16 v[144:147], a[228:231], a[148:151], v[144:147]
 buffer_load_dwordx4 v6, s[8:11], s30 offen lds
 v_mfma_f32_16x16x32_bf16 v[144:147], a[224:227], a[144:147], v[144:147]
 v_mfma_f32_16x16x32_bf16 v[140:143], a[224:227], a[136:139], v[140:143]
 v_mfma_f32_16x16x32_bf16 v[140:143], a[228:231], a[140:143], v[140:143]
 s_add_u32 m0, m0, 3072
 v_mfma_f32_16x16x32_bf16 v[136:139], a[228:231], a[132:135], v[136:139]
 v_mfma_f32_16x16x32_bf16 v[136:139], a[224:227], a[128:131], v[136:139]
 s_waitcnt vmcnt(12)
 v_mfma_f32_16x16x32_bf16 v[168:171], a[232:235], a[128:131], v[168:171]
 s_add_u32 s30, s30, s21
 v_mfma_f32_16x16x32_bf16 v[168:171], a[236:239], a[132:135], v[168:171]
 global_load_dwordx4 a[228:231], v0, s[70:71] offset:1024 sc1
 v_mfma_f32_16x16x32_bf16 v[172:175], a[236:239], a[140:143], v[172:175]
 v_mfma_f32_16x16x32_bf16 v[172:175], a[232:235], a[136:139], v[172:175]
 global_load_dwordx4 a[224:227], v0, s[70:71] offset:0 sc1
 v_mfma_f32_16x16x32_bf16 v[176:179], a[232:235], a[144:147], v[176:179]
 v_mfma_f32_16x16x32_bf16 v[176:179], a[236:239], a[148:151], v[176:179]
 v_mfma_f32_16x16x32_bf16 v[180:183], a[236:239], a[156:159], v[180:183]
 v_mfma_f32_16x16x32_bf16 v[180:183], a[232:235], a[152:155], v[180:183]
 v_mfma_f32_16x16x32_bf16 v[184:187], a[232:235], a[160:163], v[184:187]
 v_mfma_f32_16x16x32_bf16 v[184:187], a[236:239], a[164:167], v[184:187]
 v_mfma_f32_16x16x32_bf16 v[188:191], a[236:239], a[172:175], v[188:191]
 v_mfma_f32_16x16x32_bf16 v[188:191], a[232:235], a[168:171], v[188:191]
 v_mfma_f32_16x16x32_bf16 v[192:195], a[232:235], a[176:179], v[192:195]
 v_mfma_f32_16x16x32_bf16 v[192:195], a[236:239], a[180:183], v[192:195]
 v_mfma_f32_16x16x32_bf16 v[196:199], a[236:239], a[188:191], v[196:199]
 v_mfma_f32_16x16x32_bf16 v[196:199], a[232:235], a[184:187], v[196:199]
 s_waitcnt vmcnt(11)
 v_mfma_f32_16x16x32_bf16 v[228:231], a[192:195], a[184:187], v[228:231]
 v_mfma_f32_16x16x32_bf16 v[228:231], a[196:199], a[188:191], v[228:231]
 global_load_dwordx4 a[236:239], v0, s[70:71] offset:3072 sc1
 v_mfma_f32_16x16x32_bf16 v[224:227], a[196:199], a[180:183], v[224:227]
 v_mfma_f32_16x16x32_bf16 v[224:227], a[192:195], a[176:179], v[224:227]
 global_load_dwordx4 a[232:235], v0, s[70:71] offset:2048 sc1
 v_mfma_f32_16x16x32_bf16 v[220:223], a[192:195], a[168:171], v[220:223]
 s_add_u32 s70, s70, 8192
 s_addc_u32 s71, s71, 0
 v_mfma_f32_16x16x32_bf16 v[220:223], a[196:199], a[172:175], v[220:223]
 v_mfma_f32_16x16x32_bf16 v[216:219], a[196:199], a[164:167], v[216:219]
 v_mfma_f32_16x16x32_bf16 v[216:219], a[192:195], a[160:163], v[216:219]
 v_mfma_f32_16x16x32_bf16 v[212:215], a[192:195], a[152:155], v[212:215]
 v_mfma_f32_16x16x32_bf16 v[212:215], a[196:199], a[156:159], v[212:215]
 v_mfma_f32_16x16x32_bf16 v[208:211], a[196:199], a[148:151], v[208:211]
 v_mfma_f32_16x16x32_bf16 v[208:211], a[192:195], a[144:147], v[208:211]
 v_mfma_f32_16x16x32_bf16 v[204:207], a[192:195], a[136:139], v[204:207]
 v_mfma_f32_16x16x32_bf16 v[204:207], a[196:199], a[140:143], v[204:207]
 v_mfma_f32_16x16x32_bf16 v[200:203], a[196:199], a[132:135], v[200:203]
 v_mfma_f32_16x16x32_bf16 v[200:203], a[192:195], a[128:131], v[200:203]
 buffer_load_dwordx4 v6, s[8:11], s30 offen lds
 s_waitcnt vmcnt(11)
 v_mfma_f32_16x16x32_bf16 v[232:235], a[200:203], a[128:131], v[232:235]
 ds_read_b128 a[128:131], v2 offset:34816
 v_mfma_f32_16x16x32_bf16 v[232:235], a[204:207], a[132:135], v[232:235]
 global_load_dwordx4 a[196:199], v0, s[70:71] offset:-3072 sc1
 ds_read_b128 a[132:135], v2 offset:35840
 v_mfma_f32_16x16x32_bf16 v[236:239], a[204:207], a[140:143], v[236:239]
 ds_read_b128 a[140:143], v2 offset:39936
 v_mfma_f32_16x16x32_bf16 v[236:239], a[200:203], a[136:139], v[236:239]
 global_load_dwordx4 a[192:195], v0, s[70:71] offset:-4096 sc1
 ds_read_b128 a[136:139], v2 offset:38912
 v_mfma_f32_16x16x32_bf16 v[240:243], a[200:203], a[144:147], v[240:243]
 ds_read_b128 a[144:147], v2 offset:43008
 v_mfma_f32_16x16x32_bf16 v[240:243], a[204:207], a[148:151], v[240:243]
 ds_read_b128 a[148:151], v2 offset:44032
 v_mfma_f32_16x16x32_bf16 v[244:247], a[204:207], a[156:159], v[244:247]
 ds_read_b128 a[156:159], v2 offset:48128
 v_mfma_f32_16x16x32_bf16 v[244:247], a[200:203], a[152:155], v[244:247]
 ds_read_b128 a[152:155], v2 offset:47104
 s_add_u32 m0, m0, 1024
 v_mfma_f32_16x16x32_bf16 v[248:251], a[200:203], a[160:163], v[248:251]
 ds_read_b128 a[160:163], v2 offset:51200
 v_mfma_f32_16x16x32_bf16 v[248:251], a[204:207], a[164:167], v[248:251]
 ds_read_b128 a[164:167], v2 offset:52224
 v_mfma_f32_16x16x32_bf16 v[252:255], a[204:207], a[172:175], v[252:255]
 ds_read_b128 a[172:175], v2 offset:56320
 s_add_u32 s30, s30, s20
 v_mfma_f32_16x16x32_bf16 v[252:255], a[200:203], a[168:171], v[252:255]
 ds_read_b128 a[168:171], v2 offset:55296
 v_mfma_f32_16x16x32_bf16 a[248:251], a[200:203], a[176:179], a[248:251]
 ds_read_b128 a[176:179], v2 offset:59392
 v_mfma_f32_16x16x32_bf16 a[248:251], a[204:207], a[180:183], a[248:251]
 ds_read_b128 a[180:183], v2 offset:60416
 v_mfma_f32_16x16x32_bf16 a[252:255], a[204:207], a[188:191], a[252:255]
 ds_read_b128 a[188:191], v2 offset:64512
 v_mfma_f32_16x16x32_bf16 a[252:255], a[200:203], a[184:187], a[252:255]
 ds_read_b128 a[184:187], v2 offset:63488
 s_waitcnt vmcnt(11) lgkmcnt(8)
 v_mfma_f32_16x16x32_bf16 v[16:19], a[208:211], a[128:131], v[16:19]
 buffer_load_dwordx4 v6, s[8:11], s30 offen lds
 v_mfma_f32_16x16x32_bf16 v[16:19], a[212:215], a[132:135], v[16:19]
 global_load_dwordx4 a[204:207], v0, s[70:71] offset:-1024 sc1
 s_add_u32 m0, m0, 3072
 v_mfma_f32_16x16x32_bf16 v[20:23], a[212:215], a[140:143], v[20:23]
 buffer_load_dword v4, off, s[64:67], 0 sc1
 v_mfma_f32_16x16x32_bf16 v[20:23], a[208:211], a[136:139], v[20:23]
 global_load_dwordx4 a[200:203], v0, s[70:71] offset:-2048 sc1
 v_mfma_f32_16x16x32_bf16 v[24:27], a[208:211], a[144:147], v[24:27]
 s_add_u32 s30, s30, s22
 v_mfma_f32_16x16x32_bf16 v[24:27], a[212:215], a[148:151], v[24:27]
 v_mfma_f32_16x16x32_bf16 v[28:31], a[212:215], a[156:159], v[28:31]
 v_mfma_f32_16x16x32_bf16 v[28:31], a[208:211], a[152:155], v[28:31]
 s_waitcnt lgkmcnt(0)
 v_mfma_f32_16x16x32_bf16 v[32:35], a[208:211], a[160:163], v[32:35]
 v_mfma_f32_16x16x32_bf16 v[32:35], a[212:215], a[164:167], v[32:35]
 v_mfma_f32_16x16x32_bf16 v[36:39], a[212:215], a[172:175], v[36:39]
 v_mfma_f32_16x16x32_bf16 v[36:39], a[208:211], a[168:171], v[36:39]
 v_mfma_f32_16x16x32_bf16 v[40:43], a[208:211], a[176:179], v[40:43]
 v_mfma_f32_16x16x32_bf16 v[40:43], a[212:215], a[180:183], v[40:43]
 v_mfma_f32_16x16x32_bf16 v[44:47], a[212:215], a[188:191], v[44:47]
 v_mfma_f32_16x16x32_bf16 v[44:47], a[208:211], a[184:187], v[44:47]
 s_waitcnt vmcnt(12)
 v_mfma_f32_16x16x32_bf16 v[76:79], a[216:219], a[184:187], v[76:79]
 v_lshrrev_b32 v5, 6, v1
 v_mfma_f32_16x16x32_bf16 v[76:79], a[220:223], a[188:191], v[76:79]
 global_load_dwordx4 a[212:215], v0, s[70:71] offset:1024 sc1
 v_mfma_f32_16x16x32_bf16 v[72:75], a[220:223], a[180:183], v[72:75]
 v_and_b32 v6, 48, v1
 v_mfma_f32_16x16x32_bf16 v[72:75], a[216:219], a[176:179], v[72:75]
 global_load_dwordx4 a[208:211], v0, s[70:71] offset:0 sc1
 v_lshl_add_u32 v5, v5, 11, v6
 v_mfma_f32_16x16x32_bf16 v[68:71], a[216:219], a[168:171], v[68:71]
 v_mfma_f32_16x16x32_bf16 v[68:71], a[220:223], a[172:175], v[68:71]
 s_mov_b32 m0, s52
 v_mfma_f32_16x16x32_bf16 v[64:67], a[220:223], a[164:167], v[64:67]
 s_add_u32 s3, s48, 31744
 v_mfma_f32_16x16x32_bf16 v[64:67], a[216:219], a[160:163], v[64:67]
 v_mfma_f32_16x16x32_bf16 v[60:63], a[216:219], a[152:155], v[60:63]
 buffer_load_dwordx4 v5, s[40:43], s48 offen lds
 v_mfma_f32_16x16x32_bf16 v[60:63], a[220:223], a[156:159], v[60:63]
 buffer_load_dwordx4 v5, s[40:43], s3 offen offset:1024 lds
 v_mfma_f32_16x16x32_bf16 v[56:59], a[220:223], a[148:151], v[56:59]
 v_mfma_f32_16x16x32_bf16 v[56:59], a[216:219], a[144:147], v[56:59]
 s_add_u32 s48, s48, 2097152
 v_mfma_f32_16x16x32_bf16 v[52:55], a[216:219], a[136:139], v[52:55]
 v_mfma_f32_16x16x32_bf16 v[52:55], a[220:223], a[140:143], v[52:55]
 v_mfma_f32_16x16x32_bf16 v[48:51], a[220:223], a[132:135], v[48:51]
 v_mfma_f32_16x16x32_bf16 v[48:51], a[216:219], a[128:131], v[48:51]
 s_waitcnt vmcnt(13)
 v_mfma_f32_16x16x32_bf16 v[80:83], a[224:227], a[128:131], v[80:83]
 v_mfma_f32_16x16x32_bf16 v[80:83], a[228:231], a[132:135], v[80:83]
 global_load_dwordx4 a[220:223], v0, s[70:71] offset:3072 sc1
 v_mfma_f32_16x16x32_bf16 v[84:87], a[228:231], a[140:143], v[84:87]
 v_mfma_f32_16x16x32_bf16 v[84:87], a[224:227], a[136:139], v[84:87]
 global_load_dwordx4 a[216:219], v0, s[70:71] offset:2048 sc1
 v_mfma_f32_16x16x32_bf16 v[88:91], a[224:227], a[144:147], v[88:91]
 s_add_u32 s70, s70, 8192
 s_addc_u32 s71, s71, 0
 v_mfma_f32_16x16x32_bf16 v[88:91], a[228:231], a[148:151], v[88:91]
 v_mfma_f32_16x16x32_bf16 v[92:95], a[228:231], a[156:159], v[92:95]
 v_mfma_f32_16x16x32_bf16 v[92:95], a[224:227], a[152:155], v[92:95]
 v_mfma_f32_16x16x32_bf16 v[96:99], a[224:227], a[160:163], v[96:99]
 v_mfma_f32_16x16x32_bf16 v[96:99], a[228:231], a[164:167], v[96:99]
 v_mfma_f32_16x16x32_bf16 v[100:103], a[228:231], a[172:175], v[100:103]
 v_mfma_f32_16x16x32_bf16 v[100:103], a[224:227], a[168:171], v[100:103]
 v_mfma_f32_16x16x32_bf16 v[104:107], a[224:227], a[176:179], v[104:107]
 v_mfma_f32_16x16x32_bf16 v[104:107], a[228:231], a[180:183], v[104:107]
 v_mfma_f32_16x16x32_bf16 v[108:111], a[228:231], a[188:191], v[108:111]
 v_mfma_f32_16x16x32_bf16 v[108:111], a[224:227], a[184:187], v[108:111]
 s_waitcnt vmcnt(13)
 v_mfma_f32_16x16x32_bf16 a[244:247], a[232:235], a[184:187], a[244:247]
 v_mfma_f32_16x16x32_bf16 a[244:247], a[236:239], a[188:191], a[244:247]
 global_load_dwordx4 a[228:231], v0, s[70:71] offset:-3072 sc1
 v_mfma_f32_16x16x32_bf16 a[240:243], a[236:239], a[180:183], a[240:243]
 v_mfma_f32_16x16x32_bf16 a[240:243], a[232:235], a[176:179], a[240:243]
 global_load_dwordx4 a[224:227], v0, s[70:71] offset:-4096 sc1
 v_mfma_f32_16x16x32_bf16 v[132:135], a[232:235], a[168:171], v[132:135]
 v_mfma_f32_16x16x32_bf16 v[132:135], a[236:239], a[172:175], v[132:135]
 v_mfma_f32_16x16x32_bf16 v[128:131], a[236:239], a[164:167], v[128:131]
 v_mfma_f32_16x16x32_bf16 v[128:131], a[232:235], a[160:163], v[128:131]
 v_mfma_f32_16x16x32_bf16 v[124:127], a[232:235], a[152:155], v[124:127]
 v_mfma_f32_16x16x32_bf16 v[124:127], a[236:239], a[156:159], v[124:127]
 v_mfma_f32_16x16x32_bf16 v[120:123], a[236:239], a[148:151], v[120:123]
 v_mfma_f32_16x16x32_bf16 v[120:123], a[232:235], a[144:147], v[120:123]
 v_mfma_f32_16x16x32_bf16 v[116:119], a[232:235], a[136:139], v[116:119]
 v_mfma_f32_16x16x32_bf16 v[116:119], a[236:239], a[140:143], v[116:119]
 v_mfma_f32_16x16x32_bf16 v[112:115], a[236:239], a[132:135], v[112:115]
 v_mfma_f32_16x16x32_bf16 v[112:115], a[232:235], a[128:131], v[112:115]
 s_waitcnt vmcnt(12)
 v_mfma_f32_16x16x32_bf16 v[136:139], a[192:195], a[128:131], v[136:139]
 v_mfma_f32_16x16x32_bf16 v[136:139], a[196:199], a[132:135], v[136:139]
 global_load_dwordx4 a[236:239], v0, s[70:71] offset:-1024 sc1
 v_mfma_f32_16x16x32_bf16 v[140:143], a[196:199], a[140:143], v[140:143]
 v_mfma_f32_16x16x32_bf16 v[140:143], a[192:195], a[136:139], v[140:143]
 global_load_dwordx4 a[232:235], v0, s[70:71] offset:-2048 sc1
 v_mfma_f32_16x16x32_bf16 v[144:147], a[192:195], a[144:147], v[144:147]
 v_mfma_f32_16x16x32_bf16 v[144:147], a[196:199], a[148:151], v[144:147]
 v_mfma_f32_16x16x32_bf16 v[148:151], a[196:199], a[156:159], v[148:151]
 v_mfma_f32_16x16x32_bf16 v[148:151], a[192:195], a[152:155], v[148:151]
 v_mfma_f32_16x16x32_bf16 v[152:155], a[192:195], a[160:163], v[152:155]
 v_mfma_f32_16x16x32_bf16 v[152:155], a[196:199], a[164:167], v[152:155]
 v_mfma_f32_16x16x32_bf16 v[156:159], a[196:199], a[172:175], v[156:159]
 v_mfma_f32_16x16x32_bf16 v[156:159], a[192:195], a[168:171], v[156:159]
 v_mfma_f32_16x16x32_bf16 v[160:163], a[192:195], a[176:179], v[160:163]
 v_mfma_f32_16x16x32_bf16 v[160:163], a[196:199], a[180:183], v[160:163]
 v_mfma_f32_16x16x32_bf16 v[164:167], a[196:199], a[188:191], v[164:167]
 v_mfma_f32_16x16x32_bf16 v[164:167], a[192:195], a[184:187], v[164:167]
 s_waitcnt vmcnt(10)
 v_mfma_f32_16x16x32_bf16 v[196:199], a[200:203], a[184:187], v[196:199]
 v_mfma_f32_16x16x32_bf16 v[196:199], a[204:207], a[188:191], v[196:199]
 global_load_dwordx4 a[196:199], v0, s[70:71] offset:1024 sc1
 v_mfma_f32_16x16x32_bf16 v[192:195], a[204:207], a[180:183], v[192:195]
 v_mfma_f32_16x16x32_bf16 v[192:195], a[200:203], a[176:179], v[192:195]
 global_load_dwordx4 a[192:195], v0, s[70:71] offset:0 sc1
 v_mfma_f32_16x16x32_bf16 v[188:191], a[200:203], a[168:171], v[188:191]
 v_mfma_f32_16x16x32_bf16 v[188:191], a[204:207], a[172:175], v[188:191]
 v_mfma_f32_16x16x32_bf16 v[184:187], a[204:207], a[164:167], v[184:187]
 v_mfma_f32_16x16x32_bf16 v[184:187], a[200:203], a[160:163], v[184:187]
 v_mfma_f32_16x16x32_bf16 v[180:183], a[200:203], a[152:155], v[180:183]
 v_mfma_f32_16x16x32_bf16 v[180:183], a[204:207], a[156:159], v[180:183]
 v_mfma_f32_16x16x32_bf16 v[176:179], a[204:207], a[148:151], v[176:179]
 v_mfma_f32_16x16x32_bf16 v[176:179], a[200:203], a[144:147], v[176:179]
 v_mfma_f32_16x16x32_bf16 v[172:175], a[200:203], a[136:139], v[172:175]
 v_mfma_f32_16x16x32_bf16 v[172:175], a[204:207], a[140:143], v[172:175]
 v_mfma_f32_16x16x32_bf16 v[168:171], a[204:207], a[132:135], v[168:171]
 v_mfma_f32_16x16x32_bf16 v[168:171], a[200:203], a[128:131], v[168:171]
 s_waitcnt vmcnt(10)
 v_mfma_f32_16x16x32_bf16 v[200:203], a[208:211], a[128:131], v[200:203]
 v_mfma_f32_16x16x32_bf16 v[200:203], a[212:215], a[132:135], v[200:203]
 global_load_dwordx4 a[204:207], v0, s[70:71] offset:3072 sc1
 v_mfma_f32_16x16x32_bf16 v[204:207], a[212:215], a[140:143], v[204:207]
 v_mfma_f32_16x16x32_bf16 v[204:207], a[208:211], a[136:139], v[204:207]
 global_load_dwordx4 a[200:203], v0, s[70:71] offset:2048 sc1
 v_mfma_f32_16x16x32_bf16 v[208:211], a[208:211], a[144:147], v[208:211]
 s_add_u32 s70, s70, 8192
 s_addc_u32 s71, s71, 0
 v_mfma_f32_16x16x32_bf16 v[208:211], a[212:215], a[148:151], v[208:211]
 v_mfma_f32_16x16x32_bf16 v[212:215], a[212:215], a[156:159], v[212:215]
 v_mfma_f32_16x16x32_bf16 v[212:215], a[208:211], a[152:155], v[212:215]
 v_mfma_f32_16x16x32_bf16 v[216:219], a[208:211], a[160:163], v[216:219]
 v_mfma_f32_16x16x32_bf16 v[216:219], a[212:215], a[164:167], v[216:219]
 v_mfma_f32_16x16x32_bf16 v[220:223], a[212:215], a[172:175], v[220:223]
 v_cmp_gt_i32 vcc, s55, v4
 s_and_b64 vcc, exec, vcc
 s_cbranch_vccnz Lspin_pb
Lok_pb:
 s_add_u32 s55, s55, 1
 s_waitcnt lgkmcnt(0)
 s_barrier
 v_mfma_f32_16x16x32_bf16 v[220:223], a[208:211], a[168:171], v[220:223]
 s_cmp_eq_u32 s25, 0
 s_cbranch_scc1 Lxrg
Lxrgr:
 v_mfma_f32_16x16x32_bf16 v[224:227], a[208:211], a[176:179], v[224:227]
 v_mfma_f32_16x16x32_bf16 v[224:227], a[212:215], a[180:183], v[224:227]
 v_mfma_f32_16x16x32_bf16 v[228:231], a[212:215], a[188:191], v[228:231]
 v_mfma_f32_16x16x32_bf16 v[228:231], a[208:211], a[184:187], v[228:231]
 s_waitcnt vmcnt(8)
 v_mfma_f32_16x16x32_bf16 a[252:255], a[216:219], a[184:187], a[252:255]
 ds_read_b128 a[184:187], v1 offset:28672
 v_mfma_f32_16x16x32_bf16 a[252:255], a[220:223], a[188:191], a[252:255]
 global_load_dwordx4 a[212:215], v0, s[70:71] offset:-3072 sc1
 ds_read_b128 a[188:191], v1 offset:29696
 v_mfma_f32_16x16x32_bf16 a[248:251], a[220:223], a[180:183], a[248:251]
 ds_read_b128 a[180:183], v1 offset:25600
 v_mfma_f32_16x16x32_bf16 a[248:251], a[216:219], a[176:179], a[248:251]
 global_load_dwordx4 a[208:211], v0, s[70:71] offset:-4096 sc1
 ds_read_b128 a[176:179], v1 offset:24576
 v_mfma_f32_16x16x32_bf16 v[252:255], a[216:219], a[168:171], v[252:255]
 ds_read_b128 a[168:171], v1 offset:20480
 v_mfma_f32_16x16x32_bf16 v[252:255], a[220:223], a[172:175], v[252:255]
 ds_read_b128 a[172:175], v1 offset:21504
 v_mfma_f32_16x16x32_bf16 v[248:251], a[220:223], a[164:167], v[248:251]
 ds_read_b128 a[164:167], v1 offset:17408
 v_mfma_f32_16x16x32_bf16 v[248:251], a[216:219], a[160:163], v[248:251]
 ds_read_b128 a[160:163], v1 offset:16384
 v_mfma_f32_16x16x32_bf16 v[244:247], a[216:219], a[152:155], v[244:247]
 ds_read_b128 a[152:155], v1 offset:12288
 v_mfma_f32_16x16x32_bf16 v[244:247], a[220:223], a[156:159], v[244:247]
 ds_read_b128 a[156:159], v1 offset:13312
 v_mfma_f32_16x16x32_bf16 v[240:243], a[220:223], a[148:151], v[240:243]
 ds_read_b128 a[148:151], v1 offset:9216
 v_mfma_f32_16x16x32_bf16 v[240:243], a[216:219], a[144:147], v[240:243]
 ds_read_b128 a[144:147], v1 offset:8192
 v_mfma_f32_16x16x32_bf16 v[236:239], a[216:219], a[136:139], v[236:239]
 ds_read_b128 a[136:139], v1 offset:4096
 v_mfma_f32_16x16x32_bf16 v[236:239], a[220:223], a[140:143], v[236:239]
 ds_read_b128 a[140:143], v1 offset:5120
 v_mfma_f32_16x16x32_bf16 v[232:235], a[220:223], a[132:135], v[232:235]
 global_load_dwordx4 a[220:223], v0, s[70:71] offset:-1024 sc1
 ds_read_b128 a[132:135], v1 offset:1024
 v_mfma_f32_16x16x32_bf16 v[232:235], a[216:219], a[128:131], v[232:235]
 global_load_dwordx4 a[216:219], v0, s[70:71] offset:-2048 sc1
 ds_read_b128 a[128:131], v1
 s_waitcnt vmcnt(10) lgkmcnt(8)
 v_mfma_f32_16x16x32_bf16 v[44:47], a[224:227], a[184:187], v[44:47]
 v_mfma_f32_16x16x32_bf16 v[44:47], a[228:231], a[188:191], v[44:47]
 v_mov_b32 v6, v3
 s_cmp_eq_u32 s25, 0
 s_cbranch_scc1 Lgat1
Lgatr1:
 v_mfma_f32_16x16x32_bf16 v[40:43], a[228:231], a[180:183], v[40:43]
 v_mfma_f32_16x16x32_bf16 v[40:43], a[224:227], a[176:179], v[40:43]
 v_mfma_f32_16x16x32_bf16 v[36:39], a[224:227], a[168:171], v[36:39]
 v_mfma_f32_16x16x32_bf16 v[36:39], a[228:231], a[172:175], v[36:39]
 s_add_u32 m0, s50, 2048
 v_mfma_f32_16x16x32_bf16 v[32:35], a[228:231], a[164:167], v[32:35]
 v_mfma_f32_16x16x32_bf16 v[32:35], a[224:227], a[160:163], v[32:35]
 s_waitcnt lgkmcnt(0)
 v_mfma_f32_16x16x32_bf16 v[28:31], a[224:227], a[152:155], v[28:31]
 v_mfma_f32_16x16x32_bf16 v[28:31], a[228:231], a[156:159], v[28:31]
 v_mfma_f32_16x16x32_bf16 v[24:27], a[228:231], a[148:151], v[24:27]
 v_mfma_f32_16x16x32_bf16 v[24:27], a[224:227], a[144:147], v[24:27]
 v_mfma_f32_16x16x32_bf16 v[20:23], a[224:227], a[136:139], v[20:23]
 buffer_load_dwordx4 v6, s[8:11], s30 offen lds
 v_mfma_f32_16x16x32_bf16 v[20:23], a[228:231], a[140:143], v[20:23]
 v_mfma_f32_16x16x32_bf16 v[16:19], a[228:231], a[132:135], v[16:19]
 v_mfma_f32_16x16x32_bf16 v[16:19], a[224:227], a[128:131], v[16:19]
 s_waitcnt vmcnt(9)
 v_mfma_f32_16x16x32_bf16 v[48:51], a[232:235], a[128:131], v[48:51]
 s_add_u32 m0, m0, 1024
 v_mfma_f32_16x16x32_bf16 v[48:51], a[236:239], a[132:135], v[48:51]
 global_load_dwordx4 a[228:231], v0, s[70:71] offset:1024 sc1
 v_mfma_f32_16x16x32_bf16 v[52:55], a[236:239], a[140:143], v[52:55]
 v_mfma_f32_16x16x32_bf16 v[52:55], a[232:235], a[136:139], v[52:55]
 global_load_dwordx4 a[224:227], v0, s[70:71] offset:0 sc1
 s_add_u32 s30, s30, s20
 v_mfma_f32_16x16x32_bf16 v[56:59], a[232:235], a[144:147], v[56:59]
 v_mfma_f32_16x16x32_bf16 v[56:59], a[236:239], a[148:151], v[56:59]
 v_mfma_f32_16x16x32_bf16 v[60:63], a[236:239], a[156:159], v[60:63]
 v_mfma_f32_16x16x32_bf16 v[60:63], a[232:235], a[152:155], v[60:63]
 buffer_load_dwordx4 v6, s[8:11], s30 offen lds
 v_mfma_f32_16x16x32_bf16 v[64:67], a[232:235], a[160:163], v[64:67]
 v_mfma_f32_16x16x32_bf16 v[64:67], a[236:239], a[164:167], v[64:67]
 v_mfma_f32_16x16x32_bf16 v[68:71], a[236:239], a[172:175], v[68:71]
 v_mfma_f32_16x16x32_bf16 v[68:71], a[232:235], a[168:171], v[68:71]
 s_add_u32 m0, m0, 3072
 v_mfma_f32_16x16x32_bf16 v[72:75], a[232:235], a[176:179], v[72:75]
 v_mfma_f32_16x16x32_bf16 v[72:75], a[236:239], a[180:183], v[72:75]
 v_mfma_f32_16x16x32_bf16 v[76:79], a[236:239], a[188:191], v[76:79]
 s_add_u32 s30, s30, s21
 v_mfma_f32_16x16x32_bf16 v[76:79], a[232:235], a[184:187], v[76:79]
 s_waitcnt vmcnt(10)
 v_mfma_f32_16x16x32_bf16 v[108:111], a[192:195], a[184:187], v[108:111]
 v_mfma_f32_16x16x32_bf16 v[108:111], a[196:199], a[188:191], v[108:111]
 global_load_dwordx4 a[236:239], v0, s[70:71] offset:3072 sc1
 v_mfma_f32_16x16x32_bf16 v[104:107], a[196:199], a[180:183], v[104:107]
 v_mfma_f32_16x16x32_bf16 v[104:107], a[192:195], a[176:179], v[104:107]
 global_load_dwordx4 a[232:235], v0, s[70:71] offset:2048 sc1
 v_mfma_f32_16x16x32_bf16 v[100:103], a[192:195], a[168:171], v[100:103]
 s_add_u32 s70, s70, 8192
 s_addc_u32 s71, s71, 0
 v_mfma_f32_16x16x32_bf16 v[100:103], a[196:199], a[172:175], v[100:103]
 v_mfma_f32_16x16x32_bf16 v[96:99], a[196:199], a[164:167], v[96:99]
 v_mfma_f32_16x16x32_bf16 v[96:99], a[192:195], a[160:163], v[96:99]
 v_mfma_f32_16x16x32_bf16 v[92:95], a[192:195], a[152:155], v[92:95]
 v_mfma_f32_16x16x32_bf16 v[92:95], a[196:199], a[156:159], v[92:95]
 v_mfma_f32_16x16x32_bf16 v[88:91], a[196:199], a[148:151], v[88:91]
 v_mfma_f32_16x16x32_bf16 v[88:91], a[192:195], a[144:147], v[88:91]
 v_mfma_f32_16x16x32_bf16 v[84:87], a[192:195], a[136:139], v[84:87]
 v_mfma_f32_16x16x32_bf16 v[84:87], a[196:199], a[140:143], v[84:87]
 v_mfma_f32_16x16x32_bf16 v[80:83], a[196:199], a[132:135], v[80:83]
 v_mfma_f32_16x16x32_bf16 v[80:83], a[192:195], a[128:131], v[80:83]
 s_waitcnt vmcnt(10)
 v_mfma_f32_16x16x32_bf16 v[112:115], a[200:203], a[128:131], v[112:115]
 v_mfma_f32_16x16x32_bf16 v[112:115], a[204:207], a[132:135], v[112:115]
 global_load_dwordx4 a[196:199], v0, s[70:71] offset:-3072 sc1
 v_mfma_f32_16x16x32_bf16 v[116:119], a[204:207], a[140:143], v[116:119]
 v_mfma_f32_16x16x32_bf16 v[116:119], a[200:203], a[136:139], v[116:119]
 global_load_dwordx4 a[192:195], v0, s[70:71] offset:-4096 sc1
 v_mfma_f32_16x16x32_bf16 v[120:123], a[200:203], a[144:147], v[120:123]
 v_mfma_f32_16x16x32_bf16 v[120:123], a[204:207], a[148:151], v[120:123]
 v_mfma_f32_16x16x32_bf16 v[124:127], a[204:207], a[156:159], v[124:127]
 v_mfma_f32_16x16x32_bf16 v[124:127], a[200:203], a[152:155], v[124:127]
 v_mfma_f32_16x16x32_bf16 v[128:131], a[200:203], a[160:163], v[128:131]
 v_mfma_f32_16x16x32_bf16 v[128:131], a[204:207], a[164:167], v[128:131]
 v_mfma_f32_16x16x32_bf16 v[132:135], a[204:207], a[172:175], v[132:135]
 v_mfma_f32_16x16x32_bf16 v[132:135], a[200:203], a[168:171], v[132:135]
 v_mfma_f32_16x16x32_bf16 a[240:243], a[200:203], a[176:179], a[240:243]
 v_mfma_f32_16x16x32_bf16 a[240:243], a[204:207], a[180:183], a[240:243]
 v_mfma_f32_16x16x32_bf16 a[244:247], a[204:207], a[188:191], a[244:247]
 v_mfma_f32_16x16x32_bf16 a[244:247], a[200:203], a[184:187], a[244:247]
 s_waitcnt vmcnt(10)
 v_mfma_f32_16x16x32_bf16 v[164:167], a[208:211], a[184:187], v[164:167]
 v_mfma_f32_16x16x32_bf16 v[164:167], a[212:215], a[188:191], v[164:167]
 global_load_dwordx4 a[204:207], v0, s[70:71] offset:-1024 sc1
 v_mfma_f32_16x16x32_bf16 v[160:163], a[212:215], a[180:183], v[160:163]
 v_mfma_f32_16x16x32_bf16 v[160:163], a[208:211], a[176:179], v[160:163]
 global_load_dwordx4 a[200:203], v0, s[70:71] offset:-2048 sc1
 v_mfma_f32_16x16x32_bf16 v[156:159], a[208:211], a[168:171], v[156:159]
 v_mfma_f32_16x16x32_bf16 v[156:159], a[212:215], a[172:175], v[156:159]
 v_mfma_f32_16x16x32_bf16 v[152:155], a[212:215], a[164:167], v[152:155]
 buffer_load_dwordx4 v6, s[8:11], s30 offen lds
 v_mfma_f32_16x16x32_bf16 v[152:155], a[208:211], a[160:163], v[152:155]
 v_mfma_f32_16x16x32_bf16 v[148:151], a[208:211], a[152:155], v[148:151]
 v_mfma_f32_16x16x32_bf16 v[148:151], a[212:215], a[156:159], v[148:151]
 v_mfma_f32_16x16x32_bf16 v[144:147], a[212:215], a[148:151], v[144:147]
 s_add_u32 m0, m0, 1024
 v_mfma_f32_16x16x32_bf16 v[144:147], a[208:211], a[144:147], v[144:147]
 v_mfma_f32_16x16x32_bf16 v[140:143], a[208:211], a[136:139], v[140:143]
 v_mfma_f32_16x16x32_bf16 v[140:143], a[212:215], a[140:143], v[140:143]
 v_mfma_f32_16x16x32_bf16 v[136:139], a[212:215], a[132:135], v[136:139]
 s_add_u32 s30, s30, s20
 v_mfma_f32_16x16x32_bf16 v[136:139], a[208:211], a[128:131], v[136:139]
 s_waitcnt vmcnt(11)
 v_mfma_f32_16x16x32_bf16 v[168:171], a[216:219], a[128:131], v[168:171]
 v_mfma_f32_16x16x32_bf16 v[168:171], a[220:223], a[132:135], v[168:171]
 global_load_dwordx4 a[212:215], v0, s[70:71] offset:1024 sc1
 v_mfma_f32_16x16x32_bf16 v[172:175], a[220:223], a[140:143], v[172:175]
 buffer_load_dwordx4 v6, s[8:11], s30 offen lds
 v_mfma_f32_16x16x32_bf16 v[172:175], a[216:219], a[136:139], v[172:175]
 global_load_dwordx4 a[208:211], v0, s[70:71] offset:0 sc1
 v_mfma_f32_16x16x32_bf16 v[176:179], a[216:219], a[144:147], v[176:179]
 v_mfma_f32_16x16x32_bf16 v[176:179], a[220:223], a[148:151], v[176:179]
 s_add_u32 m0, m0, 3072
 v_mfma_f32_16x16x32_bf16 v[180:183], a[220:223], a[156:159], v[180:183]
 v_mfma_f32_16x16x32_bf16 v[180:183], a[216:219], a[152:155], v[180:183]
 v_mfma_f32_16x16x32_bf16 v[184:187], a[216:219], a[160:163], v[184:187]
 v_mfma_f32_16x16x32_bf16 v[184:187], a[220:223], a[164:167], v[184:187]
 s_add_u32 s30, s30, s21
 v_mfma_f32_16x16x32_bf16 v[188:191], a[220:223], a[172:175], v[188:191]
 v_mfma_f32_16x16x32_bf16 v[188:191], a[216:219], a[168:171], v[188:191]
 v_mfma_f32_16x16x32_bf16 v[192:195], a[216:219], a[176:179], v[192:195]
 v_mfma_f32_16x16x32_bf16 v[192:195], a[220:223], a[180:183], v[192:195]
 v_mfma_f32_16x16x32_bf16 v[196:199], a[220:223], a[188:191], v[196:199]
 v_mfma_f32_16x16x32_bf16 v[196:199], a[216:219], a[184:187], v[196:199]
 s_waitcnt vmcnt(11)
 v_mfma_f32_16x16x32_bf16 v[228:231], a[224:227], a[184:187], v[228:231]
 v_mfma_f32_16x16x32_bf16 v[228:231], a[228:231], a[188:191], v[228:231]
 global_load_dwordx4 a[220:223], v0, s[70:71] offset:3072 sc1
 v_mfma_f32_16x16x32_bf16 v[224:227], a[228:231], a[180:183], v[224:227]
 v_mfma_f32_16x16x32_bf16 v[224:227], a[224:227], a[176:179], v[224:227]
 global_load_dwordx4 a[216:219], v0, s[70:71] offset:2048 sc1
 v_mfma_f32_16x16x32_bf16 v[220:223], a[224:227], a[168:171], v[220:223]
 s_add_u32 s70, s70, 8192
 s_addc_u32 s71, s71, 0
 v_mfma_f32_16x16x32_bf16 v[220:223], a[228:231], a[172:175], v[220:223]
 v_mfma_f32_16x16x32_bf16 v[216:219], a[228:231], a[164:167], v[216:219]
 v_mfma_f32_16x16x32_bf16 v[216:219], a[224:227], a[160:163], v[216:219]
 v_mfma_f32_16x16x32_bf16 v[212:215], a[224:227], a[152:155], v[212:215]
 v_mfma_f32_16x16x32_bf16 v[212:215], a[228:231], a[156:159], v[212:215]
 v_mfma_f32_16x16x32_bf16 v[208:211], a[228:231], a[148:151], v[208:211]
 v_mfma_f32_16x16x32_bf16 v[208:211], a[224:227], a[144:147], v[208:211]
 v_mfma_f32_16x16x32_bf16 v[204:207], a[224:227], a[136:139], v[204:207]
 v_mfma_f32_16x16x32_bf16 v[204:207], a[228:231], a[140:143], v[204:207]
 v_mfma_f32_16x16x32_bf16 v[200:203], a[228:231], a[132:135], v[200:203]
 v_mfma_f32_16x16x32_bf16 v[200:203], a[224:227], a[128:131], v[200:203]
 s_waitcnt vmcnt(10)
 v_mfma_f32_16x16x32_bf16 v[232:235], a[232:235], a[128:131], v[232:235]
 ds_read_b128 a[128:131], v1 offset:32768
 v_mfma_f32_16x16x32_bf16 v[232:235], a[236:239], a[132:135], v[232:235]
 global_load_dwordx4 a[228:231], v0, s[70:71] offset:-3072 sc1
 ds_read_b128 a[132:135], v1 offset:33792
 v_mfma_f32_16x16x32_bf16 v[236:239], a[236:239], a[140:143], v[236:239]
 ds_read_b128 a[140:143], v1 offset:37888
 v_mfma_f32_16x16x32_bf16 v[236:239], a[232:235], a[136:139], v[236:239]
 global_load_dwordx4 a[224:227], v0, s[70:71] offset:-4096 sc1
 ds_read_b128 a[136:139], v1 offset:36864
 v_mfma_f32_16x16x32_bf16 v[240:243], a[232:235], a[144:147], v[240:243]
 ds_read_b128 a[144:147], v1 offset:40960
 v_mfma_f32_16x16x32_bf16 v[240:243], a[236:239], a[148:151], v[240:243]
 ds_read_b128 a[148:151], v1 offset:41984
 v_mfma_f32_16x16x32_bf16 v[244:247], a[236:239], a[156:159], v[244:247]
 ds_read_b128 a[156:159], v1 offset:46080
 v_mfma_f32_16x16x32_bf16 v[244:247], a[232:235], a[152:155], v[244:247]
 ds_read_b128 a[152:155], v1 offset:45056
 v_mfma_f32_16x16x32_bf16 v[248:251], a[232:235], a[160:163], v[248:251]
 ds_read_b128 a[160:163], v1 offset:49152
 v_mfma_f32_16x16x32_bf16 v[248:251], a[236:239], a[164:167], v[248:251]
 ds_read_b128 a[164:167], v1 offset:50176
 v_mfma_f32_16x16x32_bf16 v[252:255], a[236:239], a[172:175], v[252:255]
 ds_read_b128 a[172:175], v1 offset:54272
 v_mfma_f32_16x16x32_bf16 v[252:255], a[232:235], a[168:171], v[252:255]
 ds_read_b128 a[168:171], v1 offset:53248
 v_mfma_f32_16x16x32_bf16 a[248:251], a[232:235], a[176:179], a[248:251]
 ds_read_b128 a[176:179], v1 offset:57344
 v_mfma_f32_16x16x32_bf16 a[248:251], a[236:239], a[180:183], a[248:251]
 ds_read_b128 a[180:183], v1 offset:58368
 v_mfma_f32_16x16x32_bf16 a[252:255], a[236:239], a[188:191], a[252:255]
 ds_read_b128 a[188:191], v1 offset:62464
 v_mfma_f32_16x16x32_bf16 a[252:255], a[232:235], a[184:187], a[252:255]
 ds_read_b128 a[184:187], v1 offset:61440
 s_waitcnt vmcnt(10) lgkmcnt(8)
 v_mfma_f32_16x16x32_bf16 v[16:19], a[192:195], a[128:131], v[16:19]
 v_mfma_f32_16x16x32_bf16 v[16:19], a[196:199], a[132:135], v[16:19]
 buffer_load_dwordx4 v6, s[8:11], s30 offen lds
 v_mfma_f32_16x16x32_bf16 v[20:23], a[196:199], a[140:143], v[20:23]
 v_mfma_f32_16x16x32_bf16 v[20:23], a[192:195], a[136:139], v[20:23]
 v_mfma_f32_16x16x32_bf16 v[24:27], a[192:195], a[144:147], v[24:27]
 s_add_u32 m0, m0, 1024
 v_mfma_f32_16x16x32_bf16 v[24:27], a[196:199], a[148:151], v[24:27]
 v_mfma_f32_16x16x32_bf16 v[28:31], a[196:199], a[156:159], v[28:31]
 v_mfma_f32_16x16x32_bf16 v[28:31], a[192:195], a[152:155], v[28:31]
 s_waitcnt lgkmcnt(0)
 v_mfma_f32_16x16x32_bf16 v[32:35], a[192:195], a[160:163], v[32:35]
 s_add_u32 s30, s30, s20
 v_mfma_f32_16x16x32_bf16 v[32:35], a[196:199], a[164:167], v[32:35]
 v_mfma_f32_16x16x32_bf16 v[36:39], a[196:199], a[172:175], v[36:39]
 v_mfma_f32_16x16x32_bf16 v[36:39], a[192:195], a[168:171], v[36:39]
 v_mfma_f32_16x16x32_bf16 v[40:43], a[192:195], a[176:179], v[40:43]
 buffer_load_dwordx4 v6, s[8:11], s30 offen lds
 v_mfma_f32_16x16x32_bf16 v[40:43], a[196:199], a[180:183], v[40:43]
 v_mfma_f32_16x16x32_bf16 v[44:47], a[196:199], a[188:191], v[44:47]
 v_mfma_f32_16x16x32_bf16 v[44:47], a[192:195], a[184:187], v[44:47]
 s_add_u32 m0, m0, 3072
 s_waitcnt vmcnt(10)
 v_mfma_f32_16x16x32_bf16 v[76:79], a[200:203], a[184:187], v[76:79]
 v_mfma_f32_16x16x32_bf16 v[76:79], a[204:207], a[188:191], v[76:79]
 global_load_dwordx4 a[196:199], v0, s[70:71] offset:-1024 sc1
 v_mfma_f32_16x16x32_bf16 v[72:75], a[204:207], a[180:183], v[72:75]
 v_mfma_f32_16x16x32_bf16 v[72:75], a[200:203], a[176:179], v[72:75]
 global_load_dwordx4 a[192:195], v0, s[70:71] offset:-2048 sc1
 s_add_u32 s30, s30, s21
 v_mfma_f32_16x16x32_bf16 v[68:71], a[200:203], a[168:171], v[68:71]
 v_mfma_f32_16x16x32_bf16 v[68:71], a[204:207], a[172:175], v[68:71]
 v_mfma_f32_16x16x32_bf16 v[64:67], a[204:207], a[164:167], v[64:67]
 v_mfma_f32_16x16x32_bf16 v[64:67], a[200:203], a[160:163], v[64:67]
 v_mfma_f32_16x16x32_bf16 v[60:63], a[200:203], a[152:155], v[60:63]
 v_mfma_f32_16x16x32_bf16 v[60:63], a[204:207], a[156:159], v[60:63]
 v_mfma_f32_16x16x32_bf16 v[56:59], a[204:207], a[148:151], v[56:59]
 v_mfma_f32_16x16x32_bf16 v[56:59], a[200:203], a[144:147], v[56:59]
 v_mfma_f32_16x16x32_bf16 v[52:55], a[200:203], a[136:139], v[52:55]
 v_mfma_f32_16x16x32_bf16 v[52:55], a[204:207], a[140:143], v[52:55]
 v_mfma_f32_16x16x32_bf16 v[48:51], a[204:207], a[132:135], v[48:51]
 v_mfma_f32_16x16x32_bf16 v[48:51], a[200:203], a[128:131], v[48:51]
 s_waitcnt vmcnt(8)
 v_mfma_f32_16x16x32_bf16 v[80:83], a[208:211], a[128:131], v[80:83]
 v_mfma_f32_16x16x32_bf16 v[80:83], a[212:215], a[132:135], v[80:83]
 global_load_dwordx4 a[204:207], v0, s[70:71] offset:1024 sc1
 v_mfma_f32_16x16x32_bf16 v[84:87], a[212:215], a[140:143], v[84:87]
 v_mfma_f32_16x16x32_bf16 v[84:87], a[208:211], a[136:139], v[84:87]
 global_load_dwordx4 a[200:203], v0, s[70:71] offset:0 sc1
 v_mfma_f32_16x16x32_bf16 v[88:91], a[208:211], a[144:147], v[88:91]
 v_mfma_f32_16x16x32_bf16 v[88:91], a[212:215], a[148:151], v[88:91]
 v_mfma_f32_16x16x32_bf16 v[92:95], a[212:215], a[156:159], v[92:95]
 v_mfma_f32_16x16x32_bf16 v[92:95], a[208:211], a[152:155], v[92:95]
 v_mfma_f32_16x16x32_bf16 v[96:99], a[208:211], a[160:163], v[96:99]
 v_mfma_f32_16x16x32_bf16 v[96:99], a[212:215], a[164:167], v[96:99]
 v_mfma_f32_16x16x32_bf16 v[100:103], a[212:215], a[172:175], v[100:103]
 v_mfma_f32_16x16x32_bf16 v[100:103], a[208:211], a[168:171], v[100:103]
 v_mfma_f32_16x16x32_bf16 v[104:107], a[208:211], a[176:179], v[104:107]
 v_mfma_f32_16x16x32_bf16 v[104:107], a[212:215], a[180:183], v[104:107]
 v_mfma_f32_16x16x32_bf16 v[108:111], a[212:215], a[188:191], v[108:111]
 v_mfma_f32_16x16x32_bf16 v[108:111], a[208:211], a[184:187], v[108:111]
 s_waitcnt vmcnt(8)
 v_mfma_f32_16x16x32_bf16 a[244:247], a[216:219], a[184:187], a[244:247]
 v_mfma_f32_16x16x32_bf16 a[244:247], a[220:223], a[188:191], a[244:247]
 global_load_dwordx4 a[212:215], v0, s[70:71] offset:3072 sc1
 v_mfma_f32_16x16x32_bf16 a[240:243], a[220:223], a[180:183], a[240:243]
 v_mfma_f32_16x16x32_bf16 a[240:243], a[216:219], a[176:179], a[240:243]
 global_load_dwordx4 a[208:211], v0, s[70:71] offset:2048 sc1
 v_mfma_f32_16x16x32_bf16 v[132:135], a[216:219], a[168:171], v[132:135]
 s_add_u32 s70, s70, 8192
 s_addc_u32 s71, s71, 0
 v_mfma_f32_16x16x32_bf16 v[132:135], a[220:223], a[172:175], v[132:135]
 v_mfma_f32_16x16x32_bf16 v[128:131], a[220:223], a[164:167], v[128:131]
 v_mfma_f32_16x16x32_bf16 v[128:131], a[216:219], a[160:163], v[128:131]
 v_mfma_f32_16x16x32_bf16 v[124:127], a[216:219], a[152:155], v[124:127]
 v_mfma_f32_16x16x32_bf16 v[124:127], a[220:223], a[156:159], v[124:127]
 v_mfma_f32_16x16x32_bf16 v[120:123], a[220:223], a[148:151], v[120:123]
 v_mfma_f32_16x16x32_bf16 v[120:123], a[216:219], a[144:147], v[120:123]
 buffer_load_dwordx4 v6, s[8:11], s30 offen lds
 v_mfma_f32_16x16x32_bf16 v[116:119], a[216:219], a[136:139], v[116:119]
 v_mfma_f32_16x16x32_bf16 v[116:119], a[220:223], a[140:143], v[116:119]
 v_mfma_f32_16x16x32_bf16 v[112:115], a[220:223], a[132:135], v[112:115]
 s_add_u32 m0, m0, 1024
 v_mfma_f32_16x16x32_bf16 v[112:115], a[216:219], a[128:131], v[112:115]
 s_waitcnt vmcnt(9)
 v_mfma_f32_16x16x32_bf16 v[136:139], a[224:227], a[128:131], v[136:139]
 v_mfma_f32_16x16x32_bf16 v[136:139], a[228:231], a[132:135], v[136:139]
 global_load_dwordx4 a[220:223], v0, s[70:71] offset:-3072 sc1
 v_mfma_f32_16x16x32_bf16 v[140:143], a[228:231], a[140:143], v[140:143]
 s_add_u32 s30, s30, s20
 v_mfma_f32_16x16x32_bf16 v[140:143], a[224:227], a[136:139], v[140:143]
 global_load_dwordx4 a[216:219], v0, s[70:71] offset:-4096 sc1
 v_mfma_f32_16x16x32_bf16 v[144:147], a[224:227], a[144:147], v[144:147]
 v_mfma_f32_16x16x32_bf16 v[144:147], a[228:231], a[148:151], v[144:147]
 v_mfma_f32_16x16x32_bf16 v[148:151], a[228:231], a[156:159], v[148:151]
 buffer_load_dwordx4 v6, s[8:11], s30 offen lds
 v_mfma_f32_16x16x32_bf16 v[148:151], a[224:227], a[152:155], v[148:151]
 v_mfma_f32_16x16x32_bf16 v[152:155], a[224:227], a[160:163], v[152:155]
 v_mfma_f32_16x16x32_bf16 v[152:155], a[228:231], a[164:167], v[152:155]
 s_add_u32 m0, m0, 3072
 v_mfma_f32_16x16x32_bf16 v[156:159], a[228:231], a[172:175], v[156:159]
 v_mfma_f32_16x16x32_bf16 v[156:159], a[224:227], a[168:171], v[156:159]
 v_mfma_f32_16x16x32_bf16 v[160:163], a[224:227], a[176:179], v[160:163]
 v_mfma_f32_16x16x32_bf16 v[160:163], a[228:231], a[180:183], v[160:163]
 s_add_u32 s30, s30, s21
 v_mfma_f32_16x16x32_bf16 v[164:167], a[228:231], a[188:191], v[164:167]
 v_mfma_f32_16x16x32_bf16 v[164:167], a[224:227], a[184:187], v[164:167]
 s_waitcnt vmcnt(8)
 v_mfma_f32_16x16x32_bf16 v[196:199], a[192:195], a[184:187], v[196:199]
 v_mfma_f32_16x16x32_bf16 v[196:199], a[196:199], a[188:191], v[196:199]
 global_load_dwordx4 a[228:231], v0, s[70:71] offset:-1024 sc1
 v_mfma_f32_16x16x32_bf16 v[192:195], a[196:199], a[180:183], v[192:195]
 v_mfma_f32_16x16x32_bf16 v[192:195], a[192:195], a[176:179], v[192:195]
 global_load_dwordx4 a[224:227], v0, s[70:71] offset:-2048 sc1
 v_mfma_f32_16x16x32_bf16 v[188:191], a[192:195], a[168:171], v[188:191]
 v_mfma_f32_16x16x32_bf16 v[188:191], a[196:199], a[172:175], v[188:191]
 v_mfma_f32_16x16x32_bf16 v[184:187], a[196:199], a[164:167], v[184:187]
 v_mfma_f32_16x16x32_bf16 v[184:187], a[192:195], a[160:163], v[184:187]
 v_mfma_f32_16x16x32_bf16 v[180:183], a[192:195], a[152:155], v[180:183]
 v_mfma_f32_16x16x32_bf16 v[180:183], a[196:199], a[156:159], v[180:183]
 v_mfma_f32_16x16x32_bf16 v[176:179], a[196:199], a[148:151], v[176:179]
 v_mfma_f32_16x16x32_bf16 v[176:179], a[192:195], a[144:147], v[176:179]
 v_mfma_f32_16x16x32_bf16 v[172:175], a[192:195], a[136:139], v[172:175]
 v_mfma_f32_16x16x32_bf16 v[172:175], a[196:199], a[140:143], v[172:175]
 v_mfma_f32_16x16x32_bf16 v[168:171], a[196:199], a[132:135], v[168:171]
 v_mfma_f32_16x16x32_bf16 v[168:171], a[192:195], a[128:131], v[168:171]
 s_waitcnt vmcnt(8)
 v_mfma_f32_16x16x32_bf16 v[200:203], a[200:203], a[128:131], v[200:203]
 v_mfma_f32_16x16x32_bf16 v[200:203], a[204:207], a[132:135], v[200:203]
 global_load_dwordx4 a[196:199], v0, s[70:71] offset:1024 sc1
 v_mfma_f32_16x16x32_bf16 v[204:207], a[204:207], a[140:143], v[204:207]
 v_mfma_f32_16x16x32_bf16 v[204:207], a[200:203], a[136:139], v[204:207]
 global_load_dwordx4 a[192:195], v0, s[70:71] offset:0 sc1
 v_mfma_f32_16x16x32_bf16 v[208:211], a[200:203], a[144:147], v[208:211]
 v_mfma_f32_16x16x32_bf16 v[208:211], a[204:207], a[148:151], v[208:211]
 v_mfma_f32_16x16x32_bf16 v[212:215], a[204:207], a[156:159], v[212:215]
 v_mfma_f32_16x16x32_bf16 v[212:215], a[200:203], a[152:155], v[212:215]
 v_mfma_f32_16x16x32_bf16 v[216:219], a[200:203], a[160:163], v[216:219]
 v_mfma_f32_16x16x32_bf16 v[216:219], a[204:207], a[164:167], v[216:219]
 v_mfma_f32_16x16x32_bf16 v[220:223], a[204:207], a[172:175], v[220:223]
 v_mfma_f32_16x16x32_bf16 v[220:223], a[200:203], a[168:171], v[220:223]
 v_mfma_f32_16x16x32_bf16 v[224:227], a[200:203], a[176:179], v[224:227]
 v_mfma_f32_16x16x32_bf16 v[224:227], a[204:207], a[180:183], v[224:227]
 v_mfma_f32_16x16x32_bf16 v[228:231], a[204:207], a[188:191], v[228:231]
 v_mfma_f32_16x16x32_bf16 v[228:231], a[200:203], a[184:187], v[228:231]
 buffer_load_dwordx4 v6, s[8:11], s30 offen lds
 s_waitcnt vmcnt(9)
 v_mfma_f32_16x16x32_bf16 a[252:255], a[208:211], a[184:187], a[252:255]
 ds_read_b128 a[184:187], v2 offset:28672
 v_mfma_f32_16x16x32_bf16 a[252:255], a[212:215], a[188:191], a[252:255]
 global_load_dwordx4 a[204:207], v0, s[70:71] offset:3072 sc1
 ds_read_b128 a[188:191], v2 offset:29696
 v_mfma_f32_16x16x32_bf16 a[248:251], a[212:215], a[180:183], a[248:251]
 ds_read_b128 a[180:183], v2 offset:25600
 v_mfma_f32_16x16x32_bf16 a[248:251], a[208:211], a[176:179], a[248:251]
 global_load_dwordx4 a[200:203], v0, s[70:71] offset:2048 sc1
 ds_read_b128 a[176:179], v2 offset:24576
 v_mfma_f32_16x16x32_bf16 v[252:255], a[208:211], a[168:171], v[252:255]
 s_add_u32 s70, s70, 8192
 s_addc_u32 s71, s71, 0
 ds_read_b128 a[168:171], v2 offset:20480
 v_mfma_f32_16x16x32_bf16 v[252:255], a[212:215], a[172:175], v[252:255]
 ds_read_b128 a[172:175], v2 offset:21504
 v_mfma_f32_16x16x32_bf16 v[248:251], a[212:215], a[164:167], v[248:251]
 ds_read_b128 a[164:167], v2 offset:17408
 v_mfma_f32_16x16x32_bf16 v[248:251], a[208:211], a[160:163], v[248:251]
 ds_read_b128 a[160:163], v2 offset:16384
 v_mfma_f32_16x16x32_bf16 v[244:247], a[208:211], a[152:155], v[244:247]
 ds_read_b128 a[152:155], v2 offset:12288
 v_mfma_f32_16x16x32_bf16 v[244:247], a[212:215], a[156:159], v[244:247]
 ds_read_b128 a[156:159], v2 offset:13312
 s_add_u32 m0, m0, 1024
 v_mfma_f32_16x16x32_bf16 v[240:243], a[212:215], a[148:151], v[240:243]
 ds_read_b128 a[148:151], v2 offset:9216
 v_mfma_f32_16x16x32_bf16 v[240:243], a[208:211], a[144:147], v[240:243]
 ds_read_b128 a[144:147], v2 offset:8192
 v_mfma_f32_16x16x32_bf16 v[236:239], a[208:211], a[136:139], v[236:239]
 ds_read_b128 a[136:139], v2 offset:4096
 s_add_u32 s30, s30, s20
 v_mfma_f32_16x16x32_bf16 v[236:239], a[212:215], a[140:143], v[236:239]
 ds_read_b128 a[140:143], v2 offset:5120
 v_mfma_f32_16x16x32_bf16 v[232:235], a[212:215], a[132:135], v[232:235]
 ds_read_b128 a[132:135], v2 offset:1024
 v_mfma_f32_16x16x32_bf16 v[232:235], a[208:211], a[128:131], v[232:235]
 ds_read_b128 a[128:131], v2
 s_waitcnt vmcnt(8) lgkmcnt(8)
 v_mfma_f32_16x16x32_bf16 v[44:47], a[216:219], a[184:187], v[44:47]
 buffer_load_dwordx4 v6, s[8:11], s30 offen lds
 v_mfma_f32_16x16x32_bf16 v[44:47], a[220:223], a[188:191], v[44:47]
 global_load_dwordx4 a[212:215], v0, s[70:71] offset:-3072 sc1
 v_mfma_f32_16x16x32_bf16 v[40:43], a[220:223], a[180:183], v[40:43]
 v_mfma_f32_16x16x32_bf16 v[40:43], a[216:219], a[176:179], v[40:43]
 global_load_dwordx4 a[208:211], v0, s[70:71] offset:-4096 sc1
 s_add_u32 m0, m0, 3072
 v_mfma_f32_16x16x32_bf16 v[36:39], a[216:219], a[168:171], v[36:39]
 v_mfma_f32_16x16x32_bf16 v[36:39], a[220:223], a[172:175], v[36:39]
 v_mfma_f32_16x16x32_bf16 v[32:35], a[220:223], a[164:167], v[32:35]
 v_mfma_f32_16x16x32_bf16 v[32:35], a[216:219], a[160:163], v[32:35]
 s_add_u32 s30, s30, s21
 s_waitcnt lgkmcnt(0)
 v_mfma_f32_16x16x32_bf16 v[28:31], a[216:219], a[152:155], v[28:31]
 v_mfma_f32_16x16x32_bf16 v[28:31], a[220:223], a[156:159], v[28:31]
 v_mfma_f32_16x16x32_bf16 v[24:27], a[220:223], a[148:151], v[24:27]
 v_mfma_f32_16x16x32_bf16 v[24:27], a[216:219], a[144:147], v[24:27]
 v_mfma_f32_16x16x32_bf16 v[20:23], a[216:219], a[136:139], v[20:23]
 v_mfma_f32_16x16x32_bf16 v[20:23], a[220:223], a[140:143], v[20:23]
 v_mfma_f32_16x16x32_bf16 v[16:19], a[220:223], a[132:135], v[16:19]
 v_mfma_f32_16x16x32_bf16 v[16:19], a[216:219], a[128:131], v[16:19]
 s_waitcnt vmcnt(8)
 v_mfma_f32_16x16x32_bf16 v[48:51], a[224:227], a[128:131], v[48:51]
 v_mfma_f32_16x16x32_bf16 v[48:51], a[228:231], a[132:135], v[48:51]
 global_load_dwordx4 a[220:223], v0, s[70:71] offset:-1024 sc1
 v_mfma_f32_16x16x32_bf16 v[52:55], a[228:231], a[140:143], v[52:55]
 v_mfma_f32_16x16x32_bf16 v[52:55], a[224:227], a[136:139], v[52:55]
 global_load_dwordx4 a[216:219], v0, s[70:71] offset:-2048 sc1
 v_mfma_f32_16x16x32_bf16 v[56:59], a[224:227], a[144:147], v[56:59]
 v_mfma_f32_16x16x32_bf16 v[56:59], a[228:231], a[148:151], v[56:59]
 v_mfma_f32_16x16x32_bf16 v[60:63], a[228:231], a[156:159], v[60:63]
 v_mfma_f32_16x16x32_bf16 v[60:63], a[224:227], a[152:155], v[60:63]
 v_mfma_f32_16x16x32_bf16 v[64:67], a[224:227], a[160:163], v[64:67]
 v_mfma_f32_16x16x32_bf16 v[64:67], a[228:231], a[164:167], v[64:67]
 v_mfma_f32_16x16x32_bf16 v[68:71], a[228:231], a[172:175], v[68:71]
 v_mfma_f32_16x16x32_bf16 v[68:71], a[224:227], a[168:171], v[68:71]
 v_mfma_f32_16x16x32_bf16 v[72:75], a[224:227], a[176:179], v[72:75]
 v_mfma_f32_16x16x32_bf16 v[72:75], a[228:231], a[180:183], v[72:75]
 v_mfma_f32_16x16x32_bf16 v[76:79], a[228:231], a[188:191], v[76:79]
 v_mfma_f32_16x16x32_bf16 v[76:79], a[224:227], a[184:187], v[76:79]
 s_waitcnt vmcnt(8)
 v_mfma_f32_16x16x32_bf16 v[108:111], a[192:195], a[184:187], v[108:111]
 v_mfma_f32_16x16x32_bf16 v[108:111], a[196:199], a[188:191], v[108:111]
 global_load_dwordx4 a[228:231], v0, s[70:71] offset:1024 sc1
 v_mfma_f32_16x16x32_bf16 v[104:107], a[196:199], a[180:183], v[104:107]
 v_mfma_f32_16x16x32_bf16 v[104:107], a[192:195], a[176:179], v[104:107]
 global_load_dwordx4 a[224:227], v0, s[70:71] offset:0 sc1
 v_mfma_f32_16x16x32_bf16 v[100:103], a[192:195], a[168:171], v[100:103]
 v_mfma_f32_16x16x32_bf16 v[100:103], a[196:199], a[172:175], v[100:103]
 v_mfma_f32_16x16x32_bf16 v[96:99], a[196:199], a[164:167], v[96:99]
 v_mfma_f32_16x16x32_bf16 v[96:99], a[192:195], a[160:163], v[96:99]
 v_mfma_f32_16x16x32_bf16 v[92:95], a[192:195], a[152:155], v[92:95]
 v_mfma_f32_16x16x32_bf16 v[92:95], a[196:199], a[156:159], v[92:95]
 v_mfma_f32_16x16x32_bf16 v[88:91], a[196:199], a[148:151], v[88:91]
 v_mfma_f32_16x16x32_bf16 v[88:91], a[192:195], a[144:147], v[88:91]
 v_mfma_f32_16x16x32_bf16 v[84:87], a[192:195], a[136:139], v[84:87]
 v_mfma_f32_16x16x32_bf16 v[84:87], a[196:199], a[140:143], v[84:87]
 v_mfma_f32_16x16x32_bf16 v[80:83], a[196:199], a[132:135], v[80:83]
 v_mfma_f32_16x16x32_bf16 v[80:83], a[192:195], a[128:131], v[80:83]
 buffer_load_dwordx4 v6, s[8:11], s30 offen lds
 s_waitcnt vmcnt(8)
 v_mfma_f32_16x16x32_bf16 v[112:115], a[200:203], a[128:131], v[112:115]
 v_mfma_f32_16x16x32_bf16 v[112:115], a[204:207], a[132:135], v[112:115]
 global_load_dwordx4 a[196:199], v0, s[70:71] offset:3072 sc1
 v_mfma_f32_16x16x32_bf16 v[116:119], a[204:207], a[140:143], v[116:119]
 v_mfma_f32_16x16x32_bf16 v[116:119], a[200:203], a[136:139], v[116:119]
 global_load_dwordx4 a[192:195], v0, s[70:71] offset:2048 sc1
 s_add_u32 m0, m0, 1024
 v_mfma_f32_16x16x32_bf16 v[120:123], a[200:203], a[144:147], v[120:123]
 s_add_u32 s70, s70, 8192
 s_addc_u32 s71, s71, 0
 v_mfma_f32_16x16x32_bf16 v[120:123], a[204:207], a[148:151], v[120:123]
 v_mfma_f32_16x16x32_bf16 v[124:127], a[204:207], a[156:159], v[124:127]
 s_add_u32 s30, s30, s20
 v_mfma_f32_16x16x32_bf16 v[124:127], a[200:203], a[152:155], v[124:127]
 v_mfma_f32_16x16x32_bf16 v[128:131], a[200:203], a[160:163], v[128:131]
 v_mfma_f32_16x16x32_bf16 v[128:131], a[204:207], a[164:167], v[128:131]
 v_mfma_f32_16x16x32_bf16 v[132:135], a[204:207], a[172:175], v[132:135]
 buffer_load_dwordx4 v6, s[8:11], s30 offen lds
 v_mfma_f32_16x16x32_bf16 v[132:135], a[200:203], a[168:171], v[132:135]
 v_mfma_f32_16x16x32_bf16 a[240:243], a[200:203], a[176:179], a[240:243]
 v_mfma_f32_16x16x32_bf16 a[240:243], a[204:207], a[180:183], a[240:243]
 v_mfma_f32_16x16x32_bf16 a[244:247], a[204:207], a[188:191], a[244:247]
 s_add_u32 m0, m0, 3072
 v_mfma_f32_16x16x32_bf16 a[244:247], a[200:203], a[184:187], a[244:247]
 s_waitcnt vmcnt(8)
 v_mfma_f32_16x16x32_bf16 v[164:167], a[208:211], a[184:187], v[164:167]
 v_mfma_f32_16x16x32_bf16 v[164:167], a[212:215], a[188:191], v[164:167]
 global_load_dwordx4 a[204:207], v0, s[70:71] offset:-3072 sc1
 s_add_u32 s30, s30, s21
 v_mfma_f32_16x16x32_bf16 v[160:163], a[212:215], a[180:183], v[160:163]
 v_mfma_f32_16x16x32_bf16 v[160:163], a[208:211], a[176:179], v[160:163]
 global_load_dwordx4 a[200:203], v0, s[70:71] offset:-4096 sc1
 v_mfma_f32_16x16x32_bf16 v[156:159], a[208:211], a[168:171], v[156:159]
 v_mfma_f32_16x16x32_bf16 v[156:159], a[212:215], a[172:175], v[156:159]
 v_mfma_f32_16x16x32_bf16 v[152:155], a[212:215], a[164:167], v[152:155]
 v_mfma_f32_16x16x32_bf16 v[152:155], a[208:211], a[160:163], v[152:155]
 v_mfma_f32_16x16x32_bf16 v[148:151], a[208:211], a[152:155], v[148:151]
 v_mfma_f32_16x16x32_bf16 v[148:151], a[212:215], a[156:159], v[148:151]
 v_mfma_f32_16x16x32_bf16 v[144:147], a[212:215], a[148:151], v[144:147]
 v_and_b32 v5, 768, v3
 v_mfma_f32_16x16x32_bf16 v[144:147], a[208:211], a[144:147], v[144:147]
 v_and_b32 v7, 1023, v3
 v_mfma_f32_16x16x32_bf16 v[140:143], a[208:211], a[136:139], v[140:143]
 v_mfma_f32_16x16x32_bf16 v[140:143], a[212:215], a[140:143], v[140:143]
 v_add3_u32 v5, v5, v7, s52
 v_mfma_f32_16x16x32_bf16 v[136:139], a[212:215], a[132:135], v[136:139]
 v_mfma_f32_16x16x32_bf16 v[136:139], a[208:211], a[128:131], v[136:139]
 ds_read_b64_tr_b16 v[8:9], v5 offset:0
 s_waitcnt vmcnt(8)
 v_mfma_f32_16x16x32_bf16 v[168:171], a[216:219], a[128:131], v[168:171]
 v_mfma_f32_16x16x32_bf16 v[168:171], a[220:223], a[132:135], v[168:171]
 global_load_dwordx4 a[212:215], v0, s[70:71] offset:-1024 sc1
 ds_read_b64_tr_b16 v[10:11], v5 offset:256
 v_mfma_f32_16x16x32_bf16 v[172:175], a[220:223], a[140:143], v[172:175]
 ds_read_b64_tr_b16 v[12:13], v5 offset:8
 v_mfma_f32_16x16x32_bf16 v[172:175], a[216:219], a[136:139], v[172:175]
 global_load_dwordx4 a[208:211], v0, s[70:71] offset:-2048 sc1
 ds_read_b64_tr_b16 v[14:15], v5 offset:264
 v_mfma_f32_16x16x32_bf16 v[176:179], a[216:219], a[144:147], v[176:179]
 v_mfma_f32_16x16x32_bf16 v[176:179], a[220:223], a[148:151], v[176:179]
 v_mfma_f32_16x16x32_bf16 v[180:183], a[220:223], a[156:159], v[180:183]
 v_mfma_f32_16x16x32_bf16 v[180:183], a[216:219], a[152:155], v[180:183]
 v_mfma_f32_16x16x32_bf16 v[184:187], a[216:219], a[160:163], v[184:187]
 v_mfma_f32_16x16x32_bf16 v[184:187], a[220:223], a[164:167], v[184:187]
 v_mfma_f32_16x16x32_bf16 v[188:191], a[220:223], a[172:175], v[188:191]
 v_mfma_f32_16x16x32_bf16 v[188:191], a[216:219], a[168:171], v[188:191]
 v_mfma_f32_16x16x32_bf16 v[192:195], a[216:219], a[176:179], v[192:195]
 v_mfma_f32_16x16x32_bf16 v[192:195], a[220:223], a[180:183], v[192:195]
 v_mfma_f32_16x16x32_bf16 v[196:199], a[220:223], a[188:191], v[196:199]
 v_mfma_f32_16x16x32_bf16 v[196:199], a[216:219], a[184:187], v[196:199]
 s_waitcnt vmcnt(8)
 v_mfma_f32_16x16x32_bf16 v[228:231], a[224:227], a[184:187], v[228:231]
 v_mfma_f32_16x16x32_bf16 v[228:231], a[228:231], a[188:191], v[228:231]
 global_load_dwordx4 a[220:223], v0, s[70:71] offset:1024 sc1
 v_mfma_f32_16x16x32_bf16 v[224:227], a[228:231], a[180:183], v[224:227]
 s_waitcnt lgkmcnt(2)
 v_mfma_f32_16x16x32_bf16 v[224:227], a[224:227], a[176:179], v[224:227]
 global_load_dwordx4 a[216:219], v0, s[70:71] offset:0 sc1
 v_mfma_f32_16x16x32_bf16 v[220:223], a[224:227], a[168:171], v[220:223]
 buffer_store_dwordx4 v[8:11], v7, s[12:15], s49 offen sc1
 v_mfma_f32_16x16x32_bf16 v[220:223], a[228:231], a[172:175], v[220:223]
 s_waitcnt lgkmcnt(0)
 v_mfma_f32_16x16x32_bf16 v[216:219], a[228:231], a[164:167], v[216:219]
 buffer_store_dwordx4 v[12:15], v7, s[12:15], s49 offen offset:2048 sc1
 v_mfma_f32_16x16x32_bf16 v[216:219], a[224:227], a[160:163], v[216:219]
 s_add_u32 s49, s49, 2097152
 v_mfma_f32_16x16x32_bf16 v[212:215], a[224:227], a[152:155], v[212:215]
 v_mfma_f32_16x16x32_bf16 v[212:215], a[228:231], a[156:159], v[212:215]
 buffer_load_dwordx4 v6, s[8:11], s30 offen lds
 v_mfma_f32_16x16x32_bf16 v[208:211], a[228:231], a[148:151], v[208:211]
 v_mfma_f32_16x16x32_bf16 v[208:211], a[224:227], a[144:147], v[208:211]
 v_mfma_f32_16x16x32_bf16 v[204:207], a[224:227], a[136:139], v[204:207]
 v_mfma_f32_16x16x32_bf16 v[204:207], a[228:231], a[140:143], v[204:207]
 s_add_u32 m0, m0, 1024
 v_mfma_f32_16x16x32_bf16 v[200:203], a[228:231], a[132:135], v[200:203]
 v_mfma_f32_16x16x32_bf16 v[200:203], a[224:227], a[128:131], v[200:203]
 s_add_u32 s30, s30, s20
 buffer_load_dwordx4 v6, s[8:11], s30 offen lds
 s_waitcnt vmcnt(11)
 v_mfma_f32_16x16x32_bf16 v[232:235], a[192:195], a[128:131], v[232:235]
 ds_read_b128 a[128:131], v2 offset:32768
 v_mfma_f32_16x16x32_bf16 v[232:235], a[196:199], a[132:135], v[232:235]
 global_load_dwordx4 a[228:231], v0, s[70:71] offset:3072 sc1
 ds_read_b128 a[132:135], v2 offset:33792
 v_mfma_f32_16x16x32_bf16 v[236:239], a[196:199], a[140:143], v[236:239]
 ds_read_b128 a[140:143], v2 offset:37888
 v_mfma_f32_16x16x32_bf16 v[236:239], a[192:195], a[136:139], v[236:239]
 global_load_dwordx4 a[224:227], v0, s[70:71] offset:2048 sc1
 ds_read_b128 a[136:139], v2 offset:36864
 v_mfma_f32_16x16x32_bf16 v[240:243], a[192:195], a[144:147], v[240:243]
 s_add_u32 s70, s70, 8192
 s_addc_u32 s71, s71, 0
 ds_read_b128 a[144:147], v2 offset:40960
 v_mfma_f32_16x16x32_bf16 v[240:243], a[196:199], a[148:151], v[240:243]
 ds_read_b128 a[148:151], v2 offset:41984
 v_mfma_f32_16x16x32_bf16 v[244:247], a[196:199], a[156:159], v[244:247]
 ds_read_b128 a[156:159], v2 offset:46080
 v_mfma_f32_16x16x32_bf16 v[244:247], a[192:195], a[152:155], v[244:247]
 ds_read_b128 a[152:155], v2 offset:45056
 v_mfma_f32_16x16x32_bf16 v[248:251], a[192:195], a[160:163], v[248:251]
 ds_read_b128 a[160:163], v2 offset:49152
 s_add_u32 m0, m0, 3072
 v_mfma_f32_16x16x32_bf16 v[248:251], a[196:199], a[164:167], v[248:251]
 ds_read_b128 a[164:167], v2 offset:50176
 v_mfma_f32_16x16x32_bf16 v[252:255], a[196:199], a[172:175], v[252:255]
 ds_read_b128 a[172:175], v2 offset:54272
 v_mfma_f32_16x16x32_bf16 v[252:255], a[192:195], a[168:171], v[252:255]
 ds_read_b128 a[168:171], v2 offset:53248
 s_add_u32 s30, s30, s21
 v_mfma_f32_16x16x32_bf16 a[248:251], a[192:195], a[176:179], a[248:251]
 ds_read_b128 a[176:179], v2 offset:57344
 v_mfma_f32_16x16x32_bf16 a[248:251], a[196:199], a[180:183], a[248:251]
 ds_read_b128 a[180:183], v2 offset:58368
 v_mfma_f32_16x16x32_bf16 a[252:255], a[196:199], a[188:191], a[252:255]
 ds_read_b128 a[188:191], v2 offset:62464
 v_mfma_f32_16x16x32_bf16 a[252:255], a[192:195], a[184:187], a[252:255]
 ds_read_b128 a[184:187], v2 offset:61440
 s_waitcnt vmcnt(10) lgkmcnt(8)
 v_mfma_f32_16x16x32_bf16 v[16:19], a[200:203], a[128:131], v[16:19]
 v_mfma_f32_16x16x32_bf16 v[16:19], a[204:207], a[132:135], v[16:19]
 global_load_dwordx4 a[196:199], v0, s[70:71] offset:-3072 sc1
 v_mfma_f32_16x16x32_bf16 v[20:23], a[204:207], a[140:143], v[20:23]
 v_mfma_f32_16x16x32_bf16 v[20:23], a[200:203], a[136:139], v[20:23]
 global_load_dwordx4 a[192:195], v0, s[70:71] offset:-4096 sc1
 v_mfma_f32_16x16x32_bf16 v[24:27], a[200:203], a[144:147], v[24:27]
 v_mfma_f32_16x16x32_bf16 v[24:27], a[204:207], a[148:151], v[24:27]
 v_mfma_f32_16x16x32_bf16 v[28:31], a[204:207], a[156:159], v[28:31]
 v_mfma_f32_16x16x32_bf16 v[28:31], a[200:203], a[152:155], v[28:31]
 s_waitcnt lgkmcnt(0)
 v_mfma_f32_16x16x32_bf16 v[32:35], a[200:203], a[160:163], v[32:35]
 v_mfma_f32_16x16x32_bf16 v[32:35], a[204:207], a[164:167], v[32:35]
 v_mfma_f32_16x16x32_bf16 v[36:39], a[204:207], a[172:175], v[36:39]
 v_mfma_f32_16x16x32_bf16 v[36:39], a[200:203], a[168:171], v[36:39]
 v_mfma_f32_16x16x32_bf16 v[40:43], a[200:203], a[176:179], v[40:43]
 v_mfma_f32_16x16x32_bf16 v[40:43], a[204:207], a[180:183], v[40:43]
 v_mfma_f32_16x16x32_bf16 v[44:47], a[204:207], a[188:191], v[44:47]
 v_mfma_f32_16x16x32_bf16 v[44:47], a[200:203], a[184:187], v[44:47]
 s_waitcnt vmcnt(10)
 v_mfma_f32_16x16x32_bf16 v[76:79], a[208:211], a[184:187], v[76:79]
 v_mfma_f32_16x16x32_bf16 v[76:79], a[212:215], a[188:191], v[76:79]
 global_load_dwordx4 a[204:207], v0, s[70:71] offset:-1024 sc1
 v_mfma_f32_16x16x32_bf16 v[72:75], a[212:215], a[180:183], v[72:75]
 v_mfma_f32_16x16x32_bf16 v[72:75], a[208:211], a[176:179], v[72:75]
 global_load_dwordx4 a[200:203], v0, s[70:71] offset:-2048 sc1
 v_mfma_f32_16x16x32_bf16 v[68:71], a[208:211], a[168:171], v[68:71]
 v_mfma_f32_16x16x32_bf16 v[68:71], a[212:215], a[172:175], v[68:71]
 v_mfma_f32_16x16x32_bf16 v[64:67], a[212:215], a[164:167], v[64:67]
 v_mfma_f32_16x16x32_bf16 v[64:67], a[208:211], a[160:163], v[64:67]
 v_mfma_f32_16x16x32_bf16 v[60:63], a[208:211], a[152:155], v[60:63]
 v_mfma_f32_16x16x32_bf16 v[60:63], a[212:215], a[156:159], v[60:63]
 v_mfma_f32_16x16x32_bf16 v[56:59], a[212:215], a[148:151], v[56:59]
 v_mfma_f32_16x16x32_bf16 v[56:59], a[208:211], a[144:147], v[56:59]
 v_mfma_f32_16x16x32_bf16 v[52:55], a[208:211], a[136:139], v[52:55]
 v_mfma_f32_16x16x32_bf16 v[52:55], a[212:215], a[140:143], v[52:55]
 v_mfma_f32_16x16x32_bf16 v[48:51], a[212:215], a[132:135], v[48:51]
 v_mfma_f32_16x16x32_bf16 v[48:51], a[208:211], a[128:131], v[48:51]
 s_waitcnt vmcnt(10)
 v_mfma_f32_16x16x32_bf16 v[80:83], a[216:219], a[128:131], v[80:83]
 v_mfma_f32_16x16x32_bf16 v[80:83], a[220:223], a[132:135], v[80:83]
 global_load_dwordx4 a[212:215], v0, s[70:71] offset:1024 sc1
 v_mfma_f32_16x16x32_bf16 v[84:87], a[220:223], a[140:143], v[84:87]
 v_mfma_f32_16x16x32_bf16 v[84:87], a[216:219], a[136:139], v[84:87]
 global_load_dwordx4 a[208:211], v0, s[70:71] offset:0 sc1
 v_mfma_f32_16x16x32_bf16 v[88:91], a[216:219], a[144:147], v[88:91]
 buffer_load_dwordx4 v6, s[8:11], s30 offen lds
 v_mfma_f32_16x16x32_bf16 v[88:91], a[220:223], a[148:151], v[88:91]
 v_mfma_f32_16x16x32_bf16 v[92:95], a[220:223], a[156:159], v[92:95]
 v_mfma_f32_16x16x32_bf16 v[92:95], a[216:219], a[152:155], v[92:95]
 s_add_u32 m0, m0, 1024
 v_mfma_f32_16x16x32_bf16 v[96:99], a[216:219], a[160:163], v[96:99]
 v_mfma_f32_16x16x32_bf16 v[96:99], a[220:223], a[164:167], v[96:99]
 v_mfma_f32_16x16x32_bf16 v[100:103], a[220:223], a[172:175], v[100:103]
 v_mfma_f32_16x16x32_bf16 v[100:103], a[216:219], a[168:171], v[100:103]
 s_add_u32 s30, s30, s20
 v_mfma_f32_16x16x32_bf16 v[104:107], a[216:219], a[176:179], v[104:107]
 v_mfma_f32_16x16x32_bf16 v[104:107], a[220:223], a[180:183], v[104:107]
 v_mfma_f32_16x16x32_bf16 v[108:111], a[220:223], a[188:191], v[108:111]
 buffer_load_dwordx4 v6, s[8:11], s30 offen lds
 v_mfma_f32_16x16x32_bf16 v[108:111], a[216:219], a[184:187], v[108:111]
 s_waitcnt vmcnt(8)
 v_mfma_f32_16x16x32_bf16 a[244:247], a[224:227], a[184:187], a[244:247]
 v_mfma_f32_16x16x32_bf16 a[244:247], a[228:231], a[188:191], a[244:247]
 global_load_dwordx4 a[220:223], v0, s[70:71] offset:3072 sc1
 v_mfma_f32_16x16x32_bf16 a[240:243], a[228:231], a[180:183], a[240:243]
 s_add_u32 m0, m0, 3072
 v_mfma_f32_16x16x32_bf16 a[240:243], a[224:227], a[176:179], a[240:243]
 global_load_dwordx4 a[216:219], v0, s[70:71] offset:2048 sc1
 v_mfma_f32_16x16x32_bf16 v[132:135], a[224:227], a[168:171], v[132:135]
 s_add_u32 s70, s70, 8192
 s_addc_u32 s71, s71, 0
 v_mfma_f32_16x16x32_bf16 v[132:135], a[228:231], a[172:175], v[132:135]
 v_mfma_f32_16x16x32_bf16 v[128:131], a[228:231], a[164:167], v[128:131]
 s_add_u32 s30, s30, s22
 v_mfma_f32_16x16x32_bf16 v[128:131], a[224:227], a[160:163], v[128:131]
 v_mfma_f32_16x16x32_bf16 v[124:127], a[224:227], a[152:155], v[124:127]
 v_mfma_f32_16x16x32_bf16 v[124:127], a[228:231], a[156:159], v[124:127]
 v_mfma_f32_16x16x32_bf16 v[120:123], a[228:231], a[148:151], v[120:123]
 v_mfma_f32_16x16x32_bf16 v[120:123], a[224:227], a[144:147], v[120:123]
 v_mfma_f32_16x16x32_bf16 v[116:119], a[224:227], a[136:139], v[116:119]
 v_mfma_f32_16x16x32_bf16 v[116:119], a[228:231], a[140:143], v[116:119]
 v_mfma_f32_16x16x32_bf16 v[112:115], a[228:231], a[132:135], v[112:115]
 v_mfma_f32_16x16x32_bf16 v[112:115], a[224:227], a[128:131], v[112:115]
 s_waitcnt vmcnt(8)
 v_mfma_f32_16x16x32_bf16 v[136:139], a[192:195], a[128:131], v[136:139]
 v_mfma_f32_16x16x32_bf16 v[136:139], a[196:199], a[132:135], v[136:139]
 global_load_dwordx4 a[228:231], v0, s[70:71] offset:-3072 sc1
 v_mfma_f32_16x16x32_bf16 v[140:143], a[196:199], a[140:143], v[140:143]
 v_mfma_f32_16x16x32_bf16 v[140:143], a[192:195], a[136:139], v[140:143]
 global_load_dwordx4 a[224:227], v0, s[70:71] offset:-4096 sc1
 v_mfma_f32_16x16x32_bf16 v[144:147], a[192:195], a[144:147], v[144:147]
 v_mfma_f32_16x16x32_bf16 v[144:147], a[196:199], a[148:151], v[144:147]
 global_load_dwordx4 a[236:239], v0, s[70:71] offset:-1024 sc1
 v_mfma_f32_16x16x32_bf16 v[148:151], a[196:199], a[156:159], v[148:151]
 v_mfma_f32_16x16x32_bf16 v[148:151], a[192:195], a[152:155], v[148:151]
 global_load_dwordx4 a[232:235], v0, s[70:71] offset:-2048 sc1
 v_mfma_f32_16x16x32_bf16 v[152:155], a[192:195], a[160:163], v[152:155]
 v_mfma_f32_16x16x32_bf16 v[152:155], a[196:199], a[164:167], v[152:155]
 v_mfma_f32_16x16x32_bf16 v[156:159], a[196:199], a[172:175], v[156:159]
 v_mfma_f32_16x16x32_bf16 v[156:159], a[192:195], a[168:171], v[156:159]
 v_mfma_f32_16x16x32_bf16 v[160:163], a[192:195], a[176:179], v[160:163]
 v_mfma_f32_16x16x32_bf16 v[160:163], a[196:199], a[180:183], v[160:163]
 v_mfma_f32_16x16x32_bf16 v[164:167], a[196:199], a[188:191], v[164:167]
 v_mfma_f32_16x16x32_bf16 v[164:167], a[192:195], a[184:187], v[164:167]
 s_waitcnt vmcnt(10)
 v_mfma_f32_16x16x32_bf16 v[196:199], a[200:203], a[184:187], v[196:199]
 v_mfma_f32_16x16x32_bf16 v[196:199], a[204:207], a[188:191], v[196:199]
 global_load_dwordx4 a[196:199], v0, s[70:71] offset:1024 sc1
 v_mfma_f32_16x16x32_bf16 v[192:195], a[204:207], a[180:183], v[192:195]
 v_mfma_f32_16x16x32_bf16 v[192:195], a[200:203], a[176:179], v[192:195]
 global_load_dwordx4 a[192:195], v0, s[70:71] offset:0 sc1
 v_mfma_f32_16x16x32_bf16 v[188:191], a[200:203], a[168:171], v[188:191]
 v_mfma_f32_16x16x32_bf16 v[188:191], a[204:207], a[172:175], v[188:191]
 v_mfma_f32_16x16x32_bf16 v[184:187], a[204:207], a[164:167], v[184:187]
 v_mfma_f32_16x16x32_bf16 v[184:187], a[200:203], a[160:163], v[184:187]
 v_mfma_f32_16x16x32_bf16 v[180:183], a[200:203], a[152:155], v[180:183]
 v_mfma_f32_16x16x32_bf16 v[180:183], a[204:207], a[156:159], v[180:183]
 v_mfma_f32_16x16x32_bf16 v[176:179], a[204:207], a[148:151], v[176:179]
 v_mfma_f32_16x16x32_bf16 v[176:179], a[200:203], a[144:147], v[176:179]
 v_mfma_f32_16x16x32_bf16 v[172:175], a[200:203], a[136:139], v[172:175]
 v_mfma_f32_16x16x32_bf16 v[172:175], a[204:207], a[140:143], v[172:175]
 v_mfma_f32_16x16x32_bf16 v[168:171], a[204:207], a[132:135], v[168:171]
 v_mfma_f32_16x16x32_bf16 v[168:171], a[200:203], a[128:131], v[168:171]
 s_waitcnt vmcnt(10)
 v_mfma_f32_16x16x32_bf16 v[200:203], a[208:211], a[128:131], v[200:203]
 v_mfma_f32_16x16x32_bf16 v[200:203], a[212:215], a[132:135], v[200:203]
 global_load_dwordx4 a[204:207], v0, s[70:71] offset:3072 sc1
 v_mfma_f32_16x16x32_bf16 v[204:207], a[212:215], a[140:143], v[204:207]
 v_mfma_f32_16x16x32_bf16 v[204:207], a[208:211], a[136:139], v[204:207]
 global_load_dwordx4 a[200:203], v0, s[70:71] offset:2048 sc1
 v_mfma_f32_16x16x32_bf16 v[208:211], a[208:211], a[144:147], v[208:211]
 s_add_u32 s70, s70, 8192
 s_addc_u32 s71, s71, 0
 v_mfma_f32_16x16x32_bf16 v[208:211], a[212:215], a[148:151], v[208:211]
 v_mfma_f32_16x16x32_bf16 v[212:215], a[212:215], a[156:159], v[212:215]
 v_mfma_f32_16x16x32_bf16 v[212:215], a[208:211], a[152:155], v[212:215]
 v_mfma_f32_16x16x32_bf16 v[216:219], a[208:211], a[160:163], v[216:219]
 v_mfma_f32_16x16x32_bf16 v[216:219], a[212:215], a[164:167], v[216:219]
 v_mfma_f32_16x16x32_bf16 v[220:223], a[212:215], a[172:175], v[220:223]
 s_waitcnt vmcnt(10)
 s_waitcnt lgkmcnt(0)
 s_barrier
 v_mfma_f32_16x16x32_bf16 v[220:223], a[208:211], a[168:171], v[220:223]
 v_mfma_f32_16x16x32_bf16 v[224:227], a[208:211], a[176:179], v[224:227]
 v_mfma_f32_16x16x32_bf16 v[224:227], a[212:215], a[180:183], v[224:227]
 v_mfma_f32_16x16x32_bf16 v[228:231], a[212:215], a[188:191], v[228:231]
 v_mfma_f32_16x16x32_bf16 v[228:231], a[208:211], a[184:187], v[228:231]
 s_waitcnt vmcnt(8)
 v_mfma_f32_16x16x32_bf16 a[252:255], a[216:219], a[184:187], a[252:255]
 ds_read_b128 a[184:187], v1 offset:30720
 v_mfma_f32_16x16x32_bf16 a[252:255], a[220:223], a[188:191], a[252:255]
 global_load_dwordx4 a[212:215], v0, s[70:71] offset:-3072 sc1
 ds_read_b128 a[188:191], v1 offset:31744
 v_mfma_f32_16x16x32_bf16 a[248:251], a[220:223], a[180:183], a[248:251]
 ds_read_b128 a[180:183], v1 offset:27648
 v_mfma_f32_16x16x32_bf16 a[248:251], a[216:219], a[176:179], a[248:251]
 global_load_dwordx4 a[208:211], v0, s[70:71] offset:-4096 sc1
 ds_read_b128 a[176:179], v1 offset:26624
 v_mfma_f32_16x16x32_bf16 v[252:255], a[216:219], a[168:171], v[252:255]
 ds_read_b128 a[168:171], v1 offset:22528
 v_mfma_f32_16x16x32_bf16 v[252:255], a[220:223], a[172:175], v[252:255]
 ds_read_b128 a[172:175], v1 offset:23552
 v_mfma_f32_16x16x32_bf16 v[248:251], a[220:223], a[164:167], v[248:251]
 ds_read_b128 a[164:167], v1 offset:19456
 v_mfma_f32_16x16x32_bf16 v[248:251], a[216:219], a[160:163], v[248:251]
 ds_read_b128 a[160:163], v1 offset:18432
 v_mfma_f32_16x16x32_bf16 v[244:247], a[216:219], a[152:155], v[244:247]
 ds_read_b128 a[152:155], v1 offset:14336
 v_mfma_f32_16x16x32_bf16 v[244:247], a[220:223], a[156:159], v[244:247]
 ds_read_b128 a[156:159], v1 offset:15360
 v_mfma_f32_16x16x32_bf16 v[240:243], a[220:223], a[148:151], v[240:243]
 ds_read_b128 a[148:151], v1 offset:11264
 v_mfma_f32_16x16x32_bf16 v[240:243], a[216:219], a[144:147], v[240:243]
 ds_read_b128 a[144:147], v1 offset:10240
 v_mfma_f32_16x16x32_bf16 v[236:239], a[216:219], a[136:139], v[236:239]
 ds_read_b128 a[136:139], v1 offset:6144
 v_mfma_f32_16x16x32_bf16 v[236:239], a[220:223], a[140:143], v[236:239]
 ds_read_b128 a[140:143], v1 offset:7168
 v_mfma_f32_16x16x32_bf16 v[232:235], a[220:223], a[132:135], v[232:235]
 global_load_dwordx4 a[220:223], v0, s[70:71] offset:-1024 sc1
 ds_read_b128 a[132:135], v1 offset:3072
 v_mfma_f32_16x16x32_bf16 v[232:235], a[216:219], a[128:131], v[232:235]
 global_load_dwordx4 a[216:219], v0, s[70:71] offset:-2048 sc1
 ds_read_b128 a[128:131], v1 offset:2048
 s_waitcnt vmcnt(10) lgkmcnt(8)
 v_mfma_f32_16x16x32_bf16 v[44:47], a[224:227], a[184:187], v[44:47]
 v_mov_b32 v7, 1
 v_mfma_f32_16x16x32_bf16 v[44:47], a[228:231], a[188:191], v[44:47]
 v_mfma_f32_16x16x32_bf16 v[40:43], a[228:231], a[180:183], v[40:43]
 buffer_atomic_add v7, v0, s[56:59], 0 offen sc1
 v_mfma_f32_16x16x32_bf16 v[40:43], a[224:227], a[176:179], v[40:43]
 v_bfe_u32 v4, v3, 8, 2
 v_mfma_f32_16x16x32_bf16 v[36:39], a[224:227], a[168:171], v[36:39]
 v_mfma_f32_16x16x32_bf16 v[36:39], a[228:231], a[172:175], v[36:39]
 v_lshl_add_u32 v4, v4, 5, s51
 v_mfma_f32_16x16x32_bf16 v[32:35], a[228:231], a[164:167], v[32:35]
 ds_read_b128 v[8:11], v4 offset:256
 v_mfma_f32_16x16x32_bf16 v[32:35], a[224:227], a[160:163], v[32:35]
 s_waitcnt lgkmcnt(1)
 v_mfma_f32_16x16x32_bf16 v[28:31], a[224:227], a[152:155], v[28:31]
 v_mfma_f32_16x16x32_bf16 v[28:31], a[228:231], a[156:159], v[28:31]
 v_mfma_f32_16x16x32_bf16 v[24:27], a[228:231], a[148:151], v[24:27]
 v_mfma_f32_16x16x32_bf16 v[24:27], a[224:227], a[144:147], v[24:27]
 v_mfma_f32_16x16x32_bf16 v[20:23], a[224:227], a[136:139], v[20:23]
 v_mfma_f32_16x16x32_bf16 v[20:23], a[228:231], a[140:143], v[20:23]
 v_mfma_f32_16x16x32_bf16 v[16:19], a[228:231], a[132:135], v[16:19]
 v_mfma_f32_16x16x32_bf16 v[16:19], a[224:227], a[128:131], v[16:19]
 s_waitcnt vmcnt(9)
 v_mfma_f32_16x16x32_bf16 v[48:51], a[232:235], a[128:131], v[48:51]
 v_mfma_f32_16x16x32_bf16 v[48:51], a[236:239], a[132:135], v[48:51]
 global_load_dwordx4 a[228:231], v0, s[70:71] offset:1024 sc1
 v_mfma_f32_16x16x32_bf16 v[52:55], a[236:239], a[140:143], v[52:55]
 v_mfma_f32_16x16x32_bf16 v[52:55], a[232:235], a[136:139], v[52:55]
 global_load_dwordx4 a[224:227], v0, s[70:71] offset:0 sc1
 v_mfma_f32_16x16x32_bf16 v[56:59], a[232:235], a[144:147], v[56:59]
 s_waitcnt lgkmcnt(0)
 v_mfma_f32_16x16x32_bf16 v[56:59], a[236:239], a[148:151], v[56:59]
 v_mfma_f32_16x16x32_bf16 v[60:63], a[236:239], a[156:159], v[60:63]
 v_add_f32 v136, v136, v8
 v_mfma_f32_16x16x32_bf16 v[60:63], a[232:235], a[152:155], v[60:63]
 v_mfma_f32_16x16x32_bf16 v[64:67], a[232:235], a[160:163], v[64:67]
 ds_read_b128 v[12:15], v4 offset:272
 v_mfma_f32_16x16x32_bf16 v[64:67], a[236:239], a[164:167], v[64:67]
 v_add_f32 v137, v137, v9
 v_mfma_f32_16x16x32_bf16 v[68:71], a[236:239], a[172:175], v[68:71]
 v_mfma_f32_16x16x32_bf16 v[68:71], a[232:235], a[168:171], v[68:71]
 v_add_f32 v138, v138, v10
 v_mfma_f32_16x16x32_bf16 v[72:75], a[232:235], a[176:179], v[72:75]
 v_add_f32 v139, v139, v11
 v_mfma_f32_16x16x32_bf16 v[72:75], a[236:239], a[180:183], v[72:75]
 v_mfma_f32_16x16x32_bf16 v[76:79], a[236:239], a[188:191], v[76:79]
 v_add_f32 v140, v140, v8
 v_mfma_f32_16x16x32_bf16 v[76:79], a[232:235], a[184:187], v[76:79]
 v_add_f32 v141, v141, v9
 s_waitcnt vmcnt(9)
 v_mfma_f32_16x16x32_bf16 v[108:111], a[192:195], a[184:187], v[108:111]
 v_mfma_f32_16x16x32_bf16 v[108:111], a[196:199], a[188:191], v[108:111]
 global_load_dwordx4 a[236:239], v0, s[70:71] offset:3072 sc1
 v_add_f32 v142, v142, v10
 v_mfma_f32_16x16x32_bf16 v[104:107], a[196:199], a[180:183], v[104:107]
 v_add_f32 v143, v143, v11
 v_mfma_f32_16x16x32_bf16 v[104:107], a[192:195], a[176:179], v[104:107]
 global_load_dwordx4 a[232:235], v0, s[70:71] offset:2048 sc1
 v_mfma_f32_16x16x32_bf16 v[100:103], a[192:195], a[168:171], v[100:103]
 v_add_f32 v144, v144, v8
 s_add_u32 s70, s70, 8192
 s_addc_u32 s71, s71, 0
 v_mfma_f32_16x16x32_bf16 v[100:103], a[196:199], a[172:175], v[100:103]
 v_mfma_f32_16x16x32_bf16 v[96:99], a[196:199], a[164:167], v[96:99]
 v_add_f32 v145, v145, v9
 v_mfma_f32_16x16x32_bf16 v[96:99], a[192:195], a[160:163], v[96:99]
 v_add_f32 v146, v146, v10
 v_mfma_f32_16x16x32_bf16 v[92:95], a[192:195], a[152:155], v[92:95]
 v_mfma_f32_16x16x32_bf16 v[92:95], a[196:199], a[156:159], v[92:95]
 v_add_f32 v147, v147, v11
 v_mfma_f32_16x16x32_bf16 v[88:91], a[196:199], a[148:151], v[88:91]
 v_add_f32 v148, v148, v8
 v_mfma_f32_16x16x32_bf16 v[88:91], a[192:195], a[144:147], v[88:91]
 v_mfma_f32_16x16x32_bf16 v[84:87], a[192:195], a[136:139], v[84:87]
 v_add_f32 v149, v149, v9
 v_mfma_f32_16x16x32_bf16 v[84:87], a[196:199], a[140:143], v[84:87]
 v_add_f32 v150, v150, v10
 v_mfma_f32_16x16x32_bf16 v[80:83], a[196:199], a[132:135], v[80:83]
 v_mfma_f32_16x16x32_bf16 v[80:83], a[192:195], a[128:131], v[80:83]
 v_add_f32 v151, v151, v11
 s_waitcnt vmcnt(9)
 v_mfma_f32_16x16x32_bf16 v[112:115], a[200:203], a[128:131], v[112:115]
 ds_read_b128 a[128:131], v1 offset:34816
 v_add_f32 v152, v152, v8
 v_mfma_f32_16x16x32_bf16 v[112:115], a[204:207], a[132:135], v[112:115]
 global_load_dwordx4 a[196:199], v0, s[70:71] offset:-3072 sc1
 ds_read_b128 a[132:135], v1 offset:35840
 v_mfma_f32_16x16x32_bf16 v[116:119], a[204:207], a[140:143], v[116:119]
 ds_read_b128 a[140:143], v1 offset:39936
 v_add_f32 v153, v153, v9
 v_mfma_f32_16x16x32_bf16 v[116:119], a[200:203], a[136:139], v[116:119]
 global_load_dwordx4 a[192:195], v0, s[70:71] offset:-4096 sc1
 ds_read_b128 a[136:139], v1 offset:38912
 v_mfma_f32_16x16x32_bf16 v[120:123], a[200:203], a[144:147], v[120:123]
 ds_read_b128 a[144:147], v1 offset:43008
 v_add_f32 v154, v154, v10
 v_mfma_f32_16x16x32_bf16 v[120:123], a[204:207], a[148:151], v[120:123]
 ds_read_b128 a[148:151], v1 offset:44032
 v_add_f32 v155, v155, v11
 v_mfma_f32_16x16x32_bf16 v[124:127], a[204:207], a[156:159], v[124:127]
 ds_read_b128 a[156:159], v1 offset:48128
 v_mfma_f32_16x16x32_bf16 v[124:127], a[200:203], a[152:155], v[124:127]
 ds_read_b128 a[152:155], v1 offset:47104
 v_add_f32 v156, v156, v8
 v_mfma_f32_16x16x32_bf16 v[128:131], a[200:203], a[160:163], v[128:131]
 ds_read_b128 a[160:163], v1 offset:51200
 v_add_f32 v157, v157, v9
 v_mfma_f32_16x16x32_bf16 v[128:131], a[204:207], a[164:167], v[128:131]
 ds_read_b128 a[164:167], v1 offset:52224
 v_mfma_f32_16x16x32_bf16 v[132:135], a[204:207], a[172:175], v[132:135]
 ds_read_b128 a[172:175], v1 offset:56320
 v_add_f32 v158, v158, v10
 v_mfma_f32_16x16x32_bf16 v[132:135], a[200:203], a[168:171], v[132:135]
 ds_read_b128 a[168:171], v1 offset:55296
 v_add_f32 v159, v159, v11
 v_mfma_f32_16x16x32_bf16 a[240:243], a[200:203], a[176:179], a[240:243]
 ds_read_b128 a[176:179], v1 offset:59392
 v_mfma_f32_16x16x32_bf16 a[240:243], a[204:207], a[180:183], a[240:243]
 ds_read_b128 a[180:183], v1 offset:60416
 v_add_f32 v160, v160, v8
 v_mfma_f32_16x16x32_bf16 a[244:247], a[204:207], a[188:191], a[244:247]
 ds_read_b128 a[188:191], v1 offset:64512
 v_add_f32 v161, v161, v9
 v_mfma_f32_16x16x32_bf16 a[244:247], a[200:203], a[184:187], a[244:247]
 ds_read_b128 a[184:187], v1 offset:63488
 s_waitcnt vmcnt(9) lgkmcnt(8)
 v_mfma_f32_16x16x32_bf16 v[16:19], a[208:211], a[128:131], v[16:19]
 v_add_f32 v162, v162, v10
 v_mfma_f32_16x16x32_bf16 v[16:19], a[212:215], a[132:135], v[16:19]
 global_load_dwordx4 a[204:207], v0, s[70:71] offset:-1024 sc1
 v_mfma_f32_16x16x32_bf16 v[20:23], a[212:215], a[140:143], v[20:23]
 v_add_f32 v163, v163, v11
 v_mfma_f32_16x16x32_bf16 v[20:23], a[208:211], a[136:139], v[20:23]
 global_load_dwordx4 a[200:203], v0, s[70:71] offset:-2048 sc1
 v_add_f32 v164, v164, v8
 v_mfma_f32_16x16x32_bf16 v[24:27], a[208:211], a[144:147], v[24:27]
 v_mfma_f32_16x16x32_bf16 v[24:27], a[212:215], a[148:151], v[24:27]
 v_add_f32 v165, v165, v9
 v_mfma_f32_16x16x32_bf16 v[28:31], a[212:215], a[156:159], v[28:31]
 v_add_f32 v166, v166, v10
 v_mfma_f32_16x16x32_bf16 v[28:31], a[208:211], a[152:155], v[28:31]
 s_waitcnt lgkmcnt(0)
 v_mfma_f32_16x16x32_bf16 v[32:35], a[208:211], a[160:163], v[32:35]
 v_add_f32 v167, v167, v11
 v_mfma_f32_16x16x32_bf16 v[32:35], a[212:215], a[164:167], v[32:35]
 v_mfma_f32_16x16x32_bf16 v[36:39], a[212:215], a[172:175], v[36:39]
 v_mfma_f32_16x16x32_bf16 v[36:39], a[208:211], a[168:171], v[36:39]
 v_add_f32 v168, v168, v12
 v_mfma_f32_16x16x32_bf16 v[40:43], a[208:211], a[176:179], v[40:43]
 ds_read_b128 v[8:11], v4 offset:384
 v_mfma_f32_16x16x32_bf16 v[40:43], a[212:215], a[180:183], v[40:43]
 v_mfma_f32_16x16x32_bf16 v[44:47], a[212:215], a[188:191], v[44:47]
 v_add_f32 v169, v169, v13
 v_mfma_f32_16x16x32_bf16 v[44:47], a[208:211], a[184:187], v[44:47]
 s_waitcnt vmcnt(9)
 v_mfma_f32_16x16x32_bf16 v[76:79], a[216:219], a[184:187], v[76:79]
 v_add_f32 v170, v170, v14
 v_mfma_f32_16x16x32_bf16 v[76:79], a[220:223], a[188:191], v[76:79]
 global_load_dwordx4 a[212:215], v0, s[70:71] offset:1024 sc1
 v_add_f32 v171, v171, v15
 v_mfma_f32_16x16x32_bf16 v[72:75], a[220:223], a[180:183], v[72:75]
 v_mfma_f32_16x16x32_bf16 v[72:75], a[216:219], a[176:179], v[72:75]
 global_load_dwordx4 a[208:211], v0, s[70:71] offset:0 sc1
 v_add_f32 v172, v172, v12
 v_mfma_f32_16x16x32_bf16 v[68:71], a[216:219], a[168:171], v[68:71]
 v_add_f32 v173, v173, v13
 v_mfma_f32_16x16x32_bf16 v[68:71], a[220:223], a[172:175], v[68:71]
 v_mfma_f32_16x16x32_bf16 v[64:67], a[220:223], a[164:167], v[64:67]
 v_add_f32 v174, v174, v14
 v_mfma_f32_16x16x32_bf16 v[64:67], a[216:219], a[160:163], v[64:67]
 v_add_f32 v175, v175, v15
 v_mfma_f32_16x16x32_bf16 v[60:63], a[216:219], a[152:155], v[60:63]
 v_mfma_f32_16x16x32_bf16 v[60:63], a[220:223], a[156:159], v[60:63]
 v_add_f32 v176, v176, v12
 v_mfma_f32_16x16x32_bf16 v[56:59], a[220:223], a[148:151], v[56:59]
 v_add_f32 v177, v177, v13
 v_mfma_f32_16x16x32_bf16 v[56:59], a[216:219], a[144:147], v[56:59]
 v_mfma_f32_16x16x32_bf16 v[52:55], a[216:219], a[136:139], v[52:55]
 v_add_f32 v178, v178, v14
 v_mfma_f32_16x16x32_bf16 v[52:55], a[220:223], a[140:143], v[52:55]
 v_mfma_f32_16x16x32_bf16 v[48:51], a[220:223], a[132:135], v[48:51]
 v_add_f32 v179, v179, v15
 v_mfma_f32_16x16x32_bf16 v[48:51], a[216:219], a[128:131], v[48:51]
 v_add_f32 v180, v180, v12
 s_waitcnt vmcnt(8)
 v_mfma_f32_16x16x32_bf16 v[80:83], a[224:227], a[128:131], v[80:83]
 v_mfma_f32_16x16x32_bf16 v[80:83], a[228:231], a[132:135], v[80:83]
 global_load_dwordx4 a[220:223], v0, s[70:71] offset:3072 sc1
 v_add_f32 v181, v181, v13
 v_mfma_f32_16x16x32_bf16 v[84:87], a[228:231], a[140:143], v[84:87]
 v_add_f32 v182, v182, v14
 v_mfma_f32_16x16x32_bf16 v[84:87], a[224:227], a[136:139], v[84:87]
 global_load_dwordx4 a[216:219], v0, s[70:71] offset:2048 sc1
 v_mfma_f32_16x16x32_bf16 v[88:91], a[224:227], a[144:147], v[88:91]
 v_add_f32 v183, v183, v15
 s_add_u32 s70, s70, 8192
 s_addc_u32 s71, s71, 0
 v_mfma_f32_16x16x32_bf16 v[88:91], a[228:231], a[148:151], v[88:91]
 v_add_f32 v184, v184, v12
 v_mfma_f32_16x16x32_bf16 v[92:95], a[228:231], a[156:159], v[92:95]
 v_mfma_f32_16x16x32_bf16 v[92:95], a[224:227], a[152:155], v[92:95]
 v_add_f32 v185, v185, v13
 v_mfma_f32_16x16x32_bf16 v[96:99], a[224:227], a[160:163], v[96:99]
 v_add_f32 v186, v186, v14
 v_mfma_f32_16x16x32_bf16 v[96:99], a[228:231], a[164:167], v[96:99]
 v_mfma_f32_16x16x32_bf16 v[100:103], a[228:231], a[172:175], v[100:103]
 v_add_f32 v187, v187, v15
 v_mfma_f32_16x16x32_bf16 v[100:103], a[224:227], a[168:171], v[100:103]
 v_mfma_f32_16x16x32_bf16 v[104:107], a[224:227], a[176:179], v[104:107]
 v_add_f32 v188, v188, v12
 v_mfma_f32_16x16x32_bf16 v[104:107], a[228:231], a[180:183], v[104:107]
 v_add_f32 v189, v189, v13
 v_mfma_f32_16x16x32_bf16 v[108:111], a[228:231], a[188:191], v[108:111]
 v_mfma_f32_16x16x32_bf16 v[108:111], a[224:227], a[184:187], v[108:111]
 v_add_f32 v190, v190, v14
 s_waitcnt vmcnt(8)
 v_mfma_f32_16x16x32_bf16 a[244:247], a[232:235], a[184:187], a[244:247]
 ds_read_b128 a[184:187], v2 offset:30720
 v_add_f32 v191, v191, v15
 v_mfma_f32_16x16x32_bf16 a[244:247], a[236:239], a[188:191], a[244:247]
 global_load_dwordx4 a[228:231], v0, s[70:71] offset:-3072 sc1
 ds_read_b128 a[188:191], v2 offset:31744
 v_mfma_f32_16x16x32_bf16 a[240:243], a[236:239], a[180:183], a[240:243]
 ds_read_b128 a[180:183], v2 offset:27648
 v_add_f32 v192, v192, v12
 v_mfma_f32_16x16x32_bf16 a[240:243], a[232:235], a[176:179], a[240:243]
 global_load_dwordx4 a[224:227], v0, s[70:71] offset:-4096 sc1
 ds_read_b128 a[176:179], v2 offset:26624
 v_mfma_f32_16x16x32_bf16 v[132:135], a[232:235], a[168:171], v[132:135]
 ds_read_b128 a[168:171], v2 offset:22528
 v_add_f32 v193, v193, v13
 v_mfma_f32_16x16x32_bf16 v[132:135], a[236:239], a[172:175], v[132:135]
 ds_read_b128 a[172:175], v2 offset:23552
 v_add_f32 v194, v194, v14
 v_mfma_f32_16x16x32_bf16 v[128:131], a[236:239], a[164:167], v[128:131]
 ds_read_b128 a[164:167], v2 offset:19456
 v_add_f32 v195, v195, v15
 v_mfma_f32_16x16x32_bf16 v[128:131], a[232:235], a[160:163], v[128:131]
 ds_read_b128 a[160:163], v2 offset:18432
 v_mfma_f32_16x16x32_bf16 v[124:127], a[232:235], a[152:155], v[124:127]
 ds_read_b128 a[152:155], v2 offset:14336
 v_add_f32 v196, v196, v12
 v_mfma_f32_16x16x32_bf16 v[124:127], a[236:239], a[156:159], v[124:127]
 ds_read_b128 a[156:159], v2 offset:15360
 v_mfma_f32_16x16x32_bf16 v[120:123], a[236:239], a[148:151], v[120:123]
 ds_read_b128 a[148:151], v2 offset:11264
 v_add_f32 v197, v197, v13
 v_mfma_f32_16x16x32_bf16 v[120:123], a[232:235], a[144:147], v[120:123]
 ds_read_b128 a[144:147], v2 offset:10240
 v_add_f32 v198, v198, v14
 v_mfma_f32_16x16x32_bf16 v[116:119], a[232:235], a[136:139], v[116:119]
 ds_read_b128 a[136:139], v2 offset:6144
 v_mfma_f32_16x16x32_bf16 v[116:119], a[236:239], a[140:143], v[116:119]
 ds_read_b128 a[140:143], v2 offset:7168
 v_add_f32 v199, v199, v15
 v_mfma_f32_16x16x32_bf16 v[112:115], a[236:239], a[132:135], v[112:115]
 ds_read_b128 a[132:135], v2 offset:3072
 s_waitcnt lgkmcnt(15)
 v_mfma_f32_16x16x32_bf16 v[112:115], a[232:235], a[128:131], v[112:115]
 ds_read_b128 a[128:131], v2 offset:2048
 s_waitcnt vmcnt(8) lgkmcnt(8)
 v_mfma_f32_16x16x32_bf16 v[44:47], a[192:195], a[184:187], v[44:47]
 v_add_f32 v200, v200, v8
 v_mfma_f32_16x16x32_bf16 v[44:47], a[196:199], a[188:191], v[44:47]
 global_load_dwordx4 a[236:239], v0, s[70:71] offset:-1024 sc1
 ds_read_b128 v[12:15], v4 offset:400
 v_mfma_f32_16x16x32_bf16 v[40:43], a[196:199], a[180:183], v[40:43]
 v_mfma_f32_16x16x32_bf16 v[40:43], a[192:195], a[176:179], v[40:43]
 global_load_dwordx4 a[232:235], v0, s[70:71] offset:-2048 sc1
 v_add_f32 v201, v201, v9
 v_mfma_f32_16x16x32_bf16 v[36:39], a[192:195], a[168:171], v[36:39]
 v_add_f32 v202, v202, v10
 v_mfma_f32_16x16x32_bf16 v[36:39], a[196:199], a[172:175], v[36:39]
 v_mfma_f32_16x16x32_bf16 v[32:35], a[196:199], a[164:167], v[32:35]
 v_add_f32 v203, v203, v11
 v_mfma_f32_16x16x32_bf16 v[32:35], a[192:195], a[160:163], v[32:35]
 s_waitcnt lgkmcnt(1)
 v_mfma_f32_16x16x32_bf16 v[28:31], a[192:195], a[152:155], v[28:31]
 v_add_f32 v204, v204, v8
 v_mfma_f32_16x16x32_bf16 v[28:31], a[196:199], a[156:159], v[28:31]
 v_add_f32 v205, v205, v9
 v_mfma_f32_16x16x32_bf16 v[24:27], a[196:199], a[148:151], v[24:27]
 v_mfma_f32_16x16x32_bf16 v[24:27], a[192:195], a[144:147], v[24:27]
 v_add_f32 v206, v206, v10
 v_mfma_f32_16x16x32_bf16 v[20:23], a[192:195], a[136:139], v[20:23]
 v_add_f32 v207, v207, v11
 v_mfma_f32_16x16x32_bf16 v[20:23], a[196:199], a[140:143], v[20:23]
 v_mfma_f32_16x16x32_bf16 v[16:19], a[196:199], a[132:135], v[16:19]
 v_add_f32 v208, v208, v8
 v_mfma_f32_16x16x32_bf16 v[16:19], a[192:195], a[128:131], v[16:19]
 v_add_f32 v209, v209, v9
 s_waitcnt vmcnt(8)
 v_mfma_f32_16x16x32_bf16 v[48:51], a[200:203], a[128:131], v[48:51]
 v_mfma_f32_16x16x32_bf16 v[48:51], a[204:207], a[132:135], v[48:51]
 global_load_dwordx4 a[196:199], v0, s[70:71] offset:1024 sc1
 v_add_f32 v210, v210, v10
 v_mfma_f32_16x16x32_bf16 v[52:55], a[204:207], a[140:143], v[52:55]
 v_add_f32 v211, v211, v11
 v_mfma_f32_16x16x32_bf16 v[52:55], a[200:203], a[136:139], v[52:55]
 global_load_dwordx4 a[192:195], v0, s[70:71] offset:0 sc1
 v_mfma_f32_16x16x32_bf16 v[56:59], a[200:203], a[144:147], v[56:59]
 v_add_f32 v212, v212, v8
 v_mfma_f32_16x16x32_bf16 v[56:59], a[204:207], a[148:151], v[56:59]
 v_mfma_f32_16x16x32_bf16 v[60:63], a[204:207], a[156:159], v[60:63]
 v_add_f32 v213, v213, v9
 v_mfma_f32_16x16x32_bf16 v[60:63], a[200:203], a[152:155], v[60:63]
 v_add_f32 v214, v214, v10
 v_mfma_f32_16x16x32_bf16 v[64:67], a[200:203], a[160:163], v[64:67]
 v_mfma_f32_16x16x32_bf16 v[64:67], a[204:207], a[164:167], v[64:67]
 v_add_f32 v215, v215, v11
 v_mfma_f32_16x16x32_bf16 v[68:71], a[204:207], a[172:175], v[68:71]
 v_add_f32 v216, v216, v8
 v_mfma_f32_16x16x32_bf16 v[68:71], a[200:203], a[168:171], v[68:71]
 v_mfma_f32_16x16x32_bf16 v[72:75], a[200:203], a[176:179], v[72:75]
 v_add_f32 v217, v217, v9
 v_mfma_f32_16x16x32_bf16 v[72:75], a[204:207], a[180:183], v[72:75]
 v_add_f32 v218, v218, v10
 v_mfma_f32_16x16x32_bf16 v[76:79], a[204:207], a[188:191], v[76:79]
 v_mfma_f32_16x16x32_bf16 v[76:79], a[200:203], a[184:187], v[76:79]
 v_add_f32 v219, v219, v11
 s_waitcnt vmcnt(8)
 v_mfma_f32_16x16x32_bf16 v[108:111], a[208:211], a[184:187], v[108:111]
 v_add_f32 v220, v220, v8
 v_mfma_f32_16x16x32_bf16 v[108:111], a[212:215], a[188:191], v[108:111]
 global_load_dwordx4 a[204:207], v0, s[70:71] offset:3072 sc1
 v_mfma_f32_16x16x32_bf16 v[104:107], a[212:215], a[180:183], v[104:107]
 v_add_f32 v221, v221, v9
 v_mfma_f32_16x16x32_bf16 v[104:107], a[208:211], a[176:179], v[104:107]
 global_load_dwordx4 a[200:203], v0, s[70:71] offset:2048 sc1
 v_mfma_f32_16x16x32_bf16 v[100:103], a[208:211], a[168:171], v[100:103]
 v_add_f32 v222, v222, v10
 s_add_u32 s70, s70, 8192
 s_addc_u32 s71, s71, 0
 v_mfma_f32_16x16x32_bf16 v[100:103], a[212:215], a[172:175], v[100:103]
 v_add_f32 v223, v223, v11
 v_mfma_f32_16x16x32_bf16 v[96:99], a[212:215], a[164:167], v[96:99]
 v_mfma_f32_16x16x32_bf16 v[96:99], a[208:211], a[160:163], v[96:99]
 v_add_f32 v224, v224, v8
 v_mfma_f32_16x16x32_bf16 v[92:95], a[208:211], a[152:155], v[92:95]
 v_add_f32 v225, v225, v9
 v_mfma_f32_16x16x32_bf16 v[92:95], a[212:215], a[156:159], v[92:95]
 v_mfma_f32_16x16x32_bf16 v[88:91], a[212:215], a[148:151], v[88:91]
 v_add_f32 v226, v226, v10
 v_mfma_f32_16x16x32_bf16 v[88:91], a[208:211], a[144:147], v[88:91]
 v_add_f32 v227, v227, v11
 v_mfma_f32_16x16x32_bf16 v[84:87], a[208:211], a[136:139], v[84:87]
 v_mfma_f32_16x16x32_bf16 v[84:87], a[212:215], a[140:143], v[84:87]
 v_add_f32 v228, v228, v8
 v_mfma_f32_16x16x32_bf16 v[80:83], a[212:215], a[132:135], v[80:83]
 v_add_f32 v229, v229, v9
 v_mfma_f32_16x16x32_bf16 v[80:83], a[208:211], a[128:131], v[80:83]
 s_waitcnt vmcnt(8)
 v_mfma_f32_16x16x32_bf16 v[112:115], a[216:219], a[128:131], v[112:115]
 ds_read_b128 a[128:131], v2 offset:34816
 v_add_f32 v230, v230, v10
 v_mfma_f32_16x16x32_bf16 v[112:115], a[220:223], a[132:135], v[112:115]
 global_load_dwordx4 a[212:215], v0, s[70:71] offset:-3072 sc1
 ds_read_b128 a[132:135], v2 offset:35840
 v_mfma_f32_16x16x32_bf16 v[116:119], a[220:223], a[140:143], v[116:119]
 ds_read_b128 a[140:143], v2 offset:39936
 v_add_f32 v231, v231, v11
 v_mfma_f32_16x16x32_bf16 v[116:119], a[216:219], a[136:139], v[116:119]
 global_load_dwordx4 a[208:211], v0, s[70:71] offset:-4096 sc1
 ds_read_b128 a[136:139], v2 offset:38912
 s_waitcnt lgkmcnt(4)
 v_mfma_f32_16x16x32_bf16 v[120:123], a[216:219], a[144:147], v[120:123]
 ds_read_b128 a[144:147], v2 offset:43008
 v_mfma_f32_16x16x32_bf16 v[120:123], a[220:223], a[148:151], v[120:123]
 ds_read_b128 a[148:151], v2 offset:44032
 v_add_f32 v232, v232, v12
 v_mfma_f32_16x16x32_bf16 v[124:127], a[220:223], a[156:159], v[124:127]
 ds_read_b128 a[156:159], v2 offset:48128
 v_add_f32 v233, v233, v13
 v_mfma_f32_16x16x32_bf16 v[124:127], a[216:219], a[152:155], v[124:127]
 ds_read_b128 a[152:155], v2 offset:47104
 v_mfma_f32_16x16x32_bf16 v[128:131], a[216:219], a[160:163], v[128:131]
 ds_read_b128 a[160:163], v2 offset:51200
 v_add_f32 v234, v234, v14
 v_mfma_f32_16x16x32_bf16 v[128:131], a[220:223], a[164:167], v[128:131]
 ds_read_b128 a[164:167], v2 offset:52224
 v_add_f32 v235, v235, v15
 v_mfma_f32_16x16x32_bf16 v[132:135], a[220:223], a[172:175], v[132:135]
 ds_read_b128 a[172:175], v2 offset:56320
 v_mfma_f32_16x16x32_bf16 v[132:135], a[216:219], a[168:171], v[132:135]
 ds_read_b128 a[168:171], v2 offset:55296
 v_add_f32 v236, v236, v12
 v_mfma_f32_16x16x32_bf16 a[240:243], a[216:219], a[176:179], a[240:243]
 ds_read_b128 a[176:179], v2 offset:59392
 v_add_f32 v237, v237, v13
 v_mfma_f32_16x16x32_bf16 a[240:243], a[220:223], a[180:183], a[240:243]
 ds_read_b128 a[180:183], v2 offset:60416
 v_mfma_f32_16x16x32_bf16 a[244:247], a[220:223], a[188:191], a[244:247]
 ds_read_b128 a[188:191], v2 offset:64512
 v_add_f32 v238, v238, v14
 v_mfma_f32_16x16x32_bf16 a[244:247], a[216:219], a[184:187], a[244:247]
 ds_read_b128 a[184:187], v2 offset:63488
 s_waitcnt vmcnt(8) lgkmcnt(8)
 v_mfma_f32_16x16x32_bf16 v[16:19], a[224:227], a[128:131], v[16:19]
 v_add_f32 v239, v239, v15
 v_mfma_f32_16x16x32_bf16 v[16:19], a[228:231], a[132:135], v[16:19]
 global_load_dwordx4 a[220:223], v0, s[70:71] offset:-1024 sc1
 v_add_f32 v240, v240, v12
 v_mfma_f32_16x16x32_bf16 v[20:23], a[228:231], a[140:143], v[20:23]
 v_mfma_f32_16x16x32_bf16 v[20:23], a[224:227], a[136:139], v[20:23]
 global_load_dwordx4 a[216:219], v0, s[70:71] offset:-2048 sc1
 v_add_f32 v241, v241, v13
 v_mfma_f32_16x16x32_bf16 v[24:27], a[224:227], a[144:147], v[24:27]
 v_add_f32 v242, v242, v14
 v_mfma_f32_16x16x32_bf16 v[24:27], a[228:231], a[148:151], v[24:27]
 v_mfma_f32_16x16x32_bf16 v[28:31], a[228:231], a[156:159], v[28:31]
 v_add_f32 v243, v243, v15
 v_mfma_f32_16x16x32_bf16 v[28:31], a[224:227], a[152:155], v[28:31]
 v_add_f32 v244, v244, v12
 s_waitcnt lgkmcnt(0)
 v_mfma_f32_16x16x32_bf16 v[32:35], a[224:227], a[160:163], v[32:35]
 v_mfma_f32_16x16x32_bf16 v[32:35], a[228:231], a[164:167], v[32:35]
 v_add_f32 v245, v245, v13
 v_mfma_f32_16x16x32_bf16 v[36:39], a[228:231], a[172:175], v[36:39]
 v_add_f32 v246, v246, v14
 v_mfma_f32_16x16x32_bf16 v[36:39], a[224:227], a[168:171], v[36:39]
 v_mfma_f32_16x16x32_bf16 v[40:43], a[224:227], a[176:179], v[40:43]
 v_add_f32 v247, v247, v15
 v_mfma_f32_16x16x32_bf16 v[40:43], a[228:231], a[180:183], v[40:43]
 v_mfma_f32_16x16x32_bf16 v[44:47], a[228:231], a[188:191], v[44:47]
 v_add_f32 v248, v248, v12
 v_mfma_f32_16x16x32_bf16 v[44:47], a[224:227], a[184:187], v[44:47]
 v_add_f32 v249, v249, v13
 s_waitcnt vmcnt(8)
 v_mfma_f32_16x16x32_bf16 v[76:79], a[232:235], a[184:187], v[76:79]
 v_mfma_f32_16x16x32_bf16 v[76:79], a[236:239], a[188:191], v[76:79]
 global_load_dwordx4 a[228:231], v0, s[70:71] offset:1024 sc1
 v_add_f32 v250, v250, v14
 v_mfma_f32_16x16x32_bf16 v[72:75], a[236:239], a[180:183], v[72:75]
 v_add_f32 v251, v251, v15
 v_mfma_f32_16x16x32_bf16 v[72:75], a[232:235], a[176:179], v[72:75]
 global_load_dwordx4 a[224:227], v0, s[70:71] offset:0 sc1
 v_mfma_f32_16x16x32_bf16 v[68:71], a[232:235], a[168:171], v[68:71]
 v_add_f32 v252, v252, v12
 v_mfma_f32_16x16x32_bf16 v[68:71], a[236:239], a[172:175], v[68:71]
 v_add_f32 v253, v253, v13
 v_mfma_f32_16x16x32_bf16 v[64:67], a[236:239], a[164:167], v[64:67]
 v_mfma_f32_16x16x32_bf16 v[64:67], a[232:235], a[160:163], v[64:67]
 v_add_f32 v254, v254, v14
 v_mfma_f32_16x16x32_bf16 v[60:63], a[232:235], a[152:155], v[60:63]
 v_add_f32 v255, v255, v15
 v_mfma_f32_16x16x32_bf16 v[60:63], a[236:239], a[156:159], v[60:63]
 v_mfma_f32_16x16x32_bf16 v[56:59], a[236:239], a[148:151], v[56:59]
 v_accvgpr_read_b32 v5, a248
 v_mfma_f32_16x16x32_bf16 v[56:59], a[232:235], a[144:147], v[56:59]
 v_mfma_f32_16x16x32_bf16 v[52:55], a[232:235], a[136:139], v[52:55]
 v_add_f32 v5, v5, v12
 v_mfma_f32_16x16x32_bf16 v[52:55], a[236:239], a[140:143], v[52:55]
 v_accvgpr_write_b32 a248, v5
 v_mfma_f32_16x16x32_bf16 v[48:51], a[236:239], a[132:135], v[48:51]
 v_mfma_f32_16x16x32_bf16 v[48:51], a[232:235], a[128:131], v[48:51]
 v_accvgpr_read_b32 v6, a249
 s_waitcnt vmcnt(8)
 v_mfma_f32_16x16x32_bf16 v[80:83], a[192:195], a[128:131], v[80:83]
 v_add_f32 v6, v6, v13
 v_mfma_f32_16x16x32_bf16 v[80:83], a[196:199], a[132:135], v[80:83]
 global_load_dwordx4 a[236:239], v0, s[70:71] offset:3072 sc1
 v_mfma_f32_16x16x32_bf16 v[84:87], a[196:199], a[140:143], v[84:87]
 v_accvgpr_write_b32 a249, v6
 v_mfma_f32_16x16x32_bf16 v[84:87], a[192:195], a[136:139], v[84:87]
 global_load_dwordx4 a[232:235], v0, s[70:71] offset:2048 sc1
 v_accvgpr_read_b32 v5, a250
 v_mfma_f32_16x16x32_bf16 v[88:91], a[192:195], a[144:147], v[88:91]
 s_add_u32 s70, s70, 8192
 s_addc_u32 s71, s71, 0
 v_mfma_f32_16x16x32_bf16 v[88:91], a[196:199], a[148:151], v[88:91]
 v_add_f32 v5, v5, v14
 v_mfma_f32_16x16x32_bf16 v[92:95], a[196:199], a[156:159], v[92:95]
 v_accvgpr_write_b32 a250, v5
 v_mfma_f32_16x16x32_bf16 v[92:95], a[192:195], a[152:155], v[92:95]
 v_mfma_f32_16x16x32_bf16 v[96:99], a[192:195], a[160:163], v[96:99]
 v_accvgpr_read_b32 v6, a251
 v_mfma_f32_16x16x32_bf16 v[96:99], a[196:199], a[164:167], v[96:99]
 v_mfma_f32_16x16x32_bf16 v[100:103], a[196:199], a[172:175], v[100:103]
 v_add_f32 v6, v6, v15
 v_mfma_f32_16x16x32_bf16 v[100:103], a[192:195], a[168:171], v[100:103]
 v_accvgpr_write_b32 a251, v6
 v_mfma_f32_16x16x32_bf16 v[104:107], a[192:195], a[176:179], v[104:107]
 v_mfma_f32_16x16x32_bf16 v[104:107], a[196:199], a[180:183], v[104:107]
 v_accvgpr_read_b32 v5, a252
 v_mfma_f32_16x16x32_bf16 v[108:111], a[196:199], a[188:191], v[108:111]
 v_add_f32 v5, v5, v12
 v_mfma_f32_16x16x32_bf16 v[108:111], a[192:195], a[184:187], v[108:111]
 s_waitcnt vmcnt(8)
 v_mfma_f32_16x16x32_bf16 a[244:247], a[200:203], a[184:187], a[244:247]
 v_accvgpr_write_b32 a252, v5
 v_mfma_f32_16x16x32_bf16 a[244:247], a[204:207], a[188:191], a[244:247]
 global_load_dwordx4 a[196:199], v0, s[70:71] offset:-3072 sc1
 v_accvgpr_read_b32 v6, a253
 v_mfma_f32_16x16x32_bf16 a[240:243], a[204:207], a[180:183], a[240:243]
 v_mfma_f32_16x16x32_bf16 a[240:243], a[200:203], a[176:179], a[240:243]
 global_load_dwordx4 a[192:195], v0, s[70:71] offset:-4096 sc1
 v_add_f32 v6, v6, v13
 v_mfma_f32_16x16x32_bf16 v[132:135], a[200:203], a[168:171], v[132:135]
 v_accvgpr_write_b32 a253, v6
 v_mfma_f32_16x16x32_bf16 v[132:135], a[204:207], a[172:175], v[132:135]
 v_mfma_f32_16x16x32_bf16 v[128:131], a[204:207], a[164:167], v[128:131]
 v_accvgpr_read_b32 v5, a254
 v_mfma_f32_16x16x32_bf16 v[128:131], a[200:203], a[160:163], v[128:131]
 v_mfma_f32_16x16x32_bf16 v[124:127], a[200:203], a[152:155], v[124:127]
 v_add_f32 v5, v5, v14
 v_mfma_f32_16x16x32_bf16 v[124:127], a[204:207], a[156:159], v[124:127]
 v_accvgpr_write_b32 a254, v5
 v_mfma_f32_16x16x32_bf16 v[120:123], a[204:207], a[148:151], v[120:123]
 v_mfma_f32_16x16x32_bf16 v[120:123], a[200:203], a[144:147], v[120:123]
 v_accvgpr_read_b32 v6, a255
 v_mfma_f32_16x16x32_bf16 v[116:119], a[200:203], a[136:139], v[116:119]
 v_add_f32 v6, v6, v15
 v_mfma_f32_16x16x32_bf16 v[116:119], a[204:207], a[140:143], v[116:119]
 v_mfma_f32_16x16x32_bf16 v[112:115], a[204:207], a[132:135], v[112:115]
 global_load_dwordx4 a[204:207], v0, s[70:71] offset:-1024 sc1
 v_accvgpr_write_b32 a255, v6
 v_mfma_f32_16x16x32_bf16 v[112:115], a[200:203], a[128:131], v[112:115]
 global_load_dwordx4 a[200:203], v0, s[70:71] offset:-2048 sc1
 s_waitcnt vmcnt(10)
 s_mov_b32 s34, 0x10000000
 s_mov_b32 s8, s32
 s_mov_b32 s9, s33
 s_mov_b32 s10, s34
 s_mov_b32 s20, 1024
 s_mov_b32 s21, 1024
 s_mov_b32 s22, 1024
 s_xor_b32 s30, s29, 131072
 s_add_u32 s51, s51, 2048
 s_add_u32 s25, s25, 1
 s_cmp_eq_u32 s25, 6
 s_cbranch_scc1 Llast
 v_mfma_f32_16x16x32_bf16 v[136:139], a[208:211], a[128:131], v[136:139]
 v_accvgpr_read_b32 v5, a0
 v_lshlrev_b32 v6, 16, v5
 v_mfma_f32_16x16x32_bf16 v[136:139], a[212:215], a[132:135], v[136:139]
 v_and_b32 v5, s26, v5
 v_mul_f32 v6, v6, v16
 v_mfma_f32_16x16x32_bf16 v[140:143], a[212:215], a[140:143], v[140:143]
 v_mul_f32 v5, v5, v17
 v_mfma_f32_16x16x32_bf16 v[140:143], a[208:211], a[136:139], v[140:143]
 v_cvt_pk_bf16_f32 v8, v6, v5
 v_accvgpr_read_b32 v5, a1
 v_mfma_f32_16x16x32_bf16 v[144:147], a[208:211], a[144:147], v[144:147]
 v_lshlrev_b32 v6, 16, v5
 v_and_b32 v5, s26, v5
 v_mfma_f32_16x16x32_bf16 v[144:147], a[212:215], a[148:151], v[144:147]
 v_mul_f32 v6, v6, v18
 v_mul_f32 v5, v5, v19
 v_mfma_f32_16x16x32_bf16 v[148:151], a[212:215], a[156:159], v[148:151]
 v_cvt_pk_bf16_f32 v9, v6, v5
 v_accvgpr_read_b32 v5, a2
 v_mfma_f32_16x16x32_bf16 v[148:151], a[208:211], a[152:155], v[148:151]
 v_lshlrev_b32 v6, 16, v5
 v_and_b32 v5, s26, v5
 v_mfma_f32_16x16x32_bf16 v[152:155], a[208:211], a[160:163], v[152:155]
 v_mul_f32 v6, v6, v48
 v_mfma_f32_16x16x32_bf16 v[152:155], a[212:215], a[164:167], v[152:155]
 v_mul_f32 v5, v5, v49
 v_cvt_pk_bf16_f32 v10, v6, v5
 v_mfma_f32_16x16x32_bf16 v[156:159], a[212:215], a[172:175], v[156:159]
 v_accvgpr_read_b32 v5, a3
 v_lshlrev_b32 v6, 16, v5
 v_mfma_f32_16x16x32_bf16 v[156:159], a[208:211], a[168:171], v[156:159]
 v_and_b32 v5, s26, v5
 v_mul_f32 v6, v6, v50
 v_mfma_f32_16x16x32_bf16 v[160:163], a[208:211], a[176:179], v[160:163]
 v_mul_f32 v5, v5, v51
 v_cvt_pk_bf16_f32 v11, v6, v5
 v_mfma_f32_16x16x32_bf16 v[160:163], a[212:215], a[180:183], v[160:163]
 ds_write_b128 v3, v[8:11]
 s_add_u32 s68, s29, 0
 v_mfma_f32_16x16x32_bf16 v[164:167], a[212:215], a[188:191], v[164:167]
 buffer_store_dwordx4 v[8:11], v3, s[32:35], s68 offen sc1
 v_accvgpr_read_b32 v5, a32
 v_lshlrev_b32 v6, 16, v5
 v_mfma_f32_16x16x32_bf16 v[164:167], a[208:211], a[184:187], v[164:167]
 v_and_b32 v5, s26, v5
 v_mul_f32 v6, v6, v80
 s_waitcnt vmcnt(9)
 v_mfma_f32_16x16x32_bf16 v[196:199], a[216:219], a[184:187], v[196:199]
 v_mul_f32 v5, v5, v81
 v_cvt_pk_bf16_f32 v12, v6, v5
 v_mfma_f32_16x16x32_bf16 v[196:199], a[220:223], a[188:191], v[196:199]
 global_load_dwordx4 a[212:215], v0, s[70:71] offset:1024 sc1
 v_accvgpr_read_b32 v5, a33
 v_mfma_f32_16x16x32_bf16 v[192:195], a[220:223], a[180:183], v[192:195]
 v_lshlrev_b32 v6, 16, v5
 v_and_b32 v5, s26, v5
 v_mfma_f32_16x16x32_bf16 v[192:195], a[216:219], a[176:179], v[192:195]
 global_load_dwordx4 a[208:211], v0, s[70:71] offset:0 sc1
 v_mul_f32 v6, v6, v82
 v_mfma_f32_16x16x32_bf16 v[188:191], a[216:219], a[168:171], v[188:191]
 v_mul_f32 v5, v5, v83
 v_cvt_pk_bf16_f32 v13, v6, v5
 v_mfma_f32_16x16x32_bf16 v[188:191], a[220:223], a[172:175], v[188:191]
 v_accvgpr_read_b32 v5, a34
 v_lshlrev_b32 v6, 16, v5
 v_mfma_f32_16x16x32_bf16 v[184:187], a[220:223], a[164:167], v[184:187]
 v_and_b32 v5, s26, v5
 v_mul_f32 v6, v6, v112
 v_mfma_f32_16x16x32_bf16 v[184:187], a[216:219], a[160:163], v[184:187]
 v_mul_f32 v5, v5, v113
 v_cvt_pk_bf16_f32 v14, v6, v5
 v_mfma_f32_16x16x32_bf16 v[180:183], a[216:219], a[152:155], v[180:183]
 v_accvgpr_read_b32 v5, a35
 v_lshlrev_b32 v6, 16, v5
 v_mfma_f32_16x16x32_bf16 v[180:183], a[220:223], a[156:159], v[180:183]
 v_and_b32 v5, s26, v5
 v_mul_f32 v6, v6, v114
 v_mfma_f32_16x16x32_bf16 v[176:179], a[220:223], a[148:151], v[176:179]
 v_mul_f32 v5, v5, v115
 v_cvt_pk_bf16_f32 v15, v6, v5
 v_mfma_f32_16x16x32_bf16 v[176:179], a[216:219], a[144:147], v[176:179]
 ds_write_b128 v3, v[12:15] offset:1024
 v_mfma_f32_16x16x32_bf16 v[172:175], a[216:219], a[136:139], v[172:175]
 buffer_store_dwordx4 v[12:15], v3, s[32:35], s68 offen offset:1024 sc1
 v_accvgpr_read_b32 v5, a4
 v_lshlrev_b32 v6, 16, v5
 v_mfma_f32_16x16x32_bf16 v[172:175], a[220:223], a[140:143], v[172:175]
 v_and_b32 v5, s26, v5
 v_mul_f32 v6, v6, v20
 v_mfma_f32_16x16x32_bf16 v[168:171], a[220:223], a[132:135], v[168:171]
 v_mul_f32 v5, v5, v21
 v_cvt_pk_bf16_f32 v8, v6, v5
 v_mfma_f32_16x16x32_bf16 v[168:171], a[216:219], a[128:131], v[168:171]
 v_accvgpr_read_b32 v5, a5
 v_lshlrev_b32 v6, 16, v5
 s_waitcnt vmcnt(10)
 v_mfma_f32_16x16x32_bf16 v[200:203], a[224:227], a[128:131], v[200:203]
 v_and_b32 v5, s26, v5
 v_mul_f32 v6, v6, v22
 v_mfma_f32_16x16x32_bf16 v[200:203], a[228:231], a[132:135], v[200:203]
 global_load_dwordx4 a[220:223], v0, s[70:71] offset:3072 sc1
 v_mul_f32 v5, v5, v23
 v_mfma_f32_16x16x32_bf16 v[204:207], a[228:231], a[140:143], v[204:207]
 v_cvt_pk_bf16_f32 v9, v6, v5
 v_accvgpr_read_b32 v5, a6
 v_mfma_f32_16x16x32_bf16 v[204:207], a[224:227], a[136:139], v[204:207]
 global_load_dwordx4 a[216:219], v0, s[70:71] offset:2048 sc1
 v_lshlrev_b32 v6, 16, v5
 v_mfma_f32_16x16x32_bf16 v[208:211], a[224:227], a[144:147], v[208:211]
 v_and_b32 v5, s26, v5
 v_mul_f32 v6, v6, v52
 s_add_u32 s70, s70, 8192
 s_addc_u32 s71, s71, 0
 v_mfma_f32_16x16x32_bf16 v[208:211], a[228:231], a[148:151], v[208:211]
 v_mul_f32 v5, v5, v53
 v_cvt_pk_bf16_f32 v10, v6, v5
 v_mfma_f32_16x16x32_bf16 v[212:215], a[228:231], a[156:159], v[212:215]
 v_accvgpr_read_b32 v5, a7
 v_lshlrev_b32 v6, 16, v5
 v_mfma_f32_16x16x32_bf16 v[212:215], a[224:227], a[152:155], v[212:215]
 v_and_b32 v5, s26, v5
 v_mul_f32 v6, v6, v54
 v_mfma_f32_16x16x32_bf16 v[216:219], a[224:227], a[160:163], v[216:219]
 v_mul_f32 v5, v5, v55
 v_cvt_pk_bf16_f32 v11, v6, v5
 v_mfma_f32_16x16x32_bf16 v[216:219], a[228:231], a[164:167], v[216:219]
 ds_write_b128 v3, v[8:11] offset:4096
 v_mfma_f32_16x16x32_bf16 v[220:223], a[228:231], a[172:175], v[220:223]
 buffer_store_dwordx4 v[8:11], v3, s[32:35], s68 offen offset:2048 sc1
 v_accvgpr_read_b32 v5, a36
 v_lshlrev_b32 v6, 16, v5
 v_and_b32 v5, s26, v5
 v_mfma_f32_16x16x32_bf16 v[220:223], a[224:227], a[168:171], v[220:223]
 v_mul_f32 v6, v6, v84
 v_mul_f32 v5, v5, v85
 v_mfma_f32_16x16x32_bf16 v[224:227], a[224:227], a[176:179], v[224:227]
 v_cvt_pk_bf16_f32 v12, v6, v5
 v_accvgpr_read_b32 v5, a37
 v_mfma_f32_16x16x32_bf16 v[224:227], a[228:231], a[180:183], v[224:227]
 v_lshlrev_b32 v6, 16, v5
 v_and_b32 v5, s26, v5
 v_mfma_f32_16x16x32_bf16 v[228:231], a[228:231], a[188:191], v[228:231]
 v_mul_f32 v6, v6, v86
 v_mul_f32 v5, v5, v87
 v_mfma_f32_16x16x32_bf16 v[228:231], a[224:227], a[184:187], v[228:231]
 v_cvt_pk_bf16_f32 v13, v6, v5
 v_accvgpr_read_b32 v5, a38
 s_waitcnt vmcnt(11)
 v_mfma_f32_16x16x32_bf16 a[252:255], a[232:235], a[184:187], a[252:255]
 ds_read_b128 a[184:187], v2 offset:30720
 v_lshlrev_b32 v6, 16, v5
 v_mfma_f32_16x16x32_bf16 a[252:255], a[236:239], a[188:191], a[252:255]
 global_load_dwordx4 a[228:231], v0, s[70:71] offset:-3072 sc1
 ds_read_b128 a[188:191], v2 offset:31744
 v_mfma_f32_16x16x32_bf16 a[248:251], a[236:239], a[180:183], a[248:251]
 ds_read_b128 a[180:183], v2 offset:27648
 v_and_b32 v5, s26, v5
 v_mfma_f32_16x16x32_bf16 a[248:251], a[232:235], a[176:179], a[248:251]
 global_load_dwordx4 a[224:227], v0, s[70:71] offset:-4096 sc1
 ds_read_b128 a[176:179], v2 offset:26624
 v_mul_f32 v6, v6, v116
 v_mfma_f32_16x16x32_bf16 v[252:255], a[232:235], a[168:171], v[252:255]
 ds_read_b128 a[168:171], v2 offset:22528
 v_mul_f32 v5, v5, v117
 v_mfma_f32_16x16x32_bf16 v[252:255], a[236:239], a[172:175], v[252:255]
 ds_read_b128 a[172:175], v2 offset:23552
 v_cvt_pk_bf16_f32 v14, v6, v5
 v_accvgpr_read_b32 v5, a39
 v_mfma_f32_16x16x32_bf16 v[248:251], a[236:239], a[164:167], v[248:251]
 ds_read_b128 a[164:167], v2 offset:19456
 v_lshlrev_b32 v6, 16, v5
 v_and_b32 v5, s26, v5
 v_mfma_f32_16x16x32_bf16 v[248:251], a[232:235], a[160:163], v[248:251]
 ds_read_b128 a[160:163], v2 offset:18432
 v_mul_f32 v6, v6, v118
 v_mul_f32 v5, v5, v119
 v_mfma_f32_16x16x32_bf16 v[244:247], a[232:235], a[152:155], v[244:247]
 ds_read_b128 a[152:155], v2 offset:14336
 v_cvt_pk_bf16_f32 v15, v6, v5
 v_mfma_f32_16x16x32_bf16 v[244:247], a[236:239], a[156:159], v[244:247]
 ds_read_b128 a[156:159], v2 offset:15360
 ds_write_b128 v3, v[12:15] offset:5120
 v_mfma_f32_16x16x32_bf16 v[240:243], a[236:239], a[148:151], v[240:243]
 buffer_store_dwordx4 v[12:15], v3, s[32:35], s68 offen offset:3072 sc1
 ds_read_b128 a[148:151], v2 offset:11264
 v_accvgpr_read_b32 v5, a8
 v_lshlrev_b32 v6, 16, v5
 v_mfma_f32_16x16x32_bf16 v[240:243], a[232:235], a[144:147], v[240:243]
 ds_read_b128 a[144:147], v2 offset:10240
 v_and_b32 v5, s26, v5
 v_mul_f32 v6, v6, v24
 v_mfma_f32_16x16x32_bf16 v[236:239], a[232:235], a[136:139], v[236:239]
 ds_read_b128 a[136:139], v2 offset:6144
 v_mul_f32 v5, v5, v25
 v_cvt_pk_bf16_f32 v8, v6, v5
 v_mfma_f32_16x16x32_bf16 v[236:239], a[236:239], a[140:143], v[236:239]
 ds_read_b128 a[140:143], v2 offset:7168
 v_accvgpr_read_b32 v5, a9
 v_lshlrev_b32 v6, 16, v5
 v_mfma_f32_16x16x32_bf16 v[232:235], a[236:239], a[132:135], v[232:235]
 ds_read_b128 a[132:135], v2 offset:3072
 v_and_b32 v5, s26, v5
 v_mfma_f32_16x16x32_bf16 v[232:235], a[232:235], a[128:131], v[232:235]
 ds_read_b128 a[128:131], v2 offset:2048
 v_mul_f32 v6, v6, v26
 s_waitcnt vmcnt(12) lgkmcnt(9)
 v_mfma_f32_16x16x32_bf16 v[164:167], a[192:195], a[184:187], v[164:167]
 v_mul_f32 v5, v5, v27
 v_cvt_pk_bf16_f32 v9, v6, v5
 v_mfma_f32_16x16x32_bf16 v[164:167], a[196:199], a[188:191], v[164:167]
 global_load_dwordx4 a[236:239], v0, s[70:71] offset:-1024 sc1
 v_accvgpr_read_b32 v5, a10
 v_mfma_f32_16x16x32_bf16 v[160:163], a[196:199], a[180:183], v[160:163]
 v_lshlrev_b32 v6, 16, v5
 v_and_b32 v5, s26, v5
 v_mfma_f32_16x16x32_bf16 v[160:163], a[192:195], a[176:179], v[160:163]
 global_load_dwordx4 a[232:235], v0, s[70:71] offset:-2048 sc1
 v_mul_f32 v6, v6, v56
 v_mfma_f32_16x16x32_bf16 v[156:159], a[192:195], a[168:171], v[156:159]
 v_mul_f32 v5, v5, v57
 v_cvt_pk_bf16_f32 v10, v6, v5
 v_mfma_f32_16x16x32_bf16 v[156:159], a[196:199], a[172:175], v[156:159]
 v_accvgpr_read_b32 v5, a11
 v_lshlrev_b32 v6, 16, v5
 v_mfma_f32_16x16x32_bf16 v[152:155], a[196:199], a[164:167], v[152:155]
 v_and_b32 v5, s26, v5
 v_mul_f32 v6, v6, v58
 v_mfma_f32_16x16x32_bf16 v[152:155], a[192:195], a[160:163], v[152:155]
 v_mul_f32 v5, v5, v59
 v_cvt_pk_bf16_f32 v11, v6, v5
 s_waitcnt lgkmcnt(0)
 v_mfma_f32_16x16x32_bf16 v[148:151], a[192:195], a[152:155], v[148:151]
 ds_write_b128 v3, v[8:11] offset:8192
 s_add_u32 s68, s29, 4096
 v_mfma_f32_16x16x32_bf16 v[148:151], a[196:199], a[156:159], v[148:151]
 buffer_store_dwordx4 v[8:11], v3, s[32:35], s68 offen sc1
 v_accvgpr_read_b32 v5, a40
 v_lshlrev_b32 v6, 16, v5
 v_mfma_f32_16x16x32_bf16 v[144:147], a[196:199], a[148:151], v[144:147]
 v_and_b32 v5, s26, v5
 v_mul_f32 v6, v6, v88
 v_mfma_f32_16x16x32_bf16 v[144:147], a[192:195], a[144:147], v[144:147]
 v_mul_f32 v5, v5, v89
 v_cvt_pk_bf16_f32 v12, v6, v5
 v_mfma_f32_16x16x32_bf16 v[140:143], a[192:195], a[136:139], v[140:143]
 v_accvgpr_read_b32 v5, a41
 v_lshlrev_b32 v6, 16, v5
 v_mfma_f32_16x16x32_bf16 v[140:143], a[196:199], a[140:143], v[140:143]
 v_and_b32 v5, s26, v5
 v_mul_f32 v6, v6, v90
 v_mfma_f32_16x16x32_bf16 v[136:139], a[196:199], a[132:135], v[136:139]
 v_mul_f32 v5, v5, v91
 v_cvt_pk_bf16_f32 v13, v6, v5
 v_mfma_f32_16x16x32_bf16 v[136:139], a[192:195], a[128:131], v[136:139]
 v_accvgpr_read_b32 v5, a42
 v_lshlrev_b32 v6, 16, v5
 s_waitcnt vmcnt(13)
 v_mfma_f32_16x16x32_bf16 v[168:171], a[200:203], a[128:131], v[168:171]
 v_and_b32 v5, s26, v5
 v_mul_f32 v6, v6, v120
 v_mfma_f32_16x16x32_bf16 v[168:171], a[204:207], a[132:135], v[168:171]
 global_load_dwordx4 a[196:199], v0, s[70:71] offset:1024 sc1
 v_mul_f32 v5, v5, v121
 v_mfma_f32_16x16x32_bf16 v[172:175], a[204:207], a[140:143], v[172:175]
 v_cvt_pk_bf16_f32 v14, v6, v5
 v_accvgpr_read_b32 v5, a43
 v_mfma_f32_16x16x32_bf16 v[172:175], a[200:203], a[136:139], v[172:175]
 global_load_dwordx4 a[192:195], v0, s[70:71] offset:0 sc1
 v_lshlrev_b32 v6, 16, v5
 v_mfma_f32_16x16x32_bf16 v[176:179], a[200:203], a[144:147], v[176:179]
 v_and_b32 v5, s26, v5
 v_mul_f32 v6, v6, v122
 v_mfma_f32_16x16x32_bf16 v[176:179], a[204:207], a[148:151], v[176:179]
 v_mul_f32 v5, v5, v123
 v_cvt_pk_bf16_f32 v15, v6, v5
 v_mfma_f32_16x16x32_bf16 v[180:183], a[204:207], a[156:159], v[180:183]
 ds_write_b128 v3, v[12:15] offset:9216
 v_mfma_f32_16x16x32_bf16 v[180:183], a[200:203], a[152:155], v[180:183]
 v_lshlrev_b32 v4, 2, v3
 v_and_b32 v4, 192, v4
 v_mfma_f32_16x16x32_bf16 v[184:187], a[200:203], a[160:163], v[184:187]
 buffer_load_dword v4, v4, s[44:47], 0 offen sc1
 v_mfma_f32_16x16x32_bf16 v[184:187], a[204:207], a[164:167], v[184:187]
 buffer_store_dwordx4 v[12:15], v3, s[32:35], s68 offen offset:1024 sc1
 v_accvgpr_read_b32 v5, a12
 v_lshlrev_b32 v6, 16, v5
 v_and_b32 v5, s26, v5
 v_mfma_f32_16x16x32_bf16 v[188:191], a[204:207], a[172:175], v[188:191]
 v_mul_f32 v6, v6, v28
 v_mul_f32 v5, v5, v29
 v_mfma_f32_16x16x32_bf16 v[188:191], a[200:203], a[168:171], v[188:191]
 v_cvt_pk_bf16_f32 v8, v6, v5
 v_accvgpr_read_b32 v5, a13
 v_mfma_f32_16x16x32_bf16 v[192:195], a[200:203], a[176:179], v[192:195]
 v_lshlrev_b32 v6, 16, v5
 v_and_b32 v5, s26, v5
 v_mfma_f32_16x16x32_bf16 v[192:195], a[204:207], a[180:183], v[192:195]
 v_mul_f32 v6, v6, v30
 v_mul_f32 v5, v5, v31
 v_mfma_f32_16x16x32_bf16 v[196:199], a[204:207], a[188:191], v[196:199]
 v_cvt_pk_bf16_f32 v9, v6, v5
 v_accvgpr_read_b32 v5, a14
 v_mfma_f32_16x16x32_bf16 v[196:199], a[200:203], a[184:187], v[196:199]
 v_lshlrev_b32 v6, 16, v5
 v_and_b32 v5, s26, v5
 s_waitcnt vmcnt(14)
 v_mfma_f32_16x16x32_bf16 v[228:231], a[208:211], a[184:187], v[228:231]
 v_mul_f32 v6, v6, v60
 v_mul_f32 v5, v5, v61
 v_mfma_f32_16x16x32_bf16 v[228:231], a[212:215], a[188:191], v[228:231]
 global_load_dwordx4 a[204:207], v0, s[70:71] offset:3072 sc1
 v_cvt_pk_bf16_f32 v10, v6, v5
 v_mfma_f32_16x16x32_bf16 v[224:227], a[212:215], a[180:183], v[224:227]
 v_accvgpr_read_b32 v5, a15
 v_lshlrev_b32 v6, 16, v5
 v_mfma_f32_16x16x32_bf16 v[224:227], a[208:211], a[176:179], v[224:227]
 global_load_dwordx4 a[200:203], v0, s[70:71] offset:2048 sc1
 v_and_b32 v5, s26, v5
 v_mul_f32 v6, v6, v62
 v_mfma_f32_16x16x32_bf16 v[220:223], a[208:211], a[168:171], v[220:223]
 v_mul_f32 v5, v5, v63
 v_cvt_pk_bf16_f32 v11, v6, v5
 s_add_u32 s70, s70, 8192
 s_addc_u32 s71, s71, 0
 v_mfma_f32_16x16x32_bf16 v[220:223], a[212:215], a[172:175], v[220:223]
 ds_write_b128 v3, v[8:11] offset:12288
 v_mfma_f32_16x16x32_bf16 v[216:219], a[212:215], a[164:167], v[216:219]
 buffer_store_dwordx4 v[8:11], v3, s[32:35], s68 offen offset:2048 sc1
 v_accvgpr_read_b32 v5, a44
 v_lshlrev_b32 v6, 16, v5
 v_and_b32 v5, s26, v5
 v_mfma_f32_16x16x32_bf16 v[216:219], a[208:211], a[160:163], v[216:219]
 v_mul_f32 v6, v6, v92
 v_mul_f32 v5, v5, v93
 v_mfma_f32_16x16x32_bf16 v[212:215], a[208:211], a[152:155], v[212:215]
 v_cvt_pk_bf16_f32 v12, v6, v5
 v_accvgpr_read_b32 v5, a45
 v_mfma_f32_16x16x32_bf16 v[212:215], a[212:215], a[156:159], v[212:215]
 v_lshlrev_b32 v6, 16, v5
 v_and_b32 v5, s26, v5
 v_mfma_f32_16x16x32_bf16 v[208:211], a[212:215], a[148:151], v[208:211]
 v_mul_f32 v6, v6, v94
 v_mul_f32 v5, v5, v95
 v_mfma_f32_16x16x32_bf16 v[208:211], a[208:211], a[144:147], v[208:211]
 v_cvt_pk_bf16_f32 v13, v6, v5
 v_accvgpr_read_b32 v5, a46
 v_mfma_f32_16x16x32_bf16 v[204:207], a[208:211], a[136:139], v[204:207]
 v_lshlrev_b32 v6, 16, v5
 v_and_b32 v5, s26, v5
 v_mfma_f32_16x16x32_bf16 v[204:207], a[212:215], a[140:143], v[204:207]
 v_mul_f32 v6, v6, v124
 v_mul_f32 v5, v5, v125
 v_mfma_f32_16x16x32_bf16 v[200:203], a[212:215], a[132:135], v[200:203]
 v_cvt_pk_bf16_f32 v14, v6, v5
 v_accvgpr_read_b32 v5, a47
 v_mfma_f32_16x16x32_bf16 v[200:203], a[208:211], a[128:131], v[200:203]
 v_lshlrev_b32 v6, 16, v5
 v_and_b32 v5, s26, v5
 s_waitcnt vmcnt(14)
 v_mfma_f32_16x16x32_bf16 v[232:235], a[216:219], a[128:131], v[232:235]
 ds_read_b128 a[128:131], v1 offset:34816
 v_mul_f32 v6, v6, v126
 v_mfma_f32_16x16x32_bf16 v[232:235], a[220:223], a[132:135], v[232:235]
 global_load_dwordx4 a[212:215], v0, s[70:71] offset:-3072 sc1
 ds_read_b128 a[132:135], v1 offset:35840
 v_mfma_f32_16x16x32_bf16 v[236:239], a[220:223], a[140:143], v[236:239]
 ds_read_b128 a[140:143], v1 offset:39936
 v_mul_f32 v5, v5, v127
 v_mfma_f32_16x16x32_bf16 v[236:239], a[216:219], a[136:139], v[236:239]
 global_load_dwordx4 a[208:211], v0, s[70:71] offset:-4096 sc1
 ds_read_b128 a[136:139], v1 offset:38912
 v_cvt_pk_bf16_f32 v15, v6, v5
 v_mfma_f32_16x16x32_bf16 v[240:243], a[216:219], a[144:147], v[240:243]
 ds_read_b128 a[144:147], v1 offset:43008
 ds_write_b128 v3, v[12:15] offset:13312
 v_mfma_f32_16x16x32_bf16 v[240:243], a[220:223], a[148:151], v[240:243]
 buffer_store_dwordx4 v[12:15], v3, s[32:35], s68 offen offset:3072 sc1
 ds_read_b128 a[148:151], v1 offset:44032
 v_accvgpr_read_b32 v5, a16
 v_lshlrev_b32 v6, 16, v5
 v_mfma_f32_16x16x32_bf16 v[244:247], a[220:223], a[156:159], v[244:247]
 ds_read_b128 a[156:159], v1 offset:48128
 v_and_b32 v5, s26, v5
 v_mul_f32 v6, v6, v32
 v_mfma_f32_16x16x32_bf16 v[244:247], a[216:219], a[152:155], v[244:247]
 ds_read_b128 a[152:155], v1 offset:47104
 v_mul_f32 v5, v5, v33
 v_mfma_f32_16x16x32_bf16 v[248:251], a[216:219], a[160:163], v[248:251]
 ds_read_b128 a[160:163], v1 offset:51200
 v_cvt_pk_bf16_f32 v8, v6, v5
 v_accvgpr_read_b32 v5, a17
 v_mfma_f32_16x16x32_bf16 v[248:251], a[220:223], a[164:167], v[248:251]
 ds_read_b128 a[164:167], v1 offset:52224
 v_lshlrev_b32 v6, 16, v5
 v_and_b32 v5, s26, v5
 v_mfma_f32_16x16x32_bf16 v[252:255], a[220:223], a[172:175], v[252:255]
 ds_read_b128 a[172:175], v1 offset:56320
 v_mul_f32 v6, v6, v34
 v_mul_f32 v5, v5, v35
 v_mfma_f32_16x16x32_bf16 v[252:255], a[216:219], a[168:171], v[252:255]
 ds_read_b128 a[168:171], v1 offset:55296
 v_cvt_pk_bf16_f32 v9, v6, v5
 v_mfma_f32_16x16x32_bf16 a[248:251], a[216:219], a[176:179], a[248:251]
 ds_read_b128 a[176:179], v1 offset:59392
 v_accvgpr_read_b32 v5, a18
 v_mfma_f32_16x16x32_bf16 a[248:251], a[220:223], a[180:183], a[248:251]
 ds_read_b128 a[180:183], v1 offset:60416
 v_lshlrev_b32 v6, 16, v5
 v_mfma_f32_16x16x32_bf16 a[252:255], a[220:223], a[188:191], a[252:255]
 ds_read_b128 a[188:191], v1 offset:64512
 v_and_b32 v5, s26, v5
 v_mfma_f32_16x16x32_bf16 a[252:255], a[216:219], a[184:187], a[252:255]
 ds_read_b128 a[184:187], v1 offset:63488
 v_mul_f32 v6, v6, v64
 s_waitcnt vmcnt(14) lgkmcnt(8)
 v_mfma_f32_16x16x32_bf16 v[136:139], a[224:227], a[128:131], v[136:139]
 v_mul_f32 v5, v5, v65
 v_cvt_pk_bf16_f32 v10, v6, v5
 v_mfma_f32_16x16x32_bf16 v[136:139], a[228:231], a[132:135], v[136:139]
 global_load_dwordx4 a[220:223], v0, s[70:71] offset:-1024 sc1
 v_accvgpr_read_b32 v5, a19
 v_mfma_f32_16x16x32_bf16 v[140:143], a[228:231], a[140:143], v[140:143]
 v_lshlrev_b32 v6, 16, v5
 v_and_b32 v5, s26, v5
 v_mfma_f32_16x16x32_bf16 v[140:143], a[224:227], a[136:139], v[140:143]
 global_load_dwordx4 a[216:219], v0, s[70:71] offset:-2048 sc1
 v_mul_f32 v6, v6, v66
 v_mfma_f32_16x16x32_bf16 v[144:147], a[224:227], a[144:147], v[144:147]
 v_mul_f32 v5, v5, v67
 v_cvt_pk_bf16_f32 v11, v6, v5
 v_mfma_f32_16x16x32_bf16 v[144:147], a[228:231], a[148:151], v[144:147]
 ds_write_b128 v3, v[8:11] offset:16384
 s_add_u32 s68, s29, 8192
 v_mfma_f32_16x16x32_bf16 v[148:151], a[228:231], a[156:159], v[148:151]
 buffer_store_dwordx4 v[8:11], v3, s[32:35], s68 offen sc1
 v_accvgpr_read_b32 v5, a48
 v_lshlrev_b32 v6, 16, v5
 v_and_b32 v5, s26, v5
 v_mfma_f32_16x16x32_bf16 v[148:151], a[224:227], a[152:155], v[148:151]
 v_mul_f32 v6, v6, v96
 v_mul_f32 v5, v5, v97
 s_waitcnt lgkmcnt(1)
 v_mfma_f32_16x16x32_bf16 v[152:155], a[224:227], a[160:163], v[152:155]
 v_cvt_pk_bf16_f32 v12, v6, v5
 v_accvgpr_read_b32 v5, a49
 v_mfma_f32_16x16x32_bf16 v[152:155], a[228:231], a[164:167], v[152:155]
 v_lshlrev_b32 v6, 16, v5
 v_and_b32 v5, s26, v5
 v_mfma_f32_16x16x32_bf16 v[156:159], a[228:231], a[172:175], v[156:159]
 v_mul_f32 v6, v6, v98
 v_mul_f32 v5, v5, v99
 v_mfma_f32_16x16x32_bf16 v[156:159], a[224:227], a[168:171], v[156:159]
 v_cvt_pk_bf16_f32 v13, v6, v5
 v_accvgpr_read_b32 v5, a50
 v_mfma_f32_16x16x32_bf16 v[160:163], a[224:227], a[176:179], v[160:163]
 v_lshlrev_b32 v6, 16, v5
 v_and_b32 v5, s26, v5
 v_mfma_f32_16x16x32_bf16 v[160:163], a[228:231], a[180:183], v[160:163]
 v_mul_f32 v6, v6, v128
 v_mul_f32 v5, v5, v129
 v_mfma_f32_16x16x32_bf16 v[164:167], a[228:231], a[188:191], v[164:167]
 v_cvt_pk_bf16_f32 v14, v6, v5
 v_accvgpr_read_b32 v5, a51
 v_mfma_f32_16x16x32_bf16 v[164:167], a[224:227], a[184:187], v[164:167]
 v_lshlrev_b32 v6, 16, v5
 v_and_b32 v5, s26, v5
 s_waitcnt vmcnt(14)
 v_mfma_f32_16x16x32_bf16 v[196:199], a[232:235], a[184:187], v[196:199]
 v_mul_f32 v6, v6, v130
 v_mul_f32 v5, v5, v131
 v_mfma_f32_16x16x32_bf16 v[196:199], a[236:239], a[188:191], v[196:199]
 global_load_dwordx4 a[228:231], v0, s[70:71] offset:1024 sc1
 v_cvt_pk_bf16_f32 v15, v6, v5
 v_mfma_f32_16x16x32_bf16 v[192:195], a[236:239], a[180:183], v[192:195]
 ds_write_b128 v3, v[12:15] offset:17408
 v_mfma_f32_16x16x32_bf16 v[192:195], a[232:235], a[176:179], v[192:195]
 global_load_dwordx4 a[224:227], v0, s[70:71] offset:0 sc1
 v_mfma_f32_16x16x32_bf16 v[188:191], a[232:235], a[168:171], v[188:191]
 buffer_store_dwordx4 v[12:15], v3, s[32:35], s68 offen offset:1024 sc1
 v_accvgpr_read_b32 v5, a20
 v_lshlrev_b32 v6, 16, v5
 v_and_b32 v5, s26, v5
 v_mul_f32 v6, v6, v36
 v_mfma_f32_16x16x32_bf16 v[188:191], a[236:239], a[172:175], v[188:191]
 v_mul_f32 v5, v5, v37
 v_cvt_pk_bf16_f32 v8, v6, v5
 v_mfma_f32_16x16x32_bf16 v[184:187], a[236:239], a[164:167], v[184:187]
 v_accvgpr_read_b32 v5, a21
 v_lshlrev_b32 v6, 16, v5
 v_mfma_f32_16x16x32_bf16 v[184:187], a[232:235], a[160:163], v[184:187]
 v_and_b32 v5, s26, v5
 v_mul_f32 v6, v6, v38
 v_mfma_f32_16x16x32_bf16 v[180:183], a[232:235], a[152:155], v[180:183]
 v_mul_f32 v5, v5, v39
 v_cvt_pk_bf16_f32 v9, v6, v5
 v_mfma_f32_16x16x32_bf16 v[180:183], a[236:239], a[156:159], v[180:183]
 v_accvgpr_read_b32 v5, a22
 v_lshlrev_b32 v6, 16, v5
 v_mfma_f32_16x16x32_bf16 v[176:179], a[236:239], a[148:151], v[176:179]
 v_and_b32 v5, s26, v5
 v_mul_f32 v6, v6, v68
 v_mfma_f32_16x16x32_bf16 v[176:179], a[232:235], a[144:147], v[176:179]
 v_mul_f32 v5, v5, v69
 v_cvt_pk_bf16_f32 v10, v6, v5
 v_mfma_f32_16x16x32_bf16 v[172:175], a[232:235], a[136:139], v[172:175]
 v_accvgpr_read_b32 v5, a23
 v_lshlrev_b32 v6, 16, v5
 v_mfma_f32_16x16x32_bf16 v[172:175], a[236:239], a[140:143], v[172:175]
 v_and_b32 v5, s26, v5
 v_mul_f32 v6, v6, v70
 v_mfma_f32_16x16x32_bf16 v[168:171], a[236:239], a[132:135], v[168:171]
 v_mul_f32 v5, v5, v71
 v_cvt_pk_bf16_f32 v11, v6, v5
 v_mfma_f32_16x16x32_bf16 v[168:171], a[232:235], a[128:131], v[168:171]
 ds_write_b128 v3, v[8:11] offset:20480
 buffer_store_dwordx4 v[8:11], v3, s[32:35], s68 offen offset:2048 sc1
 v_accvgpr_read_b32 v5, a52
 v_lshlrev_b32 v6, 16, v5
 v_and_b32 v5, s26, v5
 s_waitcnt vmcnt(15)
 v_mfma_f32_16x16x32_bf16 v[200:203], a[192:195], a[128:131], v[200:203]
 v_mul_f32 v6, v6, v100
 v_mul_f32 v5, v5, v101
 v_mfma_f32_16x16x32_bf16 v[200:203], a[196:199], a[132:135], v[200:203]
 global_load_dwordx4 a[236:239], v0, s[70:71] offset:3072 sc1
 v_cvt_pk_bf16_f32 v12, v6, v5
 v_mfma_f32_16x16x32_bf16 v[204:207], a[196:199], a[140:143], v[204:207]
 v_accvgpr_read_b32 v5, a53
 s_waitcnt vmcnt(15)
 v_cmp_gt_i32 vcc, s27, v4
 s_and_b64 vcc, exec, vcc
 s_cbranch_vccnz Lspin_w
Lok_w:
 s_add_u32 s27, s27, 64
 v_mfma_f32_16x16x32_bf16 v[204:207], a[192:195], a[136:139], v[204:207]
 global_load_dwordx4 a[232:235], v0, s[70:71] offset:2048 sc1
 v_lshlrev_b32 v6, 16, v5
 v_mfma_f32_16x16x32_bf16 v[208:211], a[192:195], a[144:147], v[208:211]
 v_and_b32 v5, s26, v5
 v_mul_f32 v6, v6, v102
 s_add_u32 s70, s70, 1843200
 s_addc_u32 s71, s71, 0
 v_mfma_f32_16x16x32_bf16 v[208:211], a[196:199], a[148:151], v[208:211]
 v_mul_f32 v5, v5, v103
 v_cvt_pk_bf16_f32 v13, v6, v5
 v_mfma_f32_16x16x32_bf16 v[212:215], a[196:199], a[156:159], v[212:215]
 v_accvgpr_read_b32 v5, a54
 v_lshlrev_b32 v6, 16, v5
 v_mfma_f32_16x16x32_bf16 v[212:215], a[192:195], a[152:155], v[212:215]
 v_and_b32 v5, s26, v5
 v_mul_f32 v6, v6, v132
 v_mfma_f32_16x16x32_bf16 v[216:219], a[192:195], a[160:163], v[216:219]
 v_mul_f32 v5, v5, v133
 v_cvt_pk_bf16_f32 v14, v6, v5
 v_mfma_f32_16x16x32_bf16 v[216:219], a[196:199], a[164:167], v[216:219]
 v_accvgpr_read_b32 v5, a55
 v_lshlrev_b32 v6, 16, v5
 v_mfma_f32_16x16x32_bf16 v[220:223], a[196:199], a[172:175], v[220:223]
 v_and_b32 v5, s26, v5
 v_mul_f32 v6, v6, v134
 v_mfma_f32_16x16x32_bf16 v[220:223], a[192:195], a[168:171], v[220:223]
 v_mul_f32 v5, v5, v135
 v_cvt_pk_bf16_f32 v15, v6, v5
 v_mfma_f32_16x16x32_bf16 v[224:227], a[192:195], a[176:179], v[224:227]
 ds_write_b128 v3, v[12:15] offset:21504
 v_mfma_f32_16x16x32_bf16 v[224:227], a[196:199], a[180:183], v[224:227]
 buffer_store_dwordx4 v[12:15], v3, s[32:35], s68 offen offset:3072 sc1
 v_accvgpr_read_b32 v5, a24
 v_lshlrev_b32 v6, 16, v5
 v_and_b32 v5, s26, v5
 v_mfma_f32_16x16x32_bf16 v[228:231], a[196:199], a[188:191], v[228:231]
 v_mul_f32 v6, v6, v40
 v_mul_f32 v5, v5, v41
 v_mfma_f32_16x16x32_bf16 v[228:231], a[192:195], a[184:187], v[228:231]
 v_cvt_pk_bf16_f32 v8, v6, v5
 v_accvgpr_read_b32 v5, a25
 s_waitcnt vmcnt(14)
 v_mfma_f32_16x16x32_bf16 a[252:255], a[200:203], a[184:187], a[252:255]
 ds_read_b128 a[184:187], v1 offset:30720
 v_lshlrev_b32 v6, 16, v5
 v_mfma_f32_16x16x32_bf16 a[252:255], a[204:207], a[188:191], a[252:255]
 global_load_dwordx4 a[196:199], v0, s[70:71] offset:-3072 sc1
 ds_read_b128 a[188:191], v1 offset:31744
 v_mfma_f32_16x16x32_bf16 a[248:251], a[204:207], a[180:183], a[248:251]
 ds_read_b128 a[180:183], v1 offset:27648
 v_and_b32 v5, s26, v5
 v_mfma_f32_16x16x32_bf16 a[248:251], a[200:203], a[176:179], a[248:251]
 global_load_dwordx4 a[192:195], v0, s[70:71] offset:-4096 sc1
 ds_read_b128 a[176:179], v1 offset:26624
 v_mul_f32 v6, v6, v42
 v_mfma_f32_16x16x32_bf16 v[252:255], a[200:203], a[168:171], v[252:255]
 ds_read_b128 a[168:171], v1 offset:22528
 v_mul_f32 v5, v5, v43
 v_cvt_pk_bf16_f32 v9, v6, v5
 v_mfma_f32_16x16x32_bf16 v[252:255], a[204:207], a[172:175], v[252:255]
 ds_read_b128 a[172:175], v1 offset:23552
 v_accvgpr_read_b32 v5, a26
 v_mfma_f32_16x16x32_bf16 v[248:251], a[204:207], a[164:167], v[248:251]
 ds_read_b128 a[164:167], v1 offset:19456
 v_lshlrev_b32 v6, 16, v5
 v_and_b32 v5, s26, v5
 v_mfma_f32_16x16x32_bf16 v[248:251], a[200:203], a[160:163], v[248:251]
 ds_read_b128 a[160:163], v1 offset:18432
 v_mul_f32 v6, v6, v72
 v_mfma_f32_16x16x32_bf16 v[244:247], a[200:203], a[152:155], v[244:247]
 ds_read_b128 a[152:155], v1 offset:14336
 v_mul_f32 v5, v5, v73
 v_mfma_f32_16x16x32_bf16 v[244:247], a[204:207], a[156:159], v[244:247]
 ds_read_b128 a[156:159], v1 offset:15360
 v_cvt_pk_bf16_f32 v10, v6, v5
 v_mfma_f32_16x16x32_bf16 v[240:243], a[204:207], a[148:151], v[240:243]
 ds_read_b128 a[148:151], v1 offset:11264
 v_accvgpr_read_b32 v5, a27
 v_mfma_f32_16x16x32_bf16 v[240:243], a[200:203], a[144:147], v[240:243]
 ds_read_b128 a[144:147], v1 offset:10240
 v_lshlrev_b32 v6, 16, v5
 v_mfma_f32_16x16x32_bf16 v[236:239], a[200:203], a[136:139], v[236:239]
 ds_read_b128 a[136:139], v1 offset:6144
 v_and_b32 v5, s26, v5
 v_mfma_f32_16x16x32_bf16 v[236:239], a[204:207], a[140:143], v[236:239]
 ds_read_b128 a[140:143], v1 offset:7168
 v_mul_f32 v6, v6, v74
 v_mfma_f32_16x16x32_bf16 v[232:235], a[204:207], a[132:135], v[232:235]
 ds_read_b128 a[132:135], v1 offset:3072
 v_mul_f32 v5, v5, v75
 v_mfma_f32_16x16x32_bf16 v[232:235], a[200:203], a[128:131], v[232:235]
 ds_read_b128 a[128:131], v1 offset:2048
 v_cvt_pk_bf16_f32 v11, v6, v5
 s_waitcnt vmcnt(13) lgkmcnt(8)
 v_mfma_f32_16x16x32_bf16 v[164:167], a[208:211], a[184:187], v[164:167]
 ds_write_b128 v3, v[8:11] offset:24576
 v_accvgpr_read_b32 v5, a56
 v_lshlrev_b32 v6, 16, v5
 v_and_b32 v5, s26, v5
 v_mul_f32 v6, v6, v104
 v_mul_f32 v5, v5, v105
 v_cvt_pk_bf16_f32 v12, v6, v5
 v_mfma_f32_16x16x32_bf16 v[164:167], a[212:215], a[188:191], v[164:167]
 global_load_dwordx4 a[204:207], v0, s[70:71] offset:-1024 sc1
 v_accvgpr_read_b32 v5, a57
 v_lshlrev_b32 v6, 16, v5
 v_and_b32 v5, s26, v5
 v_mfma_f32_16x16x32_bf16 v[160:163], a[212:215], a[180:183], v[160:163]
 v_mul_f32 v6, v6, v106
 v_mul_f32 v5, v5, v107
 v_mfma_f32_16x16x32_bf16 v[160:163], a[208:211], a[176:179], v[160:163]
 global_load_dwordx4 a[200:203], v0, s[70:71] offset:-2048 sc1
 v_cvt_pk_bf16_f32 v13, v6, v5
 v_mfma_f32_16x16x32_bf16 v[156:159], a[208:211], a[168:171], v[156:159]
 v_accvgpr_read_b32 v5, a58
 v_accvgpr_read_b32 v7, a240
 v_mfma_f32_16x16x32_bf16 v[156:159], a[212:215], a[172:175], v[156:159]
 v_lshlrev_b32 v6, 16, v5
 v_and_b32 v5, s26, v5
 v_mfma_f32_16x16x32_bf16 v[152:155], a[212:215], a[164:167], v[152:155]
 v_mul_f32 v6, v6, v7
 v_accvgpr_read_b32 v7, a241
 v_mfma_f32_16x16x32_bf16 v[152:155], a[208:211], a[160:163], v[152:155]
 v_mul_f32 v5, v5, v7
 v_cvt_pk_bf16_f32 v14, v6, v5
 s_waitcnt lgkmcnt(1)
 v_mfma_f32_16x16x32_bf16 v[148:151], a[208:211], a[152:155], v[148:151]
 v_accvgpr_read_b32 v5, a59
 v_accvgpr_read_b32 v7, a242
 v_mfma_f32_16x16x32_bf16 v[148:151], a[212:215], a[156:159], v[148:151]
 v_lshlrev_b32 v6, 16, v5
 v_and_b32 v5, s26, v5
 v_mfma_f32_16x16x32_bf16 v[144:147], a[212:215], a[148:151], v[144:147]
 v_mul_f32 v6, v6, v7
 v_accvgpr_read_b32 v7, a243
 v_mfma_f32_16x16x32_bf16 v[144:147], a[208:211], a[144:147], v[144:147]
 v_mul_f32 v5, v5, v7
 v_cvt_pk_bf16_f32 v15, v6, v5
 v_mfma_f32_16x16x32_bf16 v[140:143], a[208:211], a[136:139], v[140:143]
 ds_write_b128 v3, v[12:15] offset:25600
 v_accvgpr_read_b32 v5, a28
 v_mfma_f32_16x16x32_bf16 v[140:143], a[212:215], a[140:143], v[140:143]
 v_lshlrev_b32 v6, 16, v5
 v_and_b32 v5, s26, v5
 v_mfma_f32_16x16x32_bf16 v[136:139], a[212:215], a[132:135], v[136:139]
 v_mul_f32 v6, v6, v44
 v_mul_f32 v5, v5, v45
 v_mfma_f32_16x16x32_bf16 v[136:139], a[208:211], a[128:131], v[136:139]
 v_cvt_pk_bf16_f32 v8, v6, v5
 v_accvgpr_read_b32 v5, a29
 s_waitcnt vmcnt(12)
 v_mfma_f32_16x16x32_bf16 v[168:171], a[216:219], a[128:131], v[168:171]
 v_lshlrev_b32 v6, 16, v5
 v_and_b32 v5, s26, v5
 v_mfma_f32_16x16x32_bf16 v[168:171], a[220:223], a[132:135], v[168:171]
 global_load_dwordx4 a[212:215], v0, s[70:71] offset:1024 sc1
 v_mul_f32 v6, v6, v46
 v_mfma_f32_16x16x32_bf16 v[172:175], a[220:223], a[140:143], v[172:175]
 v_mul_f32 v5, v5, v47
 v_cvt_pk_bf16_f32 v9, v6, v5
 v_mfma_f32_16x16x32_bf16 v[172:175], a[216:219], a[136:139], v[172:175]
 global_load_dwordx4 a[208:211], v0, s[70:71] offset:0 sc1
 v_accvgpr_read_b32 v5, a30
 v_lshlrev_b32 v6, 16, v5
 v_mfma_f32_16x16x32_bf16 v[176:179], a[216:219], a[144:147], v[176:179]
 v_and_b32 v5, s26, v5
 v_mul_f32 v6, v6, v76
 v_mfma_f32_16x16x32_bf16 v[176:179], a[220:223], a[148:151], v[176:179]
 v_mul_f32 v5, v5, v77
 v_cvt_pk_bf16_f32 v10, v6, v5
 v_mfma_f32_16x16x32_bf16 v[180:183], a[220:223], a[156:159], v[180:183]
 v_accvgpr_read_b32 v5, a31
 v_lshlrev_b32 v6, 16, v5
 v_mfma_f32_16x16x32_bf16 v[180:183], a[216:219], a[152:155], v[180:183]
 v_and_b32 v5, s26, v5
 v_mul_f32 v6, v6, v78
 v_mfma_f32_16x16x32_bf16 v[184:187], a[216:219], a[160:163], v[184:187]
 v_mul_f32 v5, v5, v79
 v_cvt_pk_bf16_f32 v11, v6, v5
 v_mfma_f32_16x16x32_bf16 v[184:187], a[220:223], a[164:167], v[184:187]
 ds_write_b128 v3, v[8:11] offset:28672
 v_mfma_f32_16x16x32_bf16 v[188:191], a[220:223], a[172:175], v[188:191]
 v_accvgpr_read_b32 v5, a60
 v_lshlrev_b32 v6, 16, v5
 v_mfma_f32_16x16x32_bf16 v[188:191], a[216:219], a[168:171], v[188:191]
 v_and_b32 v5, s26, v5
 v_mul_f32 v6, v6, v108
 v_mfma_f32_16x16x32_bf16 v[192:195], a[216:219], a[176:179], v[192:195]
 v_mul_f32 v5, v5, v109
 v_cvt_pk_bf16_f32 v12, v6, v5
 v_mfma_f32_16x16x32_bf16 v[192:195], a[220:223], a[180:183], v[192:195]
 v_accvgpr_read_b32 v5, a61
 v_lshlrev_b32 v6, 16, v5
 v_mfma_f32_16x16x32_bf16 v[196:199], a[220:223], a[188:191], v[196:199]
 v_and_b32 v5, s26, v5
 v_mul_f32 v6, v6, v110
 v_mfma_f32_16x16x32_bf16 v[196:199], a[216:219], a[184:187], v[196:199]
 v_mul_f32 v5, v5, v111
 v_cvt_pk_bf16_f32 v13, v6, v5
 s_waitcnt vmcnt(11)
 v_mfma_f32_16x16x32_bf16 v[228:231], a[224:227], a[184:187], v[228:231]
 v_accvgpr_read_b32 v5, a62
 v_accvgpr_read_b32 v7, a244
 v_mfma_f32_16x16x32_bf16 v[228:231], a[228:231], a[188:191], v[228:231]
 global_load_dwordx4 a[220:223], v0, s[70:71] offset:3072 sc1
 v_lshlrev_b32 v6, 16, v5
 v_mfma_f32_16x16x32_bf16 v[224:227], a[228:231], a[180:183], v[224:227]
 v_and_b32 v5, s26, v5
 v_mul_f32 v6, v6, v7
 v_mfma_f32_16x16x32_bf16 v[224:227], a[224:227], a[176:179], v[224:227]
 global_load_dwordx4 a[216:219], v0, s[70:71] offset:2048 sc1
 v_accvgpr_read_b32 v7, a245
 v_mfma_f32_16x16x32_bf16 v[220:223], a[224:227], a[168:171], v[220:223]
 v_mul_f32 v5, v5, v7
 v_cvt_pk_bf16_f32 v14, v6, v5
 s_add_u32 s70, s70, 8192
 s_addc_u32 s71, s71, 0
 v_mfma_f32_16x16x32_bf16 v[220:223], a[228:231], a[172:175], v[220:223]
 v_accvgpr_read_b32 v5, a63
 v_accvgpr_read_b32 v7, a246
 v_mfma_f32_16x16x32_bf16 v[216:219], a[228:231], a[164:167], v[216:219]
 v_lshlrev_b32 v6, 16, v5
 v_and_b32 v5, s26, v5
 v_mfma_f32_16x16x32_bf16 v[216:219], a[224:227], a[160:163], v[216:219]
 v_mul_f32 v6, v6, v7
 v_accvgpr_read_b32 v7, a247
 v_mfma_f32_16x16x32_bf16 v[212:215], a[224:227], a[152:155], v[212:215]
 v_mul_f32 v5, v5, v7
 v_cvt_pk_bf16_f32 v15, v6, v5
 v_mfma_f32_16x16x32_bf16 v[212:215], a[228:231], a[156:159], v[212:215]
 ds_write_b128 v3, v[12:15] offset:29696
 v_mfma_f32_16x16x32_bf16 v[208:211], a[228:231], a[148:151], v[208:211]
 s_waitcnt lgkmcnt(0)
 s_barrier
 v_mfma_f32_16x16x32_bf16 v[208:211], a[224:227], a[144:147], v[208:211]
 v_and_b32 v1, 1023, v3
 v_add_u32 v2, 65536, v1
 v_mfma_f32_16x16x32_bf16 v[204:207], a[224:227], a[136:139], v[204:207]
 v_mfma_f32_16x16x32_bf16 v[204:207], a[228:231], a[140:143], v[204:207]
 v_mfma_f32_16x16x32_bf16 v[200:203], a[228:231], a[132:135], v[200:203]
 v_mfma_f32_16x16x32_bf16 v[200:203], a[224:227], a[128:131], v[200:203]
 s_waitcnt vmcnt(9)
 v_mfma_f32_16x16x32_bf16 v[232:235], a[232:235], a[128:131], v[232:235]
 ds_read_b128 a[128:131], v1
 v_mfma_f32_16x16x32_bf16 v[232:235], a[236:239], a[132:135], v[232:235]
 global_load_dwordx4 a[228:231], v0, s[70:71] offset:-3072 sc1
 ds_read_b128 a[132:135], v1 offset:1024
 v_mfma_f32_16x16x32_bf16 v[236:239], a[236:239], a[140:143], v[236:239]
 ds_read_b128 a[140:143], v1 offset:5120
 v_mfma_f32_16x16x32_bf16 v[236:239], a[232:235], a[136:139], v[236:239]
 global_load_dwordx4 a[224:227], v0, s[70:71] offset:-4096 sc1
 ds_read_b128 a[136:139], v1 offset:4096
 v_mfma_f32_16x16x32_bf16 v[240:243], a[232:235], a[144:147], v[240:243]
 ds_read_b128 a[144:147], v1 offset:8192
 v_mfma_f32_16x16x32_bf16 v[240:243], a[236:239], a[148:151], v[240:243]
 ds_read_b128 a[148:151], v1 offset:9216
 v_mfma_f32_16x16x32_bf16 v[244:247], a[236:239], a[156:159], v[244:247]
 ds_read_b128 a[156:159], v1 offset:13312
 v_mfma_f32_16x16x32_bf16 v[244:247], a[232:235], a[152:155], v[244:247]
 ds_read_b128 a[152:155], v1 offset:12288
 v_mfma_f32_16x16x32_bf16 v[248:251], a[232:235], a[160:163], v[248:251]
 ds_read_b128 a[160:163], v1 offset:16384
 v_mfma_f32_16x16x32_bf16 v[248:251], a[236:239], a[164:167], v[248:251]
 ds_read_b128 a[164:167], v1 offset:17408
 v_mfma_f32_16x16x32_bf16 v[252:255], a[236:239], a[172:175], v[252:255]
 ds_read_b128 a[172:175], v1 offset:21504
 v_mfma_f32_16x16x32_bf16 v[252:255], a[232:235], a[168:171], v[252:255]
 ds_read_b128 a[168:171], v1 offset:20480
 v_mfma_f32_16x16x32_bf16 a[248:251], a[232:235], a[176:179], a[248:251]
 ds_read_b128 a[176:179], v1 offset:24576
 v_mfma_f32_16x16x32_bf16 a[248:251], a[236:239], a[180:183], a[248:251]
 ds_read_b128 a[180:183], v1 offset:25600
 v_mfma_f32_16x16x32_bf16 a[252:255], a[236:239], a[188:191], a[252:255]
 global_load_dwordx4 a[236:239], v0, s[70:71] offset:-1024 sc1
 ds_read_b128 a[188:191], v1 offset:29696
 v_mfma_f32_16x16x32_bf16 a[252:255], a[232:235], a[184:187], a[252:255]
 global_load_dwordx4 a[232:235], v0, s[70:71] offset:-2048 sc1
 ds_read_b128 a[184:187], v1 offset:28672
 s_waitcnt vmcnt(10) lgkmcnt(8)
 v_mfma_f32_16x16x32_bf16 v[16:19], a[192:195], a[128:131], v[16:19]
 v_accvgpr_read_b32 v5, a64
 v_lshlrev_b32 v6, 16, v5
 v_mfma_f32_16x16x32_bf16 v[16:19], a[196:199], a[132:135], v[16:19]
 ds_read_b128 v[12:15], v3 offset:24576
 v_mfma_f32_16x16x32_bf16 v[20:23], a[196:199], a[140:143], v[20:23]
 v_and_b32 v5, s26, v5
 v_mul_f32 v6, v6, v136
 v_mfma_f32_16x16x32_bf16 v[20:23], a[192:195], a[136:139], v[20:23]
 v_mul_f32 v5, v5, v137
 v_cvt_pk_bf16_f32 v8, v6, v5
 v_mfma_f32_16x16x32_bf16 v[24:27], a[192:195], a[144:147], v[24:27]
 v_accvgpr_read_b32 v5, a65
 v_lshlrev_b32 v6, 16, v5
 v_mfma_f32_16x16x32_bf16 v[24:27], a[196:199], a[148:151], v[24:27]
 v_and_b32 v5, s26, v5
 v_mul_f32 v6, v6, v138
 v_mfma_f32_16x16x32_bf16 v[28:31], a[196:199], a[156:159], v[28:31]
 v_mul_f32 v5, v5, v139
 v_cvt_pk_bf16_f32 v9, v6, v5
 v_mfma_f32_16x16x32_bf16 v[28:31], a[192:195], a[152:155], v[28:31]
 v_accvgpr_read_b32 v5, a66
 v_lshlrev_b32 v6, 16, v5
 s_waitcnt lgkmcnt(1)
 v_mfma_f32_16x16x32_bf16 v[32:35], a[192:195], a[160:163], v[32:35]
 v_and_b32 v5, s26, v5
 v_mul_f32 v6, v6, v168
 v_mfma_f32_16x16x32_bf16 v[32:35], a[196:199], a[164:167], v[32:35]
 v_mul_f32 v5, v5, v169
 v_cvt_pk_bf16_f32 v10, v6, v5
 v_mfma_f32_16x16x32_bf16 v[36:39], a[196:199], a[172:175], v[36:39]
 v_accvgpr_read_b32 v5, a67
 v_lshlrev_b32 v6, 16, v5
 v_mfma_f32_16x16x32_bf16 v[36:39], a[192:195], a[168:171], v[36:39]
 v_and_b32 v5, s26, v5
 v_mul_f32 v6, v6, v170
 v_mfma_f32_16x16x32_bf16 v[40:43], a[192:195], a[176:179], v[40:43]
 v_mul_f32 v5, v5, v171
 v_cvt_pk_bf16_f32 v11, v6, v5
 v_mfma_f32_16x16x32_bf16 v[40:43], a[196:199], a[180:183], v[40:43]
 ds_write_b128 v3, v[8:11] offset:2048
 v_mfma_f32_16x16x32_bf16 v[44:47], a[196:199], a[188:191], v[44:47]
 s_add_u32 s68, s29, 16384
 buffer_store_dwordx4 v[8:11], v3, s[32:35], s68 offen sc1
 v_mfma_f32_16x16x32_bf16 v[44:47], a[192:195], a[184:187], v[44:47]
 s_waitcnt vmcnt(9)
 v_mfma_f32_16x16x32_bf16 v[76:79], a[200:203], a[184:187], v[76:79]
 v_accvgpr_read_b32 v5, a96
 v_lshlrev_b32 v6, 16, v5
 v_mfma_f32_16x16x32_bf16 v[76:79], a[204:207], a[188:191], v[76:79]
 global_load_dwordx4 a[196:199], v0, s[70:71] offset:1024 sc1
 v_and_b32 v5, s26, v5
 v_mfma_f32_16x16x32_bf16 v[72:75], a[204:207], a[180:183], v[72:75]
 v_mul_f32 v6, v6, v200
 v_mul_f32 v5, v5, v201
 v_mfma_f32_16x16x32_bf16 v[72:75], a[200:203], a[176:179], v[72:75]
 global_load_dwordx4 a[192:195], v0, s[70:71] offset:0 sc1
 v_cvt_pk_bf16_f32 v8, v6, v5
 v_mfma_f32_16x16x32_bf16 v[68:71], a[200:203], a[168:171], v[68:71]
 v_accvgpr_read_b32 v5, a97
 v_lshlrev_b32 v6, 16, v5
 v_mfma_f32_16x16x32_bf16 v[68:71], a[204:207], a[172:175], v[68:71]
 v_and_b32 v5, s26, v5
 v_mul_f32 v6, v6, v202
 v_mfma_f32_16x16x32_bf16 v[64:67], a[204:207], a[164:167], v[64:67]
 v_mul_f32 v5, v5, v203
 v_cvt_pk_bf16_f32 v9, v6, v5
 v_mfma_f32_16x16x32_bf16 v[64:67], a[200:203], a[160:163], v[64:67]
 v_accvgpr_read_b32 v5, a98
 v_lshlrev_b32 v6, 16, v5
 v_mfma_f32_16x16x32_bf16 v[60:63], a[200:203], a[152:155], v[60:63]
 v_and_b32 v5, s26, v5
 v_mul_f32 v6, v6, v232
 v_mfma_f32_16x16x32_bf16 v[60:63], a[204:207], a[156:159], v[60:63]
 v_mul_f32 v5, v5, v233
 v_cvt_pk_bf16_f32 v10, v6, v5
 v_mfma_f32_16x16x32_bf16 v[56:59], a[204:207], a[148:151], v[56:59]
 v_accvgpr_read_b32 v5, a99
 v_lshlrev_b32 v6, 16, v5
 v_mfma_f32_16x16x32_bf16 v[56:59], a[200:203], a[144:147], v[56:59]
 v_and_b32 v5, s26, v5
 v_mul_f32 v6, v6, v234
 s_waitcnt lgkmcnt(1)
 v_mfma_f32_16x16x32_bf16 v[52:55], a[200:203], a[136:139], v[52:55]
 v_mul_f32 v5, v5, v235
 v_cvt_pk_bf16_f32 v11, v6, v5
 v_mfma_f32_16x16x32_bf16 v[52:55], a[204:207], a[140:143], v[52:55]
 ds_write_b128 v3, v[8:11] offset:3072
 v_mfma_f32_16x16x32_bf16 v[48:51], a[204:207], a[132:135], v[48:51]
 buffer_store_dwordx4 v[8:11], v3, s[32:35], s68 offen offset:1024 sc1
 v_accvgpr_read_b32 v5, a68
 v_mfma_f32_16x16x32_bf16 v[48:51], a[200:203], a[128:131], v[48:51]
 v_lshlrev_b32 v6, 16, v5
 v_and_b32 v5, s26, v5
 s_add_u32 s69, s29, 12288
 s_waitcnt vmcnt(10)
 v_mfma_f32_16x16x32_bf16 v[80:83], a[208:211], a[128:131], v[80:83]
 v_mul_f32 v6, v6, v140
 v_mul_f32 v5, v5, v141
 v_mfma_f32_16x16x32_bf16 v[80:83], a[212:215], a[132:135], v[80:83]
 global_load_dwordx4 a[204:207], v0, s[70:71] offset:3072 sc1
 v_cvt_pk_bf16_f32 v8, v6, v5
 v_mfma_f32_16x16x32_bf16 v[84:87], a[212:215], a[140:143], v[84:87]
 v_accvgpr_read_b32 v5, a69
 v_lshlrev_b32 v6, 16, v5
 v_mfma_f32_16x16x32_bf16 v[84:87], a[208:211], a[136:139], v[84:87]
 global_load_dwordx4 a[200:203], v0, s[70:71] offset:2048 sc1
 v_and_b32 v5, s26, v5
 v_mfma_f32_16x16x32_bf16 v[88:91], a[208:211], a[144:147], v[88:91]
 buffer_store_dwordx4 v[12:15], v3, s[32:35], s69 offen sc1
 s_add_u32 s70, s70, 8192
 s_addc_u32 s71, s71, 0
 v_mfma_f32_16x16x32_bf16 v[88:91], a[212:215], a[148:151], v[88:91]
 v_mul_f32 v6, v6, v142
 v_mul_f32 v5, v5, v143
 v_mfma_f32_16x16x32_bf16 v[92:95], a[212:215], a[156:159], v[92:95]
 v_cvt_pk_bf16_f32 v9, v6, v5
 v_accvgpr_read_b32 v5, a70
 v_mfma_f32_16x16x32_bf16 v[92:95], a[208:211], a[152:155], v[92:95]
 v_lshlrev_b32 v6, 16, v5
 v_and_b32 v5, s26, v5
 v_mfma_f32_16x16x32_bf16 v[96:99], a[208:211], a[160:163], v[96:99]
 v_mul_f32 v6, v6, v172
 v_mul_f32 v5, v5, v173
 v_mfma_f32_16x16x32_bf16 v[96:99], a[212:215], a[164:167], v[96:99]
 v_cvt_pk_bf16_f32 v10, v6, v5
 v_accvgpr_read_b32 v5, a71
 v_mfma_f32_16x16x32_bf16 v[100:103], a[212:215], a[172:175], v[100:103]
 v_lshlrev_b32 v6, 16, v5
 v_and_b32 v5, s26, v5
 v_mfma_f32_16x16x32_bf16 v[100:103], a[208:211], a[168:171], v[100:103]
 v_mul_f32 v6, v6, v174
 v_mul_f32 v5, v5, v175
 v_cvt_pk_bf16_f32 v11, v6, v5
 v_mfma_f32_16x16x32_bf16 v[104:107], a[208:211], a[176:179], v[104:107]
 ds_read_b128 v[12:15], v3 offset:25600
 v_mfma_f32_16x16x32_bf16 v[104:107], a[212:215], a[180:183], v[104:107]
 ds_write_b128 v3, v[8:11] offset:6144
 v_mfma_f32_16x16x32_bf16 v[108:111], a[212:215], a[188:191], v[108:111]
 buffer_store_dwordx4 v[8:11], v3, s[32:35], s68 offen offset:2048 sc1
 v_accvgpr_read_b32 v5, a100
 v_lshlrev_b32 v6, 16, v5
 v_and_b32 v5, s26, v5
 v_mfma_f32_16x16x32_bf16 v[108:111], a[208:211], a[184:187], v[108:111]
 v_mul_f32 v6, v6, v204
 v_mul_f32 v5, v5, v205
 s_waitcnt vmcnt(12)
 v_mfma_f32_16x16x32_bf16 a[244:247], a[216:219], a[184:187], a[244:247]
 ds_read_b128 a[184:187], v1 offset:61440
 v_cvt_pk_bf16_f32 v8, v6, v5
 v_mfma_f32_16x16x32_bf16 a[244:247], a[220:223], a[188:191], a[244:247]
 global_load_dwordx4 a[212:215], v0, s[70:71] offset:-3072 sc1
 ds_read_b128 a[188:191], v1 offset:62464
 v_mfma_f32_16x16x32_bf16 a[240:243], a[220:223], a[180:183], a[240:243]
 ds_read_b128 a[180:183], v1 offset:58368
 v_accvgpr_read_b32 v5, a101
 v_mfma_f32_16x16x32_bf16 a[240:243], a[216:219], a[176:179], a[240:243]
 global_load_dwordx4 a[208:211], v0, s[70:71] offset:-4096 sc1
 ds_read_b128 a[176:179], v1 offset:57344
 v_mfma_f32_16x16x32_bf16 v[132:135], a[216:219], a[168:171], v[132:135]
 ds_read_b128 a[168:171], v1 offset:53248
 v_lshlrev_b32 v6, 16, v5
 v_mfma_f32_16x16x32_bf16 v[132:135], a[220:223], a[172:175], v[132:135]
 ds_read_b128 a[172:175], v1 offset:54272
 v_and_b32 v5, s26, v5
 v_mfma_f32_16x16x32_bf16 v[128:131], a[220:223], a[164:167], v[128:131]
 ds_read_b128 a[164:167], v1 offset:50176
 v_mul_f32 v6, v6, v206
 v_mfma_f32_16x16x32_bf16 v[128:131], a[216:219], a[160:163], v[128:131]
 ds_read_b128 a[160:163], v1 offset:49152
 v_mul_f32 v5, v5, v207
 v_cvt_pk_bf16_f32 v9, v6, v5
 v_mfma_f32_16x16x32_bf16 v[124:127], a[216:219], a[152:155], v[124:127]
 ds_read_b128 a[152:155], v1 offset:45056
 v_accvgpr_read_b32 v5, a102
 v_mfma_f32_16x16x32_bf16 v[124:127], a[220:223], a[156:159], v[124:127]
 ds_read_b128 a[156:159], v1 offset:46080
 v_lshlrev_b32 v6, 16, v5
 v_and_b32 v5, s26, v5
 v_mfma_f32_16x16x32_bf16 v[120:123], a[220:223], a[148:151], v[120:123]
 ds_read_b128 a[148:151], v1 offset:41984
 v_mul_f32 v6, v6, v236
 v_mfma_f32_16x16x32_bf16 v[120:123], a[216:219], a[144:147], v[120:123]
 ds_read_b128 a[144:147], v1 offset:40960
 v_mul_f32 v5, v5, v237
 v_mfma_f32_16x16x32_bf16 v[116:119], a[216:219], a[136:139], v[116:119]
 ds_read_b128 a[136:139], v1 offset:36864
 v_cvt_pk_bf16_f32 v10, v6, v5
 v_mfma_f32_16x16x32_bf16 v[116:119], a[220:223], a[140:143], v[116:119]
 ds_read_b128 a[140:143], v1 offset:37888
 v_accvgpr_read_b32 v5, a103
 v_mfma_f32_16x16x32_bf16 v[112:115], a[220:223], a[132:135], v[112:115]
 ds_read_b128 a[132:135], v1 offset:33792
 v_lshlrev_b32 v6, 16, v5
 v_mfma_f32_16x16x32_bf16 v[112:115], a[216:219], a[128:131], v[112:115]
 ds_read_b128 a[128:131], v1 offset:32768
 v_and_b32 v5, s26, v5
 s_waitcnt vmcnt(12) lgkmcnt(8)
 v_mfma_f32_16x16x32_bf16 v[44:47], a[224:227], a[184:187], v[44:47]
 v_mul_f32 v6, v6, v238
 v_mul_f32 v5, v5, v239
 v_mfma_f32_16x16x32_bf16 v[44:47], a[228:231], a[188:191], v[44:47]
 global_load_dwordx4 a[220:223], v0, s[70:71] offset:-1024 sc1
 v_cvt_pk_bf16_f32 v11, v6, v5
 v_mfma_f32_16x16x32_bf16 v[40:43], a[228:231], a[180:183], v[40:43]
 ds_write_b128 v3, v[8:11] offset:7168
 v_mfma_f32_16x16x32_bf16 v[40:43], a[224:227], a[176:179], v[40:43]
 global_load_dwordx4 a[216:219], v0, s[70:71] offset:-2048 sc1
 v_mfma_f32_16x16x32_bf16 v[36:39], a[224:227], a[168:171], v[36:39]
 buffer_store_dwordx4 v[8:11], v3, s[32:35], s68 offen offset:3072 sc1
 v_accvgpr_read_b32 v5, a72
 v_lshlrev_b32 v6, 16, v5
 v_and_b32 v5, s26, v5
 v_mul_f32 v6, v6, v144
 v_mul_f32 v5, v5, v145
 v_mfma_f32_16x16x32_bf16 v[36:39], a[228:231], a[172:175], v[36:39]
 v_cvt_pk_bf16_f32 v8, v6, v5
 v_accvgpr_read_b32 v5, a73
 v_lshlrev_b32 v6, 16, v5
 v_mfma_f32_16x16x32_bf16 v[32:35], a[228:231], a[164:167], v[32:35]
 v_and_b32 v5, s26, v5
 v_mul_f32 v6, v6, v146
 v_mfma_f32_16x16x32_bf16 v[32:35], a[224:227], a[160:163], v[32:35]
 v_mul_f32 v5, v5, v147
 v_cvt_pk_bf16_f32 v9, v6, v5
 s_waitcnt lgkmcnt(1)
 v_mfma_f32_16x16x32_bf16 v[28:31], a[224:227], a[152:155], v[28:31]
 v_accvgpr_read_b32 v5, a74
 v_lshlrev_b32 v6, 16, v5
 v_mfma_f32_16x16x32_bf16 v[28:31], a[228:231], a[156:159], v[28:31]
 buffer_store_dwordx4 v[12:15], v3, s[32:35], s69 offen offset:1024 sc1
 v_mfma_f32_16x16x32_bf16 v[24:27], a[228:231], a[148:151], v[24:27]
 v_and_b32 v5, s26, v5
 v_mul_f32 v6, v6, v176
 v_mfma_f32_16x16x32_bf16 v[24:27], a[224:227], a[144:147], v[24:27]
 v_mul_f32 v5, v5, v177
 v_cvt_pk_bf16_f32 v10, v6, v5
 v_mfma_f32_16x16x32_bf16 v[20:23], a[224:227], a[136:139], v[20:23]
 v_accvgpr_read_b32 v5, a75
 v_lshlrev_b32 v6, 16, v5
 v_mfma_f32_16x16x32_bf16 v[20:23], a[228:231], a[140:143], v[20:23]
 v_and_b32 v5, s26, v5
 v_mul_f32 v6, v6, v178
 v_mfma_f32_16x16x32_bf16 v[16:19], a[228:231], a[132:135], v[16:19]
 v_mul_f32 v5, v5, v179
 v_cvt_pk_bf16_f32 v11, v6, v5
 v_mfma_f32_16x16x32_bf16 v[16:19], a[224:227], a[128:131], v[16:19]
 ds_write_b128 v3, v[8:11] offset:10240
 s_waitcnt vmcnt(14)
 v_mfma_f32_16x16x32_bf16 v[48:51], a[232:235], a[128:131], v[48:51]
 v_accvgpr_read_b32 v5, a104
 v_lshlrev_b32 v6, 16, v5
 v_mfma_f32_16x16x32_bf16 v[48:51], a[236:239], a[132:135], v[48:51]
 global_load_dwordx4 a[228:231], v0, s[70:71] offset:1024 sc1
 v_and_b32 v5, s26, v5
 v_mfma_f32_16x16x32_bf16 v[52:55], a[236:239], a[140:143], v[52:55]
 v_mul_f32 v6, v6, v208
 v_mul_f32 v5, v5, v209
 v_mfma_f32_16x16x32_bf16 v[52:55], a[232:235], a[136:139], v[52:55]
 global_load_dwordx4 a[224:227], v0, s[70:71] offset:0 sc1
 ds_read_b128 v[12:15], v3 offset:28672
 v_mfma_f32_16x16x32_bf16 v[56:59], a[232:235], a[144:147], v[56:59]
 v_cvt_pk_bf16_f32 v8, v6, v5
 v_accvgpr_read_b32 v5, a105
 v_mfma_f32_16x16x32_bf16 v[56:59], a[236:239], a[148:151], v[56:59]
 v_lshlrev_b32 v6, 16, v5
 v_and_b32 v5, s26, v5
 v_mfma_f32_16x16x32_bf16 v[60:63], a[236:239], a[156:159], v[60:63]
 v_mul_f32 v6, v6, v210
 v_mul_f32 v5, v5, v211
 v_mfma_f32_16x16x32_bf16 v[60:63], a[232:235], a[152:155], v[60:63]
 v_cvt_pk_bf16_f32 v9, v6, v5
 v_accvgpr_read_b32 v5, a106
 v_mfma_f32_16x16x32_bf16 v[64:67], a[232:235], a[160:163], v[64:67]
 v_lshlrev_b32 v6, 16, v5
 v_mfma_f32_16x16x32_bf16 v[64:67], a[236:239], a[164:167], v[64:67]
 v_and_b32 v5, s26, v5
 v_mul_f32 v6, v6, v240
 v_mfma_f32_16x16x32_bf16 v[68:71], a[236:239], a[172:175], v[68:71]
 v_mul_f32 v5, v5, v241
 v_cvt_pk_bf16_f32 v10, v6, v5
 v_mfma_f32_16x16x32_bf16 v[68:71], a[232:235], a[168:171], v[68:71]
 v_accvgpr_read_b32 v5, a107
 v_lshlrev_b32 v6, 16, v5
 v_mfma_f32_16x16x32_bf16 v[72:75], a[232:235], a[176:179], v[72:75]
 v_and_b32 v5, s26, v5
 v_mul_f32 v6, v6, v242
 v_mfma_f32_16x16x32_bf16 v[72:75], a[236:239], a[180:183], v[72:75]
 v_mul_f32 v5, v5, v243
 v_cvt_pk_bf16_f32 v11, v6, v5
 v_mfma_f32_16x16x32_bf16 v[76:79], a[236:239], a[188:191], v[76:79]
 ds_write_b128 v3, v[8:11] offset:11264
 v_mfma_f32_16x16x32_bf16 v[76:79], a[232:235], a[184:187], v[76:79]
 v_accvgpr_read_b32 v5, a76
 v_lshlrev_b32 v6, 16, v5
 s_waitcnt vmcnt(13)
 v_mfma_f32_16x16x32_bf16 v[108:111], a[192:195], a[184:187], v[108:111]
 v_and_b32 v5, s26, v5
 v_mul_f32 v6, v6, v148
 v_mfma_f32_16x16x32_bf16 v[108:111], a[196:199], a[188:191], v[108:111]
 global_load_dwordx4 a[236:239], v0, s[70:71] offset:3072 sc1
 v_mul_f32 v5, v5, v149
 v_mfma_f32_16x16x32_bf16 v[104:107], a[196:199], a[180:183], v[104:107]
 v_cvt_pk_bf16_f32 v8, v6, v5
 v_accvgpr_read_b32 v5, a77
 v_mfma_f32_16x16x32_bf16 v[104:107], a[192:195], a[176:179], v[104:107]
 global_load_dwordx4 a[232:235], v0, s[70:71] offset:2048 sc1
 v_lshlrev_b32 v6, 16, v5
 v_mfma_f32_16x16x32_bf16 v[100:103], a[192:195], a[168:171], v[100:103]
 v_and_b32 v5, s26, v5
 v_mul_f32 v6, v6, v150
 s_add_u32 s70, s70, 8192
 s_addc_u32 s71, s71, 0
 v_mfma_f32_16x16x32_bf16 v[100:103], a[196:199], a[172:175], v[100:103]
 v_mul_f32 v5, v5, v151
 v_cvt_pk_bf16_f32 v9, v6, v5
 v_mfma_f32_16x16x32_bf16 v[96:99], a[196:199], a[164:167], v[96:99]
 v_accvgpr_read_b32 v5, a78
 v_lshlrev_b32 v6, 16, v5
 v_mfma_f32_16x16x32_bf16 v[96:99], a[192:195], a[160:163], v[96:99]
 v_and_b32 v5, s26, v5
 v_mul_f32 v6, v6, v180
 v_mfma_f32_16x16x32_bf16 v[92:95], a[192:195], a[152:155], v[92:95]
 v_mul_f32 v5, v5, v181
 v_cvt_pk_bf16_f32 v10, v6, v5
 v_mfma_f32_16x16x32_bf16 v[92:95], a[196:199], a[156:159], v[92:95]
 v_accvgpr_read_b32 v5, a79
 v_lshlrev_b32 v6, 16, v5
 v_mfma_f32_16x16x32_bf16 v[88:91], a[196:199], a[148:151], v[88:91]
 v_and_b32 v5, s26, v5
 v_mul_f32 v6, v6, v182
 v_mfma_f32_16x16x32_bf16 v[88:91], a[192:195], a[144:147], v[88:91]
 v_mul_f32 v5, v5, v183
 v_cvt_pk_bf16_f32 v11, v6, v5
 v_mfma_f32_16x16x32_bf16 v[84:87], a[192:195], a[136:139], v[84:87]
 ds_write_b128 v3, v[8:11] offset:14336
 v_mfma_f32_16x16x32_bf16 v[84:87], a[196:199], a[140:143], v[84:87]
 v_accvgpr_read_b32 v5, a108
 v_lshlrev_b32 v6, 16, v5
 s_waitcnt lgkmcnt(2)
 v_mfma_f32_16x16x32_bf16 v[80:83], a[196:199], a[132:135], v[80:83]
 buffer_store_dwordx4 v[12:15], v3, s[32:35], s69 offen offset:2048 sc1
 v_mfma_f32_16x16x32_bf16 v[80:83], a[192:195], a[128:131], v[80:83]
 v_and_b32 v5, s26, v5
 v_mul_f32 v6, v6, v212
 s_waitcnt vmcnt(13)
 v_mfma_f32_16x16x32_bf16 v[112:115], a[200:203], a[128:131], v[112:115]
 ds_read_b128 a[128:131], v2
 v_mul_f32 v5, v5, v213
 v_mfma_f32_16x16x32_bf16 v[112:115], a[204:207], a[132:135], v[112:115]
 global_load_dwordx4 a[196:199], v0, s[70:71] offset:-3072 sc1
 ds_read_b128 a[132:135], v2 offset:1024
 v_mfma_f32_16x16x32_bf16 v[116:119], a[204:207], a[140:143], v[116:119]
 ds_read_b128 a[140:143], v2 offset:5120
 v_cvt_pk_bf16_f32 v8, v6, v5
 v_mfma_f32_16x16x32_bf16 v[116:119], a[200:203], a[136:139], v[116:119]
 global_load_dwordx4 a[192:195], v0, s[70:71] offset:-4096 sc1
 ds_read_b128 a[136:139], v2 offset:4096
 v_accvgpr_read_b32 v5, a109
 v_lshlrev_b32 v6, 16, v5
 v_mfma_f32_16x16x32_bf16 v[120:123], a[200:203], a[144:147], v[120:123]
 ds_read_b128 a[144:147], v2 offset:8192
 v_and_b32 v5, s26, v5
 v_mfma_f32_16x16x32_bf16 v[120:123], a[204:207], a[148:151], v[120:123]
 ds_read_b128 a[148:151], v2 offset:9216
 v_mul_f32 v6, v6, v214
 v_mul_f32 v5, v5, v215
 v_mfma_f32_16x16x32_bf16 v[124:127], a[204:207], a[156:159], v[124:127]
 ds_read_b128 a[156:159], v2 offset:13312
 v_cvt_pk_bf16_f32 v9, v6, v5
 v_accvgpr_read_b32 v5, a110
 v_mfma_f32_16x16x32_bf16 v[124:127], a[200:203], a[152:155], v[124:127]
 ds_read_b128 a[152:155], v2 offset:12288
 v_lshlrev_b32 v6, 16, v5
 v_mfma_f32_16x16x32_bf16 v[128:131], a[200:203], a[160:163], v[128:131]
 ds_read_b128 a[160:163], v2 offset:16384
 v_and_b32 v5, s26, v5
 v_mul_f32 v6, v6, v244
 v_mfma_f32_16x16x32_bf16 v[128:131], a[204:207], a[164:167], v[128:131]
 ds_read_b128 a[164:167], v2 offset:17408
 v_mul_f32 v5, v5, v245
 v_cvt_pk_bf16_f32 v10, v6, v5
 v_mfma_f32_16x16x32_bf16 v[132:135], a[204:207], a[172:175], v[132:135]
 ds_read_b128 a[172:175], v2 offset:21504
 ds_read_b128 v[12:15], v3 offset:29696
 v_mfma_f32_16x16x32_bf16 v[132:135], a[200:203], a[168:171], v[132:135]
 ds_read_b128 a[168:171], v2 offset:20480
 v_accvgpr_read_b32 v5, a111
 v_lshlrev_b32 v6, 16, v5
 v_mfma_f32_16x16x32_bf16 a[240:243], a[200:203], a[176:179], a[240:243]
 ds_read_b128 a[176:179], v2 offset:24576
 v_and_b32 v5, s26, v5
 v_mfma_f32_16x16x32_bf16 a[240:243], a[204:207], a[180:183], a[240:243]
 ds_read_b128 a[180:183], v2 offset:25600
 v_mul_f32 v6, v6, v246
 v_mfma_f32_16x16x32_bf16 a[244:247], a[204:207], a[188:191], a[244:247]
 ds_read_b128 a[188:191], v2 offset:29696
 v_mul_f32 v5, v5, v247
 v_mfma_f32_16x16x32_bf16 a[244:247], a[200:203], a[184:187], a[244:247]
 ds_read_b128 a[184:187], v2 offset:28672
 v_cvt_pk_bf16_f32 v11, v6, v5
 s_waitcnt vmcnt(11) lgkmcnt(9)
 v_mfma_f32_16x16x32_bf16 v[16:19], a[208:211], a[128:131], v[16:19]
 ds_write_b128 v3, v[8:11] offset:15360
 v_mfma_f32_16x16x32_bf16 v[16:19], a[212:215], a[132:135], v[16:19]
 global_load_dwordx4 a[204:207], v0, s[70:71] offset:-1024 sc1
 v_accvgpr_read_b32 v5, a80
 v_mfma_f32_16x16x32_bf16 v[20:23], a[212:215], a[140:143], v[20:23]
 v_lshlrev_b32 v6, 16, v5
 v_and_b32 v5, s26, v5
 v_mfma_f32_16x16x32_bf16 v[20:23], a[208:211], a[136:139], v[20:23]
 global_load_dwordx4 a[200:203], v0, s[70:71] offset:-2048 sc1
 v_mul_f32 v6, v6, v152
 v_mfma_f32_16x16x32_bf16 v[24:27], a[208:211], a[144:147], v[24:27]
 v_mul_f32 v5, v5, v153
 v_cvt_pk_bf16_f32 v8, v6, v5
 v_mfma_f32_16x16x32_bf16 v[24:27], a[212:215], a[148:151], v[24:27]
 v_accvgpr_read_b32 v5, a81
 v_lshlrev_b32 v6, 16, v5
 v_mfma_f32_16x16x32_bf16 v[28:31], a[212:215], a[156:159], v[28:31]
 v_and_b32 v5, s26, v5
 v_mul_f32 v6, v6, v154
 v_mfma_f32_16x16x32_bf16 v[28:31], a[208:211], a[152:155], v[28:31]
 v_mul_f32 v5, v5, v155
 v_cvt_pk_bf16_f32 v9, v6, v5
 s_waitcnt lgkmcnt(1)
 v_mfma_f32_16x16x32_bf16 v[32:35], a[208:211], a[160:163], v[32:35]
 v_accvgpr_read_b32 v5, a82
 v_lshlrev_b32 v6, 16, v5
 v_mfma_f32_16x16x32_bf16 v[32:35], a[212:215], a[164:167], v[32:35]
 v_and_b32 v5, s26, v5
 v_mul_f32 v6, v6, v184
 v_mfma_f32_16x16x32_bf16 v[36:39], a[212:215], a[172:175], v[36:39]
 v_mul_f32 v5, v5, v185
 v_cvt_pk_bf16_f32 v10, v6, v5
 v_mfma_f32_16x16x32_bf16 v[36:39], a[208:211], a[168:171], v[36:39]
 v_accvgpr_read_b32 v5, a83
 v_lshlrev_b32 v6, 16, v5
 v_mfma_f32_16x16x32_bf16 v[40:43], a[208:211], a[176:179], v[40:43]
 v_and_b32 v5, s26, v5
 v_mul_f32 v6, v6, v186
 v_mfma_f32_16x16x32_bf16 v[40:43], a[212:215], a[180:183], v[40:43]
 v_mul_f32 v5, v5, v187
 v_cvt_pk_bf16_f32 v11, v6, v5
 v_mfma_f32_16x16x32_bf16 v[44:47], a[212:215], a[188:191], v[44:47]
 ds_write_b128 v3, v[8:11] offset:18432
 v_mfma_f32_16x16x32_bf16 v[44:47], a[208:211], a[184:187], v[44:47]
 v_accvgpr_read_b32 v5, a112
 v_lshlrev_b32 v6, 16, v5
 s_waitcnt vmcnt(11)
 v_mfma_f32_16x16x32_bf16 v[76:79], a[216:219], a[184:187], v[76:79]
 v_and_b32 v5, s26, v5
 v_mul_f32 v6, v6, v216
 v_mfma_f32_16x16x32_bf16 v[76:79], a[220:223], a[188:191], v[76:79]
 global_load_dwordx4 a[212:215], v0, s[70:71] offset:1024 sc1
 v_mul_f32 v5, v5, v217
 v_mfma_f32_16x16x32_bf16 v[72:75], a[220:223], a[180:183], v[72:75]
 v_cvt_pk_bf16_f32 v8, v6, v5
 v_accvgpr_read_b32 v5, a113
 v_mfma_f32_16x16x32_bf16 v[72:75], a[216:219], a[176:179], v[72:75]
 global_load_dwordx4 a[208:211], v0, s[70:71] offset:0 sc1
 v_lshlrev_b32 v6, 16, v5
 v_mfma_f32_16x16x32_bf16 v[68:71], a[216:219], a[168:171], v[68:71]
 v_and_b32 v5, s26, v5
 v_mul_f32 v6, v6, v218
 v_mfma_f32_16x16x32_bf16 v[68:71], a[220:223], a[172:175], v[68:71]
 v_mul_f32 v5, v5, v219
 v_cvt_pk_bf16_f32 v9, v6, v5
 v_mfma_f32_16x16x32_bf16 v[64:67], a[220:223], a[164:167], v[64:67]
 v_accvgpr_read_b32 v5, a114
 v_lshlrev_b32 v6, 16, v5
 v_mfma_f32_16x16x32_bf16 v[64:67], a[216:219], a[160:163], v[64:67]
 buffer_store_dwordx4 v[12:15], v3, s[32:35], s69 offen offset:3072 sc1
 v_mfma_f32_16x16x32_bf16 v[60:63], a[216:219], a[152:155], v[60:63]
 v_and_b32 v5, s26, v5
 v_mul_f32 v6, v6, v248
 v_mfma_f32_16x16x32_bf16 v[60:63], a[220:223], a[156:159], v[60:63]
 v_mul_f32 v5, v5, v249
 v_cvt_pk_bf16_f32 v10, v6, v5
 v_mfma_f32_16x16x32_bf16 v[56:59], a[220:223], a[148:151], v[56:59]
 v_accvgpr_read_b32 v5, a115
 v_lshlrev_b32 v6, 16, v5
 v_mfma_f32_16x16x32_bf16 v[56:59], a[216:219], a[144:147], v[56:59]
 v_and_b32 v5, s26, v5
 v_mul_f32 v6, v6, v250
 v_mfma_f32_16x16x32_bf16 v[52:55], a[216:219], a[136:139], v[52:55]
 v_mul_f32 v5, v5, v251
 v_cvt_pk_bf16_f32 v11, v6, v5
 v_mfma_f32_16x16x32_bf16 v[52:55], a[220:223], a[140:143], v[52:55]
 ds_write_b128 v3, v[8:11] offset:19456
 v_mfma_f32_16x16x32_bf16 v[48:51], a[220:223], a[132:135], v[48:51]
 v_accvgpr_read_b32 v5, a84
 v_lshlrev_b32 v6, 16, v5
 v_mfma_f32_16x16x32_bf16 v[48:51], a[216:219], a[128:131], v[48:51]
 v_and_b32 v5, s26, v5
 v_mul_f32 v6, v6, v156
 s_waitcnt vmcnt(10)
 v_mfma_f32_16x16x32_bf16 v[80:83], a[224:227], a[128:131], v[80:83]
 v_mul_f32 v5, v5, v157
 v_cvt_pk_bf16_f32 v8, v6, v5
 v_mfma_f32_16x16x32_bf16 v[80:83], a[228:231], a[132:135], v[80:83]
 global_load_dwordx4 a[220:223], v0, s[70:71] offset:3072 sc1
 v_accvgpr_read_b32 v5, a85
 v_mfma_f32_16x16x32_bf16 v[84:87], a[228:231], a[140:143], v[84:87]
 v_lshlrev_b32 v6, 16, v5
 v_and_b32 v5, s26, v5
 v_mfma_f32_16x16x32_bf16 v[84:87], a[224:227], a[136:139], v[84:87]
 global_load_dwordx4 a[216:219], v0, s[70:71] offset:2048 sc1
 v_mul_f32 v6, v6, v158
 v_mfma_f32_16x16x32_bf16 v[88:91], a[224:227], a[144:147], v[88:91]
 v_mul_f32 v5, v5, v159
 v_cvt_pk_bf16_f32 v9, v6, v5
 s_add_u32 s70, s70, 8192
 s_addc_u32 s71, s71, 0
 v_mfma_f32_16x16x32_bf16 v[88:91], a[228:231], a[148:151], v[88:91]
 v_accvgpr_read_b32 v5, a86
 v_lshlrev_b32 v6, 16, v5
 v_mfma_f32_16x16x32_bf16 v[92:95], a[228:231], a[156:159], v[92:95]
 v_and_b32 v5, s26, v5
 v_mul_f32 v6, v6, v188
 v_mfma_f32_16x16x32_bf16 v[92:95], a[224:227], a[152:155], v[92:95]
 v_mul_f32 v5, v5, v189
 v_cvt_pk_bf16_f32 v10, v6, v5
 v_mfma_f32_16x16x32_bf16 v[96:99], a[224:227], a[160:163], v[96:99]
 v_accvgpr_read_b32 v5, a87
 v_lshlrev_b32 v6, 16, v5
 v_mfma_f32_16x16x32_bf16 v[96:99], a[228:231], a[164:167], v[96:99]
 v_and_b32 v5, s26, v5
 v_mul_f32 v6, v6, v190
 v_mfma_f32_16x16x32_bf16 v[100:103], a[228:231], a[172:175], v[100:103]
 v_mul_f32 v5, v5, v191
 v_cvt_pk_bf16_f32 v11, v6, v5
 v_mfma_f32_16x16x32_bf16 v[100:103], a[224:227], a[168:171], v[100:103]
 ds_write_b128 v3, v[8:11] offset:22528
 v_mfma_f32_16x16x32_bf16 v[104:107], a[224:227], a[176:179], v[104:107]
 v_accvgpr_read_b32 v5, a116
 v_lshlrev_b32 v6, 16, v5
 v_mfma_f32_16x16x32_bf16 v[104:107], a[228:231], a[180:183], v[104:107]
 v_and_b32 v5, s26, v5
 v_mul_f32 v6, v6, v220
 v_mfma_f32_16x16x32_bf16 v[108:111], a[228:231], a[188:191], v[108:111]
 v_mul_f32 v5, v5, v221
 v_cvt_pk_bf16_f32 v8, v6, v5
 v_mfma_f32_16x16x32_bf16 v[108:111], a[224:227], a[184:187], v[108:111]
 v_accvgpr_read_b32 v5, a117
 v_lshlrev_b32 v6, 16, v5
 s_waitcnt vmcnt(10)
 v_mfma_f32_16x16x32_bf16 a[244:247], a[232:235], a[184:187], a[244:247]
 ds_read_b128 a[184:187], v2 offset:61440
 v_and_b32 v5, s26, v5
 v_mfma_f32_16x16x32_bf16 a[244:247], a[236:239], a[188:191], a[244:247]
 global_load_dwordx4 a[228:231], v0, s[70:71] offset:-3072 sc1
 ds_read_b128 a[188:191], v2 offset:62464
 v_mfma_f32_16x16x32_bf16 a[240:243], a[236:239], a[180:183], a[240:243]
 ds_read_b128 a[180:183], v2 offset:58368
 v_mul_f32 v6, v6, v222
 v_mfma_f32_16x16x32_bf16 a[240:243], a[232:235], a[176:179], a[240:243]
 global_load_dwordx4 a[224:227], v0, s[70:71] offset:-4096 sc1
 ds_read_b128 a[176:179], v2 offset:57344
 v_mul_f32 v5, v5, v223
 v_cvt_pk_bf16_f32 v9, v6, v5
 v_mfma_f32_16x16x32_bf16 v[132:135], a[232:235], a[168:171], v[132:135]
 ds_read_b128 a[168:171], v2 offset:53248
 v_accvgpr_read_b32 v5, a118
 v_mfma_f32_16x16x32_bf16 v[132:135], a[236:239], a[172:175], v[132:135]
 ds_read_b128 a[172:175], v2 offset:54272
 v_lshlrev_b32 v6, 16, v5
 v_mfma_f32_16x16x32_bf16 v[128:131], a[236:239], a[164:167], v[128:131]
 ds_read_b128 a[164:167], v2 offset:50176
 v_and_b32 v5, s26, v5
 v_mfma_f32_16x16x32_bf16 v[128:131], a[232:235], a[160:163], v[128:131]
 ds_read_b128 a[160:163], v2 offset:49152
 v_mul_f32 v6, v6, v252
 v_mfma_f32_16x16x32_bf16 v[124:127], a[232:235], a[152:155], v[124:127]
 ds_read_b128 a[152:155], v2 offset:45056
 v_mul_f32 v5, v5, v253
 v_mfma_f32_16x16x32_bf16 v[124:127], a[236:239], a[156:159], v[124:127]
 ds_read_b128 a[156:159], v2 offset:46080
 v_cvt_pk_bf16_f32 v10, v6, v5
 v_mfma_f32_16x16x32_bf16 v[120:123], a[236:239], a[148:151], v[120:123]
 ds_read_b128 a[148:151], v2 offset:41984
 v_accvgpr_read_b32 v5, a119
 v_mfma_f32_16x16x32_bf16 v[120:123], a[232:235], a[144:147], v[120:123]
 ds_read_b128 a[144:147], v2 offset:40960
 v_lshlrev_b32 v6, 16, v5
 v_mfma_f32_16x16x32_bf16 v[116:119], a[232:235], a[136:139], v[116:119]
 ds_read_b128 a[136:139], v2 offset:36864
 v_and_b32 v5, s26, v5
 v_mfma_f32_16x16x32_bf16 v[116:119], a[236:239], a[140:143], v[116:119]
 ds_read_b128 a[140:143], v2 offset:37888
 v_mul_f32 v6, v6, v254
 v_mfma_f32_16x16x32_bf16 v[112:115], a[236:239], a[132:135], v[112:115]
 ds_read_b128 a[132:135], v2 offset:33792
 v_mul_f32 v5, v5, v255
 v_mfma_f32_16x16x32_bf16 v[112:115], a[232:235], a[128:131], v[112:115]
 ds_read_b128 a[128:131], v2 offset:32768
 v_cvt_pk_bf16_f32 v11, v6, v5
 s_waitcnt vmcnt(9) lgkmcnt(8)
 v_mfma_f32_16x16x32_bf16 v[44:47], a[192:195], a[184:187], v[44:47]
 ds_write_b128 v3, v[8:11] offset:23552
 v_accvgpr_read_b32 v5, a88
 v_lshlrev_b32 v6, 16, v5
 v_and_b32 v5, s26, v5
 v_mul_f32 v6, v6, v160
 v_mfma_f32_16x16x32_bf16 v[44:47], a[196:199], a[188:191], v[44:47]
 global_load_dwordx4 a[236:239], v0, s[70:71] offset:-1024 sc1
 v_mul_f32 v5, v5, v161
 v_mfma_f32_16x16x32_bf16 v[40:43], a[196:199], a[180:183], v[40:43]
 v_cvt_pk_bf16_f32 v8, v6, v5
 v_accvgpr_read_b32 v5, a89
 v_mfma_f32_16x16x32_bf16 v[40:43], a[192:195], a[176:179], v[40:43]
 global_load_dwordx4 a[232:235], v0, s[70:71] offset:-2048 sc1
 v_lshlrev_b32 v6, 16, v5
 v_mfma_f32_16x16x32_bf16 v[36:39], a[192:195], a[168:171], v[36:39]
 v_and_b32 v5, s26, v5
 v_mul_f32 v6, v6, v162
 v_mfma_f32_16x16x32_bf16 v[36:39], a[196:199], a[172:175], v[36:39]
 v_mul_f32 v5, v5, v163
 v_cvt_pk_bf16_f32 v9, v6, v5
 v_mfma_f32_16x16x32_bf16 v[32:35], a[196:199], a[164:167], v[32:35]
 v_accvgpr_read_b32 v5, a90
 v_lshlrev_b32 v6, 16, v5
 v_mfma_f32_16x16x32_bf16 v[32:35], a[192:195], a[160:163], v[32:35]
 v_and_b32 v5, s26, v5
 v_mul_f32 v6, v6, v192
 s_waitcnt lgkmcnt(1)
 v_mfma_f32_16x16x32_bf16 v[28:31], a[192:195], a[152:155], v[28:31]
 v_mul_f32 v5, v5, v193
 v_cvt_pk_bf16_f32 v10, v6, v5
 v_mfma_f32_16x16x32_bf16 v[28:31], a[196:199], a[156:159], v[28:31]
 v_accvgpr_read_b32 v5, a91
 v_lshlrev_b32 v6, 16, v5
 v_mfma_f32_16x16x32_bf16 v[24:27], a[196:199], a[148:151], v[24:27]
 v_and_b32 v5, s26, v5
 v_mul_f32 v6, v6, v194
 v_mfma_f32_16x16x32_bf16 v[24:27], a[192:195], a[144:147], v[24:27]
 v_mul_f32 v5, v5, v195
 v_cvt_pk_bf16_f32 v11, v6, v5
 v_mfma_f32_16x16x32_bf16 v[20:23], a[192:195], a[136:139], v[20:23]
 ds_write_b128 v3, v[8:11] offset:26624
 v_mfma_f32_16x16x32_bf16 v[20:23], a[196:199], a[140:143], v[20:23]
 v_accvgpr_read_b32 v5, a120
 v_lshlrev_b32 v6, 16, v5
 v_mfma_f32_16x16x32_bf16 v[16:19], a[196:199], a[132:135], v[16:19]
 v_and_b32 v5, s26, v5
 v_mul_f32 v6, v6, v224
 v_mfma_f32_16x16x32_bf16 v[16:19], a[192:195], a[128:131], v[16:19]
 v_mul_f32 v5, v5, v225
 v_cvt_pk_bf16_f32 v8, v6, v5
 s_waitcnt vmcnt(9)
 v_mfma_f32_16x16x32_bf16 v[48:51], a[200:203], a[128:131], v[48:51]
 v_accvgpr_read_b32 v5, a121
 v_lshlrev_b32 v6, 16, v5
 v_mfma_f32_16x16x32_bf16 v[48:51], a[204:207], a[132:135], v[48:51]
 global_load_dwordx4 a[196:199], v0, s[70:71] offset:1024 sc1
 v_and_b32 v5, s26, v5
 v_mfma_f32_16x16x32_bf16 v[52:55], a[204:207], a[140:143], v[52:55]
 v_mul_f32 v6, v6, v226
 v_mul_f32 v5, v5, v227
 v_mfma_f32_16x16x32_bf16 v[52:55], a[200:203], a[136:139], v[52:55]
 global_load_dwordx4 a[192:195], v0, s[70:71] offset:0 sc1
 v_cvt_pk_bf16_f32 v9, v6, v5
 v_mfma_f32_16x16x32_bf16 v[56:59], a[200:203], a[144:147], v[56:59]
 v_accvgpr_read_b32 v5, a122
 v_accvgpr_read_b32 v7, a248
 v_mfma_f32_16x16x32_bf16 v[56:59], a[204:207], a[148:151], v[56:59]
 v_lshlrev_b32 v6, 16, v5
 v_and_b32 v5, s26, v5
 v_mfma_f32_16x16x32_bf16 v[60:63], a[204:207], a[156:159], v[60:63]
 v_mul_f32 v6, v6, v7
 v_accvgpr_read_b32 v7, a249
 v_mfma_f32_16x16x32_bf16 v[60:63], a[200:203], a[152:155], v[60:63]
 v_mul_f32 v5, v5, v7
 v_cvt_pk_bf16_f32 v10, v6, v5
 v_mfma_f32_16x16x32_bf16 v[64:67], a[200:203], a[160:163], v[64:67]
 v_accvgpr_read_b32 v5, a123
 v_mfma_f32_16x16x32_bf16 v[64:67], a[204:207], a[164:167], v[64:67]
 v_accvgpr_read_b32 v7, a250
 v_lshlrev_b32 v6, 16, v5
 v_mfma_f32_16x16x32_bf16 v[68:71], a[204:207], a[172:175], v[68:71]
 v_and_b32 v5, s26, v5
 v_mul_f32 v6, v6, v7
 v_mfma_f32_16x16x32_bf16 v[68:71], a[200:203], a[168:171], v[68:71]
 v_accvgpr_read_b32 v7, a251
 v_mfma_f32_16x16x32_bf16 v[72:75], a[200:203], a[176:179], v[72:75]
 v_mul_f32 v5, v5, v7
 v_cvt_pk_bf16_f32 v11, v6, v5
 v_mfma_f32_16x16x32_bf16 v[72:75], a[204:207], a[180:183], v[72:75]
 ds_write_b128 v3, v[8:11] offset:27648
 v_mfma_f32_16x16x32_bf16 v[76:79], a[204:207], a[188:191], v[76:79]
 v_accvgpr_read_b32 v5, a92
 v_lshlrev_b32 v6, 16, v5
 v_mfma_f32_16x16x32_bf16 v[76:79], a[200:203], a[184:187], v[76:79]
 v_and_b32 v5, s26, v5
 v_mul_f32 v6, v6, v164
 s_waitcnt vmcnt(9)
 v_mfma_f32_16x16x32_bf16 v[108:111], a[208:211], a[184:187], v[108:111]
 v_mul_f32 v5, v5, v165
 v_cvt_pk_bf16_f32 v8, v6, v5
 v_mfma_f32_16x16x32_bf16 v[108:111], a[212:215], a[188:191], v[108:111]
 global_load_dwordx4 a[204:207], v0, s[70:71] offset:3072 sc1
 v_accvgpr_read_b32 v5, a93
 v_mfma_f32_16x16x32_bf16 v[104:107], a[212:215], a[180:183], v[104:107]
 v_lshlrev_b32 v6, 16, v5
 v_and_b32 v5, s26, v5
 v_mfma_f32_16x16x32_bf16 v[104:107], a[208:211], a[176:179], v[104:107]
 global_load_dwordx4 a[200:203], v0, s[70:71] offset:2048 sc1
 v_mul_f32 v6, v6, v166
 v_mfma_f32_16x16x32_bf16 v[100:103], a[208:211], a[168:171], v[100:103]
 v_mul_f32 v5, v5, v167
 v_cvt_pk_bf16_f32 v9, v6, v5
 s_add_u32 s70, s70, 8192
 s_addc_u32 s71, s71, 0
 v_mfma_f32_16x16x32_bf16 v[100:103], a[212:215], a[172:175], v[100:103]
 v_accvgpr_read_b32 v5, a94
 v_lshlrev_b32 v6, 16, v5
 v_mfma_f32_16x16x32_bf16 v[96:99], a[212:215], a[164:167], v[96:99]
 v_and_b32 v5, s26, v5
 v_mfma_f32_16x16x32_bf16 v[96:99], a[208:211], a[160:163], v[96:99]
 v_mul_f32 v6, v6, v196
 v_mul_f32 v5, v5, v197
 v_mfma_f32_16x16x32_bf16 v[92:95], a[208:211], a[152:155], v[92:95]
 v_cvt_pk_bf16_f32 v10, v6, v5
 v_mfma_f32_16x16x32_bf16 v[92:95], a[212:215], a[156:159], v[92:95]
 v_accvgpr_read_b32 v5, a95
 v_lshlrev_b32 v6, 16, v5
 v_mfma_f32_16x16x32_bf16 v[88:91], a[212:215], a[148:151], v[88:91]
 v_and_b32 v5, s26, v5
 v_mul_f32 v6, v6, v198
 v_mfma_f32_16x16x32_bf16 v[88:91], a[208:211], a[144:147], v[88:91]
 v_mul_f32 v5, v5, v199
 v_cvt_pk_bf16_f32 v11, v6, v5
 v_mfma_f32_16x16x32_bf16 v[84:87], a[208:211], a[136:139], v[84:87]
 ds_write_b128 v3, v[8:11] offset:30720
 v_mfma_f32_16x16x32_bf16 v[84:87], a[212:215], a[140:143], v[84:87]
 v_accvgpr_read_b32 v5, a124
 v_mfma_f32_16x16x32_bf16 v[80:83], a[212:215], a[132:135], v[80:83]
 v_lshlrev_b32 v6, 16, v5
 v_and_b32 v5, s26, v5
 v_mfma_f32_16x16x32_bf16 v[80:83], a[208:211], a[128:131], v[80:83]
 v_mul_f32 v6, v6, v228
 v_mul_f32 v5, v5, v229
 s_waitcnt vmcnt(8)
 v_mfma_f32_16x16x32_bf16 v[112:115], a[216:219], a[128:131], v[112:115]
 v_cvt_pk_bf16_f32 v8, v6, v5
 v_accvgpr_read_b32 v5, a125
 v_mfma_f32_16x16x32_bf16 v[112:115], a[220:223], a[132:135], v[112:115]
 global_load_dwordx4 a[212:215], v0, s[70:71] offset:-3072 sc1
 v_lshlrev_b32 v6, 16, v5
 v_mfma_f32_16x16x32_bf16 v[116:119], a[220:223], a[140:143], v[116:119]
 v_and_b32 v5, s26, v5
 v_mul_f32 v6, v6, v230
 v_mfma_f32_16x16x32_bf16 v[116:119], a[216:219], a[136:139], v[116:119]
 global_load_dwordx4 a[208:211], v0, s[70:71] offset:-4096 sc1
 v_mul_f32 v5, v5, v231
 v_mfma_f32_16x16x32_bf16 v[120:123], a[216:219], a[144:147], v[120:123]
 v_cvt_pk_bf16_f32 v9, v6, v5
 v_accvgpr_read_b32 v5, a126
 v_mfma_f32_16x16x32_bf16 v[120:123], a[220:223], a[148:151], v[120:123]
 v_accvgpr_read_b32 v7, a252
 v_mfma_f32_16x16x32_bf16 v[124:127], a[220:223], a[156:159], v[124:127]
 v_lshlrev_b32 v6, 16, v5
 v_and_b32 v5, s26, v5
 v_mfma_f32_16x16x32_bf16 v[124:127], a[216:219], a[152:155], v[124:127]
 v_mul_f32 v6, v6, v7
 v_accvgpr_read_b32 v7, a253
 v_mfma_f32_16x16x32_bf16 v[128:131], a[216:219], a[160:163], v[128:131]
 v_mul_f32 v5, v5, v7
 v_cvt_pk_bf16_f32 v10, v6, v5
 v_mfma_f32_16x16x32_bf16 v[128:131], a[220:223], a[164:167], v[128:131]
 v_accvgpr_read_b32 v5, a127
 v_accvgpr_read_b32 v7, a254
 v_mfma_f32_16x16x32_bf16 v[132:135], a[220:223], a[172:175], v[132:135]
 v_lshlrev_b32 v6, 16, v5
 v_and_b32 v5, s26, v5
 v_mfma_f32_16x16x32_bf16 v[132:135], a[216:219], a[168:171], v[132:135]
 v_mul_f32 v6, v6, v7
 v_accvgpr_read_b32 v7, a255
 v_mfma_f32_16x16x32_bf16 a[240:243], a[216:219], a[176:179], a[240:243]
 v_mul_f32 v5, v5, v7
 v_cvt_pk_bf16_f32 v11, v6, v5
 v_mfma_f32_16x16x32_bf16 a[240:243], a[220:223], a[180:183], a[240:243]
 ds_write_b128 v3, v[8:11] offset:31744
 v_mfma_f32_16x16x32_bf16 a[244:247], a[220:223], a[188:191], a[244:247]
 global_load_dwordx4 a[220:223], v0, s[70:71] offset:-1024 sc1
 v_mfma_f32_16x16x32_bf16 a[244:247], a[216:219], a[184:187], a[244:247]
 global_load_dwordx4 a[216:219], v0, s[70:71] offset:-2048 sc1
 s_waitcnt vmcnt(10)
Ls1b:
 v_mfma_f32_16x16x32_bf16 v[164:167], a[224:227], a[184:187], v[164:167]
 v_bfe_u32 v4, v3, 8, 2
 v_mfma_f32_16x16x32_bf16 v[164:167], a[228:231], a[188:191], v[164:167]
 ds_read_b128 v[12:15], v3 offset:10240
 v_mfma_f32_16x16x32_bf16 v[160:163], a[228:231], a[180:183], v[160:163]
 v_lshl_add_u32 v4, v4, 5, s51
 v_mfma_f32_16x16x32_bf16 v[160:163], a[224:227], a[176:179], v[160:163]
 ds_read_b128 v[8:11], v4
 v_mfma_f32_16x16x32_bf16 v[156:159], a[224:227], a[168:171], v[156:159]
 v_mfma_f32_16x16x32_bf16 v[156:159], a[228:231], a[172:175], v[156:159]
 v_mfma_f32_16x16x32_bf16 v[152:155], a[228:231], a[164:167], v[152:155]
 v_mfma_f32_16x16x32_bf16 v[152:155], a[224:227], a[160:163], v[152:155]
 v_mfma_f32_16x16x32_bf16 v[148:151], a[224:227], a[152:155], v[148:151]
 v_mfma_f32_16x16x32_bf16 v[148:151], a[228:231], a[156:159], v[148:151]
 v_mfma_f32_16x16x32_bf16 v[144:147], a[228:231], a[148:151], v[144:147]
 v_mfma_f32_16x16x32_bf16 v[144:147], a[224:227], a[144:147], v[144:147]
 v_mfma_f32_16x16x32_bf16 v[140:143], a[224:227], a[136:139], v[140:143]
 v_mfma_f32_16x16x32_bf16 v[140:143], a[228:231], a[140:143], v[140:143]
 s_waitcnt lgkmcnt(0)
 v_mfma_f32_16x16x32_bf16 v[136:139], a[228:231], a[132:135], v[136:139]
 v_add_f32 v16, v16, v8
 v_mfma_f32_16x16x32_bf16 v[136:139], a[224:227], a[128:131], v[136:139]
 v_add_f32 v17, v17, v9
 s_waitcnt vmcnt(8)
 v_mfma_f32_16x16x32_bf16 v[168:171], a[232:235], a[128:131], v[168:171]
 v_add_f32 v18, v18, v10
 v_mfma_f32_16x16x32_bf16 v[168:171], a[236:239], a[132:135], v[168:171]
 global_load_dwordx4 a[228:231], v0, s[70:71] offset:1024 sc1
 v_mfma_f32_16x16x32_bf16 v[172:175], a[236:239], a[140:143], v[172:175]
 s_add_u32 s31, s31, 1
 v_mfma_f32_16x16x32_bf16 v[172:175], a[232:235], a[136:139], v[172:175]
 global_load_dwordx4 a[224:227], v0, s[70:71] offset:0 sc1
 v_mfma_f32_16x16x32_bf16 v[176:179], a[232:235], a[144:147], v[176:179]
 v_mov_b32 v7, s31
 v_mfma_f32_16x16x32_bf16 v[176:179], a[236:239], a[148:151], v[176:179]
 buffer_store_dword v7, v1, s[60:63], 0 offen sc1
 v_mfma_f32_16x16x32_bf16 v[180:183], a[236:239], a[156:159], v[180:183]
 v_add_f32 v19, v19, v11
 s_add_u32 s69, s29, 20480
 v_mfma_f32_16x16x32_bf16 v[180:183], a[232:235], a[152:155], v[180:183]
 v_add_f32 v20, v20, v8
 v_mfma_f32_16x16x32_bf16 v[184:187], a[232:235], a[160:163], v[184:187]
 buffer_store_dwordx4 v[12:15], v3, s[32:35], s69 offen sc1
 v_mfma_f32_16x16x32_bf16 v[184:187], a[236:239], a[164:167], v[184:187]
 v_add_f32 v21, v21, v9
 v_mfma_f32_16x16x32_bf16 v[188:191], a[236:239], a[172:175], v[188:191]
 v_add_f32 v22, v22, v10
 v_mfma_f32_16x16x32_bf16 v[188:191], a[232:235], a[168:171], v[188:191]
 v_mfma_f32_16x16x32_bf16 v[192:195], a[232:235], a[176:179], v[192:195]
 v_add_f32 v23, v23, v11
 v_mfma_f32_16x16x32_bf16 v[192:195], a[236:239], a[180:183], v[192:195]
 v_add_f32 v24, v24, v8
 v_mfma_f32_16x16x32_bf16 v[196:199], a[236:239], a[188:191], v[196:199]
 v_add_f32 v25, v25, v9
 v_mfma_f32_16x16x32_bf16 v[196:199], a[232:235], a[184:187], v[196:199]
 ds_read_b128 v[12:15], v3 offset:11264
 s_waitcnt vmcnt(10)
 v_mfma_f32_16x16x32_bf16 v[228:231], a[192:195], a[184:187], v[228:231]
 v_add_f32 v26, v26, v10
 v_mfma_f32_16x16x32_bf16 v[228:231], a[196:199], a[188:191], v[228:231]
 global_load_dwordx4 a[236:239], v0, s[70:71] offset:3072 sc1
 v_add_f32 v27, v27, v11
 v_mfma_f32_16x16x32_bf16 v[224:227], a[196:199], a[180:183], v[224:227]
 v_add_f32 v28, v28, v8
 v_mfma_f32_16x16x32_bf16 v[224:227], a[192:195], a[176:179], v[224:227]
 global_load_dwordx4 a[232:235], v0, s[70:71] offset:2048 sc1
 v_add_f32 v29, v29, v9
 v_mfma_f32_16x16x32_bf16 v[220:223], a[192:195], a[168:171], v[220:223]
 v_add_f32 v30, v30, v10
 s_add_u32 s70, s70, 8192
 s_addc_u32 s71, s71, 0
 v_mfma_f32_16x16x32_bf16 v[220:223], a[196:199], a[172:175], v[220:223]
 v_mfma_f32_16x16x32_bf16 v[216:219], a[196:199], a[164:167], v[216:219]
 v_add_f32 v31, v31, v11
 v_mfma_f32_16x16x32_bf16 v[216:219], a[192:195], a[160:163], v[216:219]
 v_add_f32 v32, v32, v8
 v_mfma_f32_16x16x32_bf16 v[212:215], a[192:195], a[152:155], v[212:215]
 v_add_f32 v33, v33, v9
 v_mfma_f32_16x16x32_bf16 v[212:215], a[196:199], a[156:159], v[212:215]
 v_add_f32 v34, v34, v10
 v_mfma_f32_16x16x32_bf16 v[208:211], a[196:199], a[148:151], v[208:211]
 v_mfma_f32_16x16x32_bf16 v[208:211], a[192:195], a[144:147], v[208:211]
 v_add_f32 v35, v35, v11
 v_mfma_f32_16x16x32_bf16 v[204:207], a[192:195], a[136:139], v[204:207]
 v_add_f32 v36, v36, v8
 v_mfma_f32_16x16x32_bf16 v[204:207], a[196:199], a[140:143], v[204:207]
 v_add_f32 v37, v37, v9
 v_mfma_f32_16x16x32_bf16 v[200:203], a[196:199], a[132:135], v[200:203]
 v_add_f32 v38, v38, v10
 v_mfma_f32_16x16x32_bf16 v[200:203], a[192:195], a[128:131], v[200:203]
 v_add_f32 v39, v39, v11
 s_waitcnt vmcnt(10)
 v_mfma_f32_16x16x32_bf16 v[232:235], a[200:203], a[128:131], v[232:235]
 ds_read_b128 a[128:131], v2
 v_add_f32 v40, v40, v8
 v_mfma_f32_16x16x32_bf16 v[232:235], a[204:207], a[132:135], v[232:235]
 global_load_dwordx4 a[196:199], v0, s[70:71] offset:-3072 sc1
 ds_read_b128 a[132:135], v2 offset:1024
 v_mfma_f32_16x16x32_bf16 v[236:239], a[204:207], a[140:143], v[236:239]
 ds_read_b128 a[140:143], v2 offset:5120
 v_add_f32 v41, v41, v9
 s_waitcnt lgkmcnt(3)
 v_mfma_f32_16x16x32_bf16 v[236:239], a[200:203], a[136:139], v[236:239]
 global_load_dwordx4 a[192:195], v0, s[70:71] offset:-4096 sc1
 ds_read_b128 a[136:139], v2 offset:4096
 v_mfma_f32_16x16x32_bf16 v[240:243], a[200:203], a[144:147], v[240:243]
 ds_read_b128 a[144:147], v2 offset:8192
 v_add_f32 v42, v42, v10
 v_mfma_f32_16x16x32_bf16 v[240:243], a[204:207], a[148:151], v[240:243]
 buffer_store_dwordx4 v[12:15], v3, s[32:35], s69 offen offset:1024 sc1
 ds_read_b128 a[148:151], v2 offset:9216
 v_mfma_f32_16x16x32_bf16 v[244:247], a[204:207], a[156:159], v[244:247]
 ds_read_b128 a[156:159], v2 offset:13312
 v_add_f32 v43, v43, v11
 v_mfma_f32_16x16x32_bf16 v[244:247], a[200:203], a[152:155], v[244:247]
 ds_read_b128 a[152:155], v2 offset:12288
 v_add_f32 v44, v44, v8
 v_mfma_f32_16x16x32_bf16 v[248:251], a[200:203], a[160:163], v[248:251]
 ds_read_b128 a[160:163], v2 offset:16384
 v_add_f32 v45, v45, v9
 v_mfma_f32_16x16x32_bf16 v[248:251], a[204:207], a[164:167], v[248:251]
 ds_read_b128 a[164:167], v2 offset:17408
 v_add_f32 v46, v46, v10
 v_mfma_f32_16x16x32_bf16 v[252:255], a[204:207], a[172:175], v[252:255]
 ds_read_b128 a[172:175], v2 offset:21504
 v_add_f32 v47, v47, v11
 v_mfma_f32_16x16x32_bf16 v[252:255], a[200:203], a[168:171], v[252:255]
 ds_read_b128 a[168:171], v2 offset:20480
 ds_read_b128 v[8:11], v4 offset:16
 v_mfma_f32_16x16x32_bf16 a[248:251], a[200:203], a[176:179], a[248:251]
 ds_read_b128 a[176:179], v2 offset:24576
 ds_read_b128 v[12:15], v3 offset:14336
 v_mfma_f32_16x16x32_bf16 a[248:251], a[204:207], a[180:183], a[248:251]
 ds_read_b128 a[180:183], v2 offset:25600
 v_mfma_f32_16x16x32_bf16 a[252:255], a[204:207], a[188:191], a[252:255]
 ds_read_b128 a[188:191], v2 offset:29696
 v_mfma_f32_16x16x32_bf16 a[252:255], a[200:203], a[184:187], a[252:255]
 ds_read_b128 a[184:187], v2 offset:28672
 s_waitcnt vmcnt(11) lgkmcnt(10)
 v_mfma_f32_16x16x32_bf16 v[136:139], a[208:211], a[128:131], v[136:139]
 v_mfma_f32_16x16x32_bf16 v[136:139], a[212:215], a[132:135], v[136:139]
 global_load_dwordx4 a[204:207], v0, s[70:71] offset:-1024 sc1
 v_mfma_f32_16x16x32_bf16 v[140:143], a[212:215], a[140:143], v[140:143]
 v_mfma_f32_16x16x32_bf16 v[140:143], a[208:211], a[136:139], v[140:143]
 global_load_dwordx4 a[200:203], v0, s[70:71] offset:-2048 sc1
 v_mfma_f32_16x16x32_bf16 v[144:147], a[208:211], a[144:147], v[144:147]
 v_mfma_f32_16x16x32_bf16 v[144:147], a[212:215], a[148:151], v[144:147]
 s_waitcnt lgkmcnt(5)
 v_mfma_f32_16x16x32_bf16 v[148:151], a[212:215], a[156:159], v[148:151]
 v_add_f32 v48, v48, v8
 v_mfma_f32_16x16x32_bf16 v[148:151], a[208:211], a[152:155], v[148:151]
 v_add_f32 v49, v49, v9
 s_waitcnt lgkmcnt(0)
 v_mfma_f32_16x16x32_bf16 v[152:155], a[208:211], a[160:163], v[152:155]
 v_mfma_f32_16x16x32_bf16 v[152:155], a[212:215], a[164:167], v[152:155]
 v_add_f32 v50, v50, v10
 v_mfma_f32_16x16x32_bf16 v[156:159], a[212:215], a[172:175], v[156:159]
 v_add_f32 v51, v51, v11
 v_mfma_f32_16x16x32_bf16 v[156:159], a[208:211], a[168:171], v[156:159]
 v_add_f32 v52, v52, v8
 v_mfma_f32_16x16x32_bf16 v[160:163], a[208:211], a[176:179], v[160:163]
 v_add_f32 v53, v53, v9
 v_mfma_f32_16x16x32_bf16 v[160:163], a[212:215], a[180:183], v[160:163]
 v_mfma_f32_16x16x32_bf16 v[164:167], a[212:215], a[188:191], v[164:167]
 v_add_f32 v54, v54, v10
 v_mfma_f32_16x16x32_bf16 v[164:167], a[208:211], a[184:187], v[164:167]
 v_add_f32 v55, v55, v11
 s_waitcnt vmcnt(11)
 v_mfma_f32_16x16x32_bf16 v[196:199], a[216:219], a[184:187], v[196:199]
 v_add_f32 v56, v56, v8
 v_mfma_f32_16x16x32_bf16 v[196:199], a[220:223], a[188:191], v[196:199]
 global_load_dwordx4 a[212:215], v0, s[70:71] offset:1024 sc1
 v_add_f32 v57, v57, v9
 v_mfma_f32_16x16x32_bf16 v[192:195], a[220:223], a[180:183], v[192:195]
 v_add_f32 v58, v58, v10
 v_mfma_f32_16x16x32_bf16 v[192:195], a[216:219], a[176:179], v[192:195]
 global_load_dwordx4 a[208:211], v0, s[70:71] offset:0 sc1
 v_add_f32 v59, v59, v11
 v_mfma_f32_16x16x32_bf16 v[188:191], a[216:219], a[168:171], v[188:191]
 buffer_store_dwordx4 v[12:15], v3, s[32:35], s69 offen offset:2048 sc1
 v_mfma_f32_16x16x32_bf16 v[188:191], a[220:223], a[172:175], v[188:191]
 v_add_f32 v60, v60, v8
 v_mfma_f32_16x16x32_bf16 v[184:187], a[220:223], a[164:167], v[184:187]
 v_add_f32 v61, v61, v9
 v_mfma_f32_16x16x32_bf16 v[184:187], a[216:219], a[160:163], v[184:187]
 v_add_f32 v62, v62, v10
 v_mfma_f32_16x16x32_bf16 v[180:183], a[216:219], a[152:155], v[180:183]
 ds_read_b128 v[12:15], v3 offset:15360
 v_mfma_f32_16x16x32_bf16 v[180:183], a[220:223], a[156:159], v[180:183]
 v_add_f32 v63, v63, v11
 v_mfma_f32_16x16x32_bf16 v[176:179], a[220:223], a[148:151], v[176:179]
 v_add_f32 v64, v64, v8
 v_mfma_f32_16x16x32_bf16 v[176:179], a[216:219], a[144:147], v[176:179]
 v_add_f32 v65, v65, v9
 v_mfma_f32_16x16x32_bf16 v[172:175], a[216:219], a[136:139], v[172:175]
 v_mfma_f32_16x16x32_bf16 v[172:175], a[220:223], a[140:143], v[172:175]
 v_add_f32 v66, v66, v10
 v_mfma_f32_16x16x32_bf16 v[168:171], a[220:223], a[132:135], v[168:171]
 v_add_f32 v67, v67, v11
 v_mfma_f32_16x16x32_bf16 v[168:171], a[216:219], a[128:131], v[168:171]
 v_add_f32 v68, v68, v8
 s_waitcnt vmcnt(12)
 v_mfma_f32_16x16x32_bf16 v[200:203], a[224:227], a[128:131], v[200:203]
 v_add_f32 v69, v69, v9
 v_mfma_f32_16x16x32_bf16 v[200:203], a[228:231], a[132:135], v[200:203]
 global_load_dwordx4 a[220:223], v0, s[70:71] offset:3072 sc1
 v_mfma_f32_16x16x32_bf16 v[204:207], a[228:231], a[140:143], v[204:207]
 v_add_f32 v70, v70, v10
 v_mfma_f32_16x16x32_bf16 v[204:207], a[224:227], a[136:139], v[204:207]
 global_load_dwordx4 a[216:219], v0, s[70:71] offset:2048 sc1
 v_add_f32 v71, v71, v11
 v_mfma_f32_16x16x32_bf16 v[208:211], a[224:227], a[144:147], v[208:211]
 v_add_f32 v72, v72, v8
 s_add_u32 s70, s70, 8192
 s_addc_u32 s71, s71, 0
 v_mfma_f32_16x16x32_bf16 v[208:211], a[228:231], a[148:151], v[208:211]
 v_add_f32 v73, v73, v9
 v_mfma_f32_16x16x32_bf16 v[212:215], a[228:231], a[156:159], v[212:215]
 v_mfma_f32_16x16x32_bf16 v[212:215], a[224:227], a[152:155], v[212:215]
 v_add_f32 v74, v74, v10
 v_mfma_f32_16x16x32_bf16 v[216:219], a[224:227], a[160:163], v[216:219]
 v_add_f32 v75, v75, v11
 v_mfma_f32_16x16x32_bf16 v[216:219], a[228:231], a[164:167], v[216:219]
 v_add_f32 v76, v76, v8
 v_mfma_f32_16x16x32_bf16 v[220:223], a[228:231], a[172:175], v[220:223]
 v_add_f32 v77, v77, v9
 v_mfma_f32_16x16x32_bf16 v[220:223], a[224:227], a[168:171], v[220:223]
 s_waitcnt lgkmcnt(0)
 v_mfma_f32_16x16x32_bf16 v[224:227], a[224:227], a[176:179], v[224:227]
 v_add_f32 v78, v78, v10
 v_mfma_f32_16x16x32_bf16 v[224:227], a[228:231], a[180:183], v[224:227]
 v_add_f32 v79, v79, v11
 v_mfma_f32_16x16x32_bf16 v[228:231], a[228:231], a[188:191], v[228:231]
 buffer_store_dwordx4 v[12:15], v3, s[32:35], s69 offen offset:3072 sc1
 v_mfma_f32_16x16x32_bf16 v[228:231], a[224:227], a[184:187], v[228:231]
 ds_read_b128 v[8:11], v4 offset:128
 s_waitcnt vmcnt(11)
 v_mfma_f32_16x16x32_bf16 a[252:255], a[232:235], a[184:187], a[252:255]
 ds_read_b128 a[184:187], v1 offset:61440
 v_mfma_f32_16x16x32_bf16 a[252:255], a[236:239], a[188:191], a[252:255]
 global_load_dwordx4 a[228:231], v0, s[70:71] offset:-3072 sc1
 ds_read_b128 a[188:191], v1 offset:62464
 v_mfma_f32_16x16x32_bf16 a[248:251], a[236:239], a[180:183], a[248:251]
 ds_read_b128 a[180:183], v1 offset:58368
 v_mfma_f32_16x16x32_bf16 a[248:251], a[232:235], a[176:179], a[248:251]
 global_load_dwordx4 a[224:227], v0, s[70:71] offset:-4096 sc1
 ds_read_b128 a[176:179], v1 offset:57344
 v_mfma_f32_16x16x32_bf16 v[252:255], a[232:235], a[168:171], v[252:255]
 ds_read_b128 a[168:171], v1 offset:53248
 v_mfma_f32_16x16x32_bf16 v[252:255], a[236:239], a[172:175], v[252:255]
 ds_read_b128 a[172:175], v1 offset:54272
 ds_read_b128 v[12:15], v3 offset:18432
 v_mfma_f32_16x16x32_bf16 v[248:251], a[236:239], a[164:167], v[248:251]
 ds_read_b128 a[164:167], v1 offset:50176
 v_mfma_f32_16x16x32_bf16 v[248:251], a[232:235], a[160:163], v[248:251]
 ds_read_b128 a[160:163], v1 offset:49152
 v_mfma_f32_16x16x32_bf16 v[244:247], a[232:235], a[152:155], v[244:247]
 ds_read_b128 a[152:155], v1 offset:45056
 s_waitcnt lgkmcnt(10)
 v_mfma_f32_16x16x32_bf16 v[244:247], a[236:239], a[156:159], v[244:247]
 ds_read_b128 a[156:159], v1 offset:46080
 v_mfma_f32_16x16x32_bf16 v[240:243], a[236:239], a[148:151], v[240:243]
 ds_read_b128 a[148:151], v1 offset:41984
 v_add_f32 v80, v80, v8
 v_mfma_f32_16x16x32_bf16 v[240:243], a[232:235], a[144:147], v[240:243]
 ds_read_b128 a[144:147], v1 offset:40960
 v_add_f32 v81, v81, v9
 v_mfma_f32_16x16x32_bf16 v[236:239], a[232:235], a[136:139], v[236:239]
 ds_read_b128 a[136:139], v1 offset:36864
 v_add_f32 v82, v82, v10
 v_mfma_f32_16x16x32_bf16 v[236:239], a[236:239], a[140:143], v[236:239]
 ds_read_b128 a[140:143], v1 offset:37888
 v_add_f32 v83, v83, v11
 v_mfma_f32_16x16x32_bf16 v[232:235], a[236:239], a[132:135], v[232:235]
 ds_read_b128 a[132:135], v1 offset:33792
 v_mfma_f32_16x16x32_bf16 v[232:235], a[232:235], a[128:131], v[232:235]
 ds_read_b128 a[128:131], v1 offset:32768
 v_add_f32 v84, v84, v8
 s_waitcnt vmcnt(11) lgkmcnt(8)
 v_mfma_f32_16x16x32_bf16 v[164:167], a[192:195], a[184:187], v[164:167]
 v_add_f32 v85, v85, v9
 v_mfma_f32_16x16x32_bf16 v[164:167], a[196:199], a[188:191], v[164:167]
 global_load_dwordx4 a[236:239], v0, s[70:71] offset:-1024 sc1
 v_add_f32 v86, v86, v10
 v_mfma_f32_16x16x32_bf16 v[160:163], a[196:199], a[180:183], v[160:163]
 v_add_f32 v87, v87, v11
 v_mfma_f32_16x16x32_bf16 v[160:163], a[192:195], a[176:179], v[160:163]
 global_load_dwordx4 a[232:235], v0, s[70:71] offset:-2048 sc1
 v_mfma_f32_16x16x32_bf16 v[156:159], a[192:195], a[168:171], v[156:159]
 v_add_f32 v88, v88, v8
 v_mfma_f32_16x16x32_bf16 v[156:159], a[196:199], a[172:175], v[156:159]
 v_add_f32 v89, v89, v9
 v_mfma_f32_16x16x32_bf16 v[152:155], a[196:199], a[164:167], v[152:155]
 v_add_f32 v90, v90, v10
 v_mfma_f32_16x16x32_bf16 v[152:155], a[192:195], a[160:163], v[152:155]
 v_add_f32 v91, v91, v11
 s_waitcnt lgkmcnt(0)
 v_mfma_f32_16x16x32_bf16 v[148:151], a[192:195], a[152:155], v[148:151]
 v_mfma_f32_16x16x32_bf16 v[148:151], a[196:199], a[156:159], v[148:151]
 v_add_f32 v92, v92, v8
 v_mfma_f32_16x16x32_bf16 v[144:147], a[196:199], a[148:151], v[144:147]
 v_add_f32 v93, v93, v9
 s_add_u32 s69, s29, 24576
 v_mfma_f32_16x16x32_bf16 v[144:147], a[192:195], a[144:147], v[144:147]
 v_add_f32 v94, v94, v10
 v_mfma_f32_16x16x32_bf16 v[140:143], a[192:195], a[136:139], v[140:143]
 buffer_store_dwordx4 v[12:15], v3, s[32:35], s69 offen sc1
 v_mfma_f32_16x16x32_bf16 v[140:143], a[196:199], a[140:143], v[140:143]
 v_add_f32 v95, v95, v11
 v_mfma_f32_16x16x32_bf16 v[136:139], a[196:199], a[132:135], v[136:139]
 v_add_f32 v96, v96, v8
 v_mfma_f32_16x16x32_bf16 v[136:139], a[192:195], a[128:131], v[136:139]
 v_add_f32 v97, v97, v9
 s_waitcnt vmcnt(11)
 v_mfma_f32_16x16x32_bf16 v[168:171], a[200:203], a[128:131], v[168:171]
 v_add_f32 v98, v98, v10
 v_mfma_f32_16x16x32_bf16 v[168:171], a[204:207], a[132:135], v[168:171]
 global_load_dwordx4 a[196:199], v0, s[70:71] offset:1024 sc1
 v_add_f32 v99, v99, v11
 v_mfma_f32_16x16x32_bf16 v[172:175], a[204:207], a[140:143], v[172:175]
 v_add_f32 v100, v100, v8
 v_mfma_f32_16x16x32_bf16 v[172:175], a[200:203], a[136:139], v[172:175]
 global_load_dwordx4 a[192:195], v0, s[70:71] offset:0 sc1
 ds_read_b128 v[12:15], v3 offset:19456
 v_mfma_f32_16x16x32_bf16 v[176:179], a[200:203], a[144:147], v[176:179]
 v_add_f32 v101, v101, v9
 v_mfma_f32_16x16x32_bf16 v[176:179], a[204:207], a[148:151], v[176:179]
 v_add_f32 v102, v102, v10
 v_mfma_f32_16x16x32_bf16 v[180:183], a[204:207], a[156:159], v[180:183]
 v_add_f32 v103, v103, v11
 v_mfma_f32_16x16x32_bf16 v[180:183], a[200:203], a[152:155], v[180:183]
 v_mfma_f32_16x16x32_bf16 v[184:187], a[200:203], a[160:163], v[184:187]
 v_add_f32 v104, v104, v8
 v_mfma_f32_16x16x32_bf16 v[184:187], a[204:207], a[164:167], v[184:187]
 v_add_f32 v105, v105, v9
 v_mfma_f32_16x16x32_bf16 v[188:191], a[204:207], a[172:175], v[188:191]
 v_add_f32 v106, v106, v10
 v_mfma_f32_16x16x32_bf16 v[188:191], a[200:203], a[168:171], v[188:191]
 v_add_f32 v107, v107, v11
 v_mfma_f32_16x16x32_bf16 v[192:195], a[200:203], a[176:179], v[192:195]
 v_mfma_f32_16x16x32_bf16 v[192:195], a[204:207], a[180:183], v[192:195]
 v_add_f32 v108, v108, v8
 v_mfma_f32_16x16x32_bf16 v[196:199], a[204:207], a[188:191], v[196:199]
 v_add_f32 v109, v109, v9
 v_mfma_f32_16x16x32_bf16 v[196:199], a[200:203], a[184:187], v[196:199]
 v_add_f32 v110, v110, v10
 s_waitcnt vmcnt(11)
 v_mfma_f32_16x16x32_bf16 v[228:231], a[208:211], a[184:187], v[228:231]
 v_add_f32 v111, v111, v11
 v_mfma_f32_16x16x32_bf16 v[228:231], a[212:215], a[188:191], v[228:231]
 global_load_dwordx4 a[204:207], v0, s[70:71] offset:3072 sc1
 v_mfma_f32_16x16x32_bf16 v[224:227], a[212:215], a[180:183], v[224:227]
 ds_read_b128 v[8:11], v4 offset:144
 v_mfma_f32_16x16x32_bf16 v[224:227], a[208:211], a[176:179], v[224:227]
 global_load_dwordx4 a[200:203], v0, s[70:71] offset:2048 sc1
 v_mfma_f32_16x16x32_bf16 v[220:223], a[208:211], a[168:171], v[220:223]
 s_add_u32 s70, s70, 8192
 s_addc_u32 s71, s71, 0
 v_mfma_f32_16x16x32_bf16 v[220:223], a[212:215], a[172:175], v[220:223]
 v_mfma_f32_16x16x32_bf16 v[216:219], a[212:215], a[164:167], v[216:219]
 s_waitcnt lgkmcnt(1)
 v_mfma_f32_16x16x32_bf16 v[216:219], a[208:211], a[160:163], v[216:219]
 v_mfma_f32_16x16x32_bf16 v[212:215], a[208:211], a[152:155], v[212:215]
 v_mfma_f32_16x16x32_bf16 v[212:215], a[212:215], a[156:159], v[212:215]
 buffer_store_dwordx4 v[12:15], v3, s[32:35], s69 offen offset:1024 sc1
 v_mfma_f32_16x16x32_bf16 v[208:211], a[212:215], a[148:151], v[208:211]
 v_mfma_f32_16x16x32_bf16 v[208:211], a[208:211], a[144:147], v[208:211]
 v_mfma_f32_16x16x32_bf16 v[204:207], a[208:211], a[136:139], v[204:207]
 s_waitcnt lgkmcnt(0)
 v_mfma_f32_16x16x32_bf16 v[204:207], a[212:215], a[140:143], v[204:207]
 v_add_f32 v112, v112, v8
 v_mfma_f32_16x16x32_bf16 v[200:203], a[212:215], a[132:135], v[200:203]
 v_add_f32 v113, v113, v9
 v_mfma_f32_16x16x32_bf16 v[200:203], a[208:211], a[128:131], v[200:203]
 v_add_f32 v114, v114, v10
 v_add_f32 v115, v115, v11
 s_waitcnt vmcnt(11)
 v_mfma_f32_16x16x32_bf16 v[232:235], a[216:219], a[128:131], v[232:235]
 ds_read_b128 a[128:131], v1
 ds_read_b128 v[12:15], v3 offset:22528
 v_mfma_f32_16x16x32_bf16 v[232:235], a[220:223], a[132:135], v[232:235]
 global_load_dwordx4 a[212:215], v0, s[70:71] offset:-3072 sc1
 ds_read_b128 a[132:135], v1 offset:1024
 v_mfma_f32_16x16x32_bf16 v[236:239], a[220:223], a[140:143], v[236:239]
 ds_read_b128 a[140:143], v1 offset:5120
 v_add_f32 v116, v116, v8
 v_mfma_f32_16x16x32_bf16 v[236:239], a[216:219], a[136:139], v[236:239]
 global_load_dwordx4 a[208:211], v0, s[70:71] offset:-4096 sc1
 ds_read_b128 a[136:139], v1 offset:4096
 v_mfma_f32_16x16x32_bf16 v[240:243], a[216:219], a[144:147], v[240:243]
 ds_read_b128 a[144:147], v1 offset:8192
 v_add_f32 v117, v117, v9
 v_mfma_f32_16x16x32_bf16 v[240:243], a[220:223], a[148:151], v[240:243]
 ds_read_b128 a[148:151], v1 offset:9216
 v_add_f32 v118, v118, v10
 v_mfma_f32_16x16x32_bf16 v[244:247], a[220:223], a[156:159], v[244:247]
 ds_read_b128 a[156:159], v1 offset:13312
 v_add_f32 v119, v119, v11
 v_mfma_f32_16x16x32_bf16 v[244:247], a[216:219], a[152:155], v[244:247]
 ds_read_b128 a[152:155], v1 offset:12288
 v_add_f32 v120, v120, v8
 v_mfma_f32_16x16x32_bf16 v[248:251], a[216:219], a[160:163], v[248:251]
 ds_read_b128 a[160:163], v1 offset:16384
 v_add_f32 v121, v121, v9
 v_mfma_f32_16x16x32_bf16 v[248:251], a[220:223], a[164:167], v[248:251]
 ds_read_b128 a[164:167], v1 offset:17408
 v_add_f32 v122, v122, v10
 v_mfma_f32_16x16x32_bf16 v[252:255], a[220:223], a[172:175], v[252:255]
 ds_read_b128 a[172:175], v1 offset:21504
 v_mfma_f32_16x16x32_bf16 v[252:255], a[216:219], a[168:171], v[252:255]
 ds_read_b128 a[168:171], v1 offset:20480
 v_add_f32 v123, v123, v11
 v_mfma_f32_16x16x32_bf16 a[248:251], a[216:219], a[176:179], a[248:251]
 ds_read_b128 a[176:179], v1 offset:24576
 v_add_f32 v124, v124, v8
 v_mfma_f32_16x16x32_bf16 a[248:251], a[220:223], a[180:183], a[248:251]
 ds_read_b128 a[180:183], v1 offset:25600
 v_add_f32 v125, v125, v9
 v_mfma_f32_16x16x32_bf16 a[252:255], a[220:223], a[188:191], a[252:255]
 ds_read_b128 a[188:191], v1 offset:29696
 v_add_f32 v126, v126, v10
 v_mfma_f32_16x16x32_bf16 a[252:255], a[216:219], a[184:187], a[252:255]
 ds_read_b128 a[184:187], v1 offset:28672
 s_waitcnt vmcnt(10) lgkmcnt(8)
 v_mfma_f32_16x16x32_bf16 v[136:139], a[224:227], a[128:131], v[136:139]
 v_add_f32 v127, v127, v11
 v_mfma_f32_16x16x32_bf16 v[136:139], a[228:231], a[132:135], v[136:139]
 global_load_dwordx4 a[220:223], v0, s[70:71] offset:-1024 sc1
 v_add_f32 v128, v128, v8
 v_mfma_f32_16x16x32_bf16 v[140:143], a[228:231], a[140:143], v[140:143]
 v_add_f32 v129, v129, v9
 v_mfma_f32_16x16x32_bf16 v[140:143], a[224:227], a[136:139], v[140:143]
 global_load_dwordx4 a[216:219], v0, s[70:71] offset:-2048 sc1
 v_add_f32 v130, v130, v10
 v_mfma_f32_16x16x32_bf16 v[144:147], a[224:227], a[144:147], v[144:147]
 v_add_f32 v131, v131, v11
 v_mfma_f32_16x16x32_bf16 v[144:147], a[228:231], a[148:151], v[144:147]
 buffer_store_dwordx4 v[12:15], v3, s[32:35], s69 offen offset:2048 sc1
 v_mfma_f32_16x16x32_bf16 v[148:151], a[228:231], a[156:159], v[148:151]
 buffer_load_dword v4, off, s[64:67], 0 sc1
 v_mfma_f32_16x16x32_bf16 v[148:151], a[224:227], a[152:155], v[148:151]
 v_add_f32 v132, v132, v8
 s_waitcnt lgkmcnt(0)
 v_mfma_f32_16x16x32_bf16 v[152:155], a[224:227], a[160:163], v[152:155]
 v_add_f32 v133, v133, v9
 v_mfma_f32_16x16x32_bf16 v[152:155], a[228:231], a[164:167], v[152:155]
 v_mfma_f32_16x16x32_bf16 v[156:159], a[228:231], a[172:175], v[156:159]
 v_add_f32 v134, v134, v10
 v_mfma_f32_16x16x32_bf16 v[156:159], a[224:227], a[168:171], v[156:159]
 v_add_f32 v135, v135, v11
 v_mfma_f32_16x16x32_bf16 v[160:163], a[224:227], a[176:179], v[160:163]
 ds_read_b128 v[12:15], v3 offset:23552
 v_mfma_f32_16x16x32_bf16 v[160:163], a[228:231], a[180:183], v[160:163]
 v_accvgpr_read_b32 v5, a240
 v_mfma_f32_16x16x32_bf16 v[164:167], a[228:231], a[188:191], v[164:167]
 v_add_f32 v5, v5, v8
 v_mfma_f32_16x16x32_bf16 v[164:167], a[224:227], a[184:187], v[164:167]
 v_accvgpr_write_b32 a240, v5
 s_waitcnt vmcnt(12)
 v_mfma_f32_16x16x32_bf16 v[196:199], a[232:235], a[184:187], v[196:199]
 v_accvgpr_read_b32 v6, a241
 v_mfma_f32_16x16x32_bf16 v[196:199], a[236:239], a[188:191], v[196:199]
 global_load_dwordx4 a[228:231], v0, s[70:71] offset:1024 sc1
 v_add_f32 v6, v6, v9
 v_mfma_f32_16x16x32_bf16 v[192:195], a[236:239], a[180:183], v[192:195]
 v_accvgpr_write_b32 a241, v6
 v_mfma_f32_16x16x32_bf16 v[192:195], a[232:235], a[176:179], v[192:195]
 global_load_dwordx4 a[224:227], v0, s[70:71] offset:0 sc1
 v_mfma_f32_16x16x32_bf16 v[188:191], a[232:235], a[168:171], v[188:191]
 v_accvgpr_read_b32 v5, a242
 v_mfma_f32_16x16x32_bf16 v[188:191], a[236:239], a[172:175], v[188:191]
 v_add_f32 v5, v5, v10
 v_mfma_f32_16x16x32_bf16 v[184:187], a[236:239], a[164:167], v[184:187]
 v_accvgpr_write_b32 a242, v5
 v_mfma_f32_16x16x32_bf16 v[184:187], a[232:235], a[160:163], v[184:187]
 v_accvgpr_read_b32 v6, a243
 v_mfma_f32_16x16x32_bf16 v[180:183], a[232:235], a[152:155], v[180:183]
 v_mfma_f32_16x16x32_bf16 v[180:183], a[236:239], a[156:159], v[180:183]
 v_add_f32 v6, v6, v11
 v_mfma_f32_16x16x32_bf16 v[176:179], a[236:239], a[148:151], v[176:179]
 v_accvgpr_write_b32 a243, v6
 v_mfma_f32_16x16x32_bf16 v[176:179], a[232:235], a[144:147], v[176:179]
 v_accvgpr_read_b32 v5, a244
 v_mfma_f32_16x16x32_bf16 v[172:175], a[232:235], a[136:139], v[172:175]
 v_add_f32 v5, v5, v8
 v_mfma_f32_16x16x32_bf16 v[172:175], a[236:239], a[140:143], v[172:175]
 v_mfma_f32_16x16x32_bf16 v[168:171], a[236:239], a[132:135], v[168:171]
 v_accvgpr_write_b32 a244, v5
 v_mfma_f32_16x16x32_bf16 v[168:171], a[232:235], a[128:131], v[168:171]
 v_accvgpr_read_b32 v6, a245
 s_waitcnt lgkmcnt(0)
 s_waitcnt vmcnt(11)
 v_mfma_f32_16x16x32_bf16 v[200:203], a[192:195], a[128:131], v[200:203]
 v_add_f32 v6, v6, v9
 v_mfma_f32_16x16x32_bf16 v[200:203], a[196:199], a[132:135], v[200:203]
 global_load_dwordx4 a[236:239], v0, s[70:71] offset:3072 sc1
 v_accvgpr_write_b32 a245, v6
 v_mfma_f32_16x16x32_bf16 v[204:207], a[196:199], a[140:143], v[204:207]
 v_accvgpr_read_b32 v5, a246
 v_mfma_f32_16x16x32_bf16 v[204:207], a[192:195], a[136:139], v[204:207]
 global_load_dwordx4 a[232:235], v0, s[70:71] offset:2048 sc1
 v_add_f32 v5, v5, v10
 v_mfma_f32_16x16x32_bf16 v[208:211], a[192:195], a[144:147], v[208:211]
 buffer_store_dwordx4 v[12:15], v3, s[32:35], s69 offen offset:3072 sc1
 s_add_u32 s70, s70, 8192
 s_addc_u32 s71, s71, 0
 v_mfma_f32_16x16x32_bf16 v[208:211], a[196:199], a[148:151], v[208:211]
 v_accvgpr_write_b32 a246, v5
 v_mfma_f32_16x16x32_bf16 v[212:215], a[196:199], a[156:159], v[212:215]
 v_accvgpr_read_b32 v6, a247
 v_mfma_f32_16x16x32_bf16 v[212:215], a[192:195], a[152:155], v[212:215]
 v_mfma_f32_16x16x32_bf16 v[216:219], a[192:195], a[160:163], v[216:219]
 v_add_f32 v6, v6, v11
 v_mfma_f32_16x16x32_bf16 v[216:219], a[196:199], a[164:167], v[216:219]
 v_accvgpr_write_b32 a247, v6
 v_mfma_f32_16x16x32_bf16 v[220:223], a[196:199], a[172:175], v[220:223]
 s_waitcnt vmcnt(5)
 v_cmp_gt_i32 vcc, s55, v4
 s_and_b64 vcc, exec, vcc
 s_cbranch_vccnz Lspin_pa
Lok_pa:
 s_add_u32 s55, s55, 1
 s_waitcnt lgkmcnt(0)
 s_barrier
 v_mfma_f32_16x16x32_bf16 v[220:223], a[192:195], a[168:171], v[220:223]
 v_mfma_f32_16x16x32_bf16 v[224:227], a[192:195], a[176:179], v[224:227]
 v_mfma_f32_16x16x32_bf16 v[224:227], a[196:199], a[180:183], v[224:227]
 v_mfma_f32_16x16x32_bf16 v[228:231], a[196:199], a[188:191], v[228:231]
 v_mfma_f32_16x16x32_bf16 v[228:231], a[192:195], a[184:187], v[228:231]
 v_mfma_f32_16x16x32_bf16 a[252:255], a[200:203], a[184:187], a[252:255]
 ds_read_b128 a[184:187], v1 offset:30720
 v_mfma_f32_16x16x32_bf16 a[252:255], a[204:207], a[188:191], a[252:255]
 global_load_dwordx4 a[196:199], v0, s[70:71] offset:-3072 sc1
 ds_read_b128 a[188:191], v1 offset:31744
 v_mfma_f32_16x16x32_bf16 a[248:251], a[204:207], a[180:183], a[248:251]
 ds_read_b128 a[180:183], v1 offset:27648
 v_mfma_f32_16x16x32_bf16 a[248:251], a[200:203], a[176:179], a[248:251]
 global_load_dwordx4 a[192:195], v0, s[70:71] offset:-4096 sc1
 ds_read_b128 a[176:179], v1 offset:26624
 v_mfma_f32_16x16x32_bf16 v[252:255], a[200:203], a[168:171], v[252:255]
 ds_read_b128 a[168:171], v1 offset:22528
 v_mfma_f32_16x16x32_bf16 v[252:255], a[204:207], a[172:175], v[252:255]
 ds_read_b128 a[172:175], v1 offset:23552
 v_mfma_f32_16x16x32_bf16 v[248:251], a[204:207], a[164:167], v[248:251]
 ds_read_b128 a[164:167], v1 offset:19456
 v_mfma_f32_16x16x32_bf16 v[248:251], a[200:203], a[160:163], v[248:251]
 ds_read_b128 a[160:163], v1 offset:18432
 v_mfma_f32_16x16x32_bf16 v[244:247], a[200:203], a[152:155], v[244:247]
 ds_read_b128 a[152:155], v1 offset:14336
 v_mfma_f32_16x16x32_bf16 v[244:247], a[204:207], a[156:159], v[244:247]
 ds_read_b128 a[156:159], v1 offset:15360
 v_mfma_f32_16x16x32_bf16 v[240:243], a[204:207], a[148:151], v[240:243]
 ds_read_b128 a[148:151], v1 offset:11264
 v_mfma_f32_16x16x32_bf16 v[240:243], a[200:203], a[144:147], v[240:243]
 ds_read_b128 a[144:147], v1 offset:10240
 v_mfma_f32_16x16x32_bf16 v[236:239], a[200:203], a[136:139], v[236:239]
 ds_read_b128 a[136:139], v1 offset:6144
 v_mfma_f32_16x16x32_bf16 v[236:239], a[204:207], a[140:143], v[236:239]
 ds_read_b128 a[140:143], v1 offset:7168
 v_mfma_f32_16x16x32_bf16 v[232:235], a[204:207], a[132:135], v[232:235]
 global_load_dwordx4 a[204:207], v0, s[70:71] offset:-1024 sc1
 ds_read_b128 a[132:135], v1 offset:3072
 v_mfma_f32_16x16x32_bf16 v[232:235], a[200:203], a[128:131], v[232:235]
 global_load_dwordx4 a[200:203], v0, s[70:71] offset:-2048 sc1
 ds_read_b128 a[128:131], v1 offset:2048
 s_waitcnt lgkmcnt(8)
 s_branch Lloop
Llast:
 v_mfma_f32_16x16x32_bf16 v[136:139], a[208:211], a[128:131], v[136:139]
 v_accvgpr_read_b32 v5, a0
 v_lshlrev_b32 v6, 16, v5
 v_mfma_f32_16x16x32_bf16 v[136:139], a[212:215], a[132:135], v[136:139]
 v_and_b32 v5, s26, v5
 v_mul_f32 v6, v6, v16
 v_mfma_f32_16x16x32_bf16 v[140:143], a[212:215], a[140:143], v[140:143]
 v_mul_f32 v5, v5, v17
 v_cvt_pk_bf16_f32 v8, v6, v5
 v_mfma_f32_16x16x32_bf16 v[140:143], a[208:211], a[136:139], v[140:143]
 v_accvgpr_read_b32 v5, a1
 v_lshlrev_b32 v6, 16, v5
 v_mfma_f32_16x16x32_bf16 v[144:147], a[208:211], a[144:147], v[144:147]
 v_and_b32 v5, s26, v5
 v_mul_f32 v6, v6, v18
 v_mfma_f32_16x16x32_bf16 v[144:147], a[212:215], a[148:151], v[144:147]
 v_mul_f32 v5, v5, v19
 v_cvt_pk_bf16_f32 v9, v6, v5
 v_mfma_f32_16x16x32_bf16 v[148:151], a[212:215], a[156:159], v[148:151]
 v_accvgpr_read_b32 v5, a2
 v_lshlrev_b32 v6, 16, v5
 v_mfma_f32_16x16x32_bf16 v[148:151], a[208:211], a[152:155], v[148:151]
 v_and_b32 v5, s26, v5
 v_mul_f32 v6, v6, v48
 v_mfma_f32_16x16x32_bf16 v[152:155], a[208:211], a[160:163], v[152:155]
 v_mul_f32 v5, v5, v49
 v_cvt_pk_bf16_f32 v10, v6, v5
 v_mfma_f32_16x16x32_bf16 v[152:155], a[212:215], a[164:167], v[152:155]
 v_accvgpr_read_b32 v5, a3
 v_lshlrev_b32 v6, 16, v5
 v_mfma_f32_16x16x32_bf16 v[156:159], a[212:215], a[172:175], v[156:159]
 v_and_b32 v5, s26, v5
 v_mul_f32 v6, v6, v50
 v_mfma_f32_16x16x32_bf16 v[156:159], a[208:211], a[168:171], v[156:159]
 v_mul_f32 v5, v5, v51
 v_cvt_pk_bf16_f32 v11, v6, v5
 v_mfma_f32_16x16x32_bf16 v[160:163], a[208:211], a[176:179], v[160:163]
 v_lshrrev_b32 v5, 7, v1
 v_lshlrev_b32 v6, 4, v5
 v_mfma_f32_16x16x32_bf16 v[160:163], a[212:215], a[180:183], v[160:163]
 v_xor_b32 v6, v6, v1
 v_and_b32 v6, 112, v6
 v_mfma_f32_16x16x32_bf16 v[164:167], a[212:215], a[188:191], v[164:167]
 v_lshl_add_u32 v16, v5, 11, v6
 v_lshrrev_b32 v5, 4, v1
 v_mfma_f32_16x16x32_bf16 v[164:167], a[208:211], a[184:187], v[164:167]
 v_and_b32 v5, 48, v5
 v_xor_b32 v5, v5, v1
 s_waitcnt vmcnt(8)
 v_mfma_f32_16x16x32_bf16 v[196:199], a[216:219], a[184:187], v[196:199]
 v_and_b32 v5, 112, v5
 v_and_b32 v6, 240, v1
 v_mfma_f32_16x16x32_bf16 v[196:199], a[220:223], a[188:191], v[196:199]
 global_load_dwordx4 a[212:215], v0, s[70:71] offset:1024 sc1
 v_lshl_add_u32 v5, v6, 3, v5
 v_mfma_f32_16x16x32_bf16 v[192:195], a[220:223], a[180:183], v[192:195]
 v_add_u32 v17, s50, v5
 v_xor_b32 v18, 64, v17
 v_mfma_f32_16x16x32_bf16 v[192:195], a[216:219], a[176:179], v[192:195]
 global_load_dwordx4 a[208:211], v0, s[70:71] offset:0 sc1
 ds_write_b128 v17, v[8:11]
 v_mfma_f32_16x16x32_bf16 v[188:191], a[216:219], a[168:171], v[188:191]
 v_accvgpr_read_b32 v5, a32
 v_lshlrev_b32 v6, 16, v5
 v_mfma_f32_16x16x32_bf16 v[188:191], a[220:223], a[172:175], v[188:191]
 v_and_b32 v5, s26, v5
 v_mul_f32 v6, v6, v80
 v_mfma_f32_16x16x32_bf16 v[184:187], a[220:223], a[164:167], v[184:187]
 v_mul_f32 v5, v5, v81
 v_cvt_pk_bf16_f32 v12, v6, v5
 v_mfma_f32_16x16x32_bf16 v[184:187], a[216:219], a[160:163], v[184:187]
 v_accvgpr_read_b32 v5, a33
 v_lshlrev_b32 v6, 16, v5
 v_mfma_f32_16x16x32_bf16 v[180:183], a[216:219], a[152:155], v[180:183]
 v_and_b32 v5, s26, v5
 v_mul_f32 v6, v6, v82
 v_mfma_f32_16x16x32_bf16 v[180:183], a[220:223], a[156:159], v[180:183]
 v_mul_f32 v5, v5, v83
 v_cvt_pk_bf16_f32 v13, v6, v5
 v_mfma_f32_16x16x32_bf16 v[176:179], a[220:223], a[148:151], v[176:179]
 v_accvgpr_read_b32 v5, a34
 v_lshlrev_b32 v6, 16, v5
 v_mfma_f32_16x16x32_bf16 v[176:179], a[216:219], a[144:147], v[176:179]
 v_and_b32 v5, s26, v5
 v_mul_f32 v6, v6, v112
 v_mfma_f32_16x16x32_bf16 v[172:175], a[216:219], a[136:139], v[172:175]
 v_mul_f32 v5, v5, v113
 v_cvt_pk_bf16_f32 v14, v6, v5
 v_mfma_f32_16x16x32_bf16 v[172:175], a[220:223], a[140:143], v[172:175]
 v_accvgpr_read_b32 v5, a35
 v_lshlrev_b32 v6, 16, v5
 v_mfma_f32_16x16x32_bf16 v[168:171], a[220:223], a[132:135], v[168:171]
 v_and_b32 v5, s26, v5
 v_mul_f32 v6, v6, v114
 v_mfma_f32_16x16x32_bf16 v[168:171], a[216:219], a[128:131], v[168:171]
 v_mul_f32 v5, v5, v115
 v_cvt_pk_bf16_f32 v15, v6, v5
 s_waitcnt vmcnt(8)
 v_mfma_f32_16x16x32_bf16 v[200:203], a[224:227], a[128:131], v[200:203]
 ds_write_b128 v18, v[12:15]
 v_mfma_f32_16x16x32_bf16 v[200:203], a[228:231], a[132:135], v[200:203]
 global_load_dwordx4 a[220:223], v0, s[70:71] offset:3072 sc1
 ds_read_b128 v[48:51], v3
 v_mfma_f32_16x16x32_bf16 v[204:207], a[228:231], a[140:143], v[204:207]
 ds_read_b128 v[80:83], v3 offset:1024
 v_accvgpr_read_b32 v5, a4
 v_mfma_f32_16x16x32_bf16 v[204:207], a[224:227], a[136:139], v[204:207]
 global_load_dwordx4 a[216:219], v0, s[70:71] offset:2048 sc1
 v_lshlrev_b32 v6, 16, v5
 v_mfma_f32_16x16x32_bf16 v[208:211], a[224:227], a[144:147], v[208:211]
 v_and_b32 v5, s26, v5
 v_mul_f32 v6, v6, v20
 s_add_u32 s70, s70, 8192
 s_addc_u32 s71, s71, 0
 v_mfma_f32_16x16x32_bf16 v[208:211], a[228:231], a[148:151], v[208:211]
 v_mul_f32 v5, v5, v21
 v_cvt_pk_bf16_f32 v8, v6, v5
 v_mfma_f32_16x16x32_bf16 v[212:215], a[228:231], a[156:159], v[212:215]
 v_accvgpr_read_b32 v5, a5
 v_lshlrev_b32 v6, 16, v5
 v_mfma_f32_16x16x32_bf16 v[212:215], a[224:227], a[152:155], v[212:215]
 v_and_b32 v5, s26, v5
 v_mul_f32 v6, v6, v22
 v_mfma_f32_16x16x32_bf16 v[216:219], a[224:227], a[160:163], v[216:219]
 v_mul_f32 v5, v5, v23
 v_cvt_pk_bf16_f32 v9, v6, v5
 s_waitcnt lgkmcnt(1)
 s_add_u32 s3, s28, 0
 v_mfma_f32_16x16x32_bf16 v[216:219], a[228:231], a[164:167], v[216:219]
 buffer_store_dwordx4 v[48:51], v16, s[16:19], s3 offen nt
 s_waitcnt lgkmcnt(0)
 s_add_u32 s3, s28, 16384
 buffer_store_dwordx4 v[80:83], v16, s[16:19], s3 offen nt
 v_accvgpr_read_b32 v5, a6
 v_lshlrev_b32 v6, 16, v5
 v_and_b32 v5, s26, v5
 v_mfma_f32_16x16x32_bf16 v[220:223], a[228:231], a[172:175], v[220:223]
 v_mul_f32 v6, v6, v52
 v_mul_f32 v5, v5, v53
 v_mfma_f32_16x16x32_bf16 v[220:223], a[224:227], a[168:171], v[220:223]
 v_cvt_pk_bf16_f32 v10, v6, v5
 v_accvgpr_read_b32 v5, a7
 v_mfma_f32_16x16x32_bf16 v[224:227], a[224:227], a[176:179], v[224:227]
 v_lshlrev_b32 v6, 16, v5
 v_and_b32 v5, s26, v5
 v_mul_f32 v6, v6, v54
 v_mul_f32 v5, v5, v55
 v_cvt_pk_bf16_f32 v11, v6, v5
 v_mfma_f32_16x16x32_bf16 v[224:227], a[228:231], a[180:183], v[224:227]
 ds_write_b128 v17, v[8:11] offset:4096
 v_mfma_f32_16x16x32_bf16 v[228:231], a[228:231], a[188:191], v[228:231]
 v_accvgpr_read_b32 v5, a36
 v_lshlrev_b32 v6, 16, v5
 v_mfma_f32_16x16x32_bf16 v[228:231], a[224:227], a[184:187], v[228:231]
 v_and_b32 v5, s26, v5
 v_mul_f32 v6, v6, v84
 s_waitcnt vmcnt(10)
 v_mfma_f32_16x16x32_bf16 a[252:255], a[232:235], a[184:187], a[252:255]
 ds_read_b128 a[184:187], v2 offset:30720
 v_mul_f32 v5, v5, v85
 v_mfma_f32_16x16x32_bf16 a[252:255], a[236:239], a[188:191], a[252:255]
 global_load_dwordx4 a[228:231], v0, s[70:71] offset:-3072 sc1
 ds_read_b128 a[188:191], v2 offset:31744
 v_mfma_f32_16x16x32_bf16 a[248:251], a[236:239], a[180:183], a[248:251]
 ds_read_b128 a[180:183], v2 offset:27648
 v_cvt_pk_bf16_f32 v12, v6, v5
 v_mfma_f32_16x16x32_bf16 a[248:251], a[232:235], a[176:179], a[248:251]
 global_load_dwordx4 a[224:227], v0, s[70:71] offset:-4096 sc1
 ds_read_b128 a[176:179], v2 offset:26624
 v_mfma_f32_16x16x32_bf16 v[252:255], a[232:235], a[168:171], v[252:255]
 ds_read_b128 a[168:171], v2 offset:22528
 v_accvgpr_read_b32 v5, a37
 v_mfma_f32_16x16x32_bf16 v[252:255], a[236:239], a[172:175], v[252:255]
 ds_read_b128 a[172:175], v2 offset:23552
 v_lshlrev_b32 v6, 16, v5
 v_mfma_f32_16x16x32_bf16 v[248:251], a[236:239], a[164:167], v[248:251]
 ds_read_b128 a[164:167], v2 offset:19456
 v_and_b32 v5, s26, v5
 v_mfma_f32_16x16x32_bf16 v[248:251], a[232:235], a[160:163], v[248:251]
 ds_read_b128 a[160:163], v2 offset:18432
 v_mul_f32 v6, v6, v86
 v_mul_f32 v5, v5, v87
 v_mfma_f32_16x16x32_bf16 v[244:247], a[232:235], a[152:155], v[244:247]
 ds_read_b128 a[152:155], v2 offset:14336
 v_cvt_pk_bf16_f32 v13, v6, v5
 v_mfma_f32_16x16x32_bf16 v[244:247], a[236:239], a[156:159], v[244:247]
 ds_read_b128 a[156:159], v2 offset:15360
 v_accvgpr_read_b32 v5, a38
 v_lshlrev_b32 v6, 16, v5
 v_mfma_f32_16x16x32_bf16 v[240:243], a[236:239], a[148:151], v[240:243]
 ds_read_b128 a[148:151], v2 offset:11264
 v_and_b32 v5, s26, v5
 v_mul_f32 v6, v6, v116
 v_mfma_f32_16x16x32_bf16 v[240:243], a[232:235], a[144:147], v[240:243]
 ds_read_b128 a[144:147], v2 offset:10240
 v_mul_f32 v5, v5, v117
 v_cvt_pk_bf16_f32 v14, v6, v5
 v_mfma_f32_16x16x32_bf16 v[236:239], a[232:235], a[136:139], v[236:239]
 ds_read_b128 a[136:139], v2 offset:6144
 v_accvgpr_read_b32 v5, a39
 v_lshlrev_b32 v6, 16, v5
 v_mfma_f32_16x16x32_bf16 v[236:239], a[236:239], a[140:143], v[236:239]
 ds_read_b128 a[140:143], v2 offset:7168
 v_and_b32 v5, s26, v5
 v_mul_f32 v6, v6, v118
 v_mfma_f32_16x16x32_bf16 v[232:235], a[236:239], a[132:135], v[232:235]
 ds_read_b128 a[132:135], v2 offset:3072
 v_mul_f32 v5, v5, v119
 v_mfma_f32_16x16x32_bf16 v[232:235], a[232:235], a[128:131], v[232:235]
 ds_read_b128 a[128:131], v2 offset:2048
 v_cvt_pk_bf16_f32 v15, v6, v5
 s_waitcnt vmcnt(10) lgkmcnt(8)
 v_mfma_f32_16x16x32_bf16 v[164:167], a[192:195], a[184:187], v[164:167]
 ds_write_b128 v18, v[12:15] offset:4096
 v_mfma_f32_16x16x32_bf16 v[164:167], a[196:199], a[188:191], v[164:167]
 global_load_dwordx4 a[236:239], v0, s[70:71] offset:-1024 sc1
 ds_read_b128 v[48:51], v3 offset:4096
 v_mfma_f32_16x16x32_bf16 v[160:163], a[196:199], a[180:183], v[160:163]
 ds_read_b128 v[80:83], v3 offset:5120
 v_accvgpr_read_b32 v5, a8
 v_mfma_f32_16x16x32_bf16 v[160:163], a[192:195], a[176:179], v[160:163]
 global_load_dwordx4 a[232:235], v0, s[70:71] offset:-2048 sc1
 v_lshlrev_b32 v6, 16, v5
 v_mfma_f32_16x16x32_bf16 v[156:159], a[192:195], a[168:171], v[156:159]
 v_and_b32 v5, s26, v5
 v_mul_f32 v6, v6, v24
 v_mfma_f32_16x16x32_bf16 v[156:159], a[196:199], a[172:175], v[156:159]
 v_mul_f32 v5, v5, v25
 v_cvt_pk_bf16_f32 v8, v6, v5
 v_mfma_f32_16x16x32_bf16 v[152:155], a[196:199], a[164:167], v[152:155]
 v_accvgpr_read_b32 v5, a9
 v_lshlrev_b32 v6, 16, v5
 v_mfma_f32_16x16x32_bf16 v[152:155], a[192:195], a[160:163], v[152:155]
 v_and_b32 v5, s26, v5
 v_mul_f32 v6, v6, v26
 s_waitcnt lgkmcnt(3)
 v_mfma_f32_16x16x32_bf16 v[148:151], a[192:195], a[152:155], v[148:151]
 v_mul_f32 v5, v5, v27
 v_cvt_pk_bf16_f32 v9, v6, v5
 s_waitcnt lgkmcnt(1)
 s_add_u32 s3, s28, 32768
 v_mfma_f32_16x16x32_bf16 v[148:151], a[196:199], a[156:159], v[148:151]
 buffer_store_dwordx4 v[48:51], v16, s[16:19], s3 offen nt
 s_waitcnt lgkmcnt(0)
 s_add_u32 s3, s28, 49152
 buffer_store_dwordx4 v[80:83], v16, s[16:19], s3 offen nt
 v_accvgpr_read_b32 v5, a10
 v_lshlrev_b32 v6, 16, v5
 v_mfma_f32_16x16x32_bf16 v[144:147], a[196:199], a[148:151], v[144:147]
 v_and_b32 v5, s26, v5
 v_mul_f32 v6, v6, v56
 v_mfma_f32_16x16x32_bf16 v[144:147], a[192:195], a[144:147], v[144:147]
 v_mul_f32 v5, v5, v57
 v_cvt_pk_bf16_f32 v10, v6, v5
 v_mfma_f32_16x16x32_bf16 v[140:143], a[192:195], a[136:139], v[140:143]
 v_accvgpr_read_b32 v5, a11
 v_lshlrev_b32 v6, 16, v5
 v_mfma_f32_16x16x32_bf16 v[140:143], a[196:199], a[140:143], v[140:143]
 v_and_b32 v5, s26, v5
 v_mul_f32 v6, v6, v58
 v_mfma_f32_16x16x32_bf16 v[136:139], a[196:199], a[132:135], v[136:139]
 v_mul_f32 v5, v5, v59
 v_cvt_pk_bf16_f32 v11, v6, v5
 v_mfma_f32_16x16x32_bf16 v[136:139], a[192:195], a[128:131], v[136:139]
 ds_write_b128 v17, v[8:11] offset:8192
 s_waitcnt vmcnt(12)
 v_mfma_f32_16x16x32_bf16 v[168:171], a[200:203], a[128:131], v[168:171]
 v_accvgpr_read_b32 v5, a40
 v_lshlrev_b32 v6, 16, v5
 v_mfma_f32_16x16x32_bf16 v[168:171], a[204:207], a[132:135], v[168:171]
 global_load_dwordx4 a[196:199], v0, s[70:71] offset:1024 sc1
 v_and_b32 v5, s26, v5
 v_mfma_f32_16x16x32_bf16 v[172:175], a[204:207], a[140:143], v[172:175]
 v_mul_f32 v6, v6, v88
 v_mul_f32 v5, v5, v89
 v_mfma_f32_16x16x32_bf16 v[172:175], a[200:203], a[136:139], v[172:175]
 global_load_dwordx4 a[192:195], v0, s[70:71] offset:0 sc1
 v_cvt_pk_bf16_f32 v12, v6, v5
 v_mfma_f32_16x16x32_bf16 v[176:179], a[200:203], a[144:147], v[176:179]
 v_accvgpr_read_b32 v5, a41
 v_lshlrev_b32 v6, 16, v5
 v_mfma_f32_16x16x32_bf16 v[176:179], a[204:207], a[148:151], v[176:179]
 v_and_b32 v5, s26, v5
 v_mul_f32 v6, v6, v90
 v_mfma_f32_16x16x32_bf16 v[180:183], a[204:207], a[156:159], v[180:183]
 v_mul_f32 v5, v5, v91
 v_cvt_pk_bf16_f32 v13, v6, v5
 v_mfma_f32_16x16x32_bf16 v[180:183], a[200:203], a[152:155], v[180:183]
 v_accvgpr_read_b32 v5, a42
 v_lshlrev_b32 v6, 16, v5
 v_mfma_f32_16x16x32_bf16 v[184:187], a[200:203], a[160:163], v[184:187]
 v_and_b32 v5, s26, v5
 v_mul_f32 v6, v6, v120
 v_mfma_f32_16x16x32_bf16 v[184:187], a[204:207], a[164:167], v[184:187]
 v_mul_f32 v5, v5, v121
 v_cvt_pk_bf16_f32 v14, v6, v5
 v_mfma_f32_16x16x32_bf16 v[188:191], a[204:207], a[172:175], v[188:191]
 v_accvgpr_read_b32 v5, a43
 v_lshlrev_b32 v6, 16, v5
 v_mfma_f32_16x16x32_bf16 v[188:191], a[200:203], a[168:171], v[188:191]
 v_and_b32 v5, s26, v5
 v_mul_f32 v6, v6, v122
 v_mfma_f32_16x16x32_bf16 v[192:195], a[200:203], a[176:179], v[192:195]
 v_mul_f32 v5, v5, v123
 v_cvt_pk_bf16_f32 v15, v6, v5
 v_mfma_f32_16x16x32_bf16 v[192:195], a[204:207], a[180:183], v[192:195]
 ds_write_b128 v18, v[12:15] offset:8192
 v_mfma_f32_16x16x32_bf16 v[196:199], a[204:207], a[188:191], v[196:199]
 ds_read_b128 v[48:51], v3 offset:8192
 ds_read_b128 v[80:83], v3 offset:9216
 v_mfma_f32_16x16x32_bf16 v[196:199], a[200:203], a[184:187], v[196:199]
 v_accvgpr_read_b32 v5, a12
 v_lshlrev_b32 v6, 16, v5
 s_waitcnt vmcnt(12)
 v_mfma_f32_16x16x32_bf16 v[228:231], a[208:211], a[184:187], v[228:231]
 v_and_b32 v5, s26, v5
 v_mul_f32 v6, v6, v28
 v_mfma_f32_16x16x32_bf16 v[228:231], a[212:215], a[188:191], v[228:231]
 global_load_dwordx4 a[204:207], v0, s[70:71] offset:3072 sc1
 v_mul_f32 v5, v5, v29
 v_mfma_f32_16x16x32_bf16 v[224:227], a[212:215], a[180:183], v[224:227]
 v_cvt_pk_bf16_f32 v8, v6, v5
 v_accvgpr_read_b32 v5, a13
 v_mfma_f32_16x16x32_bf16 v[224:227], a[208:211], a[176:179], v[224:227]
 global_load_dwordx4 a[200:203], v0, s[70:71] offset:2048 sc1
 v_lshlrev_b32 v6, 16, v5
 v_mfma_f32_16x16x32_bf16 v[220:223], a[208:211], a[168:171], v[220:223]
 v_and_b32 v5, s26, v5
 v_mul_f32 v6, v6, v30
 s_add_u32 s70, s70, 8192
 s_addc_u32 s71, s71, 0
 v_mfma_f32_16x16x32_bf16 v[220:223], a[212:215], a[172:175], v[220:223]
 v_mul_f32 v5, v5, v31
 v_cvt_pk_bf16_f32 v9, v6, v5
 s_waitcnt lgkmcnt(1)
 s_add_u32 s3, s28, 65536
 v_mfma_f32_16x16x32_bf16 v[216:219], a[212:215], a[164:167], v[216:219]
 buffer_store_dwordx4 v[48:51], v16, s[16:19], s3 offen nt
 s_waitcnt lgkmcnt(0)
 s_add_u32 s3, s28, 81920
 buffer_store_dwordx4 v[80:83], v16, s[16:19], s3 offen nt
 v_accvgpr_read_b32 v5, a14
 v_lshlrev_b32 v6, 16, v5
 v_mfma_f32_16x16x32_bf16 v[216:219], a[208:211], a[160:163], v[216:219]
 v_and_b32 v5, s26, v5
 v_mul_f32 v6, v6, v60
 v_mfma_f32_16x16x32_bf16 v[212:215], a[208:211], a[152:155], v[212:215]
 v_mul_f32 v5, v5, v61
 v_cvt_pk_bf16_f32 v10, v6, v5
 v_mfma_f32_16x16x32_bf16 v[212:215], a[212:215], a[156:159], v[212:215]
 v_accvgpr_read_b32 v5, a15
 v_lshlrev_b32 v6, 16, v5
 v_mfma_f32_16x16x32_bf16 v[208:211], a[212:215], a[148:151], v[208:211]
 v_and_b32 v5, s26, v5
 v_mul_f32 v6, v6, v62
 v_mfma_f32_16x16x32_bf16 v[208:211], a[208:211], a[144:147], v[208:211]
 v_mul_f32 v5, v5, v63
 v_cvt_pk_bf16_f32 v11, v6, v5
 v_mfma_f32_16x16x32_bf16 v[204:207], a[208:211], a[136:139], v[204:207]
 ds_write_b128 v17, v[8:11] offset:12288
 v_mfma_f32_16x16x32_bf16 v[204:207], a[212:215], a[140:143], v[204:207]
 v_accvgpr_read_b32 v5, a44
 v_lshlrev_b32 v6, 16, v5
 v_mfma_f32_16x16x32_bf16 v[200:203], a[212:215], a[132:135], v[200:203]
 v_and_b32 v5, s26, v5
 v_mul_f32 v6, v6, v92
 v_mfma_f32_16x16x32_bf16 v[200:203], a[208:211], a[128:131], v[200:203]
 v_mul_f32 v5, v5, v93
 v_cvt_pk_bf16_f32 v12, v6, v5
 s_waitcnt vmcnt(14)
 v_mfma_f32_16x16x32_bf16 v[232:235], a[216:219], a[128:131], v[232:235]
 ds_read_b128 a[128:131], v1 offset:34816
 v_accvgpr_read_b32 v5, a45
 v_mfma_f32_16x16x32_bf16 v[232:235], a[220:223], a[132:135], v[232:235]
 global_load_dwordx4 a[212:215], v0, s[70:71] offset:-3072 sc1
 ds_read_b128 a[132:135], v1 offset:35840
 v_mfma_f32_16x16x32_bf16 v[236:239], a[220:223], a[140:143], v[236:239]
 ds_read_b128 a[140:143], v1 offset:39936
 v_lshlrev_b32 v6, 16, v5
 v_mfma_f32_16x16x32_bf16 v[236:239], a[216:219], a[136:139], v[236:239]
 global_load_dwordx4 a[208:211], v0, s[70:71] offset:-4096 sc1
 ds_read_b128 a[136:139], v1 offset:38912
 v_and_b32 v5, s26, v5
 v_mfma_f32_16x16x32_bf16 v[240:243], a[216:219], a[144:147], v[240:243]
 ds_read_b128 a[144:147], v1 offset:43008
 v_mul_f32 v6, v6, v94
 v_mul_f32 v5, v5, v95
 v_mfma_f32_16x16x32_bf16 v[240:243], a[220:223], a[148:151], v[240:243]
 ds_read_b128 a[148:151], v1 offset:44032
 v_cvt_pk_bf16_f32 v13, v6, v5
 v_mfma_f32_16x16x32_bf16 v[244:247], a[220:223], a[156:159], v[244:247]
 ds_read_b128 a[156:159], v1 offset:48128
 v_accvgpr_read_b32 v5, a46
 v_lshlrev_b32 v6, 16, v5
 v_mfma_f32_16x16x32_bf16 v[244:247], a[216:219], a[152:155], v[244:247]
 ds_read_b128 a[152:155], v1 offset:47104
 v_and_b32 v5, s26, v5
 v_mul_f32 v6, v6, v124
 v_mfma_f32_16x16x32_bf16 v[248:251], a[216:219], a[160:163], v[248:251]
 ds_read_b128 a[160:163], v1 offset:51200
 v_mul_f32 v5, v5, v125
 v_mfma_f32_16x16x32_bf16 v[248:251], a[220:223], a[164:167], v[248:251]
 ds_read_b128 a[164:167], v1 offset:52224
 v_cvt_pk_bf16_f32 v14, v6, v5
 v_mfma_f32_16x16x32_bf16 v[252:255], a[220:223], a[172:175], v[252:255]
 ds_read_b128 a[172:175], v1 offset:56320
 v_accvgpr_read_b32 v5, a47
 v_mfma_f32_16x16x32_bf16 v[252:255], a[216:219], a[168:171], v[252:255]
 ds_read_b128 a[168:171], v1 offset:55296
 v_lshlrev_b32 v6, 16, v5
 v_mfma_f32_16x16x32_bf16 a[248:251], a[216:219], a[176:179], a[248:251]
 ds_read_b128 a[176:179], v1 offset:59392
 v_and_b32 v5, s26, v5
 v_mfma_f32_16x16x32_bf16 a[248:251], a[220:223], a[180:183], a[248:251]
 ds_read_b128 a[180:183], v1 offset:60416
 v_mul_f32 v6, v6, v126
 v_mfma_f32_16x16x32_bf16 a[252:255], a[220:223], a[188:191], a[252:255]
 ds_read_b128 a[188:191], v1 offset:64512
 v_mul_f32 v5, v5, v127
 v_mfma_f32_16x16x32_bf16 a[252:255], a[216:219], a[184:187], a[252:255]
 ds_read_b128 a[184:187], v1 offset:63488
 v_cvt_pk_bf16_f32 v15, v6, v5
 s_waitcnt vmcnt(12) lgkmcnt(8)
 v_mfma_f32_16x16x32_bf16 v[136:139], a[224:227], a[128:131], v[136:139]
 ds_write_b128 v18, v[12:15] offset:12288
 ds_read_b128 v[48:51], v3 offset:12288
 ds_read_b128 v[80:83], v3 offset:13312
 v_accvgpr_read_b32 v5, a16
 v_lshlrev_b32 v6, 16, v5
 v_mfma_f32_16x16x32_bf16 v[136:139], a[228:231], a[132:135], v[136:139]
 global_load_dwordx4 a[220:223], v0, s[70:71] offset:-1024 sc1
 v_and_b32 v5, s26, v5
 v_mfma_f32_16x16x32_bf16 v[140:143], a[228:231], a[140:143], v[140:143]
 v_mul_f32 v6, v6, v32
 v_mul_f32 v5, v5, v33
 v_mfma_f32_16x16x32_bf16 v[140:143], a[224:227], a[136:139], v[140:143]
 global_load_dwordx4 a[216:219], v0, s[70:71] offset:-2048 sc1
 v_cvt_pk_bf16_f32 v8, v6, v5
 v_mfma_f32_16x16x32_bf16 v[144:147], a[224:227], a[144:147], v[144:147]
 v_accvgpr_read_b32 v5, a17
 v_lshlrev_b32 v6, 16, v5
 v_mfma_f32_16x16x32_bf16 v[144:147], a[228:231], a[148:151], v[144:147]
 v_and_b32 v5, s26, v5
 v_mul_f32 v6, v6, v34
 v_mfma_f32_16x16x32_bf16 v[148:151], a[228:231], a[156:159], v[148:151]
 v_mul_f32 v5, v5, v35
 v_cvt_pk_bf16_f32 v9, v6, v5
 s_waitcnt lgkmcnt(1)
 s_add_u32 s3, s28, 98304
 v_mfma_f32_16x16x32_bf16 v[148:151], a[224:227], a[152:155], v[148:151]
 buffer_store_dwordx4 v[48:51], v16, s[16:19], s3 offen nt
 s_waitcnt lgkmcnt(0)
 s_add_u32 s3, s28, 114688
 buffer_store_dwordx4 v[80:83], v16, s[16:19], s3 offen nt
 v_accvgpr_read_b32 v5, a18
 v_lshlrev_b32 v6, 16, v5
 v_mfma_f32_16x16x32_bf16 v[152:155], a[224:227], a[160:163], v[152:155]
 v_and_b32 v5, s26, v5
 v_mul_f32 v6, v6, v64
 v_mfma_f32_16x16x32_bf16 v[152:155], a[228:231], a[164:167], v[152:155]
 v_mul_f32 v5, v5, v65
 v_cvt_pk_bf16_f32 v10, v6, v5
 v_mfma_f32_16x16x32_bf16 v[156:159], a[228:231], a[172:175], v[156:159]
 v_accvgpr_read_b32 v5, a19
 v_lshlrev_b32 v6, 16, v5
 v_mfma_f32_16x16x32_bf16 v[156:159], a[224:227], a[168:171], v[156:159]
 v_and_b32 v5, s26, v5
 v_mul_f32 v6, v6, v66
 v_mfma_f32_16x16x32_bf16 v[160:163], a[224:227], a[176:179], v[160:163]
 v_mul_f32 v5, v5, v67
 v_cvt_pk_bf16_f32 v11, v6, v5
 v_mfma_f32_16x16x32_bf16 v[160:163], a[228:231], a[180:183], v[160:163]
 ds_write_b128 v17, v[8:11] offset:16384
 v_mfma_f32_16x16x32_bf16 v[164:167], a[228:231], a[188:191], v[164:167]
 v_accvgpr_read_b32 v5, a48
 v_lshlrev_b32 v6, 16, v5
 v_mfma_f32_16x16x32_bf16 v[164:167], a[224:227], a[184:187], v[164:167]
 v_and_b32 v5, s26, v5
 v_mul_f32 v6, v6, v96
 s_waitcnt vmcnt(14)
 v_mfma_f32_16x16x32_bf16 v[196:199], a[232:235], a[184:187], v[196:199]
 v_mul_f32 v5, v5, v97
 v_cvt_pk_bf16_f32 v12, v6, v5
 v_mfma_f32_16x16x32_bf16 v[196:199], a[236:239], a[188:191], v[196:199]
 global_load_dwordx4 a[228:231], v0, s[70:71] offset:1024 sc1
 v_accvgpr_read_b32 v5, a49
 v_mfma_f32_16x16x32_bf16 v[192:195], a[236:239], a[180:183], v[192:195]
 v_lshlrev_b32 v6, 16, v5
 v_and_b32 v5, s26, v5
 v_mfma_f32_16x16x32_bf16 v[192:195], a[232:235], a[176:179], v[192:195]
 global_load_dwordx4 a[224:227], v0, s[70:71] offset:0 sc1
 v_mul_f32 v6, v6, v98
 v_mfma_f32_16x16x32_bf16 v[188:191], a[232:235], a[168:171], v[188:191]
 v_mul_f32 v5, v5, v99
 v_cvt_pk_bf16_f32 v13, v6, v5
 v_mfma_f32_16x16x32_bf16 v[188:191], a[236:239], a[172:175], v[188:191]
 v_accvgpr_read_b32 v5, a50
 v_lshlrev_b32 v6, 16, v5
 v_mfma_f32_16x16x32_bf16 v[184:187], a[236:239], a[164:167], v[184:187]
 v_and_b32 v5, s26, v5
 v_mul_f32 v6, v6, v128
 v_mfma_f32_16x16x32_bf16 v[184:187], a[232:235], a[160:163], v[184:187]
 v_mul_f32 v5, v5, v129
 v_cvt_pk_bf16_f32 v14, v6, v5
 v_mfma_f32_16x16x32_bf16 v[180:183], a[232:235], a[152:155], v[180:183]
 v_accvgpr_read_b32 v5, a51
 v_lshlrev_b32 v6, 16, v5
 v_mfma_f32_16x16x32_bf16 v[180:183], a[236:239], a[156:159], v[180:183]
 v_and_b32 v5, s26, v5
 v_mul_f32 v6, v6, v130
 v_mfma_f32_16x16x32_bf16 v[176:179], a[236:239], a[148:151], v[176:179]
 v_mul_f32 v5, v5, v131
 v_cvt_pk_bf16_f32 v15, v6, v5
 v_mfma_f32_16x16x32_bf16 v[176:179], a[232:235], a[144:147], v[176:179]
 ds_write_b128 v18, v[12:15] offset:16384
 v_mfma_f32_16x16x32_bf16 v[172:175], a[232:235], a[136:139], v[172:175]
 ds_read_b128 v[48:51], v3 offset:16384
 ds_read_b128 v[80:83], v3 offset:17408
 v_mfma_f32_16x16x32_bf16 v[172:175], a[236:239], a[140:143], v[172:175]
 v_accvgpr_read_b32 v5, a20
 v_lshlrev_b32 v6, 16, v5
 v_mfma_f32_16x16x32_bf16 v[168:171], a[236:239], a[132:135], v[168:171]
 v_and_b32 v5, s26, v5
 v_mul_f32 v6, v6, v36
 v_mfma_f32_16x16x32_bf16 v[168:171], a[232:235], a[128:131], v[168:171]
 v_mul_f32 v5, v5, v37
 v_cvt_pk_bf16_f32 v8, v6, v5
 s_waitcnt vmcnt(12)
 v_mfma_f32_16x16x32_bf16 v[200:203], a[192:195], a[128:131], v[200:203]
 v_accvgpr_read_b32 v5, a21
 v_lshlrev_b32 v6, 16, v5
 v_mfma_f32_16x16x32_bf16 v[200:203], a[196:199], a[132:135], v[200:203]
 global_load_dwordx4 a[236:239], v0, s[70:71] offset:3072 sc1
 v_and_b32 v5, s26, v5
 v_mfma_f32_16x16x32_bf16 v[204:207], a[196:199], a[140:143], v[204:207]
 v_mul_f32 v6, v6, v38
 v_mul_f32 v5, v5, v39
 v_mfma_f32_16x16x32_bf16 v[204:207], a[192:195], a[136:139], v[204:207]
 global_load_dwordx4 a[232:235], v0, s[70:71] offset:2048 sc1
 v_cvt_pk_bf16_f32 v9, v6, v5
 s_waitcnt lgkmcnt(1)
 s_add_u32 s3, s28, 131072
 v_mfma_f32_16x16x32_bf16 v[208:211], a[192:195], a[144:147], v[208:211]
 buffer_store_dwordx4 v[48:51], v16, s[16:19], s3 offen nt
 s_waitcnt lgkmcnt(0)
 s_add_u32 s3, s28, 147456
 buffer_store_dwordx4 v[80:83], v16, s[16:19], s3 offen nt
 v_accvgpr_read_b32 v5, a22
 v_lshlrev_b32 v6, 16, v5
 s_add_u32 s70, s70, 1843200
 s_addc_u32 s71, s71, 0
 v_mfma_f32_16x16x32_bf16 v[208:211], a[196:199], a[148:151], v[208:211]
 v_and_b32 v5, s26, v5
 v_mul_f32 v6, v6, v68
 v_mfma_f32_16x16x32_bf16 v[212:215], a[196:199], a[156:159], v[212:215]
 v_mul_f32 v5, v5, v69
 v_cvt_pk_bf16_f32 v10, v6, v5
 v_mfma_f32_16x16x32_bf16 v[212:215], a[192:195], a[152:155], v[212:215]
 v_accvgpr_read_b32 v5, a23
 v_lshlrev_b32 v6, 16, v5
 v_mfma_f32_16x16x32_bf16 v[216:219], a[192:195], a[160:163], v[216:219]
 v_and_b32 v5, s26, v5
 v_mul_f32 v6, v6, v70
 v_mfma_f32_16x16x32_bf16 v[216:219], a[196:199], a[164:167], v[216:219]
 v_mul_f32 v5, v5, v71
 v_cvt_pk_bf16_f32 v11, v6, v5
 v_mfma_f32_16x16x32_bf16 v[220:223], a[196:199], a[172:175], v[220:223]
 ds_write_b128 v17, v[8:11] offset:20480
 v_mfma_f32_16x16x32_bf16 v[220:223], a[192:195], a[168:171], v[220:223]
 v_accvgpr_read_b32 v5, a52
 v_lshlrev_b32 v6, 16, v5
 v_mfma_f32_16x16x32_bf16 v[224:227], a[192:195], a[176:179], v[224:227]
 v_and_b32 v5, s26, v5
 v_mul_f32 v6, v6, v100
 v_mfma_f32_16x16x32_bf16 v[224:227], a[196:199], a[180:183], v[224:227]
 v_mul_f32 v5, v5, v101
 v_cvt_pk_bf16_f32 v12, v6, v5
 v_mfma_f32_16x16x32_bf16 v[228:231], a[196:199], a[188:191], v[228:231]
 v_accvgpr_read_b32 v5, a53
 v_lshlrev_b32 v6, 16, v5
 v_mfma_f32_16x16x32_bf16 v[228:231], a[192:195], a[184:187], v[228:231]
 v_and_b32 v5, s26, v5
 v_mul_f32 v6, v6, v102
 s_waitcnt vmcnt(14)
 v_mfma_f32_16x16x32_bf16 a[252:255], a[200:203], a[184:187], a[252:255]
 ds_read_b128 a[184:187], v1 offset:30720
 v_mul_f32 v5, v5, v103
 v_mfma_f32_16x16x32_bf16 a[252:255], a[204:207], a[188:191], a[252:255]
 ds_read_b128 a[188:191], v1 offset:31744
 v_cvt_pk_bf16_f32 v13, v6, v5
 v_mfma_f32_16x16x32_bf16 a[248:251], a[204:207], a[180:183], a[248:251]
 ds_read_b128 a[180:183], v1 offset:27648
 v_accvgpr_read_b32 v5, a54
 v_mfma_f32_16x16x32_bf16 a[248:251], a[200:203], a[176:179], a[248:251]
 ds_read_b128 a[176:179], v1 offset:26624
 v_lshlrev_b32 v6, 16, v5
 v_mfma_f32_16x16x32_bf16 v[252:255], a[200:203], a[168:171], v[252:255]
 ds_read_b128 a[168:171], v1 offset:22528
 v_and_b32 v5, s26, v5
 v_mfma_f32_16x16x32_bf16 v[252:255], a[204:207], a[172:175], v[252:255]
 ds_read_b128 a[172:175], v1 offset:23552
 v_mul_f32 v6, v6, v132
 v_mfma_f32_16x16x32_bf16 v[248:251], a[204:207], a[164:167], v[248:251]
 ds_read_b128 a[164:167], v1 offset:19456
 v_mul_f32 v5, v5, v133
 v_mfma_f32_16x16x32_bf16 v[248:251], a[200:203], a[160:163], v[248:251]
 ds_read_b128 a[160:163], v1 offset:18432
 v_cvt_pk_bf16_f32 v14, v6, v5
 v_mfma_f32_16x16x32_bf16 v[244:247], a[200:203], a[152:155], v[244:247]
 ds_read_b128 a[152:155], v1 offset:14336
 v_accvgpr_read_b32 v5, a55
 v_mfma_f32_16x16x32_bf16 v[244:247], a[204:207], a[156:159], v[244:247]
 ds_read_b128 a[156:159], v1 offset:15360
 v_lshlrev_b32 v6, 16, v5
 v_mfma_f32_16x16x32_bf16 v[240:243], a[204:207], a[148:151], v[240:243]
 ds_read_b128 a[148:151], v1 offset:11264
 v_and_b32 v5, s26, v5
 v_mfma_f32_16x16x32_bf16 v[240:243], a[200:203], a[144:147], v[240:243]
 ds_read_b128 a[144:147], v1 offset:10240
 v_mul_f32 v6, v6, v134
 v_mfma_f32_16x16x32_bf16 v[236:239], a[200:203], a[136:139], v[236:239]
 ds_read_b128 a[136:139], v1 offset:6144
 v_mul_f32 v5, v5, v135
 v_mfma_f32_16x16x32_bf16 v[236:239], a[204:207], a[140:143], v[236:239]
 ds_read_b128 a[140:143], v1 offset:7168
 v_cvt_pk_bf16_f32 v15, v6, v5
 v_mfma_f32_16x16x32_bf16 v[232:235], a[204:207], a[132:135], v[232:235]
 ds_read_b128 a[132:135], v1 offset:3072
 v_mfma_f32_16x16x32_bf16 v[232:235], a[200:203], a[128:131], v[232:235]
 ds_read_b128 a[128:131], v1 offset:2048
 ds_write_b128 v18, v[12:15] offset:20480
 ds_read_b128 v[48:51], v3 offset:20480
 ds_read_b128 v[80:83], v3 offset:21504
 v_accvgpr_read_b32 v5, a24
 v_lshlrev_b32 v6, 16, v5
 s_waitcnt vmcnt(10) lgkmcnt(11)
 v_mfma_f32_16x16x32_bf16 v[164:167], a[208:211], a[184:187], v[164:167]
 v_and_b32 v5, s26, v5
 v_mul_f32 v6, v6, v40
 v_mfma_f32_16x16x32_bf16 v[164:167], a[212:215], a[188:191], v[164:167]
 v_mul_f32 v5, v5, v41
 v_cvt_pk_bf16_f32 v8, v6, v5
 v_mfma_f32_16x16x32_bf16 v[160:163], a[212:215], a[180:183], v[160:163]
 v_accvgpr_read_b32 v5, a25
 v_lshlrev_b32 v6, 16, v5
 v_mfma_f32_16x16x32_bf16 v[160:163], a[208:211], a[176:179], v[160:163]
 v_and_b32 v5, s26, v5
 v_mul_f32 v6, v6, v42
 v_mfma_f32_16x16x32_bf16 v[156:159], a[208:211], a[168:171], v[156:159]
 v_mul_f32 v5, v5, v43
 v_cvt_pk_bf16_f32 v9, v6, v5
 s_waitcnt lgkmcnt(1)
 s_add_u32 s3, s28, 163840
 v_mfma_f32_16x16x32_bf16 v[156:159], a[212:215], a[172:175], v[156:159]
 buffer_store_dwordx4 v[48:51], v16, s[16:19], s3 offen nt
 s_waitcnt lgkmcnt(0)
 s_add_u32 s3, s28, 180224
 buffer_store_dwordx4 v[80:83], v16, s[16:19], s3 offen nt
 v_accvgpr_read_b32 v5, a26
 v_lshlrev_b32 v6, 16, v5
 v_and_b32 v5, s26, v5
 v_mfma_f32_16x16x32_bf16 v[152:155], a[212:215], a[164:167], v[152:155]
 v_mul_f32 v6, v6, v72
 v_mul_f32 v5, v5, v73
 v_mfma_f32_16x16x32_bf16 v[152:155], a[208:211], a[160:163], v[152:155]
 v_cvt_pk_bf16_f32 v10, v6, v5
 v_accvgpr_read_b32 v5, a27
 v_mfma_f32_16x16x32_bf16 v[148:151], a[208:211], a[152:155], v[148:151]
 v_lshlrev_b32 v6, 16, v5
 v_and_b32 v5, s26, v5
 v_mfma_f32_16x16x32_bf16 v[148:151], a[212:215], a[156:159], v[148:151]
 v_mul_f32 v6, v6, v74
 v_mul_f32 v5, v5, v75
 v_mfma_f32_16x16x32_bf16 v[144:147], a[212:215], a[148:151], v[144:147]
 v_cvt_pk_bf16_f32 v11, v6, v5
 v_mfma_f32_16x16x32_bf16 v[144:147], a[208:211], a[144:147], v[144:147]
 ds_write_b128 v17, v[8:11] offset:24576
 v_mfma_f32_16x16x32_bf16 v[140:143], a[208:211], a[136:139], v[140:143]
 v_accvgpr_read_b32 v5, a56
 v_lshlrev_b32 v6, 16, v5
 v_mfma_f32_16x16x32_bf16 v[140:143], a[212:215], a[140:143], v[140:143]
 v_and_b32 v5, s26, v5
 v_mul_f32 v6, v6, v104
 v_mfma_f32_16x16x32_bf16 v[136:139], a[212:215], a[132:135], v[136:139]
 v_mul_f32 v5, v5, v105
 v_cvt_pk_bf16_f32 v12, v6, v5
 v_mfma_f32_16x16x32_bf16 v[136:139], a[208:211], a[128:131], v[136:139]
 v_accvgpr_read_b32 v5, a57
 v_lshlrev_b32 v6, 16, v5
 s_waitcnt vmcnt(10)
 v_mfma_f32_16x16x32_bf16 v[168:171], a[216:219], a[128:131], v[168:171]
 v_and_b32 v5, s26, v5
 v_mul_f32 v6, v6, v106
 v_mfma_f32_16x16x32_bf16 v[168:171], a[220:223], a[132:135], v[168:171]
 v_mul_f32 v5, v5, v107
 v_cvt_pk_bf16_f32 v13, v6, v5
 v_mfma_f32_16x16x32_bf16 v[172:175], a[220:223], a[140:143], v[172:175]
 v_accvgpr_read_b32 v5, a58
 v_accvgpr_read_b32 v7, a240
 v_mfma_f32_16x16x32_bf16 v[172:175], a[216:219], a[136:139], v[172:175]
 v_lshlrev_b32 v6, 16, v5
 v_and_b32 v5, s26, v5
 v_mfma_f32_16x16x32_bf16 v[176:179], a[216:219], a[144:147], v[176:179]
 v_mul_f32 v6, v6, v7
 v_accvgpr_read_b32 v7, a241
 v_mfma_f32_16x16x32_bf16 v[176:179], a[220:223], a[148:151], v[176:179]
 v_mul_f32 v5, v5, v7
 v_cvt_pk_bf16_f32 v14, v6, v5
 v_mfma_f32_16x16x32_bf16 v[180:183], a[220:223], a[156:159], v[180:183]
 v_accvgpr_read_b32 v5, a59
 v_accvgpr_read_b32 v7, a242
 v_mfma_f32_16x16x32_bf16 v[180:183], a[216:219], a[152:155], v[180:183]
 v_lshlrev_b32 v6, 16, v5
 v_and_b32 v5, s26, v5
 v_mfma_f32_16x16x32_bf16 v[184:187], a[216:219], a[160:163], v[184:187]
 v_mul_f32 v6, v6, v7
 v_accvgpr_read_b32 v7, a243
 v_mfma_f32_16x16x32_bf16 v[184:187], a[220:223], a[164:167], v[184:187]
 v_mul_f32 v5, v5, v7
 v_cvt_pk_bf16_f32 v15, v6, v5
 v_mfma_f32_16x16x32_bf16 v[188:191], a[220:223], a[172:175], v[188:191]
 ds_write_b128 v18, v[12:15] offset:24576
 v_mfma_f32_16x16x32_bf16 v[188:191], a[216:219], a[168:171], v[188:191]
 ds_read_b128 v[48:51], v3 offset:24576
 ds_read_b128 v[80:83], v3 offset:25600
 v_mfma_f32_16x16x32_bf16 v[192:195], a[216:219], a[176:179], v[192:195]
 v_accvgpr_read_b32 v5, a28
 v_lshlrev_b32 v6, 16, v5
 v_mfma_f32_16x16x32_bf16 v[192:195], a[220:223], a[180:183], v[192:195]
 v_and_b32 v5, s26, v5
 v_mul_f32 v6, v6, v44
 v_mfma_f32_16x16x32_bf16 v[196:199], a[220:223], a[188:191], v[196:199]
 v_mul_f32 v5, v5, v45
 v_cvt_pk_bf16_f32 v8, v6, v5
 v_mfma_f32_16x16x32_bf16 v[196:199], a[216:219], a[184:187], v[196:199]
 v_accvgpr_read_b32 v5, a29
 v_lshlrev_b32 v6, 16, v5
 s_waitcnt vmcnt(6)
 v_mfma_f32_16x16x32_bf16 v[228:231], a[224:227], a[184:187], v[228:231]
 v_and_b32 v5, s26, v5
 v_mul_f32 v6, v6, v46
 v_mfma_f32_16x16x32_bf16 v[228:231], a[228:231], a[188:191], v[228:231]
 v_mul_f32 v5, v5, v47
 v_cvt_pk_bf16_f32 v9, v6, v5
 s_waitcnt lgkmcnt(1)
 v_mfma_f32_16x16x32_bf16 v[224:227], a[228:231], a[180:183], v[224:227]
 s_add_u32 s3, s28, 196608
 buffer_store_dwordx4 v[48:51], v16, s[16:19], s3 offen nt
 v_mfma_f32_16x16x32_bf16 v[224:227], a[224:227], a[176:179], v[224:227]
 s_waitcnt lgkmcnt(0)
 s_add_u32 s3, s28, 212992
 v_mfma_f32_16x16x32_bf16 v[220:223], a[224:227], a[168:171], v[220:223]
 buffer_store_dwordx4 v[80:83], v16, s[16:19], s3 offen nt
 v_accvgpr_read_b32 v5, a30
 v_mfma_f32_16x16x32_bf16 v[220:223], a[228:231], a[172:175], v[220:223]
 v_lshlrev_b32 v6, 16, v5
 v_mfma_f32_16x16x32_bf16 v[216:219], a[228:231], a[164:167], v[216:219]
 v_and_b32 v5, s26, v5
 v_mul_f32 v6, v6, v76
 v_mfma_f32_16x16x32_bf16 v[216:219], a[224:227], a[160:163], v[216:219]
 v_mul_f32 v5, v5, v77
 v_cvt_pk_bf16_f32 v10, v6, v5
 v_mfma_f32_16x16x32_bf16 v[212:215], a[224:227], a[152:155], v[212:215]
 v_accvgpr_read_b32 v5, a31
 v_lshlrev_b32 v6, 16, v5
 v_mfma_f32_16x16x32_bf16 v[212:215], a[228:231], a[156:159], v[212:215]
 v_and_b32 v5, s26, v5
 v_mul_f32 v6, v6, v78
 v_mfma_f32_16x16x32_bf16 v[208:211], a[228:231], a[148:151], v[208:211]
 v_mul_f32 v5, v5, v79
 v_cvt_pk_bf16_f32 v11, v6, v5
 v_mfma_f32_16x16x32_bf16 v[208:211], a[224:227], a[144:147], v[208:211]
 ds_write_b128 v17, v[8:11] offset:28672
 v_mfma_f32_16x16x32_bf16 v[204:207], a[224:227], a[136:139], v[204:207]
 v_accvgpr_read_b32 v5, a60
 v_lshlrev_b32 v6, 16, v5
 v_mfma_f32_16x16x32_bf16 v[204:207], a[228:231], a[140:143], v[204:207]
 v_and_b32 v5, s26, v5
 v_mul_f32 v6, v6, v108
 v_mfma_f32_16x16x32_bf16 v[200:203], a[228:231], a[132:135], v[200:203]
 v_mul_f32 v5, v5, v109
 v_cvt_pk_bf16_f32 v12, v6, v5
 v_mfma_f32_16x16x32_bf16 v[200:203], a[224:227], a[128:131], v[200:203]
 v_accvgpr_read_b32 v5, a61
 v_lshlrev_b32 v6, 16, v5
 s_waitcnt vmcnt(6)
 v_mfma_f32_16x16x32_bf16 v[232:235], a[232:235], a[128:131], v[232:235]
 v_and_b32 v5, s26, v5
 v_mul_f32 v6, v6, v110
 v_mfma_f32_16x16x32_bf16 v[232:235], a[236:239], a[132:135], v[232:235]
 v_mul_f32 v5, v5, v111
 v_cvt_pk_bf16_f32 v13, v6, v5
 v_mfma_f32_16x16x32_bf16 v[236:239], a[236:239], a[140:143], v[236:239]
 v_accvgpr_read_b32 v5, a62
 v_accvgpr_read_b32 v7, a244
 v_mfma_f32_16x16x32_bf16 v[236:239], a[232:235], a[136:139], v[236:239]
 v_lshlrev_b32 v6, 16, v5
 v_and_b32 v5, s26, v5
 v_mfma_f32_16x16x32_bf16 v[240:243], a[232:235], a[144:147], v[240:243]
 v_mul_f32 v6, v6, v7
 v_accvgpr_read_b32 v7, a245
 v_mfma_f32_16x16x32_bf16 v[240:243], a[236:239], a[148:151], v[240:243]
 v_mul_f32 v5, v5, v7
 v_cvt_pk_bf16_f32 v14, v6, v5
 v_mfma_f32_16x16x32_bf16 v[244:247], a[236:239], a[156:159], v[244:247]
 v_accvgpr_read_b32 v5, a63
 v_accvgpr_read_b32 v7, a246
 v_mfma_f32_16x16x32_bf16 v[244:247], a[232:235], a[152:155], v[244:247]
 v_lshlrev_b32 v6, 16, v5
 v_and_b32 v5, s26, v5
 v_mfma_f32_16x16x32_bf16 v[248:251], a[232:235], a[160:163], v[248:251]
 v_mul_f32 v6, v6, v7
 v_accvgpr_read_b32 v7, a247
 v_mfma_f32_16x16x32_bf16 v[248:251], a[236:239], a[164:167], v[248:251]
 v_mul_f32 v5, v5, v7
 v_cvt_pk_bf16_f32 v15, v6, v5
 v_mfma_f32_16x16x32_bf16 v[252:255], a[236:239], a[172:175], v[252:255]
 ds_write_b128 v18, v[12:15] offset:28672
 v_mfma_f32_16x16x32_bf16 v[252:255], a[232:235], a[168:171], v[252:255]
 ds_read_b128 v[48:51], v3 offset:28672
 ds_read_b128 v[80:83], v3 offset:29696
 v_mfma_f32_16x16x32_bf16 a[248:251], a[232:235], a[176:179], a[248:251]
 s_waitcnt lgkmcnt(1)
 s_add_u32 s3, s28, 229376
 v_mfma_f32_16x16x32_bf16 a[248:251], a[236:239], a[180:183], a[248:251]
 buffer_store_dwordx4 v[48:51], v16, s[16:19], s3 offen nt
 s_waitcnt lgkmcnt(0)
 v_mfma_f32_16x16x32_bf16 a[252:255], a[236:239], a[188:191], a[252:255]
 s_add_u32 s3, s28, 245760
 buffer_store_dwordx4 v[80:83], v16, s[16:19], s3 offen nt
 v_mfma_f32_16x16x32_bf16 a[252:255], a[232:235], a[184:187], a[252:255]
 s_nop 7
 v_accvgpr_read_b32 v7, a64
 v_lshlrev_b32 v6, 16, v7
 v_and_b32 v7, s26, v7
 v_pk_mul_f32 v[6:7], v[6:7], v[136:137]
 v_cvt_pk_bf16_f32 v8, v6, v7
 v_accvgpr_read_b32 v7, a65
 v_lshlrev_b32 v6, 16, v7
 v_and_b32 v7, s26, v7
 v_pk_mul_f32 v[6:7], v[6:7], v[138:139]
 v_cvt_pk_bf16_f32 v9, v6, v7
 v_accvgpr_read_b32 v7, a66
 v_lshlrev_b32 v6, 16, v7
 v_and_b32 v7, s26, v7
 v_pk_mul_f32 v[6:7], v[6:7], v[168:169]
 v_cvt_pk_bf16_f32 v10, v6, v7
 v_accvgpr_read_b32 v7, a67
 v_lshlrev_b32 v6, 16, v7
 v_and_b32 v7, s26, v7
 v_pk_mul_f32 v[6:7], v[6:7], v[170:171]
 v_cvt_pk_bf16_f32 v11, v6, v7
 ds_write_b128 v17, v[8:11]
 v_accvgpr_read_b32 v7, a96
 v_lshlrev_b32 v6, 16, v7
 v_and_b32 v7, s26, v7
 v_pk_mul_f32 v[6:7], v[6:7], v[200:201]
 v_cvt_pk_bf16_f32 v12, v6, v7
 v_accvgpr_read_b32 v7, a97
 v_lshlrev_b32 v6, 16, v7
 v_and_b32 v7, s26, v7
 v_pk_mul_f32 v[6:7], v[6:7], v[202:203]
 v_cvt_pk_bf16_f32 v13, v6, v7
 v_accvgpr_read_b32 v7, a98
 v_lshlrev_b32 v6, 16, v7
 v_and_b32 v7, s26, v7
 v_pk_mul_f32 v[6:7], v[6:7], v[232:233]
 v_cvt_pk_bf16_f32 v14, v6, v7
 v_accvgpr_read_b32 v7, a99
 v_lshlrev_b32 v6, 16, v7
 v_and_b32 v7, s26, v7
 v_pk_mul_f32 v[6:7], v[6:7], v[234:235]
 v_cvt_pk_bf16_f32 v15, v6, v7
 ds_write_b128 v18, v[12:15]
 ds_read_b128 v[48:51], v3
 ds_read_b128 v[80:83], v3 offset:1024
 v_accvgpr_read_b32 v7, a68
 v_lshlrev_b32 v6, 16, v7
 v_and_b32 v7, s26, v7
 v_pk_mul_f32 v[6:7], v[6:7], v[140:141]
 v_cvt_pk_bf16_f32 v8, v6, v7
 v_accvgpr_read_b32 v7, a69
 v_lshlrev_b32 v6, 16, v7
 v_and_b32 v7, s26, v7
 v_pk_mul_f32 v[6:7], v[6:7], v[142:143]
 v_cvt_pk_bf16_f32 v9, v6, v7
 v_accvgpr_read_b32 v7, a70
 v_lshlrev_b32 v6, 16, v7
 s_waitcnt lgkmcnt(1)
 s_add_u32 s3, s28, 0
 buffer_store_dwordx4 v[48:51], v16, s[16:19], s3 offen offset:128 nt
 s_waitcnt lgkmcnt(0)
 s_add_u32 s3, s28, 16384
 buffer_store_dwordx4 v[80:83], v16, s[16:19], s3 offen offset:128 nt
 v_and_b32 v7, s26, v7
 v_pk_mul_f32 v[6:7], v[6:7], v[172:173]
 v_cvt_pk_bf16_f32 v10, v6, v7
 v_accvgpr_read_b32 v7, a71
 v_lshlrev_b32 v6, 16, v7
 v_and_b32 v7, s26, v7
 v_pk_mul_f32 v[6:7], v[6:7], v[174:175]
 v_cvt_pk_bf16_f32 v11, v6, v7
 ds_write_b128 v17, v[8:11] offset:4096
 v_accvgpr_read_b32 v7, a100
 v_lshlrev_b32 v6, 16, v7
 v_and_b32 v7, s26, v7
 v_pk_mul_f32 v[6:7], v[6:7], v[204:205]
 v_cvt_pk_bf16_f32 v12, v6, v7
 v_accvgpr_read_b32 v7, a101
 v_lshlrev_b32 v6, 16, v7
 v_and_b32 v7, s26, v7
 v_pk_mul_f32 v[6:7], v[6:7], v[206:207]
 v_cvt_pk_bf16_f32 v13, v6, v7
 v_accvgpr_read_b32 v7, a102
 v_lshlrev_b32 v6, 16, v7
 v_and_b32 v7, s26, v7
 v_pk_mul_f32 v[6:7], v[6:7], v[236:237]
 v_cvt_pk_bf16_f32 v14, v6, v7
 v_accvgpr_read_b32 v7, a103
 v_lshlrev_b32 v6, 16, v7
 v_and_b32 v7, s26, v7
 v_pk_mul_f32 v[6:7], v[6:7], v[238:239]
 v_cvt_pk_bf16_f32 v15, v6, v7
 ds_write_b128 v18, v[12:15] offset:4096
 ds_read_b128 v[48:51], v3 offset:4096
 ds_read_b128 v[80:83], v3 offset:5120
 v_accvgpr_read_b32 v7, a72
 v_lshlrev_b32 v6, 16, v7
 v_and_b32 v7, s26, v7
 v_pk_mul_f32 v[6:7], v[6:7], v[144:145]
 v_cvt_pk_bf16_f32 v8, v6, v7
 v_accvgpr_read_b32 v7, a73
 v_lshlrev_b32 v6, 16, v7
 v_and_b32 v7, s26, v7
 v_pk_mul_f32 v[6:7], v[6:7], v[146:147]
 v_cvt_pk_bf16_f32 v9, v6, v7
 v_accvgpr_read_b32 v7, a74
 v_lshlrev_b32 v6, 16, v7
 s_waitcnt lgkmcnt(1)
 s_add_u32 s3, s28, 32768
 buffer_store_dwordx4 v[48:51], v16, s[16:19], s3 offen offset:128 nt
 s_waitcnt lgkmcnt(0)
 s_add_u32 s3, s28, 49152
 buffer_store_dwordx4 v[80:83], v16, s[16:19], s3 offen offset:128 nt
 v_and_b32 v7, s26, v7
 v_pk_mul_f32 v[6:7], v[6:7], v[176:177]
 v_cvt_pk_bf16_f32 v10, v6, v7
 v_accvgpr_read_b32 v7, a75
 v_lshlrev_b32 v6, 16, v7
 v_and_b32 v7, s26, v7
 v_pk_mul_f32 v[6:7], v[6:7], v[178:179]
 v_cvt_pk_bf16_f32 v11, v6, v7
 ds_write_b128 v17, v[8:11] offset:8192
 v_accvgpr_read_b32 v7, a104
 v_lshlrev_b32 v6, 16, v7
 v_and_b32 v7, s26, v7
 v_pk_mul_f32 v[6:7], v[6:7], v[208:209]
 v_cvt_pk_bf16_f32 v12, v6, v7
 v_accvgpr_read_b32 v7, a105
 v_lshlrev_b32 v6, 16, v7
 v_and_b32 v7, s26, v7
 v_pk_mul_f32 v[6:7], v[6:7], v[210:211]
 v_cvt_pk_bf16_f32 v13, v6, v7
 v_accvgpr_read_b32 v7, a106
 v_lshlrev_b32 v6, 16, v7
 v_and_b32 v7, s26, v7
 v_pk_mul_f32 v[6:7], v[6:7], v[240:241]
 v_cvt_pk_bf16_f32 v14, v6, v7
 v_accvgpr_read_b32 v7, a107
 v_lshlrev_b32 v6, 16, v7
 v_and_b32 v7, s26, v7
 v_pk_mul_f32 v[6:7], v[6:7], v[242:243]
 v_cvt_pk_bf16_f32 v15, v6, v7
 ds_write_b128 v18, v[12:15] offset:8192
 ds_read_b128 v[48:51], v3 offset:8192
 ds_read_b128 v[80:83], v3 offset:9216
 v_accvgpr_read_b32 v7, a76
 v_lshlrev_b32 v6, 16, v7
 v_and_b32 v7, s26, v7
 v_pk_mul_f32 v[6:7], v[6:7], v[148:149]
 v_cvt_pk_bf16_f32 v8, v6, v7
 v_accvgpr_read_b32 v7, a77
 v_lshlrev_b32 v6, 16, v7
 v_and_b32 v7, s26, v7
 v_pk_mul_f32 v[6:7], v[6:7], v[150:151]
 v_cvt_pk_bf16_f32 v9, v6, v7
 v_accvgpr_read_b32 v7, a78
 v_lshlrev_b32 v6, 16, v7
 s_waitcnt lgkmcnt(1)
 s_add_u32 s3, s28, 65536
 buffer_store_dwordx4 v[48:51], v16, s[16:19], s3 offen offset:128 nt
 s_waitcnt lgkmcnt(0)
 s_add_u32 s3, s28, 81920
 buffer_store_dwordx4 v[80:83], v16, s[16:19], s3 offen offset:128 nt
 v_and_b32 v7, s26, v7
 v_pk_mul_f32 v[6:7], v[6:7], v[180:181]
 v_cvt_pk_bf16_f32 v10, v6, v7
 v_accvgpr_read_b32 v7, a79
 v_lshlrev_b32 v6, 16, v7
 v_and_b32 v7, s26, v7
 v_pk_mul_f32 v[6:7], v[6:7], v[182:183]
 v_cvt_pk_bf16_f32 v11, v6, v7
 ds_write_b128 v17, v[8:11] offset:12288
 v_accvgpr_read_b32 v7, a108
 v_lshlrev_b32 v6, 16, v7
 v_and_b32 v7, s26, v7
 v_pk_mul_f32 v[6:7], v[6:7], v[212:213]
 v_cvt_pk_bf16_f32 v12, v6, v7
 v_accvgpr_read_b32 v7, a109
 v_lshlrev_b32 v6, 16, v7
 v_and_b32 v7, s26, v7
 v_pk_mul_f32 v[6:7], v[6:7], v[214:215]
 v_cvt_pk_bf16_f32 v13, v6, v7
 v_accvgpr_read_b32 v7, a110
 v_lshlrev_b32 v6, 16, v7
 v_and_b32 v7, s26, v7
 v_pk_mul_f32 v[6:7], v[6:7], v[244:245]
 v_cvt_pk_bf16_f32 v14, v6, v7
 v_accvgpr_read_b32 v7, a111
 v_lshlrev_b32 v6, 16, v7
 v_and_b32 v7, s26, v7
 v_pk_mul_f32 v[6:7], v[6:7], v[246:247]
 v_cvt_pk_bf16_f32 v15, v6, v7
 ds_write_b128 v18, v[12:15] offset:12288
 ds_read_b128 v[48:51], v3 offset:12288
 ds_read_b128 v[80:83], v3 offset:13312
 v_accvgpr_read_b32 v7, a80
 v_lshlrev_b32 v6, 16, v7
 v_and_b32 v7, s26, v7
 v_pk_mul_f32 v[6:7], v[6:7], v[152:153]
 v_cvt_pk_bf16_f32 v8, v6, v7
 v_accvgpr_read_b32 v7, a81
 v_lshlrev_b32 v6, 16, v7
 v_and_b32 v7, s26, v7
 v_pk_mul_f32 v[6:7], v[6:7], v[154:155]
 v_cvt_pk_bf16_f32 v9, v6, v7
 v_accvgpr_read_b32 v7, a82
 v_lshlrev_b32 v6, 16, v7
 s_waitcnt lgkmcnt(1)
 s_add_u32 s3, s28, 98304
 buffer_store_dwordx4 v[48:51], v16, s[16:19], s3 offen offset:128 nt
 s_waitcnt lgkmcnt(0)
 s_add_u32 s3, s28, 114688
 buffer_store_dwordx4 v[80:83], v16, s[16:19], s3 offen offset:128 nt
 v_and_b32 v7, s26, v7
 v_pk_mul_f32 v[6:7], v[6:7], v[184:185]
 v_cvt_pk_bf16_f32 v10, v6, v7
 v_accvgpr_read_b32 v7, a83
 v_lshlrev_b32 v6, 16, v7
 v_and_b32 v7, s26, v7
 v_pk_mul_f32 v[6:7], v[6:7], v[186:187]
 v_cvt_pk_bf16_f32 v11, v6, v7
 ds_write_b128 v17, v[8:11] offset:16384
 v_accvgpr_read_b32 v7, a112
 v_lshlrev_b32 v6, 16, v7
 v_and_b32 v7, s26, v7
 v_pk_mul_f32 v[6:7], v[6:7], v[216:217]
 v_cvt_pk_bf16_f32 v12, v6, v7
 v_accvgpr_read_b32 v7, a113
 v_lshlrev_b32 v6, 16, v7
 v_and_b32 v7, s26, v7
 v_pk_mul_f32 v[6:7], v[6:7], v[218:219]
 v_cvt_pk_bf16_f32 v13, v6, v7
 v_accvgpr_read_b32 v7, a114
 v_lshlrev_b32 v6, 16, v7
 v_and_b32 v7, s26, v7
 v_pk_mul_f32 v[6:7], v[6:7], v[248:249]
 v_cvt_pk_bf16_f32 v14, v6, v7
 v_accvgpr_read_b32 v7, a115
 v_lshlrev_b32 v6, 16, v7
 v_and_b32 v7, s26, v7
 v_pk_mul_f32 v[6:7], v[6:7], v[250:251]
 v_cvt_pk_bf16_f32 v15, v6, v7
 ds_write_b128 v18, v[12:15] offset:16384
 ds_read_b128 v[48:51], v3 offset:16384
 ds_read_b128 v[80:83], v3 offset:17408
 v_accvgpr_read_b32 v7, a84
 v_lshlrev_b32 v6, 16, v7
 v_and_b32 v7, s26, v7
 v_pk_mul_f32 v[6:7], v[6:7], v[156:157]
 v_cvt_pk_bf16_f32 v8, v6, v7
 v_accvgpr_read_b32 v7, a85
 v_lshlrev_b32 v6, 16, v7
 v_and_b32 v7, s26, v7
 v_pk_mul_f32 v[6:7], v[6:7], v[158:159]
 v_cvt_pk_bf16_f32 v9, v6, v7
 v_accvgpr_read_b32 v7, a86
 v_lshlrev_b32 v6, 16, v7
 s_waitcnt lgkmcnt(1)
 s_add_u32 s3, s28, 131072
 buffer_store_dwordx4 v[48:51], v16, s[16:19], s3 offen offset:128 nt
 s_waitcnt lgkmcnt(0)
 s_add_u32 s3, s28, 147456
 buffer_store_dwordx4 v[80:83], v16, s[16:19], s3 offen offset:128 nt
 v_and_b32 v7, s26, v7
 v_pk_mul_f32 v[6:7], v[6:7], v[188:189]
 v_cvt_pk_bf16_f32 v10, v6, v7
 v_accvgpr_read_b32 v7, a87
 v_lshlrev_b32 v6, 16, v7
 v_and_b32 v7, s26, v7
 v_pk_mul_f32 v[6:7], v[6:7], v[190:191]
 v_cvt_pk_bf16_f32 v11, v6, v7
 ds_write_b128 v17, v[8:11] offset:20480
 v_accvgpr_read_b32 v7, a116
 v_lshlrev_b32 v6, 16, v7
 v_and_b32 v7, s26, v7
 v_pk_mul_f32 v[6:7], v[6:7], v[220:221]
 v_cvt_pk_bf16_f32 v12, v6, v7
 v_accvgpr_read_b32 v7, a117
 v_lshlrev_b32 v6, 16, v7
 v_and_b32 v7, s26, v7
 v_pk_mul_f32 v[6:7], v[6:7], v[222:223]
 v_cvt_pk_bf16_f32 v13, v6, v7
 v_accvgpr_read_b32 v7, a118
 v_lshlrev_b32 v6, 16, v7
 v_and_b32 v7, s26, v7
 v_pk_mul_f32 v[6:7], v[6:7], v[252:253]
 v_cvt_pk_bf16_f32 v14, v6, v7
 v_accvgpr_read_b32 v7, a119
 v_lshlrev_b32 v6, 16, v7
 v_and_b32 v7, s26, v7
 v_pk_mul_f32 v[6:7], v[6:7], v[254:255]
 v_cvt_pk_bf16_f32 v15, v6, v7
 ds_write_b128 v18, v[12:15] offset:20480
 ds_read_b128 v[48:51], v3 offset:20480
 ds_read_b128 v[80:83], v3 offset:21504
 v_accvgpr_read_b32 v7, a88
 v_lshlrev_b32 v6, 16, v7
 v_and_b32 v7, s26, v7
 v_pk_mul_f32 v[6:7], v[6:7], v[160:161]
 v_cvt_pk_bf16_f32 v8, v6, v7
 v_accvgpr_read_b32 v7, a89
 v_lshlrev_b32 v6, 16, v7
 v_and_b32 v7, s26, v7
 v_pk_mul_f32 v[6:7], v[6:7], v[162:163]
 v_cvt_pk_bf16_f32 v9, v6, v7
 v_accvgpr_read_b32 v7, a90
 v_lshlrev_b32 v6, 16, v7
 s_waitcnt lgkmcnt(1)
 s_add_u32 s3, s28, 163840
 buffer_store_dwordx4 v[48:51], v16, s[16:19], s3 offen offset:128 nt
 s_waitcnt lgkmcnt(0)
 s_add_u32 s3, s28, 180224
 buffer_store_dwordx4 v[80:83], v16, s[16:19], s3 offen offset:128 nt
 v_and_b32 v7, s26, v7
 v_pk_mul_f32 v[6:7], v[6:7], v[192:193]
 v_cvt_pk_bf16_f32 v10, v6, v7
 v_accvgpr_read_b32 v7, a91
 v_lshlrev_b32 v6, 16, v7
 v_and_b32 v7, s26, v7
 v_pk_mul_f32 v[6:7], v[6:7], v[194:195]
 v_cvt_pk_bf16_f32 v11, v6, v7
 ds_write_b128 v17, v[8:11] offset:24576
 v_accvgpr_read_b32 v7, a120
 v_lshlrev_b32 v6, 16, v7
 v_and_b32 v7, s26, v7
 v_pk_mul_f32 v[6:7], v[6:7], v[224:225]
 v_cvt_pk_bf16_f32 v12, v6, v7
 v_accvgpr_read_b32 v7, a121
 v_lshlrev_b32 v6, 16, v7
 v_and_b32 v7, s26, v7
 v_pk_mul_f32 v[6:7], v[6:7], v[226:227]
 v_cvt_pk_bf16_f32 v13, v6, v7
 v_accvgpr_read_b32 v7, a122
 v_accvgpr_read_b32 v112, a248
 v_accvgpr_read_b32 v113, a249
 v_lshlrev_b32 v6, 16, v7
 v_and_b32 v7, s26, v7
 v_pk_mul_f32 v[6:7], v[6:7], v[112:113]
 v_cvt_pk_bf16_f32 v14, v6, v7
 v_accvgpr_read_b32 v7, a123
 v_accvgpr_read_b32 v112, a250
 v_accvgpr_read_b32 v113, a251
 v_lshlrev_b32 v6, 16, v7
 v_and_b32 v7, s26, v7
 v_pk_mul_f32 v[6:7], v[6:7], v[112:113]
 v_cvt_pk_bf16_f32 v15, v6, v7
 ds_write_b128 v18, v[12:15] offset:24576
 ds_read_b128 v[48:51], v3 offset:24576
 ds_read_b128 v[80:83], v3 offset:25600
 v_accvgpr_read_b32 v7, a92
 v_lshlrev_b32 v6, 16, v7
 v_and_b32 v7, s26, v7
 v_pk_mul_f32 v[6:7], v[6:7], v[164:165]
 v_cvt_pk_bf16_f32 v8, v6, v7
 v_accvgpr_read_b32 v7, a93
 v_lshlrev_b32 v6, 16, v7
 v_and_b32 v7, s26, v7
 v_pk_mul_f32 v[6:7], v[6:7], v[166:167]
 v_cvt_pk_bf16_f32 v9, v6, v7
 v_accvgpr_read_b32 v7, a94
 v_lshlrev_b32 v6, 16, v7
 s_waitcnt lgkmcnt(1)
 s_add_u32 s3, s28, 196608
 buffer_store_dwordx4 v[48:51], v16, s[16:19], s3 offen offset:128 nt
 s_waitcnt lgkmcnt(0)
 s_add_u32 s3, s28, 212992
 buffer_store_dwordx4 v[80:83], v16, s[16:19], s3 offen offset:128 nt
 v_and_b32 v7, s26, v7
 v_pk_mul_f32 v[6:7], v[6:7], v[196:197]
 v_cvt_pk_bf16_f32 v10, v6, v7
 v_accvgpr_read_b32 v7, a95
 v_lshlrev_b32 v6, 16, v7
 v_and_b32 v7, s26, v7
 v_pk_mul_f32 v[6:7], v[6:7], v[198:199]
 v_cvt_pk_bf16_f32 v11, v6, v7
 ds_write_b128 v17, v[8:11] offset:28672
 v_accvgpr_read_b32 v7, a124
 v_lshlrev_b32 v6, 16, v7
 v_and_b32 v7, s26, v7
 v_pk_mul_f32 v[6:7], v[6:7], v[228:229]
 v_cvt_pk_bf16_f32 v12, v6, v7
 v_accvgpr_read_b32 v7, a125
 v_lshlrev_b32 v6, 16, v7
 v_and_b32 v7, s26, v7
 v_pk_mul_f32 v[6:7], v[6:7], v[230:231]
 v_cvt_pk_bf16_f32 v13, v6, v7
 v_accvgpr_read_b32 v7, a126
 v_accvgpr_read_b32 v112, a252
 v_accvgpr_read_b32 v113, a253
 v_lshlrev_b32 v6, 16, v7
 v_and_b32 v7, s26, v7
 v_pk_mul_f32 v[6:7], v[6:7], v[112:113]
 v_cvt_pk_bf16_f32 v14, v6, v7
 v_accvgpr_read_b32 v7, a127
 v_accvgpr_read_b32 v112, a254
 v_accvgpr_read_b32 v113, a255
 v_lshlrev_b32 v6, 16, v7
 v_and_b32 v7, s26, v7
 v_pk_mul_f32 v[6:7], v[6:7], v[112:113]
 v_cvt_pk_bf16_f32 v15, v6, v7
 ds_write_b128 v18, v[12:15] offset:28672
 ds_read_b128 v[48:51], v3 offset:28672
 ds_read_b128 v[80:83], v3 offset:29696
 s_waitcnt lgkmcnt(1)
 s_add_u32 s3, s28, 229376
 buffer_store_dwordx4 v[48:51], v16, s[16:19], s3 offen offset:128 nt
 s_waitcnt lgkmcnt(0)
 s_add_u32 s3, s28, 245760
 buffer_store_dwordx4 v[80:83], v16, s[16:19], s3 offen offset:128 nt
Lend:
 s_endpgm
Lspin_pro:
 s_add_u32 s53, s53, 1
 v_lshlrev_b32 v4, 2, v3
 v_and_b32 v4, 192, v4
 buffer_load_dword v4, v4, s[44:47], 0 offen sc1
 s_cmp_ge_u32 s53, 0x100000
 s_cbranch_scc1 Lgiveup_pro
 s_waitcnt vmcnt(0)
 v_cmp_gt_i32 vcc, s27, v4
 s_and_b64 vcc, exec, vcc
 s_cbranch_vccnz Lspin_pro
Lgiveup_pro:
 s_waitcnt vmcnt(0)
 s_branch Lok_pro
Lspin_pa:
 s_add_u32 s53, s53, 1
 buffer_load_dword v4, off, s[64:67], 0 sc1
 s_cmp_ge_u32 s53, 0x100000
 s_cbranch_scc1 Lgiveup_pa
 s_waitcnt vmcnt(0)
 v_cmp_gt_i32 vcc, s55, v4
 s_and_b64 vcc, exec, vcc
 s_cbranch_vccnz Lspin_pa
Lgiveup_pa:
 s_waitcnt vmcnt(0)
 s_branch Lok_pa
Lgat0:
 v_lshrrev_b32 v5, 4, v3
 v_and_b32 v5, 0x20, v5
 v_xor_b32 v5, v5, v3
 v_and_b32 v5, 0x30, v5
 v_bfe_u32 v6, v3, 6, 4
 v_lshl_add_u32 v6, v6, 11, v5
 s_branch Lgatr0
Lxrg:
 v_lshrrev_b32 v5, 2, v3
 v_and_b32 v5, 0x20, v5
 v_lshrrev_b32 v2, 4, v3
 v_xor_b32 v5, v5, v2
 v_and_b32 v5, 0x30, v5
 v_bfe_u32 v1, v3, 4, 4
 v_lshl_add_u32 v1, v1, 6, v5
 v_add_u32 v2, 0x10000, v1
 s_branch Lxrgr
Lspin_pb:
 s_add_u32 s53, s53, 1
 buffer_load_dword v4, off, s[64:67], 0 sc1
 s_cmp_ge_u32 s53, 0x100000
 s_cbranch_scc1 Lgiveup_pb
 s_waitcnt vmcnt(0)
 v_cmp_gt_i32 vcc, s55, v4
 s_and_b64 vcc, exec, vcc
 s_cbranch_vccnz Lspin_pb
Lgiveup_pb:
 s_waitcnt vmcnt(0)
 s_branch Lok_pb
Lgat1:
 v_lshrrev_b32 v5, 4, v3
 v_and_b32 v5, 0x20, v5
 v_xor_b32 v5, v5, v3
 v_and_b32 v5, 0x30, v5
 v_bfe_u32 v6, v3, 6, 4
 v_lshl_add_u32 v6, v6, 11, v5
 s_branch Lgatr1
Lspin_w:
 s_add_u32 s53, s53, 1
 v_lshlrev_b32 v4, 2, v3
 v_and_b32 v4, 192, v4
 buffer_load_dword v4, v4, s[44:47], 0 offen sc1
 s_cmp_ge_u32 s53, 0x100000
 s_cbranch_scc1 Lgiveup_w
 s_waitcnt vmcnt(0)
 v_cmp_gt_i32 vcc, s27, v4
 s_and_b64 vcc, exec, vcc
 s_cbranch_vccnz Lspin_w
Lgiveup_w:
 s_waitcnt vmcnt(0)
 s_branch Lok_w
.section .rodata,"a"
.p2align 6
.amdhsa_kernel standalone__cross_network_dcn__recsys_kernel
  .amdhsa_next_free_vgpr 512
  .amdhsa_next_free_sgpr 102
  .amdhsa_accum_offset 256
  .amdhsa_group_segment_fixed_size 0
  .amdhsa_kernarg_size 48
  .amdhsa_user_sgpr_count 2
  .amdhsa_user_sgpr_kernarg_segment_ptr 1
  .amdhsa_system_sgpr_workgroup_id_x 1
  .amdhsa_float_denorm_mode_32 3
.end_amdhsa_kernel
```

```asm
; @launch grid=(256,1,1) block=(256,1,1) lds=151552
.amdgcn_target "amdgcn-amd-amdhsa--gfx950"
.text
.globl standalone__cross_network_dcn__recsys_kernel
.p2align 8
.type standalone__cross_network_dcn__recsys_kernel,@function
standalone__cross_network_dcn__recsys_kernel:
 s_cmp_ge_u32 s2, 256
 s_cbranch_scc1 Lend
 s_load_dwordx4 s[56:59], s[0:1], 0
 s_load_dwordx4 s[60:63], s[0:1], 16
 s_load_dwordx4 s[64:67], s[0:1], 32
 v_lshrrev_b32 v9, 6, v0
 v_and_b32 v10, 63, v0
 v_readfirstlane_b32 s54, v9
 v_lshlrev_b32 v1, 4, v10
 s_getpc_b64 s[4:5]
Lpc:
 v_lshlrev_b32 v11, 6, v0
 s_bfe_u32 s3, s2, 0x20003
 s_lshl_b32 s3, s3, 14
 v_add_u32 v11, s3, v11
 v_min_u32 v12, Lend-Lpc, v11
 global_load_dword v60, v12, s[4:5]
 v_add_u32 v11, 16384, v11
 v_lshrrev_b32 v11, 7, v0
 v_and_b32 v12, 127, v0
 v_lshlrev_b32 v12, 3, v12
 v_lshl_add_u32 v30, v11, 11, v12
 v_lshlrev_b32 v31, 4, v0
 v_add_u32 v31, 131072, v31
 v_add_u32 v2, 65536, v1
 v_lshl_add_u32 v3, v9, 15, v1
 v_lshl_add_u32 v0, v9, 18, v1
 s_and_b32 s7, s2, 1
 s_lshr_b32 s28, s2, 1
 s_lshl_b32 s28, s28, 18
 s_lshl_b32 s6, s7, 10
 s_add_u32 s28, s28, s6
 s_lshl_b32 s6, s54, 8
 s_add_u32 s28, s28, s6
 s_mov_b32 s26, 0xffff0000
 s_lshl_b32 s24, s7, 20
 s_mov_b32 s25, 0
 s_mov_b32 s53, 0
 s_mov_b32 s31, -1
 s_mov_b32 s27, 64
 s_mov_b32 s55, -1
 s_lshl_b32 s50, s54, 15
 s_lshl_b32 s29, s2, 17
 s_add_u32 s29, s29, 33554432
 s_xor_b32 s30, s29, 131072
 s_lshr_b32 s4, s2, 3
 s_and_b32 s5, s2, 7
 s_lshl_b32 s48, s4, 16
 s_lshl_b32 s6, s5, 8
 s_add_u32 s48, s48, s6
 s_lshl_b32 s6, s54, 6
 s_add_u32 s48, s48, s6
 s_lshl_b32 s49, s5, 18
 s_and_b32 s6, s4, 1
 s_lshl_b32 s6, s6, 10
 s_add_u32 s49, s49, s6
 s_lshr_b32 s6, s4, 4
 s_lshr_b32 s5, s5, 2
 s_xor_b32 s5, s5, s6
 s_bfe_u32 s6, s4, 0x10001
 s_lshl_b32 s3, s5, 1
 s_add_u32 s3, s3, s6
 s_lshl_b32 s3, s3, 16
 s_add_u32 s49, s49, s3
 s_bfe_u32 s4, s4, 0x20002
 s_xor_b32 s5, s5, s6
 s_lshr_b32 s3, s54, 1
 s_lshl_b32 s3, s3, 4
 s_lshr_b32 s6, s54, 1
 s_mul_i32 s6, s6, 3
 s_xor_b32 s6, s6, s4
 s_lshl_b32 s6, s6, 2
 s_add_u32 s3, s3, s6
 s_and_b32 s6, s54, 1
 s_lshl_b32 s6, s6, 1
 s_add_u32 s3, s3, s6
 s_lshl_b32 s4, s4, 3
 s_lshl_b32 s6, s54, 1
 s_add_u32 s4, s4, s6
 s_cmp_eq_u32 s5, 0
 s_cselect_b32 s3, s3, s4
 s_lshl_b32 s3, s3, 11
 s_add_u32 s49, s49, s3
 s_lshl_b32 s52, s54, 11
 s_add_u32 s52, s52, 143360
 s_lshl_b32 s51, s54, 9
 s_add_u32 s51, s51, 131072
 s_waitcnt lgkmcnt(0)
 s_mov_b32 s40, s58
 s_mov_b32 s41, s59
 s_mov_b32 s42, 0xc00000
 s_mov_b32 s43, 0x20000
 v_lshrrev_b32 v5, 6, v1
 v_and_b32 v6, 48, v1
 v_lshl_add_u32 v5, v5, 11, v6
 s_mov_b32 m0, s52
 s_add_u32 s3, s48, 31744
 buffer_load_dwordx4 v5, s[40:43], s48 offen lds
 buffer_load_dwordx4 v5, s[40:43], s3 offen offset:1024 lds
 s_add_u32 s48, s48, 2097152
 s_mov_b32 s20, s60
 s_mov_b32 s21, s61
 s_mov_b32 s22, 0x3000
 s_mov_b32 s23, 0x20000
 s_lshl_b32 s3, s7, 10
 buffer_load_dwordx2 v[32:33], v30, s[20:23], s3 offen
 s_add_u32 s3, s3, 4096
 buffer_load_dwordx2 v[34:35], v30, s[20:23], s3 offen
 s_add_u32 s3, s3, 4096
 buffer_load_dwordx2 v[36:37], v30, s[20:23], s3 offen
 s_add_u32 s3, s3, 4096
 s_mov_b32 s8, s56
 s_mov_b32 s9, s57
 s_mov_b32 s10, 0x2000000
 s_mov_b32 s11, 0x20000
 s_mov_b32 s16, s62
 s_mov_b32 s17, s63
 s_mov_b32 s18, 0x2000000
 s_mov_b32 s19, 0x20000
 s_mov_b32 s12, s66
 s_mov_b32 s13, s67
 s_mov_b32 s14, 0xc00000
 s_mov_b32 s15, 0x20000
 s_mov_b32 s32, s66
 s_mov_b32 s33, s67
 s_mov_b32 s34, 0x0
 s_mov_b32 s35, 0x20000
 s_mov_b32 s44, s64
 s_mov_b32 s45, s65
 s_mov_b32 s46, 0x100
 s_mov_b32 s47, 0x20000
 s_add_u32 s24, s24, 4096
 s_add_u32 s70, s66, s24
 s_addc_u32 s71, s67, 0
 s_sub_u32 s24, s24, 4096
 s_and_b32 s3, s2, 3
 s_lshl_b32 s3, s3, 6
 s_add_u32 s56, s44, s3
 s_addc_u32 s57, s45, 0
 s_mov_b32 s58, 0x4
 s_mov_b32 s59, 0x20000
 s_lshl_b32 s3, s2, 2
 s_add_u32 s3, s3, s54
 s_lshl_b32 s3, s3, 7
 s_add_u32 s3, s3, 15728640
 s_add_u32 s60, s32, s3
 s_addc_u32 s61, s33, 0
 s_mov_b32 s62, 0x4
 s_mov_b32 s63, 0x20000
 s_xor_b32 s3, s3, 512
 s_add_u32 s64, s32, s3
 s_addc_u32 s65, s33, 0
 s_mov_b32 s66, 0x4
 s_mov_b32 s67, 0x20000
 v_lshrrev_b32 v5, 2, v1
 v_and_b32 v5, 64, v5
 v_xor_b32 v5, v5, v1
 v_and_b32 v5, 112, v5
 v_lshrrev_b32 v6, 7, v1
 v_lshl_add_u32 v23, v6, 11, v5
 s_and_b32 s69, s28, 2047
 s_lshl_b32 s3, s7, 20
 s_add_u32 s69, s69, s3
 s_add_u32 m0, s50, 0
 s_add_u32 s3, s69, 0
 buffer_load_dwordx4 v23, s[40:43], s3 offen lds
 s_add_u32 m0, s50, 1024
 s_add_u32 s3, s69, 16384
 buffer_load_dwordx4 v23, s[40:43], s3 offen lds
 s_add_u32 m0, s50, 4096
 s_add_u32 s3, s69, 32768
 buffer_load_dwordx4 v23, s[40:43], s3 offen lds
 s_add_u32 m0, s50, 5120
 s_add_u32 s3, s69, 49152
 buffer_load_dwordx4 v23, s[40:43], s3 offen lds
 s_add_u32 m0, s50, 8192
 s_add_u32 s3, s69, 65536
 buffer_load_dwordx4 v23, s[40:43], s3 offen lds
 s_add_u32 m0, s50, 9216
 s_add_u32 s3, s69, 81920
 buffer_load_dwordx4 v23, s[40:43], s3 offen lds
 s_add_u32 m0, s50, 12288
 s_add_u32 s3, s69, 98304
 buffer_load_dwordx4 v23, s[40:43], s3 offen lds
 s_add_u32 m0, s50, 13312
 s_add_u32 s3, s69, 114688
 buffer_load_dwordx4 v23, s[40:43], s3 offen lds
 s_add_u32 m0, s50, 16384
 s_add_u32 s3, s69, 262144
 buffer_load_dwordx4 v23, s[40:43], s3 offen lds
 s_add_u32 m0, s50, 17408
 s_add_u32 s3, s69, 278528
 buffer_load_dwordx4 v23, s[40:43], s3 offen lds
 s_add_u32 m0, s50, 20480
 s_add_u32 s3, s69, 294912
 buffer_load_dwordx4 v23, s[40:43], s3 offen lds
 s_add_u32 m0, s50, 21504
 s_add_u32 s3, s69, 311296
 buffer_load_dwordx4 v23, s[40:43], s3 offen lds
 s_add_u32 m0, s50, 24576
 s_add_u32 s3, s69, 327680
 buffer_load_dwordx4 v23, s[40:43], s3 offen lds
 s_add_u32 m0, s50, 25600
 s_add_u32 s3, s69, 344064
 buffer_load_dwordx4 v23, s[40:43], s3 offen lds
 s_add_u32 m0, s50, 28672
 s_add_u32 s3, s69, 360448
 buffer_load_dwordx4 v23, s[40:43], s3 offen lds
 s_add_u32 m0, s50, 29696
 s_add_u32 s3, s69, 376832
 buffer_load_dwordx4 v23, s[40:43], s3 offen lds
 v_mov_b32 v7, 0
 buffer_store_dword v7, v1, s[60:63], 0 offen sc1
 v_lshrrev_b32 v5, 7, v1
 v_lshlrev_b32 v6, 4, v5
 v_xor_b32 v6, v6, v1
 v_and_b32 v6, 112, v6
 v_lshl_add_u32 v20, v5, 11, v6
 v_lshrrev_b32 v5, 4, v1
 v_and_b32 v5, 48, v5
 v_xor_b32 v5, v5, v1
 v_and_b32 v5, 112, v5
 v_and_b32 v6, 240, v1
 v_lshl_add_u32 v5, v6, 3, v5
 v_add_u32 v21, s50, v5
 v_xor_b32 v22, 64, v21
 v_lshrrev_b32 v5, 1, v1
 v_and_b32 v5, 64, v5
 v_and_b32 v6, 48, v1
 v_or_b32 v5, v5, v6
 v_and_b32 v6, 192, v1
 v_lshl_add_u32 v5, v6, 1, v5
 v_and_b32 v6, 256, v1
 v_lshl_add_u32 v5, v6, 2, v5
 v_and_b32 v6, 512, v1
 v_lshl_add_u32 v5, v6, 3, v5
 v_add_u32 v24, s50, v5
 v_xor_b32 v25, 64, v24
 v_mov_b32 v64, 1.0
 v_mov_b32 v65, 1.0
 v_mov_b32 v66, 1.0
 v_mov_b32 v67, 1.0
 v_mov_b32 v68, 1.0
 v_mov_b32 v69, 1.0
 v_mov_b32 v70, 1.0
 v_mov_b32 v71, 1.0
 v_mov_b32 v72, 1.0
 v_mov_b32 v73, 1.0
 v_mov_b32 v74, 1.0
 v_mov_b32 v75, 1.0
 v_mov_b32 v76, 1.0
 v_mov_b32 v77, 1.0
 v_mov_b32 v78, 1.0
 v_mov_b32 v79, 1.0
 v_mov_b32 v80, 1.0
 v_mov_b32 v81, 1.0
 v_mov_b32 v82, 1.0
 v_mov_b32 v83, 1.0
 v_mov_b32 v84, 1.0
 v_mov_b32 v85, 1.0
 v_mov_b32 v86, 1.0
 v_mov_b32 v87, 1.0
 v_mov_b32 v88, 1.0
 v_mov_b32 v89, 1.0
 v_mov_b32 v90, 1.0
 v_mov_b32 v91, 1.0
 v_mov_b32 v92, 1.0
 v_mov_b32 v93, 1.0
 v_mov_b32 v94, 1.0
 v_mov_b32 v95, 1.0
 v_mov_b32 v96, 1.0
 v_mov_b32 v97, 1.0
 v_mov_b32 v98, 1.0
 v_mov_b32 v99, 1.0
 v_mov_b32 v100, 1.0
 v_mov_b32 v101, 1.0
 v_mov_b32 v102, 1.0
 v_mov_b32 v103, 1.0
 v_mov_b32 v104, 1.0
 v_mov_b32 v105, 1.0
 v_mov_b32 v106, 1.0
 v_mov_b32 v107, 1.0
 v_mov_b32 v108, 1.0
 v_mov_b32 v109, 1.0
 v_mov_b32 v110, 1.0
 v_mov_b32 v111, 1.0
 v_mov_b32 v112, 1.0
 v_mov_b32 v113, 1.0
 v_mov_b32 v114, 1.0
 v_mov_b32 v115, 1.0
 v_mov_b32 v116, 1.0
 v_mov_b32 v117, 1.0
 v_mov_b32 v118, 1.0
 v_mov_b32 v119, 1.0
 v_mov_b32 v120, 1.0
 v_mov_b32 v121, 1.0
 v_mov_b32 v122, 1.0
 v_mov_b32 v123, 1.0
 v_mov_b32 v124, 1.0
 v_mov_b32 v125, 1.0
 v_mov_b32 v126, 1.0
 v_mov_b32 v127, 1.0
 v_mov_b32 v128, 1.0
 v_mov_b32 v129, 1.0
 v_mov_b32 v130, 1.0
 v_mov_b32 v131, 1.0
 v_mov_b32 v132, 1.0
 v_mov_b32 v133, 1.0
 v_mov_b32 v134, 1.0
 v_mov_b32 v135, 1.0
 v_accvgpr_write_b32 a240, 1.0
 v_accvgpr_write_b32 a241, 1.0
 v_accvgpr_write_b32 a242, 1.0
 v_accvgpr_write_b32 a243, 1.0
 v_accvgpr_write_b32 a244, 1.0
 v_accvgpr_write_b32 a245, 1.0
 v_accvgpr_write_b32 a246, 1.0
 v_accvgpr_write_b32 a247, 1.0
 v_mov_b32 v216, 1.0
 v_mov_b32 v217, 1.0
 v_mov_b32 v218, 1.0
 v_mov_b32 v219, 1.0
 v_mov_b32 v220, 1.0
 v_mov_b32 v221, 1.0
 v_mov_b32 v222, 1.0
 v_mov_b32 v223, 1.0
 v_mov_b32 v224, 1.0
 v_mov_b32 v225, 1.0
 v_mov_b32 v226, 1.0
 v_mov_b32 v227, 1.0
 v_mov_b32 v228, 1.0
 v_mov_b32 v229, 1.0
 v_mov_b32 v230, 1.0
 v_mov_b32 v231, 1.0
 v_mov_b32 v232, 1.0
 v_mov_b32 v233, 1.0
 v_mov_b32 v234, 1.0
 v_mov_b32 v235, 1.0
 v_mov_b32 v236, 1.0
 v_mov_b32 v237, 1.0
 v_mov_b32 v238, 1.0
 v_mov_b32 v239, 1.0
 v_mov_b32 v240, 1.0
 v_mov_b32 v241, 1.0
 v_mov_b32 v242, 1.0
 v_mov_b32 v243, 1.0
 v_mov_b32 v244, 1.0
 v_mov_b32 v245, 1.0
 v_mov_b32 v246, 1.0
 v_mov_b32 v247, 1.0
 v_mov_b32 v248, 1.0
 v_mov_b32 v249, 1.0
 v_mov_b32 v250, 1.0
 v_mov_b32 v251, 1.0
 v_mov_b32 v252, 1.0
 v_mov_b32 v253, 1.0
 v_mov_b32 v254, 1.0
 v_mov_b32 v255, 1.0
 v_accvgpr_write_b32 a248, 1.0
 v_accvgpr_write_b32 a249, 1.0
 v_accvgpr_write_b32 a250, 1.0
 v_accvgpr_write_b32 a251, 1.0
 v_accvgpr_write_b32 a252, 1.0
 v_accvgpr_write_b32 a253, 1.0
 v_accvgpr_write_b32 a254, 1.0
 v_accvgpr_write_b32 a255, 1.0
 v_and_b32 v5, 768, v3
 v_and_b32 v7, 1023, v3
 v_add3_u32 v5, v5, v7, s52
 s_waitcnt vmcnt(20)
 ds_read_b64_tr_b16 v[8:9], v5 offset:0
 ds_read_b64_tr_b16 v[10:11], v5 offset:256
 ds_read_b64_tr_b16 v[12:13], v5 offset:8
 ds_read_b64_tr_b16 v[14:15], v5 offset:264
 s_waitcnt lgkmcnt(2)
 buffer_store_dwordx4 v[8:11], v7, s[12:15], s49 offen sc1
 s_waitcnt lgkmcnt(0)
 buffer_store_dwordx4 v[12:15], v7, s[12:15], s49 offen offset:2048 sc1
 s_add_u32 s49, s49, 2097152
 s_add_u32 m0, s50, 2048
 s_add_u32 s3, s69, 524288
 buffer_load_dwordx4 v23, s[40:43], s3 offen lds
 s_add_u32 m0, s50, 3072
 s_add_u32 s3, s69, 540672
 buffer_load_dwordx4 v23, s[40:43], s3 offen lds
 s_add_u32 m0, s50, 6144
 s_add_u32 s3, s69, 557056
 buffer_load_dwordx4 v23, s[40:43], s3 offen lds
 s_add_u32 m0, s50, 7168
 s_add_u32 s3, s69, 573440
 buffer_load_dwordx4 v23, s[40:43], s3 offen lds
 s_add_u32 m0, s50, 10240
 s_add_u32 s3, s69, 589824
 buffer_load_dwordx4 v23, s[40:43], s3 offen lds
 s_add_u32 m0, s50, 11264
 s_add_u32 s3, s69, 606208
 buffer_load_dwordx4 v23, s[40:43], s3 offen lds
 s_add_u32 m0, s50, 14336
 s_add_u32 s3, s69, 622592
 buffer_load_dwordx4 v23, s[40:43], s3 offen lds
 s_add_u32 m0, s50, 15360
 s_add_u32 s3, s69, 638976
 buffer_load_dwordx4 v23, s[40:43], s3 offen lds
 s_waitcnt vmcnt(29)
 v_lshlrev_b32 v40, 16, v32
 v_and_b32 v41, s26, v32
 v_lshlrev_b32 v42, 16, v33
 v_and_b32 v43, s26, v33
 ds_write_b128 v31, v[40:43]
 s_waitcnt vmcnt(28)
 v_lshlrev_b32 v44, 16, v34
 v_and_b32 v45, s26, v34
 v_lshlrev_b32 v46, 16, v35
 v_and_b32 v47, s26, v35
 ds_write_b128 v31, v[44:47] offset:4096
 s_waitcnt vmcnt(27)
 v_lshlrev_b32 v48, 16, v36
 v_and_b32 v49, s26, v36
 v_lshlrev_b32 v50, 16, v37
 v_and_b32 v51, s26, v37
 ds_write_b128 v31, v[48:51] offset:8192
 s_waitcnt lgkmcnt(0)
 v_mov_b32 v32, 1.0
 v_mov_b32 v33, 1.0
 v_mov_b32 v34, 1.0
 v_mov_b32 v35, 1.0
 v_mov_b32 v36, 1.0
 v_mov_b32 v37, 1.0
 v_mov_b32 v38, 1.0
 v_mov_b32 v39, 1.0
 v_mov_b32 v40, 1.0
 v_mov_b32 v41, 1.0
 v_mov_b32 v42, 1.0
 v_mov_b32 v43, 1.0
 v_mov_b32 v44, 1.0
 v_mov_b32 v45, 1.0
 v_mov_b32 v46, 1.0
 v_mov_b32 v47, 1.0
 v_mov_b32 v48, 1.0
 v_mov_b32 v49, 1.0
 v_mov_b32 v50, 1.0
 v_mov_b32 v51, 1.0
 v_mov_b32 v52, 1.0
 v_mov_b32 v53, 1.0
 v_mov_b32 v54, 1.0
 v_mov_b32 v55, 1.0
 v_mov_b32 v56, 1.0
 v_mov_b32 v57, 1.0
 v_mov_b32 v58, 1.0
 v_mov_b32 v59, 1.0
 v_mov_b32 v60, 1.0
 v_mov_b32 v61, 1.0
 v_mov_b32 v62, 1.0
 v_mov_b32 v63, 1.0
 s_waitcnt vmcnt(23)
 ds_read_b64_tr_b16 v[136:137], v24 offset:0
 ds_read_b64_tr_b16 v[138:139], v24 offset:512
 ds_read_b64_tr_b16 v[144:145], v24 offset:8
 ds_read_b64_tr_b16 v[146:147], v24 offset:520
 ds_read_b64_tr_b16 v[152:153], v25 offset:0
 ds_read_b64_tr_b16 v[154:155], v25 offset:512
 ds_read_b64_tr_b16 v[160:161], v25 offset:8
 ds_read_b64_tr_b16 v[162:163], v25 offset:520
 s_waitcnt vmcnt(19)
 ds_read_b64_tr_b16 v[140:141], v24 offset:8192
 ds_read_b64_tr_b16 v[142:143], v24 offset:8704
 ds_read_b64_tr_b16 v[148:149], v24 offset:8200
 ds_read_b64_tr_b16 v[150:151], v24 offset:8712
 ds_read_b64_tr_b16 v[156:157], v25 offset:8192
 ds_read_b64_tr_b16 v[158:159], v25 offset:8704
 ds_read_b64_tr_b16 v[164:165], v25 offset:8200
 ds_read_b64_tr_b16 v[166:167], v25 offset:8712
 s_waitcnt lgkmcnt(8)
 s_add_u32 m0, s50, 0
 s_add_u32 s3, s28, 0
 buffer_load_dwordx4 v20, s[8:11], s3 offen lds
 s_add_u32 m0, s50, 1024
 s_add_u32 s3, s28, 16384
 buffer_load_dwordx4 v20, s[8:11], s3 offen lds
 s_add_u32 m0, s50, 4096
 s_add_u32 s3, s28, 32768
 buffer_load_dwordx4 v20, s[8:11], s3 offen lds
 s_add_u32 m0, s50, 5120
 s_add_u32 s3, s28, 49152
 buffer_load_dwordx4 v20, s[8:11], s3 offen lds
 s_waitcnt vmcnt(19)
 ds_read_b64_tr_b16 v[168:169], v24 offset:16384
 ds_read_b64_tr_b16 v[170:171], v24 offset:16896
 ds_read_b64_tr_b16 v[176:177], v24 offset:16392
 ds_read_b64_tr_b16 v[178:179], v24 offset:16904
 ds_read_b64_tr_b16 v[184:185], v25 offset:16384
 ds_read_b64_tr_b16 v[186:187], v25 offset:16896
 ds_read_b64_tr_b16 v[192:193], v25 offset:16392
 ds_read_b64_tr_b16 v[194:195], v25 offset:16904
 s_waitcnt lgkmcnt(8)
 s_add_u32 m0, s50, 8192
 s_add_u32 s3, s28, 65536
 buffer_load_dwordx4 v20, s[8:11], s3 offen lds
 s_add_u32 m0, s50, 9216
 s_add_u32 s3, s28, 81920
 buffer_load_dwordx4 v20, s[8:11], s3 offen lds
 s_add_u32 m0, s50, 12288
 s_add_u32 s3, s28, 98304
 buffer_load_dwordx4 v20, s[8:11], s3 offen lds
 s_add_u32 m0, s50, 13312
 s_add_u32 s3, s28, 114688
 buffer_load_dwordx4 v20, s[8:11], s3 offen lds
 s_waitcnt vmcnt(19)
 ds_read_b64_tr_b16 v[172:173], v24 offset:24576
 ds_read_b64_tr_b16 v[174:175], v24 offset:25088
 ds_read_b64_tr_b16 v[180:181], v24 offset:24584
 ds_read_b64_tr_b16 v[182:183], v24 offset:25096
 ds_read_b64_tr_b16 v[188:189], v25 offset:24576
 ds_read_b64_tr_b16 v[190:191], v25 offset:25088
 ds_read_b64_tr_b16 v[196:197], v25 offset:24584
 ds_read_b64_tr_b16 v[198:199], v25 offset:25096
 s_waitcnt vmcnt(16)
 s_barrier
 v_mov_b32 v7, 1
 buffer_atomic_add v7, v0, s[56:59], 0 offen sc1
 s_add_u32 m0, s50, 18432
 s_add_u32 s3, s69, 786432
 buffer_load_dwordx4 v23, s[40:43], s3 offen lds
 s_add_u32 m0, s50, 19456
 s_add_u32 s3, s69, 802816
 buffer_load_dwordx4 v23, s[40:43], s3 offen lds
 s_add_u32 m0, s50, 22528
 s_add_u32 s3, s69, 819200
 buffer_load_dwordx4 v23, s[40:43], s3 offen lds
 s_add_u32 m0, s50, 23552
 s_add_u32 s3, s69, 835584
 buffer_load_dwordx4 v23, s[40:43], s3 offen lds
 s_add_u32 m0, s50, 26624
 s_add_u32 s3, s69, 851968
 buffer_load_dwordx4 v23, s[40:43], s3 offen lds
 s_add_u32 m0, s50, 27648
 s_add_u32 s3, s69, 868352
 buffer_load_dwordx4 v23, s[40:43], s3 offen lds
 s_add_u32 m0, s50, 30720
 s_add_u32 s3, s69, 884736
 buffer_load_dwordx4 v23, s[40:43], s3 offen lds
 s_add_u32 m0, s50, 31744
 s_add_u32 s3, s69, 901120
 buffer_load_dwordx4 v23, s[40:43], s3 offen lds
 s_waitcnt lgkmcnt(0)
 s_add_u32 m0, s50, 16384
 s_add_u32 s3, s28, 131072
 buffer_load_dwordx4 v20, s[8:11], s3 offen lds
 s_add_u32 m0, s50, 17408
 s_add_u32 s3, s28, 147456
 buffer_load_dwordx4 v20, s[8:11], s3 offen lds
 s_add_u32 m0, s50, 20480
 s_add_u32 s3, s28, 163840
 buffer_load_dwordx4 v20, s[8:11], s3 offen lds
 s_add_u32 m0, s50, 21504
 s_add_u32 s3, s28, 180224
 buffer_load_dwordx4 v20, s[8:11], s3 offen lds
 s_add_u32 m0, s50, 24576
 s_add_u32 s3, s28, 196608
 buffer_load_dwordx4 v20, s[8:11], s3 offen lds
 s_add_u32 m0, s50, 25600
 s_add_u32 s3, s28, 212992
 buffer_load_dwordx4 v20, s[8:11], s3 offen lds
 s_add_u32 m0, s50, 28672
 s_add_u32 s3, s28, 229376
 buffer_load_dwordx4 v20, s[8:11], s3 offen lds
 s_add_u32 m0, s50, 29696
 s_add_u32 s3, s28, 245760
 buffer_load_dwordx4 v20, s[8:11], s3 offen lds
 s_waitcnt vmcnt(29)
 ds_read_b64_tr_b16 v[200:201], v24 offset:2048
 ds_read_b64_tr_b16 v[202:203], v24 offset:2560
 ds_read_b64_tr_b16 v[208:209], v24 offset:2056
 ds_read_b64_tr_b16 v[210:211], v24 offset:2568
 ds_read_b64_tr_b16 a[224:225], v25 offset:2048
 ds_read_b64_tr_b16 a[226:227], v25 offset:2560
 ds_read_b64_tr_b16 a[232:233], v25 offset:2056
 ds_read_b64_tr_b16 a[234:235], v25 offset:2568
 s_waitcnt vmcnt(25)
 ds_read_b64_tr_b16 v[204:205], v24 offset:10240
 ds_read_b64_tr_b16 v[206:207], v24 offset:10752
 ds_read_b64_tr_b16 v[212:213], v24 offset:10248
 ds_read_b64_tr_b16 v[214:215], v24 offset:10760
 ds_read_b64_tr_b16 a[228:229], v25 offset:10240
 ds_read_b64_tr_b16 a[230:231], v25 offset:10752
 ds_read_b64_tr_b16 a[236:237], v25 offset:10248
 ds_read_b64_tr_b16 a[238:239], v25 offset:10760
 s_waitcnt vmcnt(12)
 ds_read_b64_tr_b16 a[192:193], v24 offset:18432
 ds_read_b64_tr_b16 a[194:195], v24 offset:18944
 ds_read_b64_tr_b16 a[200:201], v24 offset:18440
 ds_read_b64_tr_b16 a[202:203], v24 offset:18952
 ds_read_b64_tr_b16 a[208:209], v25 offset:18432
 ds_read_b64_tr_b16 a[210:211], v25 offset:18944
 ds_read_b64_tr_b16 a[216:217], v25 offset:18440
 ds_read_b64_tr_b16 a[218:219], v25 offset:18952
 s_waitcnt vmcnt(8)
 ds_read_b64_tr_b16 a[196:197], v24 offset:26624
 ds_read_b64_tr_b16 a[198:199], v24 offset:27136
 ds_read_b64_tr_b16 a[204:205], v24 offset:26632
 ds_read_b64_tr_b16 a[206:207], v24 offset:27144
 ds_read_b64_tr_b16 a[212:213], v25 offset:26624
 ds_read_b64_tr_b16 a[214:215], v25 offset:27136
 ds_read_b64_tr_b16 a[220:221], v25 offset:26632
 ds_read_b64_tr_b16 a[222:223], v25 offset:27144
 ds_read_b128 a[0:3], v21
 ds_read_b128 a[32:35], v22
 ds_read_b128 a[4:7], v21 offset:4096
 ds_read_b128 a[36:39], v22 offset:4096
 s_waitcnt lgkmcnt(2)
 ds_write_b128 v3, a[0:3]
 ds_write_b128 v3, a[32:35] offset:1024
 ds_read_b128 a[8:11], v21 offset:8192
 ds_read_b128 a[40:43], v22 offset:8192
 s_waitcnt lgkmcnt(4)
 ds_write_b128 v3, a[4:7] offset:4096
 ds_write_b128 v3, a[36:39] offset:5120
 ds_read_b128 a[12:15], v21 offset:12288
 ds_read_b128 a[44:47], v22 offset:12288
 s_waitcnt lgkmcnt(4)
 ds_write_b128 v3, a[8:11] offset:8192
 ds_write_b128 v3, a[40:43] offset:9216
 s_waitcnt vmcnt(6)
 ds_read_b128 a[16:19], v21 offset:16384
 ds_read_b128 a[48:51], v22 offset:16384
 s_waitcnt lgkmcnt(4)
 ds_write_b128 v3, a[12:15] offset:12288
 ds_write_b128 v3, a[44:47] offset:13312
 s_waitcnt vmcnt(4)
 ds_read_b128 a[20:23], v21 offset:20480
 ds_read_b128 a[52:55], v22 offset:20480
 s_waitcnt lgkmcnt(4)
 ds_write_b128 v3, a[16:19] offset:16384
 ds_write_b128 v3, a[48:51] offset:17408
 s_waitcnt vmcnt(2)
 ds_read_b128 a[24:27], v21 offset:24576
 ds_read_b128 a[56:59], v22 offset:24576
 s_waitcnt lgkmcnt(4)
 ds_write_b128 v3, a[20:23] offset:20480
 ds_write_b128 v3, a[52:55] offset:21504
 s_waitcnt lgkmcnt(0)
 v_lshlrev_b32 v4, 2, v3
 v_and_b32 v4, 192, v4
 buffer_load_dword v4, v4, s[44:47], 0 offen sc1
 s_add_u32 m0, s50, 2048
 s_add_u32 s3, s28, 128
 buffer_load_dwordx4 v20, s[8:11], s3 offen lds
 s_add_u32 m0, s50, 3072
 s_add_u32 s3, s28, 16512
 buffer_load_dwordx4 v20, s[8:11], s3 offen lds
 s_waitcnt vmcnt(3)
 ds_read_b128 a[28:31], v21 offset:28672
 ds_read_b128 a[60:63], v22 offset:28672
 ds_write_b128 v3, a[24:27] offset:24576
 ds_write_b128 v3, a[56:59] offset:25600
 s_waitcnt lgkmcnt(2)
 ds_write_b128 v3, a[28:31] offset:28672
 ds_write_b128 v3, a[60:63] offset:29696
 s_add_u32 m0, s50, 6144
 s_add_u32 s3, s28, 32896
 buffer_load_dwordx4 v20, s[8:11], s3 offen lds
 s_add_u32 m0, s50, 7168
 s_add_u32 s3, s28, 49280
 buffer_load_dwordx4 v20, s[8:11], s3 offen lds
 s_add_u32 m0, s50, 10240
 s_add_u32 s3, s28, 65664
 buffer_load_dwordx4 v20, s[8:11], s3 offen lds
 s_add_u32 m0, s50, 11264
 s_add_u32 s3, s28, 82048
 buffer_load_dwordx4 v20, s[8:11], s3 offen lds
 v_mov_b32 v8, v20
 v_mov_b32 v16, 1.0
 v_mov_b32 v17, 1.0
 v_mov_b32 v18, 1.0
 v_mov_b32 v19, 1.0
 v_mov_b32 v20, 1.0
 v_mov_b32 v21, 1.0
 v_mov_b32 v22, 1.0
 v_mov_b32 v23, 1.0
 v_mov_b32 v24, 1.0
 v_mov_b32 v25, 1.0
 v_mov_b32 v26, 1.0
 v_mov_b32 v27, 1.0
 v_mov_b32 v28, 1.0
 v_mov_b32 v29, 1.0
 v_mov_b32 v30, 1.0
 v_mov_b32 v31, 1.0
 s_add_u32 s70, s70, 32768
 s_addc_u32 s71, s71, 0
 s_xor_b32 s30, s28, 1024
 s_mov_b32 s20, 64
 s_mov_b32 s21, 32704
 s_mov_b32 s22, 0xfffc8040
 s_waitcnt lgkmcnt(0)
 s_barrier
 ds_read_b128 a[128:131], v1
 ds_read_b128 a[132:135], v1 offset:1024
 ds_read_b128 a[140:143], v1 offset:5120
 ds_read_b128 a[136:139], v1 offset:4096
 ds_read_b128 a[144:147], v1 offset:8192
 ds_read_b128 a[148:151], v1 offset:9216
 ds_read_b128 a[156:159], v1 offset:13312
 ds_read_b128 a[152:155], v1 offset:12288
 ds_read_b128 a[160:163], v1 offset:16384
 ds_read_b128 a[164:167], v1 offset:17408
 ds_read_b128 a[172:175], v1 offset:21504
 ds_read_b128 a[168:171], v1 offset:20480
 ds_read_b128 a[176:179], v1 offset:24576
 ds_read_b128 a[180:183], v1 offset:25600
 ds_read_b128 a[188:191], v1 offset:29696
 ds_read_b128 a[184:187], v1 offset:28672
 s_waitcnt lgkmcnt(8)
 v_mfma_f32_16x16x32_bf16 v[16:19], v[136:139], a[128:131], v[16:19]
 s_add_u32 m0, s50, 14336
 v_mfma_f32_16x16x32_bf16 v[16:19], v[140:143], a[132:135], v[16:19]
 v_mfma_f32_16x16x32_bf16 v[20:23], v[140:143], a[140:143], v[20:23]
 s_add_u32 s3, s28, 98432
 v_mfma_f32_16x16x32_bf16 v[20:23], v[136:139], a[136:139], v[20:23]
 buffer_load_dwordx4 v8, s[8:11], s3 offen lds
 v_mfma_f32_16x16x32_bf16 v[24:27], v[136:139], a[144:147], v[24:27]
 s_add_u32 m0, s50, 15360
 v_mfma_f32_16x16x32_bf16 v[24:27], v[140:143], a[148:151], v[24:27]
 v_mfma_f32_16x16x32_bf16 v[28:31], v[140:143], a[156:159], v[28:31]
 s_add_u32 s3, s28, 114816
 v_mfma_f32_16x16x32_bf16 v[28:31], v[136:139], a[152:155], v[28:31]
 buffer_load_dwordx4 v8, s[8:11], s3 offen lds
 s_waitcnt lgkmcnt(0)
 v_mfma_f32_16x16x32_bf16 v[32:35], v[136:139], a[160:163], v[32:35]
 s_add_u32 m0, s50, 18432
 v_mfma_f32_16x16x32_bf16 v[32:35], v[140:143], a[164:167], v[32:35]
 s_add_u32 s3, s28, 131200
 v_mfma_f32_16x16x32_bf16 v[36:39], v[140:143], a[172:175], v[36:39]
 v_mfma_f32_16x16x32_bf16 v[36:39], v[136:139], a[168:171], v[36:39]
 buffer_load_dwordx4 v8, s[8:11], s3 offen lds
 v_mfma_f32_16x16x32_bf16 v[40:43], v[136:139], a[176:179], v[40:43]
 s_add_u32 m0, s50, 19456
 v_mfma_f32_16x16x32_bf16 v[40:43], v[140:143], a[180:183], v[40:43]
 s_add_u32 s3, s28, 147584
 v_mfma_f32_16x16x32_bf16 v[44:47], v[140:143], a[188:191], v[44:47]
 v_mfma_f32_16x16x32_bf16 v[44:47], v[136:139], a[184:187], v[44:47]
 buffer_load_dwordx4 v8, s[8:11], s3 offen lds
 v_mfma_f32_16x16x32_bf16 v[76:79], v[144:147], a[184:187], v[76:79]
 s_add_u32 m0, s50, 22528
 v_mfma_f32_16x16x32_bf16 v[76:79], v[148:151], a[188:191], v[76:79]
 s_add_u32 s3, s28, 163968
 v_mfma_f32_16x16x32_bf16 v[72:75], v[148:151], a[180:183], v[72:75]
 v_mov_b32 v136, 1.0
 v_mfma_f32_16x16x32_bf16 v[72:75], v[144:147], a[176:179], v[72:75]
 buffer_load_dwordx4 v8, s[8:11], s3 offen lds
 v_mfma_f32_16x16x32_bf16 v[68:71], v[144:147], a[168:171], v[68:71]
 s_add_u32 m0, s50, 23552
 v_mov_b32 v137, 1.0
 v_mfma_f32_16x16x32_bf16 v[68:71], v[148:151], a[172:175], v[68:71]
 s_add_u32 s3, s28, 180352
 v_mov_b32 v138, 1.0
 v_mfma_f32_16x16x32_bf16 v[64:67], v[148:151], a[164:167], v[64:67]
 buffer_load_dwordx4 v8, s[8:11], s3 offen lds
 v_mfma_f32_16x16x32_bf16 v[64:67], v[144:147], a[160:163], v[64:67]
 v_mov_b32 v139, 1.0
 v_mfma_f32_16x16x32_bf16 v[60:63], v[144:147], a[152:155], v[60:63]
 s_add_u32 m0, s50, 26624
 v_mov_b32 v140, 1.0
 v_mfma_f32_16x16x32_bf16 v[60:63], v[148:151], a[156:159], v[60:63]
 v_mfma_f32_16x16x32_bf16 v[56:59], v[148:151], a[148:151], v[56:59]
 s_add_u32 s3, s28, 196736
 v_mov_b32 v141, 1.0
 v_mfma_f32_16x16x32_bf16 v[56:59], v[144:147], a[144:147], v[56:59]
 v_mov_b32 v142, 1.0
 v_mfma_f32_16x16x32_bf16 v[52:55], v[144:147], a[136:139], v[52:55]
 buffer_load_dwordx4 v8, s[8:11], s3 offen lds
 s_add_u32 m0, s50, 27648
 v_mfma_f32_16x16x32_bf16 v[52:55], v[148:151], a[140:143], v[52:55]
 v_mov_b32 v143, 1.0
 v_mfma_f32_16x16x32_bf16 v[48:51], v[148:151], a[132:135], v[48:51]
 s_add_u32 s3, s28, 213120
 v_mfma_f32_16x16x32_bf16 v[48:51], v[144:147], a[128:131], v[48:51]
 buffer_load_dwordx4 v8, s[8:11], s3 offen lds
 v_mfma_f32_16x16x32_bf16 v[80:83], v[152:155], a[128:131], v[80:83]
 s_add_u32 m0, s50, 30720
 v_mfma_f32_16x16x32_bf16 v[80:83], v[156:159], a[132:135], v[80:83]
 v_mfma_f32_16x16x32_bf16 v[84:87], v[156:159], a[140:143], v[84:87]
 s_add_u32 s3, s28, 229504
 v_mov_b32 v144, 1.0
 v_mfma_f32_16x16x32_bf16 v[84:87], v[152:155], a[136:139], v[84:87]
 buffer_load_dwordx4 v8, s[8:11], s3 offen lds
 v_mfma_f32_16x16x32_bf16 v[88:91], v[152:155], a[144:147], v[88:91]
 s_add_u32 m0, s50, 31744
 v_mov_b32 v145, 1.0
 v_mfma_f32_16x16x32_bf16 v[88:91], v[156:159], a[148:151], v[88:91]
 s_add_u32 s3, s28, 245888
 v_mov_b32 v146, 1.0
 v_mfma_f32_16x16x32_bf16 v[92:95], v[156:159], a[156:159], v[92:95]
 buffer_load_dwordx4 v8, s[8:11], s3 offen lds
 v_mfma_f32_16x16x32_bf16 v[92:95], v[152:155], a[152:155], v[92:95]
 v_mov_b32 v147, 1.0
 v_mfma_f32_16x16x32_bf16 v[96:99], v[152:155], a[160:163], v[96:99]
 v_mov_b32 v148, 1.0
 v_mfma_f32_16x16x32_bf16 v[96:99], v[156:159], a[164:167], v[96:99]
 v_mfma_f32_16x16x32_bf16 v[100:103], v[156:159], a[172:175], v[100:103]
 v_mov_b32 v149, 1.0
 v_mfma_f32_16x16x32_bf16 v[100:103], v[152:155], a[168:171], v[100:103]
 v_mov_b32 v150, 1.0
 v_mfma_f32_16x16x32_bf16 v[104:107], v[152:155], a[176:179], v[104:107]
 v_mfma_f32_16x16x32_bf16 v[104:107], v[156:159], a[180:183], v[104:107]
 v_mov_b32 v151, 1.0
 v_mfma_f32_16x16x32_bf16 v[108:111], v[156:159], a[188:191], v[108:111]
 v_mfma_f32_16x16x32_bf16 v[108:111], v[152:155], a[184:187], v[108:111]
 v_mfma_f32_16x16x32_bf16 a[244:247], v[160:163], a[184:187], a[244:247]
 ds_read_b128 a[184:187], v1 offset:61440
 v_mfma_f32_16x16x32_bf16 a[244:247], v[164:167], a[188:191], a[244:247]
 ds_read_b128 a[188:191], v1 offset:62464
 v_mfma_f32_16x16x32_bf16 a[240:243], v[164:167], a[180:183], a[240:243]
 ds_read_b128 a[180:183], v1 offset:58368
 v_mov_b32 v152, 1.0
 v_mfma_f32_16x16x32_bf16 a[240:243], v[160:163], a[176:179], a[240:243]
 ds_read_b128 a[176:179], v1 offset:57344
 v_mfma_f32_16x16x32_bf16 v[132:135], v[160:163], a[168:171], v[132:135]
 ds_read_b128 a[168:171], v1 offset:53248
 v_mov_b32 v153, 1.0
 v_mfma_f32_16x16x32_bf16 v[132:135], v[164:167], a[172:175], v[132:135]
 ds_read_b128 a[172:175], v1 offset:54272
 v_mov_b32 v154, 1.0
 v_mfma_f32_16x16x32_bf16 v[128:131], v[164:167], a[164:167], v[128:131]
 ds_read_b128 a[164:167], v1 offset:50176
 v_mfma_f32_16x16x32_bf16 v[128:131], v[160:163], a[160:163], v[128:131]
 ds_read_b128 a[160:163], v1 offset:49152
 v_mov_b32 v155, 1.0
 v_mfma_f32_16x16x32_bf16 v[124:127], v[160:163], a[152:155], v[124:127]
 ds_read_b128 a[152:155], v1 offset:45056
 v_mov_b32 v156, 1.0
 v_mfma_f32_16x16x32_bf16 v[124:127], v[164:167], a[156:159], v[124:127]
 ds_read_b128 a[156:159], v1 offset:46080
 v_mfma_f32_16x16x32_bf16 v[120:123], v[164:167], a[148:151], v[120:123]
 ds_read_b128 a[148:151], v1 offset:41984
 v_mov_b32 v157, 1.0
 v_mfma_f32_16x16x32_bf16 v[120:123], v[160:163], a[144:147], v[120:123]
 ds_read_b128 a[144:147], v1 offset:40960
 v_mov_b32 v158, 1.0
 v_mfma_f32_16x16x32_bf16 v[116:119], v[160:163], a[136:139], v[116:119]
 ds_read_b128 a[136:139], v1 offset:36864
 v_mfma_f32_16x16x32_bf16 v[116:119], v[164:167], a[140:143], v[116:119]
 ds_read_b128 a[140:143], v1 offset:37888
 v_mov_b32 v159, 1.0
 v_mfma_f32_16x16x32_bf16 v[112:115], v[164:167], a[132:135], v[112:115]
 ds_read_b128 a[132:135], v1 offset:33792
 v_mfma_f32_16x16x32_bf16 v[112:115], v[160:163], a[128:131], v[112:115]
 ds_read_b128 a[128:131], v1 offset:32768
 s_waitcnt lgkmcnt(8)
 v_mfma_f32_16x16x32_bf16 v[44:47], v[168:171], a[184:187], v[44:47]
 v_mfma_f32_16x16x32_bf16 v[44:47], v[172:175], a[188:191], v[44:47]
 v_mfma_f32_16x16x32_bf16 v[40:43], v[172:175], a[180:183], v[40:43]
 v_mov_b32 v160, 1.0
 v_mfma_f32_16x16x32_bf16 v[40:43], v[168:171], a[176:179], v[40:43]
 v_mfma_f32_16x16x32_bf16 v[36:39], v[168:171], a[168:171], v[36:39]
 v_mov_b32 v161, 1.0
 v_mfma_f32_16x16x32_bf16 v[36:39], v[172:175], a[172:175], v[36:39]
 v_mov_b32 v162, 1.0
 v_mfma_f32_16x16x32_bf16 v[32:35], v[172:175], a[164:167], v[32:35]
 v_mfma_f32_16x16x32_bf16 v[32:35], v[168:171], a[160:163], v[32:35]
 v_mov_b32 v163, 1.0
 s_waitcnt lgkmcnt(0)
 v_mfma_f32_16x16x32_bf16 v[28:31], v[168:171], a[152:155], v[28:31]
 v_mov_b32 v164, 1.0
 v_mfma_f32_16x16x32_bf16 v[28:31], v[172:175], a[156:159], v[28:31]
 v_mfma_f32_16x16x32_bf16 v[24:27], v[172:175], a[148:151], v[24:27]
 v_mov_b32 v165, 1.0
 v_mfma_f32_16x16x32_bf16 v[24:27], v[168:171], a[144:147], v[24:27]
 v_mov_b32 v166, 1.0
 v_mfma_f32_16x16x32_bf16 v[20:23], v[168:171], a[136:139], v[20:23]
 v_mfma_f32_16x16x32_bf16 v[20:23], v[172:175], a[140:143], v[20:23]
 v_mov_b32 v167, 1.0
 v_mfma_f32_16x16x32_bf16 v[16:19], v[172:175], a[132:135], v[16:19]
 v_mfma_f32_16x16x32_bf16 v[16:19], v[168:171], a[128:131], v[16:19]
 v_mfma_f32_16x16x32_bf16 v[48:51], v[176:179], a[128:131], v[48:51]
 v_mfma_f32_16x16x32_bf16 v[48:51], v[180:183], a[132:135], v[48:51]
 v_mfma_f32_16x16x32_bf16 v[52:55], v[180:183], a[140:143], v[52:55]
 v_mov_b32 v168, 1.0
 v_mfma_f32_16x16x32_bf16 v[52:55], v[176:179], a[136:139], v[52:55]
 v_mfma_f32_16x16x32_bf16 v[56:59], v[176:179], a[144:147], v[56:59]
 v_mov_b32 v169, 1.0
 v_mfma_f32_16x16x32_bf16 v[56:59], v[180:183], a[148:151], v[56:59]
 v_mov_b32 v170, 1.0
 v_mfma_f32_16x16x32_bf16 v[60:63], v[180:183], a[156:159], v[60:63]
 v_mfma_f32_16x16x32_bf16 v[60:63], v[176:179], a[152:155], v[60:63]
 v_mov_b32 v171, 1.0
 v_mfma_f32_16x16x32_bf16 v[64:67], v[176:179], a[160:163], v[64:67]
 v_mov_b32 v172, 1.0
 v_mfma_f32_16x16x32_bf16 v[64:67], v[180:183], a[164:167], v[64:67]
 v_mfma_f32_16x16x32_bf16 v[68:71], v[180:183], a[172:175], v[68:71]
 v_mov_b32 v173, 1.0
 v_mfma_f32_16x16x32_bf16 v[68:71], v[176:179], a[168:171], v[68:71]
 v_mov_b32 v174, 1.0
 v_mfma_f32_16x16x32_bf16 v[72:75], v[176:179], a[176:179], v[72:75]
 v_mfma_f32_16x16x32_bf16 v[72:75], v[180:183], a[180:183], v[72:75]
 v_mov_b32 v175, 1.0
 v_mfma_f32_16x16x32_bf16 v[76:79], v[180:183], a[188:191], v[76:79]
 v_mfma_f32_16x16x32_bf16 v[76:79], v[176:179], a[184:187], v[76:79]
 v_mfma_f32_16x16x32_bf16 v[108:111], v[184:187], a[184:187], v[108:111]
 v_mfma_f32_16x16x32_bf16 v[108:111], v[188:191], a[188:191], v[108:111]
 v_mfma_f32_16x16x32_bf16 v[104:107], v[188:191], a[180:183], v[104:107]
 v_mov_b32 v176, 1.0
 v_mfma_f32_16x16x32_bf16 v[104:107], v[184:187], a[176:179], v[104:107]
 v_mfma_f32_16x16x32_bf16 v[100:103], v[184:187], a[168:171], v[100:103]
 v_mov_b32 v177, 1.0
 v_mfma_f32_16x16x32_bf16 v[100:103], v[188:191], a[172:175], v[100:103]
 v_mov_b32 v178, 1.0
 v_mfma_f32_16x16x32_bf16 v[96:99], v[188:191], a[164:167], v[96:99]
 v_mfma_f32_16x16x32_bf16 v[96:99], v[184:187], a[160:163], v[96:99]
 v_mov_b32 v179, 1.0
 v_mfma_f32_16x16x32_bf16 v[92:95], v[184:187], a[152:155], v[92:95]
 v_mov_b32 v180, 1.0
 v_mfma_f32_16x16x32_bf16 v[92:95], v[188:191], a[156:159], v[92:95]
 v_mfma_f32_16x16x32_bf16 v[88:91], v[188:191], a[148:151], v[88:91]
 v_mov_b32 v181, 1.0
 v_mfma_f32_16x16x32_bf16 v[88:91], v[184:187], a[144:147], v[88:91]
 v_mov_b32 v182, 1.0
 v_mfma_f32_16x16x32_bf16 v[84:87], v[184:187], a[136:139], v[84:87]
 v_mfma_f32_16x16x32_bf16 v[84:87], v[188:191], a[140:143], v[84:87]
 v_mov_b32 v183, 1.0
 v_mfma_f32_16x16x32_bf16 v[80:83], v[188:191], a[132:135], v[80:83]
 v_mfma_f32_16x16x32_bf16 v[80:83], v[184:187], a[128:131], v[80:83]
 v_mfma_f32_16x16x32_bf16 v[112:115], v[192:195], a[128:131], v[112:115]
 ds_read_b128 a[128:131], v2
 v_mfma_f32_16x16x32_bf16 v[112:115], v[196:199], a[132:135], v[112:115]
 ds_read_b128 a[132:135], v2 offset:1024
 v_mfma_f32_16x16x32_bf16 v[116:119], v[196:199], a[140:143], v[116:119]
 ds_read_b128 a[140:143], v2 offset:5120
 v_mov_b32 v184, 1.0
 v_mfma_f32_16x16x32_bf16 v[116:119], v[192:195], a[136:139], v[116:119]
 ds_read_b128 a[136:139], v2 offset:4096
 v_mfma_f32_16x16x32_bf16 v[120:123], v[192:195], a[144:147], v[120:123]
 ds_read_b128 a[144:147], v2 offset:8192
 v_mov_b32 v185, 1.0
 v_mfma_f32_16x16x32_bf16 v[120:123], v[196:199], a[148:151], v[120:123]
 ds_read_b128 a[148:151], v2 offset:9216
 v_mov_b32 v186, 1.0
 v_mfma_f32_16x16x32_bf16 v[124:127], v[196:199], a[156:159], v[124:127]
 ds_read_b128 a[156:159], v2 offset:13312
 v_mfma_f32_16x16x32_bf16 v[124:127], v[192:195], a[152:155], v[124:127]
 ds_read_b128 a[152:155], v2 offset:12288
 v_mov_b32 v187, 1.0
 v_mfma_f32_16x16x32_bf16 v[128:131], v[192:195], a[160:163], v[128:131]
 ds_read_b128 a[160:163], v2 offset:16384
 v_mov_b32 v188, 1.0
 v_mfma_f32_16x16x32_bf16 v[128:131], v[196:199], a[164:167], v[128:131]
 ds_read_b128 a[164:167], v2 offset:17408
 v_mfma_f32_16x16x32_bf16 v[132:135], v[196:199], a[172:175], v[132:135]
 ds_read_b128 a[172:175], v2 offset:21504
 v_mov_b32 v189, 1.0
 v_mfma_f32_16x16x32_bf16 v[132:135], v[192:195], a[168:171], v[132:135]
 ds_read_b128 a[168:171], v2 offset:20480
 v_mov_b32 v190, 1.0
 v_mfma_f32_16x16x32_bf16 a[240:243], v[192:195], a[176:179], a[240:243]
 ds_read_b128 a[176:179], v2 offset:24576
 v_mfma_f32_16x16x32_bf16 a[240:243], v[196:199], a[180:183], a[240:243]
 ds_read_b128 a[180:183], v2 offset:25600
 v_mov_b32 v191, 1.0
 v_mfma_f32_16x16x32_bf16 a[244:247], v[196:199], a[188:191], a[244:247]
 ds_read_b128 a[188:191], v2 offset:29696
 v_mfma_f32_16x16x32_bf16 a[244:247], v[192:195], a[184:187], a[244:247]
 ds_read_b128 a[184:187], v2 offset:28672
 s_waitcnt lgkmcnt(8)
 v_mfma_f32_16x16x32_bf16 v[16:19], v[200:203], a[128:131], v[16:19]
 v_mfma_f32_16x16x32_bf16 v[16:19], v[204:207], a[132:135], v[16:19]
 v_mfma_f32_16x16x32_bf16 v[20:23], v[204:207], a[140:143], v[20:23]
 v_mov_b32 v192, 1.0
 v_mfma_f32_16x16x32_bf16 v[20:23], v[200:203], a[136:139], v[20:23]
 v_mfma_f32_16x16x32_bf16 v[24:27], v[200:203], a[144:147], v[24:27]
 v_mov_b32 v193, 1.0
 v_mfma_f32_16x16x32_bf16 v[24:27], v[204:207], a[148:151], v[24:27]
 v_mov_b32 v194, 1.0
 v_mfma_f32_16x16x32_bf16 v[28:31], v[204:207], a[156:159], v[28:31]
 v_mfma_f32_16x16x32_bf16 v[28:31], v[200:203], a[152:155], v[28:31]
 v_mov_b32 v195, 1.0
 s_waitcnt lgkmcnt(0)
 v_mfma_f32_16x16x32_bf16 v[32:35], v[200:203], a[160:163], v[32:35]
 v_mov_b32 v196, 1.0
 v_mfma_f32_16x16x32_bf16 v[32:35], v[204:207], a[164:167], v[32:35]
 v_mfma_f32_16x16x32_bf16 v[36:39], v[204:207], a[172:175], v[36:39]
 v_mov_b32 v197, 1.0
 v_mfma_f32_16x16x32_bf16 v[36:39], v[200:203], a[168:171], v[36:39]
 v_mov_b32 v198, 1.0
 v_mfma_f32_16x16x32_bf16 v[40:43], v[200:203], a[176:179], v[40:43]
 v_mfma_f32_16x16x32_bf16 v[40:43], v[204:207], a[180:183], v[40:43]
 v_mov_b32 v199, 1.0
 v_mfma_f32_16x16x32_bf16 v[44:47], v[204:207], a[188:191], v[44:47]
 v_mfma_f32_16x16x32_bf16 v[44:47], v[200:203], a[184:187], v[44:47]
 v_mfma_f32_16x16x32_bf16 v[76:79], v[208:211], a[184:187], v[76:79]
 v_mfma_f32_16x16x32_bf16 v[76:79], v[212:215], a[188:191], v[76:79]
 v_mfma_f32_16x16x32_bf16 v[72:75], v[212:215], a[180:183], v[72:75]
 v_mov_b32 v200, 1.0
 v_mfma_f32_16x16x32_bf16 v[72:75], v[208:211], a[176:179], v[72:75]
 v_mfma_f32_16x16x32_bf16 v[68:71], v[208:211], a[168:171], v[68:71]
 v_mov_b32 v201, 1.0
 v_mfma_f32_16x16x32_bf16 v[68:71], v[212:215], a[172:175], v[68:71]
 v_mov_b32 v202, 1.0
 v_mfma_f32_16x16x32_bf16 v[64:67], v[212:215], a[164:167], v[64:67]
 v_mfma_f32_16x16x32_bf16 v[64:67], v[208:211], a[160:163], v[64:67]
 v_mov_b32 v203, 1.0
 v_mfma_f32_16x16x32_bf16 v[60:63], v[208:211], a[152:155], v[60:63]
 v_mov_b32 v204, 1.0
 v_mfma_f32_16x16x32_bf16 v[60:63], v[212:215], a[156:159], v[60:63]
 v_mfma_f32_16x16x32_bf16 v[56:59], v[212:215], a[148:151], v[56:59]
 v_mov_b32 v205, 1.0
 v_mfma_f32_16x16x32_bf16 v[56:59], v[208:211], a[144:147], v[56:59]
 v_mov_b32 v206, 1.0
 v_mfma_f32_16x16x32_bf16 v[52:55], v[208:211], a[136:139], v[52:55]
 v_mfma_f32_16x16x32_bf16 v[52:55], v[212:215], a[140:143], v[52:55]
 v_mov_b32 v207, 1.0
 v_mfma_f32_16x16x32_bf16 v[48:51], v[212:215], a[132:135], v[48:51]
 v_mfma_f32_16x16x32_bf16 v[48:51], v[208:211], a[128:131], v[48:51]
 v_mfma_f32_16x16x32_bf16 v[80:83], a[224:227], a[128:131], v[80:83]
 v_mfma_f32_16x16x32_bf16 v[80:83], a[228:231], a[132:135], v[80:83]
 v_mfma_f32_16x16x32_bf16 v[84:87], a[228:231], a[140:143], v[84:87]
 v_mov_b32 v208, 1.0
 s_waitcnt vmcnt(16)
 v_cmp_gt_i32 vcc, s27, v4
 s_and_b64 vcc, exec, vcc
 s_cbranch_vccnz Lspin_pro
Lok_pro:
 s_add_u32 s27, s27, 64
 v_mfma_f32_16x16x32_bf16 v[84:87], a[224:227], a[136:139], v[84:87]
 v_mfma_f32_16x16x32_bf16 v[88:91], a[224:227], a[144:147], v[88:91]
 v_mov_b32 v209, 1.0
 v_mfma_f32_16x16x32_bf16 v[88:91], a[228:231], a[148:151], v[88:91]
 v_mov_b32 v210, 1.0
 v_mfma_f32_16x16x32_bf16 v[92:95], a[228:231], a[156:159], v[92:95]
 v_mfma_f32_16x16x32_bf16 v[92:95], a[224:227], a[152:155], v[92:95]
 v_mov_b32 v211, 1.0
 v_mfma_f32_16x16x32_bf16 v[96:99], a[224:227], a[160:163], v[96:99]
 v_mov_b32 v212, 1.0
 v_mfma_f32_16x16x32_bf16 v[96:99], a[228:231], a[164:167], v[96:99]
 v_mfma_f32_16x16x32_bf16 v[100:103], a[228:231], a[172:175], v[100:103]
 v_mov_b32 v213, 1.0
 v_mfma_f32_16x16x32_bf16 v[100:103], a[224:227], a[168:171], v[100:103]
 v_mov_b32 v214, 1.0
 v_mfma_f32_16x16x32_bf16 v[104:107], a[224:227], a[176:179], v[104:107]
 v_mfma_f32_16x16x32_bf16 v[104:107], a[228:231], a[180:183], v[104:107]
 v_mov_b32 v215, 1.0
 v_mfma_f32_16x16x32_bf16 v[108:111], a[228:231], a[188:191], v[108:111]
 v_mfma_f32_16x16x32_bf16 v[108:111], a[224:227], a[184:187], v[108:111]
 v_mfma_f32_16x16x32_bf16 a[244:247], a[232:235], a[184:187], a[244:247]
 ds_read_b128 a[184:187], v2 offset:61440
 v_mfma_f32_16x16x32_bf16 a[244:247], a[236:239], a[188:191], a[244:247]
 global_load_dwordx4 a[228:231], v0, s[70:71] offset:-3072 sc1
 ds_read_b128 a[188:191], v2 offset:62464
 v_mfma_f32_16x16x32_bf16 a[240:243], a[236:239], a[180:183], a[240:243]
 ds_read_b128 a[180:183], v2 offset:58368
 v_mfma_f32_16x16x32_bf16 a[240:243], a[232:235], a[176:179], a[240:243]
 global_load_dwordx4 a[224:227], v0, s[70:71] offset:-4096 sc1
 ds_read_b128 a[176:179], v2 offset:57344
 v_mfma_f32_16x16x32_bf16 v[132:135], a[232:235], a[168:171], v[132:135]
 ds_read_b128 a[168:171], v2 offset:53248
 v_mfma_f32_16x16x32_bf16 v[132:135], a[236:239], a[172:175], v[132:135]
 ds_read_b128 a[172:175], v2 offset:54272
 v_mfma_f32_16x16x32_bf16 v[128:131], a[236:239], a[164:167], v[128:131]
 ds_read_b128 a[164:167], v2 offset:50176
 v_mfma_f32_16x16x32_bf16 v[128:131], a[232:235], a[160:163], v[128:131]
 ds_read_b128 a[160:163], v2 offset:49152
 v_mfma_f32_16x16x32_bf16 v[124:127], a[232:235], a[152:155], v[124:127]
 ds_read_b128 a[152:155], v2 offset:45056
 v_mfma_f32_16x16x32_bf16 v[124:127], a[236:239], a[156:159], v[124:127]
 ds_read_b128 a[156:159], v2 offset:46080
 v_mfma_f32_16x16x32_bf16 v[120:123], a[236:239], a[148:151], v[120:123]
 ds_read_b128 a[148:151], v2 offset:41984
 v_mfma_f32_16x16x32_bf16 v[120:123], a[232:235], a[144:147], v[120:123]
 ds_read_b128 a[144:147], v2 offset:40960
 v_mfma_f32_16x16x32_bf16 v[116:119], a[232:235], a[136:139], v[116:119]
 ds_read_b128 a[136:139], v2 offset:36864
 v_mfma_f32_16x16x32_bf16 v[116:119], a[236:239], a[140:143], v[116:119]
 ds_read_b128 a[140:143], v2 offset:37888
 v_mfma_f32_16x16x32_bf16 v[112:115], a[236:239], a[132:135], v[112:115]
 ds_read_b128 a[132:135], v2 offset:33792
 v_mfma_f32_16x16x32_bf16 v[112:115], a[232:235], a[128:131], v[112:115]
 ds_read_b128 a[128:131], v2 offset:32768
 s_waitcnt lgkmcnt(8)
 v_mfma_f32_16x16x32_bf16 v[44:47], a[192:195], a[184:187], v[44:47]
 v_mfma_f32_16x16x32_bf16 v[44:47], a[196:199], a[188:191], v[44:47]
 global_load_dwordx4 a[236:239], v0, s[70:71] offset:-1024 sc1
 v_mfma_f32_16x16x32_bf16 v[40:43], a[196:199], a[180:183], v[40:43]
 v_mfma_f32_16x16x32_bf16 v[40:43], a[192:195], a[176:179], v[40:43]
 global_load_dwordx4 a[232:235], v0, s[70:71] offset:-2048 sc1
 v_mfma_f32_16x16x32_bf16 v[36:39], a[192:195], a[168:171], v[36:39]
 v_mfma_f32_16x16x32_bf16 v[36:39], a[196:199], a[172:175], v[36:39]
 v_mfma_f32_16x16x32_bf16 v[32:35], a[196:199], a[164:167], v[32:35]
 v_mfma_f32_16x16x32_bf16 v[32:35], a[192:195], a[160:163], v[32:35]
 s_waitcnt lgkmcnt(0)
 v_mfma_f32_16x16x32_bf16 v[28:31], a[192:195], a[152:155], v[28:31]
 v_mfma_f32_16x16x32_bf16 v[28:31], a[196:199], a[156:159], v[28:31]
 v_mfma_f32_16x16x32_bf16 v[24:27], a[196:199], a[148:151], v[24:27]
 v_mfma_f32_16x16x32_bf16 v[24:27], a[192:195], a[144:147], v[24:27]
 v_mfma_f32_16x16x32_bf16 v[20:23], a[192:195], a[136:139], v[20:23]
 v_mfma_f32_16x16x32_bf16 v[20:23], a[196:199], a[140:143], v[20:23]
 v_mfma_f32_16x16x32_bf16 v[16:19], a[196:199], a[132:135], v[16:19]
 v_mfma_f32_16x16x32_bf16 v[16:19], a[192:195], a[128:131], v[16:19]
 v_mfma_f32_16x16x32_bf16 v[48:51], a[200:203], a[128:131], v[48:51]
 v_mfma_f32_16x16x32_bf16 v[48:51], a[204:207], a[132:135], v[48:51]
 global_load_dwordx4 a[196:199], v0, s[70:71] offset:1024 sc1
 v_mfma_f32_16x16x32_bf16 v[52:55], a[204:207], a[140:143], v[52:55]
 v_mfma_f32_16x16x32_bf16 v[52:55], a[200:203], a[136:139], v[52:55]
 global_load_dwordx4 a[192:195], v0, s[70:71] offset:0 sc1
 v_mfma_f32_16x16x32_bf16 v[56:59], a[200:203], a[144:147], v[56:59]
 v_mfma_f32_16x16x32_bf16 v[56:59], a[204:207], a[148:151], v[56:59]
 v_mfma_f32_16x16x32_bf16 v[60:63], a[204:207], a[156:159], v[60:63]
 v_mfma_f32_16x16x32_bf16 v[60:63], a[200:203], a[152:155], v[60:63]
 v_mfma_f32_16x16x32_bf16 v[64:67], a[200:203], a[160:163], v[64:67]
 v_mfma_f32_16x16x32_bf16 v[64:67], a[204:207], a[164:167], v[64:67]
 v_mfma_f32_16x16x32_bf16 v[68:71], a[204:207], a[172:175], v[68:71]
 v_mfma_f32_16x16x32_bf16 v[68:71], a[200:203], a[168:171], v[68:71]
 v_mfma_f32_16x16x32_bf16 v[72:75], a[200:203], a[176:179], v[72:75]
 v_mfma_f32_16x16x32_bf16 v[72:75], a[204:207], a[180:183], v[72:75]
 v_mfma_f32_16x16x32_bf16 v[76:79], a[204:207], a[188:191], v[76:79]
 v_mfma_f32_16x16x32_bf16 v[76:79], a[200:203], a[184:187], v[76:79]
 v_mfma_f32_16x16x32_bf16 v[108:111], a[208:211], a[184:187], v[108:111]
 v_mfma_f32_16x16x32_bf16 v[108:111], a[212:215], a[188:191], v[108:111]
 global_load_dwordx4 a[204:207], v0, s[70:71] offset:3072 sc1
 v_mfma_f32_16x16x32_bf16 v[104:107], a[212:215], a[180:183], v[104:107]
 v_mfma_f32_16x16x32_bf16 v[104:107], a[208:211], a[176:179], v[104:107]
 global_load_dwordx4 a[200:203], v0, s[70:71] offset:2048 sc1
 v_mfma_f32_16x16x32_bf16 v[100:103], a[208:211], a[168:171], v[100:103]
 s_add_u32 s70, s70, 8192
 s_addc_u32 s71, s71, 0
 v_mfma_f32_16x16x32_bf16 v[100:103], a[212:215], a[172:175], v[100:103]
 v_mfma_f32_16x16x32_bf16 v[96:99], a[212:215], a[164:167], v[96:99]
 v_mfma_f32_16x16x32_bf16 v[96:99], a[208:211], a[160:163], v[96:99]
 v_mfma_f32_16x16x32_bf16 v[92:95], a[208:211], a[152:155], v[92:95]
 v_mfma_f32_16x16x32_bf16 v[92:95], a[212:215], a[156:159], v[92:95]
 v_mfma_f32_16x16x32_bf16 v[88:91], a[212:215], a[148:151], v[88:91]
 v_mfma_f32_16x16x32_bf16 v[88:91], a[208:211], a[144:147], v[88:91]
 v_mfma_f32_16x16x32_bf16 v[84:87], a[208:211], a[136:139], v[84:87]
 v_mfma_f32_16x16x32_bf16 v[84:87], a[212:215], a[140:143], v[84:87]
 v_mfma_f32_16x16x32_bf16 v[80:83], a[212:215], a[132:135], v[80:83]
 v_mfma_f32_16x16x32_bf16 v[80:83], a[208:211], a[128:131], v[80:83]
 v_mfma_f32_16x16x32_bf16 v[112:115], a[216:219], a[128:131], v[112:115]
 v_mfma_f32_16x16x32_bf16 v[112:115], a[220:223], a[132:135], v[112:115]
 global_load_dwordx4 a[212:215], v0, s[70:71] offset:-3072 sc1
 v_mfma_f32_16x16x32_bf16 v[116:119], a[220:223], a[140:143], v[116:119]
 v_mfma_f32_16x16x32_bf16 v[116:119], a[216:219], a[136:139], v[116:119]
 global_load_dwordx4 a[208:211], v0, s[70:71] offset:-4096 sc1
 v_mfma_f32_16x16x32_bf16 v[120:123], a[216:219], a[144:147], v[120:123]
 v_mfma_f32_16x16x32_bf16 v[120:123], a[220:223], a[148:151], v[120:123]
 v_mfma_f32_16x16x32_bf16 v[124:127], a[220:223], a[156:159], v[124:127]
 v_mfma_f32_16x16x32_bf16 v[124:127], a[216:219], a[152:155], v[124:127]
 v_mfma_f32_16x16x32_bf16 v[128:131], a[216:219], a[160:163], v[128:131]
 v_mfma_f32_16x16x32_bf16 v[128:131], a[220:223], a[164:167], v[128:131]
 v_mfma_f32_16x16x32_bf16 v[132:135], a[220:223], a[172:175], v[132:135]
 v_mfma_f32_16x16x32_bf16 v[132:135], a[216:219], a[168:171], v[132:135]
 v_mfma_f32_16x16x32_bf16 a[240:243], a[216:219], a[176:179], a[240:243]
 v_mfma_f32_16x16x32_bf16 a[240:243], a[220:223], a[180:183], a[240:243]
 v_mfma_f32_16x16x32_bf16 a[244:247], a[220:223], a[188:191], a[244:247]
 global_load_dwordx4 a[220:223], v0, s[70:71] offset:-1024 sc1
 v_mfma_f32_16x16x32_bf16 a[244:247], a[216:219], a[184:187], a[244:247]
 global_load_dwordx4 a[216:219], v0, s[70:71] offset:-2048 sc1
 s_waitcnt vmcnt(10)
 v_mfma_f32_16x16x32_bf16 v[164:167], a[224:227], a[184:187], v[164:167]
 v_lshrrev_b32 v5, 4, v1
 v_mfma_f32_16x16x32_bf16 v[164:167], a[228:231], a[188:191], v[164:167]
 v_and_b32 v5, 48, v5
 v_mfma_f32_16x16x32_bf16 v[160:163], a[228:231], a[180:183], v[160:163]
 v_xor_b32 v5, v5, v1
 v_mfma_f32_16x16x32_bf16 v[160:163], a[224:227], a[176:179], v[160:163]
 v_and_b32 v5, 112, v5
 v_mfma_f32_16x16x32_bf16 v[156:159], a[224:227], a[168:171], v[156:159]
 v_and_b32 v6, 240, v1
 v_mfma_f32_16x16x32_bf16 v[156:159], a[228:231], a[172:175], v[156:159]
 v_lshl_add_u32 v5, v6, 3, v5
 v_mfma_f32_16x16x32_bf16 v[152:155], a[228:231], a[164:167], v[152:155]
 v_add_u32 v8, s50, v5
 v_mfma_f32_16x16x32_bf16 v[152:155], a[224:227], a[160:163], v[152:155]
 v_xor_b32 v9, 64, v8
 v_mfma_f32_16x16x32_bf16 v[148:151], a[224:227], a[152:155], v[148:151]
 v_mfma_f32_16x16x32_bf16 v[148:151], a[228:231], a[156:159], v[148:151]
 ds_read_b128 a[64:67], v8 offset:2048
 ds_read_b128 a[96:99], v9 offset:2048
 v_mfma_f32_16x16x32_bf16 v[144:147], a[228:231], a[148:151], v[144:147]
 v_mfma_f32_16x16x32_bf16 v[144:147], a[224:227], a[144:147], v[144:147]
 v_mfma_f32_16x16x32_bf16 v[140:143], a[224:227], a[136:139], v[140:143]
 v_mfma_f32_16x16x32_bf16 v[140:143], a[228:231], a[140:143], v[140:143]
 v_mfma_f32_16x16x32_bf16 v[136:139], a[228:231], a[132:135], v[136:139]
 ds_read_b128 a[68:71], v8 offset:6144
 v_mfma_f32_16x16x32_bf16 v[136:139], a[224:227], a[128:131], v[136:139]
 ds_read_b128 a[100:103], v9 offset:6144
 s_waitcnt vmcnt(8)
 v_mfma_f32_16x16x32_bf16 v[168:171], a[232:235], a[128:131], v[168:171]
 v_mfma_f32_16x16x32_bf16 v[168:171], a[236:239], a[132:135], v[168:171]
 global_load_dwordx4 a[228:231], v0, s[70:71] offset:1024 sc1
 v_mfma_f32_16x16x32_bf16 v[172:175], a[236:239], a[140:143], v[172:175]
 v_mfma_f32_16x16x32_bf16 v[172:175], a[232:235], a[136:139], v[172:175]
 global_load_dwordx4 a[224:227], v0, s[70:71] offset:0 sc1
 s_waitcnt lgkmcnt(2)
 v_mfma_f32_16x16x32_bf16 v[176:179], a[232:235], a[144:147], v[176:179]
 ds_write_b128 v3, a[64:67] offset:2048
 v_mfma_f32_16x16x32_bf16 v[176:179], a[236:239], a[148:151], v[176:179]
 ds_write_b128 v3, a[96:99] offset:3072
 v_mfma_f32_16x16x32_bf16 v[180:183], a[236:239], a[156:159], v[180:183]
 v_mfma_f32_16x16x32_bf16 v[180:183], a[232:235], a[152:155], v[180:183]
 ds_read_b128 a[72:75], v8 offset:10240
 v_mfma_f32_16x16x32_bf16 v[184:187], a[232:235], a[160:163], v[184:187]
 ds_read_b128 a[104:107], v9 offset:10240
 v_mfma_f32_16x16x32_bf16 v[184:187], a[236:239], a[164:167], v[184:187]
 v_mfma_f32_16x16x32_bf16 v[188:191], a[236:239], a[172:175], v[188:191]
 v_mfma_f32_16x16x32_bf16 v[188:191], a[232:235], a[168:171], v[188:191]
 v_mfma_f32_16x16x32_bf16 v[192:195], a[232:235], a[176:179], v[192:195]
 s_waitcnt lgkmcnt(4)
 v_mfma_f32_16x16x32_bf16 v[192:195], a[236:239], a[180:183], v[192:195]
 ds_write_b128 v3, a[68:71] offset:6144
 ds_write_b128 v3, a[100:103] offset:7168
 v_mfma_f32_16x16x32_bf16 v[196:199], a[236:239], a[188:191], v[196:199]
 v_mfma_f32_16x16x32_bf16 v[196:199], a[232:235], a[184:187], v[196:199]
 ds_read_b128 a[76:79], v8 offset:14336
 s_waitcnt vmcnt(8)
 v_mfma_f32_16x16x32_bf16 v[228:231], a[192:195], a[184:187], v[228:231]
 ds_read_b128 a[108:111], v9 offset:14336
 v_mfma_f32_16x16x32_bf16 v[228:231], a[196:199], a[188:191], v[228:231]
 global_load_dwordx4 a[236:239], v0, s[70:71] offset:3072 sc1
 v_mfma_f32_16x16x32_bf16 v[224:227], a[196:199], a[180:183], v[224:227]
 v_mfma_f32_16x16x32_bf16 v[224:227], a[192:195], a[176:179], v[224:227]
 global_load_dwordx4 a[232:235], v0, s[70:71] offset:2048 sc1
 v_mfma_f32_16x16x32_bf16 v[220:223], a[192:195], a[168:171], v[220:223]
 s_waitcnt lgkmcnt(4)
 s_add_u32 s70, s70, 8192
 s_addc_u32 s71, s71, 0
 v_mfma_f32_16x16x32_bf16 v[220:223], a[196:199], a[172:175], v[220:223]
 ds_write_b128 v3, a[72:75] offset:10240
 v_mfma_f32_16x16x32_bf16 v[216:219], a[196:199], a[164:167], v[216:219]
 ds_write_b128 v3, a[104:107] offset:11264
 v_mfma_f32_16x16x32_bf16 v[216:219], a[192:195], a[160:163], v[216:219]
 v_mfma_f32_16x16x32_bf16 v[212:215], a[192:195], a[152:155], v[212:215]
 ds_read_b128 a[80:83], v8 offset:18432
 v_mfma_f32_16x16x32_bf16 v[212:215], a[196:199], a[156:159], v[212:215]
 ds_read_b128 a[112:115], v9 offset:18432
 v_mfma_f32_16x16x32_bf16 v[208:211], a[196:199], a[148:151], v[208:211]
 v_mfma_f32_16x16x32_bf16 v[208:211], a[192:195], a[144:147], v[208:211]
 v_mfma_f32_16x16x32_bf16 v[204:207], a[192:195], a[136:139], v[204:207]
 s_waitcnt lgkmcnt(4)
 ds_write_b128 v3, a[76:79] offset:14336
 ds_write_b128 v3, a[108:111] offset:15360
 v_mfma_f32_16x16x32_bf16 v[204:207], a[196:199], a[140:143], v[204:207]
 v_mfma_f32_16x16x32_bf16 v[200:203], a[196:199], a[132:135], v[200:203]
 v_mfma_f32_16x16x32_bf16 v[200:203], a[192:195], a[128:131], v[200:203]
 s_waitcnt vmcnt(8)
 v_mfma_f32_16x16x32_bf16 v[232:235], a[200:203], a[128:131], v[232:235]
 ds_read_b128 a[128:131], v2
 ds_read_b128 a[84:87], v8 offset:22528
 v_mfma_f32_16x16x32_bf16 v[232:235], a[204:207], a[132:135], v[232:235]
 global_load_dwordx4 a[196:199], v0, s[70:71] offset:-3072 sc1
 ds_read_b128 a[132:135], v2 offset:1024
 v_mfma_f32_16x16x32_bf16 v[236:239], a[204:207], a[140:143], v[236:239]
 ds_read_b128 a[140:143], v2 offset:5120
 ds_read_b128 a[116:119], v9 offset:22528
 v_mfma_f32_16x16x32_bf16 v[236:239], a[200:203], a[136:139], v[236:239]
 global_load_dwordx4 a[192:195], v0, s[70:71] offset:-4096 sc1
 ds_read_b128 a[136:139], v2 offset:4096
 v_mfma_f32_16x16x32_bf16 v[240:243], a[200:203], a[144:147], v[240:243]
 ds_read_b128 a[144:147], v2 offset:8192
 v_mfma_f32_16x16x32_bf16 v[240:243], a[204:207], a[148:151], v[240:243]
 ds_read_b128 a[148:151], v2 offset:9216
 s_waitcnt lgkmcnt(10)
 v_mfma_f32_16x16x32_bf16 v[244:247], a[204:207], a[156:159], v[244:247]
 ds_read_b128 a[156:159], v2 offset:13312
 v_mfma_f32_16x16x32_bf16 v[244:247], a[200:203], a[152:155], v[244:247]
 ds_read_b128 a[152:155], v2 offset:12288
 v_mfma_f32_16x16x32_bf16 v[248:251], a[200:203], a[160:163], v[248:251]
 ds_read_b128 a[160:163], v2 offset:16384
 v_mfma_f32_16x16x32_bf16 v[248:251], a[204:207], a[164:167], v[248:251]
 ds_read_b128 a[164:167], v2 offset:17408
 v_mfma_f32_16x16x32_bf16 v[252:255], a[204:207], a[172:175], v[252:255]
 ds_read_b128 a[172:175], v2 offset:21504
 v_mfma_f32_16x16x32_bf16 v[252:255], a[200:203], a[168:171], v[252:255]
 ds_read_b128 a[168:171], v2 offset:20480
 v_mfma_f32_16x16x32_bf16 a[248:251], a[200:203], a[176:179], a[248:251]
 ds_read_b128 a[176:179], v2 offset:24576
 v_mfma_f32_16x16x32_bf16 a[248:251], a[204:207], a[180:183], a[248:251]
 ds_read_b128 a[180:183], v2 offset:25600
 v_mfma_f32_16x16x32_bf16 a[252:255], a[204:207], a[188:191], a[252:255]
 ds_read_b128 a[188:191], v2 offset:29696
 v_mfma_f32_16x16x32_bf16 a[252:255], a[200:203], a[184:187], a[252:255]
 ds_read_b128 a[184:187], v2 offset:28672
 ds_write_b128 v3, a[80:83] offset:18432
 ds_write_b128 v3, a[112:115] offset:19456
 ds_read_b128 a[88:91], v8 offset:26624
 ds_read_b128 a[120:123], v9 offset:26624
 s_waitcnt vmcnt(8) lgkmcnt(12)
 v_mfma_f32_16x16x32_bf16 v[136:139], a[208:211], a[128:131], v[136:139]
 v_mfma_f32_16x16x32_bf16 v[136:139], a[212:215], a[132:135], v[136:139]
 global_load_dwordx4 a[204:207], v0, s[70:71] offset:-1024 sc1
 v_mfma_f32_16x16x32_bf16 v[140:143], a[212:215], a[140:143], v[140:143]
 ds_write_b128 v3, a[84:87] offset:22528
 ds_write_b128 v3, a[116:119] offset:23552
 v_mfma_f32_16x16x32_bf16 v[140:143], a[208:211], a[136:139], v[140:143]
 global_load_dwordx4 a[200:203], v0, s[70:71] offset:-2048 sc1
 ds_read_b128 a[92:95], v8 offset:30720
 v_mfma_f32_16x16x32_bf16 v[144:147], a[208:211], a[144:147], v[144:147]
 ds_read_b128 a[124:127], v9 offset:30720
 v_mfma_f32_16x16x32_bf16 v[144:147], a[212:215], a[148:151], v[144:147]
 v_mfma_f32_16x16x32_bf16 v[148:151], a[212:215], a[156:159], v[148:151]
 v_mfma_f32_16x16x32_bf16 v[148:151], a[208:211], a[152:155], v[148:151]
 s_waitcnt lgkmcnt(4)
 ds_write_b128 v3, a[88:91] offset:26624
 v_mfma_f32_16x16x32_bf16 v[152:155], a[208:211], a[160:163], v[152:155]
 ds_write_b128 v3, a[120:123] offset:27648
 v_mfma_f32_16x16x32_bf16 v[152:155], a[212:215], a[164:167], v[152:155]
 v_mfma_f32_16x16x32_bf16 v[156:159], a[212:215], a[172:175], v[156:159]
 v_mfma_f32_16x16x32_bf16 v[156:159], a[208:211], a[168:171], v[156:159]
 v_mfma_f32_16x16x32_bf16 v[160:163], a[208:211], a[176:179], v[160:163]
 v_mfma_f32_16x16x32_bf16 v[160:163], a[212:215], a[180:183], v[160:163]
 s_waitcnt lgkmcnt(2)
 v_mfma_f32_16x16x32_bf16 v[164:167], a[212:215], a[188:191], v[164:167]
 ds_write_b128 v3, a[92:95] offset:30720
 v_mfma_f32_16x16x32_bf16 v[164:167], a[208:211], a[184:187], v[164:167]
 ds_write_b128 v3, a[124:127] offset:31744
 s_waitcnt vmcnt(8)
 v_mfma_f32_16x16x32_bf16 v[196:199], a[216:219], a[184:187], v[196:199]
 v_bfe_u32 v4, v3, 8, 2
 v_mfma_f32_16x16x32_bf16 v[196:199], a[220:223], a[188:191], v[196:199]
 global_load_dwordx4 a[212:215], v0, s[70:71] offset:1024 sc1
 v_lshl_add_u32 v4, v4, 5, s51
 v_mfma_f32_16x16x32_bf16 v[192:195], a[220:223], a[180:183], v[192:195]
 ds_read_b128 v[8:11], v4
 v_mfma_f32_16x16x32_bf16 v[192:195], a[216:219], a[176:179], v[192:195]
 global_load_dwordx4 a[208:211], v0, s[70:71] offset:0 sc1
 v_mfma_f32_16x16x32_bf16 v[188:191], a[216:219], a[168:171], v[188:191]
 v_mfma_f32_16x16x32_bf16 v[188:191], a[220:223], a[172:175], v[188:191]
 v_mfma_f32_16x16x32_bf16 v[184:187], a[220:223], a[164:167], v[184:187]
 v_mfma_f32_16x16x32_bf16 v[184:187], a[216:219], a[160:163], v[184:187]
 v_mfma_f32_16x16x32_bf16 v[180:183], a[216:219], a[152:155], v[180:183]
 v_mfma_f32_16x16x32_bf16 v[180:183], a[220:223], a[156:159], v[180:183]
 v_mfma_f32_16x16x32_bf16 v[176:179], a[220:223], a[148:151], v[176:179]
 v_mfma_f32_16x16x32_bf16 v[176:179], a[216:219], a[144:147], v[176:179]
 s_waitcnt lgkmcnt(0)
 v_add_f32 v16, v16, v8
 v_mfma_f32_16x16x32_bf16 v[172:175], a[216:219], a[136:139], v[172:175]
 ds_read_b128 v[12:15], v4 offset:16
 v_mfma_f32_16x16x32_bf16 v[172:175], a[220:223], a[140:143], v[172:175]
 v_add_f32 v17, v17, v9
 v_mfma_f32_16x16x32_bf16 v[168:171], a[220:223], a[132:135], v[168:171]
 v_add_f32 v18, v18, v10
 v_mfma_f32_16x16x32_bf16 v[168:171], a[216:219], a[128:131], v[168:171]
 v_add_f32 v19, v19, v11
 s_waitcnt vmcnt(8)
 v_mfma_f32_16x16x32_bf16 v[200:203], a[224:227], a[128:131], v[200:203]
 v_add_f32 v20, v20, v8
 v_mfma_f32_16x16x32_bf16 v[200:203], a[228:231], a[132:135], v[200:203]
 global_load_dwordx4 a[220:223], v0, s[70:71] offset:3072 sc1
 v_add_f32 v21, v21, v9
 v_mfma_f32_16x16x32_bf16 v[204:207], a[228:231], a[140:143], v[204:207]
 v_add_f32 v22, v22, v10
 v_mfma_f32_16x16x32_bf16 v[204:207], a[224:227], a[136:139], v[204:207]
 global_load_dwordx4 a[216:219], v0, s[70:71] offset:2048 sc1
 v_add_f32 v23, v23, v11
 v_mfma_f32_16x16x32_bf16 v[208:211], a[224:227], a[144:147], v[208:211]
 v_add_f32 v24, v24, v8
 s_add_u32 s70, s70, 8192
 s_addc_u32 s71, s71, 0
 v_mfma_f32_16x16x32_bf16 v[208:211], a[228:231], a[148:151], v[208:211]
 v_add_f32 v25, v25, v9
 v_mfma_f32_16x16x32_bf16 v[212:215], a[228:231], a[156:159], v[212:215]
 v_add_f32 v26, v26, v10
 v_mfma_f32_16x16x32_bf16 v[212:215], a[224:227], a[152:155], v[212:215]
 v_add_f32 v27, v27, v11
 v_mfma_f32_16x16x32_bf16 v[216:219], a[224:227], a[160:163], v[216:219]
 v_add_f32 v28, v28, v8
 v_mfma_f32_16x16x32_bf16 v[216:219], a[228:231], a[164:167], v[216:219]
 v_add_f32 v29, v29, v9
 v_mfma_f32_16x16x32_bf16 v[220:223], a[228:231], a[172:175], v[220:223]
 v_add_f32 v30, v30, v10
 v_mfma_f32_16x16x32_bf16 v[220:223], a[224:227], a[168:171], v[220:223]
 v_add_f32 v31, v31, v11
 v_add_f32 v32, v32, v8
 v_mfma_f32_16x16x32_bf16 v[224:227], a[224:227], a[176:179], v[224:227]
 v_add_f32 v33, v33, v9
 v_mfma_f32_16x16x32_bf16 v[224:227], a[228:231], a[180:183], v[224:227]
 v_add_f32 v34, v34, v10
 v_mfma_f32_16x16x32_bf16 v[228:231], a[228:231], a[188:191], v[228:231]
 v_add_f32 v35, v35, v11
 v_mfma_f32_16x16x32_bf16 v[228:231], a[224:227], a[184:187], v[228:231]
 v_add_f32 v36, v36, v8
 v_add_f32 v37, v37, v9
 s_waitcnt vmcnt(8)
 v_mfma_f32_16x16x32_bf16 a[252:255], a[232:235], a[184:187], a[252:255]
 ds_read_b128 a[184:187], v1 offset:61440
 v_add_f32 v38, v38, v10
 v_mfma_f32_16x16x32_bf16 a[252:255], a[236:239], a[188:191], a[252:255]
 global_load_dwordx4 a[228:231], v0, s[70:71] offset:-3072 sc1
 ds_read_b128 a[188:191], v1 offset:62464
 v_mfma_f32_16x16x32_bf16 a[248:251], a[236:239], a[180:183], a[248:251]
 ds_read_b128 a[180:183], v1 offset:58368
 v_add_f32 v39, v39, v11
 v_mfma_f32_16x16x32_bf16 a[248:251], a[232:235], a[176:179], a[248:251]
 global_load_dwordx4 a[224:227], v0, s[70:71] offset:-4096 sc1
 ds_read_b128 a[176:179], v1 offset:57344
 v_mfma_f32_16x16x32_bf16 v[252:255], a[232:235], a[168:171], v[252:255]
 ds_read_b128 a[168:171], v1 offset:53248
 v_add_f32 v40, v40, v8
 v_mfma_f32_16x16x32_bf16 v[252:255], a[236:239], a[172:175], v[252:255]
 ds_read_b128 a[172:175], v1 offset:54272
 v_add_f32 v41, v41, v9
 v_mfma_f32_16x16x32_bf16 v[248:251], a[236:239], a[164:167], v[248:251]
 ds_read_b128 a[164:167], v1 offset:50176
 v_add_f32 v42, v42, v10
 v_mfma_f32_16x16x32_bf16 v[248:251], a[232:235], a[160:163], v[248:251]
 ds_read_b128 a[160:163], v1 offset:49152
 v_add_f32 v43, v43, v11
 v_mfma_f32_16x16x32_bf16 v[244:247], a[232:235], a[152:155], v[244:247]
 ds_read_b128 a[152:155], v1 offset:45056
 v_add_f32 v44, v44, v8
 v_mfma_f32_16x16x32_bf16 v[244:247], a[236:239], a[156:159], v[244:247]
 ds_read_b128 a[156:159], v1 offset:46080
 v_add_f32 v45, v45, v9
 v_mfma_f32_16x16x32_bf16 v[240:243], a[236:239], a[148:151], v[240:243]
 ds_read_b128 a[148:151], v1 offset:41984
 v_add_f32 v46, v46, v10
 v_mfma_f32_16x16x32_bf16 v[240:243], a[232:235], a[144:147], v[240:243]
 ds_read_b128 a[144:147], v1 offset:40960
 v_add_f32 v47, v47, v11
 s_waitcnt lgkmcnt(12)
 v_mfma_f32_16x16x32_bf16 v[236:239], a[232:235], a[136:139], v[236:239]
 ds_read_b128 a[136:139], v1 offset:36864
 v_add_f32 v48, v48, v12
 v_mfma_f32_16x16x32_bf16 v[236:239], a[236:239], a[140:143], v[236:239]
 ds_read_b128 a[140:143], v1 offset:37888
 ds_read_b128 v[8:11], v4 offset:128
 v_mfma_f32_16x16x32_bf16 v[232:235], a[236:239], a[132:135], v[232:235]
 ds_read_b128 a[132:135], v1 offset:33792
 v_add_f32 v49, v49, v13
 v_mfma_f32_16x16x32_bf16 v[232:235], a[232:235], a[128:131], v[232:235]
 ds_read_b128 a[128:131], v1 offset:32768
 v_add_f32 v50, v50, v14
 s_waitcnt vmcnt(8) lgkmcnt(9)
 v_mfma_f32_16x16x32_bf16 v[164:167], a[192:195], a[184:187], v[164:167]
 v_add_f32 v51, v51, v15
 v_add_f32 v52, v52, v12
 v_mfma_f32_16x16x32_bf16 v[164:167], a[196:199], a[188:191], v[164:167]
 global_load_dwordx4 a[236:239], v0, s[70:71] offset:-1024 sc1
 v_add_f32 v53, v53, v13
 v_mfma_f32_16x16x32_bf16 v[160:163], a[196:199], a[180:183], v[160:163]
 v_add_f32 v54, v54, v14
 v_mfma_f32_16x16x32_bf16 v[160:163], a[192:195], a[176:179], v[160:163]
 global_load_dwordx4 a[232:235], v0, s[70:71] offset:-2048 sc1
 v_add_f32 v55, v55, v15
 v_mfma_f32_16x16x32_bf16 v[156:159], a[192:195], a[168:171], v[156:159]
 v_add_f32 v56, v56, v12
 v_mfma_f32_16x16x32_bf16 v[156:159], a[196:199], a[172:175], v[156:159]
 v_add_f32 v57, v57, v13
 v_mfma_f32_16x16x32_bf16 v[152:155], a[196:199], a[164:167], v[152:155]
 v_add_f32 v58, v58, v14
 v_mfma_f32_16x16x32_bf16 v[152:155], a[192:195], a[160:163], v[152:155]
 v_add_f32 v59, v59, v15
 s_waitcnt lgkmcnt(0)
 v_mfma_f32_16x16x32_bf16 v[148:151], a[192:195], a[152:155], v[148:151]
 v_add_f32 v60, v60, v12
 v_mfma_f32_16x16x32_bf16 v[148:151], a[196:199], a[156:159], v[148:151]
 v_add_f32 v61, v61, v13
 v_mfma_f32_16x16x32_bf16 v[144:147], a[196:199], a[148:151], v[144:147]
 v_add_f32 v62, v62, v14
 v_mfma_f32_16x16x32_bf16 v[144:147], a[192:195], a[144:147], v[144:147]
 v_add_f32 v63, v63, v15
 v_mfma_f32_16x16x32_bf16 v[140:143], a[192:195], a[136:139], v[140:143]
 v_add_f32 v64, v64, v12
 v_mfma_f32_16x16x32_bf16 v[140:143], a[196:199], a[140:143], v[140:143]
 v_add_f32 v65, v65, v13
 v_mfma_f32_16x16x32_bf16 v[136:139], a[196:199], a[132:135], v[136:139]
 v_add_f32 v66, v66, v14
 v_mfma_f32_16x16x32_bf16 v[136:139], a[192:195], a[128:131], v[136:139]
 v_add_f32 v67, v67, v15
 s_waitcnt vmcnt(8)
 v_mfma_f32_16x16x32_bf16 v[168:171], a[200:203], a[128:131], v[168:171]
 v_add_f32 v68, v68, v12
 v_mfma_f32_16x16x32_bf16 v[168:171], a[204:207], a[132:135], v[168:171]
 global_load_dwordx4 a[196:199], v0, s[70:71] offset:1024 sc1
 v_add_f32 v69, v69, v13
 v_mfma_f32_16x16x32_bf16 v[172:175], a[204:207], a[140:143], v[172:175]
 v_add_f32 v70, v70, v14
 v_add_f32 v71, v71, v15
 v_mfma_f32_16x16x32_bf16 v[172:175], a[200:203], a[136:139], v[172:175]
 global_load_dwordx4 a[192:195], v0, s[70:71] offset:0 sc1
 v_add_f32 v72, v72, v12
 v_mfma_f32_16x16x32_bf16 v[176:179], a[200:203], a[144:147], v[176:179]
 v_add_f32 v73, v73, v13
 v_mfma_f32_16x16x32_bf16 v[176:179], a[204:207], a[148:151], v[176:179]
 v_add_f32 v74, v74, v14
 v_mfma_f32_16x16x32_bf16 v[180:183], a[204:207], a[156:159], v[180:183]
 v_add_f32 v75, v75, v15
 v_mfma_f32_16x16x32_bf16 v[180:183], a[200:203], a[152:155], v[180:183]
 v_add_f32 v76, v76, v12
 v_mfma_f32_16x16x32_bf16 v[184:187], a[200:203], a[160:163], v[184:187]
 v_add_f32 v77, v77, v13
 v_mfma_f32_16x16x32_bf16 v[184:187], a[204:207], a[164:167], v[184:187]
 v_add_f32 v78, v78, v14
 v_mfma_f32_16x16x32_bf16 v[188:191], a[204:207], a[172:175], v[188:191]
 v_add_f32 v79, v79, v15
 v_mfma_f32_16x16x32_bf16 v[188:191], a[200:203], a[168:171], v[188:191]
 v_mfma_f32_16x16x32_bf16 v[192:195], a[200:203], a[176:179], v[192:195]
 v_add_f32 v80, v80, v8
 v_mfma_f32_16x16x32_bf16 v[192:195], a[204:207], a[180:183], v[192:195]
 ds_read_b128 v[12:15], v4 offset:144
 v_mfma_f32_16x16x32_bf16 v[196:199], a[204:207], a[188:191], v[196:199]
 v_add_f32 v81, v81, v9
 v_mfma_f32_16x16x32_bf16 v[196:199], a[200:203], a[184:187], v[196:199]
 v_add_f32 v82, v82, v10
 s_waitcnt vmcnt(8)
 v_mfma_f32_16x16x32_bf16 v[228:231], a[208:211], a[184:187], v[228:231]
 v_add_f32 v83, v83, v11
 v_mfma_f32_16x16x32_bf16 v[228:231], a[212:215], a[188:191], v[228:231]
 global_load_dwordx4 a[204:207], v0, s[70:71] offset:3072 sc1
 v_add_f32 v84, v84, v8
 v_mfma_f32_16x16x32_bf16 v[224:227], a[212:215], a[180:183], v[224:227]
 v_add_f32 v85, v85, v9
 v_mfma_f32_16x16x32_bf16 v[224:227], a[208:211], a[176:179], v[224:227]
 global_load_dwordx4 a[200:203], v0, s[70:71] offset:2048 sc1
 v_add_f32 v86, v86, v10
 v_mfma_f32_16x16x32_bf16 v[220:223], a[208:211], a[168:171], v[220:223]
 v_add_f32 v87, v87, v11
 s_add_u32 s70, s70, 8192
 s_addc_u32 s71, s71, 0
 v_mfma_f32_16x16x32_bf16 v[220:223], a[212:215], a[172:175], v[220:223]
 v_add_f32 v88, v88, v8
 v_add_f32 v89, v89, v9
 v_mfma_f32_16x16x32_bf16 v[216:219], a[212:215], a[164:167], v[216:219]
 v_add_f32 v90, v90, v10
 v_mfma_f32_16x16x32_bf16 v[216:219], a[208:211], a[160:163], v[216:219]
 v_add_f32 v91, v91, v11
 v_mfma_f32_16x16x32_bf16 v[212:215], a[208:211], a[152:155], v[212:215]
 v_add_f32 v92, v92, v8
 v_mfma_f32_16x16x32_bf16 v[212:215], a[212:215], a[156:159], v[212:215]
 v_add_f32 v93, v93, v9
 v_mfma_f32_16x16x32_bf16 v[208:211], a[212:215], a[148:151], v[208:211]
 v_add_f32 v94, v94, v10
 v_mfma_f32_16x16x32_bf16 v[208:211], a[208:211], a[144:147], v[208:211]
 v_add_f32 v95, v95, v11
 v_mfma_f32_16x16x32_bf16 v[204:207], a[208:211], a[136:139], v[204:207]
 v_add_f32 v96, v96, v8
 v_mfma_f32_16x16x32_bf16 v[204:207], a[212:215], a[140:143], v[204:207]
 v_add_f32 v97, v97, v9
 v_mfma_f32_16x16x32_bf16 v[200:203], a[212:215], a[132:135], v[200:203]
 v_add_f32 v98, v98, v10
 v_add_f32 v99, v99, v11
 v_mfma_f32_16x16x32_bf16 v[200:203], a[208:211], a[128:131], v[200:203]
 v_add_f32 v100, v100, v8
 v_add_f32 v101, v101, v9
 s_waitcnt vmcnt(8)
 v_mfma_f32_16x16x32_bf16 v[232:235], a[216:219], a[128:131], v[232:235]
 ds_read_b128 a[128:131], v1
 v_add_f32 v102, v102, v10
 v_mfma_f32_16x16x32_bf16 v[232:235], a[220:223], a[132:135], v[232:235]
 global_load_dwordx4 a[212:215], v0, s[70:71] offset:-3072 sc1
 ds_read_b128 a[132:135], v1 offset:1024
 v_mfma_f32_16x16x32_bf16 v[236:239], a[220:223], a[140:143], v[236:239]
 ds_read_b128 a[140:143], v1 offset:5120
 v_add_f32 v103, v103, v11
 v_mfma_f32_16x16x32_bf16 v[236:239], a[216:219], a[136:139], v[236:239]
 global_load_dwordx4 a[208:211], v0, s[70:71] offset:-4096 sc1
 ds_read_b128 a[136:139], v1 offset:4096
 v_mfma_f32_16x16x32_bf16 v[240:243], a[216:219], a[144:147], v[240:243]
 ds_read_b128 a[144:147], v1 offset:8192
 v_add_f32 v104, v104, v8
 v_mfma_f32_16x16x32_bf16 v[240:243], a[220:223], a[148:151], v[240:243]
 ds_read_b128 a[148:151], v1 offset:9216
 v_add_f32 v105, v105, v9
 v_mfma_f32_16x16x32_bf16 v[244:247], a[220:223], a[156:159], v[244:247]
 ds_read_b128 a[156:159], v1 offset:13312
 v_add_f32 v106, v106, v10
 v_mfma_f32_16x16x32_bf16 v[244:247], a[216:219], a[152:155], v[244:247]
 ds_read_b128 a[152:155], v1 offset:12288
 v_add_f32 v107, v107, v11
 v_mfma_f32_16x16x32_bf16 v[248:251], a[216:219], a[160:163], v[248:251]
 ds_read_b128 a[160:163], v1 offset:16384
 v_add_f32 v108, v108, v8
 v_mfma_f32_16x16x32_bf16 v[248:251], a[220:223], a[164:167], v[248:251]
 ds_read_b128 a[164:167], v1 offset:17408
 v_add_f32 v109, v109, v9
 v_mfma_f32_16x16x32_bf16 v[252:255], a[220:223], a[172:175], v[252:255]
 ds_read_b128 a[172:175], v1 offset:21504
 v_add_f32 v110, v110, v10
 v_mfma_f32_16x16x32_bf16 v[252:255], a[216:219], a[168:171], v[252:255]
 ds_read_b128 a[168:171], v1 offset:20480
 v_add_f32 v111, v111, v11
 s_waitcnt lgkmcnt(12)
 v_mfma_f32_16x16x32_bf16 a[248:251], a[216:219], a[176:179], a[248:251]
 ds_read_b128 a[176:179], v1 offset:24576
 v_add_f32 v112, v112, v12
 v_mfma_f32_16x16x32_bf16 a[248:251], a[220:223], a[180:183], a[248:251]
 ds_read_b128 a[180:183], v1 offset:25600
 v_add_f32 v113, v113, v13
 v_mfma_f32_16x16x32_bf16 a[252:255], a[220:223], a[188:191], a[252:255]
 ds_read_b128 a[188:191], v1 offset:29696
 v_add_f32 v114, v114, v14
 v_mfma_f32_16x16x32_bf16 a[252:255], a[216:219], a[184:187], a[252:255]
 ds_read_b128 a[184:187], v1 offset:28672
 v_add_f32 v115, v115, v15
 s_waitcnt vmcnt(8) lgkmcnt(8)
 v_mfma_f32_16x16x32_bf16 v[136:139], a[224:227], a[128:131], v[136:139]
 v_add_f32 v116, v116, v12
 v_mfma_f32_16x16x32_bf16 v[136:139], a[228:231], a[132:135], v[136:139]
 global_load_dwordx4 a[220:223], v0, s[70:71] offset:-1024 sc1
 v_add_f32 v117, v117, v13
 v_mfma_f32_16x16x32_bf16 v[140:143], a[228:231], a[140:143], v[140:143]
 v_add_f32 v118, v118, v14
 v_mfma_f32_16x16x32_bf16 v[140:143], a[224:227], a[136:139], v[140:143]
 global_load_dwordx4 a[216:219], v0, s[70:71] offset:-2048 sc1
 v_add_f32 v119, v119, v15
 v_mfma_f32_16x16x32_bf16 v[144:147], a[224:227], a[144:147], v[144:147]
 v_add_f32 v120, v120, v12
 v_mfma_f32_16x16x32_bf16 v[144:147], a[228:231], a[148:151], v[144:147]
 v_add_f32 v121, v121, v13
 v_mfma_f32_16x16x32_bf16 v[148:151], a[228:231], a[156:159], v[148:151]
 v_add_f32 v122, v122, v14
 v_mfma_f32_16x16x32_bf16 v[148:151], a[224:227], a[152:155], v[148:151]
 v_add_f32 v123, v123, v15
 s_waitcnt lgkmcnt(0)
 v_mfma_f32_16x16x32_bf16 v[152:155], a[224:227], a[160:163], v[152:155]
 v_add_f32 v124, v124, v12
 v_mfma_f32_16x16x32_bf16 v[152:155], a[228:231], a[164:167], v[152:155]
 v_add_f32 v125, v125, v13
 v_mfma_f32_16x16x32_bf16 v[156:159], a[228:231], a[172:175], v[156:159]
 v_add_f32 v126, v126, v14
 v_mfma_f32_16x16x32_bf16 v[156:159], a[224:227], a[168:171], v[156:159]
 v_add_f32 v127, v127, v15
 v_mfma_f32_16x16x32_bf16 v[160:163], a[224:227], a[176:179], v[160:163]
 v_add_f32 v128, v128, v12
 v_add_f32 v129, v129, v13
 v_mfma_f32_16x16x32_bf16 v[160:163], a[228:231], a[180:183], v[160:163]
 v_add_f32 v130, v130, v14
 v_mfma_f32_16x16x32_bf16 v[164:167], a[228:231], a[188:191], v[164:167]
 v_add_f32 v131, v131, v15
 v_mfma_f32_16x16x32_bf16 v[164:167], a[224:227], a[184:187], v[164:167]
 v_add_f32 v132, v132, v12
 s_waitcnt vmcnt(8)
 v_mfma_f32_16x16x32_bf16 v[196:199], a[232:235], a[184:187], v[196:199]
 v_add_f32 v133, v133, v13
 v_mfma_f32_16x16x32_bf16 v[196:199], a[236:239], a[188:191], v[196:199]
 global_load_dwordx4 a[228:231], v0, s[70:71] offset:1024 sc1
 v_add_f32 v134, v134, v14
 v_mfma_f32_16x16x32_bf16 v[192:195], a[236:239], a[180:183], v[192:195]
 v_add_f32 v135, v135, v15
 v_mfma_f32_16x16x32_bf16 v[192:195], a[232:235], a[176:179], v[192:195]
 global_load_dwordx4 a[224:227], v0, s[70:71] offset:0 sc1
 v_accvgpr_read_b32 v5, a240
 v_mfma_f32_16x16x32_bf16 v[188:191], a[232:235], a[168:171], v[188:191]
 v_add_f32 v5, v5, v12
 v_mfma_f32_16x16x32_bf16 v[188:191], a[236:239], a[172:175], v[188:191]
 v_accvgpr_write_b32 a240, v5
 v_mfma_f32_16x16x32_bf16 v[184:187], a[236:239], a[164:167], v[184:187]
 v_accvgpr_read_b32 v6, a241
 v_mfma_f32_16x16x32_bf16 v[184:187], a[232:235], a[160:163], v[184:187]
 v_add_f32 v6, v6, v13
 v_mfma_f32_16x16x32_bf16 v[180:183], a[232:235], a[152:155], v[180:183]
 v_accvgpr_write_b32 a241, v6
 v_mfma_f32_16x16x32_bf16 v[180:183], a[236:239], a[156:159], v[180:183]
 v_accvgpr_read_b32 v5, a242
 v_mfma_f32_16x16x32_bf16 v[176:179], a[236:239], a[148:151], v[176:179]
 v_add_f32 v5, v5, v14
 v_mfma_f32_16x16x32_bf16 v[176:179], a[232:235], a[144:147], v[176:179]
 v_accvgpr_write_b32 a242, v5
 v_mfma_f32_16x16x32_bf16 v[172:175], a[232:235], a[136:139], v[172:175]
 v_accvgpr_read_b32 v6, a243
 v_mfma_f32_16x16x32_bf16 v[172:175], a[236:239], a[140:143], v[172:175]
 v_add_f32 v6, v6, v15
 v_mfma_f32_16x16x32_bf16 v[168:171], a[236:239], a[132:135], v[168:171]
 v_accvgpr_write_b32 a243, v6
 v_mfma_f32_16x16x32_bf16 v[168:171], a[232:235], a[128:131], v[168:171]
 v_accvgpr_read_b32 v5, a244
 s_waitcnt vmcnt(8)
 v_mfma_f32_16x16x32_bf16 v[200:203], a[192:195], a[128:131], v[200:203]
 v_add_f32 v5, v5, v12
 v_accvgpr_write_b32 a244, v5
 v_mfma_f32_16x16x32_bf16 v[200:203], a[196:199], a[132:135], v[200:203]
 global_load_dwordx4 a[236:239], v0, s[70:71] offset:3072 sc1
 v_accvgpr_read_b32 v6, a245
 v_mfma_f32_16x16x32_bf16 v[204:207], a[196:199], a[140:143], v[204:207]
 v_add_f32 v6, v6, v13
 v_mfma_f32_16x16x32_bf16 v[204:207], a[192:195], a[136:139], v[204:207]
 global_load_dwordx4 a[232:235], v0, s[70:71] offset:2048 sc1
 v_accvgpr_write_b32 a245, v6
 v_mfma_f32_16x16x32_bf16 v[208:211], a[192:195], a[144:147], v[208:211]
 v_accvgpr_read_b32 v5, a246
 s_add_u32 s70, s70, 8192
 s_addc_u32 s71, s71, 0
 v_mfma_f32_16x16x32_bf16 v[208:211], a[196:199], a[148:151], v[208:211]
 v_add_f32 v5, v5, v14
 v_mfma_f32_16x16x32_bf16 v[212:215], a[196:199], a[156:159], v[212:215]
 v_accvgpr_write_b32 a246, v5
 v_mfma_f32_16x16x32_bf16 v[212:215], a[192:195], a[152:155], v[212:215]
 v_accvgpr_read_b32 v6, a247
 v_mfma_f32_16x16x32_bf16 v[216:219], a[192:195], a[160:163], v[216:219]
 v_add_f32 v6, v6, v15
 v_mfma_f32_16x16x32_bf16 v[216:219], a[196:199], a[164:167], v[216:219]
 v_accvgpr_write_b32 a247, v6
 v_mfma_f32_16x16x32_bf16 v[220:223], a[196:199], a[172:175], v[220:223]
 s_add_u32 s55, s55, 1
 s_waitcnt lgkmcnt(0)
 s_barrier
 v_mfma_f32_16x16x32_bf16 v[220:223], a[192:195], a[168:171], v[220:223]
 v_mfma_f32_16x16x32_bf16 v[224:227], a[192:195], a[176:179], v[224:227]
 v_mfma_f32_16x16x32_bf16 v[224:227], a[196:199], a[180:183], v[224:227]
 v_mfma_f32_16x16x32_bf16 v[228:231], a[196:199], a[188:191], v[228:231]
 v_mfma_f32_16x16x32_bf16 v[228:231], a[192:195], a[184:187], v[228:231]
 s_waitcnt vmcnt(8)
 v_mfma_f32_16x16x32_bf16 a[252:255], a[200:203], a[184:187], a[252:255]
 ds_read_b128 a[184:187], v1 offset:30720
 v_mfma_f32_16x16x32_bf16 a[252:255], a[204:207], a[188:191], a[252:255]
 global_load_dwordx4 a[196:199], v0, s[70:71] offset:-3072 sc1
 ds_read_b128 a[188:191], v1 offset:31744
 v_mfma_f32_16x16x32_bf16 a[248:251], a[204:207], a[180:183], a[248:251]
 ds_read_b128 a[180:183], v1 offset:27648
 v_mfma_f32_16x16x32_bf16 a[248:251], a[200:203], a[176:179], a[248:251]
 global_load_dwordx4 a[192:195], v0, s[70:71] offset:-4096 sc1
 ds_read_b128 a[176:179], v1 offset:26624
 v_mfma_f32_16x16x32_bf16 v[252:255], a[200:203], a[168:171], v[252:255]
 ds_read_b128 a[168:171], v1 offset:22528
 v_mfma_f32_16x16x32_bf16 v[252:255], a[204:207], a[172:175], v[252:255]
 ds_read_b128 a[172:175], v1 offset:23552
 v_mfma_f32_16x16x32_bf16 v[248:251], a[204:207], a[164:167], v[248:251]
 ds_read_b128 a[164:167], v1 offset:19456
 v_mfma_f32_16x16x32_bf16 v[248:251], a[200:203], a[160:163], v[248:251]
 ds_read_b128 a[160:163], v1 offset:18432
 v_mfma_f32_16x16x32_bf16 v[244:247], a[200:203], a[152:155], v[244:247]
 ds_read_b128 a[152:155], v1 offset:14336
 v_mfma_f32_16x16x32_bf16 v[244:247], a[204:207], a[156:159], v[244:247]
 ds_read_b128 a[156:159], v1 offset:15360
 v_mfma_f32_16x16x32_bf16 v[240:243], a[204:207], a[148:151], v[240:243]
 ds_read_b128 a[148:151], v1 offset:11264
 v_mfma_f32_16x16x32_bf16 v[240:243], a[200:203], a[144:147], v[240:243]
 ds_read_b128 a[144:147], v1 offset:10240
 v_mfma_f32_16x16x32_bf16 v[236:239], a[200:203], a[136:139], v[236:239]
 ds_read_b128 a[136:139], v1 offset:6144
 v_mfma_f32_16x16x32_bf16 v[236:239], a[204:207], a[140:143], v[236:239]
 ds_read_b128 a[140:143], v1 offset:7168
 v_mfma_f32_16x16x32_bf16 v[232:235], a[204:207], a[132:135], v[232:235]
 global_load_dwordx4 a[204:207], v0, s[70:71] offset:-1024 sc1
 ds_read_b128 a[132:135], v1 offset:3072
 v_mfma_f32_16x16x32_bf16 v[232:235], a[200:203], a[128:131], v[232:235]
 global_load_dwordx4 a[200:203], v0, s[70:71] offset:-2048 sc1
 ds_read_b128 a[128:131], v1 offset:2048
 s_waitcnt vmcnt(10) lgkmcnt(8)
Lloop:
 v_mfma_f32_16x16x32_bf16 v[44:47], a[208:211], a[184:187], v[44:47]
 v_mfma_f32_16x16x32_bf16 v[44:47], a[212:215], a[188:191], v[44:47]
 v_mov_b32 v6, v3
 s_cmp_eq_u32 s25, 0
 s_cbranch_scc1 Lgat0
Lgatr0:
 v_mfma_f32_16x16x32_bf16 v[40:43], a[212:215], a[180:183], v[40:43]
 v_mfma_f32_16x16x32_bf16 v[40:43], a[208:211], a[176:179], v[40:43]
 ds_read_b128 v[12:15], v3 offset:26624
 v_mfma_f32_16x16x32_bf16 v[36:39], a[208:211], a[168:171], v[36:39]
 s_add_u32 m0, s50, 0
 v_mfma_f32_16x16x32_bf16 v[36:39], a[212:215], a[172:175], v[36:39]
 v_mfma_f32_16x16x32_bf16 v[32:35], a[212:215], a[164:167], v[32:35]
 v_mfma_f32_16x16x32_bf16 v[32:35], a[208:211], a[160:163], v[32:35]
 s_waitcnt lgkmcnt(1)
 v_mfma_f32_16x16x32_bf16 v[28:31], a[208:211], a[152:155], v[28:31]
 v_mfma_f32_16x16x32_bf16 v[28:31], a[212:215], a[156:159], v[28:31]
 v_mfma_f32_16x16x32_bf16 v[24:27], a[212:215], a[148:151], v[24:27]
 v_mfma_f32_16x16x32_bf16 v[24:27], a[208:211], a[144:147], v[24:27]
 buffer_load_dwordx4 v6, s[8:11], s30 offen lds
 v_mfma_f32_16x16x32_bf16 v[20:23], a[208:211], a[136:139], v[20:23]
 v_mfma_f32_16x16x32_bf16 v[20:23], a[212:215], a[140:143], v[20:23]
 v_mfma_f32_16x16x32_bf16 v[16:19], a[212:215], a[132:135], v[16:19]
 s_add_u32 m0, m0, 1024
 v_mfma_f32_16x16x32_bf16 v[16:19], a[208:211], a[128:131], v[16:19]
 s_waitcnt vmcnt(9)
 v_mfma_f32_16x16x32_bf16 v[48:51], a[216:219], a[128:131], v[48:51]
 v_mfma_f32_16x16x32_bf16 v[48:51], a[220:223], a[132:135], v[48:51]
 global_load_dwordx4 a[212:215], v0, s[70:71] offset:1024 sc1
 s_add_u32 s30, s30, s20
 v_mfma_f32_16x16x32_bf16 v[52:55], a[220:223], a[140:143], v[52:55]
 v_mfma_f32_16x16x32_bf16 v[52:55], a[216:219], a[136:139], v[52:55]
 global_load_dwordx4 a[208:211], v0, s[70:71] offset:0 sc1
 v_mfma_f32_16x16x32_bf16 v[56:59], a[216:219], a[144:147], v[56:59]
 buffer_load_dwordx4 v6, s[8:11], s30 offen lds
 s_waitcnt lgkmcnt(0)
 v_mfma_f32_16x16x32_bf16 v[56:59], a[220:223], a[148:151], v[56:59]
 v_mfma_f32_16x16x32_bf16 v[60:63], a[220:223], a[156:159], v[60:63]
 s_add_u32 s69, s29, 28672
 v_mfma_f32_16x16x32_bf16 v[60:63], a[216:219], a[152:155], v[60:63]
 v_mfma_f32_16x16x32_bf16 v[64:67], a[216:219], a[160:163], v[64:67]
 s_add_u32 m0, m0, 3072
 v_mfma_f32_16x16x32_bf16 v[64:67], a[220:223], a[164:167], v[64:67]
 buffer_store_dwordx4 v[12:15], v3, s[32:35], s69 offen sc1
 v_mfma_f32_16x16x32_bf16 v[68:71], a[220:223], a[172:175], v[68:71]
 v_mfma_f32_16x16x32_bf16 v[68:71], a[216:219], a[168:171], v[68:71]
 s_add_u32 s30, s30, s21
 v_mfma_f32_16x16x32_bf16 v[72:75], a[216:219], a[176:179], v[72:75]
 v_mfma_f32_16x16x32_bf16 v[72:75], a[220:223], a[180:183], v[72:75]
 v_mfma_f32_16x16x32_bf16 v[76:79], a[220:223], a[188:191], v[76:79]
 v_mfma_f32_16x16x32_bf16 v[76:79], a[216:219], a[184:187], v[76:79]
 ds_read_b128 v[12:15], v3 offset:27648
 s_waitcnt vmcnt(11)
 v_mfma_f32_16x16x32_bf16 v[108:111], a[224:227], a[184:187], v[108:111]
 v_mfma_f32_16x16x32_bf16 v[108:111], a[228:231], a[188:191], v[108:111]
 global_load_dwordx4 a[220:223], v0, s[70:71] offset:3072 sc1
 v_mfma_f32_16x16x32_bf16 v[104:107], a[228:231], a[180:183], v[104:107]
 v_mfma_f32_16x16x32_bf16 v[104:107], a[224:227], a[176:179], v[104:107]
 global_load_dwordx4 a[216:219], v0, s[70:71] offset:2048 sc1
 v_mfma_f32_16x16x32_bf16 v[100:103], a[224:227], a[168:171], v[100:103]
 s_add_u32 s70, s70, 8192
 s_addc_u32 s71, s71, 0
 v_mfma_f32_16x16x32_bf16 v[100:103], a[228:231], a[172:175], v[100:103]
 v_mfma_f32_16x16x32_bf16 v[96:99], a[228:231], a[164:167], v[96:99]
 v_mfma_f32_16x16x32_bf16 v[96:99], a[224:227], a[160:163], v[96:99]
 v_mfma_f32_16x16x32_bf16 v[92:95], a[224:227], a[152:155], v[92:95]
 v_mfma_f32_16x16x32_bf16 v[92:95], a[228:231], a[156:159], v[92:95]
 v_mfma_f32_16x16x32_bf16 v[88:91], a[228:231], a[148:151], v[88:91]
 v_mfma_f32_16x16x32_bf16 v[88:91], a[224:227], a[144:147], v[88:91]
 v_mfma_f32_16x16x32_bf16 v[84:87], a[224:227], a[136:139], v[84:87]
 v_mfma_f32_16x16x32_bf16 v[84:87], a[228:231], a[140:143], v[84:87]
 v_mfma_f32_16x16x32_bf16 v[80:83], a[228:231], a[132:135], v[80:83]
 v_mfma_f32_16x16x32_bf16 v[80:83], a[224:227], a[128:131], v[80:83]
 s_waitcnt vmcnt(11)
 v_mfma_f32_16x16x32_bf16 v[112:115], a[232:235], a[128:131], v[112:115]
 v_mfma_f32_16x16x32_bf16 v[112:115], a[236:239], a[132:135], v[112:115]
 global_load_dwordx4 a[228:231], v0, s[70:71] offset:-3072 sc1
 s_waitcnt lgkmcnt(0)
 v_mfma_f32_16x16x32_bf16 v[116:119], a[236:239], a[140:143], v[116:119]
 v_mfma_f32_16x16x32_bf16 v[116:119], a[232:235], a[136:139], v[116:119]
 global_load_dwordx4 a[224:227], v0, s[70:71] offset:-4096 sc1
 v_mfma_f32_16x16x32_bf16 v[120:123], a[232:235], a[144:147], v[120:123]
 buffer_store_dwordx4 v[12:15], v3, s[32:35], s69 offen offset:1024 sc1
 v_mfma_f32_16x16x32_bf16 v[120:123], a[236:239], a[148:151], v[120:123]
 v_mfma_f32_16x16x32_bf16 v[124:127], a[236:239], a[156:159], v[124:127]
 v_mfma_f32_16x16x32_bf16 v[124:127], a[232:235], a[152:155], v[124:127]
 v_mfma_f32_16x16x32_bf16 v[128:131], a[232:235], a[160:163], v[128:131]
 v_mfma_f32_16x16x32_bf16 v[128:131], a[236:239], a[164:167], v[128:131]
 v_mfma_f32_16x16x32_bf16 v[132:135], a[236:239], a[172:175], v[132:135]
 ds_read_b128 v[12:15], v3 offset:30720
 v_mfma_f32_16x16x32_bf16 v[132:135], a[232:235], a[168:171], v[132:135]
 v_mfma_f32_16x16x32_bf16 a[240:243], a[232:235], a[176:179], a[240:243]
 v_mfma_f32_16x16x32_bf16 a[240:243], a[236:239], a[180:183], a[240:243]
 v_mfma_f32_16x16x32_bf16 a[244:247], a[236:239], a[188:191], a[244:247]
 buffer_load_dwordx4 v6, s[8:11], s30 offen lds
 v_mfma_f32_16x16x32_bf16 a[244:247], a[232:235], a[184:187], a[244:247]
 s_waitcnt vmcnt(13)
 v_mfma_f32_16x16x32_bf16 v[164:167], a[192:195], a[184:187], v[164:167]
 v_mfma_f32_16x16x32_bf16 v[164:167], a[196:199], a[188:191], v[164:167]
 global_load_dwordx4 a[236:239], v0, s[70:71] offset:-1024 sc1
 v_mfma_f32_16x16x32_bf16 v[160:163], a[196:199], a[180:183], v[160:163]
 s_add_u32 m0, m0, 1024
 v_mfma_f32_16x16x32_bf16 v[160:163], a[192:195], a[176:179], v[160:163]
 global_load_dwordx4 a[232:235], v0, s[70:71] offset:-2048 sc1
 v_mfma_f32_16x16x32_bf16 v[156:159], a[192:195], a[168:171], v[156:159]
 v_mfma_f32_16x16x32_bf16 v[156:159], a[196:199], a[172:175], v[156:159]
 s_add_u32 s30, s30, s20
 v_mfma_f32_16x16x32_bf16 v[152:155], a[196:199], a[164:167], v[152:155]
 v_mfma_f32_16x16x32_bf16 v[152:155], a[192:195], a[160:163], v[152:155]
 v_mfma_f32_16x16x32_bf16 v[148:151], a[192:195], a[152:155], v[148:151]
 buffer_load_dwordx4 v6, s[8:11], s30 offen lds
 v_mfma_f32_16x16x32_bf16 v[148:151], a[196:199], a[156:159], v[148:151]
 v_mfma_f32_16x16x32_bf16 v[144:147], a[196:199], a[148:151], v[144:147]
 v_mfma_f32_16x16x32_bf16 v[144:147], a[192:195], a[144:147], v[144:147]
 s_add_u32 m0, m0, 3072
 s_waitcnt lgkmcnt(0)
 v_mfma_f32_16x16x32_bf16 v[140:143], a[192:195], a[136:139], v[140:143]
 v_mfma_f32_16x16x32_bf16 v[140:143], a[196:199], a[140:143], v[140:143]
 v_mfma_f32_16x16x32_bf16 v[136:139], a[196:199], a[132:135], v[136:139]
 s_add_u32 s30, s30, s21
 buffer_store_dwordx4 v[12:15], v3, s[32:35], s69 offen offset:2048 sc1
 v_mfma_f32_16x16x32_bf16 v[136:139], a[192:195], a[128:131], v[136:139]
 s_waitcnt vmcnt(15)
 v_mfma_f32_16x16x32_bf16 v[168:171], a[200:203], a[128:131], v[168:171]
 v_mfma_f32_16x16x32_bf16 v[168:171], a[204:207], a[132:135], v[168:171]
 global_load_dwordx4 a[196:199], v0, s[70:71] offset:1024 sc1
 v_mfma_f32_16x16x32_bf16 v[172:175], a[204:207], a[140:143], v[172:175]
 v_mfma_f32_16x16x32_bf16 v[172:175], a[200:203], a[136:139], v[172:175]
 global_load_dwordx4 a[192:195], v0, s[70:71] offset:0 sc1
 v_mfma_f32_16x16x32_bf16 v[176:179], a[200:203], a[144:147], v[176:179]
 ds_read_b128 v[12:15], v3 offset:31744
 v_mfma_f32_16x16x32_bf16 v[176:179], a[204:207], a[148:151], v[176:179]
 v_mfma_f32_16x16x32_bf16 v[180:183], a[204:207], a[156:159], v[180:183]
 v_mfma_f32_16x16x32_bf16 v[180:183], a[200:203], a[152:155], v[180:183]
 v_mfma_f32_16x16x32_bf16 v[184:187], a[200:203], a[160:163], v[184:187]
 v_mfma_f32_16x16x32_bf16 v[184:187], a[204:207], a[164:167], v[184:187]
 v_mfma_f32_16x16x32_bf16 v[188:191], a[204:207], a[172:175], v[188:191]
 v_mfma_f32_16x16x32_bf16 v[188:191], a[200:203], a[168:171], v[188:191]
 v_mfma_f32_16x16x32_bf16 v[192:195], a[200:203], a[176:179], v[192:195]
 v_mfma_f32_16x16x32_bf16 v[192:195], a[204:207], a[180:183], v[192:195]
 v_mfma_f32_16x16x32_bf16 v[196:199], a[204:207], a[188:191], v[196:199]
 v_mfma_f32_16x16x32_bf16 v[196:199], a[200:203], a[184:187], v[196:199]
 s_waitcnt vmcnt(14)
 v_mfma_f32_16x16x32_bf16 v[228:231], a[208:211], a[184:187], v[228:231]
 v_mfma_f32_16x16x32_bf16 v[228:231], a[212:215], a[188:191], v[228:231]
 global_load_dwordx4 a[204:207], v0, s[70:71] offset:3072 sc1
 v_mfma_f32_16x16x32_bf16 v[224:227], a[212:215], a[180:183], v[224:227]
 v_mfma_f32_16x16x32_bf16 v[224:227], a[208:211], a[176:179], v[224:227]
 global_load_dwordx4 a[200:203], v0, s[70:71] offset:2048 sc1
 v_mfma_f32_16x16x32_bf16 v[220:223], a[208:211], a[168:171], v[220:223]
 s_add_u32 s70, s70, 8192
 s_addc_u32 s71, s71, 0
 v_mfma_f32_16x16x32_bf16 v[220:223], a[212:215], a[172:175], v[220:223]
 v_mfma_f32_16x16x32_bf16 v[216:219], a[212:215], a[164:167], v[216:219]
 s_waitcnt lgkmcnt(0)
 v_mfma_f32_16x16x32_bf16 v[216:219], a[208:211], a[160:163], v[216:219]
 v_mfma_f32_16x16x32_bf16 v[212:215], a[208:211], a[152:155], v[212:215]
 buffer_store_dwordx4 v[12:15], v3, s[32:35], s69 offen offset:3072 sc1
 v_mfma_f32_16x16x32_bf16 v[212:215], a[212:215], a[156:159], v[212:215]
 v_mfma_f32_16x16x32_bf16 v[208:211], a[212:215], a[148:151], v[208:211]
 v_mfma_f32_16x16x32_bf16 v[208:211], a[208:211], a[144:147], v[208:211]
 v_mfma_f32_16x16x32_bf16 v[204:207], a[208:211], a[136:139], v[204:207]
 v_mfma_f32_16x16x32_bf16 v[204:207], a[212:215], a[140:143], v[204:207]
 v_mfma_f32_16x16x32_bf16 v[200:203], a[212:215], a[132:135], v[200:203]
 v_mfma_f32_16x16x32_bf16 v[200:203], a[208:211], a[128:131], v[200:203]
 buffer_load_dwordx4 v6, s[8:11], s30 offen lds
 s_waitcnt vmcnt(14)
 v_mfma_f32_16x16x32_bf16 v[232:235], a[216:219], a[128:131], v[232:235]
 ds_read_b128 a[128:131], v1 offset:34816
 v_mfma_f32_16x16x32_bf16 v[232:235], a[220:223], a[132:135], v[232:235]
 global_load_dwordx4 a[212:215], v0, s[70:71] offset:-3072 sc1
 ds_read_b128 a[132:135], v1 offset:35840
 v_mfma_f32_16x16x32_bf16 v[236:239], a[220:223], a[140:143], v[236:239]
 ds_read_b128 a[140:143], v1 offset:39936
 v_mfma_f32_16x16x32_bf16 v[236:239], a[216:219], a[136:139], v[236:239]
 global_load_dwordx4 a[208:211], v0, s[70:71] offset:-4096 sc1
 ds_read_b128 a[136:139], v1 offset:38912
 v_mfma_f32_16x16x32_bf16 v[240:243], a[216:219], a[144:147], v[240:243]
 ds_read_b128 a[144:147], v1 offset:43008
 v_mfma_f32_16x16x32_bf16 v[240:243], a[220:223], a[148:151], v[240:243]
 ds_read_b128 a[148:151], v1 offset:44032
 s_add_u32 m0, m0, 1024
 v_mfma_f32_16x16x32_bf16 v[244:247], a[220:223], a[156:159], v[244:247]
 ds_read_b128 a[156:159], v1 offset:48128
 v_mfma_f32_16x16x32_bf16 v[244:247], a[216:219], a[152:155], v[244:247]
 ds_read_b128 a[152:155], v1 offset:47104
 v_mfma_f32_16x16x32_bf16 v[248:251], a[216:219], a[160:163], v[248:251]
 ds_read_b128 a[160:163], v1 offset:51200
 s_add_u32 s30, s30, s20
 v_mfma_f32_16x16x32_bf16 v[248:251], a[220:223], a[164:167], v[248:251]
 ds_read_b128 a[164:167], v1 offset:52224
 v_mfma_f32_16x16x32_bf16 v[252:255], a[220:223], a[172:175], v[252:255]
 ds_read_b128 a[172:175], v1 offset:56320
 v_mfma_f32_16x16x32_bf16 v[252:255], a[216:219], a[168:171], v[252:255]
 ds_read_b128 a[168:171], v1 offset:55296
 v_mfma_f32_16x16x32_bf16 a[248:251], a[216:219], a[176:179], a[248:251]
 ds_read_b128 a[176:179], v1 offset:59392
 v_mfma_f32_16x16x32_bf16 a[248:251], a[220:223], a[180:183], a[248:251]
 ds_read_b128 a[180:183], v1 offset:60416
 v_mfma_f32_16x16x32_bf16 a[252:255], a[220:223], a[188:191], a[252:255]
 ds_read_b128 a[188:191], v1 offset:64512
 v_mfma_f32_16x16x32_bf16 a[252:255], a[216:219], a[184:187], a[252:255]
 ds_read_b128 a[184:187], v1 offset:63488
 s_waitcnt vmcnt(14) lgkmcnt(8)
 v_mfma_f32_16x16x32_bf16 v[16:19], a[224:227], a[128:131], v[16:19]
 buffer_load_dwordx4 v6, s[8:11], s30 offen lds
 s_add_u32 m0, m0, 3072
 v_mfma_f32_16x16x32_bf16 v[16:19], a[228:231], a[132:135], v[16:19]
 global_load_dwordx4 a[220:223], v0, s[70:71] offset:-1024 sc1
 v_mfma_f32_16x16x32_bf16 v[20:23], a[228:231], a[140:143], v[20:23]
 s_add_u32 s30, s30, s21
 v_mfma_f32_16x16x32_bf16 v[20:23], a[224:227], a[136:139], v[20:23]
 global_load_dwordx4 a[216:219], v0, s[70:71] offset:-2048 sc1
 v_mfma_f32_16x16x32_bf16 v[24:27], a[224:227], a[144:147], v[24:27]
 v_mfma_f32_16x16x32_bf16 v[24:27], a[228:231], a[148:151], v[24:27]
 v_mfma_f32_16x16x32_bf16 v[28:31], a[228:231], a[156:159], v[28:31]
 v_mfma_f32_16x16x32_bf16 v[28:31], a[224:227], a[152:155], v[28:31]
 s_waitcnt lgkmcnt(0)
 v_mfma_f32_16x16x32_bf16 v[32:35], a[224:227], a[160:163], v[32:35]
 v_mfma_f32_16x16x32_bf16 v[32:35], a[228:231], a[164:167], v[32:35]
 v_mfma_f32_16x16x32_bf16 v[36:39], a[228:231], a[172:175], v[36:39]
 v_mfma_f32_16x16x32_bf16 v[36:39], a[224:227], a[168:171], v[36:39]
 v_mfma_f32_16x16x32_bf16 v[40:43], a[224:227], a[176:179], v[40:43]
 v_mfma_f32_16x16x32_bf16 v[40:43], a[228:231], a[180:183], v[40:43]
 v_mfma_f32_16x16x32_bf16 v[44:47], a[228:231], a[188:191], v[44:47]
 v_mfma_f32_16x16x32_bf16 v[44:47], a[224:227], a[184:187], v[44:47]
 s_waitcnt vmcnt(13)
 v_mfma_f32_16x16x32_bf16 v[76:79], a[232:235], a[184:187], v[76:79]
 v_mfma_f32_16x16x32_bf16 v[76:79], a[236:239], a[188:191], v[76:79]
 global_load_dwordx4 a[228:231], v0, s[70:71] offset:1024 sc1
 v_mfma_f32_16x16x32_bf16 v[72:75], a[236:239], a[180:183], v[72:75]
 v_mfma_f32_16x16x32_bf16 v[72:75], a[232:235], a[176:179], v[72:75]
 global_load_dwordx4 a[224:227], v0, s[70:71] offset:0 sc1
 v_mfma_f32_16x16x32_bf16 v[68:71], a[232:235], a[168:171], v[68:71]
 v_mfma_f32_16x16x32_bf16 v[68:71], a[236:239], a[172:175], v[68:71]
 v_mfma_f32_16x16x32_bf16 v[64:67], a[236:239], a[164:167], v[64:67]
 s_add_u32 s31, s31, 1
 s_waitcnt vmcnt(8)
 v_mov_b32 v7, s31
 buffer_store_dword v7, v1, s[60:63], 0 offen sc1
 v_mfma_f32_16x16x32_bf16 v[64:67], a[232:235], a[160:163], v[64:67]
 s_add_u32 s29, s29, 0x2000000
 v_mfma_f32_16x16x32_bf16 v[60:63], a[232:235], a[152:155], v[60:63]
 v_mfma_f32_16x16x32_bf16 v[60:63], a[236:239], a[156:159], v[60:63]
 v_mfma_f32_16x16x32_bf16 v[56:59], a[236:239], a[148:151], v[56:59]
 v_mfma_f32_16x16x32_bf16 v[56:59], a[232:235], a[144:147], v[56:59]
 v_mfma_f32_16x16x32_bf16 v[52:55], a[232:235], a[136:139], v[52:55]
 v_mfma_f32_16x16x32_bf16 v[52:55], a[236:239], a[140:143], v[52:55]
 v_mfma_f32_16x16x32_bf16 v[48:51], a[236:239], a[132:135], v[48:51]
 v_mfma_f32_16x16x32_bf16 v[48:51], a[232:235], a[128:131], v[48:51]
 v_mfma_f32_16x16x32_bf16 v[80:83], a[192:195], a[128:131], v[80:83]
 v_mfma_f32_16x16x32_bf16 v[80:83], a[196:199], a[132:135], v[80:83]
 global_load_dwordx4 a[236:239], v0, s[70:71] offset:3072 sc1
 v_mfma_f32_16x16x32_bf16 v[84:87], a[196:199], a[140:143], v[84:87]
 v_mfma_f32_16x16x32_bf16 v[84:87], a[192:195], a[136:139], v[84:87]
 global_load_dwordx4 a[232:235], v0, s[70:71] offset:2048 sc1
 v_mfma_f32_16x16x32_bf16 v[88:91], a[192:195], a[144:147], v[88:91]
 s_add_u32 s70, s70, 8192
 s_addc_u32 s71, s71, 0
 v_mfma_f32_16x16x32_bf16 v[88:91], a[196:199], a[148:151], v[88:91]
 buffer_load_dwordx4 v6, s[8:11], s30 offen lds
 v_mfma_f32_16x16x32_bf16 v[92:95], a[196:199], a[156:159], v[92:95]
 v_mfma_f32_16x16x32_bf16 v[92:95], a[192:195], a[152:155], v[92:95]
 v_mfma_f32_16x16x32_bf16 v[96:99], a[192:195], a[160:163], v[96:99]
 v_mfma_f32_16x16x32_bf16 v[96:99], a[196:199], a[164:167], v[96:99]
 s_add_u32 m0, m0, 1024
 v_mfma_f32_16x16x32_bf16 v[100:103], a[196:199], a[172:175], v[100:103]
 v_mfma_f32_16x16x32_bf16 v[100:103], a[192:195], a[168:171], v[100:103]
 v_mfma_f32_16x16x32_bf16 v[104:107], a[192:195], a[176:179], v[104:107]
 s_add_u32 s30, s30, s20
 v_mfma_f32_16x16x32_bf16 v[104:107], a[196:199], a[180:183], v[104:107]
 v_mfma_f32_16x16x32_bf16 v[108:111], a[196:199], a[188:191], v[108:111]
 v_mfma_f32_16x16x32_bf16 v[108:111], a[192:195], a[184:187], v[108:111]
 buffer_load_dwordx4 v6, s[8:11], s30 offen lds
 v_mfma_f32_16x16x32_bf16 a[244:247], a[200:203], a[184:187], a[244:247]
 v_mfma_f32_16x16x32_bf16 a[244:247], a[204:207], a[188:191], a[244:247]
 global_load_dwordx4 a[196:199], v0, s[70:71] offset:-3072 sc1
 v_mfma_f32_16x16x32_bf16 a[240:243], a[204:207], a[180:183], a[240:243]
 s_add_u32 m0, m0, 3072
 v_mfma_f32_16x16x32_bf16 a[240:243], a[200:203], a[176:179], a[240:243]
 global_load_dwordx4 a[192:195], v0, s[70:71] offset:-4096 sc1
 v_mfma_f32_16x16x32_bf16 v[132:135], a[200:203], a[168:171], v[132:135]
 v_mfma_f32_16x16x32_bf16 v[132:135], a[204:207], a[172:175], v[132:135]
 v_mfma_f32_16x16x32_bf16 v[128:131], a[204:207], a[164:167], v[128:131]
 s_add_u32 s30, s30, s21
 v_mfma_f32_16x16x32_bf16 v[128:131], a[200:203], a[160:163], v[128:131]
 v_mfma_f32_16x16x32_bf16 v[124:127], a[200:203], a[152:155], v[124:127]
 v_mfma_f32_16x16x32_bf16 v[124:127], a[204:207], a[156:159], v[124:127]
 v_mfma_f32_16x16x32_bf16 v[120:123], a[204:207], a[148:151], v[120:123]
 v_mfma_f32_16x16x32_bf16 v[120:123], a[200:203], a[144:147], v[120:123]
 v_mfma_f32_16x16x32_bf16 v[116:119], a[200:203], a[136:139], v[116:119]
 v_mfma_f32_16x16x32_bf16 v[116:119], a[204:207], a[140:143], v[116:119]
 v_mfma_f32_16x16x32_bf16 v[112:115], a[204:207], a[132:135], v[112:115]
 v_mfma_f32_16x16x32_bf16 v[112:115], a[200:203], a[128:131], v[112:115]
 s_waitcnt vmcnt(12)
 v_mfma_f32_16x16x32_bf16 v[136:139], a[208:211], a[128:131], v[136:139]
 v_mfma_f32_16x16x32_bf16 v[136:139], a[212:215], a[132:135], v[136:139]
 global_load_dwordx4 a[204:207], v0, s[70:71] offset:-1024 sc1
 v_mfma_f32_16x16x32_bf16 v[140:143], a[212:215], a[140:143], v[140:143]
 v_mfma_f32_16x16x32_bf16 v[140:143], a[208:211], a[136:139], v[140:143]
 global_load_dwordx4 a[200:203], v0, s[70:71] offset:-2048 sc1
 v_mfma_f32_16x16x32_bf16 v[144:147], a[208:211], a[144:147], v[144:147]
 v_mfma_f32_16x16x32_bf16 v[144:147], a[212:215], a[148:151], v[144:147]
 v_mfma_f32_16x16x32_bf16 v[148:151], a[212:215], a[156:159], v[148:151]
 v_mfma_f32_16x16x32_bf16 v[148:151], a[208:211], a[152:155], v[148:151]
 v_mfma_f32_16x16x32_bf16 v[152:155], a[208:211], a[160:163], v[152:155]
 v_mfma_f32_16x16x32_bf16 v[152:155], a[212:215], a[164:167], v[152:155]
 v_mfma_f32_16x16x32_bf16 v[156:159], a[212:215], a[172:175], v[156:159]
 v_mfma_f32_16x16x32_bf16 v[156:159], a[208:211], a[168:171], v[156:159]
 v_mfma_f32_16x16x32_bf16 v[160:163], a[208:211], a[176:179], v[160:163]
 v_mfma_f32_16x16x32_bf16 v[160:163], a[212:215], a[180:183], v[160:163]
 v_mfma_f32_16x16x32_bf16 v[164:167], a[212:215], a[188:191], v[164:167]
 v_mfma_f32_16x16x32_bf16 v[164:167], a[208:211], a[184:187], v[164:167]
 s_waitcnt vmcnt(11)
 v_mfma_f32_16x16x32_bf16 v[196:199], a[216:219], a[184:187], v[196:199]
 v_mfma_f32_16x16x32_bf16 v[196:199], a[220:223], a[188:191], v[196:199]
 global_load_dwordx4 a[212:215], v0, s[70:71] offset:1024 sc1
 v_mfma_f32_16x16x32_bf16 v[192:195], a[220:223], a[180:183], v[192:195]
 v_mfma_f32_16x16x32_bf16 v[192:195], a[216:219], a[176:179], v[192:195]
 global_load_dwordx4 a[208:211], v0, s[70:71] offset:0 sc1
 v_mfma_f32_16x16x32_bf16 v[188:191], a[216:219], a[168:171], v[188:191]
 v_mfma_f32_16x16x32_bf16 v[188:191], a[220:223], a[172:175], v[188:191]
 v_mfma_f32_16x16x32_bf16 v[184:187], a[220:223], a[164:167], v[184:187]
 v_mfma_f32_16x16x32_bf16 v[184:187], a[216:219], a[160:163], v[184:187]
 v_mfma_f32_16x16x32_bf16 v[180:183], a[216:219], a[152:155], v[180:183]
 v_mfma_f32_16x16x32_bf16 v[180:183], a[220:223], a[156:159], v[180:183]
 buffer_load_dwordx4 v6, s[8:11], s30 offen lds
 v_mfma_f32_16x16x32_bf16 v[176:179], a[220:223], a[148:151], v[176:179]
 v_mfma_f32_16x16x32_bf16 v[176:179], a[216:219], a[144:147], v[176:179]
 v_mfma_f32_16x16x32_bf16 v[172:175], a[216:219], a[136:139], v[172:175]
 s_add_u32 m0, m0, 1024
 v_mfma_f32_16x16x32_bf16 v[172:175], a[220:223], a[140:143], v[172:175]
 v_mfma_f32_16x16x32_bf16 v[168:171], a[220:223], a[132:135], v[168:171]
 v_mfma_f32_16x16x32_bf16 v[168:171], a[216:219], a[128:131], v[168:171]
 s_waitcnt vmcnt(12)
 v_mfma_f32_16x16x32_bf16 v[200:203], a[224:227], a[128:131], v[200:203]
 s_add_u32 s30, s30, s20
 v_mfma_f32_16x16x32_bf16 v[200:203], a[228:231], a[132:135], v[200:203]
 global_load_dwordx4 a[220:223], v0, s[70:71] offset:3072 sc1
 v_mfma_f32_16x16x32_bf16 v[204:207], a[228:231], a[140:143], v[204:207]
 buffer_load_dwordx4 v6, s[8:11], s30 offen lds
 v_mfma_f32_16x16x32_bf16 v[204:207], a[224:227], a[136:139], v[204:207]
 global_load_dwordx4 a[216:219], v0, s[70:71] offset:2048 sc1
 v_mfma_f32_16x16x32_bf16 v[208:211], a[224:227], a[144:147], v[208:211]
 s_add_u32 s70, s70, 8192
 s_addc_u32 s71, s71, 0
 v_mfma_f32_16x16x32_bf16 v[208:211], a[228:231], a[148:151], v[208:211]
 v_mfma_f32_16x16x32_bf16 v[212:215], a[228:231], a[156:159], v[212:215]
 s_add_u32 m0, m0, 3072
 v_mfma_f32_16x16x32_bf16 v[212:215], a[224:227], a[152:155], v[212:215]
 v_mfma_f32_16x16x32_bf16 v[216:219], a[224:227], a[160:163], v[216:219]
 v_mfma_f32_16x16x32_bf16 v[216:219], a[228:231], a[164:167], v[216:219]
 s_add_u32 s30, s30, s21
 v_mfma_f32_16x16x32_bf16 v[220:223], a[228:231], a[172:175], v[220:223]
 v_mfma_f32_16x16x32_bf16 v[220:223], a[224:227], a[168:171], v[220:223]
 v_mfma_f32_16x16x32_bf16 v[224:227], a[224:227], a[176:179], v[224:227]
 v_mfma_f32_16x16x32_bf16 v[224:227], a[228:231], a[180:183], v[224:227]
 v_mfma_f32_16x16x32_bf16 v[228:231], a[228:231], a[188:191], v[228:231]
 v_mfma_f32_16x16x32_bf16 v[228:231], a[224:227], a[184:187], v[228:231]
 s_waitcnt vmcnt(12)
 v_mfma_f32_16x16x32_bf16 a[252:255], a[232:235], a[184:187], a[252:255]
 ds_read_b128 a[184:187], v2 offset:30720
 v_mfma_f32_16x16x32_bf16 a[252:255], a[236:239], a[188:191], a[252:255]
 global_load_dwordx4 a[228:231], v0, s[70:71] offset:-3072 sc1
 ds_read_b128 a[188:191], v2 offset:31744
 v_mfma_f32_16x16x32_bf16 a[248:251], a[236:239], a[180:183], a[248:251]
 ds_read_b128 a[180:183], v2 offset:27648
 v_mfma_f32_16x16x32_bf16 a[248:251], a[232:235], a[176:179], a[248:251]
 global_load_dwordx4 a[224:227], v0, s[70:71] offset:-4096 sc1
 ds_read_b128 a[176:179], v2 offset:26624
 v_mfma_f32_16x16x32_bf16 v[252:255], a[232:235], a[168:171], v[252:255]
 ds_read_b128 a[168:171], v2 offset:22528
 v_mfma_f32_16x16x32_bf16 v[252:255], a[236:239], a[172:175], v[252:255]
 ds_read_b128 a[172:175], v2 offset:23552
 v_mfma_f32_16x16x32_bf16 v[248:251], a[236:239], a[164:167], v[248:251]
 ds_read_b128 a[164:167], v2 offset:19456
 v_mfma_f32_16x16x32_bf16 v[248:251], a[232:235], a[160:163], v[248:251]
 ds_read_b128 a[160:163], v2 offset:18432
 v_mfma_f32_16x16x32_bf16 v[244:247], a[232:235], a[152:155], v[244:247]
 ds_read_b128 a[152:155], v2 offset:14336
 v_mfma_f32_16x16x32_bf16 v[244:247], a[236:239], a[156:159], v[244:247]
 ds_read_b128 a[156:159], v2 offset:15360
 v_mfma_f32_16x16x32_bf16 v[240:243], a[236:239], a[148:151], v[240:243]
 ds_read_b128 a[148:151], v2 offset:11264
 v_mfma_f32_16x16x32_bf16 v[240:243], a[232:235], a[144:147], v[240:243]
 ds_read_b128 a[144:147], v2 offset:10240
 v_mfma_f32_16x16x32_bf16 v[236:239], a[232:235], a[136:139], v[236:239]
 ds_read_b128 a[136:139], v2 offset:6144
 v_mfma_f32_16x16x32_bf16 v[236:239], a[236:239], a[140:143], v[236:239]
 ds_read_b128 a[140:143], v2 offset:7168
 v_mfma_f32_16x16x32_bf16 v[232:235], a[236:239], a[132:135], v[232:235]
 ds_read_b128 a[132:135], v2 offset:3072
 v_mfma_f32_16x16x32_bf16 v[232:235], a[232:235], a[128:131], v[232:235]
 ds_read_b128 a[128:131], v2 offset:2048
 s_waitcnt vmcnt(10) lgkmcnt(8)
 v_mfma_f32_16x16x32_bf16 v[44:47], a[192:195], a[184:187], v[44:47]
 v_mfma_f32_16x16x32_bf16 v[44:47], a[196:199], a[188:191], v[44:47]
 global_load_dwordx4 a[236:239], v0, s[70:71] offset:-1024 sc1
 v_mfma_f32_16x16x32_bf16 v[40:43], a[196:199], a[180:183], v[40:43]
 v_mfma_f32_16x16x32_bf16 v[40:43], a[192:195], a[176:179], v[40:43]
 global_load_dwordx4 a[232:235], v0, s[70:71] offset:-2048 sc1
 v_mfma_f32_16x16x32_bf16 v[36:39], a[192:195], a[168:171], v[36:39]
 v_mfma_f32_16x16x32_bf16 v[36:39], a[196:199], a[172:175], v[36:39]
 v_mfma_f32_16x16x32_bf16 v[32:35], a[196:199], a[164:167], v[32:35]
 v_mfma_f32_16x16x32_bf16 v[32:35], a[192:195], a[160:163], v[32:35]
 s_waitcnt lgkmcnt(0)
 v_mfma_f32_16x16x32_bf16 v[28:31], a[192:195], a[152:155], v[28:31]
 v_mfma_f32_16x16x32_bf16 v[28:31], a[196:199], a[156:159], v[28:31]
 v_mfma_f32_16x16x32_bf16 v[24:27], a[196:199], a[148:151], v[24:27]
 v_mfma_f32_16x16x32_bf16 v[24:27], a[192:195], a[144:147], v[24:27]
 v_mfma_f32_16x16x32_bf16 v[20:23], a[192:195], a[136:139], v[20:23]
 v_mfma_f32_16x16x32_bf16 v[20:23], a[196:199], a[140:143], v[20:23]
 buffer_load_dwordx4 v6, s[8:11], s30 offen lds
 v_mfma_f32_16x16x32_bf16 v[16:19], a[196:199], a[132:135], v[16:19]
 v_mfma_f32_16x16x32_bf16 v[16:19], a[192:195], a[128:131], v[16:19]
 s_waitcnt vmcnt(11)
 v_mfma_f32_16x16x32_bf16 v[48:51], a[200:203], a[128:131], v[48:51]
 s_add_u32 m0, m0, 1024
 v_mfma_f32_16x16x32_bf16 v[48:51], a[204:207], a[132:135], v[48:51]
 global_load_dwordx4 a[196:199], v0, s[70:71] offset:1024 sc1
 v_mfma_f32_16x16x32_bf16 v[52:55], a[204:207], a[140:143], v[52:55]
 v_mfma_f32_16x16x32_bf16 v[52:55], a[200:203], a[136:139], v[52:55]
 global_load_dwordx4 a[192:195], v0, s[70:71] offset:0 sc1
 s_add_u32 s30, s30, s20
 v_mfma_f32_16x16x32_bf16 v[56:59], a[200:203], a[144:147], v[56:59]
 v_mfma_f32_16x16x32_bf16 v[56:59], a[204:207], a[148:151], v[56:59]
 v_mfma_f32_16x16x32_bf16 v[60:63], a[204:207], a[156:159], v[60:63]
 buffer_load_dwordx4 v6, s[8:11], s30 offen lds
 v_mfma_f32_16x16x32_bf16 v[60:63], a[200:203], a[152:155], v[60:63]
 v_mfma_f32_16x16x32_bf16 v[64:67], a[200:203], a[160:163], v[64:67]
 v_mfma_f32_16x16x32_bf16 v[64:67], a[204:207], a[164:167], v[64:67]
 v_mfma_f32_16x16x32_bf16 v[68:71], a[204:207], a[172:175], v[68:71]
 s_add_u32 m0, m0, 3072
 v_mfma_f32_16x16x32_bf16 v[68:71], a[200:203], a[168:171], v[68:71]
 v_mfma_f32_16x16x32_bf16 v[72:75], a[200:203], a[176:179], v[72:75]
 v_mfma_f32_16x16x32_bf16 v[72:75], a[204:207], a[180:183], v[72:75]
 s_add_u32 s30, s30, s21
 v_mfma_f32_16x16x32_bf16 v[76:79], a[204:207], a[188:191], v[76:79]
 v_mfma_f32_16x16x32_bf16 v[76:79], a[200:203], a[184:187], v[76:79]
 s_waitcnt vmcnt(12)
 v_mfma_f32_16x16x32_bf16 v[108:111], a[208:211], a[184:187], v[108:111]
 v_mfma_f32_16x16x32_bf16 v[108:111], a[212:215], a[188:191], v[108:111]
 global_load_dwordx4 a[204:207], v0, s[70:71] offset:3072 sc1
 v_mfma_f32_16x16x32_bf16 v[104:107], a[212:215], a[180:183], v[104:107]
 v_mfma_f32_16x16x32_bf16 v[104:107], a[208:211], a[176:179], v[104:107]
 global_load_dwordx4 a[200:203], v0, s[70:71] offset:2048 sc1
 v_mfma_f32_16x16x32_bf16 v[100:103], a[208:211], a[168:171], v[100:103]
 s_add_u32 s70, s70, 8192
 s_addc_u32 s71, s71, 0
 v_mfma_f32_16x16x32_bf16 v[100:103], a[212:215], a[172:175], v[100:103]
 v_mfma_f32_16x16x32_bf16 v[96:99], a[212:215], a[164:167], v[96:99]
 v_mfma_f32_16x16x32_bf16 v[96:99], a[208:211], a[160:163], v[96:99]
 v_mfma_f32_16x16x32_bf16 v[92:95], a[208:211], a[152:155], v[92:95]
 v_mfma_f32_16x16x32_bf16 v[92:95], a[212:215], a[156:159], v[92:95]
 v_mfma_f32_16x16x32_bf16 v[88:91], a[212:215], a[148:151], v[88:91]
 v_mfma_f32_16x16x32_bf16 v[88:91], a[208:211], a[144:147], v[88:91]
 v_mfma_f32_16x16x32_bf16 v[84:87], a[208:211], a[136:139], v[84:87]
 v_mfma_f32_16x16x32_bf16 v[84:87], a[212:215], a[140:143], v[84:87]
 v_mfma_f32_16x16x32_bf16 v[80:83], a[212:215], a[132:135], v[80:83]
 v_mfma_f32_16x16x32_bf16 v[80:83], a[208:211], a[128:131], v[80:83]
 s_waitcnt vmcnt(10)
 v_mfma_f32_16x16x32_bf16 v[112:115], a[216:219], a[128:131], v[112:115]
 v_mfma_f32_16x16x32_bf16 v[112:115], a[220:223], a[132:135], v[112:115]
 global_load_dwordx4 a[212:215], v0, s[70:71] offset:-3072 sc1
 v_mfma_f32_16x16x32_bf16 v[116:119], a[220:223], a[140:143], v[116:119]
 v_mfma_f32_16x16x32_bf16 v[116:119], a[216:219], a[136:139], v[116:119]
 global_load_dwordx4 a[208:211], v0, s[70:71] offset:-4096 sc1
 v_mfma_f32_16x16x32_bf16 v[120:123], a[216:219], a[144:147], v[120:123]
 v_mfma_f32_16x16x32_bf16 v[120:123], a[220:223], a[148:151], v[120:123]
 v_mfma_f32_16x16x32_bf16 v[124:127], a[220:223], a[156:159], v[124:127]
 v_mfma_f32_16x16x32_bf16 v[124:127], a[216:219], a[152:155], v[124:127]
 v_mfma_f32_16x16x32_bf16 v[128:131], a[216:219], a[160:163], v[128:131]
 v_mfma_f32_16x16x32_bf16 v[128:131], a[220:223], a[164:167], v[128:131]
 v_mfma_f32_16x16x32_bf16 v[132:135], a[220:223], a[172:175], v[132:135]
 v_mfma_f32_16x16x32_bf16 v[132:135], a[216:219], a[168:171], v[132:135]
 v_mfma_f32_16x16x32_bf16 a[240:243], a[216:219], a[176:179], a[240:243]
 v_mfma_f32_16x16x32_bf16 a[240:243], a[220:223], a[180:183], a[240:243]
 v_mfma_f32_16x16x32_bf16 a[244:247], a[220:223], a[188:191], a[244:247]
 v_mfma_f32_16x16x32_bf16 a[244:247], a[216:219], a[184:187], a[244:247]
 s_waitcnt vmcnt(10)
 v_mfma_f32_16x16x32_bf16 v[164:167], a[224:227], a[184:187], v[164:167]
 buffer_load_dwordx4 v6, s[8:11], s30 offen lds
 v_mfma_f32_16x16x32_bf16 v[164:167], a[228:231], a[188:191], v[164:167]
 global_load_dwordx4 a[220:223], v0, s[70:71] offset:-1024 sc1
 v_mfma_f32_16x16x32_bf16 v[160:163], a[228:231], a[180:183], v[160:163]
 v_mfma_f32_16x16x32_bf16 v[160:163], a[224:227], a[176:179], v[160:163]
 global_load_dwordx4 a[216:219], v0, s[70:71] offset:-2048 sc1
 s_add_u32 m0, m0, 1024
 v_mfma_f32_16x16x32_bf16 v[156:159], a[224:227], a[168:171], v[156:159]
 v_mfma_f32_16x16x32_bf16 v[156:159], a[228:231], a[172:175], v[156:159]
 v_mfma_f32_16x16x32_bf16 v[152:155], a[228:231], a[164:167], v[152:155]
 v_mfma_f32_16x16x32_bf16 v[152:155], a[224:227], a[160:163], v[152:155]
 s_add_u32 s30, s30, s20
 v_mfma_f32_16x16x32_bf16 v[148:151], a[224:227], a[152:155], v[148:151]
 v_mfma_f32_16x16x32_bf16 v[148:151], a[228:231], a[156:159], v[148:151]
 v_mfma_f32_16x16x32_bf16 v[144:147], a[228:231], a[148:151], v[144:147]
 buffer_load_dwordx4 v6, s[8:11], s30 offen lds
 v_mfma_f32_16x16x32_bf16 v[144:147], a[224:227], a[144:147], v[144:147]
 v_mfma_f32_16x16x32_bf16 v[140:143], a[224:227], a[136:139], v[140:143]
 v_mfma_f32_16x16x32_bf16 v[140:143], a[228:231], a[140:143], v[140:143]
 s_add_u32 m0, m0, 3072
 v_mfma_f32_16x16x32_bf16 v[136:139], a[228:231], a[132:135], v[136:139]
 v_mfma_f32_16x16x32_bf16 v[136:139], a[224:227], a[128:131], v[136:139]
 s_waitcnt vmcnt(12)
 v_mfma_f32_16x16x32_bf16 v[168:171], a[232:235], a[128:131], v[168:171]
 s_add_u32 s30, s30, s21
 v_mfma_f32_16x16x32_bf16 v[168:171], a[236:239], a[132:135], v[168:171]
 global_load_dwordx4 a[228:231], v0, s[70:71] offset:1024 sc1
 v_mfma_f32_16x16x32_bf16 v[172:175], a[236:239], a[140:143], v[172:175]
 v_mfma_f32_16x16x32_bf16 v[172:175], a[232:235], a[136:139], v[172:175]
 global_load_dwordx4 a[224:227], v0, s[70:71] offset:0 sc1
 v_mfma_f32_16x16x32_bf16 v[176:179], a[232:235], a[144:147], v[176:179]
 v_mfma_f32_16x16x32_bf16 v[176:179], a[236:239], a[148:151], v[176:179]
 v_mfma_f32_16x16x32_bf16 v[180:183], a[236:239], a[156:159], v[180:183]
 v_mfma_f32_16x16x32_bf16 v[180:183], a[232:235], a[152:155], v[180:183]
 v_mfma_f32_16x16x32_bf16 v[184:187], a[232:235], a[160:163], v[184:187]
 v_mfma_f32_16x16x32_bf16 v[184:187], a[236:239], a[164:167], v[184:187]
 v_mfma_f32_16x16x32_bf16 v[188:191], a[236:239], a[172:175], v[188:191]
 v_mfma_f32_16x16x32_bf16 v[188:191], a[232:235], a[168:171], v[188:191]
 v_mfma_f32_16x16x32_bf16 v[192:195], a[232:235], a[176:179], v[192:195]
 v_mfma_f32_16x16x32_bf16 v[192:195], a[236:239], a[180:183], v[192:195]
 v_mfma_f32_16x16x32_bf16 v[196:199], a[236:239], a[188:191], v[196:199]
 v_mfma_f32_16x16x32_bf16 v[196:199], a[232:235], a[184:187], v[196:199]
 s_waitcnt vmcnt(11)
 v_mfma_f32_16x16x32_bf16 v[228:231], a[192:195], a[184:187], v[228:231]
 v_mfma_f32_16x16x32_bf16 v[228:231], a[196:199], a[188:191], v[228:231]
 global_load_dwordx4 a[236:239], v0, s[70:71] offset:3072 sc1
 v_mfma_f32_16x16x32_bf16 v[224:227], a[196:199], a[180:183], v[224:227]
 v_mfma_f32_16x16x32_bf16 v[224:227], a[192:195], a[176:179], v[224:227]
 global_load_dwordx4 a[232:235], v0, s[70:71] offset:2048 sc1
 v_mfma_f32_16x16x32_bf16 v[220:223], a[192:195], a[168:171], v[220:223]
 s_add_u32 s70, s70, 8192
 s_addc_u32 s71, s71, 0
 v_mfma_f32_16x16x32_bf16 v[220:223], a[196:199], a[172:175], v[220:223]
 v_mfma_f32_16x16x32_bf16 v[216:219], a[196:199], a[164:167], v[216:219]
 v_mfma_f32_16x16x32_bf16 v[216:219], a[192:195], a[160:163], v[216:219]
 v_mfma_f32_16x16x32_bf16 v[212:215], a[192:195], a[152:155], v[212:215]
 v_mfma_f32_16x16x32_bf16 v[212:215], a[196:199], a[156:159], v[212:215]
 v_mfma_f32_16x16x32_bf16 v[208:211], a[196:199], a[148:151], v[208:211]
 v_mfma_f32_16x16x32_bf16 v[208:211], a[192:195], a[144:147], v[208:211]
 v_mfma_f32_16x16x32_bf16 v[204:207], a[192:195], a[136:139], v[204:207]
 v_mfma_f32_16x16x32_bf16 v[204:207], a[196:199], a[140:143], v[204:207]
 v_mfma_f32_16x16x32_bf16 v[200:203], a[196:199], a[132:135], v[200:203]
 v_mfma_f32_16x16x32_bf16 v[200:203], a[192:195], a[128:131], v[200:203]
 buffer_load_dwordx4 v6, s[8:11], s30 offen lds
 s_waitcnt vmcnt(11)
 v_mfma_f32_16x16x32_bf16 v[232:235], a[200:203], a[128:131], v[232:235]
 ds_read_b128 a[128:131], v2 offset:34816
 v_mfma_f32_16x16x32_bf16 v[232:235], a[204:207], a[132:135], v[232:235]
 global_load_dwordx4 a[196:199], v0, s[70:71] offset:-3072 sc1
 ds_read_b128 a[132:135], v2 offset:35840
 v_mfma_f32_16x16x32_bf16 v[236:239], a[204:207], a[140:143], v[236:239]
 ds_read_b128 a[140:143], v2 offset:39936
 v_mfma_f32_16x16x32_bf16 v[236:239], a[200:203], a[136:139], v[236:239]
 global_load_dwordx4 a[192:195], v0, s[70:71] offset:-4096 sc1
 ds_read_b128 a[136:139], v2 offset:38912
 v_mfma_f32_16x16x32_bf16 v[240:243], a[200:203], a[144:147], v[240:243]
 ds_read_b128 a[144:147], v2 offset:43008
 v_mfma_f32_16x16x32_bf16 v[240:243], a[204:207], a[148:151], v[240:243]
 ds_read_b128 a[148:151], v2 offset:44032
 v_mfma_f32_16x16x32_bf16 v[244:247], a[204:207], a[156:159], v[244:247]
 ds_read_b128 a[156:159], v2 offset:48128
 v_mfma_f32_16x16x32_bf16 v[244:247], a[200:203], a[152:155], v[244:247]
 ds_read_b128 a[152:155], v2 offset:47104
 s_add_u32 m0, m0, 1024
 v_mfma_f32_16x16x32_bf16 v[248:251], a[200:203], a[160:163], v[248:251]
 ds_read_b128 a[160:163], v2 offset:51200
 v_mfma_f32_16x16x32_bf16 v[248:251], a[204:207], a[164:167], v[248:251]
 ds_read_b128 a[164:167], v2 offset:52224
 v_mfma_f32_16x16x32_bf16 v[252:255], a[204:207], a[172:175], v[252:255]
 ds_read_b128 a[172:175], v2 offset:56320
 s_add_u32 s30, s30, s20
 v_mfma_f32_16x16x32_bf16 v[252:255], a[200:203], a[168:171], v[252:255]
 ds_read_b128 a[168:171], v2 offset:55296
 v_mfma_f32_16x16x32_bf16 a[248:251], a[200:203], a[176:179], a[248:251]
 ds_read_b128 a[176:179], v2 offset:59392
 v_mfma_f32_16x16x32_bf16 a[248:251], a[204:207], a[180:183], a[248:251]
 ds_read_b128 a[180:183], v2 offset:60416
 v_mfma_f32_16x16x32_bf16 a[252:255], a[204:207], a[188:191], a[252:255]
 ds_read_b128 a[188:191], v2 offset:64512
 v_mfma_f32_16x16x32_bf16 a[252:255], a[200:203], a[184:187], a[252:255]
 ds_read_b128 a[184:187], v2 offset:63488
 s_waitcnt vmcnt(11) lgkmcnt(8)
 v_mfma_f32_16x16x32_bf16 v[16:19], a[208:211], a[128:131], v[16:19]
 buffer_load_dwordx4 v6, s[8:11], s30 offen lds
 v_mfma_f32_16x16x32_bf16 v[16:19], a[212:215], a[132:135], v[16:19]
 global_load_dwordx4 a[204:207], v0, s[70:71] offset:-1024 sc1
 s_add_u32 m0, m0, 3072
 v_mfma_f32_16x16x32_bf16 v[20:23], a[212:215], a[140:143], v[20:23]
 buffer_load_dword v4, off, s[64:67], 0 sc1
 v_mfma_f32_16x16x32_bf16 v[20:23], a[208:211], a[136:139], v[20:23]
 global_load_dwordx4 a[200:203], v0, s[70:71] offset:-2048 sc1
 v_mfma_f32_16x16x32_bf16 v[24:27], a[208:211], a[144:147], v[24:27]
 s_add_u32 s30, s30, s22
 v_mfma_f32_16x16x32_bf16 v[24:27], a[212:215], a[148:151], v[24:27]
 v_mfma_f32_16x16x32_bf16 v[28:31], a[212:215], a[156:159], v[28:31]
 v_mfma_f32_16x16x32_bf16 v[28:31], a[208:211], a[152:155], v[28:31]
 s_waitcnt lgkmcnt(0)
 v_mfma_f32_16x16x32_bf16 v[32:35], a[208:211], a[160:163], v[32:35]
 v_mfma_f32_16x16x32_bf16 v[32:35], a[212:215], a[164:167], v[32:35]
 v_mfma_f32_16x16x32_bf16 v[36:39], a[212:215], a[172:175], v[36:39]
 v_mfma_f32_16x16x32_bf16 v[36:39], a[208:211], a[168:171], v[36:39]
 v_mfma_f32_16x16x32_bf16 v[40:43], a[208:211], a[176:179], v[40:43]
 v_mfma_f32_16x16x32_bf16 v[40:43], a[212:215], a[180:183], v[40:43]
 v_mfma_f32_16x16x32_bf16 v[44:47], a[212:215], a[188:191], v[44:47]
 v_mfma_f32_16x16x32_bf16 v[44:47], a[208:211], a[184:187], v[44:47]
 s_waitcnt vmcnt(12)
 v_mfma_f32_16x16x32_bf16 v[76:79], a[216:219], a[184:187], v[76:79]
 v_lshrrev_b32 v5, 6, v1
 v_mfma_f32_16x16x32_bf16 v[76:79], a[220:223], a[188:191], v[76:79]
 global_load_dwordx4 a[212:215], v0, s[70:71] offset:1024 sc1
 v_mfma_f32_16x16x32_bf16 v[72:75], a[220:223], a[180:183], v[72:75]
 v_and_b32 v6, 48, v1
 v_mfma_f32_16x16x32_bf16 v[72:75], a[216:219], a[176:179], v[72:75]
 global_load_dwordx4 a[208:211], v0, s[70:71] offset:0 sc1
 v_lshl_add_u32 v5, v5, 11, v6
 v_mfma_f32_16x16x32_bf16 v[68:71], a[216:219], a[168:171], v[68:71]
 v_mfma_f32_16x16x32_bf16 v[68:71], a[220:223], a[172:175], v[68:71]
 s_mov_b32 m0, s52
 v_mfma_f32_16x16x32_bf16 v[64:67], a[220:223], a[164:167], v[64:67]
 s_add_u32 s3, s48, 31744
 v_mfma_f32_16x16x32_bf16 v[64:67], a[216:219], a[160:163], v[64:67]
 v_mfma_f32_16x16x32_bf16 v[60:63], a[216:219], a[152:155], v[60:63]
 buffer_load_dwordx4 v5, s[40:43], s48 offen lds
 v_mfma_f32_16x16x32_bf16 v[60:63], a[220:223], a[156:159], v[60:63]
 buffer_load_dwordx4 v5, s[40:43], s3 offen offset:1024 lds
 v_mfma_f32_16x16x32_bf16 v[56:59], a[220:223], a[148:151], v[56:59]
 v_mfma_f32_16x16x32_bf16 v[56:59], a[216:219], a[144:147], v[56:59]
 s_add_u32 s48, s48, 2097152
 v_mfma_f32_16x16x32_bf16 v[52:55], a[216:219], a[136:139], v[52:55]
 v_mfma_f32_16x16x32_bf16 v[52:55], a[220:223], a[140:143], v[52:55]
 v_mfma_f32_16x16x32_bf16 v[48:51], a[220:223], a[132:135], v[48:51]
 v_mfma_f32_16x16x32_bf16 v[48:51], a[216:219], a[128:131], v[48:51]
 s_waitcnt vmcnt(13)
 v_mfma_f32_16x16x32_bf16 v[80:83], a[224:227], a[128:131], v[80:83]
 v_mfma_f32_16x16x32_bf16 v[80:83], a[228:231], a[132:135], v[80:83]
 global_load_dwordx4 a[220:223], v0, s[70:71] offset:3072 sc1
 v_mfma_f32_16x16x32_bf16 v[84:87], a[228:231], a[140:143], v[84:87]
 v_mfma_f32_16x16x32_bf16 v[84:87], a[224:227], a[136:139], v[84:87]
 global_load_dwordx4 a[216:219], v0, s[70:71] offset:2048 sc1
 v_mfma_f32_16x16x32_bf16 v[88:91], a[224:227], a[144:147], v[88:91]
 s_add_u32 s70, s70, 8192
 s_addc_u32 s71, s71, 0
 v_mfma_f32_16x16x32_bf16 v[88:91], a[228:231], a[148:151], v[88:91]
 v_mfma_f32_16x16x32_bf16 v[92:95], a[228:231], a[156:159], v[92:95]
 v_mfma_f32_16x16x32_bf16 v[92:95], a[224:227], a[152:155], v[92:95]
 v_mfma_f32_16x16x32_bf16 v[96:99], a[224:227], a[160:163], v[96:99]
 v_mfma_f32_16x16x32_bf16 v[96:99], a[228:231], a[164:167], v[96:99]
 v_mfma_f32_16x16x32_bf16 v[100:103], a[228:231], a[172:175], v[100:103]
 v_mfma_f32_16x16x32_bf16 v[100:103], a[224:227], a[168:171], v[100:103]
 v_mfma_f32_16x16x32_bf16 v[104:107], a[224:227], a[176:179], v[104:107]
 v_mfma_f32_16x16x32_bf16 v[104:107], a[228:231], a[180:183], v[104:107]
 v_mfma_f32_16x16x32_bf16 v[108:111], a[228:231], a[188:191], v[108:111]
 v_mfma_f32_16x16x32_bf16 v[108:111], a[224:227], a[184:187], v[108:111]
 s_waitcnt vmcnt(13)
 v_mfma_f32_16x16x32_bf16 a[244:247], a[232:235], a[184:187], a[244:247]
 v_mfma_f32_16x16x32_bf16 a[244:247], a[236:239], a[188:191], a[244:247]
 global_load_dwordx4 a[228:231], v0, s[70:71] offset:-3072 sc1
 v_mfma_f32_16x16x32_bf16 a[240:243], a[236:239], a[180:183], a[240:243]
 v_mfma_f32_16x16x32_bf16 a[240:243], a[232:235], a[176:179], a[240:243]
 global_load_dwordx4 a[224:227], v0, s[70:71] offset:-4096 sc1
 v_mfma_f32_16x16x32_bf16 v[132:135], a[232:235], a[168:171], v[132:135]
 v_mfma_f32_16x16x32_bf16 v[132:135], a[236:239], a[172:175], v[132:135]
 v_mfma_f32_16x16x32_bf16 v[128:131], a[236:239], a[164:167], v[128:131]
 v_mfma_f32_16x16x32_bf16 v[128:131], a[232:235], a[160:163], v[128:131]
 v_mfma_f32_16x16x32_bf16 v[124:127], a[232:235], a[152:155], v[124:127]
 v_mfma_f32_16x16x32_bf16 v[124:127], a[236:239], a[156:159], v[124:127]
 v_mfma_f32_16x16x32_bf16 v[120:123], a[236:239], a[148:151], v[120:123]
 v_mfma_f32_16x16x32_bf16 v[120:123], a[232:235], a[144:147], v[120:123]
 v_mfma_f32_16x16x32_bf16 v[116:119], a[232:235], a[136:139], v[116:119]
 v_mfma_f32_16x16x32_bf16 v[116:119], a[236:239], a[140:143], v[116:119]
 v_mfma_f32_16x16x32_bf16 v[112:115], a[236:239], a[132:135], v[112:115]
 v_mfma_f32_16x16x32_bf16 v[112:115], a[232:235], a[128:131], v[112:115]
 s_waitcnt vmcnt(12)
 v_mfma_f32_16x16x32_bf16 v[136:139], a[192:195], a[128:131], v[136:139]
 v_mfma_f32_16x16x32_bf16 v[136:139], a[196:199], a[132:135], v[136:139]
 global_load_dwordx4 a[236:239], v0, s[70:71] offset:-1024 sc1
 v_mfma_f32_16x16x32_bf16 v[140:143], a[196:199], a[140:143], v[140:143]
 v_mfma_f32_16x16x32_bf16 v[140:143], a[192:195], a[136:139], v[140:143]
 global_load_dwordx4 a[232:235], v0, s[70:71] offset:-2048 sc1
 v_mfma_f32_16x16x32_bf16 v[144:147], a[192:195], a[144:147], v[144:147]
 v_mfma_f32_16x16x32_bf16 v[144:147], a[196:199], a[148:151], v[144:147]
 v_mfma_f32_16x16x32_bf16 v[148:151], a[196:199], a[156:159], v[148:151]
 v_mfma_f32_16x16x32_bf16 v[148:151], a[192:195], a[152:155], v[148:151]
 v_mfma_f32_16x16x32_bf16 v[152:155], a[192:195], a[160:163], v[152:155]
 v_mfma_f32_16x16x32_bf16 v[152:155], a[196:199], a[164:167], v[152:155]
 v_mfma_f32_16x16x32_bf16 v[156:159], a[196:199], a[172:175], v[156:159]
 v_mfma_f32_16x16x32_bf16 v[156:159], a[192:195], a[168:171], v[156:159]
 v_mfma_f32_16x16x32_bf16 v[160:163], a[192:195], a[176:179], v[160:163]
 v_mfma_f32_16x16x32_bf16 v[160:163], a[196:199], a[180:183], v[160:163]
 v_mfma_f32_16x16x32_bf16 v[164:167], a[196:199], a[188:191], v[164:167]
 v_mfma_f32_16x16x32_bf16 v[164:167], a[192:195], a[184:187], v[164:167]
 s_waitcnt vmcnt(10)
 v_mfma_f32_16x16x32_bf16 v[196:199], a[200:203], a[184:187], v[196:199]
 v_mfma_f32_16x16x32_bf16 v[196:199], a[204:207], a[188:191], v[196:199]
 global_load_dwordx4 a[196:199], v0, s[70:71] offset:1024 sc1
 v_mfma_f32_16x16x32_bf16 v[192:195], a[204:207], a[180:183], v[192:195]
 v_mfma_f32_16x16x32_bf16 v[192:195], a[200:203], a[176:179], v[192:195]
 global_load_dwordx4 a[192:195], v0, s[70:71] offset:0 sc1
 v_mfma_f32_16x16x32_bf16 v[188:191], a[200:203], a[168:171], v[188:191]
 v_mfma_f32_16x16x32_bf16 v[188:191], a[204:207], a[172:175], v[188:191]
 v_mfma_f32_16x16x32_bf16 v[184:187], a[204:207], a[164:167], v[184:187]
 v_mfma_f32_16x16x32_bf16 v[184:187], a[200:203], a[160:163], v[184:187]
 v_mfma_f32_16x16x32_bf16 v[180:183], a[200:203], a[152:155], v[180:183]
 v_mfma_f32_16x16x32_bf16 v[180:183], a[204:207], a[156:159], v[180:183]
 v_mfma_f32_16x16x32_bf16 v[176:179], a[204:207], a[148:151], v[176:179]
 v_mfma_f32_16x16x32_bf16 v[176:179], a[200:203], a[144:147], v[176:179]
 v_mfma_f32_16x16x32_bf16 v[172:175], a[200:203], a[136:139], v[172:175]
 v_mfma_f32_16x16x32_bf16 v[172:175], a[204:207], a[140:143], v[172:175]
 v_mfma_f32_16x16x32_bf16 v[168:171], a[204:207], a[132:135], v[168:171]
 v_mfma_f32_16x16x32_bf16 v[168:171], a[200:203], a[128:131], v[168:171]
 s_waitcnt vmcnt(10)
 v_mfma_f32_16x16x32_bf16 v[200:203], a[208:211], a[128:131], v[200:203]
 v_mfma_f32_16x16x32_bf16 v[200:203], a[212:215], a[132:135], v[200:203]
 global_load_dwordx4 a[204:207], v0, s[70:71] offset:3072 sc1
 v_mfma_f32_16x16x32_bf16 v[204:207], a[212:215], a[140:143], v[204:207]
 v_mfma_f32_16x16x32_bf16 v[204:207], a[208:211], a[136:139], v[204:207]
 global_load_dwordx4 a[200:203], v0, s[70:71] offset:2048 sc1
 v_mfma_f32_16x16x32_bf16 v[208:211], a[208:211], a[144:147], v[208:211]
 s_add_u32 s70, s70, 8192
 s_addc_u32 s71, s71, 0
 v_mfma_f32_16x16x32_bf16 v[208:211], a[212:215], a[148:151], v[208:211]
 v_mfma_f32_16x16x32_bf16 v[212:215], a[212:215], a[156:159], v[212:215]
 v_mfma_f32_16x16x32_bf16 v[212:215], a[208:211], a[152:155], v[212:215]
 v_mfma_f32_16x16x32_bf16 v[216:219], a[208:211], a[160:163], v[216:219]
 v_mfma_f32_16x16x32_bf16 v[216:219], a[212:215], a[164:167], v[216:219]
 v_mfma_f32_16x16x32_bf16 v[220:223], a[212:215], a[172:175], v[220:223]
 v_cmp_gt_i32 vcc, s55, v4
 s_and_b64 vcc, exec, vcc
 s_cbranch_vccnz Lspin_pb
Lok_pb:
 s_add_u32 s55, s55, 1
 s_waitcnt lgkmcnt(0)
 s_barrier
 v_mfma_f32_16x16x32_bf16 v[220:223], a[208:211], a[168:171], v[220:223]
 s_cmp_eq_u32 s25, 0
 s_cbranch_scc1 Lxrg
Lxrgr:
 v_mfma_f32_16x16x32_bf16 v[224:227], a[208:211], a[176:179], v[224:227]
 v_mfma_f32_16x16x32_bf16 v[224:227], a[212:215], a[180:183], v[224:227]
 v_mfma_f32_16x16x32_bf16 v[228:231], a[212:215], a[188:191], v[228:231]
 v_mfma_f32_16x16x32_bf16 v[228:231], a[208:211], a[184:187], v[228:231]
 s_waitcnt vmcnt(8)
 v_mfma_f32_16x16x32_bf16 a[252:255], a[216:219], a[184:187], a[252:255]
 ds_read_b128 a[184:187], v1 offset:28672
 v_mfma_f32_16x16x32_bf16 a[252:255], a[220:223], a[188:191], a[252:255]
 global_load_dwordx4 a[212:215], v0, s[70:71] offset:-3072 sc1
 ds_read_b128 a[188:191], v1 offset:29696
 v_mfma_f32_16x16x32_bf16 a[248:251], a[220:223], a[180:183], a[248:251]
 ds_read_b128 a[180:183], v1 offset:25600
 v_mfma_f32_16x16x32_bf16 a[248:251], a[216:219], a[176:179], a[248:251]
 global_load_dwordx4 a[208:211], v0, s[70:71] offset:-4096 sc1
 ds_read_b128 a[176:179], v1 offset:24576
 v_mfma_f32_16x16x32_bf16 v[252:255], a[216:219], a[168:171], v[252:255]
 ds_read_b128 a[168:171], v1 offset:20480
 v_mfma_f32_16x16x32_bf16 v[252:255], a[220:223], a[172:175], v[252:255]
 ds_read_b128 a[172:175], v1 offset:21504
 v_mfma_f32_16x16x32_bf16 v[248:251], a[220:223], a[164:167], v[248:251]
 ds_read_b128 a[164:167], v1 offset:17408
 v_mfma_f32_16x16x32_bf16 v[248:251], a[216:219], a[160:163], v[248:251]
 ds_read_b128 a[160:163], v1 offset:16384
 v_mfma_f32_16x16x32_bf16 v[244:247], a[216:219], a[152:155], v[244:247]
 ds_read_b128 a[152:155], v1 offset:12288
 v_mfma_f32_16x16x32_bf16 v[244:247], a[220:223], a[156:159], v[244:247]
 ds_read_b128 a[156:159], v1 offset:13312
 v_mfma_f32_16x16x32_bf16 v[240:243], a[220:223], a[148:151], v[240:243]
 ds_read_b128 a[148:151], v1 offset:9216
 v_mfma_f32_16x16x32_bf16 v[240:243], a[216:219], a[144:147], v[240:243]
 ds_read_b128 a[144:147], v1 offset:8192
 v_mfma_f32_16x16x32_bf16 v[236:239], a[216:219], a[136:139], v[236:239]
 ds_read_b128 a[136:139], v1 offset:4096
 v_mfma_f32_16x16x32_bf16 v[236:239], a[220:223], a[140:143], v[236:239]
 ds_read_b128 a[140:143], v1 offset:5120
 v_mfma_f32_16x16x32_bf16 v[232:235], a[220:223], a[132:135], v[232:235]
 global_load_dwordx4 a[220:223], v0, s[70:71] offset:-1024 sc1
 ds_read_b128 a[132:135], v1 offset:1024
 v_mfma_f32_16x16x32_bf16 v[232:235], a[216:219], a[128:131], v[232:235]
 global_load_dwordx4 a[216:219], v0, s[70:71] offset:-2048 sc1
 ds_read_b128 a[128:131], v1
 s_waitcnt vmcnt(10) lgkmcnt(8)
 v_mfma_f32_16x16x32_bf16 v[44:47], a[224:227], a[184:187], v[44:47]
 v_mfma_f32_16x16x32_bf16 v[44:47], a[228:231], a[188:191], v[44:47]
 v_mov_b32 v6, v3
 s_cmp_eq_u32 s25, 0
 s_cbranch_scc1 Lgat1
Lgatr1:
 v_mfma_f32_16x16x32_bf16 v[40:43], a[228:231], a[180:183], v[40:43]
 v_mfma_f32_16x16x32_bf16 v[40:43], a[224:227], a[176:179], v[40:43]
 v_mfma_f32_16x16x32_bf16 v[36:39], a[224:227], a[168:171], v[36:39]
 v_mfma_f32_16x16x32_bf16 v[36:39], a[228:231], a[172:175], v[36:39]
 s_add_u32 m0, s50, 2048
 v_mfma_f32_16x16x32_bf16 v[32:35], a[228:231], a[164:167], v[32:35]
 v_mfma_f32_16x16x32_bf16 v[32:35], a[224:227], a[160:163], v[32:35]
 s_waitcnt lgkmcnt(0)
 v_mfma_f32_16x16x32_bf16 v[28:31], a[224:227], a[152:155], v[28:31]
 v_mfma_f32_16x16x32_bf16 v[28:31], a[228:231], a[156:159], v[28:31]
 v_mfma_f32_16x16x32_bf16 v[24:27], a[228:231], a[148:151], v[24:27]
 v_mfma_f32_16x16x32_bf16 v[24:27], a[224:227], a[144:147], v[24:27]
 v_mfma_f32_16x16x32_bf16 v[20:23], a[224:227], a[136:139], v[20:23]
 buffer_load_dwordx4 v6, s[8:11], s30 offen lds
 v_mfma_f32_16x16x32_bf16 v[20:23], a[228:231], a[140:143], v[20:23]
 v_mfma_f32_16x16x32_bf16 v[16:19], a[228:231], a[132:135], v[16:19]
 v_mfma_f32_16x16x32_bf16 v[16:19], a[224:227], a[128:131], v[16:19]
 s_waitcnt vmcnt(9)
 v_mfma_f32_16x16x32_bf16 v[48:51], a[232:235], a[128:131], v[48:51]
 s_add_u32 m0, m0, 1024
 v_mfma_f32_16x16x32_bf16 v[48:51], a[236:239], a[132:135], v[48:51]
 global_load_dwordx4 a[228:231], v0, s[70:71] offset:1024 sc1
 v_mfma_f32_16x16x32_bf16 v[52:55], a[236:239], a[140:143], v[52:55]
 v_mfma_f32_16x16x32_bf16 v[52:55], a[232:235], a[136:139], v[52:55]
 global_load_dwordx4 a[224:227], v0, s[70:71] offset:0 sc1
 s_add_u32 s30, s30, s20
 v_mfma_f32_16x16x32_bf16 v[56:59], a[232:235], a[144:147], v[56:59]
 v_mfma_f32_16x16x32_bf16 v[56:59], a[236:239], a[148:151], v[56:59]
 v_mfma_f32_16x16x32_bf16 v[60:63], a[236:239], a[156:159], v[60:63]
 v_mfma_f32_16x16x32_bf16 v[60:63], a[232:235], a[152:155], v[60:63]
 buffer_load_dwordx4 v6, s[8:11], s30 offen lds
 v_mfma_f32_16x16x32_bf16 v[64:67], a[232:235], a[160:163], v[64:67]
 v_mfma_f32_16x16x32_bf16 v[64:67], a[236:239], a[164:167], v[64:67]
 v_mfma_f32_16x16x32_bf16 v[68:71], a[236:239], a[172:175], v[68:71]
 v_mfma_f32_16x16x32_bf16 v[68:71], a[232:235], a[168:171], v[68:71]
 s_add_u32 m0, m0, 3072
 v_mfma_f32_16x16x32_bf16 v[72:75], a[232:235], a[176:179], v[72:75]
 v_mfma_f32_16x16x32_bf16 v[72:75], a[236:239], a[180:183], v[72:75]
 v_mfma_f32_16x16x32_bf16 v[76:79], a[236:239], a[188:191], v[76:79]
 s_add_u32 s30, s30, s21
 v_mfma_f32_16x16x32_bf16 v[76:79], a[232:235], a[184:187], v[76:79]
 s_waitcnt vmcnt(10)
 v_mfma_f32_16x16x32_bf16 v[108:111], a[192:195], a[184:187], v[108:111]
 v_mfma_f32_16x16x32_bf16 v[108:111], a[196:199], a[188:191], v[108:111]
 global_load_dwordx4 a[236:239], v0, s[70:71] offset:3072 sc1
 v_mfma_f32_16x16x32_bf16 v[104:107], a[196:199], a[180:183], v[104:107]
 v_mfma_f32_16x16x32_bf16 v[104:107], a[192:195], a[176:179], v[104:107]
 global_load_dwordx4 a[232:235], v0, s[70:71] offset:2048 sc1
 v_mfma_f32_16x16x32_bf16 v[100:103], a[192:195], a[168:171], v[100:103]
 s_add_u32 s70, s70, 8192
 s_addc_u32 s71, s71, 0
 v_mfma_f32_16x16x32_bf16 v[100:103], a[196:199], a[172:175], v[100:103]
 v_mfma_f32_16x16x32_bf16 v[96:99], a[196:199], a[164:167], v[96:99]
 v_mfma_f32_16x16x32_bf16 v[96:99], a[192:195], a[160:163], v[96:99]
 v_mfma_f32_16x16x32_bf16 v[92:95], a[192:195], a[152:155], v[92:95]
 v_mfma_f32_16x16x32_bf16 v[92:95], a[196:199], a[156:159], v[92:95]
 v_mfma_f32_16x16x32_bf16 v[88:91], a[196:199], a[148:151], v[88:91]
 v_mfma_f32_16x16x32_bf16 v[88:91], a[192:195], a[144:147], v[88:91]
 v_mfma_f32_16x16x32_bf16 v[84:87], a[192:195], a[136:139], v[84:87]
 v_mfma_f32_16x16x32_bf16 v[84:87], a[196:199], a[140:143], v[84:87]
 v_mfma_f32_16x16x32_bf16 v[80:83], a[196:199], a[132:135], v[80:83]
 v_mfma_f32_16x16x32_bf16 v[80:83], a[192:195], a[128:131], v[80:83]
 s_waitcnt vmcnt(10)
 v_mfma_f32_16x16x32_bf16 v[112:115], a[200:203], a[128:131], v[112:115]
 v_mfma_f32_16x16x32_bf16 v[112:115], a[204:207], a[132:135], v[112:115]
 global_load_dwordx4 a[196:199], v0, s[70:71] offset:-3072 sc1
 v_mfma_f32_16x16x32_bf16 v[116:119], a[204:207], a[140:143], v[116:119]
 v_mfma_f32_16x16x32_bf16 v[116:119], a[200:203], a[136:139], v[116:119]
 global_load_dwordx4 a[192:195], v0, s[70:71] offset:-4096 sc1
 v_mfma_f32_16x16x32_bf16 v[120:123], a[200:203], a[144:147], v[120:123]
 v_mfma_f32_16x16x32_bf16 v[120:123], a[204:207], a[148:151], v[120:123]
 v_mfma_f32_16x16x32_bf16 v[124:127], a[204:207], a[156:159], v[124:127]
 v_mfma_f32_16x16x32_bf16 v[124:127], a[200:203], a[152:155], v[124:127]
 v_mfma_f32_16x16x32_bf16 v[128:131], a[200:203], a[160:163], v[128:131]
 v_mfma_f32_16x16x32_bf16 v[128:131], a[204:207], a[164:167], v[128:131]
 v_mfma_f32_16x16x32_bf16 v[132:135], a[204:207], a[172:175], v[132:135]
 v_mfma_f32_16x16x32_bf16 v[132:135], a[200:203], a[168:171], v[132:135]
 v_mfma_f32_16x16x32_bf16 a[240:243], a[200:203], a[176:179], a[240:243]
 v_mfma_f32_16x16x32_bf16 a[240:243], a[204:207], a[180:183], a[240:243]
 v_mfma_f32_16x16x32_bf16 a[244:247], a[204:207], a[188:191], a[244:247]
 v_mfma_f32_16x16x32_bf16 a[244:247], a[200:203], a[184:187], a[244:247]
 s_waitcnt vmcnt(10)
 v_mfma_f32_16x16x32_bf16 v[164:167], a[208:211], a[184:187], v[164:167]
 v_mfma_f32_16x16x32_bf16 v[164:167], a[212:215], a[188:191], v[164:167]
 global_load_dwordx4 a[204:207], v0, s[70:71] offset:-1024 sc1
 v_mfma_f32_16x16x32_bf16 v[160:163], a[212:215], a[180:183], v[160:163]
 v_mfma_f32_16x16x32_bf16 v[160:163], a[208:211], a[176:179], v[160:163]
 global_load_dwordx4 a[200:203], v0, s[70:71] offset:-2048 sc1
 v_mfma_f32_16x16x32_bf16 v[156:159], a[208:211], a[168:171], v[156:159]
 v_mfma_f32_16x16x32_bf16 v[156:159], a[212:215], a[172:175], v[156:159]
 v_mfma_f32_16x16x32_bf16 v[152:155], a[212:215], a[164:167], v[152:155]
 buffer_load_dwordx4 v6, s[8:11], s30 offen lds
 v_mfma_f32_16x16x32_bf16 v[152:155], a[208:211], a[160:163], v[152:155]
 v_mfma_f32_16x16x32_bf16 v[148:151], a[208:211], a[152:155], v[148:151]
 v_mfma_f32_16x16x32_bf16 v[148:151], a[212:215], a[156:159], v[148:151]
 v_mfma_f32_16x16x32_bf16 v[144:147], a[212:215], a[148:151], v[144:147]
 s_add_u32 m0, m0, 1024
 v_mfma_f32_16x16x32_bf16 v[144:147], a[208:211], a[144:147], v[144:147]
 v_mfma_f32_16x16x32_bf16 v[140:143], a[208:211], a[136:139], v[140:143]
 v_mfma_f32_16x16x32_bf16 v[140:143], a[212:215], a[140:143], v[140:143]
 v_mfma_f32_16x16x32_bf16 v[136:139], a[212:215], a[132:135], v[136:139]
 s_add_u32 s30, s30, s20
 v_mfma_f32_16x16x32_bf16 v[136:139], a[208:211], a[128:131], v[136:139]
 s_waitcnt vmcnt(11)
 v_mfma_f32_16x16x32_bf16 v[168:171], a[216:219], a[128:131], v[168:171]
 v_mfma_f32_16x16x32_bf16 v[168:171], a[220:223], a[132:135], v[168:171]
 global_load_dwordx4 a[212:215], v0, s[70:71] offset:1024 sc1
 v_mfma_f32_16x16x32_bf16 v[172:175], a[220:223], a[140:143], v[172:175]
 buffer_load_dwordx4 v6, s[8:11], s30 offen lds
 v_mfma_f32_16x16x32_bf16 v[172:175], a[216:219], a[136:139], v[172:175]
 global_load_dwordx4 a[208:211], v0, s[70:71] offset:0 sc1
 v_mfma_f32_16x16x32_bf16 v[176:179], a[216:219], a[144:147], v[176:179]
 v_mfma_f32_16x16x32_bf16 v[176:179], a[220:223], a[148:151], v[176:179]
 s_add_u32 m0, m0, 3072
 v_mfma_f32_16x16x32_bf16 v[180:183], a[220:223], a[156:159], v[180:183]
 v_mfma_f32_16x16x32_bf16 v[180:183], a[216:219], a[152:155], v[180:183]
 v_mfma_f32_16x16x32_bf16 v[184:187], a[216:219], a[160:163], v[184:187]
 v_mfma_f32_16x16x32_bf16 v[184:187], a[220:223], a[164:167], v[184:187]
 s_add_u32 s30, s30, s21
 v_mfma_f32_16x16x32_bf16 v[188:191], a[220:223], a[172:175], v[188:191]
 v_mfma_f32_16x16x32_bf16 v[188:191], a[216:219], a[168:171], v[188:191]
 v_mfma_f32_16x16x32_bf16 v[192:195], a[216:219], a[176:179], v[192:195]
 v_mfma_f32_16x16x32_bf16 v[192:195], a[220:223], a[180:183], v[192:195]
 v_mfma_f32_16x16x32_bf16 v[196:199], a[220:223], a[188:191], v[196:199]
 v_mfma_f32_16x16x32_bf16 v[196:199], a[216:219], a[184:187], v[196:199]
 s_waitcnt vmcnt(11)
 v_mfma_f32_16x16x32_bf16 v[228:231], a[224:227], a[184:187], v[228:231]
 v_mfma_f32_16x16x32_bf16 v[228:231], a[228:231], a[188:191], v[228:231]
 global_load_dwordx4 a[220:223], v0, s[70:71] offset:3072 sc1
 v_mfma_f32_16x16x32_bf16 v[224:227], a[228:231], a[180:183], v[224:227]
 v_mfma_f32_16x16x32_bf16 v[224:227], a[224:227], a[176:179], v[224:227]
 global_load_dwordx4 a[216:219], v0, s[70:71] offset:2048 sc1
 v_mfma_f32_16x16x32_bf16 v[220:223], a[224:227], a[168:171], v[220:223]
 s_add_u32 s70, s70, 8192
 s_addc_u32 s71, s71, 0
 v_mfma_f32_16x16x32_bf16 v[220:223], a[228:231], a[172:175], v[220:223]
 v_mfma_f32_16x16x32_bf16 v[216:219], a[228:231], a[164:167], v[216:219]
 v_mfma_f32_16x16x32_bf16 v[216:219], a[224:227], a[160:163], v[216:219]
 v_mfma_f32_16x16x32_bf16 v[212:215], a[224:227], a[152:155], v[212:215]
 v_mfma_f32_16x16x32_bf16 v[212:215], a[228:231], a[156:159], v[212:215]
 v_mfma_f32_16x16x32_bf16 v[208:211], a[228:231], a[148:151], v[208:211]
 v_mfma_f32_16x16x32_bf16 v[208:211], a[224:227], a[144:147], v[208:211]
 v_mfma_f32_16x16x32_bf16 v[204:207], a[224:227], a[136:139], v[204:207]
 v_mfma_f32_16x16x32_bf16 v[204:207], a[228:231], a[140:143], v[204:207]
 v_mfma_f32_16x16x32_bf16 v[200:203], a[228:231], a[132:135], v[200:203]
 v_mfma_f32_16x16x32_bf16 v[200:203], a[224:227], a[128:131], v[200:203]
 s_waitcnt vmcnt(10)
 v_mfma_f32_16x16x32_bf16 v[232:235], a[232:235], a[128:131], v[232:235]
 ds_read_b128 a[128:131], v1 offset:32768
 v_mfma_f32_16x16x32_bf16 v[232:235], a[236:239], a[132:135], v[232:235]
 global_load_dwordx4 a[228:231], v0, s[70:71] offset:-3072 sc1
 ds_read_b128 a[132:135], v1 offset:33792
 v_mfma_f32_16x16x32_bf16 v[236:239], a[236:239], a[140:143], v[236:239]
 ds_read_b128 a[140:143], v1 offset:37888
 v_mfma_f32_16x16x32_bf16 v[236:239], a[232:235], a[136:139], v[236:239]
 global_load_dwordx4 a[224:227], v0, s[70:71] offset:-4096 sc1
 ds_read_b128 a[136:139], v1 offset:36864
 v_mfma_f32_16x16x32_bf16 v[240:243], a[232:235], a[144:147], v[240:243]
 ds_read_b128 a[144:147], v1 offset:40960
 v_mfma_f32_16x16x32_bf16 v[240:243], a[236:239], a[148:151], v[240:243]
 ds_read_b128 a[148:151], v1 offset:41984
 v_mfma_f32_16x16x32_bf16 v[244:247], a[236:239], a[156:159], v[244:247]
 ds_read_b128 a[156:159], v1 offset:46080
 v_mfma_f32_16x16x32_bf16 v[244:247], a[232:235], a[152:155], v[244:247]
 ds_read_b128 a[152:155], v1 offset:45056
 v_mfma_f32_16x16x32_bf16 v[248:251], a[232:235], a[160:163], v[248:251]
 ds_read_b128 a[160:163], v1 offset:49152
 v_mfma_f32_16x16x32_bf16 v[248:251], a[236:239], a[164:167], v[248:251]
 ds_read_b128 a[164:167], v1 offset:50176
 v_mfma_f32_16x16x32_bf16 v[252:255], a[236:239], a[172:175], v[252:255]
 ds_read_b128 a[172:175], v1 offset:54272
 v_mfma_f32_16x16x32_bf16 v[252:255], a[232:235], a[168:171], v[252:255]
 ds_read_b128 a[168:171], v1 offset:53248
 v_mfma_f32_16x16x32_bf16 a[248:251], a[232:235], a[176:179], a[248:251]
 ds_read_b128 a[176:179], v1 offset:57344
 v_mfma_f32_16x16x32_bf16 a[248:251], a[236:239], a[180:183], a[248:251]
 ds_read_b128 a[180:183], v1 offset:58368
 v_mfma_f32_16x16x32_bf16 a[252:255], a[236:239], a[188:191], a[252:255]
 ds_read_b128 a[188:191], v1 offset:62464
 v_mfma_f32_16x16x32_bf16 a[252:255], a[232:235], a[184:187], a[252:255]
 ds_read_b128 a[184:187], v1 offset:61440
 s_waitcnt vmcnt(10) lgkmcnt(8)
 v_mfma_f32_16x16x32_bf16 v[16:19], a[192:195], a[128:131], v[16:19]
 v_mfma_f32_16x16x32_bf16 v[16:19], a[196:199], a[132:135], v[16:19]
 buffer_load_dwordx4 v6, s[8:11], s30 offen lds
 v_mfma_f32_16x16x32_bf16 v[20:23], a[196:199], a[140:143], v[20:23]
 v_mfma_f32_16x16x32_bf16 v[20:23], a[192:195], a[136:139], v[20:23]
 v_mfma_f32_16x16x32_bf16 v[24:27], a[192:195], a[144:147], v[24:27]
 s_add_u32 m0, m0, 1024
 v_mfma_f32_16x16x32_bf16 v[24:27], a[196:199], a[148:151], v[24:27]
 v_mfma_f32_16x16x32_bf16 v[28:31], a[196:199], a[156:159], v[28:31]
 v_mfma_f32_16x16x32_bf16 v[28:31], a[192:195], a[152:155], v[28:31]
 s_waitcnt lgkmcnt(0)
 v_mfma_f32_16x16x32_bf16 v[32:35], a[192:195], a[160:163], v[32:35]
 s_add_u32 s30, s30, s20
 v_mfma_f32_16x16x32_bf16 v[32:35], a[196:199], a[164:167], v[32:35]
 v_mfma_f32_16x16x32_bf16 v[36:39], a[196:199], a[172:175], v[36:39]
 v_mfma_f32_16x16x32_bf16 v[36:39], a[192:195], a[168:171], v[36:39]
 v_mfma_f32_16x16x32_bf16 v[40:43], a[192:195], a[176:179], v[40:43]
 buffer_load_dwordx4 v6, s[8:11], s30 offen lds
 v_mfma_f32_16x16x32_bf16 v[40:43], a[196:199], a[180:183], v[40:43]
 v_mfma_f32_16x16x32_bf16 v[44:47], a[196:199], a[188:191], v[44:47]
 v_mfma_f32_16x16x32_bf16 v[44:47], a[192:195], a[184:187], v[44:47]
 s_add_u32 m0, m0, 3072
 s_waitcnt vmcnt(10)
 v_mfma_f32_16x16x32_bf16 v[76:79], a[200:203], a[184:187], v[76:79]
 v_mfma_f32_16x16x32_bf16 v[76:79], a[204:207], a[188:191], v[76:79]
 global_load_dwordx4 a[196:199], v0, s[70:71] offset:-1024 sc1
 v_mfma_f32_16x16x32_bf16 v[72:75], a[204:207], a[180:183], v[72:75]
 v_mfma_f32_16x16x32_bf16 v[72:75], a[200:203], a[176:179], v[72:75]
 global_load_dwordx4 a[192:195], v0, s[70:71] offset:-2048 sc1
 s_add_u32 s30, s30, s21
 v_mfma_f32_16x16x32_bf16 v[68:71], a[200:203], a[168:171], v[68:71]
 v_mfma_f32_16x16x32_bf16 v[68:71], a[204:207], a[172:175], v[68:71]
 v_mfma_f32_16x16x32_bf16 v[64:67], a[204:207], a[164:167], v[64:67]
 v_mfma_f32_16x16x32_bf16 v[64:67], a[200:203], a[160:163], v[64:67]
 v_mfma_f32_16x16x32_bf16 v[60:63], a[200:203], a[152:155], v[60:63]
 v_mfma_f32_16x16x32_bf16 v[60:63], a[204:207], a[156:159], v[60:63]
 v_mfma_f32_16x16x32_bf16 v[56:59], a[204:207], a[148:151], v[56:59]
 v_mfma_f32_16x16x32_bf16 v[56:59], a[200:203], a[144:147], v[56:59]
 v_mfma_f32_16x16x32_bf16 v[52:55], a[200:203], a[136:139], v[52:55]
 v_mfma_f32_16x16x32_bf16 v[52:55], a[204:207], a[140:143], v[52:55]
 v_mfma_f32_16x16x32_bf16 v[48:51], a[204:207], a[132:135], v[48:51]
 v_mfma_f32_16x16x32_bf16 v[48:51], a[200:203], a[128:131], v[48:51]
 s_waitcnt vmcnt(8)
 v_mfma_f32_16x16x32_bf16 v[80:83], a[208:211], a[128:131], v[80:83]
 v_mfma_f32_16x16x32_bf16 v[80:83], a[212:215], a[132:135], v[80:83]
 global_load_dwordx4 a[204:207], v0, s[70:71] offset:1024 sc1
 v_mfma_f32_16x16x32_bf16 v[84:87], a[212:215], a[140:143], v[84:87]
 v_mfma_f32_16x16x32_bf16 v[84:87], a[208:211], a[136:139], v[84:87]
 global_load_dwordx4 a[200:203], v0, s[70:71] offset:0 sc1
 v_mfma_f32_16x16x32_bf16 v[88:91], a[208:211], a[144:147], v[88:91]
 v_mfma_f32_16x16x32_bf16 v[88:91], a[212:215], a[148:151], v[88:91]
 v_mfma_f32_16x16x32_bf16 v[92:95], a[212:215], a[156:159], v[92:95]
 v_mfma_f32_16x16x32_bf16 v[92:95], a[208:211], a[152:155], v[92:95]
 v_mfma_f32_16x16x32_bf16 v[96:99], a[208:211], a[160:163], v[96:99]
 v_mfma_f32_16x16x32_bf16 v[96:99], a[212:215], a[164:167], v[96:99]
 v_mfma_f32_16x16x32_bf16 v[100:103], a[212:215], a[172:175], v[100:103]
 v_mfma_f32_16x16x32_bf16 v[100:103], a[208:211], a[168:171], v[100:103]
 v_mfma_f32_16x16x32_bf16 v[104:107], a[208:211], a[176:179], v[104:107]
 v_mfma_f32_16x16x32_bf16 v[104:107], a[212:215], a[180:183], v[104:107]
 v_mfma_f32_16x16x32_bf16 v[108:111], a[212:215], a[188:191], v[108:111]
 v_mfma_f32_16x16x32_bf16 v[108:111], a[208:211], a[184:187], v[108:111]
 s_waitcnt vmcnt(8)
 v_mfma_f32_16x16x32_bf16 a[244:247], a[216:219], a[184:187], a[244:247]
 v_mfma_f32_16x16x32_bf16 a[244:247], a[220:223], a[188:191], a[244:247]
 global_load_dwordx4 a[212:215], v0, s[70:71] offset:3072 sc1
 v_mfma_f32_16x16x32_bf16 a[240:243], a[220:223], a[180:183], a[240:243]
 v_mfma_f32_16x16x32_bf16 a[240:243], a[216:219], a[176:179], a[240:243]
 global_load_dwordx4 a[208:211], v0, s[70:71] offset:2048 sc1
 v_mfma_f32_16x16x32_bf16 v[132:135], a[216:219], a[168:171], v[132:135]
 s_add_u32 s70, s70, 8192
 s_addc_u32 s71, s71, 0
 v_mfma_f32_16x16x32_bf16 v[132:135], a[220:223], a[172:175], v[132:135]
 v_mfma_f32_16x16x32_bf16 v[128:131], a[220:223], a[164:167], v[128:131]
 v_mfma_f32_16x16x32_bf16 v[128:131], a[216:219], a[160:163], v[128:131]
 v_mfma_f32_16x16x32_bf16 v[124:127], a[216:219], a[152:155], v[124:127]
 v_mfma_f32_16x16x32_bf16 v[124:127], a[220:223], a[156:159], v[124:127]
 v_mfma_f32_16x16x32_bf16 v[120:123], a[220:223], a[148:151], v[120:123]
 v_mfma_f32_16x16x32_bf16 v[120:123], a[216:219], a[144:147], v[120:123]
 buffer_load_dwordx4 v6, s[8:11], s30 offen lds
 v_mfma_f32_16x16x32_bf16 v[116:119], a[216:219], a[136:139], v[116:119]
 v_mfma_f32_16x16x32_bf16 v[116:119], a[220:223], a[140:143], v[116:119]
 v_mfma_f32_16x16x32_bf16 v[112:115], a[220:223], a[132:135], v[112:115]
 s_add_u32 m0, m0, 1024
 v_mfma_f32_16x16x32_bf16 v[112:115], a[216:219], a[128:131], v[112:115]
 s_waitcnt vmcnt(9)
 v_mfma_f32_16x16x32_bf16 v[136:139], a[224:227], a[128:131], v[136:139]
 v_mfma_f32_16x16x32_bf16 v[136:139], a[228:231], a[132:135], v[136:139]
 global_load_dwordx4 a[220:223], v0, s[70:71] offset:-3072 sc1
 v_mfma_f32_16x16x32_bf16 v[140:143], a[228:231], a[140:143], v[140:143]
 s_add_u32 s30, s30, s20
 v_mfma_f32_16x16x32_bf16 v[140:143], a[224:227], a[136:139], v[140:143]
 global_load_dwordx4 a[216:219], v0, s[70:71] offset:-4096 sc1
 v_mfma_f32_16x16x32_bf16 v[144:147], a[224:227], a[144:147], v[144:147]
 v_mfma_f32_16x16x32_bf16 v[144:147], a[228:231], a[148:151], v[144:147]
 v_mfma_f32_16x16x32_bf16 v[148:151], a[228:231], a[156:159], v[148:151]
 buffer_load_dwordx4 v6, s[8:11], s30 offen lds
 v_mfma_f32_16x16x32_bf16 v[148:151], a[224:227], a[152:155], v[148:151]
 v_mfma_f32_16x16x32_bf16 v[152:155], a[224:227], a[160:163], v[152:155]
 v_mfma_f32_16x16x32_bf16 v[152:155], a[228:231], a[164:167], v[152:155]
 s_add_u32 m0, m0, 3072
 v_mfma_f32_16x16x32_bf16 v[156:159], a[228:231], a[172:175], v[156:159]
 v_mfma_f32_16x16x32_bf16 v[156:159], a[224:227], a[168:171], v[156:159]
 v_mfma_f32_16x16x32_bf16 v[160:163], a[224:227], a[176:179], v[160:163]
 v_mfma_f32_16x16x32_bf16 v[160:163], a[228:231], a[180:183], v[160:163]
 s_add_u32 s30, s30, s21
 v_mfma_f32_16x16x32_bf16 v[164:167], a[228:231], a[188:191], v[164:167]
 v_mfma_f32_16x16x32_bf16 v[164:167], a[224:227], a[184:187], v[164:167]
 s_waitcnt vmcnt(8)
 v_mfma_f32_16x16x32_bf16 v[196:199], a[192:195], a[184:187], v[196:199]
 v_mfma_f32_16x16x32_bf16 v[196:199], a[196:199], a[188:191], v[196:199]
 global_load_dwordx4 a[228:231], v0, s[70:71] offset:-1024 sc1
 v_mfma_f32_16x16x32_bf16 v[192:195], a[196:199], a[180:183], v[192:195]
 v_mfma_f32_16x16x32_bf16 v[192:195], a[192:195], a[176:179], v[192:195]
 global_load_dwordx4 a[224:227], v0, s[70:71] offset:-2048 sc1
 v_mfma_f32_16x16x32_bf16 v[188:191], a[192:195], a[168:171], v[188:191]
 v_mfma_f32_16x16x32_bf16 v[188:191], a[196:199], a[172:175], v[188:191]
 v_mfma_f32_16x16x32_bf16 v[184:187], a[196:199], a[164:167], v[184:187]
 v_mfma_f32_16x16x32_bf16 v[184:187], a[192:195], a[160:163], v[184:187]
 v_mfma_f32_16x16x32_bf16 v[180:183], a[192:195], a[152:155], v[180:183]
 v_mfma_f32_16x16x32_bf16 v[180:183], a[196:199], a[156:159], v[180:183]
 v_mfma_f32_16x16x32_bf16 v[176:179], a[196:199], a[148:151], v[176:179]
 v_mfma_f32_16x16x32_bf16 v[176:179], a[192:195], a[144:147], v[176:179]
 v_mfma_f32_16x16x32_bf16 v[172:175], a[192:195], a[136:139], v[172:175]
 v_mfma_f32_16x16x32_bf16 v[172:175], a[196:199], a[140:143], v[172:175]
 v_mfma_f32_16x16x32_bf16 v[168:171], a[196:199], a[132:135], v[168:171]
 v_mfma_f32_16x16x32_bf16 v[168:171], a[192:195], a[128:131], v[168:171]
 s_waitcnt vmcnt(8)
 v_mfma_f32_16x16x32_bf16 v[200:203], a[200:203], a[128:131], v[200:203]
 v_mfma_f32_16x16x32_bf16 v[200:203], a[204:207], a[132:135], v[200:203]
 global_load_dwordx4 a[196:199], v0, s[70:71] offset:1024 sc1
 v_mfma_f32_16x16x32_bf16 v[204:207], a[204:207], a[140:143], v[204:207]
 v_mfma_f32_16x16x32_bf16 v[204:207], a[200:203], a[136:139], v[204:207]
 global_load_dwordx4 a[192:195], v0, s[70:71] offset:0 sc1
 v_mfma_f32_16x16x32_bf16 v[208:211], a[200:203], a[144:147], v[208:211]
 v_mfma_f32_16x16x32_bf16 v[208:211], a[204:207], a[148:151], v[208:211]
 v_mfma_f32_16x16x32_bf16 v[212:215], a[204:207], a[156:159], v[212:215]
 v_mfma_f32_16x16x32_bf16 v[212:215], a[200:203], a[152:155], v[212:215]
 v_mfma_f32_16x16x32_bf16 v[216:219], a[200:203], a[160:163], v[216:219]
 v_mfma_f32_16x16x32_bf16 v[216:219], a[204:207], a[164:167], v[216:219]
 v_mfma_f32_16x16x32_bf16 v[220:223], a[204:207], a[172:175], v[220:223]
 v_mfma_f32_16x16x32_bf16 v[220:223], a[200:203], a[168:171], v[220:223]
 v_mfma_f32_16x16x32_bf16 v[224:227], a[200:203], a[176:179], v[224:227]
 v_mfma_f32_16x16x32_bf16 v[224:227], a[204:207], a[180:183], v[224:227]
 v_mfma_f32_16x16x32_bf16 v[228:231], a[204:207], a[188:191], v[228:231]
 v_mfma_f32_16x16x32_bf16 v[228:231], a[200:203], a[184:187], v[228:231]
 buffer_load_dwordx4 v6, s[8:11], s30 offen lds
 s_waitcnt vmcnt(9)
 v_mfma_f32_16x16x32_bf16 a[252:255], a[208:211], a[184:187], a[252:255]
 ds_read_b128 a[184:187], v2 offset:28672
 v_mfma_f32_16x16x32_bf16 a[252:255], a[212:215], a[188:191], a[252:255]
 global_load_dwordx4 a[204:207], v0, s[70:71] offset:3072 sc1
 ds_read_b128 a[188:191], v2 offset:29696
 v_mfma_f32_16x16x32_bf16 a[248:251], a[212:215], a[180:183], a[248:251]
 ds_read_b128 a[180:183], v2 offset:25600
 v_mfma_f32_16x16x32_bf16 a[248:251], a[208:211], a[176:179], a[248:251]
 global_load_dwordx4 a[200:203], v0, s[70:71] offset:2048 sc1
 ds_read_b128 a[176:179], v2 offset:24576
 v_mfma_f32_16x16x32_bf16 v[252:255], a[208:211], a[168:171], v[252:255]
 s_add_u32 s70, s70, 8192
 s_addc_u32 s71, s71, 0
 ds_read_b128 a[168:171], v2 offset:20480
 v_mfma_f32_16x16x32_bf16 v[252:255], a[212:215], a[172:175], v[252:255]
 ds_read_b128 a[172:175], v2 offset:21504
 v_mfma_f32_16x16x32_bf16 v[248:251], a[212:215], a[164:167], v[248:251]
 ds_read_b128 a[164:167], v2 offset:17408
 v_mfma_f32_16x16x32_bf16 v[248:251], a[208:211], a[160:163], v[248:251]
 ds_read_b128 a[160:163], v2 offset:16384
 v_mfma_f32_16x16x32_bf16 v[244:247], a[208:211], a[152:155], v[244:247]
 ds_read_b128 a[152:155], v2 offset:12288
 v_mfma_f32_16x16x32_bf16 v[244:247], a[212:215], a[156:159], v[244:247]
 ds_read_b128 a[156:159], v2 offset:13312
 s_add_u32 m0, m0, 1024
 v_mfma_f32_16x16x32_bf16 v[240:243], a[212:215], a[148:151], v[240:243]
 ds_read_b128 a[148:151], v2 offset:9216
 v_mfma_f32_16x16x32_bf16 v[240:243], a[208:211], a[144:147], v[240:243]
 ds_read_b128 a[144:147], v2 offset:8192
 v_mfma_f32_16x16x32_bf16 v[236:239], a[208:211], a[136:139], v[236:239]
 ds_read_b128 a[136:139], v2 offset:4096
 s_add_u32 s30, s30, s20
 v_mfma_f32_16x16x32_bf16 v[236:239], a[212:215], a[140:143], v[236:239]
 ds_read_b128 a[140:143], v2 offset:5120
 v_mfma_f32_16x16x32_bf16 v[232:235], a[212:215], a[132:135], v[232:235]
 ds_read_b128 a[132:135], v2 offset:1024
 v_mfma_f32_16x16x32_bf16 v[232:235], a[208:211], a[128:131], v[232:235]
 ds_read_b128 a[128:131], v2
 s_waitcnt vmcnt(8) lgkmcnt(8)
 v_mfma_f32_16x16x32_bf16 v[44:47], a[216:219], a[184:187], v[44:47]
 buffer_load_dwordx4 v6, s[8:11], s30 offen lds
 v_mfma_f32_16x16x32_bf16 v[44:47], a[220:223], a[188:191], v[44:47]
 global_load_dwordx4 a[212:215], v0, s[70:71] offset:-3072 sc1
 v_mfma_f32_16x16x32_bf16 v[40:43], a[220:223], a[180:183], v[40:43]
 v_mfma_f32_16x16x32_bf16 v[40:43], a[216:219], a[176:179], v[40:43]
 global_load_dwordx4 a[208:211], v0, s[70:71] offset:-4096 sc1
 s_add_u32 m0, m0, 3072
 v_mfma_f32_16x16x32_bf16 v[36:39], a[216:219], a[168:171], v[36:39]
 v_mfma_f32_16x16x32_bf16 v[36:39], a[220:223], a[172:175], v[36:39]
 v_mfma_f32_16x16x32_bf16 v[32:35], a[220:223], a[164:167], v[32:35]
 v_mfma_f32_16x16x32_bf16 v[32:35], a[216:219], a[160:163], v[32:35]
 s_add_u32 s30, s30, s21
 s_waitcnt lgkmcnt(0)
 v_mfma_f32_16x16x32_bf16 v[28:31], a[216:219], a[152:155], v[28:31]
 v_mfma_f32_16x16x32_bf16 v[28:31], a[220:223], a[156:159], v[28:31]
 v_mfma_f32_16x16x32_bf16 v[24:27], a[220:223], a[148:151], v[24:27]
 v_mfma_f32_16x16x32_bf16 v[24:27], a[216:219], a[144:147], v[24:27]
 v_mfma_f32_16x16x32_bf16 v[20:23], a[216:219], a[136:139], v[20:23]
 v_mfma_f32_16x16x32_bf16 v[20:23], a[220:223], a[140:143], v[20:23]
 v_mfma_f32_16x16x32_bf16 v[16:19], a[220:223], a[132:135], v[16:19]
 v_mfma_f32_16x16x32_bf16 v[16:19], a[216:219], a[128:131], v[16:19]
 s_waitcnt vmcnt(8)
 v_mfma_f32_16x16x32_bf16 v[48:51], a[224:227], a[128:131], v[48:51]
 v_mfma_f32_16x16x32_bf16 v[48:51], a[228:231], a[132:135], v[48:51]
 global_load_dwordx4 a[220:223], v0, s[70:71] offset:-1024 sc1
 v_mfma_f32_16x16x32_bf16 v[52:55], a[228:231], a[140:143], v[52:55]
 v_mfma_f32_16x16x32_bf16 v[52:55], a[224:227], a[136:139], v[52:55]
 global_load_dwordx4 a[216:219], v0, s[70:71] offset:-2048 sc1
 v_mfma_f32_16x16x32_bf16 v[56:59], a[224:227], a[144:147], v[56:59]
 v_mfma_f32_16x16x32_bf16 v[56:59], a[228:231], a[148:151], v[56:59]
 v_mfma_f32_16x16x32_bf16 v[60:63], a[228:231], a[156:159], v[60:63]
 v_mfma_f32_16x16x32_bf16 v[60:63], a[224:227], a[152:155], v[60:63]
 v_mfma_f32_16x16x32_bf16 v[64:67], a[224:227], a[160:163], v[64:67]
 v_mfma_f32_16x16x32_bf16 v[64:67], a[228:231], a[164:167], v[64:67]
 v_mfma_f32_16x16x32_bf16 v[68:71], a[228:231], a[172:175], v[68:71]
 v_mfma_f32_16x16x32_bf16 v[68:71], a[224:227], a[168:171], v[68:71]
 v_mfma_f32_16x16x32_bf16 v[72:75], a[224:227], a[176:179], v[72:75]
 v_mfma_f32_16x16x32_bf16 v[72:75], a[228:231], a[180:183], v[72:75]
 v_mfma_f32_16x16x32_bf16 v[76:79], a[228:231], a[188:191], v[76:79]
 v_mfma_f32_16x16x32_bf16 v[76:79], a[224:227], a[184:187], v[76:79]
 s_waitcnt vmcnt(8)
 v_mfma_f32_16x16x32_bf16 v[108:111], a[192:195], a[184:187], v[108:111]
 v_mfma_f32_16x16x32_bf16 v[108:111], a[196:199], a[188:191], v[108:111]
 global_load_dwordx4 a[228:231], v0, s[70:71] offset:1024 sc1
 v_mfma_f32_16x16x32_bf16 v[104:107], a[196:199], a[180:183], v[104:107]
 v_mfma_f32_16x16x32_bf16 v[104:107], a[192:195], a[176:179], v[104:107]
 global_load_dwordx4 a[224:227], v0, s[70:71] offset:0 sc1
 v_mfma_f32_16x16x32_bf16 v[100:103], a[192:195], a[168:171], v[100:103]
 v_mfma_f32_16x16x32_bf16 v[100:103], a[196:199], a[172:175], v[100:103]
 v_mfma_f32_16x16x32_bf16 v[96:99], a[196:199], a[164:167], v[96:99]
 v_mfma_f32_16x16x32_bf16 v[96:99], a[192:195], a[160:163], v[96:99]
 v_mfma_f32_16x16x32_bf16 v[92:95], a[192:195], a[152:155], v[92:95]
 v_mfma_f32_16x16x32_bf16 v[92:95], a[196:199], a[156:159], v[92:95]
 v_mfma_f32_16x16x32_bf16 v[88:91], a[196:199], a[148:151], v[88:91]
 v_mfma_f32_16x16x32_bf16 v[88:91], a[192:195], a[144:147], v[88:91]
 v_mfma_f32_16x16x32_bf16 v[84:87], a[192:195], a[136:139], v[84:87]
 v_mfma_f32_16x16x32_bf16 v[84:87], a[196:199], a[140:143], v[84:87]
 v_mfma_f32_16x16x32_bf16 v[80:83], a[196:199], a[132:135], v[80:83]
 v_mfma_f32_16x16x32_bf16 v[80:83], a[192:195], a[128:131], v[80:83]
 buffer_load_dwordx4 v6, s[8:11], s30 offen lds
 s_waitcnt vmcnt(8)
 v_mfma_f32_16x16x32_bf16 v[112:115], a[200:203], a[128:131], v[112:115]
 v_mfma_f32_16x16x32_bf16 v[112:115], a[204:207], a[132:135], v[112:115]
 global_load_dwordx4 a[196:199], v0, s[70:71] offset:3072 sc1
 v_mfma_f32_16x16x32_bf16 v[116:119], a[204:207], a[140:143], v[116:119]
 v_mfma_f32_16x16x32_bf16 v[116:119], a[200:203], a[136:139], v[116:119]
 global_load_dwordx4 a[192:195], v0, s[70:71] offset:2048 sc1
 s_add_u32 m0, m0, 1024
 v_mfma_f32_16x16x32_bf16 v[120:123], a[200:203], a[144:147], v[120:123]
 s_add_u32 s70, s70, 8192
 s_addc_u32 s71, s71, 0
 v_mfma_f32_16x16x32_bf16 v[120:123], a[204:207], a[148:151], v[120:123]
 v_mfma_f32_16x16x32_bf16 v[124:127], a[204:207], a[156:159], v[124:127]
 s_add_u32 s30, s30, s20
 v_mfma_f32_16x16x32_bf16 v[124:127], a[200:203], a[152:155], v[124:127]
 v_mfma_f32_16x16x32_bf16 v[128:131], a[200:203], a[160:163], v[128:131]
 v_mfma_f32_16x16x32_bf16 v[128:131], a[204:207], a[164:167], v[128:131]
 v_mfma_f32_16x16x32_bf16 v[132:135], a[204:207], a[172:175], v[132:135]
 buffer_load_dwordx4 v6, s[8:11], s30 offen lds
 v_mfma_f32_16x16x32_bf16 v[132:135], a[200:203], a[168:171], v[132:135]
 v_mfma_f32_16x16x32_bf16 a[240:243], a[200:203], a[176:179], a[240:243]
 v_mfma_f32_16x16x32_bf16 a[240:243], a[204:207], a[180:183], a[240:243]
 v_mfma_f32_16x16x32_bf16 a[244:247], a[204:207], a[188:191], a[244:247]
 s_add_u32 m0, m0, 3072
 v_mfma_f32_16x16x32_bf16 a[244:247], a[200:203], a[184:187], a[244:247]
 s_waitcnt vmcnt(8)
 v_mfma_f32_16x16x32_bf16 v[164:167], a[208:211], a[184:187], v[164:167]
 v_mfma_f32_16x16x32_bf16 v[164:167], a[212:215], a[188:191], v[164:167]
 global_load_dwordx4 a[204:207], v0, s[70:71] offset:-3072 sc1
 s_add_u32 s30, s30, s21
 v_mfma_f32_16x16x32_bf16 v[160:163], a[212:215], a[180:183], v[160:163]
 v_mfma_f32_16x16x32_bf16 v[160:163], a[208:211], a[176:179], v[160:163]
 global_load_dwordx4 a[200:203], v0, s[70:71] offset:-4096 sc1
 v_mfma_f32_16x16x32_bf16 v[156:159], a[208:211], a[168:171], v[156:159]
 v_mfma_f32_16x16x32_bf16 v[156:159], a[212:215], a[172:175], v[156:159]
 v_mfma_f32_16x16x32_bf16 v[152:155], a[212:215], a[164:167], v[152:155]
 v_mfma_f32_16x16x32_bf16 v[152:155], a[208:211], a[160:163], v[152:155]
 v_mfma_f32_16x16x32_bf16 v[148:151], a[208:211], a[152:155], v[148:151]
 v_mfma_f32_16x16x32_bf16 v[148:151], a[212:215], a[156:159], v[148:151]
 v_mfma_f32_16x16x32_bf16 v[144:147], a[212:215], a[148:151], v[144:147]
 v_and_b32 v5, 768, v3
 v_mfma_f32_16x16x32_bf16 v[144:147], a[208:211], a[144:147], v[144:147]
 v_and_b32 v7, 1023, v3
 v_mfma_f32_16x16x32_bf16 v[140:143], a[208:211], a[136:139], v[140:143]
 v_mfma_f32_16x16x32_bf16 v[140:143], a[212:215], a[140:143], v[140:143]
 v_add3_u32 v5, v5, v7, s52
 v_mfma_f32_16x16x32_bf16 v[136:139], a[212:215], a[132:135], v[136:139]
 v_mfma_f32_16x16x32_bf16 v[136:139], a[208:211], a[128:131], v[136:139]
 ds_read_b64_tr_b16 v[8:9], v5 offset:0
 s_waitcnt vmcnt(8)
 v_mfma_f32_16x16x32_bf16 v[168:171], a[216:219], a[128:131], v[168:171]
 v_mfma_f32_16x16x32_bf16 v[168:171], a[220:223], a[132:135], v[168:171]
 global_load_dwordx4 a[212:215], v0, s[70:71] offset:-1024 sc1
 ds_read_b64_tr_b16 v[10:11], v5 offset:256
 v_mfma_f32_16x16x32_bf16 v[172:175], a[220:223], a[140:143], v[172:175]
 ds_read_b64_tr_b16 v[12:13], v5 offset:8
 v_mfma_f32_16x16x32_bf16 v[172:175], a[216:219], a[136:139], v[172:175]
 global_load_dwordx4 a[208:211], v0, s[70:71] offset:-2048 sc1
 ds_read_b64_tr_b16 v[14:15], v5 offset:264
 v_mfma_f32_16x16x32_bf16 v[176:179], a[216:219], a[144:147], v[176:179]
 v_mfma_f32_16x16x32_bf16 v[176:179], a[220:223], a[148:151], v[176:179]
 v_mfma_f32_16x16x32_bf16 v[180:183], a[220:223], a[156:159], v[180:183]
 v_mfma_f32_16x16x32_bf16 v[180:183], a[216:219], a[152:155], v[180:183]
 v_mfma_f32_16x16x32_bf16 v[184:187], a[216:219], a[160:163], v[184:187]
 v_mfma_f32_16x16x32_bf16 v[184:187], a[220:223], a[164:167], v[184:187]
 v_mfma_f32_16x16x32_bf16 v[188:191], a[220:223], a[172:175], v[188:191]
 v_mfma_f32_16x16x32_bf16 v[188:191], a[216:219], a[168:171], v[188:191]
 v_mfma_f32_16x16x32_bf16 v[192:195], a[216:219], a[176:179], v[192:195]
 v_mfma_f32_16x16x32_bf16 v[192:195], a[220:223], a[180:183], v[192:195]
 v_mfma_f32_16x16x32_bf16 v[196:199], a[220:223], a[188:191], v[196:199]
 v_mfma_f32_16x16x32_bf16 v[196:199], a[216:219], a[184:187], v[196:199]
 s_waitcnt vmcnt(8)
 v_mfma_f32_16x16x32_bf16 v[228:231], a[224:227], a[184:187], v[228:231]
 v_mfma_f32_16x16x32_bf16 v[228:231], a[228:231], a[188:191], v[228:231]
 global_load_dwordx4 a[220:223], v0, s[70:71] offset:1024 sc1
 v_mfma_f32_16x16x32_bf16 v[224:227], a[228:231], a[180:183], v[224:227]
 s_waitcnt lgkmcnt(2)
 v_mfma_f32_16x16x32_bf16 v[224:227], a[224:227], a[176:179], v[224:227]
 global_load_dwordx4 a[216:219], v0, s[70:71] offset:0 sc1
 v_mfma_f32_16x16x32_bf16 v[220:223], a[224:227], a[168:171], v[220:223]
 buffer_store_dwordx4 v[8:11], v7, s[12:15], s49 offen sc1
 v_mfma_f32_16x16x32_bf16 v[220:223], a[228:231], a[172:175], v[220:223]
 s_waitcnt lgkmcnt(0)
 v_mfma_f32_16x16x32_bf16 v[216:219], a[228:231], a[164:167], v[216:219]
 buffer_store_dwordx4 v[12:15], v7, s[12:15], s49 offen offset:2048 sc1
 v_mfma_f32_16x16x32_bf16 v[216:219], a[224:227], a[160:163], v[216:219]
 s_add_u32 s49, s49, 2097152
 v_mfma_f32_16x16x32_bf16 v[212:215], a[224:227], a[152:155], v[212:215]
 v_mfma_f32_16x16x32_bf16 v[212:215], a[228:231], a[156:159], v[212:215]
 buffer_load_dwordx4 v6, s[8:11], s30 offen lds
 v_mfma_f32_16x16x32_bf16 v[208:211], a[228:231], a[148:151], v[208:211]
 v_mfma_f32_16x16x32_bf16 v[208:211], a[224:227], a[144:147], v[208:211]
 v_mfma_f32_16x16x32_bf16 v[204:207], a[224:227], a[136:139], v[204:207]
 v_mfma_f32_16x16x32_bf16 v[204:207], a[228:231], a[140:143], v[204:207]
 s_add_u32 m0, m0, 1024
 v_mfma_f32_16x16x32_bf16 v[200:203], a[228:231], a[132:135], v[200:203]
 v_mfma_f32_16x16x32_bf16 v[200:203], a[224:227], a[128:131], v[200:203]
 s_add_u32 s30, s30, s20
 buffer_load_dwordx4 v6, s[8:11], s30 offen lds
 s_waitcnt vmcnt(11)
 v_mfma_f32_16x16x32_bf16 v[232:235], a[192:195], a[128:131], v[232:235]
 ds_read_b128 a[128:131], v2 offset:32768
 v_mfma_f32_16x16x32_bf16 v[232:235], a[196:199], a[132:135], v[232:235]
 global_load_dwordx4 a[228:231], v0, s[70:71] offset:3072 sc1
 ds_read_b128 a[132:135], v2 offset:33792
 v_mfma_f32_16x16x32_bf16 v[236:239], a[196:199], a[140:143], v[236:239]
 ds_read_b128 a[140:143], v2 offset:37888
 v_mfma_f32_16x16x32_bf16 v[236:239], a[192:195], a[136:139], v[236:239]
 global_load_dwordx4 a[224:227], v0, s[70:71] offset:2048 sc1
 ds_read_b128 a[136:139], v2 offset:36864
 v_mfma_f32_16x16x32_bf16 v[240:243], a[192:195], a[144:147], v[240:243]
 s_add_u32 s70, s70, 8192
 s_addc_u32 s71, s71, 0
 ds_read_b128 a[144:147], v2 offset:40960
 v_mfma_f32_16x16x32_bf16 v[240:243], a[196:199], a[148:151], v[240:243]
 ds_read_b128 a[148:151], v2 offset:41984
 v_mfma_f32_16x16x32_bf16 v[244:247], a[196:199], a[156:159], v[244:247]
 ds_read_b128 a[156:159], v2 offset:46080
 v_mfma_f32_16x16x32_bf16 v[244:247], a[192:195], a[152:155], v[244:247]
 ds_read_b128 a[152:155], v2 offset:45056
 v_mfma_f32_16x16x32_bf16 v[248:251], a[192:195], a[160:163], v[248:251]
 ds_read_b128 a[160:163], v2 offset:49152
 s_add_u32 m0, m0, 3072
 v_mfma_f32_16x16x32_bf16 v[248:251], a[196:199], a[164:167], v[248:251]
 ds_read_b128 a[164:167], v2 offset:50176
 v_mfma_f32_16x16x32_bf16 v[252:255], a[196:199], a[172:175], v[252:255]
 ds_read_b128 a[172:175], v2 offset:54272
 v_mfma_f32_16x16x32_bf16 v[252:255], a[192:195], a[168:171], v[252:255]
 ds_read_b128 a[168:171], v2 offset:53248
 s_add_u32 s30, s30, s21
 v_mfma_f32_16x16x32_bf16 a[248:251], a[192:195], a[176:179], a[248:251]
 ds_read_b128 a[176:179], v2 offset:57344
 v_mfma_f32_16x16x32_bf16 a[248:251], a[196:199], a[180:183], a[248:251]
 ds_read_b128 a[180:183], v2 offset:58368
 v_mfma_f32_16x16x32_bf16 a[252:255], a[196:199], a[188:191], a[252:255]
 ds_read_b128 a[188:191], v2 offset:62464
 v_mfma_f32_16x16x32_bf16 a[252:255], a[192:195], a[184:187], a[252:255]
 ds_read_b128 a[184:187], v2 offset:61440
 s_waitcnt vmcnt(10) lgkmcnt(8)
 v_mfma_f32_16x16x32_bf16 v[16:19], a[200:203], a[128:131], v[16:19]
 v_mfma_f32_16x16x32_bf16 v[16:19], a[204:207], a[132:135], v[16:19]
 global_load_dwordx4 a[196:199], v0, s[70:71] offset:-3072 sc1
 v_mfma_f32_16x16x32_bf16 v[20:23], a[204:207], a[140:143], v[20:23]
 v_mfma_f32_16x16x32_bf16 v[20:23], a[200:203], a[136:139], v[20:23]
 global_load_dwordx4 a[192:195], v0, s[70:71] offset:-4096 sc1
 v_mfma_f32_16x16x32_bf16 v[24:27], a[200:203], a[144:147], v[24:27]
 v_mfma_f32_16x16x32_bf16 v[24:27], a[204:207], a[148:151], v[24:27]
 v_mfma_f32_16x16x32_bf16 v[28:31], a[204:207], a[156:159], v[28:31]
 v_mfma_f32_16x16x32_bf16 v[28:31], a[200:203], a[152:155], v[28:31]
 s_waitcnt lgkmcnt(0)
 v_mfma_f32_16x16x32_bf16 v[32:35], a[200:203], a[160:163], v[32:35]
 v_mfma_f32_16x16x32_bf16 v[32:35], a[204:207], a[164:167], v[32:35]
 v_mfma_f32_16x16x32_bf16 v[36:39], a[204:207], a[172:175], v[36:39]
 v_mfma_f32_16x16x32_bf16 v[36:39], a[200:203], a[168:171], v[36:39]
 v_mfma_f32_16x16x32_bf16 v[40:43], a[200:203], a[176:179], v[40:43]
 v_mfma_f32_16x16x32_bf16 v[40:43], a[204:207], a[180:183], v[40:43]
 v_mfma_f32_16x16x32_bf16 v[44:47], a[204:207], a[188:191], v[44:47]
 v_mfma_f32_16x16x32_bf16 v[44:47], a[200:203], a[184:187], v[44:47]
 s_waitcnt vmcnt(10)
 v_mfma_f32_16x16x32_bf16 v[76:79], a[208:211], a[184:187], v[76:79]
 v_mfma_f32_16x16x32_bf16 v[76:79], a[212:215], a[188:191], v[76:79]
 global_load_dwordx4 a[204:207], v0, s[70:71] offset:-1024 sc1
 v_mfma_f32_16x16x32_bf16 v[72:75], a[212:215], a[180:183], v[72:75]
 v_mfma_f32_16x16x32_bf16 v[72:75], a[208:211], a[176:179], v[72:75]
 global_load_dwordx4 a[200:203], v0, s[70:71] offset:-2048 sc1
 v_mfma_f32_16x16x32_bf16 v[68:71], a[208:211], a[168:171], v[68:71]
 v_mfma_f32_16x16x32_bf16 v[68:71], a[212:215], a[172:175], v[68:71]
 v_mfma_f32_16x16x32_bf16 v[64:67], a[212:215], a[164:167], v[64:67]
 v_mfma_f32_16x16x32_bf16 v[64:67], a[208:211], a[160:163], v[64:67]
 v_mfma_f32_16x16x32_bf16 v[60:63], a[208:211], a[152:155], v[60:63]
 v_mfma_f32_16x16x32_bf16 v[60:63], a[212:215], a[156:159], v[60:63]
 v_mfma_f32_16x16x32_bf16 v[56:59], a[212:215], a[148:151], v[56:59]
 v_mfma_f32_16x16x32_bf16 v[56:59], a[208:211], a[144:147], v[56:59]
 v_mfma_f32_16x16x32_bf16 v[52:55], a[208:211], a[136:139], v[52:55]
 v_mfma_f32_16x16x32_bf16 v[52:55], a[212:215], a[140:143], v[52:55]
 v_mfma_f32_16x16x32_bf16 v[48:51], a[212:215], a[132:135], v[48:51]
 v_mfma_f32_16x16x32_bf16 v[48:51], a[208:211], a[128:131], v[48:51]
 s_waitcnt vmcnt(10)
 v_mfma_f32_16x16x32_bf16 v[80:83], a[216:219], a[128:131], v[80:83]
 v_mfma_f32_16x16x32_bf16 v[80:83], a[220:223], a[132:135], v[80:83]
 global_load_dwordx4 a[212:215], v0, s[70:71] offset:1024 sc1
 v_mfma_f32_16x16x32_bf16 v[84:87], a[220:223], a[140:143], v[84:87]
 v_mfma_f32_16x16x32_bf16 v[84:87], a[216:219], a[136:139], v[84:87]
 global_load_dwordx4 a[208:211], v0, s[70:71] offset:0 sc1
 v_mfma_f32_16x16x32_bf16 v[88:91], a[216:219], a[144:147], v[88:91]
 buffer_load_dwordx4 v6, s[8:11], s30 offen lds
 v_mfma_f32_16x16x32_bf16 v[88:91], a[220:223], a[148:151], v[88:91]
 v_mfma_f32_16x16x32_bf16 v[92:95], a[220:223], a[156:159], v[92:95]
 v_mfma_f32_16x16x32_bf16 v[92:95], a[216:219], a[152:155], v[92:95]
 s_add_u32 m0, m0, 1024
 v_mfma_f32_16x16x32_bf16 v[96:99], a[216:219], a[160:163], v[96:99]
 v_mfma_f32_16x16x32_bf16 v[96:99], a[220:223], a[164:167], v[96:99]
 v_mfma_f32_16x16x32_bf16 v[100:103], a[220:223], a[172:175], v[100:103]
 v_mfma_f32_16x16x32_bf16 v[100:103], a[216:219], a[168:171], v[100:103]
 s_add_u32 s30, s30, s20
 v_mfma_f32_16x16x32_bf16 v[104:107], a[216:219], a[176:179], v[104:107]
 v_mfma_f32_16x16x32_bf16 v[104:107], a[220:223], a[180:183], v[104:107]
 v_mfma_f32_16x16x32_bf16 v[108:111], a[220:223], a[188:191], v[108:111]
 buffer_load_dwordx4 v6, s[8:11], s30 offen lds
 v_mfma_f32_16x16x32_bf16 v[108:111], a[216:219], a[184:187], v[108:111]
 s_waitcnt vmcnt(8)
 v_mfma_f32_16x16x32_bf16 a[244:247], a[224:227], a[184:187], a[244:247]
 v_mfma_f32_16x16x32_bf16 a[244:247], a[228:231], a[188:191], a[244:247]
 global_load_dwordx4 a[220:223], v0, s[70:71] offset:3072 sc1
 v_mfma_f32_16x16x32_bf16 a[240:243], a[228:231], a[180:183], a[240:243]
 s_add_u32 m0, m0, 3072
 v_mfma_f32_16x16x32_bf16 a[240:243], a[224:227], a[176:179], a[240:243]
 global_load_dwordx4 a[216:219], v0, s[70:71] offset:2048 sc1
 v_mfma_f32_16x16x32_bf16 v[132:135], a[224:227], a[168:171], v[132:135]
 s_add_u32 s70, s70, 8192
 s_addc_u32 s71, s71, 0
 v_mfma_f32_16x16x32_bf16 v[132:135], a[228:231], a[172:175], v[132:135]
 v_mfma_f32_16x16x32_bf16 v[128:131], a[228:231], a[164:167], v[128:131]
 s_add_u32 s30, s30, s22
 v_mfma_f32_16x16x32_bf16 v[128:131], a[224:227], a[160:163], v[128:131]
 v_mfma_f32_16x16x32_bf16 v[124:127], a[224:227], a[152:155], v[124:127]
 v_mfma_f32_16x16x32_bf16 v[124:127], a[228:231], a[156:159], v[124:127]
 v_mfma_f32_16x16x32_bf16 v[120:123], a[228:231], a[148:151], v[120:123]
 v_mfma_f32_16x16x32_bf16 v[120:123], a[224:227], a[144:147], v[120:123]
 v_mfma_f32_16x16x32_bf16 v[116:119], a[224:227], a[136:139], v[116:119]
 v_mfma_f32_16x16x32_bf16 v[116:119], a[228:231], a[140:143], v[116:119]
 v_mfma_f32_16x16x32_bf16 v[112:115], a[228:231], a[132:135], v[112:115]
 v_mfma_f32_16x16x32_bf16 v[112:115], a[224:227], a[128:131], v[112:115]
 s_waitcnt vmcnt(8)
 v_mfma_f32_16x16x32_bf16 v[136:139], a[192:195], a[128:131], v[136:139]
 v_mfma_f32_16x16x32_bf16 v[136:139], a[196:199], a[132:135], v[136:139]
 global_load_dwordx4 a[228:231], v0, s[70:71] offset:-3072 sc1
 v_mfma_f32_16x16x32_bf16 v[140:143], a[196:199], a[140:143], v[140:143]
 v_mfma_f32_16x16x32_bf16 v[140:143], a[192:195], a[136:139], v[140:143]
 global_load_dwordx4 a[224:227], v0, s[70:71] offset:-4096 sc1
 v_mfma_f32_16x16x32_bf16 v[144:147], a[192:195], a[144:147], v[144:147]
 v_mfma_f32_16x16x32_bf16 v[144:147], a[196:199], a[148:151], v[144:147]
 global_load_dwordx4 a[236:239], v0, s[70:71] offset:-1024 sc1
 v_mfma_f32_16x16x32_bf16 v[148:151], a[196:199], a[156:159], v[148:151]
 v_mfma_f32_16x16x32_bf16 v[148:151], a[192:195], a[152:155], v[148:151]
 global_load_dwordx4 a[232:235], v0, s[70:71] offset:-2048 sc1
 v_mfma_f32_16x16x32_bf16 v[152:155], a[192:195], a[160:163], v[152:155]
 v_mfma_f32_16x16x32_bf16 v[152:155], a[196:199], a[164:167], v[152:155]
 v_mfma_f32_16x16x32_bf16 v[156:159], a[196:199], a[172:175], v[156:159]
 v_mfma_f32_16x16x32_bf16 v[156:159], a[192:195], a[168:171], v[156:159]
 v_mfma_f32_16x16x32_bf16 v[160:163], a[192:195], a[176:179], v[160:163]
 v_mfma_f32_16x16x32_bf16 v[160:163], a[196:199], a[180:183], v[160:163]
 v_mfma_f32_16x16x32_bf16 v[164:167], a[196:199], a[188:191], v[164:167]
 v_mfma_f32_16x16x32_bf16 v[164:167], a[192:195], a[184:187], v[164:167]
 s_waitcnt vmcnt(10)
 v_mfma_f32_16x16x32_bf16 v[196:199], a[200:203], a[184:187], v[196:199]
 v_mfma_f32_16x16x32_bf16 v[196:199], a[204:207], a[188:191], v[196:199]
 global_load_dwordx4 a[196:199], v0, s[70:71] offset:1024 sc1
 v_mfma_f32_16x16x32_bf16 v[192:195], a[204:207], a[180:183], v[192:195]
 v_mfma_f32_16x16x32_bf16 v[192:195], a[200:203], a[176:179], v[192:195]
 global_load_dwordx4 a[192:195], v0, s[70:71] offset:0 sc1
 v_mfma_f32_16x16x32_bf16 v[188:191], a[200:203], a[168:171], v[188:191]
 v_mfma_f32_16x16x32_bf16 v[188:191], a[204:207], a[172:175], v[188:191]
 v_mfma_f32_16x16x32_bf16 v[184:187], a[204:207], a[164:167], v[184:187]
 v_mfma_f32_16x16x32_bf16 v[184:187], a[200:203], a[160:163], v[184:187]
 v_mfma_f32_16x16x32_bf16 v[180:183], a[200:203], a[152:155], v[180:183]
 v_mfma_f32_16x16x32_bf16 v[180:183], a[204:207], a[156:159], v[180:183]
 v_mfma_f32_16x16x32_bf16 v[176:179], a[204:207], a[148:151], v[176:179]
 v_mfma_f32_16x16x32_bf16 v[176:179], a[200:203], a[144:147], v[176:179]
 v_mfma_f32_16x16x32_bf16 v[172:175], a[200:203], a[136:139], v[172:175]
 v_mfma_f32_16x16x32_bf16 v[172:175], a[204:207], a[140:143], v[172:175]
 v_mfma_f32_16x16x32_bf16 v[168:171], a[204:207], a[132:135], v[168:171]
 v_mfma_f32_16x16x32_bf16 v[168:171], a[200:203], a[128:131], v[168:171]
 s_waitcnt vmcnt(10)
 v_mfma_f32_16x16x32_bf16 v[200:203], a[208:211], a[128:131], v[200:203]
 v_mfma_f32_16x16x32_bf16 v[200:203], a[212:215], a[132:135], v[200:203]
 global_load_dwordx4 a[204:207], v0, s[70:71] offset:3072 sc1
 v_mfma_f32_16x16x32_bf16 v[204:207], a[212:215], a[140:143], v[204:207]
 v_mfma_f32_16x16x32_bf16 v[204:207], a[208:211], a[136:139], v[204:207]
 global_load_dwordx4 a[200:203], v0, s[70:71] offset:2048 sc1
 v_mfma_f32_16x16x32_bf16 v[208:211], a[208:211], a[144:147], v[208:211]
 s_add_u32 s70, s70, 8192
 s_addc_u32 s71, s71, 0
 v_mfma_f32_16x16x32_bf16 v[208:211], a[212:215], a[148:151], v[208:211]
 v_mfma_f32_16x16x32_bf16 v[212:215], a[212:215], a[156:159], v[212:215]
 v_mfma_f32_16x16x32_bf16 v[212:215], a[208:211], a[152:155], v[212:215]
 v_mfma_f32_16x16x32_bf16 v[216:219], a[208:211], a[160:163], v[216:219]
 v_mfma_f32_16x16x32_bf16 v[216:219], a[212:215], a[164:167], v[216:219]
 v_mfma_f32_16x16x32_bf16 v[220:223], a[212:215], a[172:175], v[220:223]
 s_waitcnt vmcnt(10)
 s_waitcnt lgkmcnt(0)
 s_barrier
 v_mfma_f32_16x16x32_bf16 v[220:223], a[208:211], a[168:171], v[220:223]
 v_mfma_f32_16x16x32_bf16 v[224:227], a[208:211], a[176:179], v[224:227]
 v_mfma_f32_16x16x32_bf16 v[224:227], a[212:215], a[180:183], v[224:227]
 v_mfma_f32_16x16x32_bf16 v[228:231], a[212:215], a[188:191], v[228:231]
 v_mfma_f32_16x16x32_bf16 v[228:231], a[208:211], a[184:187], v[228:231]
 s_waitcnt vmcnt(8)
 v_mfma_f32_16x16x32_bf16 a[252:255], a[216:219], a[184:187], a[252:255]
 ds_read_b128 a[184:187], v1 offset:30720
 v_mfma_f32_16x16x32_bf16 a[252:255], a[220:223], a[188:191], a[252:255]
 global_load_dwordx4 a[212:215], v0, s[70:71] offset:-3072 sc1
 ds_read_b128 a[188:191], v1 offset:31744
 v_mfma_f32_16x16x32_bf16 a[248:251], a[220:223], a[180:183], a[248:251]
 ds_read_b128 a[180:183], v1 offset:27648
 v_mfma_f32_16x16x32_bf16 a[248:251], a[216:219], a[176:179], a[248:251]
 global_load_dwordx4 a[208:211], v0, s[70:71] offset:-4096 sc1
 ds_read_b128 a[176:179], v1 offset:26624
 v_mfma_f32_16x16x32_bf16 v[252:255], a[216:219], a[168:171], v[252:255]
 ds_read_b128 a[168:171], v1 offset:22528
 v_mfma_f32_16x16x32_bf16 v[252:255], a[220:223], a[172:175], v[252:255]
 ds_read_b128 a[172:175], v1 offset:23552
 v_mfma_f32_16x16x32_bf16 v[248:251], a[220:223], a[164:167], v[248:251]
 ds_read_b128 a[164:167], v1 offset:19456
 v_mfma_f32_16x16x32_bf16 v[248:251], a[216:219], a[160:163], v[248:251]
 ds_read_b128 a[160:163], v1 offset:18432
 v_mfma_f32_16x16x32_bf16 v[244:247], a[216:219], a[152:155], v[244:247]
 ds_read_b128 a[152:155], v1 offset:14336
 v_mfma_f32_16x16x32_bf16 v[244:247], a[220:223], a[156:159], v[244:247]
 ds_read_b128 a[156:159], v1 offset:15360
 v_mfma_f32_16x16x32_bf16 v[240:243], a[220:223], a[148:151], v[240:243]
 ds_read_b128 a[148:151], v1 offset:11264
 v_mfma_f32_16x16x32_bf16 v[240:243], a[216:219], a[144:147], v[240:243]
 ds_read_b128 a[144:147], v1 offset:10240
 v_mfma_f32_16x16x32_bf16 v[236:239], a[216:219], a[136:139], v[236:239]
 ds_read_b128 a[136:139], v1 offset:6144
 v_mfma_f32_16x16x32_bf16 v[236:239], a[220:223], a[140:143], v[236:239]
 ds_read_b128 a[140:143], v1 offset:7168
 v_mfma_f32_16x16x32_bf16 v[232:235], a[220:223], a[132:135], v[232:235]
 global_load_dwordx4 a[220:223], v0, s[70:71] offset:-1024 sc1
 ds_read_b128 a[132:135], v1 offset:3072
 v_mfma_f32_16x16x32_bf16 v[232:235], a[216:219], a[128:131], v[232:235]
 global_load_dwordx4 a[216:219], v0, s[70:71] offset:-2048 sc1
 ds_read_b128 a[128:131], v1 offset:2048
 s_waitcnt vmcnt(10) lgkmcnt(8)
 v_mfma_f32_16x16x32_bf16 v[44:47], a[224:227], a[184:187], v[44:47]
 v_mov_b32 v7, 1
 v_mfma_f32_16x16x32_bf16 v[44:47], a[228:231], a[188:191], v[44:47]
 v_mfma_f32_16x16x32_bf16 v[40:43], a[228:231], a[180:183], v[40:43]
 buffer_atomic_add v7, v0, s[56:59], 0 offen sc1
 v_mfma_f32_16x16x32_bf16 v[40:43], a[224:227], a[176:179], v[40:43]
 v_bfe_u32 v4, v3, 8, 2
 v_mfma_f32_16x16x32_bf16 v[36:39], a[224:227], a[168:171], v[36:39]
 v_mfma_f32_16x16x32_bf16 v[36:39], a[228:231], a[172:175], v[36:39]
 v_lshl_add_u32 v4, v4, 5, s51
 v_mfma_f32_16x16x32_bf16 v[32:35], a[228:231], a[164:167], v[32:35]
 ds_read_b128 v[8:11], v4 offset:256
 v_mfma_f32_16x16x32_bf16 v[32:35], a[224:227], a[160:163], v[32:35]
 s_waitcnt lgkmcnt(1)
 v_mfma_f32_16x16x32_bf16 v[28:31], a[224:227], a[152:155], v[28:31]
 v_mfma_f32_16x16x32_bf16 v[28:31], a[228:231], a[156:159], v[28:31]
 v_mfma_f32_16x16x32_bf16 v[24:27], a[228:231], a[148:151], v[24:27]
 v_mfma_f32_16x16x32_bf16 v[24:27], a[224:227], a[144:147], v[24:27]
 v_mfma_f32_16x16x32_bf16 v[20:23], a[224:227], a[136:139], v[20:23]
 v_mfma_f32_16x16x32_bf16 v[20:23], a[228:231], a[140:143], v[20:23]
 v_mfma_f32_16x16x32_bf16 v[16:19], a[228:231], a[132:135], v[16:19]
 v_mfma_f32_16x16x32_bf16 v[16:19], a[224:227], a[128:131], v[16:19]
 s_waitcnt vmcnt(9)
 v_mfma_f32_16x16x32_bf16 v[48:51], a[232:235], a[128:131], v[48:51]
 v_mfma_f32_16x16x32_bf16 v[48:51], a[236:239], a[132:135], v[48:51]
 global_load_dwordx4 a[228:231], v0, s[70:71] offset:1024 sc1
 v_mfma_f32_16x16x32_bf16 v[52:55], a[236:239], a[140:143], v[52:55]
 v_mfma_f32_16x16x32_bf16 v[52:55], a[232:235], a[136:139], v[52:55]
 global_load_dwordx4 a[224:227], v0, s[70:71] offset:0 sc1
 v_mfma_f32_16x16x32_bf16 v[56:59], a[232:235], a[144:147], v[56:59]
 s_waitcnt lgkmcnt(0)
 v_mfma_f32_16x16x32_bf16 v[56:59], a[236:239], a[148:151], v[56:59]
 v_mfma_f32_16x16x32_bf16 v[60:63], a[236:239], a[156:159], v[60:63]
 v_add_f32 v136, v136, v8
 v_mfma_f32_16x16x32_bf16 v[60:63], a[232:235], a[152:155], v[60:63]
 v_mfma_f32_16x16x32_bf16 v[64:67], a[232:235], a[160:163], v[64:67]
 ds_read_b128 v[12:15], v4 offset:272
 v_mfma_f32_16x16x32_bf16 v[64:67], a[236:239], a[164:167], v[64:67]
 v_add_f32 v137, v137, v9
 v_mfma_f32_16x16x32_bf16 v[68:71], a[236:239], a[172:175], v[68:71]
 v_mfma_f32_16x16x32_bf16 v[68:71], a[232:235], a[168:171], v[68:71]
 v_add_f32 v138, v138, v10
 v_mfma_f32_16x16x32_bf16 v[72:75], a[232:235], a[176:179], v[72:75]
 v_add_f32 v139, v139, v11
 v_mfma_f32_16x16x32_bf16 v[72:75], a[236:239], a[180:183], v[72:75]
 v_mfma_f32_16x16x32_bf16 v[76:79], a[236:239], a[188:191], v[76:79]
 v_add_f32 v140, v140, v8
 v_mfma_f32_16x16x32_bf16 v[76:79], a[232:235], a[184:187], v[76:79]
 v_add_f32 v141, v141, v9
 s_waitcnt vmcnt(9)
 v_mfma_f32_16x16x32_bf16 v[108:111], a[192:195], a[184:187], v[108:111]
 v_mfma_f32_16x16x32_bf16 v[108:111], a[196:199], a[188:191], v[108:111]
 global_load_dwordx4 a[236:239], v0, s[70:71] offset:3072 sc1
 v_add_f32 v142, v142, v10
 v_mfma_f32_16x16x32_bf16 v[104:107], a[196:199], a[180:183], v[104:107]
 v_add_f32 v143, v143, v11
 v_mfma_f32_16x16x32_bf16 v[104:107], a[192:195], a[176:179], v[104:107]
 global_load_dwordx4 a[232:235], v0, s[70:71] offset:2048 sc1
 v_mfma_f32_16x16x32_bf16 v[100:103], a[192:195], a[168:171], v[100:103]
 v_add_f32 v144, v144, v8
 s_add_u32 s70, s70, 8192
 s_addc_u32 s71, s71, 0
 v_mfma_f32_16x16x32_bf16 v[100:103], a[196:199], a[172:175], v[100:103]
 v_mfma_f32_16x16x32_bf16 v[96:99], a[196:199], a[164:167], v[96:99]
 v_add_f32 v145, v145, v9
 v_mfma_f32_16x16x32_bf16 v[96:99], a[192:195], a[160:163], v[96:99]
 v_add_f32 v146, v146, v10
 v_mfma_f32_16x16x32_bf16 v[92:95], a[192:195], a[152:155], v[92:95]
 v_mfma_f32_16x16x32_bf16 v[92:95], a[196:199], a[156:159], v[92:95]
 v_add_f32 v147, v147, v11
 v_mfma_f32_16x16x32_bf16 v[88:91], a[196:199], a[148:151], v[88:91]
 v_add_f32 v148, v148, v8
 v_mfma_f32_16x16x32_bf16 v[88:91], a[192:195], a[144:147], v[88:91]
 v_mfma_f32_16x16x32_bf16 v[84:87], a[192:195], a[136:139], v[84:87]
 v_add_f32 v149, v149, v9
 v_mfma_f32_16x16x32_bf16 v[84:87], a[196:199], a[140:143], v[84:87]
 v_add_f32 v150, v150, v10
 v_mfma_f32_16x16x32_bf16 v[80:83], a[196:199], a[132:135], v[80:83]
 v_mfma_f32_16x16x32_bf16 v[80:83], a[192:195], a[128:131], v[80:83]
 v_add_f32 v151, v151, v11
 s_waitcnt vmcnt(9)
 v_mfma_f32_16x16x32_bf16 v[112:115], a[200:203], a[128:131], v[112:115]
 ds_read_b128 a[128:131], v1 offset:34816
 v_add_f32 v152, v152, v8
 v_mfma_f32_16x16x32_bf16 v[112:115], a[204:207], a[132:135], v[112:115]
 global_load_dwordx4 a[196:199], v0, s[70:71] offset:-3072 sc1
 ds_read_b128 a[132:135], v1 offset:35840
 v_mfma_f32_16x16x32_bf16 v[116:119], a[204:207], a[140:143], v[116:119]
 ds_read_b128 a[140:143], v1 offset:39936
 v_add_f32 v153, v153, v9
 v_mfma_f32_16x16x32_bf16 v[116:119], a[200:203], a[136:139], v[116:119]
 global_load_dwordx4 a[192:195], v0, s[70:71] offset:-4096 sc1
 ds_read_b128 a[136:139], v1 offset:38912
 v_mfma_f32_16x16x32_bf16 v[120:123], a[200:203], a[144:147], v[120:123]
 ds_read_b128 a[144:147], v1 offset:43008
 v_add_f32 v154, v154, v10
 v_mfma_f32_16x16x32_bf16 v[120:123], a[204:207], a[148:151], v[120:123]
 ds_read_b128 a[148:151], v1 offset:44032
 v_add_f32 v155, v155, v11
 v_mfma_f32_16x16x32_bf16 v[124:127], a[204:207], a[156:159], v[124:127]
 ds_read_b128 a[156:159], v1 offset:48128
 v_mfma_f32_16x16x32_bf16 v[124:127], a[200:203], a[152:155], v[124:127]
 ds_read_b128 a[152:155], v1 offset:47104
 v_add_f32 v156, v156, v8
 v_mfma_f32_16x16x32_bf16 v[128:131], a[200:203], a[160:163], v[128:131]
 ds_read_b128 a[160:163], v1 offset:51200
 v_add_f32 v157, v157, v9
 v_mfma_f32_16x16x32_bf16 v[128:131], a[204:207], a[164:167], v[128:131]
 ds_read_b128 a[164:167], v1 offset:52224
 v_mfma_f32_16x16x32_bf16 v[132:135], a[204:207], a[172:175], v[132:135]
 ds_read_b128 a[172:175], v1 offset:56320
 v_add_f32 v158, v158, v10
 v_mfma_f32_16x16x32_bf16 v[132:135], a[200:203], a[168:171], v[132:135]
 ds_read_b128 a[168:171], v1 offset:55296
 v_add_f32 v159, v159, v11
 v_mfma_f32_16x16x32_bf16 a[240:243], a[200:203], a[176:179], a[240:243]
 ds_read_b128 a[176:179], v1 offset:59392
 v_mfma_f32_16x16x32_bf16 a[240:243], a[204:207], a[180:183], a[240:243]
 ds_read_b128 a[180:183], v1 offset:60416
 v_add_f32 v160, v160, v8
 v_mfma_f32_16x16x32_bf16 a[244:247], a[204:207], a[188:191], a[244:247]
 ds_read_b128 a[188:191], v1 offset:64512
 v_add_f32 v161, v161, v9
 v_mfma_f32_16x16x32_bf16 a[244:247], a[200:203], a[184:187], a[244:247]
 ds_read_b128 a[184:187], v1 offset:63488
 s_waitcnt vmcnt(9) lgkmcnt(8)
 v_mfma_f32_16x16x32_bf16 v[16:19], a[208:211], a[128:131], v[16:19]
 v_add_f32 v162, v162, v10
 v_mfma_f32_16x16x32_bf16 v[16:19], a[212:215], a[132:135], v[16:19]
 global_load_dwordx4 a[204:207], v0, s[70:71] offset:-1024 sc1
 v_mfma_f32_16x16x32_bf16 v[20:23], a[212:215], a[140:143], v[20:23]
 v_add_f32 v163, v163, v11
 v_mfma_f32_16x16x32_bf16 v[20:23], a[208:211], a[136:139], v[20:23]
 global_load_dwordx4 a[200:203], v0, s[70:71] offset:-2048 sc1
 v_add_f32 v164, v164, v8
 v_mfma_f32_16x16x32_bf16 v[24:27], a[208:211], a[144:147], v[24:27]
 v_mfma_f32_16x16x32_bf16 v[24:27], a[212:215], a[148:151], v[24:27]
 v_add_f32 v165, v165, v9
 v_mfma_f32_16x16x32_bf16 v[28:31], a[212:215], a[156:159], v[28:31]
 v_add_f32 v166, v166, v10
 v_mfma_f32_16x16x32_bf16 v[28:31], a[208:211], a[152:155], v[28:31]
 s_waitcnt lgkmcnt(0)
 v_mfma_f32_16x16x32_bf16 v[32:35], a[208:211], a[160:163], v[32:35]
 v_add_f32 v167, v167, v11
 v_mfma_f32_16x16x32_bf16 v[32:35], a[212:215], a[164:167], v[32:35]
 v_mfma_f32_16x16x32_bf16 v[36:39], a[212:215], a[172:175], v[36:39]
 v_mfma_f32_16x16x32_bf16 v[36:39], a[208:211], a[168:171], v[36:39]
 v_add_f32 v168, v168, v12
 v_mfma_f32_16x16x32_bf16 v[40:43], a[208:211], a[176:179], v[40:43]
 ds_read_b128 v[8:11], v4 offset:384
 v_mfma_f32_16x16x32_bf16 v[40:43], a[212:215], a[180:183], v[40:43]
 v_mfma_f32_16x16x32_bf16 v[44:47], a[212:215], a[188:191], v[44:47]
 v_add_f32 v169, v169, v13
 v_mfma_f32_16x16x32_bf16 v[44:47], a[208:211], a[184:187], v[44:47]
 s_waitcnt vmcnt(9)
 v_mfma_f32_16x16x32_bf16 v[76:79], a[216:219], a[184:187], v[76:79]
 v_add_f32 v170, v170, v14
 v_mfma_f32_16x16x32_bf16 v[76:79], a[220:223], a[188:191], v[76:79]
 global_load_dwordx4 a[212:215], v0, s[70:71] offset:1024 sc1
 v_add_f32 v171, v171, v15
 v_mfma_f32_16x16x32_bf16 v[72:75], a[220:223], a[180:183], v[72:75]
 v_mfma_f32_16x16x32_bf16 v[72:75], a[216:219], a[176:179], v[72:75]
 global_load_dwordx4 a[208:211], v0, s[70:71] offset:0 sc1
 v_add_f32 v172, v172, v12
 v_mfma_f32_16x16x32_bf16 v[68:71], a[216:219], a[168:171], v[68:71]
 v_add_f32 v173, v173, v13
 v_mfma_f32_16x16x32_bf16 v[68:71], a[220:223], a[172:175], v[68:71]
 v_mfma_f32_16x16x32_bf16 v[64:67], a[220:223], a[164:167], v[64:67]
 v_add_f32 v174, v174, v14
 v_mfma_f32_16x16x32_bf16 v[64:67], a[216:219], a[160:163], v[64:67]
 v_add_f32 v175, v175, v15
 v_mfma_f32_16x16x32_bf16 v[60:63], a[216:219], a[152:155], v[60:63]
 v_mfma_f32_16x16x32_bf16 v[60:63], a[220:223], a[156:159], v[60:63]
 v_add_f32 v176, v176, v12
 v_mfma_f32_16x16x32_bf16 v[56:59], a[220:223], a[148:151], v[56:59]
 v_add_f32 v177, v177, v13
 v_mfma_f32_16x16x32_bf16 v[56:59], a[216:219], a[144:147], v[56:59]
 v_mfma_f32_16x16x32_bf16 v[52:55], a[216:219], a[136:139], v[52:55]
 v_add_f32 v178, v178, v14
 v_mfma_f32_16x16x32_bf16 v[52:55], a[220:223], a[140:143], v[52:55]
 v_mfma_f32_16x16x32_bf16 v[48:51], a[220:223], a[132:135], v[48:51]
 v_add_f32 v179, v179, v15
 v_mfma_f32_16x16x32_bf16 v[48:51], a[216:219], a[128:131], v[48:51]
 v_add_f32 v180, v180, v12
 s_waitcnt vmcnt(8)
 v_mfma_f32_16x16x32_bf16 v[80:83], a[224:227], a[128:131], v[80:83]
 v_mfma_f32_16x16x32_bf16 v[80:83], a[228:231], a[132:135], v[80:83]
 global_load_dwordx4 a[220:223], v0, s[70:71] offset:3072 sc1
 v_add_f32 v181, v181, v13
 v_mfma_f32_16x16x32_bf16 v[84:87], a[228:231], a[140:143], v[84:87]
 v_add_f32 v182, v182, v14
 v_mfma_f32_16x16x32_bf16 v[84:87], a[224:227], a[136:139], v[84:87]
 global_load_dwordx4 a[216:219], v0, s[70:71] offset:2048 sc1
 v_mfma_f32_16x16x32_bf16 v[88:91], a[224:227], a[144:147], v[88:91]
 v_add_f32 v183, v183, v15
 s_add_u32 s70, s70, 8192
 s_addc_u32 s71, s71, 0
 v_mfma_f32_16x16x32_bf16 v[88:91], a[228:231], a[148:151], v[88:91]
 v_add_f32 v184, v184, v12
 v_mfma_f32_16x16x32_bf16 v[92:95], a[228:231], a[156:159], v[92:95]
 v_mfma_f32_16x16x32_bf16 v[92:95], a[224:227], a[152:155], v[92:95]
 v_add_f32 v185, v185, v13
 v_mfma_f32_16x16x32_bf16 v[96:99], a[224:227], a[160:163], v[96:99]
 v_add_f32 v186, v186, v14
 v_mfma_f32_16x16x32_bf16 v[96:99], a[228:231], a[164:167], v[96:99]
 v_mfma_f32_16x16x32_bf16 v[100:103], a[228:231], a[172:175], v[100:103]
 v_add_f32 v187, v187, v15
 v_mfma_f32_16x16x32_bf16 v[100:103], a[224:227], a[168:171], v[100:103]
 v_mfma_f32_16x16x32_bf16 v[104:107], a[224:227], a[176:179], v[104:107]
 v_add_f32 v188, v188, v12
 v_mfma_f32_16x16x32_bf16 v[104:107], a[228:231], a[180:183], v[104:107]
 v_add_f32 v189, v189, v13
 v_mfma_f32_16x16x32_bf16 v[108:111], a[228:231], a[188:191], v[108:111]
 v_mfma_f32_16x16x32_bf16 v[108:111], a[224:227], a[184:187], v[108:111]
 v_add_f32 v190, v190, v14
 s_waitcnt vmcnt(8)
 v_mfma_f32_16x16x32_bf16 a[244:247], a[232:235], a[184:187], a[244:247]
 ds_read_b128 a[184:187], v2 offset:30720
 v_add_f32 v191, v191, v15
 v_mfma_f32_16x16x32_bf16 a[244:247], a[236:239], a[188:191], a[244:247]
 global_load_dwordx4 a[228:231], v0, s[70:71] offset:-3072 sc1
 ds_read_b128 a[188:191], v2 offset:31744
 v_mfma_f32_16x16x32_bf16 a[240:243], a[236:239], a[180:183], a[240:243]
 ds_read_b128 a[180:183], v2 offset:27648
 v_add_f32 v192, v192, v12
 v_mfma_f32_16x16x32_bf16 a[240:243], a[232:235], a[176:179], a[240:243]
 global_load_dwordx4 a[224:227], v0, s[70:71] offset:-4096 sc1
 ds_read_b128 a[176:179], v2 offset:26624
 v_mfma_f32_16x16x32_bf16 v[132:135], a[232:235], a[168:171], v[132:135]
 ds_read_b128 a[168:171], v2 offset:22528
 v_add_f32 v193, v193, v13
 v_mfma_f32_16x16x32_bf16 v[132:135], a[236:239], a[172:175], v[132:135]
 ds_read_b128 a[172:175], v2 offset:23552
 v_add_f32 v194, v194, v14
 v_mfma_f32_16x16x32_bf16 v[128:131], a[236:239], a[164:167], v[128:131]
 ds_read_b128 a[164:167], v2 offset:19456
 v_add_f32 v195, v195, v15
 v_mfma_f32_16x16x32_bf16 v[128:131], a[232:235], a[160:163], v[128:131]
 ds_read_b128 a[160:163], v2 offset:18432
 v_mfma_f32_16x16x32_bf16 v[124:127], a[232:235], a[152:155], v[124:127]
 ds_read_b128 a[152:155], v2 offset:14336
 v_add_f32 v196, v196, v12
 v_mfma_f32_16x16x32_bf16 v[124:127], a[236:239], a[156:159], v[124:127]
 ds_read_b128 a[156:159], v2 offset:15360
 v_mfma_f32_16x16x32_bf16 v[120:123], a[236:239], a[148:151], v[120:123]
 ds_read_b128 a[148:151], v2 offset:11264
 v_add_f32 v197, v197, v13
 v_mfma_f32_16x16x32_bf16 v[120:123], a[232:235], a[144:147], v[120:123]
 ds_read_b128 a[144:147], v2 offset:10240
 v_add_f32 v198, v198, v14
 v_mfma_f32_16x16x32_bf16 v[116:119], a[232:235], a[136:139], v[116:119]
 ds_read_b128 a[136:139], v2 offset:6144
 v_mfma_f32_16x16x32_bf16 v[116:119], a[236:239], a[140:143], v[116:119]
 ds_read_b128 a[140:143], v2 offset:7168
 v_add_f32 v199, v199, v15
 v_mfma_f32_16x16x32_bf16 v[112:115], a[236:239], a[132:135], v[112:115]
 ds_read_b128 a[132:135], v2 offset:3072
 s_waitcnt lgkmcnt(15)
 v_mfma_f32_16x16x32_bf16 v[112:115], a[232:235], a[128:131], v[112:115]
 ds_read_b128 a[128:131], v2 offset:2048
 s_waitcnt vmcnt(8) lgkmcnt(8)
 v_mfma_f32_16x16x32_bf16 v[44:47], a[192:195], a[184:187], v[44:47]
 v_add_f32 v200, v200, v8
 v_mfma_f32_16x16x32_bf16 v[44:47], a[196:199], a[188:191], v[44:47]
 global_load_dwordx4 a[236:239], v0, s[70:71] offset:-1024 sc1
 ds_read_b128 v[12:15], v4 offset:400
 v_mfma_f32_16x16x32_bf16 v[40:43], a[196:199], a[180:183], v[40:43]
 v_mfma_f32_16x16x32_bf16 v[40:43], a[192:195], a[176:179], v[40:43]
 global_load_dwordx4 a[232:235], v0, s[70:71] offset:-2048 sc1
 v_add_f32 v201, v201, v9
 v_mfma_f32_16x16x32_bf16 v[36:39], a[192:195], a[168:171], v[36:39]
 v_add_f32 v202, v202, v10
 v_mfma_f32_16x16x32_bf16 v[36:39], a[196:199], a[172:175], v[36:39]
 v_mfma_f32_16x16x32_bf16 v[32:35], a[196:199], a[164:167], v[32:35]
 v_add_f32 v203, v203, v11
 v_mfma_f32_16x16x32_bf16 v[32:35], a[192:195], a[160:163], v[32:35]
 s_waitcnt lgkmcnt(1)
 v_mfma_f32_16x16x32_bf16 v[28:31], a[192:195], a[152:155], v[28:31]
 v_add_f32 v204, v204, v8
 v_mfma_f32_16x16x32_bf16 v[28:31], a[196:199], a[156:159], v[28:31]
 v_add_f32 v205, v205, v9
 v_mfma_f32_16x16x32_bf16 v[24:27], a[196:199], a[148:151], v[24:27]
 v_mfma_f32_16x16x32_bf16 v[24:27], a[192:195], a[144:147], v[24:27]
 v_add_f32 v206, v206, v10
 v_mfma_f32_16x16x32_bf16 v[20:23], a[192:195], a[136:139], v[20:23]
 v_add_f32 v207, v207, v11
 v_mfma_f32_16x16x32_bf16 v[20:23], a[196:199], a[140:143], v[20:23]
 v_mfma_f32_16x16x32_bf16 v[16:19], a[196:199], a[132:135], v[16:19]
 v_add_f32 v208, v208, v8
 v_mfma_f32_16x16x32_bf16 v[16:19], a[192:195], a[128:131], v[16:19]
 v_add_f32 v209, v209, v9
 s_waitcnt vmcnt(8)
 v_mfma_f32_16x16x32_bf16 v[48:51], a[200:203], a[128:131], v[48:51]
 v_mfma_f32_16x16x32_bf16 v[48:51], a[204:207], a[132:135], v[48:51]
 global_load_dwordx4 a[196:199], v0, s[70:71] offset:1024 sc1
 v_add_f32 v210, v210, v10
 v_mfma_f32_16x16x32_bf16 v[52:55], a[204:207], a[140:143], v[52:55]
 v_add_f32 v211, v211, v11
 v_mfma_f32_16x16x32_bf16 v[52:55], a[200:203], a[136:139], v[52:55]
 global_load_dwordx4 a[192:195], v0, s[70:71] offset:0 sc1
 v_mfma_f32_16x16x32_bf16 v[56:59], a[200:203], a[144:147], v[56:59]
 v_add_f32 v212, v212, v8
 v_mfma_f32_16x16x32_bf16 v[56:59], a[204:207], a[148:151], v[56:59]
 v_mfma_f32_16x16x32_bf16 v[60:63], a[204:207], a[156:159], v[60:63]
 v_add_f32 v213, v213, v9
 v_mfma_f32_16x16x32_bf16 v[60:63], a[200:203], a[152:155], v[60:63]
 v_add_f32 v214, v214, v10
 v_mfma_f32_16x16x32_bf16 v[64:67], a[200:203], a[160:163], v[64:67]
 v_mfma_f32_16x16x32_bf16 v[64:67], a[204:207], a[164:167], v[64:67]
 v_add_f32 v215, v215, v11
 v_mfma_f32_16x16x32_bf16 v[68:71], a[204:207], a[172:175], v[68:71]
 v_add_f32 v216, v216, v8
 v_mfma_f32_16x16x32_bf16 v[68:71], a[200:203], a[168:171], v[68:71]
 v_mfma_f32_16x16x32_bf16 v[72:75], a[200:203], a[176:179], v[72:75]
 v_add_f32 v217, v217, v9
 v_mfma_f32_16x16x32_bf16 v[72:75], a[204:207], a[180:183], v[72:75]
 v_add_f32 v218, v218, v10
 v_mfma_f32_16x16x32_bf16 v[76:79], a[204:207], a[188:191], v[76:79]
 v_mfma_f32_16x16x32_bf16 v[76:79], a[200:203], a[184:187], v[76:79]
 v_add_f32 v219, v219, v11
 s_waitcnt vmcnt(8)
 v_mfma_f32_16x16x32_bf16 v[108:111], a[208:211], a[184:187], v[108:111]
 v_add_f32 v220, v220, v8
 v_mfma_f32_16x16x32_bf16 v[108:111], a[212:215], a[188:191], v[108:111]
 global_load_dwordx4 a[204:207], v0, s[70:71] offset:3072 sc1
 v_mfma_f32_16x16x32_bf16 v[104:107], a[212:215], a[180:183], v[104:107]
 v_add_f32 v221, v221, v9
 v_mfma_f32_16x16x32_bf16 v[104:107], a[208:211], a[176:179], v[104:107]
 global_load_dwordx4 a[200:203], v0, s[70:71] offset:2048 sc1
 v_mfma_f32_16x16x32_bf16 v[100:103], a[208:211], a[168:171], v[100:103]
 v_add_f32 v222, v222, v10
 s_add_u32 s70, s70, 8192
 s_addc_u32 s71, s71, 0
 v_mfma_f32_16x16x32_bf16 v[100:103], a[212:215], a[172:175], v[100:103]
 v_add_f32 v223, v223, v11
 v_mfma_f32_16x16x32_bf16 v[96:99], a[212:215], a[164:167], v[96:99]
 v_mfma_f32_16x16x32_bf16 v[96:99], a[208:211], a[160:163], v[96:99]
 v_add_f32 v224, v224, v8
 v_mfma_f32_16x16x32_bf16 v[92:95], a[208:211], a[152:155], v[92:95]
 v_add_f32 v225, v225, v9
 v_mfma_f32_16x16x32_bf16 v[92:95], a[212:215], a[156:159], v[92:95]
 v_mfma_f32_16x16x32_bf16 v[88:91], a[212:215], a[148:151], v[88:91]
 v_add_f32 v226, v226, v10
 v_mfma_f32_16x16x32_bf16 v[88:91], a[208:211], a[144:147], v[88:91]
 v_add_f32 v227, v227, v11
 v_mfma_f32_16x16x32_bf16 v[84:87], a[208:211], a[136:139], v[84:87]
 v_mfma_f32_16x16x32_bf16 v[84:87], a[212:215], a[140:143], v[84:87]
 v_add_f32 v228, v228, v8
 v_mfma_f32_16x16x32_bf16 v[80:83], a[212:215], a[132:135], v[80:83]
 v_add_f32 v229, v229, v9
 v_mfma_f32_16x16x32_bf16 v[80:83], a[208:211], a[128:131], v[80:83]
 s_waitcnt vmcnt(8)
 v_mfma_f32_16x16x32_bf16 v[112:115], a[216:219], a[128:131], v[112:115]
 ds_read_b128 a[128:131], v2 offset:34816
 v_add_f32 v230, v230, v10
 v_mfma_f32_16x16x32_bf16 v[112:115], a[220:223], a[132:135], v[112:115]
 global_load_dwordx4 a[212:215], v0, s[70:71] offset:-3072 sc1
 ds_read_b128 a[132:135], v2 offset:35840
 v_mfma_f32_16x16x32_bf16 v[116:119], a[220:223], a[140:143], v[116:119]
 ds_read_b128 a[140:143], v2 offset:39936
 v_add_f32 v231, v231, v11
 v_mfma_f32_16x16x32_bf16 v[116:119], a[216:219], a[136:139], v[116:119]
 global_load_dwordx4 a[208:211], v0, s[70:71] offset:-4096 sc1
 ds_read_b128 a[136:139], v2 offset:38912
 s_waitcnt lgkmcnt(4)
 v_mfma_f32_16x16x32_bf16 v[120:123], a[216:219], a[144:147], v[120:123]
 ds_read_b128 a[144:147], v2 offset:43008
 v_mfma_f32_16x16x32_bf16 v[120:123], a[220:223], a[148:151], v[120:123]
 ds_read_b128 a[148:151], v2 offset:44032
 v_add_f32 v232, v232, v12
 v_mfma_f32_16x16x32_bf16 v[124:127], a[220:223], a[156:159], v[124:127]
 ds_read_b128 a[156:159], v2 offset:48128
 v_add_f32 v233, v233, v13
 v_mfma_f32_16x16x32_bf16 v[124:127], a[216:219], a[152:155], v[124:127]
 ds_read_b128 a[152:155], v2 offset:47104
 v_mfma_f32_16x16x32_bf16 v[128:131], a[216:219], a[160:163], v[128:131]
 ds_read_b128 a[160:163], v2 offset:51200
 v_add_f32 v234, v234, v14
 v_mfma_f32_16x16x32_bf16 v[128:131], a[220:223], a[164:167], v[128:131]
 ds_read_b128 a[164:167], v2 offset:52224
 v_add_f32 v235, v235, v15
 v_mfma_f32_16x16x32_bf16 v[132:135], a[220:223], a[172:175], v[132:135]
 ds_read_b128 a[172:175], v2 offset:56320
 v_mfma_f32_16x16x32_bf16 v[132:135], a[216:219], a[168:171], v[132:135]
 ds_read_b128 a[168:171], v2 offset:55296
 v_add_f32 v236, v236, v12
 v_mfma_f32_16x16x32_bf16 a[240:243], a[216:219], a[176:179], a[240:243]
 ds_read_b128 a[176:179], v2 offset:59392
 v_add_f32 v237, v237, v13
 v_mfma_f32_16x16x32_bf16 a[240:243], a[220:223], a[180:183], a[240:243]
 ds_read_b128 a[180:183], v2 offset:60416
 v_mfma_f32_16x16x32_bf16 a[244:247], a[220:223], a[188:191], a[244:247]
 ds_read_b128 a[188:191], v2 offset:64512
 v_add_f32 v238, v238, v14
 v_mfma_f32_16x16x32_bf16 a[244:247], a[216:219], a[184:187], a[244:247]
 ds_read_b128 a[184:187], v2 offset:63488
 s_waitcnt vmcnt(8) lgkmcnt(8)
 v_mfma_f32_16x16x32_bf16 v[16:19], a[224:227], a[128:131], v[16:19]
 v_add_f32 v239, v239, v15
 v_mfma_f32_16x16x32_bf16 v[16:19], a[228:231], a[132:135], v[16:19]
 global_load_dwordx4 a[220:223], v0, s[70:71] offset:-1024 sc1
 v_add_f32 v240, v240, v12
 v_mfma_f32_16x16x32_bf16 v[20:23], a[228:231], a[140:143], v[20:23]
 v_mfma_f32_16x16x32_bf16 v[20:23], a[224:227], a[136:139], v[20:23]
 global_load_dwordx4 a[216:219], v0, s[70:71] offset:-2048 sc1
 v_add_f32 v241, v241, v13
 v_mfma_f32_16x16x32_bf16 v[24:27], a[224:227], a[144:147], v[24:27]
 v_add_f32 v242, v242, v14
 v_mfma_f32_16x16x32_bf16 v[24:27], a[228:231], a[148:151], v[24:27]
 v_mfma_f32_16x16x32_bf16 v[28:31], a[228:231], a[156:159], v[28:31]
 v_add_f32 v243, v243, v15
 v_mfma_f32_16x16x32_bf16 v[28:31], a[224:227], a[152:155], v[28:31]
 v_add_f32 v244, v244, v12
 s_waitcnt lgkmcnt(0)
 v_mfma_f32_16x16x32_bf16 v[32:35], a[224:227], a[160:163], v[32:35]
 v_mfma_f32_16x16x32_bf16 v[32:35], a[228:231], a[164:167], v[32:35]
 v_add_f32 v245, v245, v13
 v_mfma_f32_16x16x32_bf16 v[36:39], a[228:231], a[172:175], v[36:39]
 v_add_f32 v246, v246, v14
 v_mfma_f32_16x16x32_bf16 v[36:39], a[224:227], a[168:171], v[36:39]
 v_mfma_f32_16x16x32_bf16 v[40:43], a[224:227], a[176:179], v[40:43]
 v_add_f32 v247, v247, v15
 v_mfma_f32_16x16x32_bf16 v[40:43], a[228:231], a[180:183], v[40:43]
 v_mfma_f32_16x16x32_bf16 v[44:47], a[228:231], a[188:191], v[44:47]
 v_add_f32 v248, v248, v12
 v_mfma_f32_16x16x32_bf16 v[44:47], a[224:227], a[184:187], v[44:47]
 v_add_f32 v249, v249, v13
 s_waitcnt vmcnt(8)
 v_mfma_f32_16x16x32_bf16 v[76:79], a[232:235], a[184:187], v[76:79]
 v_mfma_f32_16x16x32_bf16 v[76:79], a[236:239], a[188:191], v[76:79]
 global_load_dwordx4 a[228:231], v0, s[70:71] offset:1024 sc1
 v_add_f32 v250, v250, v14
 v_mfma_f32_16x16x32_bf16 v[72:75], a[236:239], a[180:183], v[72:75]
 v_add_f32 v251, v251, v15
 v_mfma_f32_16x16x32_bf16 v[72:75], a[232:235], a[176:179], v[72:75]
 global_load_dwordx4 a[224:227], v0, s[70:71] offset:0 sc1
 v_mfma_f32_16x16x32_bf16 v[68:71], a[232:235], a[168:171], v[68:71]
 v_add_f32 v252, v252, v12
 v_mfma_f32_16x16x32_bf16 v[68:71], a[236:239], a[172:175], v[68:71]
 v_add_f32 v253, v253, v13
 v_mfma_f32_16x16x32_bf16 v[64:67], a[236:239], a[164:167], v[64:67]
 v_mfma_f32_16x16x32_bf16 v[64:67], a[232:235], a[160:163], v[64:67]
 v_add_f32 v254, v254, v14
 v_mfma_f32_16x16x32_bf16 v[60:63], a[232:235], a[152:155], v[60:63]
 v_add_f32 v255, v255, v15
 v_mfma_f32_16x16x32_bf16 v[60:63], a[236:239], a[156:159], v[60:63]
 v_mfma_f32_16x16x32_bf16 v[56:59], a[236:239], a[148:151], v[56:59]
 v_accvgpr_read_b32 v5, a248
 v_mfma_f32_16x16x32_bf16 v[56:59], a[232:235], a[144:147], v[56:59]
 v_mfma_f32_16x16x32_bf16 v[52:55], a[232:235], a[136:139], v[52:55]
 v_add_f32 v5, v5, v12
 v_mfma_f32_16x16x32_bf16 v[52:55], a[236:239], a[140:143], v[52:55]
 v_accvgpr_write_b32 a248, v5
 v_mfma_f32_16x16x32_bf16 v[48:51], a[236:239], a[132:135], v[48:51]
 v_mfma_f32_16x16x32_bf16 v[48:51], a[232:235], a[128:131], v[48:51]
 v_accvgpr_read_b32 v6, a249
 s_waitcnt vmcnt(8)
 v_mfma_f32_16x16x32_bf16 v[80:83], a[192:195], a[128:131], v[80:83]
 v_add_f32 v6, v6, v13
 v_mfma_f32_16x16x32_bf16 v[80:83], a[196:199], a[132:135], v[80:83]
 global_load_dwordx4 a[236:239], v0, s[70:71] offset:3072 sc1
 v_mfma_f32_16x16x32_bf16 v[84:87], a[196:199], a[140:143], v[84:87]
 v_accvgpr_write_b32 a249, v6
 v_mfma_f32_16x16x32_bf16 v[84:87], a[192:195], a[136:139], v[84:87]
 global_load_dwordx4 a[232:235], v0, s[70:71] offset:2048 sc1
 v_accvgpr_read_b32 v5, a250
 v_mfma_f32_16x16x32_bf16 v[88:91], a[192:195], a[144:147], v[88:91]
 s_add_u32 s70, s70, 8192
 s_addc_u32 s71, s71, 0
 v_mfma_f32_16x16x32_bf16 v[88:91], a[196:199], a[148:151], v[88:91]
 v_add_f32 v5, v5, v14
 v_mfma_f32_16x16x32_bf16 v[92:95], a[196:199], a[156:159], v[92:95]
 v_accvgpr_write_b32 a250, v5
 v_mfma_f32_16x16x32_bf16 v[92:95], a[192:195], a[152:155], v[92:95]
 v_mfma_f32_16x16x32_bf16 v[96:99], a[192:195], a[160:163], v[96:99]
 v_accvgpr_read_b32 v6, a251
 v_mfma_f32_16x16x32_bf16 v[96:99], a[196:199], a[164:167], v[96:99]
 v_mfma_f32_16x16x32_bf16 v[100:103], a[196:199], a[172:175], v[100:103]
 v_add_f32 v6, v6, v15
 v_mfma_f32_16x16x32_bf16 v[100:103], a[192:195], a[168:171], v[100:103]
 v_accvgpr_write_b32 a251, v6
 v_mfma_f32_16x16x32_bf16 v[104:107], a[192:195], a[176:179], v[104:107]
 v_mfma_f32_16x16x32_bf16 v[104:107], a[196:199], a[180:183], v[104:107]
 v_accvgpr_read_b32 v5, a252
 v_mfma_f32_16x16x32_bf16 v[108:111], a[196:199], a[188:191], v[108:111]
 v_add_f32 v5, v5, v12
 v_mfma_f32_16x16x32_bf16 v[108:111], a[192:195], a[184:187], v[108:111]
 s_waitcnt vmcnt(8)
 v_mfma_f32_16x16x32_bf16 a[244:247], a[200:203], a[184:187], a[244:247]
 v_accvgpr_write_b32 a252, v5
 v_mfma_f32_16x16x32_bf16 a[244:247], a[204:207], a[188:191], a[244:247]
 global_load_dwordx4 a[196:199], v0, s[70:71] offset:-3072 sc1
 v_accvgpr_read_b32 v6, a253
 v_mfma_f32_16x16x32_bf16 a[240:243], a[204:207], a[180:183], a[240:243]
 v_mfma_f32_16x16x32_bf16 a[240:243], a[200:203], a[176:179], a[240:243]
 global_load_dwordx4 a[192:195], v0, s[70:71] offset:-4096 sc1
 v_add_f32 v6, v6, v13
 v_mfma_f32_16x16x32_bf16 v[132:135], a[200:203], a[168:171], v[132:135]
 v_accvgpr_write_b32 a253, v6
 v_mfma_f32_16x16x32_bf16 v[132:135], a[204:207], a[172:175], v[132:135]
 v_mfma_f32_16x16x32_bf16 v[128:131], a[204:207], a[164:167], v[128:131]
 v_accvgpr_read_b32 v5, a254
 v_mfma_f32_16x16x32_bf16 v[128:131], a[200:203], a[160:163], v[128:131]
 v_mfma_f32_16x16x32_bf16 v[124:127], a[200:203], a[152:155], v[124:127]
 v_add_f32 v5, v5, v14
 v_mfma_f32_16x16x32_bf16 v[124:127], a[204:207], a[156:159], v[124:127]
 v_accvgpr_write_b32 a254, v5
 v_mfma_f32_16x16x32_bf16 v[120:123], a[204:207], a[148:151], v[120:123]
 v_mfma_f32_16x16x32_bf16 v[120:123], a[200:203], a[144:147], v[120:123]
 v_accvgpr_read_b32 v6, a255
 v_mfma_f32_16x16x32_bf16 v[116:119], a[200:203], a[136:139], v[116:119]
 v_add_f32 v6, v6, v15
 v_mfma_f32_16x16x32_bf16 v[116:119], a[204:207], a[140:143], v[116:119]
 v_mfma_f32_16x16x32_bf16 v[112:115], a[204:207], a[132:135], v[112:115]
 global_load_dwordx4 a[204:207], v0, s[70:71] offset:-1024 sc1
 v_accvgpr_write_b32 a255, v6
 v_mfma_f32_16x16x32_bf16 v[112:115], a[200:203], a[128:131], v[112:115]
 global_load_dwordx4 a[200:203], v0, s[70:71] offset:-2048 sc1
 s_waitcnt vmcnt(10)
 s_mov_b32 s34, 0x10000000
 s_mov_b32 s8, s32
 s_mov_b32 s9, s33
 s_mov_b32 s10, s34
 s_mov_b32 s20, 1024
 s_mov_b32 s21, 1024
 s_mov_b32 s22, 1024
 s_xor_b32 s30, s29, 131072
 s_add_u32 s51, s51, 2048
 s_add_u32 s25, s25, 1
 s_cmp_eq_u32 s25, 6
 s_cbranch_scc1 Llast
 v_mfma_f32_16x16x32_bf16 v[136:139], a[208:211], a[128:131], v[136:139]
 v_accvgpr_read_b32 v5, a0
 v_lshlrev_b32 v6, 16, v5
 v_mfma_f32_16x16x32_bf16 v[136:139], a[212:215], a[132:135], v[136:139]
 v_and_b32 v5, s26, v5
 v_mul_f32 v6, v6, v16
 v_mfma_f32_16x16x32_bf16 v[140:143], a[212:215], a[140:143], v[140:143]
 v_mul_f32 v5, v5, v17
 v_mfma_f32_16x16x32_bf16 v[140:143], a[208:211], a[136:139], v[140:143]
 v_cvt_pk_bf16_f32 v8, v6, v5
 v_accvgpr_read_b32 v5, a1
 v_mfma_f32_16x16x32_bf16 v[144:147], a[208:211], a[144:147], v[144:147]
 v_lshlrev_b32 v6, 16, v5
 v_and_b32 v5, s26, v5
 v_mfma_f32_16x16x32_bf16 v[144:147], a[212:215], a[148:151], v[144:147]
 v_mul_f32 v6, v6, v18
 v_mul_f32 v5, v5, v19
 v_mfma_f32_16x16x32_bf16 v[148:151], a[212:215], a[156:159], v[148:151]
 v_cvt_pk_bf16_f32 v9, v6, v5
 v_accvgpr_read_b32 v5, a2
 v_mfma_f32_16x16x32_bf16 v[148:151], a[208:211], a[152:155], v[148:151]
 v_lshlrev_b32 v6, 16, v5
 v_and_b32 v5, s26, v5
 v_mfma_f32_16x16x32_bf16 v[152:155], a[208:211], a[160:163], v[152:155]
 v_mul_f32 v6, v6, v48
 v_mfma_f32_16x16x32_bf16 v[152:155], a[212:215], a[164:167], v[152:155]
 v_mul_f32 v5, v5, v49
 v_cvt_pk_bf16_f32 v10, v6, v5
 v_mfma_f32_16x16x32_bf16 v[156:159], a[212:215], a[172:175], v[156:159]
 v_accvgpr_read_b32 v5, a3
 v_lshlrev_b32 v6, 16, v5
 v_mfma_f32_16x16x32_bf16 v[156:159], a[208:211], a[168:171], v[156:159]
 v_and_b32 v5, s26, v5
 v_mul_f32 v6, v6, v50
 v_mfma_f32_16x16x32_bf16 v[160:163], a[208:211], a[176:179], v[160:163]
 v_mul_f32 v5, v5, v51
 v_cvt_pk_bf16_f32 v11, v6, v5
 v_mfma_f32_16x16x32_bf16 v[160:163], a[212:215], a[180:183], v[160:163]
 ds_write_b128 v3, v[8:11]
 s_add_u32 s68, s29, 0
 v_mfma_f32_16x16x32_bf16 v[164:167], a[212:215], a[188:191], v[164:167]
 buffer_store_dwordx4 v[8:11], v3, s[32:35], s68 offen sc1
 v_accvgpr_read_b32 v5, a32
 v_lshlrev_b32 v6, 16, v5
 v_mfma_f32_16x16x32_bf16 v[164:167], a[208:211], a[184:187], v[164:167]
 v_and_b32 v5, s26, v5
 v_mul_f32 v6, v6, v80
 s_waitcnt vmcnt(9)
 v_mfma_f32_16x16x32_bf16 v[196:199], a[216:219], a[184:187], v[196:199]
 v_mul_f32 v5, v5, v81
 v_cvt_pk_bf16_f32 v12, v6, v5
 v_mfma_f32_16x16x32_bf16 v[196:199], a[220:223], a[188:191], v[196:199]
 global_load_dwordx4 a[212:215], v0, s[70:71] offset:1024 sc1
 v_accvgpr_read_b32 v5, a33
 v_mfma_f32_16x16x32_bf16 v[192:195], a[220:223], a[180:183], v[192:195]
 v_lshlrev_b32 v6, 16, v5
 v_and_b32 v5, s26, v5
 v_mfma_f32_16x16x32_bf16 v[192:195], a[216:219], a[176:179], v[192:195]
 global_load_dwordx4 a[208:211], v0, s[70:71] offset:0 sc1
 v_mul_f32 v6, v6, v82
 v_mfma_f32_16x16x32_bf16 v[188:191], a[216:219], a[168:171], v[188:191]
 v_mul_f32 v5, v5, v83
 v_cvt_pk_bf16_f32 v13, v6, v5
 v_mfma_f32_16x16x32_bf16 v[188:191], a[220:223], a[172:175], v[188:191]
 v_accvgpr_read_b32 v5, a34
 v_lshlrev_b32 v6, 16, v5
 v_mfma_f32_16x16x32_bf16 v[184:187], a[220:223], a[164:167], v[184:187]
 v_and_b32 v5, s26, v5
 v_mul_f32 v6, v6, v112
 v_mfma_f32_16x16x32_bf16 v[184:187], a[216:219], a[160:163], v[184:187]
 v_mul_f32 v5, v5, v113
 v_cvt_pk_bf16_f32 v14, v6, v5
 v_mfma_f32_16x16x32_bf16 v[180:183], a[216:219], a[152:155], v[180:183]
 v_accvgpr_read_b32 v5, a35
 v_lshlrev_b32 v6, 16, v5
 v_mfma_f32_16x16x32_bf16 v[180:183], a[220:223], a[156:159], v[180:183]
 v_and_b32 v5, s26, v5
 v_mul_f32 v6, v6, v114
 v_mfma_f32_16x16x32_bf16 v[176:179], a[220:223], a[148:151], v[176:179]
 v_mul_f32 v5, v5, v115
 v_cvt_pk_bf16_f32 v15, v6, v5
 v_mfma_f32_16x16x32_bf16 v[176:179], a[216:219], a[144:147], v[176:179]
 ds_write_b128 v3, v[12:15] offset:1024
 v_mfma_f32_16x16x32_bf16 v[172:175], a[216:219], a[136:139], v[172:175]
 buffer_store_dwordx4 v[12:15], v3, s[32:35], s68 offen offset:1024 sc1
 v_accvgpr_read_b32 v5, a4
 v_lshlrev_b32 v6, 16, v5
 v_mfma_f32_16x16x32_bf16 v[172:175], a[220:223], a[140:143], v[172:175]
 v_and_b32 v5, s26, v5
 v_mul_f32 v6, v6, v20
 v_mfma_f32_16x16x32_bf16 v[168:171], a[220:223], a[132:135], v[168:171]
 v_mul_f32 v5, v5, v21
 v_cvt_pk_bf16_f32 v8, v6, v5
 v_mfma_f32_16x16x32_bf16 v[168:171], a[216:219], a[128:131], v[168:171]
 v_accvgpr_read_b32 v5, a5
 v_lshlrev_b32 v6, 16, v5
 s_waitcnt vmcnt(10)
 v_mfma_f32_16x16x32_bf16 v[200:203], a[224:227], a[128:131], v[200:203]
 v_and_b32 v5, s26, v5
 v_mul_f32 v6, v6, v22
 v_mfma_f32_16x16x32_bf16 v[200:203], a[228:231], a[132:135], v[200:203]
 global_load_dwordx4 a[220:223], v0, s[70:71] offset:3072 sc1
 v_mul_f32 v5, v5, v23
 v_mfma_f32_16x16x32_bf16 v[204:207], a[228:231], a[140:143], v[204:207]
 v_cvt_pk_bf16_f32 v9, v6, v5
 v_accvgpr_read_b32 v5, a6
 v_mfma_f32_16x16x32_bf16 v[204:207], a[224:227], a[136:139], v[204:207]
 global_load_dwordx4 a[216:219], v0, s[70:71] offset:2048 sc1
 v_lshlrev_b32 v6, 16, v5
 v_mfma_f32_16x16x32_bf16 v[208:211], a[224:227], a[144:147], v[208:211]
 v_and_b32 v5, s26, v5
 v_mul_f32 v6, v6, v52
 s_add_u32 s70, s70, 8192
 s_addc_u32 s71, s71, 0
 v_mfma_f32_16x16x32_bf16 v[208:211], a[228:231], a[148:151], v[208:211]
 v_mul_f32 v5, v5, v53
 v_cvt_pk_bf16_f32 v10, v6, v5
 v_mfma_f32_16x16x32_bf16 v[212:215], a[228:231], a[156:159], v[212:215]
 v_accvgpr_read_b32 v5, a7
 v_lshlrev_b32 v6, 16, v5
 v_mfma_f32_16x16x32_bf16 v[212:215], a[224:227], a[152:155], v[212:215]
 v_and_b32 v5, s26, v5
 v_mul_f32 v6, v6, v54
 v_mfma_f32_16x16x32_bf16 v[216:219], a[224:227], a[160:163], v[216:219]
 v_mul_f32 v5, v5, v55
 v_cvt_pk_bf16_f32 v11, v6, v5
 v_mfma_f32_16x16x32_bf16 v[216:219], a[228:231], a[164:167], v[216:219]
 ds_write_b128 v3, v[8:11] offset:4096
 v_mfma_f32_16x16x32_bf16 v[220:223], a[228:231], a[172:175], v[220:223]
 buffer_store_dwordx4 v[8:11], v3, s[32:35], s68 offen offset:2048 sc1
 v_accvgpr_read_b32 v5, a36
 v_lshlrev_b32 v6, 16, v5
 v_and_b32 v5, s26, v5
 v_mfma_f32_16x16x32_bf16 v[220:223], a[224:227], a[168:171], v[220:223]
 v_mul_f32 v6, v6, v84
 v_mul_f32 v5, v5, v85
 v_mfma_f32_16x16x32_bf16 v[224:227], a[224:227], a[176:179], v[224:227]
 v_cvt_pk_bf16_f32 v12, v6, v5
 v_accvgpr_read_b32 v5, a37
 v_mfma_f32_16x16x32_bf16 v[224:227], a[228:231], a[180:183], v[224:227]
 v_lshlrev_b32 v6, 16, v5
 v_and_b32 v5, s26, v5
 v_mfma_f32_16x16x32_bf16 v[228:231], a[228:231], a[188:191], v[228:231]
 v_mul_f32 v6, v6, v86
 v_mul_f32 v5, v5, v87
 v_mfma_f32_16x16x32_bf16 v[228:231], a[224:227], a[184:187], v[228:231]
 v_cvt_pk_bf16_f32 v13, v6, v5
 v_accvgpr_read_b32 v5, a38
 s_waitcnt vmcnt(11)
 v_mfma_f32_16x16x32_bf16 a[252:255], a[232:235], a[184:187], a[252:255]
 ds_read_b128 a[184:187], v2 offset:30720
 v_lshlrev_b32 v6, 16, v5
 v_mfma_f32_16x16x32_bf16 a[252:255], a[236:239], a[188:191], a[252:255]
 global_load_dwordx4 a[228:231], v0, s[70:71] offset:-3072 sc1
 ds_read_b128 a[188:191], v2 offset:31744
 v_mfma_f32_16x16x32_bf16 a[248:251], a[236:239], a[180:183], a[248:251]
 ds_read_b128 a[180:183], v2 offset:27648
 v_and_b32 v5, s26, v5
 v_mfma_f32_16x16x32_bf16 a[248:251], a[232:235], a[176:179], a[248:251]
 global_load_dwordx4 a[224:227], v0, s[70:71] offset:-4096 sc1
 ds_read_b128 a[176:179], v2 offset:26624
 v_mul_f32 v6, v6, v116
 v_mfma_f32_16x16x32_bf16 v[252:255], a[232:235], a[168:171], v[252:255]
 ds_read_b128 a[168:171], v2 offset:22528
 v_mul_f32 v5, v5, v117
 v_mfma_f32_16x16x32_bf16 v[252:255], a[236:239], a[172:175], v[252:255]
 ds_read_b128 a[172:175], v2 offset:23552
 v_cvt_pk_bf16_f32 v14, v6, v5
 v_accvgpr_read_b32 v5, a39
 v_mfma_f32_16x16x32_bf16 v[248:251], a[236:239], a[164:167], v[248:251]
 ds_read_b128 a[164:167], v2 offset:19456
 v_lshlrev_b32 v6, 16, v5
 v_and_b32 v5, s26, v5
 v_mfma_f32_16x16x32_bf16 v[248:251], a[232:235], a[160:163], v[248:251]
 ds_read_b128 a[160:163], v2 offset:18432
 v_mul_f32 v6, v6, v118
 v_mul_f32 v5, v5, v119
 v_mfma_f32_16x16x32_bf16 v[244:247], a[232:235], a[152:155], v[244:247]
 ds_read_b128 a[152:155], v2 offset:14336
 v_cvt_pk_bf16_f32 v15, v6, v5
 v_mfma_f32_16x16x32_bf16 v[244:247], a[236:239], a[156:159], v[244:247]
 ds_read_b128 a[156:159], v2 offset:15360
 ds_write_b128 v3, v[12:15] offset:5120
 v_mfma_f32_16x16x32_bf16 v[240:243], a[236:239], a[148:151], v[240:243]
 buffer_store_dwordx4 v[12:15], v3, s[32:35], s68 offen offset:3072 sc1
 ds_read_b128 a[148:151], v2 offset:11264
 v_accvgpr_read_b32 v5, a8
 v_lshlrev_b32 v6, 16, v5
 v_mfma_f32_16x16x32_bf16 v[240:243], a[232:235], a[144:147], v[240:243]
 ds_read_b128 a[144:147], v2 offset:10240
 v_and_b32 v5, s26, v5
 v_mul_f32 v6, v6, v24
 v_mfma_f32_16x16x32_bf16 v[236:239], a[232:235], a[136:139], v[236:239]
 ds_read_b128 a[136:139], v2 offset:6144
 v_mul_f32 v5, v5, v25
 v_cvt_pk_bf16_f32 v8, v6, v5
 v_mfma_f32_16x16x32_bf16 v[236:239], a[236:239], a[140:143], v[236:239]
 ds_read_b128 a[140:143], v2 offset:7168
 v_accvgpr_read_b32 v5, a9
 v_lshlrev_b32 v6, 16, v5
 v_mfma_f32_16x16x32_bf16 v[232:235], a[236:239], a[132:135], v[232:235]
 ds_read_b128 a[132:135], v2 offset:3072
 v_and_b32 v5, s26, v5
 v_mfma_f32_16x16x32_bf16 v[232:235], a[232:235], a[128:131], v[232:235]
 ds_read_b128 a[128:131], v2 offset:2048
 v_mul_f32 v6, v6, v26
 s_waitcnt vmcnt(12) lgkmcnt(9)
 v_mfma_f32_16x16x32_bf16 v[164:167], a[192:195], a[184:187], v[164:167]
 v_mul_f32 v5, v5, v27
 v_cvt_pk_bf16_f32 v9, v6, v5
 v_mfma_f32_16x16x32_bf16 v[164:167], a[196:199], a[188:191], v[164:167]
 global_load_dwordx4 a[236:239], v0, s[70:71] offset:-1024 sc1
 v_accvgpr_read_b32 v5, a10
 v_mfma_f32_16x16x32_bf16 v[160:163], a[196:199], a[180:183], v[160:163]
 v_lshlrev_b32 v6, 16, v5
 v_and_b32 v5, s26, v5
 v_mfma_f32_16x16x32_bf16 v[160:163], a[192:195], a[176:179], v[160:163]
 global_load_dwordx4 a[232:235], v0, s[70:71] offset:-2048 sc1
 v_mul_f32 v6, v6, v56
 v_mfma_f32_16x16x32_bf16 v[156:159], a[192:195], a[168:171], v[156:159]
 v_mul_f32 v5, v5, v57
 v_cvt_pk_bf16_f32 v10, v6, v5
 v_mfma_f32_16x16x32_bf16 v[156:159], a[196:199], a[172:175], v[156:159]
 v_accvgpr_read_b32 v5, a11
 v_lshlrev_b32 v6, 16, v5
 v_mfma_f32_16x16x32_bf16 v[152:155], a[196:199], a[164:167], v[152:155]
 v_and_b32 v5, s26, v5
 v_mul_f32 v6, v6, v58
 v_mfma_f32_16x16x32_bf16 v[152:155], a[192:195], a[160:163], v[152:155]
 v_mul_f32 v5, v5, v59
 v_cvt_pk_bf16_f32 v11, v6, v5
 s_waitcnt lgkmcnt(0)
 v_mfma_f32_16x16x32_bf16 v[148:151], a[192:195], a[152:155], v[148:151]
 ds_write_b128 v3, v[8:11] offset:8192
 v_mfma_f32_16x16x32_bf16 v[148:151], a[196:199], a[156:159], v[148:151]
 v_lshlrev_b32 v4, 2, v3
 v_and_b32 v4, 192, v4
 v_mfma_f32_16x16x32_bf16 v[144:147], a[196:199], a[148:151], v[144:147]
 buffer_load_dword v4, v4, s[44:47], 0 offen sc1
 s_add_u32 s68, s29, 4096
 v_mfma_f32_16x16x32_bf16 v[144:147], a[192:195], a[144:147], v[144:147]
 buffer_store_dwordx4 v[8:11], v3, s[32:35], s68 offen sc1
 v_accvgpr_read_b32 v5, a40
 v_lshlrev_b32 v6, 16, v5
 v_and_b32 v5, s26, v5
 v_mfma_f32_16x16x32_bf16 v[140:143], a[192:195], a[136:139], v[140:143]
 v_mul_f32 v6, v6, v88
 v_mul_f32 v5, v5, v89
 v_mfma_f32_16x16x32_bf16 v[140:143], a[196:199], a[140:143], v[140:143]
 v_cvt_pk_bf16_f32 v12, v6, v5
 v_accvgpr_read_b32 v5, a41
 v_mfma_f32_16x16x32_bf16 v[136:139], a[196:199], a[132:135], v[136:139]
 v_lshlrev_b32 v6, 16, v5
 v_and_b32 v5, s26, v5
 v_mfma_f32_16x16x32_bf16 v[136:139], a[192:195], a[128:131], v[136:139]
 v_mul_f32 v6, v6, v90
 v_mul_f32 v5, v5, v91
 s_waitcnt vmcnt(14)
 v_mfma_f32_16x16x32_bf16 v[168:171], a[200:203], a[128:131], v[168:171]
 v_cvt_pk_bf16_f32 v13, v6, v5
 v_accvgpr_read_b32 v5, a42
 v_mfma_f32_16x16x32_bf16 v[168:171], a[204:207], a[132:135], v[168:171]
 global_load_dwordx4 a[196:199], v0, s[70:71] offset:1024 sc1
 v_lshlrev_b32 v6, 16, v5
 v_mfma_f32_16x16x32_bf16 v[172:175], a[204:207], a[140:143], v[172:175]
 v_and_b32 v5, s26, v5
 v_mul_f32 v6, v6, v120
 v_mfma_f32_16x16x32_bf16 v[172:175], a[200:203], a[136:139], v[172:175]
 global_load_dwordx4 a[192:195], v0, s[70:71] offset:0 sc1
 v_mul_f32 v5, v5, v121
 v_mfma_f32_16x16x32_bf16 v[176:179], a[200:203], a[144:147], v[176:179]
 v_cvt_pk_bf16_f32 v14, v6, v5
 v_accvgpr_read_b32 v5, a43
 v_mfma_f32_16x16x32_bf16 v[176:179], a[204:207], a[148:151], v[176:179]
 v_lshlrev_b32 v6, 16, v5
 v_and_b32 v5, s26, v5
 v_mfma_f32_16x16x32_bf16 v[180:183], a[204:207], a[156:159], v[180:183]
 v_mul_f32 v6, v6, v122
 v_mul_f32 v5, v5, v123
 v_mfma_f32_16x16x32_bf16 v[180:183], a[200:203], a[152:155], v[180:183]
 v_cvt_pk_bf16_f32 v15, v6, v5
 v_mfma_f32_16x16x32_bf16 v[184:187], a[200:203], a[160:163], v[184:187]
 ds_write_b128 v3, v[12:15] offset:9216
 v_mfma_f32_16x16x32_bf16 v[184:187], a[204:207], a[164:167], v[184:187]
 buffer_store_dwordx4 v[12:15], v3, s[32:35], s68 offen offset:1024 sc1
 v_accvgpr_read_b32 v5, a12
 v_lshlrev_b32 v6, 16, v5
 v_and_b32 v5, s26, v5
 v_mfma_f32_16x16x32_bf16 v[188:191], a[204:207], a[172:175], v[188:191]
 v_mul_f32 v6, v6, v28
 v_mul_f32 v5, v5, v29
 v_mfma_f32_16x16x32_bf16 v[188:191], a[200:203], a[168:171], v[188:191]
 v_cvt_pk_bf16_f32 v8, v6, v5
 v_accvgpr_read_b32 v5, a13
 v_mfma_f32_16x16x32_bf16 v[192:195], a[200:203], a[176:179], v[192:195]
 v_lshlrev_b32 v6, 16, v5
 v_and_b32 v5, s26, v5
 v_mfma_f32_16x16x32_bf16 v[192:195], a[204:207], a[180:183], v[192:195]
 v_mul_f32 v6, v6, v30
 v_mul_f32 v5, v5, v31
 v_mfma_f32_16x16x32_bf16 v[196:199], a[204:207], a[188:191], v[196:199]
 v_cvt_pk_bf16_f32 v9, v6, v5
 v_accvgpr_read_b32 v5, a14
 v_mfma_f32_16x16x32_bf16 v[196:199], a[200:203], a[184:187], v[196:199]
 v_lshlrev_b32 v6, 16, v5
 v_and_b32 v5, s26, v5
 s_waitcnt vmcnt(14)
 v_mfma_f32_16x16x32_bf16 v[228:231], a[208:211], a[184:187], v[228:231]
 v_mul_f32 v6, v6, v60
 v_mul_f32 v5, v5, v61
 v_mfma_f32_16x16x32_bf16 v[228:231], a[212:215], a[188:191], v[228:231]
 global_load_dwordx4 a[204:207], v0, s[70:71] offset:3072 sc1
 v_cvt_pk_bf16_f32 v10, v6, v5
 v_mfma_f32_16x16x32_bf16 v[224:227], a[212:215], a[180:183], v[224:227]
 v_accvgpr_read_b32 v5, a15
 v_lshlrev_b32 v6, 16, v5
 v_mfma_f32_16x16x32_bf16 v[224:227], a[208:211], a[176:179], v[224:227]
 global_load_dwordx4 a[200:203], v0, s[70:71] offset:2048 sc1
 v_and_b32 v5, s26, v5
 v_mul_f32 v6, v6, v62
 v_mfma_f32_16x16x32_bf16 v[220:223], a[208:211], a[168:171], v[220:223]
 v_mul_f32 v5, v5, v63
 v_cvt_pk_bf16_f32 v11, v6, v5
 s_add_u32 s70, s70, 8192
 s_addc_u32 s71, s71, 0
 v_mfma_f32_16x16x32_bf16 v[220:223], a[212:215], a[172:175], v[220:223]
 ds_write_b128 v3, v[8:11] offset:12288
 v_mfma_f32_16x16x32_bf16 v[216:219], a[212:215], a[164:167], v[216:219]
 buffer_store_dwordx4 v[8:11], v3, s[32:35], s68 offen offset:2048 sc1
 v_accvgpr_read_b32 v5, a44
 v_lshlrev_b32 v6, 16, v5
 v_and_b32 v5, s26, v5
 v_mfma_f32_16x16x32_bf16 v[216:219], a[208:211], a[160:163], v[216:219]
 v_mul_f32 v6, v6, v92
 v_mul_f32 v5, v5, v93
 v_mfma_f32_16x16x32_bf16 v[212:215], a[208:211], a[152:155], v[212:215]
 v_cvt_pk_bf16_f32 v12, v6, v5
 v_accvgpr_read_b32 v5, a45
 v_mfma_f32_16x16x32_bf16 v[212:215], a[212:215], a[156:159], v[212:215]
 v_lshlrev_b32 v6, 16, v5
 v_and_b32 v5, s26, v5
 v_mfma_f32_16x16x32_bf16 v[208:211], a[212:215], a[148:151], v[208:211]
 v_mul_f32 v6, v6, v94
 v_mul_f32 v5, v5, v95
 v_mfma_f32_16x16x32_bf16 v[208:211], a[208:211], a[144:147], v[208:211]
 v_cvt_pk_bf16_f32 v13, v6, v5
 v_accvgpr_read_b32 v5, a46
 v_mfma_f32_16x16x32_bf16 v[204:207], a[208:211], a[136:139], v[204:207]
 v_lshlrev_b32 v6, 16, v5
 v_and_b32 v5, s26, v5
 v_mfma_f32_16x16x32_bf16 v[204:207], a[212:215], a[140:143], v[204:207]
 v_mul_f32 v6, v6, v124
 v_mul_f32 v5, v5, v125
 v_mfma_f32_16x16x32_bf16 v[200:203], a[212:215], a[132:135], v[200:203]
 v_cvt_pk_bf16_f32 v14, v6, v5
 v_accvgpr_read_b32 v5, a47
 v_mfma_f32_16x16x32_bf16 v[200:203], a[208:211], a[128:131], v[200:203]
 v_lshlrev_b32 v6, 16, v5
 v_and_b32 v5, s26, v5
 s_waitcnt vmcnt(14)
 v_mfma_f32_16x16x32_bf16 v[232:235], a[216:219], a[128:131], v[232:235]
 ds_read_b128 a[128:131], v1 offset:34816
 v_mul_f32 v6, v6, v126
 v_mfma_f32_16x16x32_bf16 v[232:235], a[220:223], a[132:135], v[232:235]
 global_load_dwordx4 a[212:215], v0, s[70:71] offset:-3072 sc1
 ds_read_b128 a[132:135], v1 offset:35840
 v_mfma_f32_16x16x32_bf16 v[236:239], a[220:223], a[140:143], v[236:239]
 ds_read_b128 a[140:143], v1 offset:39936
 v_mul_f32 v5, v5, v127
 v_mfma_f32_16x16x32_bf16 v[236:239], a[216:219], a[136:139], v[236:239]
 global_load_dwordx4 a[208:211], v0, s[70:71] offset:-4096 sc1
 ds_read_b128 a[136:139], v1 offset:38912
 v_cvt_pk_bf16_f32 v15, v6, v5
 v_mfma_f32_16x16x32_bf16 v[240:243], a[216:219], a[144:147], v[240:243]
 ds_read_b128 a[144:147], v1 offset:43008
 ds_write_b128 v3, v[12:15] offset:13312
 v_mfma_f32_16x16x32_bf16 v[240:243], a[220:223], a[148:151], v[240:243]
 buffer_store_dwordx4 v[12:15], v3, s[32:35], s68 offen offset:3072 sc1
 ds_read_b128 a[148:151], v1 offset:44032
 v_accvgpr_read_b32 v5, a16
 v_lshlrev_b32 v6, 16, v5
 v_mfma_f32_16x16x32_bf16 v[244:247], a[220:223], a[156:159], v[244:247]
 ds_read_b128 a[156:159], v1 offset:48128
 v_and_b32 v5, s26, v5
 v_mul_f32 v6, v6, v32
 v_mfma_f32_16x16x32_bf16 v[244:247], a[216:219], a[152:155], v[244:247]
 ds_read_b128 a[152:155], v1 offset:47104
 v_mul_f32 v5, v5, v33
 v_mfma_f32_16x16x32_bf16 v[248:251], a[216:219], a[160:163], v[248:251]
 ds_read_b128 a[160:163], v1 offset:51200
 v_cvt_pk_bf16_f32 v8, v6, v5
 v_accvgpr_read_b32 v5, a17
 v_mfma_f32_16x16x32_bf16 v[248:251], a[220:223], a[164:167], v[248:251]
 ds_read_b128 a[164:167], v1 offset:52224
 v_lshlrev_b32 v6, 16, v5
 v_and_b32 v5, s26, v5
 v_mfma_f32_16x16x32_bf16 v[252:255], a[220:223], a[172:175], v[252:255]
 ds_read_b128 a[172:175], v1 offset:56320
 v_mul_f32 v6, v6, v34
 v_mul_f32 v5, v5, v35
 v_mfma_f32_16x16x32_bf16 v[252:255], a[216:219], a[168:171], v[252:255]
 ds_read_b128 a[168:171], v1 offset:55296
 v_cvt_pk_bf16_f32 v9, v6, v5
 v_mfma_f32_16x16x32_bf16 a[248:251], a[216:219], a[176:179], a[248:251]
 ds_read_b128 a[176:179], v1 offset:59392
 v_accvgpr_read_b32 v5, a18
 v_mfma_f32_16x16x32_bf16 a[248:251], a[220:223], a[180:183], a[248:251]
 ds_read_b128 a[180:183], v1 offset:60416
 v_lshlrev_b32 v6, 16, v5
 v_mfma_f32_16x16x32_bf16 a[252:255], a[220:223], a[188:191], a[252:255]
 ds_read_b128 a[188:191], v1 offset:64512
 v_and_b32 v5, s26, v5
 v_mfma_f32_16x16x32_bf16 a[252:255], a[216:219], a[184:187], a[252:255]
 ds_read_b128 a[184:187], v1 offset:63488
 v_mul_f32 v6, v6, v64
 s_waitcnt vmcnt(14) lgkmcnt(8)
 v_mfma_f32_16x16x32_bf16 v[136:139], a[224:227], a[128:131], v[136:139]
 v_mul_f32 v5, v5, v65
 v_cvt_pk_bf16_f32 v10, v6, v5
 v_mfma_f32_16x16x32_bf16 v[136:139], a[228:231], a[132:135], v[136:139]
 global_load_dwordx4 a[220:223], v0, s[70:71] offset:-1024 sc1
 v_accvgpr_read_b32 v5, a19
 v_mfma_f32_16x16x32_bf16 v[140:143], a[228:231], a[140:143], v[140:143]
 v_lshlrev_b32 v6, 16, v5
 v_and_b32 v5, s26, v5
 v_mfma_f32_16x16x32_bf16 v[140:143], a[224:227], a[136:139], v[140:143]
 global_load_dwordx4 a[216:219], v0, s[70:71] offset:-2048 sc1
 v_mul_f32 v6, v6, v66
 v_mfma_f32_16x16x32_bf16 v[144:147], a[224:227], a[144:147], v[144:147]
 v_mul_f32 v5, v5, v67
 v_cvt_pk_bf16_f32 v11, v6, v5
 v_mfma_f32_16x16x32_bf16 v[144:147], a[228:231], a[148:151], v[144:147]
 ds_write_b128 v3, v[8:11] offset:16384
 s_add_u32 s68, s29, 8192
 v_mfma_f32_16x16x32_bf16 v[148:151], a[228:231], a[156:159], v[148:151]
 buffer_store_dwordx4 v[8:11], v3, s[32:35], s68 offen sc1
 v_accvgpr_read_b32 v5, a48
 v_lshlrev_b32 v6, 16, v5
 v_and_b32 v5, s26, v5
 v_mfma_f32_16x16x32_bf16 v[148:151], a[224:227], a[152:155], v[148:151]
 v_mul_f32 v6, v6, v96
 v_mul_f32 v5, v5, v97
 s_waitcnt lgkmcnt(1)
 v_mfma_f32_16x16x32_bf16 v[152:155], a[224:227], a[160:163], v[152:155]
 v_cvt_pk_bf16_f32 v12, v6, v5
 v_accvgpr_read_b32 v5, a49
 v_mfma_f32_16x16x32_bf16 v[152:155], a[228:231], a[164:167], v[152:155]
 v_lshlrev_b32 v6, 16, v5
 v_and_b32 v5, s26, v5
 v_mfma_f32_16x16x32_bf16 v[156:159], a[228:231], a[172:175], v[156:159]
 v_mul_f32 v6, v6, v98
 v_mul_f32 v5, v5, v99
 v_mfma_f32_16x16x32_bf16 v[156:159], a[224:227], a[168:171], v[156:159]
 v_cvt_pk_bf16_f32 v13, v6, v5
 v_accvgpr_read_b32 v5, a50
 v_mfma_f32_16x16x32_bf16 v[160:163], a[224:227], a[176:179], v[160:163]
 v_lshlrev_b32 v6, 16, v5
 v_and_b32 v5, s26, v5
 v_mfma_f32_16x16x32_bf16 v[160:163], a[228:231], a[180:183], v[160:163]
 v_mul_f32 v6, v6, v128
 v_mul_f32 v5, v5, v129
 v_mfma_f32_16x16x32_bf16 v[164:167], a[228:231], a[188:191], v[164:167]
 v_cvt_pk_bf16_f32 v14, v6, v5
 v_accvgpr_read_b32 v5, a51
 v_mfma_f32_16x16x32_bf16 v[164:167], a[224:227], a[184:187], v[164:167]
 v_lshlrev_b32 v6, 16, v5
 v_and_b32 v5, s26, v5
 s_waitcnt vmcnt(14)
 v_mfma_f32_16x16x32_bf16 v[196:199], a[232:235], a[184:187], v[196:199]
 v_mul_f32 v6, v6, v130
 v_mul_f32 v5, v5, v131
 v_mfma_f32_16x16x32_bf16 v[196:199], a[236:239], a[188:191], v[196:199]
 global_load_dwordx4 a[228:231], v0, s[70:71] offset:1024 sc1
 v_cvt_pk_bf16_f32 v15, v6, v5
 v_mfma_f32_16x16x32_bf16 v[192:195], a[236:239], a[180:183], v[192:195]
 ds_write_b128 v3, v[12:15] offset:17408
 v_mfma_f32_16x16x32_bf16 v[192:195], a[232:235], a[176:179], v[192:195]
 global_load_dwordx4 a[224:227], v0, s[70:71] offset:0 sc1
 v_mfma_f32_16x16x32_bf16 v[188:191], a[232:235], a[168:171], v[188:191]
 buffer_store_dwordx4 v[12:15], v3, s[32:35], s68 offen offset:1024 sc1
 v_accvgpr_read_b32 v5, a20
 v_lshlrev_b32 v6, 16, v5
 v_and_b32 v5, s26, v5
 v_mul_f32 v6, v6, v36
 v_mfma_f32_16x16x32_bf16 v[188:191], a[236:239], a[172:175], v[188:191]
 v_mul_f32 v5, v5, v37
 v_cvt_pk_bf16_f32 v8, v6, v5
 v_mfma_f32_16x16x32_bf16 v[184:187], a[236:239], a[164:167], v[184:187]
 v_accvgpr_read_b32 v5, a21
 v_lshlrev_b32 v6, 16, v5
 v_mfma_f32_16x16x32_bf16 v[184:187], a[232:235], a[160:163], v[184:187]
 v_and_b32 v5, s26, v5
 v_mul_f32 v6, v6, v38
 v_mfma_f32_16x16x32_bf16 v[180:183], a[232:235], a[152:155], v[180:183]
 v_mul_f32 v5, v5, v39
 v_cvt_pk_bf16_f32 v9, v6, v5
 v_mfma_f32_16x16x32_bf16 v[180:183], a[236:239], a[156:159], v[180:183]
 v_accvgpr_read_b32 v5, a22
 v_lshlrev_b32 v6, 16, v5
 v_mfma_f32_16x16x32_bf16 v[176:179], a[236:239], a[148:151], v[176:179]
 v_and_b32 v5, s26, v5
 v_mul_f32 v6, v6, v68
 v_mfma_f32_16x16x32_bf16 v[176:179], a[232:235], a[144:147], v[176:179]
 v_mul_f32 v5, v5, v69
 v_cvt_pk_bf16_f32 v10, v6, v5
 v_mfma_f32_16x16x32_bf16 v[172:175], a[232:235], a[136:139], v[172:175]
 v_accvgpr_read_b32 v5, a23
 v_lshlrev_b32 v6, 16, v5
 v_mfma_f32_16x16x32_bf16 v[172:175], a[236:239], a[140:143], v[172:175]
 v_and_b32 v5, s26, v5
 v_mul_f32 v6, v6, v70
 v_mfma_f32_16x16x32_bf16 v[168:171], a[236:239], a[132:135], v[168:171]
 v_mul_f32 v5, v5, v71
 v_cvt_pk_bf16_f32 v11, v6, v5
 v_mfma_f32_16x16x32_bf16 v[168:171], a[232:235], a[128:131], v[168:171]
 ds_write_b128 v3, v[8:11] offset:20480
 buffer_store_dwordx4 v[8:11], v3, s[32:35], s68 offen offset:2048 sc1
 v_accvgpr_read_b32 v5, a52
 v_lshlrev_b32 v6, 16, v5
 v_and_b32 v5, s26, v5
 s_waitcnt vmcnt(14)
 v_mfma_f32_16x16x32_bf16 v[200:203], a[192:195], a[128:131], v[200:203]
 v_mul_f32 v6, v6, v100
 v_mul_f32 v5, v5, v101
 v_mfma_f32_16x16x32_bf16 v[200:203], a[196:199], a[132:135], v[200:203]
 global_load_dwordx4 a[236:239], v0, s[70:71] offset:3072 sc1
 v_cvt_pk_bf16_f32 v12, v6, v5
 v_mfma_f32_16x16x32_bf16 v[204:207], a[196:199], a[140:143], v[204:207]
 v_accvgpr_read_b32 v5, a53
 v_cmp_gt_i32 vcc, s27, v4
 s_and_b64 vcc, exec, vcc
 s_cbranch_vccnz Lspin_w
Lok_w:
 s_add_u32 s27, s27, 64
 v_mfma_f32_16x16x32_bf16 v[204:207], a[192:195], a[136:139], v[204:207]
 global_load_dwordx4 a[232:235], v0, s[70:71] offset:2048 sc1
 v_lshlrev_b32 v6, 16, v5
 v_mfma_f32_16x16x32_bf16 v[208:211], a[192:195], a[144:147], v[208:211]
 v_and_b32 v5, s26, v5
 v_mul_f32 v6, v6, v102
 s_add_u32 s70, s70, 1843200
 s_addc_u32 s71, s71, 0
 v_mfma_f32_16x16x32_bf16 v[208:211], a[196:199], a[148:151], v[208:211]
 v_mul_f32 v5, v5, v103
 v_cvt_pk_bf16_f32 v13, v6, v5
 v_mfma_f32_16x16x32_bf16 v[212:215], a[196:199], a[156:159], v[212:215]
 v_accvgpr_read_b32 v5, a54
 v_lshlrev_b32 v6, 16, v5
 v_mfma_f32_16x16x32_bf16 v[212:215], a[192:195], a[152:155], v[212:215]
 v_and_b32 v5, s26, v5
 v_mul_f32 v6, v6, v132
 v_mfma_f32_16x16x32_bf16 v[216:219], a[192:195], a[160:163], v[216:219]
 v_mul_f32 v5, v5, v133
 v_cvt_pk_bf16_f32 v14, v6, v5
 v_mfma_f32_16x16x32_bf16 v[216:219], a[196:199], a[164:167], v[216:219]
 v_accvgpr_read_b32 v5, a55
 v_lshlrev_b32 v6, 16, v5
 v_mfma_f32_16x16x32_bf16 v[220:223], a[196:199], a[172:175], v[220:223]
 v_and_b32 v5, s26, v5
 v_mul_f32 v6, v6, v134
 v_mfma_f32_16x16x32_bf16 v[220:223], a[192:195], a[168:171], v[220:223]
 v_mul_f32 v5, v5, v135
 v_cvt_pk_bf16_f32 v15, v6, v5
 v_mfma_f32_16x16x32_bf16 v[224:227], a[192:195], a[176:179], v[224:227]
 ds_write_b128 v3, v[12:15] offset:21504
 v_mfma_f32_16x16x32_bf16 v[224:227], a[196:199], a[180:183], v[224:227]
 buffer_store_dwordx4 v[12:15], v3, s[32:35], s68 offen offset:3072 sc1
 v_accvgpr_read_b32 v5, a24
 v_lshlrev_b32 v6, 16, v5
 v_and_b32 v5, s26, v5
 v_mfma_f32_16x16x32_bf16 v[228:231], a[196:199], a[188:191], v[228:231]
 v_mul_f32 v6, v6, v40
 v_mul_f32 v5, v5, v41
 v_mfma_f32_16x16x32_bf16 v[228:231], a[192:195], a[184:187], v[228:231]
 v_cvt_pk_bf16_f32 v8, v6, v5
 v_accvgpr_read_b32 v5, a25
 s_waitcnt vmcnt(14)
 v_mfma_f32_16x16x32_bf16 a[252:255], a[200:203], a[184:187], a[252:255]
 ds_read_b128 a[184:187], v1 offset:30720
 v_lshlrev_b32 v6, 16, v5
 v_mfma_f32_16x16x32_bf16 a[252:255], a[204:207], a[188:191], a[252:255]
 global_load_dwordx4 a[196:199], v0, s[70:71] offset:-3072 sc1
 ds_read_b128 a[188:191], v1 offset:31744
 v_mfma_f32_16x16x32_bf16 a[248:251], a[204:207], a[180:183], a[248:251]
 ds_read_b128 a[180:183], v1 offset:27648
 v_and_b32 v5, s26, v5
 v_mfma_f32_16x16x32_bf16 a[248:251], a[200:203], a[176:179], a[248:251]
 global_load_dwordx4 a[192:195], v0, s[70:71] offset:-4096 sc1
 ds_read_b128 a[176:179], v1 offset:26624
 v_mul_f32 v6, v6, v42
 v_mfma_f32_16x16x32_bf16 v[252:255], a[200:203], a[168:171], v[252:255]
 ds_read_b128 a[168:171], v1 offset:22528
 v_mul_f32 v5, v5, v43
 v_cvt_pk_bf16_f32 v9, v6, v5
 v_mfma_f32_16x16x32_bf16 v[252:255], a[204:207], a[172:175], v[252:255]
 ds_read_b128 a[172:175], v1 offset:23552
 v_accvgpr_read_b32 v5, a26
 v_mfma_f32_16x16x32_bf16 v[248:251], a[204:207], a[164:167], v[248:251]
 ds_read_b128 a[164:167], v1 offset:19456
 v_lshlrev_b32 v6, 16, v5
 v_and_b32 v5, s26, v5
 v_mfma_f32_16x16x32_bf16 v[248:251], a[200:203], a[160:163], v[248:251]
 ds_read_b128 a[160:163], v1 offset:18432
 v_mul_f32 v6, v6, v72
 v_mfma_f32_16x16x32_bf16 v[244:247], a[200:203], a[152:155], v[244:247]
 ds_read_b128 a[152:155], v1 offset:14336
 v_mul_f32 v5, v5, v73
 v_mfma_f32_16x16x32_bf16 v[244:247], a[204:207], a[156:159], v[244:247]
 ds_read_b128 a[156:159], v1 offset:15360
 v_cvt_pk_bf16_f32 v10, v6, v5
 v_mfma_f32_16x16x32_bf16 v[240:243], a[204:207], a[148:151], v[240:243]
 ds_read_b128 a[148:151], v1 offset:11264
 v_accvgpr_read_b32 v5, a27
 v_mfma_f32_16x16x32_bf16 v[240:243], a[200:203], a[144:147], v[240:243]
 ds_read_b128 a[144:147], v1 offset:10240
 v_lshlrev_b32 v6, 16, v5
 v_mfma_f32_16x16x32_bf16 v[236:239], a[200:203], a[136:139], v[236:239]
 ds_read_b128 a[136:139], v1 offset:6144
 v_and_b32 v5, s26, v5
 v_mfma_f32_16x16x32_bf16 v[236:239], a[204:207], a[140:143], v[236:239]
 ds_read_b128 a[140:143], v1 offset:7168
 v_mul_f32 v6, v6, v74
 v_mfma_f32_16x16x32_bf16 v[232:235], a[204:207], a[132:135], v[232:235]
 ds_read_b128 a[132:135], v1 offset:3072
 v_mul_f32 v5, v5, v75
 v_mfma_f32_16x16x32_bf16 v[232:235], a[200:203], a[128:131], v[232:235]
 ds_read_b128 a[128:131], v1 offset:2048
 v_cvt_pk_bf16_f32 v11, v6, v5
 s_waitcnt vmcnt(13) lgkmcnt(8)
 v_mfma_f32_16x16x32_bf16 v[164:167], a[208:211], a[184:187], v[164:167]
 ds_write_b128 v3, v[8:11] offset:24576
 v_accvgpr_read_b32 v5, a56
 v_lshlrev_b32 v6, 16, v5
 v_and_b32 v5, s26, v5
 v_mul_f32 v6, v6, v104
 v_mul_f32 v5, v5, v105
 v_cvt_pk_bf16_f32 v12, v6, v5
 v_mfma_f32_16x16x32_bf16 v[164:167], a[212:215], a[188:191], v[164:167]
 global_load_dwordx4 a[204:207], v0, s[70:71] offset:-1024 sc1
 v_accvgpr_read_b32 v5, a57
 v_lshlrev_b32 v6, 16, v5
 v_and_b32 v5, s26, v5
 v_mfma_f32_16x16x32_bf16 v[160:163], a[212:215], a[180:183], v[160:163]
 v_mul_f32 v6, v6, v106
 v_mul_f32 v5, v5, v107
 v_mfma_f32_16x16x32_bf16 v[160:163], a[208:211], a[176:179], v[160:163]
 global_load_dwordx4 a[200:203], v0, s[70:71] offset:-2048 sc1
 v_cvt_pk_bf16_f32 v13, v6, v5
 v_mfma_f32_16x16x32_bf16 v[156:159], a[208:211], a[168:171], v[156:159]
 v_accvgpr_read_b32 v5, a58
 v_accvgpr_read_b32 v7, a240
 v_mfma_f32_16x16x32_bf16 v[156:159], a[212:215], a[172:175], v[156:159]
 v_lshlrev_b32 v6, 16, v5
 v_and_b32 v5, s26, v5
 v_mfma_f32_16x16x32_bf16 v[152:155], a[212:215], a[164:167], v[152:155]
 v_mul_f32 v6, v6, v7
 v_accvgpr_read_b32 v7, a241
 v_mfma_f32_16x16x32_bf16 v[152:155], a[208:211], a[160:163], v[152:155]
 v_mul_f32 v5, v5, v7
 v_cvt_pk_bf16_f32 v14, v6, v5
 s_waitcnt lgkmcnt(1)
 v_mfma_f32_16x16x32_bf16 v[148:151], a[208:211], a[152:155], v[148:151]
 v_accvgpr_read_b32 v5, a59
 v_accvgpr_read_b32 v7, a242
 v_mfma_f32_16x16x32_bf16 v[148:151], a[212:215], a[156:159], v[148:151]
 v_lshlrev_b32 v6, 16, v5
 v_and_b32 v5, s26, v5
 v_mfma_f32_16x16x32_bf16 v[144:147], a[212:215], a[148:151], v[144:147]
 v_mul_f32 v6, v6, v7
 v_accvgpr_read_b32 v7, a243
 v_mfma_f32_16x16x32_bf16 v[144:147], a[208:211], a[144:147], v[144:147]
 v_mul_f32 v5, v5, v7
 v_cvt_pk_bf16_f32 v15, v6, v5
 v_mfma_f32_16x16x32_bf16 v[140:143], a[208:211], a[136:139], v[140:143]
 ds_write_b128 v3, v[12:15] offset:25600
 v_accvgpr_read_b32 v5, a28
 v_mfma_f32_16x16x32_bf16 v[140:143], a[212:215], a[140:143], v[140:143]
 v_lshlrev_b32 v6, 16, v5
 v_and_b32 v5, s26, v5
 v_mfma_f32_16x16x32_bf16 v[136:139], a[212:215], a[132:135], v[136:139]
 v_mul_f32 v6, v6, v44
 v_mul_f32 v5, v5, v45
 v_mfma_f32_16x16x32_bf16 v[136:139], a[208:211], a[128:131], v[136:139]
 v_cvt_pk_bf16_f32 v8, v6, v5
 v_accvgpr_read_b32 v5, a29
 s_waitcnt vmcnt(12)
 v_mfma_f32_16x16x32_bf16 v[168:171], a[216:219], a[128:131], v[168:171]
 v_lshlrev_b32 v6, 16, v5
 v_and_b32 v5, s26, v5
 v_mfma_f32_16x16x32_bf16 v[168:171], a[220:223], a[132:135], v[168:171]
 global_load_dwordx4 a[212:215], v0, s[70:71] offset:1024 sc1
 v_mul_f32 v6, v6, v46
 v_mfma_f32_16x16x32_bf16 v[172:175], a[220:223], a[140:143], v[172:175]
 v_mul_f32 v5, v5, v47
 v_cvt_pk_bf16_f32 v9, v6, v5
 v_mfma_f32_16x16x32_bf16 v[172:175], a[216:219], a[136:139], v[172:175]
 global_load_dwordx4 a[208:211], v0, s[70:71] offset:0 sc1
 v_accvgpr_read_b32 v5, a30
 v_lshlrev_b32 v6, 16, v5
 v_mfma_f32_16x16x32_bf16 v[176:179], a[216:219], a[144:147], v[176:179]
 v_and_b32 v5, s26, v5
 v_mul_f32 v6, v6, v76
 v_mfma_f32_16x16x32_bf16 v[176:179], a[220:223], a[148:151], v[176:179]
 v_mul_f32 v5, v5, v77
 v_cvt_pk_bf16_f32 v10, v6, v5
 v_mfma_f32_16x16x32_bf16 v[180:183], a[220:223], a[156:159], v[180:183]
 v_accvgpr_read_b32 v5, a31
 v_lshlrev_b32 v6, 16, v5
 v_mfma_f32_16x16x32_bf16 v[180:183], a[216:219], a[152:155], v[180:183]
 v_and_b32 v5, s26, v5
 v_mul_f32 v6, v6, v78
 v_mfma_f32_16x16x32_bf16 v[184:187], a[216:219], a[160:163], v[184:187]
 v_mul_f32 v5, v5, v79
 v_cvt_pk_bf16_f32 v11, v6, v5
 v_mfma_f32_16x16x32_bf16 v[184:187], a[220:223], a[164:167], v[184:187]
 ds_write_b128 v3, v[8:11] offset:28672
 v_mfma_f32_16x16x32_bf16 v[188:191], a[220:223], a[172:175], v[188:191]
 v_accvgpr_read_b32 v5, a60
 v_lshlrev_b32 v6, 16, v5
 v_mfma_f32_16x16x32_bf16 v[188:191], a[216:219], a[168:171], v[188:191]
 v_and_b32 v5, s26, v5
 v_mul_f32 v6, v6, v108
 v_mfma_f32_16x16x32_bf16 v[192:195], a[216:219], a[176:179], v[192:195]
 v_mul_f32 v5, v5, v109
 v_cvt_pk_bf16_f32 v12, v6, v5
 v_mfma_f32_16x16x32_bf16 v[192:195], a[220:223], a[180:183], v[192:195]
 v_accvgpr_read_b32 v5, a61
 v_lshlrev_b32 v6, 16, v5
 v_mfma_f32_16x16x32_bf16 v[196:199], a[220:223], a[188:191], v[196:199]
 v_and_b32 v5, s26, v5
 v_mul_f32 v6, v6, v110
 v_mfma_f32_16x16x32_bf16 v[196:199], a[216:219], a[184:187], v[196:199]
 v_mul_f32 v5, v5, v111
 v_cvt_pk_bf16_f32 v13, v6, v5
 s_waitcnt vmcnt(11)
 v_mfma_f32_16x16x32_bf16 v[228:231], a[224:227], a[184:187], v[228:231]
 v_accvgpr_read_b32 v5, a62
 v_accvgpr_read_b32 v7, a244
 v_mfma_f32_16x16x32_bf16 v[228:231], a[228:231], a[188:191], v[228:231]
 global_load_dwordx4 a[220:223], v0, s[70:71] offset:3072 sc1
 v_lshlrev_b32 v6, 16, v5
 v_mfma_f32_16x16x32_bf16 v[224:227], a[228:231], a[180:183], v[224:227]
 v_and_b32 v5, s26, v5
 v_mul_f32 v6, v6, v7
 v_mfma_f32_16x16x32_bf16 v[224:227], a[224:227], a[176:179], v[224:227]
 global_load_dwordx4 a[216:219], v0, s[70:71] offset:2048 sc1
 v_accvgpr_read_b32 v7, a245
 v_mfma_f32_16x16x32_bf16 v[220:223], a[224:227], a[168:171], v[220:223]
 v_mul_f32 v5, v5, v7
 v_cvt_pk_bf16_f32 v14, v6, v5
 s_add_u32 s70, s70, 8192
 s_addc_u32 s71, s71, 0
 v_mfma_f32_16x16x32_bf16 v[220:223], a[228:231], a[172:175], v[220:223]
 v_accvgpr_read_b32 v5, a63
 v_accvgpr_read_b32 v7, a246
 v_mfma_f32_16x16x32_bf16 v[216:219], a[228:231], a[164:167], v[216:219]
 v_lshlrev_b32 v6, 16, v5
 v_and_b32 v5, s26, v5
 v_mfma_f32_16x16x32_bf16 v[216:219], a[224:227], a[160:163], v[216:219]
 v_mul_f32 v6, v6, v7
 v_accvgpr_read_b32 v7, a247
 v_mfma_f32_16x16x32_bf16 v[212:215], a[224:227], a[152:155], v[212:215]
 v_mul_f32 v5, v5, v7
 v_cvt_pk_bf16_f32 v15, v6, v5
 v_mfma_f32_16x16x32_bf16 v[212:215], a[228:231], a[156:159], v[212:215]
 ds_write_b128 v3, v[12:15] offset:29696
 v_mfma_f32_16x16x32_bf16 v[208:211], a[228:231], a[148:151], v[208:211]
 s_waitcnt lgkmcnt(0)
 s_barrier
 v_mfma_f32_16x16x32_bf16 v[208:211], a[224:227], a[144:147], v[208:211]
 v_and_b32 v1, 1023, v3
 v_add_u32 v2, 65536, v1
 v_mfma_f32_16x16x32_bf16 v[204:207], a[224:227], a[136:139], v[204:207]
 v_mfma_f32_16x16x32_bf16 v[204:207], a[228:231], a[140:143], v[204:207]
 v_mfma_f32_16x16x32_bf16 v[200:203], a[228:231], a[132:135], v[200:203]
 v_mfma_f32_16x16x32_bf16 v[200:203], a[224:227], a[128:131], v[200:203]
 s_waitcnt vmcnt(9)
 v_mfma_f32_16x16x32_bf16 v[232:235], a[232:235], a[128:131], v[232:235]
 ds_read_b128 a[128:131], v1
 v_mfma_f32_16x16x32_bf16 v[232:235], a[236:239], a[132:135], v[232:235]
 global_load_dwordx4 a[228:231], v0, s[70:71] offset:-3072 sc1
 ds_read_b128 a[132:135], v1 offset:1024
 v_mfma_f32_16x16x32_bf16 v[236:239], a[236:239], a[140:143], v[236:239]
 ds_read_b128 a[140:143], v1 offset:5120
 v_mfma_f32_16x16x32_bf16 v[236:239], a[232:235], a[136:139], v[236:239]
 global_load_dwordx4 a[224:227], v0, s[70:71] offset:-4096 sc1
 ds_read_b128 a[136:139], v1 offset:4096
 v_mfma_f32_16x16x32_bf16 v[240:243], a[232:235], a[144:147], v[240:243]
 ds_read_b128 a[144:147], v1 offset:8192
 v_mfma_f32_16x16x32_bf16 v[240:243], a[236:239], a[148:151], v[240:243]
 ds_read_b128 a[148:151], v1 offset:9216
 v_mfma_f32_16x16x32_bf16 v[244:247], a[236:239], a[156:159], v[244:247]
 ds_read_b128 a[156:159], v1 offset:13312
 v_mfma_f32_16x16x32_bf16 v[244:247], a[232:235], a[152:155], v[244:247]
 ds_read_b128 a[152:155], v1 offset:12288
 v_mfma_f32_16x16x32_bf16 v[248:251], a[232:235], a[160:163], v[248:251]
 ds_read_b128 a[160:163], v1 offset:16384
 v_mfma_f32_16x16x32_bf16 v[248:251], a[236:239], a[164:167], v[248:251]
 ds_read_b128 a[164:167], v1 offset:17408
 v_mfma_f32_16x16x32_bf16 v[252:255], a[236:239], a[172:175], v[252:255]
 ds_read_b128 a[172:175], v1 offset:21504
 v_mfma_f32_16x16x32_bf16 v[252:255], a[232:235], a[168:171], v[252:255]
 ds_read_b128 a[168:171], v1 offset:20480
 v_mfma_f32_16x16x32_bf16 a[248:251], a[232:235], a[176:179], a[248:251]
 ds_read_b128 a[176:179], v1 offset:24576
 v_mfma_f32_16x16x32_bf16 a[248:251], a[236:239], a[180:183], a[248:251]
 ds_read_b128 a[180:183], v1 offset:25600
 v_mfma_f32_16x16x32_bf16 a[252:255], a[236:239], a[188:191], a[252:255]
 global_load_dwordx4 a[236:239], v0, s[70:71] offset:-1024 sc1
 ds_read_b128 a[188:191], v1 offset:29696
 v_mfma_f32_16x16x32_bf16 a[252:255], a[232:235], a[184:187], a[252:255]
 global_load_dwordx4 a[232:235], v0, s[70:71] offset:-2048 sc1
 ds_read_b128 a[184:187], v1 offset:28672
 s_waitcnt vmcnt(10) lgkmcnt(8)
 v_mfma_f32_16x16x32_bf16 v[16:19], a[192:195], a[128:131], v[16:19]
 v_accvgpr_read_b32 v5, a64
 v_lshlrev_b32 v6, 16, v5
 v_mfma_f32_16x16x32_bf16 v[16:19], a[196:199], a[132:135], v[16:19]
 ds_read_b128 v[12:15], v3 offset:24576
 v_mfma_f32_16x16x32_bf16 v[20:23], a[196:199], a[140:143], v[20:23]
 v_and_b32 v5, s26, v5
 v_mul_f32 v6, v6, v136
 v_mfma_f32_16x16x32_bf16 v[20:23], a[192:195], a[136:139], v[20:23]
 v_mul_f32 v5, v5, v137
 v_cvt_pk_bf16_f32 v8, v6, v5
 v_mfma_f32_16x16x32_bf16 v[24:27], a[192:195], a[144:147], v[24:27]
 v_accvgpr_read_b32 v5, a65
 v_lshlrev_b32 v6, 16, v5
 v_mfma_f32_16x16x32_bf16 v[24:27], a[196:199], a[148:151], v[24:27]
 v_and_b32 v5, s26, v5
 v_mul_f32 v6, v6, v138
 v_mfma_f32_16x16x32_bf16 v[28:31], a[196:199], a[156:159], v[28:31]
 v_mul_f32 v5, v5, v139
 v_cvt_pk_bf16_f32 v9, v6, v5
 v_mfma_f32_16x16x32_bf16 v[28:31], a[192:195], a[152:155], v[28:31]
 v_accvgpr_read_b32 v5, a66
 v_lshlrev_b32 v6, 16, v5
 s_waitcnt lgkmcnt(1)
 v_mfma_f32_16x16x32_bf16 v[32:35], a[192:195], a[160:163], v[32:35]
 v_and_b32 v5, s26, v5
 v_mul_f32 v6, v6, v168
 v_mfma_f32_16x16x32_bf16 v[32:35], a[196:199], a[164:167], v[32:35]
 v_mul_f32 v5, v5, v169
 v_cvt_pk_bf16_f32 v10, v6, v5
 v_mfma_f32_16x16x32_bf16 v[36:39], a[196:199], a[172:175], v[36:39]
 v_accvgpr_read_b32 v5, a67
 v_lshlrev_b32 v6, 16, v5
 v_mfma_f32_16x16x32_bf16 v[36:39], a[192:195], a[168:171], v[36:39]
 v_and_b32 v5, s26, v5
 v_mul_f32 v6, v6, v170
 v_mfma_f32_16x16x32_bf16 v[40:43], a[192:195], a[176:179], v[40:43]
 v_mul_f32 v5, v5, v171
 v_cvt_pk_bf16_f32 v11, v6, v5
 v_mfma_f32_16x16x32_bf16 v[40:43], a[196:199], a[180:183], v[40:43]
 ds_write_b128 v3, v[8:11] offset:2048
 v_mfma_f32_16x16x32_bf16 v[44:47], a[196:199], a[188:191], v[44:47]
 s_add_u32 s68, s29, 16384
 buffer_store_dwordx4 v[8:11], v3, s[32:35], s68 offen sc1
 v_mfma_f32_16x16x32_bf16 v[44:47], a[192:195], a[184:187], v[44:47]
 s_waitcnt vmcnt(9)
 v_mfma_f32_16x16x32_bf16 v[76:79], a[200:203], a[184:187], v[76:79]
 v_accvgpr_read_b32 v5, a96
 v_lshlrev_b32 v6, 16, v5
 v_mfma_f32_16x16x32_bf16 v[76:79], a[204:207], a[188:191], v[76:79]
 global_load_dwordx4 a[196:199], v0, s[70:71] offset:1024 sc1
 v_and_b32 v5, s26, v5
 v_mfma_f32_16x16x32_bf16 v[72:75], a[204:207], a[180:183], v[72:75]
 v_mul_f32 v6, v6, v200
 v_mul_f32 v5, v5, v201
 v_mfma_f32_16x16x32_bf16 v[72:75], a[200:203], a[176:179], v[72:75]
 global_load_dwordx4 a[192:195], v0, s[70:71] offset:0 sc1
 v_cvt_pk_bf16_f32 v8, v6, v5
 v_mfma_f32_16x16x32_bf16 v[68:71], a[200:203], a[168:171], v[68:71]
 v_accvgpr_read_b32 v5, a97
 v_lshlrev_b32 v6, 16, v5
 v_mfma_f32_16x16x32_bf16 v[68:71], a[204:207], a[172:175], v[68:71]
 v_and_b32 v5, s26, v5
 v_mul_f32 v6, v6, v202
 v_mfma_f32_16x16x32_bf16 v[64:67], a[204:207], a[164:167], v[64:67]
 v_mul_f32 v5, v5, v203
 v_cvt_pk_bf16_f32 v9, v6, v5
 v_mfma_f32_16x16x32_bf16 v[64:67], a[200:203], a[160:163], v[64:67]
 v_accvgpr_read_b32 v5, a98
 v_lshlrev_b32 v6, 16, v5
 v_mfma_f32_16x16x32_bf16 v[60:63], a[200:203], a[152:155], v[60:63]
 v_and_b32 v5, s26, v5
 v_mul_f32 v6, v6, v232
 v_mfma_f32_16x16x32_bf16 v[60:63], a[204:207], a[156:159], v[60:63]
 v_mul_f32 v5, v5, v233
 v_cvt_pk_bf16_f32 v10, v6, v5
 v_mfma_f32_16x16x32_bf16 v[56:59], a[204:207], a[148:151], v[56:59]
 v_accvgpr_read_b32 v5, a99
 v_lshlrev_b32 v6, 16, v5
 v_mfma_f32_16x16x32_bf16 v[56:59], a[200:203], a[144:147], v[56:59]
 v_and_b32 v5, s26, v5
 v_mul_f32 v6, v6, v234
 s_waitcnt lgkmcnt(1)
 v_mfma_f32_16x16x32_bf16 v[52:55], a[200:203], a[136:139], v[52:55]
 v_mul_f32 v5, v5, v235
 v_cvt_pk_bf16_f32 v11, v6, v5
 v_mfma_f32_16x16x32_bf16 v[52:55], a[204:207], a[140:143], v[52:55]
 ds_write_b128 v3, v[8:11] offset:3072
 v_mfma_f32_16x16x32_bf16 v[48:51], a[204:207], a[132:135], v[48:51]
 buffer_store_dwordx4 v[8:11], v3, s[32:35], s68 offen offset:1024 sc1
 v_accvgpr_read_b32 v5, a68
 v_mfma_f32_16x16x32_bf16 v[48:51], a[200:203], a[128:131], v[48:51]
 v_lshlrev_b32 v6, 16, v5
 v_and_b32 v5, s26, v5
 s_add_u32 s69, s29, 12288
 s_waitcnt vmcnt(10)
 v_mfma_f32_16x16x32_bf16 v[80:83], a[208:211], a[128:131], v[80:83]
 v_mul_f32 v6, v6, v140
 v_mul_f32 v5, v5, v141
 v_mfma_f32_16x16x32_bf16 v[80:83], a[212:215], a[132:135], v[80:83]
 global_load_dwordx4 a[204:207], v0, s[70:71] offset:3072 sc1
 v_cvt_pk_bf16_f32 v8, v6, v5
 v_mfma_f32_16x16x32_bf16 v[84:87], a[212:215], a[140:143], v[84:87]
 v_accvgpr_read_b32 v5, a69
 v_lshlrev_b32 v6, 16, v5
 v_mfma_f32_16x16x32_bf16 v[84:87], a[208:211], a[136:139], v[84:87]
 global_load_dwordx4 a[200:203], v0, s[70:71] offset:2048 sc1
 v_and_b32 v5, s26, v5
 v_mfma_f32_16x16x32_bf16 v[88:91], a[208:211], a[144:147], v[88:91]
 buffer_store_dwordx4 v[12:15], v3, s[32:35], s69 offen sc1
 s_add_u32 s70, s70, 8192
 s_addc_u32 s71, s71, 0
 v_mfma_f32_16x16x32_bf16 v[88:91], a[212:215], a[148:151], v[88:91]
 v_mul_f32 v6, v6, v142
 v_mul_f32 v5, v5, v143
 v_mfma_f32_16x16x32_bf16 v[92:95], a[212:215], a[156:159], v[92:95]
 v_cvt_pk_bf16_f32 v9, v6, v5
 v_accvgpr_read_b32 v5, a70
 v_mfma_f32_16x16x32_bf16 v[92:95], a[208:211], a[152:155], v[92:95]
 v_lshlrev_b32 v6, 16, v5
 v_and_b32 v5, s26, v5
 v_mfma_f32_16x16x32_bf16 v[96:99], a[208:211], a[160:163], v[96:99]
 v_mul_f32 v6, v6, v172
 v_mul_f32 v5, v5, v173
 v_mfma_f32_16x16x32_bf16 v[96:99], a[212:215], a[164:167], v[96:99]
 v_cvt_pk_bf16_f32 v10, v6, v5
 v_accvgpr_read_b32 v5, a71
 v_mfma_f32_16x16x32_bf16 v[100:103], a[212:215], a[172:175], v[100:103]
 v_lshlrev_b32 v6, 16, v5
 v_and_b32 v5, s26, v5
 v_mfma_f32_16x16x32_bf16 v[100:103], a[208:211], a[168:171], v[100:103]
 v_mul_f32 v6, v6, v174
 v_mul_f32 v5, v5, v175
 v_cvt_pk_bf16_f32 v11, v6, v5
 v_mfma_f32_16x16x32_bf16 v[104:107], a[208:211], a[176:179], v[104:107]
 ds_read_b128 v[12:15], v3 offset:25600
 v_mfma_f32_16x16x32_bf16 v[104:107], a[212:215], a[180:183], v[104:107]
 ds_write_b128 v3, v[8:11] offset:6144
 v_mfma_f32_16x16x32_bf16 v[108:111], a[212:215], a[188:191], v[108:111]
 buffer_store_dwordx4 v[8:11], v3, s[32:35], s68 offen offset:2048 sc1
 v_accvgpr_read_b32 v5, a100
 v_lshlrev_b32 v6, 16, v5
 v_and_b32 v5, s26, v5
 v_mfma_f32_16x16x32_bf16 v[108:111], a[208:211], a[184:187], v[108:111]
 v_mul_f32 v6, v6, v204
 v_mul_f32 v5, v5, v205
 s_waitcnt vmcnt(12)
 v_mfma_f32_16x16x32_bf16 a[244:247], a[216:219], a[184:187], a[244:247]
 ds_read_b128 a[184:187], v1 offset:61440
 v_cvt_pk_bf16_f32 v8, v6, v5
 v_mfma_f32_16x16x32_bf16 a[244:247], a[220:223], a[188:191], a[244:247]
 global_load_dwordx4 a[212:215], v0, s[70:71] offset:-3072 sc1
 ds_read_b128 a[188:191], v1 offset:62464
 v_mfma_f32_16x16x32_bf16 a[240:243], a[220:223], a[180:183], a[240:243]
 ds_read_b128 a[180:183], v1 offset:58368
 v_accvgpr_read_b32 v5, a101
 v_mfma_f32_16x16x32_bf16 a[240:243], a[216:219], a[176:179], a[240:243]
 global_load_dwordx4 a[208:211], v0, s[70:71] offset:-4096 sc1
 ds_read_b128 a[176:179], v1 offset:57344
 v_mfma_f32_16x16x32_bf16 v[132:135], a[216:219], a[168:171], v[132:135]
 ds_read_b128 a[168:171], v1 offset:53248
 v_lshlrev_b32 v6, 16, v5
 v_mfma_f32_16x16x32_bf16 v[132:135], a[220:223], a[172:175], v[132:135]
 ds_read_b128 a[172:175], v1 offset:54272
 v_and_b32 v5, s26, v5
 v_mfma_f32_16x16x32_bf16 v[128:131], a[220:223], a[164:167], v[128:131]
 ds_read_b128 a[164:167], v1 offset:50176
 v_mul_f32 v6, v6, v206
 v_mfma_f32_16x16x32_bf16 v[128:131], a[216:219], a[160:163], v[128:131]
 ds_read_b128 a[160:163], v1 offset:49152
 v_mul_f32 v5, v5, v207
 v_cvt_pk_bf16_f32 v9, v6, v5
 v_mfma_f32_16x16x32_bf16 v[124:127], a[216:219], a[152:155], v[124:127]
 ds_read_b128 a[152:155], v1 offset:45056
 v_accvgpr_read_b32 v5, a102
 v_mfma_f32_16x16x32_bf16 v[124:127], a[220:223], a[156:159], v[124:127]
 ds_read_b128 a[156:159], v1 offset:46080
 v_lshlrev_b32 v6, 16, v5
 v_and_b32 v5, s26, v5
 v_mfma_f32_16x16x32_bf16 v[120:123], a[220:223], a[148:151], v[120:123]
 ds_read_b128 a[148:151], v1 offset:41984
 v_mul_f32 v6, v6, v236
 v_mfma_f32_16x16x32_bf16 v[120:123], a[216:219], a[144:147], v[120:123]
 ds_read_b128 a[144:147], v1 offset:40960
 v_mul_f32 v5, v5, v237
 v_mfma_f32_16x16x32_bf16 v[116:119], a[216:219], a[136:139], v[116:119]
 ds_read_b128 a[136:139], v1 offset:36864
 v_cvt_pk_bf16_f32 v10, v6, v5
 v_mfma_f32_16x16x32_bf16 v[116:119], a[220:223], a[140:143], v[116:119]
 ds_read_b128 a[140:143], v1 offset:37888
 v_accvgpr_read_b32 v5, a103
 v_mfma_f32_16x16x32_bf16 v[112:115], a[220:223], a[132:135], v[112:115]
 ds_read_b128 a[132:135], v1 offset:33792
 v_lshlrev_b32 v6, 16, v5
 v_mfma_f32_16x16x32_bf16 v[112:115], a[216:219], a[128:131], v[112:115]
 ds_read_b128 a[128:131], v1 offset:32768
 v_and_b32 v5, s26, v5
 s_waitcnt vmcnt(12) lgkmcnt(8)
 v_mfma_f32_16x16x32_bf16 v[44:47], a[224:227], a[184:187], v[44:47]
 v_mul_f32 v6, v6, v238
 v_mul_f32 v5, v5, v239
 v_mfma_f32_16x16x32_bf16 v[44:47], a[228:231], a[188:191], v[44:47]
 global_load_dwordx4 a[220:223], v0, s[70:71] offset:-1024 sc1
 v_cvt_pk_bf16_f32 v11, v6, v5
 v_mfma_f32_16x16x32_bf16 v[40:43], a[228:231], a[180:183], v[40:43]
 ds_write_b128 v3, v[8:11] offset:7168
 v_mfma_f32_16x16x32_bf16 v[40:43], a[224:227], a[176:179], v[40:43]
 global_load_dwordx4 a[216:219], v0, s[70:71] offset:-2048 sc1
 v_mfma_f32_16x16x32_bf16 v[36:39], a[224:227], a[168:171], v[36:39]
 buffer_store_dwordx4 v[8:11], v3, s[32:35], s68 offen offset:3072 sc1
 v_accvgpr_read_b32 v5, a72
 v_lshlrev_b32 v6, 16, v5
 v_and_b32 v5, s26, v5
 v_mul_f32 v6, v6, v144
 v_mul_f32 v5, v5, v145
 v_mfma_f32_16x16x32_bf16 v[36:39], a[228:231], a[172:175], v[36:39]
 v_cvt_pk_bf16_f32 v8, v6, v5
 v_accvgpr_read_b32 v5, a73
 v_lshlrev_b32 v6, 16, v5
 v_mfma_f32_16x16x32_bf16 v[32:35], a[228:231], a[164:167], v[32:35]
 v_and_b32 v5, s26, v5
 v_mul_f32 v6, v6, v146
 v_mfma_f32_16x16x32_bf16 v[32:35], a[224:227], a[160:163], v[32:35]
 v_mul_f32 v5, v5, v147
 v_cvt_pk_bf16_f32 v9, v6, v5
 s_waitcnt lgkmcnt(1)
 v_mfma_f32_16x16x32_bf16 v[28:31], a[224:227], a[152:155], v[28:31]
 v_accvgpr_read_b32 v5, a74
 v_lshlrev_b32 v6, 16, v5
 v_mfma_f32_16x16x32_bf16 v[28:31], a[228:231], a[156:159], v[28:31]
 buffer_store_dwordx4 v[12:15], v3, s[32:35], s69 offen offset:1024 sc1
 v_mfma_f32_16x16x32_bf16 v[24:27], a[228:231], a[148:151], v[24:27]
 v_and_b32 v5, s26, v5
 v_mul_f32 v6, v6, v176
 v_mfma_f32_16x16x32_bf16 v[24:27], a[224:227], a[144:147], v[24:27]
 v_mul_f32 v5, v5, v177
 v_cvt_pk_bf16_f32 v10, v6, v5
 v_mfma_f32_16x16x32_bf16 v[20:23], a[224:227], a[136:139], v[20:23]
 v_accvgpr_read_b32 v5, a75
 v_lshlrev_b32 v6, 16, v5
 v_mfma_f32_16x16x32_bf16 v[20:23], a[228:231], a[140:143], v[20:23]
 v_and_b32 v5, s26, v5
 v_mul_f32 v6, v6, v178
 v_mfma_f32_16x16x32_bf16 v[16:19], a[228:231], a[132:135], v[16:19]
 v_mul_f32 v5, v5, v179
 v_cvt_pk_bf16_f32 v11, v6, v5
 v_mfma_f32_16x16x32_bf16 v[16:19], a[224:227], a[128:131], v[16:19]
 ds_write_b128 v3, v[8:11] offset:10240
 s_waitcnt vmcnt(14)
 v_mfma_f32_16x16x32_bf16 v[48:51], a[232:235], a[128:131], v[48:51]
 v_accvgpr_read_b32 v5, a104
 v_lshlrev_b32 v6, 16, v5
 v_mfma_f32_16x16x32_bf16 v[48:51], a[236:239], a[132:135], v[48:51]
 global_load_dwordx4 a[228:231], v0, s[70:71] offset:1024 sc1
 v_and_b32 v5, s26, v5
 v_mfma_f32_16x16x32_bf16 v[52:55], a[236:239], a[140:143], v[52:55]
 v_mul_f32 v6, v6, v208
 v_mul_f32 v5, v5, v209
 v_mfma_f32_16x16x32_bf16 v[52:55], a[232:235], a[136:139], v[52:55]
 global_load_dwordx4 a[224:227], v0, s[70:71] offset:0 sc1
 ds_read_b128 v[12:15], v3 offset:28672
 v_mfma_f32_16x16x32_bf16 v[56:59], a[232:235], a[144:147], v[56:59]
 v_cvt_pk_bf16_f32 v8, v6, v5
 v_accvgpr_read_b32 v5, a105
 v_mfma_f32_16x16x32_bf16 v[56:59], a[236:239], a[148:151], v[56:59]
 v_lshlrev_b32 v6, 16, v5
 v_and_b32 v5, s26, v5
 v_mfma_f32_16x16x32_bf16 v[60:63], a[236:239], a[156:159], v[60:63]
 v_mul_f32 v6, v6, v210
 v_mul_f32 v5, v5, v211
 v_mfma_f32_16x16x32_bf16 v[60:63], a[232:235], a[152:155], v[60:63]
 v_cvt_pk_bf16_f32 v9, v6, v5
 v_accvgpr_read_b32 v5, a106
 v_mfma_f32_16x16x32_bf16 v[64:67], a[232:235], a[160:163], v[64:67]
 v_lshlrev_b32 v6, 16, v5
 v_mfma_f32_16x16x32_bf16 v[64:67], a[236:239], a[164:167], v[64:67]
 v_and_b32 v5, s26, v5
 v_mul_f32 v6, v6, v240
 v_mfma_f32_16x16x32_bf16 v[68:71], a[236:239], a[172:175], v[68:71]
 v_mul_f32 v5, v5, v241
 v_cvt_pk_bf16_f32 v10, v6, v5
 v_mfma_f32_16x16x32_bf16 v[68:71], a[232:235], a[168:171], v[68:71]
 v_accvgpr_read_b32 v5, a107
 v_lshlrev_b32 v6, 16, v5
 v_mfma_f32_16x16x32_bf16 v[72:75], a[232:235], a[176:179], v[72:75]
 v_and_b32 v5, s26, v5
 v_mul_f32 v6, v6, v242
 v_mfma_f32_16x16x32_bf16 v[72:75], a[236:239], a[180:183], v[72:75]
 v_mul_f32 v5, v5, v243
 v_cvt_pk_bf16_f32 v11, v6, v5
 v_mfma_f32_16x16x32_bf16 v[76:79], a[236:239], a[188:191], v[76:79]
 ds_write_b128 v3, v[8:11] offset:11264
 v_mfma_f32_16x16x32_bf16 v[76:79], a[232:235], a[184:187], v[76:79]
 v_accvgpr_read_b32 v5, a76
 v_lshlrev_b32 v6, 16, v5
 s_waitcnt vmcnt(13)
 v_mfma_f32_16x16x32_bf16 v[108:111], a[192:195], a[184:187], v[108:111]
 v_and_b32 v5, s26, v5
 v_mul_f32 v6, v6, v148
 v_mfma_f32_16x16x32_bf16 v[108:111], a[196:199], a[188:191], v[108:111]
 global_load_dwordx4 a[236:239], v0, s[70:71] offset:3072 sc1
 v_mul_f32 v5, v5, v149
 v_mfma_f32_16x16x32_bf16 v[104:107], a[196:199], a[180:183], v[104:107]
 v_cvt_pk_bf16_f32 v8, v6, v5
 v_accvgpr_read_b32 v5, a77
 v_mfma_f32_16x16x32_bf16 v[104:107], a[192:195], a[176:179], v[104:107]
 global_load_dwordx4 a[232:235], v0, s[70:71] offset:2048 sc1
 v_lshlrev_b32 v6, 16, v5
 v_mfma_f32_16x16x32_bf16 v[100:103], a[192:195], a[168:171], v[100:103]
 v_and_b32 v5, s26, v5
 v_mul_f32 v6, v6, v150
 s_add_u32 s70, s70, 8192
 s_addc_u32 s71, s71, 0
 v_mfma_f32_16x16x32_bf16 v[100:103], a[196:199], a[172:175], v[100:103]
 v_mul_f32 v5, v5, v151
 v_cvt_pk_bf16_f32 v9, v6, v5
 v_mfma_f32_16x16x32_bf16 v[96:99], a[196:199], a[164:167], v[96:99]
 v_accvgpr_read_b32 v5, a78
 v_lshlrev_b32 v6, 16, v5
 v_mfma_f32_16x16x32_bf16 v[96:99], a[192:195], a[160:163], v[96:99]
 v_and_b32 v5, s26, v5
 v_mul_f32 v6, v6, v180
 v_mfma_f32_16x16x32_bf16 v[92:95], a[192:195], a[152:155], v[92:95]
 v_mul_f32 v5, v5, v181
 v_cvt_pk_bf16_f32 v10, v6, v5
 v_mfma_f32_16x16x32_bf16 v[92:95], a[196:199], a[156:159], v[92:95]
 v_accvgpr_read_b32 v5, a79
 v_lshlrev_b32 v6, 16, v5
 v_mfma_f32_16x16x32_bf16 v[88:91], a[196:199], a[148:151], v[88:91]
 v_and_b32 v5, s26, v5
 v_mul_f32 v6, v6, v182
 v_mfma_f32_16x16x32_bf16 v[88:91], a[192:195], a[144:147], v[88:91]
 v_mul_f32 v5, v5, v183
 v_cvt_pk_bf16_f32 v11, v6, v5
 v_mfma_f32_16x16x32_bf16 v[84:87], a[192:195], a[136:139], v[84:87]
 ds_write_b128 v3, v[8:11] offset:14336
 v_mfma_f32_16x16x32_bf16 v[84:87], a[196:199], a[140:143], v[84:87]
 v_accvgpr_read_b32 v5, a108
 v_lshlrev_b32 v6, 16, v5
 s_waitcnt lgkmcnt(2)
 v_mfma_f32_16x16x32_bf16 v[80:83], a[196:199], a[132:135], v[80:83]
 buffer_store_dwordx4 v[12:15], v3, s[32:35], s69 offen offset:2048 sc1
 v_mfma_f32_16x16x32_bf16 v[80:83], a[192:195], a[128:131], v[80:83]
 v_and_b32 v5, s26, v5
 v_mul_f32 v6, v6, v212
 s_waitcnt vmcnt(13)
 v_mfma_f32_16x16x32_bf16 v[112:115], a[200:203], a[128:131], v[112:115]
 ds_read_b128 a[128:131], v2
 v_mul_f32 v5, v5, v213
 v_mfma_f32_16x16x32_bf16 v[112:115], a[204:207], a[132:135], v[112:115]
 global_load_dwordx4 a[196:199], v0, s[70:71] offset:-3072 sc1
 ds_read_b128 a[132:135], v2 offset:1024
 v_mfma_f32_16x16x32_bf16 v[116:119], a[204:207], a[140:143], v[116:119]
 ds_read_b128 a[140:143], v2 offset:5120
 v_cvt_pk_bf16_f32 v8, v6, v5
 v_mfma_f32_16x16x32_bf16 v[116:119], a[200:203], a[136:139], v[116:119]
 global_load_dwordx4 a[192:195], v0, s[70:71] offset:-4096 sc1
 ds_read_b128 a[136:139], v2 offset:4096
 v_accvgpr_read_b32 v5, a109
 v_lshlrev_b32 v6, 16, v5
 v_mfma_f32_16x16x32_bf16 v[120:123], a[200:203], a[144:147], v[120:123]
 ds_read_b128 a[144:147], v2 offset:8192
 v_and_b32 v5, s26, v5
 v_mfma_f32_16x16x32_bf16 v[120:123], a[204:207], a[148:151], v[120:123]
 ds_read_b128 a[148:151], v2 offset:9216
 v_mul_f32 v6, v6, v214
 v_mul_f32 v5, v5, v215
 v_mfma_f32_16x16x32_bf16 v[124:127], a[204:207], a[156:159], v[124:127]
 ds_read_b128 a[156:159], v2 offset:13312
 v_cvt_pk_bf16_f32 v9, v6, v5
 v_accvgpr_read_b32 v5, a110
 v_mfma_f32_16x16x32_bf16 v[124:127], a[200:203], a[152:155], v[124:127]
 ds_read_b128 a[152:155], v2 offset:12288
 v_lshlrev_b32 v6, 16, v5
 v_mfma_f32_16x16x32_bf16 v[128:131], a[200:203], a[160:163], v[128:131]
 ds_read_b128 a[160:163], v2 offset:16384
 v_and_b32 v5, s26, v5
 v_mul_f32 v6, v6, v244
 v_mfma_f32_16x16x32_bf16 v[128:131], a[204:207], a[164:167], v[128:131]
 ds_read_b128 a[164:167], v2 offset:17408
 v_mul_f32 v5, v5, v245
 v_cvt_pk_bf16_f32 v10, v6, v5
 v_mfma_f32_16x16x32_bf16 v[132:135], a[204:207], a[172:175], v[132:135]
 ds_read_b128 a[172:175], v2 offset:21504
 ds_read_b128 v[12:15], v3 offset:29696
 v_mfma_f32_16x16x32_bf16 v[132:135], a[200:203], a[168:171], v[132:135]
 ds_read_b128 a[168:171], v2 offset:20480
 v_accvgpr_read_b32 v5, a111
 v_lshlrev_b32 v6, 16, v5
 v_mfma_f32_16x16x32_bf16 a[240:243], a[200:203], a[176:179], a[240:243]
 ds_read_b128 a[176:179], v2 offset:24576
 v_and_b32 v5, s26, v5
 v_mfma_f32_16x16x32_bf16 a[240:243], a[204:207], a[180:183], a[240:243]
 ds_read_b128 a[180:183], v2 offset:25600
 v_mul_f32 v6, v6, v246
 v_mfma_f32_16x16x32_bf16 a[244:247], a[204:207], a[188:191], a[244:247]
 ds_read_b128 a[188:191], v2 offset:29696
 v_mul_f32 v5, v5, v247
 v_mfma_f32_16x16x32_bf16 a[244:247], a[200:203], a[184:187], a[244:247]
 ds_read_b128 a[184:187], v2 offset:28672
 v_cvt_pk_bf16_f32 v11, v6, v5
 s_waitcnt vmcnt(11) lgkmcnt(9)
 v_mfma_f32_16x16x32_bf16 v[16:19], a[208:211], a[128:131], v[16:19]
 ds_write_b128 v3, v[8:11] offset:15360
 v_mfma_f32_16x16x32_bf16 v[16:19], a[212:215], a[132:135], v[16:19]
 global_load_dwordx4 a[204:207], v0, s[70:71] offset:-1024 sc1
 v_accvgpr_read_b32 v5, a80
 v_mfma_f32_16x16x32_bf16 v[20:23], a[212:215], a[140:143], v[20:23]
 v_lshlrev_b32 v6, 16, v5
 v_and_b32 v5, s26, v5
 v_mfma_f32_16x16x32_bf16 v[20:23], a[208:211], a[136:139], v[20:23]
 global_load_dwordx4 a[200:203], v0, s[70:71] offset:-2048 sc1
 v_mul_f32 v6, v6, v152
 v_mfma_f32_16x16x32_bf16 v[24:27], a[208:211], a[144:147], v[24:27]
 v_mul_f32 v5, v5, v153
 v_cvt_pk_bf16_f32 v8, v6, v5
 v_mfma_f32_16x16x32_bf16 v[24:27], a[212:215], a[148:151], v[24:27]
 v_accvgpr_read_b32 v5, a81
 v_lshlrev_b32 v6, 16, v5
 v_mfma_f32_16x16x32_bf16 v[28:31], a[212:215], a[156:159], v[28:31]
 v_and_b32 v5, s26, v5
 v_mul_f32 v6, v6, v154
 v_mfma_f32_16x16x32_bf16 v[28:31], a[208:211], a[152:155], v[28:31]
 v_mul_f32 v5, v5, v155
 v_cvt_pk_bf16_f32 v9, v6, v5
 s_waitcnt lgkmcnt(1)
 v_mfma_f32_16x16x32_bf16 v[32:35], a[208:211], a[160:163], v[32:35]
 v_accvgpr_read_b32 v5, a82
 v_lshlrev_b32 v6, 16, v5
 v_mfma_f32_16x16x32_bf16 v[32:35], a[212:215], a[164:167], v[32:35]
 v_and_b32 v5, s26, v5
 v_mul_f32 v6, v6, v184
 v_mfma_f32_16x16x32_bf16 v[36:39], a[212:215], a[172:175], v[36:39]
 v_mul_f32 v5, v5, v185
 v_cvt_pk_bf16_f32 v10, v6, v5
 v_mfma_f32_16x16x32_bf16 v[36:39], a[208:211], a[168:171], v[36:39]
 v_accvgpr_read_b32 v5, a83
 v_lshlrev_b32 v6, 16, v5
 v_mfma_f32_16x16x32_bf16 v[40:43], a[208:211], a[176:179], v[40:43]
 v_and_b32 v5, s26, v5
 v_mul_f32 v6, v6, v186
 v_mfma_f32_16x16x32_bf16 v[40:43], a[212:215], a[180:183], v[40:43]
 v_mul_f32 v5, v5, v187
 v_cvt_pk_bf16_f32 v11, v6, v5
 v_mfma_f32_16x16x32_bf16 v[44:47], a[212:215], a[188:191], v[44:47]
 ds_write_b128 v3, v[8:11] offset:18432
 v_mfma_f32_16x16x32_bf16 v[44:47], a[208:211], a[184:187], v[44:47]
 v_accvgpr_read_b32 v5, a112
 v_lshlrev_b32 v6, 16, v5
 s_waitcnt vmcnt(11)
 v_mfma_f32_16x16x32_bf16 v[76:79], a[216:219], a[184:187], v[76:79]
 v_and_b32 v5, s26, v5
 v_mul_f32 v6, v6, v216
 v_mfma_f32_16x16x32_bf16 v[76:79], a[220:223], a[188:191], v[76:79]
 global_load_dwordx4 a[212:215], v0, s[70:71] offset:1024 sc1
 v_mul_f32 v5, v5, v217
 v_mfma_f32_16x16x32_bf16 v[72:75], a[220:223], a[180:183], v[72:75]
 v_cvt_pk_bf16_f32 v8, v6, v5
 v_accvgpr_read_b32 v5, a113
 v_mfma_f32_16x16x32_bf16 v[72:75], a[216:219], a[176:179], v[72:75]
 global_load_dwordx4 a[208:211], v0, s[70:71] offset:0 sc1
 v_lshlrev_b32 v6, 16, v5
 v_mfma_f32_16x16x32_bf16 v[68:71], a[216:219], a[168:171], v[68:71]
 v_and_b32 v5, s26, v5
 v_mul_f32 v6, v6, v218
 v_mfma_f32_16x16x32_bf16 v[68:71], a[220:223], a[172:175], v[68:71]
 v_mul_f32 v5, v5, v219
 v_cvt_pk_bf16_f32 v9, v6, v5
 v_mfma_f32_16x16x32_bf16 v[64:67], a[220:223], a[164:167], v[64:67]
 v_accvgpr_read_b32 v5, a114
 v_lshlrev_b32 v6, 16, v5
 v_mfma_f32_16x16x32_bf16 v[64:67], a[216:219], a[160:163], v[64:67]
 buffer_store_dwordx4 v[12:15], v3, s[32:35], s69 offen offset:3072 sc1
 v_mfma_f32_16x16x32_bf16 v[60:63], a[216:219], a[152:155], v[60:63]
 v_and_b32 v5, s26, v5
 v_mul_f32 v6, v6, v248
 v_mfma_f32_16x16x32_bf16 v[60:63], a[220:223], a[156:159], v[60:63]
 v_mul_f32 v5, v5, v249
 v_cvt_pk_bf16_f32 v10, v6, v5
 v_mfma_f32_16x16x32_bf16 v[56:59], a[220:223], a[148:151], v[56:59]
 v_accvgpr_read_b32 v5, a115
 v_lshlrev_b32 v6, 16, v5
 v_mfma_f32_16x16x32_bf16 v[56:59], a[216:219], a[144:147], v[56:59]
 v_and_b32 v5, s26, v5
 v_mul_f32 v6, v6, v250
 v_mfma_f32_16x16x32_bf16 v[52:55], a[216:219], a[136:139], v[52:55]
 v_mul_f32 v5, v5, v251
 v_cvt_pk_bf16_f32 v11, v6, v5
 v_mfma_f32_16x16x32_bf16 v[52:55], a[220:223], a[140:143], v[52:55]
 ds_write_b128 v3, v[8:11] offset:19456
 v_mfma_f32_16x16x32_bf16 v[48:51], a[220:223], a[132:135], v[48:51]
 v_accvgpr_read_b32 v5, a84
 v_lshlrev_b32 v6, 16, v5
 v_mfma_f32_16x16x32_bf16 v[48:51], a[216:219], a[128:131], v[48:51]
 v_and_b32 v5, s26, v5
 v_mul_f32 v6, v6, v156
 s_waitcnt vmcnt(10)
 v_mfma_f32_16x16x32_bf16 v[80:83], a[224:227], a[128:131], v[80:83]
 v_mul_f32 v5, v5, v157
 v_cvt_pk_bf16_f32 v8, v6, v5
 v_mfma_f32_16x16x32_bf16 v[80:83], a[228:231], a[132:135], v[80:83]
 global_load_dwordx4 a[220:223], v0, s[70:71] offset:3072 sc1
 v_accvgpr_read_b32 v5, a85
 v_mfma_f32_16x16x32_bf16 v[84:87], a[228:231], a[140:143], v[84:87]
 v_lshlrev_b32 v6, 16, v5
 v_and_b32 v5, s26, v5
 v_mfma_f32_16x16x32_bf16 v[84:87], a[224:227], a[136:139], v[84:87]
 global_load_dwordx4 a[216:219], v0, s[70:71] offset:2048 sc1
 v_mul_f32 v6, v6, v158
 v_mfma_f32_16x16x32_bf16 v[88:91], a[224:227], a[144:147], v[88:91]
 v_mul_f32 v5, v5, v159
 v_cvt_pk_bf16_f32 v9, v6, v5
 s_add_u32 s70, s70, 8192
 s_addc_u32 s71, s71, 0
 v_mfma_f32_16x16x32_bf16 v[88:91], a[228:231], a[148:151], v[88:91]
 v_accvgpr_read_b32 v5, a86
 v_lshlrev_b32 v6, 16, v5
 v_mfma_f32_16x16x32_bf16 v[92:95], a[228:231], a[156:159], v[92:95]
 v_and_b32 v5, s26, v5
 v_mul_f32 v6, v6, v188
 v_mfma_f32_16x16x32_bf16 v[92:95], a[224:227], a[152:155], v[92:95]
 v_mul_f32 v5, v5, v189
 v_cvt_pk_bf16_f32 v10, v6, v5
 v_mfma_f32_16x16x32_bf16 v[96:99], a[224:227], a[160:163], v[96:99]
 v_accvgpr_read_b32 v5, a87
 v_lshlrev_b32 v6, 16, v5
 v_mfma_f32_16x16x32_bf16 v[96:99], a[228:231], a[164:167], v[96:99]
 v_and_b32 v5, s26, v5
 v_mul_f32 v6, v6, v190
 v_mfma_f32_16x16x32_bf16 v[100:103], a[228:231], a[172:175], v[100:103]
 v_mul_f32 v5, v5, v191
 v_cvt_pk_bf16_f32 v11, v6, v5
 v_mfma_f32_16x16x32_bf16 v[100:103], a[224:227], a[168:171], v[100:103]
 ds_write_b128 v3, v[8:11] offset:22528
 v_mfma_f32_16x16x32_bf16 v[104:107], a[224:227], a[176:179], v[104:107]
 v_accvgpr_read_b32 v5, a116
 v_lshlrev_b32 v6, 16, v5
 v_mfma_f32_16x16x32_bf16 v[104:107], a[228:231], a[180:183], v[104:107]
 v_and_b32 v5, s26, v5
 v_mul_f32 v6, v6, v220
 v_mfma_f32_16x16x32_bf16 v[108:111], a[228:231], a[188:191], v[108:111]
 v_mul_f32 v5, v5, v221
 v_cvt_pk_bf16_f32 v8, v6, v5
 v_mfma_f32_16x16x32_bf16 v[108:111], a[224:227], a[184:187], v[108:111]
 v_accvgpr_read_b32 v5, a117
 v_lshlrev_b32 v6, 16, v5
 s_waitcnt vmcnt(10)
 v_mfma_f32_16x16x32_bf16 a[244:247], a[232:235], a[184:187], a[244:247]
 ds_read_b128 a[184:187], v2 offset:61440
 v_and_b32 v5, s26, v5
 v_mfma_f32_16x16x32_bf16 a[244:247], a[236:239], a[188:191], a[244:247]
 global_load_dwordx4 a[228:231], v0, s[70:71] offset:-3072 sc1
 ds_read_b128 a[188:191], v2 offset:62464
 v_mfma_f32_16x16x32_bf16 a[240:243], a[236:239], a[180:183], a[240:243]
 ds_read_b128 a[180:183], v2 offset:58368
 v_mul_f32 v6, v6, v222
 v_mfma_f32_16x16x32_bf16 a[240:243], a[232:235], a[176:179], a[240:243]
 global_load_dwordx4 a[224:227], v0, s[70:71] offset:-4096 sc1
 ds_read_b128 a[176:179], v2 offset:57344
 v_mul_f32 v5, v5, v223
 v_cvt_pk_bf16_f32 v9, v6, v5
 v_mfma_f32_16x16x32_bf16 v[132:135], a[232:235], a[168:171], v[132:135]
 ds_read_b128 a[168:171], v2 offset:53248
 v_accvgpr_read_b32 v5, a118
 v_mfma_f32_16x16x32_bf16 v[132:135], a[236:239], a[172:175], v[132:135]
 ds_read_b128 a[172:175], v2 offset:54272
 v_lshlrev_b32 v6, 16, v5
 v_mfma_f32_16x16x32_bf16 v[128:131], a[236:239], a[164:167], v[128:131]
 ds_read_b128 a[164:167], v2 offset:50176
 v_and_b32 v5, s26, v5
 v_mfma_f32_16x16x32_bf16 v[128:131], a[232:235], a[160:163], v[128:131]
 ds_read_b128 a[160:163], v2 offset:49152
 v_mul_f32 v6, v6, v252
 v_mfma_f32_16x16x32_bf16 v[124:127], a[232:235], a[152:155], v[124:127]
 ds_read_b128 a[152:155], v2 offset:45056
 v_mul_f32 v5, v5, v253
 v_mfma_f32_16x16x32_bf16 v[124:127], a[236:239], a[156:159], v[124:127]
 ds_read_b128 a[156:159], v2 offset:46080
 v_cvt_pk_bf16_f32 v10, v6, v5
 v_mfma_f32_16x16x32_bf16 v[120:123], a[236:239], a[148:151], v[120:123]
 ds_read_b128 a[148:151], v2 offset:41984
 v_accvgpr_read_b32 v5, a119
 v_mfma_f32_16x16x32_bf16 v[120:123], a[232:235], a[144:147], v[120:123]
 ds_read_b128 a[144:147], v2 offset:40960
 v_lshlrev_b32 v6, 16, v5
 v_mfma_f32_16x16x32_bf16 v[116:119], a[232:235], a[136:139], v[116:119]
 ds_read_b128 a[136:139], v2 offset:36864
 v_and_b32 v5, s26, v5
 v_mfma_f32_16x16x32_bf16 v[116:119], a[236:239], a[140:143], v[116:119]
 ds_read_b128 a[140:143], v2 offset:37888
 v_mul_f32 v6, v6, v254
 v_mfma_f32_16x16x32_bf16 v[112:115], a[236:239], a[132:135], v[112:115]
 ds_read_b128 a[132:135], v2 offset:33792
 v_mul_f32 v5, v5, v255
 v_mfma_f32_16x16x32_bf16 v[112:115], a[232:235], a[128:131], v[112:115]
 ds_read_b128 a[128:131], v2 offset:32768
 v_cvt_pk_bf16_f32 v11, v6, v5
 s_waitcnt vmcnt(9) lgkmcnt(8)
 v_mfma_f32_16x16x32_bf16 v[44:47], a[192:195], a[184:187], v[44:47]
 ds_write_b128 v3, v[8:11] offset:23552
 v_accvgpr_read_b32 v5, a88
 v_lshlrev_b32 v6, 16, v5
 v_and_b32 v5, s26, v5
 v_mul_f32 v6, v6, v160
 v_mfma_f32_16x16x32_bf16 v[44:47], a[196:199], a[188:191], v[44:47]
 global_load_dwordx4 a[236:239], v0, s[70:71] offset:-1024 sc1
 v_mul_f32 v5, v5, v161
 v_mfma_f32_16x16x32_bf16 v[40:43], a[196:199], a[180:183], v[40:43]
 v_cvt_pk_bf16_f32 v8, v6, v5
 v_accvgpr_read_b32 v5, a89
 v_mfma_f32_16x16x32_bf16 v[40:43], a[192:195], a[176:179], v[40:43]
 global_load_dwordx4 a[232:235], v0, s[70:71] offset:-2048 sc1
 v_lshlrev_b32 v6, 16, v5
 v_mfma_f32_16x16x32_bf16 v[36:39], a[192:195], a[168:171], v[36:39]
 v_and_b32 v5, s26, v5
 v_mul_f32 v6, v6, v162
 v_mfma_f32_16x16x32_bf16 v[36:39], a[196:199], a[172:175], v[36:39]
 v_mul_f32 v5, v5, v163
 v_cvt_pk_bf16_f32 v9, v6, v5
 v_mfma_f32_16x16x32_bf16 v[32:35], a[196:199], a[164:167], v[32:35]
 v_accvgpr_read_b32 v5, a90
 v_lshlrev_b32 v6, 16, v5
 v_mfma_f32_16x16x32_bf16 v[32:35], a[192:195], a[160:163], v[32:35]
 v_and_b32 v5, s26, v5
 v_mul_f32 v6, v6, v192
 s_waitcnt lgkmcnt(1)
 v_mfma_f32_16x16x32_bf16 v[28:31], a[192:195], a[152:155], v[28:31]
 v_mul_f32 v5, v5, v193
 v_cvt_pk_bf16_f32 v10, v6, v5
 v_mfma_f32_16x16x32_bf16 v[28:31], a[196:199], a[156:159], v[28:31]
 v_accvgpr_read_b32 v5, a91
 v_lshlrev_b32 v6, 16, v5
 v_mfma_f32_16x16x32_bf16 v[24:27], a[196:199], a[148:151], v[24:27]
 v_and_b32 v5, s26, v5
 v_mul_f32 v6, v6, v194
 v_mfma_f32_16x16x32_bf16 v[24:27], a[192:195], a[144:147], v[24:27]
 v_mul_f32 v5, v5, v195
 v_cvt_pk_bf16_f32 v11, v6, v5
 v_mfma_f32_16x16x32_bf16 v[20:23], a[192:195], a[136:139], v[20:23]
 ds_write_b128 v3, v[8:11] offset:26624
 v_mfma_f32_16x16x32_bf16 v[20:23], a[196:199], a[140:143], v[20:23]
 v_accvgpr_read_b32 v5, a120
 v_lshlrev_b32 v6, 16, v5
 v_mfma_f32_16x16x32_bf16 v[16:19], a[196:199], a[132:135], v[16:19]
 v_and_b32 v5, s26, v5
 v_mul_f32 v6, v6, v224
 v_mfma_f32_16x16x32_bf16 v[16:19], a[192:195], a[128:131], v[16:19]
 v_mul_f32 v5, v5, v225
 v_cvt_pk_bf16_f32 v8, v6, v5
 s_waitcnt vmcnt(9)
 v_mfma_f32_16x16x32_bf16 v[48:51], a[200:203], a[128:131], v[48:51]
 v_accvgpr_read_b32 v5, a121
 v_lshlrev_b32 v6, 16, v5
 v_mfma_f32_16x16x32_bf16 v[48:51], a[204:207], a[132:135], v[48:51]
 global_load_dwordx4 a[196:199], v0, s[70:71] offset:1024 sc1
 v_and_b32 v5, s26, v5
 v_mfma_f32_16x16x32_bf16 v[52:55], a[204:207], a[140:143], v[52:55]
 v_mul_f32 v6, v6, v226
 v_mul_f32 v5, v5, v227
 v_mfma_f32_16x16x32_bf16 v[52:55], a[200:203], a[136:139], v[52:55]
 global_load_dwordx4 a[192:195], v0, s[70:71] offset:0 sc1
 v_cvt_pk_bf16_f32 v9, v6, v5
 v_mfma_f32_16x16x32_bf16 v[56:59], a[200:203], a[144:147], v[56:59]
 v_accvgpr_read_b32 v5, a122
 v_accvgpr_read_b32 v7, a248
 v_mfma_f32_16x16x32_bf16 v[56:59], a[204:207], a[148:151], v[56:59]
 v_lshlrev_b32 v6, 16, v5
 v_and_b32 v5, s26, v5
 v_mfma_f32_16x16x32_bf16 v[60:63], a[204:207], a[156:159], v[60:63]
 v_mul_f32 v6, v6, v7
 v_accvgpr_read_b32 v7, a249
 v_mfma_f32_16x16x32_bf16 v[60:63], a[200:203], a[152:155], v[60:63]
 v_mul_f32 v5, v5, v7
 v_cvt_pk_bf16_f32 v10, v6, v5
 v_mfma_f32_16x16x32_bf16 v[64:67], a[200:203], a[160:163], v[64:67]
 v_accvgpr_read_b32 v5, a123
 v_mfma_f32_16x16x32_bf16 v[64:67], a[204:207], a[164:167], v[64:67]
 v_accvgpr_read_b32 v7, a250
 v_lshlrev_b32 v6, 16, v5
 v_mfma_f32_16x16x32_bf16 v[68:71], a[204:207], a[172:175], v[68:71]
 v_and_b32 v5, s26, v5
 v_mul_f32 v6, v6, v7
 v_mfma_f32_16x16x32_bf16 v[68:71], a[200:203], a[168:171], v[68:71]
 v_accvgpr_read_b32 v7, a251
 v_mfma_f32_16x16x32_bf16 v[72:75], a[200:203], a[176:179], v[72:75]
 v_mul_f32 v5, v5, v7
 v_cvt_pk_bf16_f32 v11, v6, v5
 v_mfma_f32_16x16x32_bf16 v[72:75], a[204:207], a[180:183], v[72:75]
 ds_write_b128 v3, v[8:11] offset:27648
 v_mfma_f32_16x16x32_bf16 v[76:79], a[204:207], a[188:191], v[76:79]
 v_accvgpr_read_b32 v5, a92
 v_lshlrev_b32 v6, 16, v5
 v_mfma_f32_16x16x32_bf16 v[76:79], a[200:203], a[184:187], v[76:79]
 v_and_b32 v5, s26, v5
 v_mul_f32 v6, v6, v164
 s_waitcnt vmcnt(9)
 v_mfma_f32_16x16x32_bf16 v[108:111], a[208:211], a[184:187], v[108:111]
 v_mul_f32 v5, v5, v165
 v_cvt_pk_bf16_f32 v8, v6, v5
 v_mfma_f32_16x16x32_bf16 v[108:111], a[212:215], a[188:191], v[108:111]
 global_load_dwordx4 a[204:207], v0, s[70:71] offset:3072 sc1
 v_accvgpr_read_b32 v5, a93
 v_mfma_f32_16x16x32_bf16 v[104:107], a[212:215], a[180:183], v[104:107]
 v_lshlrev_b32 v6, 16, v5
 v_and_b32 v5, s26, v5
 v_mfma_f32_16x16x32_bf16 v[104:107], a[208:211], a[176:179], v[104:107]
 global_load_dwordx4 a[200:203], v0, s[70:71] offset:2048 sc1
 v_mul_f32 v6, v6, v166
 v_mfma_f32_16x16x32_bf16 v[100:103], a[208:211], a[168:171], v[100:103]
 v_mul_f32 v5, v5, v167
 v_cvt_pk_bf16_f32 v9, v6, v5
 s_add_u32 s70, s70, 8192
 s_addc_u32 s71, s71, 0
 v_mfma_f32_16x16x32_bf16 v[100:103], a[212:215], a[172:175], v[100:103]
 v_accvgpr_read_b32 v5, a94
 v_lshlrev_b32 v6, 16, v5
 v_mfma_f32_16x16x32_bf16 v[96:99], a[212:215], a[164:167], v[96:99]
 v_and_b32 v5, s26, v5
 v_mfma_f32_16x16x32_bf16 v[96:99], a[208:211], a[160:163], v[96:99]
 v_mul_f32 v6, v6, v196
 v_mul_f32 v5, v5, v197
 v_mfma_f32_16x16x32_bf16 v[92:95], a[208:211], a[152:155], v[92:95]
 v_cvt_pk_bf16_f32 v10, v6, v5
 v_mfma_f32_16x16x32_bf16 v[92:95], a[212:215], a[156:159], v[92:95]
 v_accvgpr_read_b32 v5, a95
 v_lshlrev_b32 v6, 16, v5
 v_mfma_f32_16x16x32_bf16 v[88:91], a[212:215], a[148:151], v[88:91]
 v_and_b32 v5, s26, v5
 v_mul_f32 v6, v6, v198
 v_mfma_f32_16x16x32_bf16 v[88:91], a[208:211], a[144:147], v[88:91]
 v_mul_f32 v5, v5, v199
 v_cvt_pk_bf16_f32 v11, v6, v5
 v_mfma_f32_16x16x32_bf16 v[84:87], a[208:211], a[136:139], v[84:87]
 ds_write_b128 v3, v[8:11] offset:30720
 v_mfma_f32_16x16x32_bf16 v[84:87], a[212:215], a[140:143], v[84:87]
 v_accvgpr_read_b32 v5, a124
 v_mfma_f32_16x16x32_bf16 v[80:83], a[212:215], a[132:135], v[80:83]
 v_lshlrev_b32 v6, 16, v5
 v_and_b32 v5, s26, v5
 v_mfma_f32_16x16x32_bf16 v[80:83], a[208:211], a[128:131], v[80:83]
 v_mul_f32 v6, v6, v228
 v_mul_f32 v5, v5, v229
 s_waitcnt vmcnt(8)
 v_mfma_f32_16x16x32_bf16 v[112:115], a[216:219], a[128:131], v[112:115]
 v_cvt_pk_bf16_f32 v8, v6, v5
 v_accvgpr_read_b32 v5, a125
 v_mfma_f32_16x16x32_bf16 v[112:115], a[220:223], a[132:135], v[112:115]
 global_load_dwordx4 a[212:215], v0, s[70:71] offset:-3072 sc1
 v_lshlrev_b32 v6, 16, v5
 v_mfma_f32_16x16x32_bf16 v[116:119], a[220:223], a[140:143], v[116:119]
 v_and_b32 v5, s26, v5
 v_mul_f32 v6, v6, v230
 v_mfma_f32_16x16x32_bf16 v[116:119], a[216:219], a[136:139], v[116:119]
 global_load_dwordx4 a[208:211], v0, s[70:71] offset:-4096 sc1
 v_mul_f32 v5, v5, v231
 v_mfma_f32_16x16x32_bf16 v[120:123], a[216:219], a[144:147], v[120:123]
 v_cvt_pk_bf16_f32 v9, v6, v5
 v_accvgpr_read_b32 v5, a126
 v_mfma_f32_16x16x32_bf16 v[120:123], a[220:223], a[148:151], v[120:123]
 v_accvgpr_read_b32 v7, a252
 v_mfma_f32_16x16x32_bf16 v[124:127], a[220:223], a[156:159], v[124:127]
 v_lshlrev_b32 v6, 16, v5
 v_and_b32 v5, s26, v5
 v_mfma_f32_16x16x32_bf16 v[124:127], a[216:219], a[152:155], v[124:127]
 v_mul_f32 v6, v6, v7
 v_accvgpr_read_b32 v7, a253
 v_mfma_f32_16x16x32_bf16 v[128:131], a[216:219], a[160:163], v[128:131]
 v_mul_f32 v5, v5, v7
 v_cvt_pk_bf16_f32 v10, v6, v5
 v_mfma_f32_16x16x32_bf16 v[128:131], a[220:223], a[164:167], v[128:131]
 v_accvgpr_read_b32 v5, a127
 v_accvgpr_read_b32 v7, a254
 v_mfma_f32_16x16x32_bf16 v[132:135], a[220:223], a[172:175], v[132:135]
 v_lshlrev_b32 v6, 16, v5
 v_and_b32 v5, s26, v5
 v_mfma_f32_16x16x32_bf16 v[132:135], a[216:219], a[168:171], v[132:135]
 v_mul_f32 v6, v6, v7
 v_accvgpr_read_b32 v7, a255
 v_mfma_f32_16x16x32_bf16 a[240:243], a[216:219], a[176:179], a[240:243]
 v_mul_f32 v5, v5, v7
 v_cvt_pk_bf16_f32 v11, v6, v5
 v_mfma_f32_16x16x32_bf16 a[240:243], a[220:223], a[180:183], a[240:243]
 ds_write_b128 v3, v[8:11] offset:31744
 v_mfma_f32_16x16x32_bf16 a[244:247], a[220:223], a[188:191], a[244:247]
 global_load_dwordx4 a[220:223], v0, s[70:71] offset:-1024 sc1
 v_mfma_f32_16x16x32_bf16 a[244:247], a[216:219], a[184:187], a[244:247]
 global_load_dwordx4 a[216:219], v0, s[70:71] offset:-2048 sc1
 s_waitcnt vmcnt(10)
Ls1b:
 v_mfma_f32_16x16x32_bf16 v[164:167], a[224:227], a[184:187], v[164:167]
 v_bfe_u32 v4, v3, 8, 2
 v_mfma_f32_16x16x32_bf16 v[164:167], a[228:231], a[188:191], v[164:167]
 ds_read_b128 v[12:15], v3 offset:10240
 v_mfma_f32_16x16x32_bf16 v[160:163], a[228:231], a[180:183], v[160:163]
 v_lshl_add_u32 v4, v4, 5, s51
 v_mfma_f32_16x16x32_bf16 v[160:163], a[224:227], a[176:179], v[160:163]
 ds_read_b128 v[8:11], v4
 v_mfma_f32_16x16x32_bf16 v[156:159], a[224:227], a[168:171], v[156:159]
 v_mfma_f32_16x16x32_bf16 v[156:159], a[228:231], a[172:175], v[156:159]
 v_mfma_f32_16x16x32_bf16 v[152:155], a[228:231], a[164:167], v[152:155]
 v_mfma_f32_16x16x32_bf16 v[152:155], a[224:227], a[160:163], v[152:155]
 v_mfma_f32_16x16x32_bf16 v[148:151], a[224:227], a[152:155], v[148:151]
 v_mfma_f32_16x16x32_bf16 v[148:151], a[228:231], a[156:159], v[148:151]
 v_mfma_f32_16x16x32_bf16 v[144:147], a[228:231], a[148:151], v[144:147]
 v_mfma_f32_16x16x32_bf16 v[144:147], a[224:227], a[144:147], v[144:147]
 v_mfma_f32_16x16x32_bf16 v[140:143], a[224:227], a[136:139], v[140:143]
 v_mfma_f32_16x16x32_bf16 v[140:143], a[228:231], a[140:143], v[140:143]
 s_waitcnt lgkmcnt(0)
 v_mfma_f32_16x16x32_bf16 v[136:139], a[228:231], a[132:135], v[136:139]
 v_add_f32 v16, v16, v8
 v_mfma_f32_16x16x32_bf16 v[136:139], a[224:227], a[128:131], v[136:139]
 v_add_f32 v17, v17, v9
 s_waitcnt vmcnt(8)
 v_mfma_f32_16x16x32_bf16 v[168:171], a[232:235], a[128:131], v[168:171]
 v_add_f32 v18, v18, v10
 v_mfma_f32_16x16x32_bf16 v[168:171], a[236:239], a[132:135], v[168:171]
 global_load_dwordx4 a[228:231], v0, s[70:71] offset:1024 sc1
 v_mfma_f32_16x16x32_bf16 v[172:175], a[236:239], a[140:143], v[172:175]
 s_add_u32 s31, s31, 1
 v_mfma_f32_16x16x32_bf16 v[172:175], a[232:235], a[136:139], v[172:175]
 global_load_dwordx4 a[224:227], v0, s[70:71] offset:0 sc1
 v_mfma_f32_16x16x32_bf16 v[176:179], a[232:235], a[144:147], v[176:179]
 v_mov_b32 v7, s31
 v_mfma_f32_16x16x32_bf16 v[176:179], a[236:239], a[148:151], v[176:179]
 buffer_store_dword v7, v1, s[60:63], 0 offen sc1
 v_mfma_f32_16x16x32_bf16 v[180:183], a[236:239], a[156:159], v[180:183]
 v_add_f32 v19, v19, v11
 s_add_u32 s69, s29, 20480
 v_mfma_f32_16x16x32_bf16 v[180:183], a[232:235], a[152:155], v[180:183]
 v_add_f32 v20, v20, v8
 v_mfma_f32_16x16x32_bf16 v[184:187], a[232:235], a[160:163], v[184:187]
 buffer_store_dwordx4 v[12:15], v3, s[32:35], s69 offen sc1
 v_mfma_f32_16x16x32_bf16 v[184:187], a[236:239], a[164:167], v[184:187]
 v_add_f32 v21, v21, v9
 v_mfma_f32_16x16x32_bf16 v[188:191], a[236:239], a[172:175], v[188:191]
 v_add_f32 v22, v22, v10
 v_mfma_f32_16x16x32_bf16 v[188:191], a[232:235], a[168:171], v[188:191]
 v_mfma_f32_16x16x32_bf16 v[192:195], a[232:235], a[176:179], v[192:195]
 v_add_f32 v23, v23, v11
 v_mfma_f32_16x16x32_bf16 v[192:195], a[236:239], a[180:183], v[192:195]
 v_add_f32 v24, v24, v8
 v_mfma_f32_16x16x32_bf16 v[196:199], a[236:239], a[188:191], v[196:199]
 v_add_f32 v25, v25, v9
 v_mfma_f32_16x16x32_bf16 v[196:199], a[232:235], a[184:187], v[196:199]
 ds_read_b128 v[12:15], v3 offset:11264
 s_waitcnt vmcnt(10)
 v_mfma_f32_16x16x32_bf16 v[228:231], a[192:195], a[184:187], v[228:231]
 v_add_f32 v26, v26, v10
 v_mfma_f32_16x16x32_bf16 v[228:231], a[196:199], a[188:191], v[228:231]
 global_load_dwordx4 a[236:239], v0, s[70:71] offset:3072 sc1
 v_add_f32 v27, v27, v11
 v_mfma_f32_16x16x32_bf16 v[224:227], a[196:199], a[180:183], v[224:227]
 v_add_f32 v28, v28, v8
 v_mfma_f32_16x16x32_bf16 v[224:227], a[192:195], a[176:179], v[224:227]
 global_load_dwordx4 a[232:235], v0, s[70:71] offset:2048 sc1
 v_add_f32 v29, v29, v9
 v_mfma_f32_16x16x32_bf16 v[220:223], a[192:195], a[168:171], v[220:223]
 v_add_f32 v30, v30, v10
 s_add_u32 s70, s70, 8192
 s_addc_u32 s71, s71, 0
 v_mfma_f32_16x16x32_bf16 v[220:223], a[196:199], a[172:175], v[220:223]
 v_mfma_f32_16x16x32_bf16 v[216:219], a[196:199], a[164:167], v[216:219]
 v_add_f32 v31, v31, v11
 v_mfma_f32_16x16x32_bf16 v[216:219], a[192:195], a[160:163], v[216:219]
 v_add_f32 v32, v32, v8
 v_mfma_f32_16x16x32_bf16 v[212:215], a[192:195], a[152:155], v[212:215]
 v_add_f32 v33, v33, v9
 v_mfma_f32_16x16x32_bf16 v[212:215], a[196:199], a[156:159], v[212:215]
 v_add_f32 v34, v34, v10
 v_mfma_f32_16x16x32_bf16 v[208:211], a[196:199], a[148:151], v[208:211]
 v_mfma_f32_16x16x32_bf16 v[208:211], a[192:195], a[144:147], v[208:211]
 v_add_f32 v35, v35, v11
 v_mfma_f32_16x16x32_bf16 v[204:207], a[192:195], a[136:139], v[204:207]
 v_add_f32 v36, v36, v8
 v_mfma_f32_16x16x32_bf16 v[204:207], a[196:199], a[140:143], v[204:207]
 v_add_f32 v37, v37, v9
 v_mfma_f32_16x16x32_bf16 v[200:203], a[196:199], a[132:135], v[200:203]
 v_add_f32 v38, v38, v10
 v_mfma_f32_16x16x32_bf16 v[200:203], a[192:195], a[128:131], v[200:203]
 v_add_f32 v39, v39, v11
 s_waitcnt vmcnt(10)
 v_mfma_f32_16x16x32_bf16 v[232:235], a[200:203], a[128:131], v[232:235]
 ds_read_b128 a[128:131], v2
 v_add_f32 v40, v40, v8
 v_mfma_f32_16x16x32_bf16 v[232:235], a[204:207], a[132:135], v[232:235]
 global_load_dwordx4 a[196:199], v0, s[70:71] offset:-3072 sc1
 ds_read_b128 a[132:135], v2 offset:1024
 v_mfma_f32_16x16x32_bf16 v[236:239], a[204:207], a[140:143], v[236:239]
 ds_read_b128 a[140:143], v2 offset:5120
 v_add_f32 v41, v41, v9
 s_waitcnt lgkmcnt(3)
 v_mfma_f32_16x16x32_bf16 v[236:239], a[200:203], a[136:139], v[236:239]
 global_load_dwordx4 a[192:195], v0, s[70:71] offset:-4096 sc1
 ds_read_b128 a[136:139], v2 offset:4096
 v_mfma_f32_16x16x32_bf16 v[240:243], a[200:203], a[144:147], v[240:243]
 ds_read_b128 a[144:147], v2 offset:8192
 v_add_f32 v42, v42, v10
 v_mfma_f32_16x16x32_bf16 v[240:243], a[204:207], a[148:151], v[240:243]
 buffer_store_dwordx4 v[12:15], v3, s[32:35], s69 offen offset:1024 sc1
 ds_read_b128 a[148:151], v2 offset:9216
 v_mfma_f32_16x16x32_bf16 v[244:247], a[204:207], a[156:159], v[244:247]
 ds_read_b128 a[156:159], v2 offset:13312
 v_add_f32 v43, v43, v11
 v_mfma_f32_16x16x32_bf16 v[244:247], a[200:203], a[152:155], v[244:247]
 ds_read_b128 a[152:155], v2 offset:12288
 v_add_f32 v44, v44, v8
 v_mfma_f32_16x16x32_bf16 v[248:251], a[200:203], a[160:163], v[248:251]
 ds_read_b128 a[160:163], v2 offset:16384
 v_add_f32 v45, v45, v9
 v_mfma_f32_16x16x32_bf16 v[248:251], a[204:207], a[164:167], v[248:251]
 ds_read_b128 a[164:167], v2 offset:17408
 v_add_f32 v46, v46, v10
 v_mfma_f32_16x16x32_bf16 v[252:255], a[204:207], a[172:175], v[252:255]
 ds_read_b128 a[172:175], v2 offset:21504
 v_add_f32 v47, v47, v11
 v_mfma_f32_16x16x32_bf16 v[252:255], a[200:203], a[168:171], v[252:255]
 ds_read_b128 a[168:171], v2 offset:20480
 ds_read_b128 v[8:11], v4 offset:16
 v_mfma_f32_16x16x32_bf16 a[248:251], a[200:203], a[176:179], a[248:251]
 ds_read_b128 a[176:179], v2 offset:24576
 ds_read_b128 v[12:15], v3 offset:14336
 v_mfma_f32_16x16x32_bf16 a[248:251], a[204:207], a[180:183], a[248:251]
 ds_read_b128 a[180:183], v2 offset:25600
 v_mfma_f32_16x16x32_bf16 a[252:255], a[204:207], a[188:191], a[252:255]
 ds_read_b128 a[188:191], v2 offset:29696
 v_mfma_f32_16x16x32_bf16 a[252:255], a[200:203], a[184:187], a[252:255]
 ds_read_b128 a[184:187], v2 offset:28672
 s_waitcnt vmcnt(11) lgkmcnt(10)
 v_mfma_f32_16x16x32_bf16 v[136:139], a[208:211], a[128:131], v[136:139]
 v_mfma_f32_16x16x32_bf16 v[136:139], a[212:215], a[132:135], v[136:139]
 global_load_dwordx4 a[204:207], v0, s[70:71] offset:-1024 sc1
 v_mfma_f32_16x16x32_bf16 v[140:143], a[212:215], a[140:143], v[140:143]
 v_mfma_f32_16x16x32_bf16 v[140:143], a[208:211], a[136:139], v[140:143]
 global_load_dwordx4 a[200:203], v0, s[70:71] offset:-2048 sc1
 v_mfma_f32_16x16x32_bf16 v[144:147], a[208:211], a[144:147], v[144:147]
 v_mfma_f32_16x16x32_bf16 v[144:147], a[212:215], a[148:151], v[144:147]
 s_waitcnt lgkmcnt(5)
 v_mfma_f32_16x16x32_bf16 v[148:151], a[212:215], a[156:159], v[148:151]
 v_add_f32 v48, v48, v8
 v_mfma_f32_16x16x32_bf16 v[148:151], a[208:211], a[152:155], v[148:151]
 v_add_f32 v49, v49, v9
 s_waitcnt lgkmcnt(0)
 v_mfma_f32_16x16x32_bf16 v[152:155], a[208:211], a[160:163], v[152:155]
 v_mfma_f32_16x16x32_bf16 v[152:155], a[212:215], a[164:167], v[152:155]
 v_add_f32 v50, v50, v10
 v_mfma_f32_16x16x32_bf16 v[156:159], a[212:215], a[172:175], v[156:159]
 v_add_f32 v51, v51, v11
 v_mfma_f32_16x16x32_bf16 v[156:159], a[208:211], a[168:171], v[156:159]
 v_add_f32 v52, v52, v8
 v_mfma_f32_16x16x32_bf16 v[160:163], a[208:211], a[176:179], v[160:163]
 v_add_f32 v53, v53, v9
 v_mfma_f32_16x16x32_bf16 v[160:163], a[212:215], a[180:183], v[160:163]
 v_mfma_f32_16x16x32_bf16 v[164:167], a[212:215], a[188:191], v[164:167]
 v_add_f32 v54, v54, v10
 v_mfma_f32_16x16x32_bf16 v[164:167], a[208:211], a[184:187], v[164:167]
 v_add_f32 v55, v55, v11
 s_waitcnt vmcnt(11)
 v_mfma_f32_16x16x32_bf16 v[196:199], a[216:219], a[184:187], v[196:199]
 v_add_f32 v56, v56, v8
 v_mfma_f32_16x16x32_bf16 v[196:199], a[220:223], a[188:191], v[196:199]
 global_load_dwordx4 a[212:215], v0, s[70:71] offset:1024 sc1
 v_add_f32 v57, v57, v9
 v_mfma_f32_16x16x32_bf16 v[192:195], a[220:223], a[180:183], v[192:195]
 v_add_f32 v58, v58, v10
 v_mfma_f32_16x16x32_bf16 v[192:195], a[216:219], a[176:179], v[192:195]
 global_load_dwordx4 a[208:211], v0, s[70:71] offset:0 sc1
 v_add_f32 v59, v59, v11
 v_mfma_f32_16x16x32_bf16 v[188:191], a[216:219], a[168:171], v[188:191]
 buffer_store_dwordx4 v[12:15], v3, s[32:35], s69 offen offset:2048 sc1
 v_mfma_f32_16x16x32_bf16 v[188:191], a[220:223], a[172:175], v[188:191]
 v_add_f32 v60, v60, v8
 v_mfma_f32_16x16x32_bf16 v[184:187], a[220:223], a[164:167], v[184:187]
 v_add_f32 v61, v61, v9
 v_mfma_f32_16x16x32_bf16 v[184:187], a[216:219], a[160:163], v[184:187]
 v_add_f32 v62, v62, v10
 v_mfma_f32_16x16x32_bf16 v[180:183], a[216:219], a[152:155], v[180:183]
 ds_read_b128 v[12:15], v3 offset:15360
 v_mfma_f32_16x16x32_bf16 v[180:183], a[220:223], a[156:159], v[180:183]
 v_add_f32 v63, v63, v11
 v_mfma_f32_16x16x32_bf16 v[176:179], a[220:223], a[148:151], v[176:179]
 v_add_f32 v64, v64, v8
 v_mfma_f32_16x16x32_bf16 v[176:179], a[216:219], a[144:147], v[176:179]
 v_add_f32 v65, v65, v9
 v_mfma_f32_16x16x32_bf16 v[172:175], a[216:219], a[136:139], v[172:175]
 v_mfma_f32_16x16x32_bf16 v[172:175], a[220:223], a[140:143], v[172:175]
 v_add_f32 v66, v66, v10
 v_mfma_f32_16x16x32_bf16 v[168:171], a[220:223], a[132:135], v[168:171]
 v_add_f32 v67, v67, v11
 v_mfma_f32_16x16x32_bf16 v[168:171], a[216:219], a[128:131], v[168:171]
 v_add_f32 v68, v68, v8
 s_waitcnt vmcnt(12)
 v_mfma_f32_16x16x32_bf16 v[200:203], a[224:227], a[128:131], v[200:203]
 v_add_f32 v69, v69, v9
 v_mfma_f32_16x16x32_bf16 v[200:203], a[228:231], a[132:135], v[200:203]
 global_load_dwordx4 a[220:223], v0, s[70:71] offset:3072 sc1
 v_mfma_f32_16x16x32_bf16 v[204:207], a[228:231], a[140:143], v[204:207]
 v_add_f32 v70, v70, v10
 v_mfma_f32_16x16x32_bf16 v[204:207], a[224:227], a[136:139], v[204:207]
 global_load_dwordx4 a[216:219], v0, s[70:71] offset:2048 sc1
 v_add_f32 v71, v71, v11
 v_mfma_f32_16x16x32_bf16 v[208:211], a[224:227], a[144:147], v[208:211]
 v_add_f32 v72, v72, v8
 s_add_u32 s70, s70, 8192
 s_addc_u32 s71, s71, 0
 v_mfma_f32_16x16x32_bf16 v[208:211], a[228:231], a[148:151], v[208:211]
 v_add_f32 v73, v73, v9
 v_mfma_f32_16x16x32_bf16 v[212:215], a[228:231], a[156:159], v[212:215]
 v_mfma_f32_16x16x32_bf16 v[212:215], a[224:227], a[152:155], v[212:215]
 v_add_f32 v74, v74, v10
 v_mfma_f32_16x16x32_bf16 v[216:219], a[224:227], a[160:163], v[216:219]
 v_add_f32 v75, v75, v11
 v_mfma_f32_16x16x32_bf16 v[216:219], a[228:231], a[164:167], v[216:219]
 v_add_f32 v76, v76, v8
 v_mfma_f32_16x16x32_bf16 v[220:223], a[228:231], a[172:175], v[220:223]
 v_add_f32 v77, v77, v9
 v_mfma_f32_16x16x32_bf16 v[220:223], a[224:227], a[168:171], v[220:223]
 s_waitcnt lgkmcnt(0)
 v_mfma_f32_16x16x32_bf16 v[224:227], a[224:227], a[176:179], v[224:227]
 v_add_f32 v78, v78, v10
 v_mfma_f32_16x16x32_bf16 v[224:227], a[228:231], a[180:183], v[224:227]
 v_add_f32 v79, v79, v11
 v_mfma_f32_16x16x32_bf16 v[228:231], a[228:231], a[188:191], v[228:231]
 buffer_store_dwordx4 v[12:15], v3, s[32:35], s69 offen offset:3072 sc1
 v_mfma_f32_16x16x32_bf16 v[228:231], a[224:227], a[184:187], v[228:231]
 ds_read_b128 v[8:11], v4 offset:128
 s_waitcnt vmcnt(11)
 v_mfma_f32_16x16x32_bf16 a[252:255], a[232:235], a[184:187], a[252:255]
 ds_read_b128 a[184:187], v1 offset:61440
 v_mfma_f32_16x16x32_bf16 a[252:255], a[236:239], a[188:191], a[252:255]
 global_load_dwordx4 a[228:231], v0, s[70:71] offset:-3072 sc1
 ds_read_b128 a[188:191], v1 offset:62464
 v_mfma_f32_16x16x32_bf16 a[248:251], a[236:239], a[180:183], a[248:251]
 ds_read_b128 a[180:183], v1 offset:58368
 v_mfma_f32_16x16x32_bf16 a[248:251], a[232:235], a[176:179], a[248:251]
 global_load_dwordx4 a[224:227], v0, s[70:71] offset:-4096 sc1
 ds_read_b128 a[176:179], v1 offset:57344
 v_mfma_f32_16x16x32_bf16 v[252:255], a[232:235], a[168:171], v[252:255]
 ds_read_b128 a[168:171], v1 offset:53248
 v_mfma_f32_16x16x32_bf16 v[252:255], a[236:239], a[172:175], v[252:255]
 ds_read_b128 a[172:175], v1 offset:54272
 ds_read_b128 v[12:15], v3 offset:18432
 v_mfma_f32_16x16x32_bf16 v[248:251], a[236:239], a[164:167], v[248:251]
 ds_read_b128 a[164:167], v1 offset:50176
 v_mfma_f32_16x16x32_bf16 v[248:251], a[232:235], a[160:163], v[248:251]
 ds_read_b128 a[160:163], v1 offset:49152
 v_mfma_f32_16x16x32_bf16 v[244:247], a[232:235], a[152:155], v[244:247]
 ds_read_b128 a[152:155], v1 offset:45056
 s_waitcnt lgkmcnt(10)
 v_mfma_f32_16x16x32_bf16 v[244:247], a[236:239], a[156:159], v[244:247]
 ds_read_b128 a[156:159], v1 offset:46080
 v_mfma_f32_16x16x32_bf16 v[240:243], a[236:239], a[148:151], v[240:243]
 ds_read_b128 a[148:151], v1 offset:41984
 v_add_f32 v80, v80, v8
 v_mfma_f32_16x16x32_bf16 v[240:243], a[232:235], a[144:147], v[240:243]
 ds_read_b128 a[144:147], v1 offset:40960
 v_add_f32 v81, v81, v9
 v_mfma_f32_16x16x32_bf16 v[236:239], a[232:235], a[136:139], v[236:239]
 ds_read_b128 a[136:139], v1 offset:36864
 v_add_f32 v82, v82, v10
 v_mfma_f32_16x16x32_bf16 v[236:239], a[236:239], a[140:143], v[236:239]
 ds_read_b128 a[140:143], v1 offset:37888
 v_add_f32 v83, v83, v11
 v_mfma_f32_16x16x32_bf16 v[232:235], a[236:239], a[132:135], v[232:235]
 ds_read_b128 a[132:135], v1 offset:33792
 v_mfma_f32_16x16x32_bf16 v[232:235], a[232:235], a[128:131], v[232:235]
 ds_read_b128 a[128:131], v1 offset:32768
 v_add_f32 v84, v84, v8
 s_waitcnt vmcnt(11) lgkmcnt(8)
 v_mfma_f32_16x16x32_bf16 v[164:167], a[192:195], a[184:187], v[164:167]
 v_add_f32 v85, v85, v9
 v_mfma_f32_16x16x32_bf16 v[164:167], a[196:199], a[188:191], v[164:167]
 global_load_dwordx4 a[236:239], v0, s[70:71] offset:-1024 sc1
 v_add_f32 v86, v86, v10
 v_mfma_f32_16x16x32_bf16 v[160:163], a[196:199], a[180:183], v[160:163]
 v_add_f32 v87, v87, v11
 v_mfma_f32_16x16x32_bf16 v[160:163], a[192:195], a[176:179], v[160:163]
 global_load_dwordx4 a[232:235], v0, s[70:71] offset:-2048 sc1
 v_mfma_f32_16x16x32_bf16 v[156:159], a[192:195], a[168:171], v[156:159]
 v_add_f32 v88, v88, v8
 v_mfma_f32_16x16x32_bf16 v[156:159], a[196:199], a[172:175], v[156:159]
 v_add_f32 v89, v89, v9
 v_mfma_f32_16x16x32_bf16 v[152:155], a[196:199], a[164:167], v[152:155]
 v_add_f32 v90, v90, v10
 v_mfma_f32_16x16x32_bf16 v[152:155], a[192:195], a[160:163], v[152:155]
 v_add_f32 v91, v91, v11
 s_waitcnt lgkmcnt(0)
 v_mfma_f32_16x16x32_bf16 v[148:151], a[192:195], a[152:155], v[148:151]
 v_mfma_f32_16x16x32_bf16 v[148:151], a[196:199], a[156:159], v[148:151]
 v_add_f32 v92, v92, v8
 v_mfma_f32_16x16x32_bf16 v[144:147], a[196:199], a[148:151], v[144:147]
 v_add_f32 v93, v93, v9
 s_add_u32 s69, s29, 24576
 v_mfma_f32_16x16x32_bf16 v[144:147], a[192:195], a[144:147], v[144:147]
 v_add_f32 v94, v94, v10
 v_mfma_f32_16x16x32_bf16 v[140:143], a[192:195], a[136:139], v[140:143]
 buffer_store_dwordx4 v[12:15], v3, s[32:35], s69 offen sc1
 v_mfma_f32_16x16x32_bf16 v[140:143], a[196:199], a[140:143], v[140:143]
 v_add_f32 v95, v95, v11
 v_mfma_f32_16x16x32_bf16 v[136:139], a[196:199], a[132:135], v[136:139]
 v_add_f32 v96, v96, v8
 v_mfma_f32_16x16x32_bf16 v[136:139], a[192:195], a[128:131], v[136:139]
 v_add_f32 v97, v97, v9
 s_waitcnt vmcnt(11)
 v_mfma_f32_16x16x32_bf16 v[168:171], a[200:203], a[128:131], v[168:171]
 v_add_f32 v98, v98, v10
 v_mfma_f32_16x16x32_bf16 v[168:171], a[204:207], a[132:135], v[168:171]
 global_load_dwordx4 a[196:199], v0, s[70:71] offset:1024 sc1
 v_add_f32 v99, v99, v11
 v_mfma_f32_16x16x32_bf16 v[172:175], a[204:207], a[140:143], v[172:175]
 v_add_f32 v100, v100, v8
 v_mfma_f32_16x16x32_bf16 v[172:175], a[200:203], a[136:139], v[172:175]
 global_load_dwordx4 a[192:195], v0, s[70:71] offset:0 sc1
 ds_read_b128 v[12:15], v3 offset:19456
 v_mfma_f32_16x16x32_bf16 v[176:179], a[200:203], a[144:147], v[176:179]
 v_add_f32 v101, v101, v9
 v_mfma_f32_16x16x32_bf16 v[176:179], a[204:207], a[148:151], v[176:179]
 v_add_f32 v102, v102, v10
 v_mfma_f32_16x16x32_bf16 v[180:183], a[204:207], a[156:159], v[180:183]
 v_add_f32 v103, v103, v11
 v_mfma_f32_16x16x32_bf16 v[180:183], a[200:203], a[152:155], v[180:183]
 v_mfma_f32_16x16x32_bf16 v[184:187], a[200:203], a[160:163], v[184:187]
 v_add_f32 v104, v104, v8
 v_mfma_f32_16x16x32_bf16 v[184:187], a[204:207], a[164:167], v[184:187]
 v_add_f32 v105, v105, v9
 v_mfma_f32_16x16x32_bf16 v[188:191], a[204:207], a[172:175], v[188:191]
 v_add_f32 v106, v106, v10
 v_mfma_f32_16x16x32_bf16 v[188:191], a[200:203], a[168:171], v[188:191]
 v_add_f32 v107, v107, v11
 v_mfma_f32_16x16x32_bf16 v[192:195], a[200:203], a[176:179], v[192:195]
 v_mfma_f32_16x16x32_bf16 v[192:195], a[204:207], a[180:183], v[192:195]
 v_add_f32 v108, v108, v8
 v_mfma_f32_16x16x32_bf16 v[196:199], a[204:207], a[188:191], v[196:199]
 v_add_f32 v109, v109, v9
 v_mfma_f32_16x16x32_bf16 v[196:199], a[200:203], a[184:187], v[196:199]
 v_add_f32 v110, v110, v10
 s_waitcnt vmcnt(11)
 v_mfma_f32_16x16x32_bf16 v[228:231], a[208:211], a[184:187], v[228:231]
 v_add_f32 v111, v111, v11
 v_mfma_f32_16x16x32_bf16 v[228:231], a[212:215], a[188:191], v[228:231]
 global_load_dwordx4 a[204:207], v0, s[70:71] offset:3072 sc1
 v_mfma_f32_16x16x32_bf16 v[224:227], a[212:215], a[180:183], v[224:227]
 ds_read_b128 v[8:11], v4 offset:144
 v_mfma_f32_16x16x32_bf16 v[224:227], a[208:211], a[176:179], v[224:227]
 global_load_dwordx4 a[200:203], v0, s[70:71] offset:2048 sc1
 v_mfma_f32_16x16x32_bf16 v[220:223], a[208:211], a[168:171], v[220:223]
 s_add_u32 s70, s70, 8192
 s_addc_u32 s71, s71, 0
 v_mfma_f32_16x16x32_bf16 v[220:223], a[212:215], a[172:175], v[220:223]
 v_mfma_f32_16x16x32_bf16 v[216:219], a[212:215], a[164:167], v[216:219]
 s_waitcnt lgkmcnt(1)
 v_mfma_f32_16x16x32_bf16 v[216:219], a[208:211], a[160:163], v[216:219]
 v_mfma_f32_16x16x32_bf16 v[212:215], a[208:211], a[152:155], v[212:215]
 v_mfma_f32_16x16x32_bf16 v[212:215], a[212:215], a[156:159], v[212:215]
 buffer_store_dwordx4 v[12:15], v3, s[32:35], s69 offen offset:1024 sc1
 v_mfma_f32_16x16x32_bf16 v[208:211], a[212:215], a[148:151], v[208:211]
 v_mfma_f32_16x16x32_bf16 v[208:211], a[208:211], a[144:147], v[208:211]
 v_mfma_f32_16x16x32_bf16 v[204:207], a[208:211], a[136:139], v[204:207]
 s_waitcnt lgkmcnt(0)
 v_mfma_f32_16x16x32_bf16 v[204:207], a[212:215], a[140:143], v[204:207]
 v_add_f32 v112, v112, v8
 v_mfma_f32_16x16x32_bf16 v[200:203], a[212:215], a[132:135], v[200:203]
 v_add_f32 v113, v113, v9
 v_mfma_f32_16x16x32_bf16 v[200:203], a[208:211], a[128:131], v[200:203]
 v_add_f32 v114, v114, v10
 v_add_f32 v115, v115, v11
 s_waitcnt vmcnt(11)
 v_mfma_f32_16x16x32_bf16 v[232:235], a[216:219], a[128:131], v[232:235]
 ds_read_b128 a[128:131], v1
 ds_read_b128 v[12:15], v3 offset:22528
 v_mfma_f32_16x16x32_bf16 v[232:235], a[220:223], a[132:135], v[232:235]
 global_load_dwordx4 a[212:215], v0, s[70:71] offset:-3072 sc1
 ds_read_b128 a[132:135], v1 offset:1024
 v_mfma_f32_16x16x32_bf16 v[236:239], a[220:223], a[140:143], v[236:239]
 ds_read_b128 a[140:143], v1 offset:5120
 v_add_f32 v116, v116, v8
 v_mfma_f32_16x16x32_bf16 v[236:239], a[216:219], a[136:139], v[236:239]
 global_load_dwordx4 a[208:211], v0, s[70:71] offset:-4096 sc1
 ds_read_b128 a[136:139], v1 offset:4096
 v_mfma_f32_16x16x32_bf16 v[240:243], a[216:219], a[144:147], v[240:243]
 ds_read_b128 a[144:147], v1 offset:8192
 v_add_f32 v117, v117, v9
 v_mfma_f32_16x16x32_bf16 v[240:243], a[220:223], a[148:151], v[240:243]
 ds_read_b128 a[148:151], v1 offset:9216
 v_add_f32 v118, v118, v10
 v_mfma_f32_16x16x32_bf16 v[244:247], a[220:223], a[156:159], v[244:247]
 ds_read_b128 a[156:159], v1 offset:13312
 v_add_f32 v119, v119, v11
 v_mfma_f32_16x16x32_bf16 v[244:247], a[216:219], a[152:155], v[244:247]
 ds_read_b128 a[152:155], v1 offset:12288
 v_add_f32 v120, v120, v8
 v_mfma_f32_16x16x32_bf16 v[248:251], a[216:219], a[160:163], v[248:251]
 ds_read_b128 a[160:163], v1 offset:16384
 v_add_f32 v121, v121, v9
 v_mfma_f32_16x16x32_bf16 v[248:251], a[220:223], a[164:167], v[248:251]
 ds_read_b128 a[164:167], v1 offset:17408
 v_add_f32 v122, v122, v10
 v_mfma_f32_16x16x32_bf16 v[252:255], a[220:223], a[172:175], v[252:255]
 ds_read_b128 a[172:175], v1 offset:21504
 v_mfma_f32_16x16x32_bf16 v[252:255], a[216:219], a[168:171], v[252:255]
 ds_read_b128 a[168:171], v1 offset:20480
 v_add_f32 v123, v123, v11
 v_mfma_f32_16x16x32_bf16 a[248:251], a[216:219], a[176:179], a[248:251]
 ds_read_b128 a[176:179], v1 offset:24576
 v_add_f32 v124, v124, v8
 v_mfma_f32_16x16x32_bf16 a[248:251], a[220:223], a[180:183], a[248:251]
 ds_read_b128 a[180:183], v1 offset:25600
 v_add_f32 v125, v125, v9
 v_mfma_f32_16x16x32_bf16 a[252:255], a[220:223], a[188:191], a[252:255]
 ds_read_b128 a[188:191], v1 offset:29696
 v_add_f32 v126, v126, v10
 v_mfma_f32_16x16x32_bf16 a[252:255], a[216:219], a[184:187], a[252:255]
 ds_read_b128 a[184:187], v1 offset:28672
 s_waitcnt vmcnt(10) lgkmcnt(8)
 v_mfma_f32_16x16x32_bf16 v[136:139], a[224:227], a[128:131], v[136:139]
 v_add_f32 v127, v127, v11
 v_mfma_f32_16x16x32_bf16 v[136:139], a[228:231], a[132:135], v[136:139]
 global_load_dwordx4 a[220:223], v0, s[70:71] offset:-1024 sc1
 v_add_f32 v128, v128, v8
 v_mfma_f32_16x16x32_bf16 v[140:143], a[228:231], a[140:143], v[140:143]
 v_add_f32 v129, v129, v9
 v_mfma_f32_16x16x32_bf16 v[140:143], a[224:227], a[136:139], v[140:143]
 global_load_dwordx4 a[216:219], v0, s[70:71] offset:-2048 sc1
 v_add_f32 v130, v130, v10
 v_mfma_f32_16x16x32_bf16 v[144:147], a[224:227], a[144:147], v[144:147]
 v_add_f32 v131, v131, v11
 v_mfma_f32_16x16x32_bf16 v[144:147], a[228:231], a[148:151], v[144:147]
 buffer_store_dwordx4 v[12:15], v3, s[32:35], s69 offen offset:2048 sc1
 v_mfma_f32_16x16x32_bf16 v[148:151], a[228:231], a[156:159], v[148:151]
 buffer_load_dword v4, off, s[64:67], 0 sc1
 v_mfma_f32_16x16x32_bf16 v[148:151], a[224:227], a[152:155], v[148:151]
 v_add_f32 v132, v132, v8
 s_waitcnt lgkmcnt(0)
 v_mfma_f32_16x16x32_bf16 v[152:155], a[224:227], a[160:163], v[152:155]
 v_add_f32 v133, v133, v9
 v_mfma_f32_16x16x32_bf16 v[152:155], a[228:231], a[164:167], v[152:155]
 v_mfma_f32_16x16x32_bf16 v[156:159], a[228:231], a[172:175], v[156:159]
 v_add_f32 v134, v134, v10
 v_mfma_f32_16x16x32_bf16 v[156:159], a[224:227], a[168:171], v[156:159]
 v_add_f32 v135, v135, v11
 v_mfma_f32_16x16x32_bf16 v[160:163], a[224:227], a[176:179], v[160:163]
 ds_read_b128 v[12:15], v3 offset:23552
 v_mfma_f32_16x16x32_bf16 v[160:163], a[228:231], a[180:183], v[160:163]
 v_accvgpr_read_b32 v5, a240
 v_mfma_f32_16x16x32_bf16 v[164:167], a[228:231], a[188:191], v[164:167]
 v_add_f32 v5, v5, v8
 v_mfma_f32_16x16x32_bf16 v[164:167], a[224:227], a[184:187], v[164:167]
 v_accvgpr_write_b32 a240, v5
 s_waitcnt vmcnt(12)
 v_mfma_f32_16x16x32_bf16 v[196:199], a[232:235], a[184:187], v[196:199]
 v_accvgpr_read_b32 v6, a241
 v_mfma_f32_16x16x32_bf16 v[196:199], a[236:239], a[188:191], v[196:199]
 global_load_dwordx4 a[228:231], v0, s[70:71] offset:1024 sc1
 v_add_f32 v6, v6, v9
 v_mfma_f32_16x16x32_bf16 v[192:195], a[236:239], a[180:183], v[192:195]
 v_accvgpr_write_b32 a241, v6
 v_mfma_f32_16x16x32_bf16 v[192:195], a[232:235], a[176:179], v[192:195]
 global_load_dwordx4 a[224:227], v0, s[70:71] offset:0 sc1
 v_mfma_f32_16x16x32_bf16 v[188:191], a[232:235], a[168:171], v[188:191]
 v_accvgpr_read_b32 v5, a242
 v_mfma_f32_16x16x32_bf16 v[188:191], a[236:239], a[172:175], v[188:191]
 v_add_f32 v5, v5, v10
 v_mfma_f32_16x16x32_bf16 v[184:187], a[236:239], a[164:167], v[184:187]
 v_accvgpr_write_b32 a242, v5
 v_mfma_f32_16x16x32_bf16 v[184:187], a[232:235], a[160:163], v[184:187]
 v_accvgpr_read_b32 v6, a243
 v_mfma_f32_16x16x32_bf16 v[180:183], a[232:235], a[152:155], v[180:183]
 v_mfma_f32_16x16x32_bf16 v[180:183], a[236:239], a[156:159], v[180:183]
 v_add_f32 v6, v6, v11
 v_mfma_f32_16x16x32_bf16 v[176:179], a[236:239], a[148:151], v[176:179]
 v_accvgpr_write_b32 a243, v6
 v_mfma_f32_16x16x32_bf16 v[176:179], a[232:235], a[144:147], v[176:179]
 v_accvgpr_read_b32 v5, a244
 v_mfma_f32_16x16x32_bf16 v[172:175], a[232:235], a[136:139], v[172:175]
 v_add_f32 v5, v5, v8
 v_mfma_f32_16x16x32_bf16 v[172:175], a[236:239], a[140:143], v[172:175]
 v_mfma_f32_16x16x32_bf16 v[168:171], a[236:239], a[132:135], v[168:171]
 v_accvgpr_write_b32 a244, v5
 v_mfma_f32_16x16x32_bf16 v[168:171], a[232:235], a[128:131], v[168:171]
 v_accvgpr_read_b32 v6, a245
 s_waitcnt lgkmcnt(0)
 s_waitcnt vmcnt(11)
 v_mfma_f32_16x16x32_bf16 v[200:203], a[192:195], a[128:131], v[200:203]
 v_add_f32 v6, v6, v9
 v_mfma_f32_16x16x32_bf16 v[200:203], a[196:199], a[132:135], v[200:203]
 global_load_dwordx4 a[236:239], v0, s[70:71] offset:3072 sc1
 v_accvgpr_write_b32 a245, v6
 v_mfma_f32_16x16x32_bf16 v[204:207], a[196:199], a[140:143], v[204:207]
 v_accvgpr_read_b32 v5, a246
 v_mfma_f32_16x16x32_bf16 v[204:207], a[192:195], a[136:139], v[204:207]
 global_load_dwordx4 a[232:235], v0, s[70:71] offset:2048 sc1
 v_add_f32 v5, v5, v10
 v_mfma_f32_16x16x32_bf16 v[208:211], a[192:195], a[144:147], v[208:211]
 buffer_store_dwordx4 v[12:15], v3, s[32:35], s69 offen offset:3072 sc1
 s_add_u32 s70, s70, 8192
 s_addc_u32 s71, s71, 0
 v_mfma_f32_16x16x32_bf16 v[208:211], a[196:199], a[148:151], v[208:211]
 v_accvgpr_write_b32 a246, v5
 v_mfma_f32_16x16x32_bf16 v[212:215], a[196:199], a[156:159], v[212:215]
 v_accvgpr_read_b32 v6, a247
 v_mfma_f32_16x16x32_bf16 v[212:215], a[192:195], a[152:155], v[212:215]
 v_mfma_f32_16x16x32_bf16 v[216:219], a[192:195], a[160:163], v[216:219]
 v_add_f32 v6, v6, v11
 v_mfma_f32_16x16x32_bf16 v[216:219], a[196:199], a[164:167], v[216:219]
 v_accvgpr_write_b32 a247, v6
 v_mfma_f32_16x16x32_bf16 v[220:223], a[196:199], a[172:175], v[220:223]
 s_waitcnt vmcnt(5)
 v_cmp_gt_i32 vcc, s55, v4
 s_and_b64 vcc, exec, vcc
 s_cbranch_vccnz Lspin_pa
Lok_pa:
 s_add_u32 s55, s55, 1
 s_waitcnt lgkmcnt(0)
 s_barrier
 v_mfma_f32_16x16x32_bf16 v[220:223], a[192:195], a[168:171], v[220:223]
 v_mfma_f32_16x16x32_bf16 v[224:227], a[192:195], a[176:179], v[224:227]
 v_mfma_f32_16x16x32_bf16 v[224:227], a[196:199], a[180:183], v[224:227]
 v_mfma_f32_16x16x32_bf16 v[228:231], a[196:199], a[188:191], v[228:231]
 v_mfma_f32_16x16x32_bf16 v[228:231], a[192:195], a[184:187], v[228:231]
 v_mfma_f32_16x16x32_bf16 a[252:255], a[200:203], a[184:187], a[252:255]
 ds_read_b128 a[184:187], v1 offset:30720
 v_mfma_f32_16x16x32_bf16 a[252:255], a[204:207], a[188:191], a[252:255]
 global_load_dwordx4 a[196:199], v0, s[70:71] offset:-3072 sc1
 ds_read_b128 a[188:191], v1 offset:31744
 v_mfma_f32_16x16x32_bf16 a[248:251], a[204:207], a[180:183], a[248:251]
 ds_read_b128 a[180:183], v1 offset:27648
 v_mfma_f32_16x16x32_bf16 a[248:251], a[200:203], a[176:179], a[248:251]
 global_load_dwordx4 a[192:195], v0, s[70:71] offset:-4096 sc1
 ds_read_b128 a[176:179], v1 offset:26624
 v_mfma_f32_16x16x32_bf16 v[252:255], a[200:203], a[168:171], v[252:255]
 ds_read_b128 a[168:171], v1 offset:22528
 v_mfma_f32_16x16x32_bf16 v[252:255], a[204:207], a[172:175], v[252:255]
 ds_read_b128 a[172:175], v1 offset:23552
 v_mfma_f32_16x16x32_bf16 v[248:251], a[204:207], a[164:167], v[248:251]
 ds_read_b128 a[164:167], v1 offset:19456
 v_mfma_f32_16x16x32_bf16 v[248:251], a[200:203], a[160:163], v[248:251]
 ds_read_b128 a[160:163], v1 offset:18432
 v_mfma_f32_16x16x32_bf16 v[244:247], a[200:203], a[152:155], v[244:247]
 ds_read_b128 a[152:155], v1 offset:14336
 v_mfma_f32_16x16x32_bf16 v[244:247], a[204:207], a[156:159], v[244:247]
 ds_read_b128 a[156:159], v1 offset:15360
 v_mfma_f32_16x16x32_bf16 v[240:243], a[204:207], a[148:151], v[240:243]
 ds_read_b128 a[148:151], v1 offset:11264
 v_mfma_f32_16x16x32_bf16 v[240:243], a[200:203], a[144:147], v[240:243]
 ds_read_b128 a[144:147], v1 offset:10240
 v_mfma_f32_16x16x32_bf16 v[236:239], a[200:203], a[136:139], v[236:239]
 ds_read_b128 a[136:139], v1 offset:6144
 v_mfma_f32_16x16x32_bf16 v[236:239], a[204:207], a[140:143], v[236:239]
 ds_read_b128 a[140:143], v1 offset:7168
 v_mfma_f32_16x16x32_bf16 v[232:235], a[204:207], a[132:135], v[232:235]
 global_load_dwordx4 a[204:207], v0, s[70:71] offset:-1024 sc1
 ds_read_b128 a[132:135], v1 offset:3072
 v_mfma_f32_16x16x32_bf16 v[232:235], a[200:203], a[128:131], v[232:235]
 global_load_dwordx4 a[200:203], v0, s[70:71] offset:-2048 sc1
 ds_read_b128 a[128:131], v1 offset:2048
 s_waitcnt lgkmcnt(8)
 s_branch Lloop
Llast:
 v_mfma_f32_16x16x32_bf16 v[136:139], a[208:211], a[128:131], v[136:139]
 v_accvgpr_read_b32 v5, a0
 v_lshlrev_b32 v6, 16, v5
 v_mfma_f32_16x16x32_bf16 v[136:139], a[212:215], a[132:135], v[136:139]
 v_and_b32 v5, s26, v5
 v_mul_f32 v6, v6, v16
 v_mfma_f32_16x16x32_bf16 v[140:143], a[212:215], a[140:143], v[140:143]
 v_mul_f32 v5, v5, v17
 v_cvt_pk_bf16_f32 v8, v6, v5
 v_mfma_f32_16x16x32_bf16 v[140:143], a[208:211], a[136:139], v[140:143]
 v_accvgpr_read_b32 v5, a1
 v_lshlrev_b32 v6, 16, v5
 v_mfma_f32_16x16x32_bf16 v[144:147], a[208:211], a[144:147], v[144:147]
 v_and_b32 v5, s26, v5
 v_mul_f32 v6, v6, v18
 v_mfma_f32_16x16x32_bf16 v[144:147], a[212:215], a[148:151], v[144:147]
 v_mul_f32 v5, v5, v19
 v_cvt_pk_bf16_f32 v9, v6, v5
 v_mfma_f32_16x16x32_bf16 v[148:151], a[212:215], a[156:159], v[148:151]
 v_accvgpr_read_b32 v5, a2
 v_lshlrev_b32 v6, 16, v5
 v_mfma_f32_16x16x32_bf16 v[148:151], a[208:211], a[152:155], v[148:151]
 v_and_b32 v5, s26, v5
 v_mul_f32 v6, v6, v48
 v_mfma_f32_16x16x32_bf16 v[152:155], a[208:211], a[160:163], v[152:155]
 v_mul_f32 v5, v5, v49
 v_cvt_pk_bf16_f32 v10, v6, v5
 v_mfma_f32_16x16x32_bf16 v[152:155], a[212:215], a[164:167], v[152:155]
 v_accvgpr_read_b32 v5, a3
 v_lshlrev_b32 v6, 16, v5
 v_mfma_f32_16x16x32_bf16 v[156:159], a[212:215], a[172:175], v[156:159]
 v_and_b32 v5, s26, v5
 v_mul_f32 v6, v6, v50
 v_mfma_f32_16x16x32_bf16 v[156:159], a[208:211], a[168:171], v[156:159]
 v_mul_f32 v5, v5, v51
 v_cvt_pk_bf16_f32 v11, v6, v5
 v_mfma_f32_16x16x32_bf16 v[160:163], a[208:211], a[176:179], v[160:163]
 v_lshrrev_b32 v5, 7, v1
 v_lshlrev_b32 v6, 4, v5
 v_mfma_f32_16x16x32_bf16 v[160:163], a[212:215], a[180:183], v[160:163]
 v_xor_b32 v6, v6, v1
 v_and_b32 v6, 112, v6
 v_mfma_f32_16x16x32_bf16 v[164:167], a[212:215], a[188:191], v[164:167]
 v_lshl_add_u32 v16, v5, 11, v6
 v_lshrrev_b32 v5, 4, v1
 v_mfma_f32_16x16x32_bf16 v[164:167], a[208:211], a[184:187], v[164:167]
 v_and_b32 v5, 48, v5
 v_xor_b32 v5, v5, v1
 s_waitcnt vmcnt(8)
 v_mfma_f32_16x16x32_bf16 v[196:199], a[216:219], a[184:187], v[196:199]
 v_and_b32 v5, 112, v5
 v_and_b32 v6, 240, v1
 v_mfma_f32_16x16x32_bf16 v[196:199], a[220:223], a[188:191], v[196:199]
 global_load_dwordx4 a[212:215], v0, s[70:71] offset:1024 sc1
 v_lshl_add_u32 v5, v6, 3, v5
 v_mfma_f32_16x16x32_bf16 v[192:195], a[220:223], a[180:183], v[192:195]
 v_add_u32 v17, s50, v5
 v_xor_b32 v18, 64, v17
 v_mfma_f32_16x16x32_bf16 v[192:195], a[216:219], a[176:179], v[192:195]
 global_load_dwordx4 a[208:211], v0, s[70:71] offset:0 sc1
 ds_write_b128 v17, v[8:11]
 v_mfma_f32_16x16x32_bf16 v[188:191], a[216:219], a[168:171], v[188:191]
 v_accvgpr_read_b32 v5, a32
 v_lshlrev_b32 v6, 16, v5
 v_mfma_f32_16x16x32_bf16 v[188:191], a[220:223], a[172:175], v[188:191]
 v_and_b32 v5, s26, v5
 v_mul_f32 v6, v6, v80
 v_mfma_f32_16x16x32_bf16 v[184:187], a[220:223], a[164:167], v[184:187]
 v_mul_f32 v5, v5, v81
 v_cvt_pk_bf16_f32 v12, v6, v5
 v_mfma_f32_16x16x32_bf16 v[184:187], a[216:219], a[160:163], v[184:187]
 v_accvgpr_read_b32 v5, a33
 v_lshlrev_b32 v6, 16, v5
 v_mfma_f32_16x16x32_bf16 v[180:183], a[216:219], a[152:155], v[180:183]
 v_and_b32 v5, s26, v5
 v_mul_f32 v6, v6, v82
 v_mfma_f32_16x16x32_bf16 v[180:183], a[220:223], a[156:159], v[180:183]
 v_mul_f32 v5, v5, v83
 v_cvt_pk_bf16_f32 v13, v6, v5
 v_mfma_f32_16x16x32_bf16 v[176:179], a[220:223], a[148:151], v[176:179]
 v_accvgpr_read_b32 v5, a34
 v_lshlrev_b32 v6, 16, v5
 v_mfma_f32_16x16x32_bf16 v[176:179], a[216:219], a[144:147], v[176:179]
 v_and_b32 v5, s26, v5
 v_mul_f32 v6, v6, v112
 v_mfma_f32_16x16x32_bf16 v[172:175], a[216:219], a[136:139], v[172:175]
 v_mul_f32 v5, v5, v113
 v_cvt_pk_bf16_f32 v14, v6, v5
 v_mfma_f32_16x16x32_bf16 v[172:175], a[220:223], a[140:143], v[172:175]
 v_accvgpr_read_b32 v5, a35
 v_lshlrev_b32 v6, 16, v5
 v_mfma_f32_16x16x32_bf16 v[168:171], a[220:223], a[132:135], v[168:171]
 v_and_b32 v5, s26, v5
 v_mul_f32 v6, v6, v114
 v_mfma_f32_16x16x32_bf16 v[168:171], a[216:219], a[128:131], v[168:171]
 v_mul_f32 v5, v5, v115
 v_cvt_pk_bf16_f32 v15, v6, v5
 s_waitcnt vmcnt(8)
 v_mfma_f32_16x16x32_bf16 v[200:203], a[224:227], a[128:131], v[200:203]
 ds_write_b128 v18, v[12:15]
 v_mfma_f32_16x16x32_bf16 v[200:203], a[228:231], a[132:135], v[200:203]
 global_load_dwordx4 a[220:223], v0, s[70:71] offset:3072 sc1
 ds_read_b128 v[48:51], v3
 v_mfma_f32_16x16x32_bf16 v[204:207], a[228:231], a[140:143], v[204:207]
 ds_read_b128 v[80:83], v3 offset:1024
 v_accvgpr_read_b32 v5, a4
 v_mfma_f32_16x16x32_bf16 v[204:207], a[224:227], a[136:139], v[204:207]
 global_load_dwordx4 a[216:219], v0, s[70:71] offset:2048 sc1
 v_lshlrev_b32 v6, 16, v5
 v_mfma_f32_16x16x32_bf16 v[208:211], a[224:227], a[144:147], v[208:211]
 v_and_b32 v5, s26, v5
 v_mul_f32 v6, v6, v20
 s_add_u32 s70, s70, 8192
 s_addc_u32 s71, s71, 0
 v_mfma_f32_16x16x32_bf16 v[208:211], a[228:231], a[148:151], v[208:211]
 v_mul_f32 v5, v5, v21
 v_cvt_pk_bf16_f32 v8, v6, v5
 v_mfma_f32_16x16x32_bf16 v[212:215], a[228:231], a[156:159], v[212:215]
 v_accvgpr_read_b32 v5, a5
 v_lshlrev_b32 v6, 16, v5
 v_mfma_f32_16x16x32_bf16 v[212:215], a[224:227], a[152:155], v[212:215]
 v_and_b32 v5, s26, v5
 v_mul_f32 v6, v6, v22
 v_mfma_f32_16x16x32_bf16 v[216:219], a[224:227], a[160:163], v[216:219]
 v_mul_f32 v5, v5, v23
 v_cvt_pk_bf16_f32 v9, v6, v5
 s_waitcnt lgkmcnt(1)
 s_add_u32 s3, s28, 0
 v_mfma_f32_16x16x32_bf16 v[216:219], a[228:231], a[164:167], v[216:219]
 buffer_store_dwordx4 v[48:51], v16, s[16:19], s3 offen nt
 s_waitcnt lgkmcnt(0)
 s_add_u32 s3, s28, 16384
 buffer_store_dwordx4 v[80:83], v16, s[16:19], s3 offen nt
 v_accvgpr_read_b32 v5, a6
 v_lshlrev_b32 v6, 16, v5
 v_and_b32 v5, s26, v5
 v_mfma_f32_16x16x32_bf16 v[220:223], a[228:231], a[172:175], v[220:223]
 v_mul_f32 v6, v6, v52
 v_mul_f32 v5, v5, v53
 v_mfma_f32_16x16x32_bf16 v[220:223], a[224:227], a[168:171], v[220:223]
 v_cvt_pk_bf16_f32 v10, v6, v5
 v_accvgpr_read_b32 v5, a7
 v_mfma_f32_16x16x32_bf16 v[224:227], a[224:227], a[176:179], v[224:227]
 v_lshlrev_b32 v6, 16, v5
 v_and_b32 v5, s26, v5
 v_mul_f32 v6, v6, v54
 v_mul_f32 v5, v5, v55
 v_cvt_pk_bf16_f32 v11, v6, v5
 v_mfma_f32_16x16x32_bf16 v[224:227], a[228:231], a[180:183], v[224:227]
 ds_write_b128 v17, v[8:11] offset:4096
 v_mfma_f32_16x16x32_bf16 v[228:231], a[228:231], a[188:191], v[228:231]
 v_accvgpr_read_b32 v5, a36
 v_lshlrev_b32 v6, 16, v5
 v_mfma_f32_16x16x32_bf16 v[228:231], a[224:227], a[184:187], v[228:231]
 v_and_b32 v5, s26, v5
 v_mul_f32 v6, v6, v84
 s_waitcnt vmcnt(10)
 v_mfma_f32_16x16x32_bf16 a[252:255], a[232:235], a[184:187], a[252:255]
 ds_read_b128 a[184:187], v2 offset:30720
 v_mul_f32 v5, v5, v85
 v_mfma_f32_16x16x32_bf16 a[252:255], a[236:239], a[188:191], a[252:255]
 global_load_dwordx4 a[228:231], v0, s[70:71] offset:-3072 sc1
 ds_read_b128 a[188:191], v2 offset:31744
 v_mfma_f32_16x16x32_bf16 a[248:251], a[236:239], a[180:183], a[248:251]
 ds_read_b128 a[180:183], v2 offset:27648
 v_cvt_pk_bf16_f32 v12, v6, v5
 v_mfma_f32_16x16x32_bf16 a[248:251], a[232:235], a[176:179], a[248:251]
 global_load_dwordx4 a[224:227], v0, s[70:71] offset:-4096 sc1
 ds_read_b128 a[176:179], v2 offset:26624
 v_mfma_f32_16x16x32_bf16 v[252:255], a[232:235], a[168:171], v[252:255]
 ds_read_b128 a[168:171], v2 offset:22528
 v_accvgpr_read_b32 v5, a37
 v_mfma_f32_16x16x32_bf16 v[252:255], a[236:239], a[172:175], v[252:255]
 ds_read_b128 a[172:175], v2 offset:23552
 v_lshlrev_b32 v6, 16, v5
 v_mfma_f32_16x16x32_bf16 v[248:251], a[236:239], a[164:167], v[248:251]
 ds_read_b128 a[164:167], v2 offset:19456
 v_and_b32 v5, s26, v5
 v_mfma_f32_16x16x32_bf16 v[248:251], a[232:235], a[160:163], v[248:251]
 ds_read_b128 a[160:163], v2 offset:18432
 v_mul_f32 v6, v6, v86
 v_mul_f32 v5, v5, v87
 v_mfma_f32_16x16x32_bf16 v[244:247], a[232:235], a[152:155], v[244:247]
 ds_read_b128 a[152:155], v2 offset:14336
 v_cvt_pk_bf16_f32 v13, v6, v5
 v_mfma_f32_16x16x32_bf16 v[244:247], a[236:239], a[156:159], v[244:247]
 ds_read_b128 a[156:159], v2 offset:15360
 v_accvgpr_read_b32 v5, a38
 v_lshlrev_b32 v6, 16, v5
 v_mfma_f32_16x16x32_bf16 v[240:243], a[236:239], a[148:151], v[240:243]
 ds_read_b128 a[148:151], v2 offset:11264
 v_and_b32 v5, s26, v5
 v_mul_f32 v6, v6, v116
 v_mfma_f32_16x16x32_bf16 v[240:243], a[232:235], a[144:147], v[240:243]
 ds_read_b128 a[144:147], v2 offset:10240
 v_mul_f32 v5, v5, v117
 v_cvt_pk_bf16_f32 v14, v6, v5
 v_mfma_f32_16x16x32_bf16 v[236:239], a[232:235], a[136:139], v[236:239]
 ds_read_b128 a[136:139], v2 offset:6144
 v_accvgpr_read_b32 v5, a39
 v_lshlrev_b32 v6, 16, v5
 v_mfma_f32_16x16x32_bf16 v[236:239], a[236:239], a[140:143], v[236:239]
 ds_read_b128 a[140:143], v2 offset:7168
 v_and_b32 v5, s26, v5
 v_mul_f32 v6, v6, v118
 v_mfma_f32_16x16x32_bf16 v[232:235], a[236:239], a[132:135], v[232:235]
 ds_read_b128 a[132:135], v2 offset:3072
 v_mul_f32 v5, v5, v119
 v_mfma_f32_16x16x32_bf16 v[232:235], a[232:235], a[128:131], v[232:235]
 ds_read_b128 a[128:131], v2 offset:2048
 v_cvt_pk_bf16_f32 v15, v6, v5
 s_waitcnt vmcnt(10) lgkmcnt(8)
 v_mfma_f32_16x16x32_bf16 v[164:167], a[192:195], a[184:187], v[164:167]
 ds_write_b128 v18, v[12:15] offset:4096
 v_mfma_f32_16x16x32_bf16 v[164:167], a[196:199], a[188:191], v[164:167]
 global_load_dwordx4 a[236:239], v0, s[70:71] offset:-1024 sc1
 ds_read_b128 v[48:51], v3 offset:4096
 v_mfma_f32_16x16x32_bf16 v[160:163], a[196:199], a[180:183], v[160:163]
 ds_read_b128 v[80:83], v3 offset:5120
 v_accvgpr_read_b32 v5, a8
 v_mfma_f32_16x16x32_bf16 v[160:163], a[192:195], a[176:179], v[160:163]
 global_load_dwordx4 a[232:235], v0, s[70:71] offset:-2048 sc1
 v_lshlrev_b32 v6, 16, v5
 v_mfma_f32_16x16x32_bf16 v[156:159], a[192:195], a[168:171], v[156:159]
 v_and_b32 v5, s26, v5
 v_mul_f32 v6, v6, v24
 v_mfma_f32_16x16x32_bf16 v[156:159], a[196:199], a[172:175], v[156:159]
 v_mul_f32 v5, v5, v25
 v_cvt_pk_bf16_f32 v8, v6, v5
 v_mfma_f32_16x16x32_bf16 v[152:155], a[196:199], a[164:167], v[152:155]
 v_accvgpr_read_b32 v5, a9
 v_lshlrev_b32 v6, 16, v5
 v_mfma_f32_16x16x32_bf16 v[152:155], a[192:195], a[160:163], v[152:155]
 v_and_b32 v5, s26, v5
 v_mul_f32 v6, v6, v26
 s_waitcnt lgkmcnt(3)
 v_mfma_f32_16x16x32_bf16 v[148:151], a[192:195], a[152:155], v[148:151]
 v_mul_f32 v5, v5, v27
 v_cvt_pk_bf16_f32 v9, v6, v5
 s_waitcnt lgkmcnt(1)
 s_add_u32 s3, s28, 32768
 v_mfma_f32_16x16x32_bf16 v[148:151], a[196:199], a[156:159], v[148:151]
 buffer_store_dwordx4 v[48:51], v16, s[16:19], s3 offen nt
 s_waitcnt lgkmcnt(0)
 s_add_u32 s3, s28, 49152
 buffer_store_dwordx4 v[80:83], v16, s[16:19], s3 offen nt
 v_accvgpr_read_b32 v5, a10
 v_lshlrev_b32 v6, 16, v5
 v_mfma_f32_16x16x32_bf16 v[144:147], a[196:199], a[148:151], v[144:147]
 v_and_b32 v5, s26, v5
 v_mul_f32 v6, v6, v56
 v_mfma_f32_16x16x32_bf16 v[144:147], a[192:195], a[144:147], v[144:147]
 v_mul_f32 v5, v5, v57
 v_cvt_pk_bf16_f32 v10, v6, v5
 v_mfma_f32_16x16x32_bf16 v[140:143], a[192:195], a[136:139], v[140:143]
 v_accvgpr_read_b32 v5, a11
 v_lshlrev_b32 v6, 16, v5
 v_mfma_f32_16x16x32_bf16 v[140:143], a[196:199], a[140:143], v[140:143]
 v_and_b32 v5, s26, v5
 v_mul_f32 v6, v6, v58
 v_mfma_f32_16x16x32_bf16 v[136:139], a[196:199], a[132:135], v[136:139]
 v_mul_f32 v5, v5, v59
 v_cvt_pk_bf16_f32 v11, v6, v5
 v_mfma_f32_16x16x32_bf16 v[136:139], a[192:195], a[128:131], v[136:139]
 ds_write_b128 v17, v[8:11] offset:8192
 s_waitcnt vmcnt(12)
 v_mfma_f32_16x16x32_bf16 v[168:171], a[200:203], a[128:131], v[168:171]
 v_accvgpr_read_b32 v5, a40
 v_lshlrev_b32 v6, 16, v5
 v_mfma_f32_16x16x32_bf16 v[168:171], a[204:207], a[132:135], v[168:171]
 global_load_dwordx4 a[196:199], v0, s[70:71] offset:1024 sc1
 v_and_b32 v5, s26, v5
 v_mfma_f32_16x16x32_bf16 v[172:175], a[204:207], a[140:143], v[172:175]
 v_mul_f32 v6, v6, v88
 v_mul_f32 v5, v5, v89
 v_mfma_f32_16x16x32_bf16 v[172:175], a[200:203], a[136:139], v[172:175]
 global_load_dwordx4 a[192:195], v0, s[70:71] offset:0 sc1
 v_cvt_pk_bf16_f32 v12, v6, v5
 v_mfma_f32_16x16x32_bf16 v[176:179], a[200:203], a[144:147], v[176:179]
 v_accvgpr_read_b32 v5, a41
 v_lshlrev_b32 v6, 16, v5
 v_mfma_f32_16x16x32_bf16 v[176:179], a[204:207], a[148:151], v[176:179]
 v_and_b32 v5, s26, v5
 v_mul_f32 v6, v6, v90
 v_mfma_f32_16x16x32_bf16 v[180:183], a[204:207], a[156:159], v[180:183]
 v_mul_f32 v5, v5, v91
 v_cvt_pk_bf16_f32 v13, v6, v5
 v_mfma_f32_16x16x32_bf16 v[180:183], a[200:203], a[152:155], v[180:183]
 v_accvgpr_read_b32 v5, a42
 v_lshlrev_b32 v6, 16, v5
 v_mfma_f32_16x16x32_bf16 v[184:187], a[200:203], a[160:163], v[184:187]
 v_and_b32 v5, s26, v5
 v_mul_f32 v6, v6, v120
 v_mfma_f32_16x16x32_bf16 v[184:187], a[204:207], a[164:167], v[184:187]
 v_mul_f32 v5, v5, v121
 v_cvt_pk_bf16_f32 v14, v6, v5
 v_mfma_f32_16x16x32_bf16 v[188:191], a[204:207], a[172:175], v[188:191]
 v_accvgpr_read_b32 v5, a43
 v_lshlrev_b32 v6, 16, v5
 v_mfma_f32_16x16x32_bf16 v[188:191], a[200:203], a[168:171], v[188:191]
 v_and_b32 v5, s26, v5
 v_mul_f32 v6, v6, v122
 v_mfma_f32_16x16x32_bf16 v[192:195], a[200:203], a[176:179], v[192:195]
 v_mul_f32 v5, v5, v123
 v_cvt_pk_bf16_f32 v15, v6, v5
 v_mfma_f32_16x16x32_bf16 v[192:195], a[204:207], a[180:183], v[192:195]
 ds_write_b128 v18, v[12:15] offset:8192
 v_mfma_f32_16x16x32_bf16 v[196:199], a[204:207], a[188:191], v[196:199]
 ds_read_b128 v[48:51], v3 offset:8192
 ds_read_b128 v[80:83], v3 offset:9216
 v_mfma_f32_16x16x32_bf16 v[196:199], a[200:203], a[184:187], v[196:199]
 v_accvgpr_read_b32 v5, a12
 v_lshlrev_b32 v6, 16, v5
 s_waitcnt vmcnt(12)
 v_mfma_f32_16x16x32_bf16 v[228:231], a[208:211], a[184:187], v[228:231]
 v_and_b32 v5, s26, v5
 v_mul_f32 v6, v6, v28
 v_mfma_f32_16x16x32_bf16 v[228:231], a[212:215], a[188:191], v[228:231]
 global_load_dwordx4 a[204:207], v0, s[70:71] offset:3072 sc1
 v_mul_f32 v5, v5, v29
 v_mfma_f32_16x16x32_bf16 v[224:227], a[212:215], a[180:183], v[224:227]
 v_cvt_pk_bf16_f32 v8, v6, v5
 v_accvgpr_read_b32 v5, a13
 v_mfma_f32_16x16x32_bf16 v[224:227], a[208:211], a[176:179], v[224:227]
 global_load_dwordx4 a[200:203], v0, s[70:71] offset:2048 sc1
 v_lshlrev_b32 v6, 16, v5
 v_mfma_f32_16x16x32_bf16 v[220:223], a[208:211], a[168:171], v[220:223]
 v_and_b32 v5, s26, v5
 v_mul_f32 v6, v6, v30
 s_add_u32 s70, s70, 8192
 s_addc_u32 s71, s71, 0
 v_mfma_f32_16x16x32_bf16 v[220:223], a[212:215], a[172:175], v[220:223]
 v_mul_f32 v5, v5, v31
 v_cvt_pk_bf16_f32 v9, v6, v5
 s_waitcnt lgkmcnt(1)
 s_add_u32 s3, s28, 65536
 v_mfma_f32_16x16x32_bf16 v[216:219], a[212:215], a[164:167], v[216:219]
 buffer_store_dwordx4 v[48:51], v16, s[16:19], s3 offen nt
 s_waitcnt lgkmcnt(0)
 s_add_u32 s3, s28, 81920
 buffer_store_dwordx4 v[80:83], v16, s[16:19], s3 offen nt
 v_accvgpr_read_b32 v5, a14
 v_lshlrev_b32 v6, 16, v5
 v_mfma_f32_16x16x32_bf16 v[216:219], a[208:211], a[160:163], v[216:219]
 v_and_b32 v5, s26, v5
 v_mul_f32 v6, v6, v60
 v_mfma_f32_16x16x32_bf16 v[212:215], a[208:211], a[152:155], v[212:215]
 v_mul_f32 v5, v5, v61
 v_cvt_pk_bf16_f32 v10, v6, v5
 v_mfma_f32_16x16x32_bf16 v[212:215], a[212:215], a[156:159], v[212:215]
 v_accvgpr_read_b32 v5, a15
 v_lshlrev_b32 v6, 16, v5
 v_mfma_f32_16x16x32_bf16 v[208:211], a[212:215], a[148:151], v[208:211]
 v_and_b32 v5, s26, v5
 v_mul_f32 v6, v6, v62
 v_mfma_f32_16x16x32_bf16 v[208:211], a[208:211], a[144:147], v[208:211]
 v_mul_f32 v5, v5, v63
 v_cvt_pk_bf16_f32 v11, v6, v5
 v_mfma_f32_16x16x32_bf16 v[204:207], a[208:211], a[136:139], v[204:207]
 ds_write_b128 v17, v[8:11] offset:12288
 v_mfma_f32_16x16x32_bf16 v[204:207], a[212:215], a[140:143], v[204:207]
 v_accvgpr_read_b32 v5, a44
 v_lshlrev_b32 v6, 16, v5
 v_mfma_f32_16x16x32_bf16 v[200:203], a[212:215], a[132:135], v[200:203]
 v_and_b32 v5, s26, v5
 v_mul_f32 v6, v6, v92
 v_mfma_f32_16x16x32_bf16 v[200:203], a[208:211], a[128:131], v[200:203]
 v_mul_f32 v5, v5, v93
 v_cvt_pk_bf16_f32 v12, v6, v5
 s_waitcnt vmcnt(14)
 v_mfma_f32_16x16x32_bf16 v[232:235], a[216:219], a[128:131], v[232:235]
 ds_read_b128 a[128:131], v1 offset:34816
 v_accvgpr_read_b32 v5, a45
 v_mfma_f32_16x16x32_bf16 v[232:235], a[220:223], a[132:135], v[232:235]
 global_load_dwordx4 a[212:215], v0, s[70:71] offset:-3072 sc1
 ds_read_b128 a[132:135], v1 offset:35840
 v_mfma_f32_16x16x32_bf16 v[236:239], a[220:223], a[140:143], v[236:239]
 ds_read_b128 a[140:143], v1 offset:39936
 v_lshlrev_b32 v6, 16, v5
 v_mfma_f32_16x16x32_bf16 v[236:239], a[216:219], a[136:139], v[236:239]
 global_load_dwordx4 a[208:211], v0, s[70:71] offset:-4096 sc1
 ds_read_b128 a[136:139], v1 offset:38912
 v_and_b32 v5, s26, v5
 v_mfma_f32_16x16x32_bf16 v[240:243], a[216:219], a[144:147], v[240:243]
 ds_read_b128 a[144:147], v1 offset:43008
 v_mul_f32 v6, v6, v94
 v_mul_f32 v5, v5, v95
 v_mfma_f32_16x16x32_bf16 v[240:243], a[220:223], a[148:151], v[240:243]
 ds_read_b128 a[148:151], v1 offset:44032
 v_cvt_pk_bf16_f32 v13, v6, v5
 v_mfma_f32_16x16x32_bf16 v[244:247], a[220:223], a[156:159], v[244:247]
 ds_read_b128 a[156:159], v1 offset:48128
 v_accvgpr_read_b32 v5, a46
 v_lshlrev_b32 v6, 16, v5
 v_mfma_f32_16x16x32_bf16 v[244:247], a[216:219], a[152:155], v[244:247]
 ds_read_b128 a[152:155], v1 offset:47104
 v_and_b32 v5, s26, v5
 v_mul_f32 v6, v6, v124
 v_mfma_f32_16x16x32_bf16 v[248:251], a[216:219], a[160:163], v[248:251]
 ds_read_b128 a[160:163], v1 offset:51200
 v_mul_f32 v5, v5, v125
 v_mfma_f32_16x16x32_bf16 v[248:251], a[220:223], a[164:167], v[248:251]
 ds_read_b128 a[164:167], v1 offset:52224
 v_cvt_pk_bf16_f32 v14, v6, v5
 v_mfma_f32_16x16x32_bf16 v[252:255], a[220:223], a[172:175], v[252:255]
 ds_read_b128 a[172:175], v1 offset:56320
 v_accvgpr_read_b32 v5, a47
 v_mfma_f32_16x16x32_bf16 v[252:255], a[216:219], a[168:171], v[252:255]
 ds_read_b128 a[168:171], v1 offset:55296
 v_lshlrev_b32 v6, 16, v5
 v_mfma_f32_16x16x32_bf16 a[248:251], a[216:219], a[176:179], a[248:251]
 ds_read_b128 a[176:179], v1 offset:59392
 v_and_b32 v5, s26, v5
 v_mfma_f32_16x16x32_bf16 a[248:251], a[220:223], a[180:183], a[248:251]
 ds_read_b128 a[180:183], v1 offset:60416
 v_mul_f32 v6, v6, v126
 v_mfma_f32_16x16x32_bf16 a[252:255], a[220:223], a[188:191], a[252:255]
 ds_read_b128 a[188:191], v1 offset:64512
 v_mul_f32 v5, v5, v127
 v_mfma_f32_16x16x32_bf16 a[252:255], a[216:219], a[184:187], a[252:255]
 ds_read_b128 a[184:187], v1 offset:63488
 v_cvt_pk_bf16_f32 v15, v6, v5
 s_waitcnt vmcnt(12) lgkmcnt(8)
 v_mfma_f32_16x16x32_bf16 v[136:139], a[224:227], a[128:131], v[136:139]
 ds_write_b128 v18, v[12:15] offset:12288
 ds_read_b128 v[48:51], v3 offset:12288
 ds_read_b128 v[80:83], v3 offset:13312
 v_accvgpr_read_b32 v5, a16
 v_lshlrev_b32 v6, 16, v5
 v_mfma_f32_16x16x32_bf16 v[136:139], a[228:231], a[132:135], v[136:139]
 global_load_dwordx4 a[220:223], v0, s[70:71] offset:-1024 sc1
 v_and_b32 v5, s26, v5
 v_mfma_f32_16x16x32_bf16 v[140:143], a[228:231], a[140:143], v[140:143]
 v_mul_f32 v6, v6, v32
 v_mul_f32 v5, v5, v33
 v_mfma_f32_16x16x32_bf16 v[140:143], a[224:227], a[136:139], v[140:143]
 global_load_dwordx4 a[216:219], v0, s[70:71] offset:-2048 sc1
 v_cvt_pk_bf16_f32 v8, v6, v5
 v_mfma_f32_16x16x32_bf16 v[144:147], a[224:227], a[144:147], v[144:147]
 v_accvgpr_read_b32 v5, a17
 v_lshlrev_b32 v6, 16, v5
 v_mfma_f32_16x16x32_bf16 v[144:147], a[228:231], a[148:151], v[144:147]
 v_and_b32 v5, s26, v5
 v_mul_f32 v6, v6, v34
 v_mfma_f32_16x16x32_bf16 v[148:151], a[228:231], a[156:159], v[148:151]
 v_mul_f32 v5, v5, v35
 v_cvt_pk_bf16_f32 v9, v6, v5
 s_waitcnt lgkmcnt(1)
 s_add_u32 s3, s28, 98304
 v_mfma_f32_16x16x32_bf16 v[148:151], a[224:227], a[152:155], v[148:151]
 buffer_store_dwordx4 v[48:51], v16, s[16:19], s3 offen nt
 s_waitcnt lgkmcnt(0)
 s_add_u32 s3, s28, 114688
 buffer_store_dwordx4 v[80:83], v16, s[16:19], s3 offen nt
 v_accvgpr_read_b32 v5, a18
 v_lshlrev_b32 v6, 16, v5
 v_mfma_f32_16x16x32_bf16 v[152:155], a[224:227], a[160:163], v[152:155]
 v_and_b32 v5, s26, v5
 v_mul_f32 v6, v6, v64
 v_mfma_f32_16x16x32_bf16 v[152:155], a[228:231], a[164:167], v[152:155]
 v_mul_f32 v5, v5, v65
 v_cvt_pk_bf16_f32 v10, v6, v5
 v_mfma_f32_16x16x32_bf16 v[156:159], a[228:231], a[172:175], v[156:159]
 v_accvgpr_read_b32 v5, a19
 v_lshlrev_b32 v6, 16, v5
 v_mfma_f32_16x16x32_bf16 v[156:159], a[224:227], a[168:171], v[156:159]
 v_and_b32 v5, s26, v5
 v_mul_f32 v6, v6, v66
 v_mfma_f32_16x16x32_bf16 v[160:163], a[224:227], a[176:179], v[160:163]
 v_mul_f32 v5, v5, v67
 v_cvt_pk_bf16_f32 v11, v6, v5
 v_mfma_f32_16x16x32_bf16 v[160:163], a[228:231], a[180:183], v[160:163]
 ds_write_b128 v17, v[8:11] offset:16384
 v_mfma_f32_16x16x32_bf16 v[164:167], a[228:231], a[188:191], v[164:167]
 v_accvgpr_read_b32 v5, a48
 v_lshlrev_b32 v6, 16, v5
 v_mfma_f32_16x16x32_bf16 v[164:167], a[224:227], a[184:187], v[164:167]
 v_and_b32 v5, s26, v5
 v_mul_f32 v6, v6, v96
 s_waitcnt vmcnt(14)
 v_mfma_f32_16x16x32_bf16 v[196:199], a[232:235], a[184:187], v[196:199]
 v_mul_f32 v5, v5, v97
 v_cvt_pk_bf16_f32 v12, v6, v5
 v_mfma_f32_16x16x32_bf16 v[196:199], a[236:239], a[188:191], v[196:199]
 global_load_dwordx4 a[228:231], v0, s[70:71] offset:1024 sc1
 v_accvgpr_read_b32 v5, a49
 v_mfma_f32_16x16x32_bf16 v[192:195], a[236:239], a[180:183], v[192:195]
 v_lshlrev_b32 v6, 16, v5
 v_and_b32 v5, s26, v5
 v_mfma_f32_16x16x32_bf16 v[192:195], a[232:235], a[176:179], v[192:195]
 global_load_dwordx4 a[224:227], v0, s[70:71] offset:0 sc1
 v_mul_f32 v6, v6, v98
 v_mfma_f32_16x16x32_bf16 v[188:191], a[232:235], a[168:171], v[188:191]
 v_mul_f32 v5, v5, v99
 v_cvt_pk_bf16_f32 v13, v6, v5
 v_mfma_f32_16x16x32_bf16 v[188:191], a[236:239], a[172:175], v[188:191]
 v_accvgpr_read_b32 v5, a50
 v_lshlrev_b32 v6, 16, v5
 v_mfma_f32_16x16x32_bf16 v[184:187], a[236:239], a[164:167], v[184:187]
 v_and_b32 v5, s26, v5
 v_mul_f32 v6, v6, v128
 v_mfma_f32_16x16x32_bf16 v[184:187], a[232:235], a[160:163], v[184:187]
 v_mul_f32 v5, v5, v129
 v_cvt_pk_bf16_f32 v14, v6, v5
 v_mfma_f32_16x16x32_bf16 v[180:183], a[232:235], a[152:155], v[180:183]
 v_accvgpr_read_b32 v5, a51
 v_lshlrev_b32 v6, 16, v5
 v_mfma_f32_16x16x32_bf16 v[180:183], a[236:239], a[156:159], v[180:183]
 v_and_b32 v5, s26, v5
 v_mul_f32 v6, v6, v130
 v_mfma_f32_16x16x32_bf16 v[176:179], a[236:239], a[148:151], v[176:179]
 v_mul_f32 v5, v5, v131
 v_cvt_pk_bf16_f32 v15, v6, v5
 v_mfma_f32_16x16x32_bf16 v[176:179], a[232:235], a[144:147], v[176:179]
 ds_write_b128 v18, v[12:15] offset:16384
 v_mfma_f32_16x16x32_bf16 v[172:175], a[232:235], a[136:139], v[172:175]
 ds_read_b128 v[48:51], v3 offset:16384
 ds_read_b128 v[80:83], v3 offset:17408
 v_mfma_f32_16x16x32_bf16 v[172:175], a[236:239], a[140:143], v[172:175]
 v_accvgpr_read_b32 v5, a20
 v_lshlrev_b32 v6, 16, v5
 v_mfma_f32_16x16x32_bf16 v[168:171], a[236:239], a[132:135], v[168:171]
 v_and_b32 v5, s26, v5
 v_mul_f32 v6, v6, v36
 v_mfma_f32_16x16x32_bf16 v[168:171], a[232:235], a[128:131], v[168:171]
 v_mul_f32 v5, v5, v37
 v_cvt_pk_bf16_f32 v8, v6, v5
 s_waitcnt vmcnt(12)
 v_mfma_f32_16x16x32_bf16 v[200:203], a[192:195], a[128:131], v[200:203]
 v_accvgpr_read_b32 v5, a21
 v_lshlrev_b32 v6, 16, v5
 v_mfma_f32_16x16x32_bf16 v[200:203], a[196:199], a[132:135], v[200:203]
 global_load_dwordx4 a[236:239], v0, s[70:71] offset:3072 sc1
 v_and_b32 v5, s26, v5
 v_mfma_f32_16x16x32_bf16 v[204:207], a[196:199], a[140:143], v[204:207]
 v_mul_f32 v6, v6, v38
 v_mul_f32 v5, v5, v39
 v_mfma_f32_16x16x32_bf16 v[204:207], a[192:195], a[136:139], v[204:207]
 global_load_dwordx4 a[232:235], v0, s[70:71] offset:2048 sc1
 v_cvt_pk_bf16_f32 v9, v6, v5
 s_waitcnt lgkmcnt(1)
 s_add_u32 s3, s28, 131072
 v_mfma_f32_16x16x32_bf16 v[208:211], a[192:195], a[144:147], v[208:211]
 buffer_store_dwordx4 v[48:51], v16, s[16:19], s3 offen nt
 s_waitcnt lgkmcnt(0)
 s_add_u32 s3, s28, 147456
 buffer_store_dwordx4 v[80:83], v16, s[16:19], s3 offen nt
 v_accvgpr_read_b32 v5, a22
 v_lshlrev_b32 v6, 16, v5
 s_add_u32 s70, s70, 1843200
 s_addc_u32 s71, s71, 0
 v_mfma_f32_16x16x32_bf16 v[208:211], a[196:199], a[148:151], v[208:211]
 v_and_b32 v5, s26, v5
 v_mul_f32 v6, v6, v68
 v_mfma_f32_16x16x32_bf16 v[212:215], a[196:199], a[156:159], v[212:215]
 v_mul_f32 v5, v5, v69
 v_cvt_pk_bf16_f32 v10, v6, v5
 v_mfma_f32_16x16x32_bf16 v[212:215], a[192:195], a[152:155], v[212:215]
 v_accvgpr_read_b32 v5, a23
 v_lshlrev_b32 v6, 16, v5
 v_mfma_f32_16x16x32_bf16 v[216:219], a[192:195], a[160:163], v[216:219]
 v_and_b32 v5, s26, v5
 v_mul_f32 v6, v6, v70
 v_mfma_f32_16x16x32_bf16 v[216:219], a[196:199], a[164:167], v[216:219]
 v_mul_f32 v5, v5, v71
 v_cvt_pk_bf16_f32 v11, v6, v5
 v_mfma_f32_16x16x32_bf16 v[220:223], a[196:199], a[172:175], v[220:223]
 ds_write_b128 v17, v[8:11] offset:20480
 v_mfma_f32_16x16x32_bf16 v[220:223], a[192:195], a[168:171], v[220:223]
 v_accvgpr_read_b32 v5, a52
 v_lshlrev_b32 v6, 16, v5
 v_mfma_f32_16x16x32_bf16 v[224:227], a[192:195], a[176:179], v[224:227]
 v_and_b32 v5, s26, v5
 v_mul_f32 v6, v6, v100
 v_mfma_f32_16x16x32_bf16 v[224:227], a[196:199], a[180:183], v[224:227]
 v_mul_f32 v5, v5, v101
 v_cvt_pk_bf16_f32 v12, v6, v5
 v_mfma_f32_16x16x32_bf16 v[228:231], a[196:199], a[188:191], v[228:231]
 v_accvgpr_read_b32 v5, a53
 v_lshlrev_b32 v6, 16, v5
 v_mfma_f32_16x16x32_bf16 v[228:231], a[192:195], a[184:187], v[228:231]
 v_and_b32 v5, s26, v5
 v_mul_f32 v6, v6, v102
 s_waitcnt vmcnt(14)
 v_mfma_f32_16x16x32_bf16 a[252:255], a[200:203], a[184:187], a[252:255]
 ds_read_b128 a[184:187], v1 offset:30720
 v_mul_f32 v5, v5, v103
 v_mfma_f32_16x16x32_bf16 a[252:255], a[204:207], a[188:191], a[252:255]
 ds_read_b128 a[188:191], v1 offset:31744
 v_cvt_pk_bf16_f32 v13, v6, v5
 v_mfma_f32_16x16x32_bf16 a[248:251], a[204:207], a[180:183], a[248:251]
 ds_read_b128 a[180:183], v1 offset:27648
 v_accvgpr_read_b32 v5, a54
 v_mfma_f32_16x16x32_bf16 a[248:251], a[200:203], a[176:179], a[248:251]
 ds_read_b128 a[176:179], v1 offset:26624
 v_lshlrev_b32 v6, 16, v5
 v_mfma_f32_16x16x32_bf16 v[252:255], a[200:203], a[168:171], v[252:255]
 ds_read_b128 a[168:171], v1 offset:22528
 v_and_b32 v5, s26, v5
 v_mfma_f32_16x16x32_bf16 v[252:255], a[204:207], a[172:175], v[252:255]
 ds_read_b128 a[172:175], v1 offset:23552
 v_mul_f32 v6, v6, v132
 v_mfma_f32_16x16x32_bf16 v[248:251], a[204:207], a[164:167], v[248:251]
 ds_read_b128 a[164:167], v1 offset:19456
 v_mul_f32 v5, v5, v133
 v_mfma_f32_16x16x32_bf16 v[248:251], a[200:203], a[160:163], v[248:251]
 ds_read_b128 a[160:163], v1 offset:18432
 v_cvt_pk_bf16_f32 v14, v6, v5
 v_mfma_f32_16x16x32_bf16 v[244:247], a[200:203], a[152:155], v[244:247]
 ds_read_b128 a[152:155], v1 offset:14336
 v_accvgpr_read_b32 v5, a55
 v_mfma_f32_16x16x32_bf16 v[244:247], a[204:207], a[156:159], v[244:247]
 ds_read_b128 a[156:159], v1 offset:15360
 v_lshlrev_b32 v6, 16, v5
 v_mfma_f32_16x16x32_bf16 v[240:243], a[204:207], a[148:151], v[240:243]
 ds_read_b128 a[148:151], v1 offset:11264
 v_and_b32 v5, s26, v5
 v_mfma_f32_16x16x32_bf16 v[240:243], a[200:203], a[144:147], v[240:243]
 ds_read_b128 a[144:147], v1 offset:10240
 v_mul_f32 v6, v6, v134
 v_mfma_f32_16x16x32_bf16 v[236:239], a[200:203], a[136:139], v[236:239]
 ds_read_b128 a[136:139], v1 offset:6144
 v_mul_f32 v5, v5, v135
 v_mfma_f32_16x16x32_bf16 v[236:239], a[204:207], a[140:143], v[236:239]
 ds_read_b128 a[140:143], v1 offset:7168
 v_cvt_pk_bf16_f32 v15, v6, v5
 v_mfma_f32_16x16x32_bf16 v[232:235], a[204:207], a[132:135], v[232:235]
 ds_read_b128 a[132:135], v1 offset:3072
 v_mfma_f32_16x16x32_bf16 v[232:235], a[200:203], a[128:131], v[232:235]
 ds_read_b128 a[128:131], v1 offset:2048
 ds_write_b128 v18, v[12:15] offset:20480
 ds_read_b128 v[48:51], v3 offset:20480
 ds_read_b128 v[80:83], v3 offset:21504
 v_accvgpr_read_b32 v5, a24
 v_lshlrev_b32 v6, 16, v5
 s_waitcnt vmcnt(10) lgkmcnt(11)
 v_mfma_f32_16x16x32_bf16 v[164:167], a[208:211], a[184:187], v[164:167]
 v_and_b32 v5, s26, v5
 v_mul_f32 v6, v6, v40
 v_mfma_f32_16x16x32_bf16 v[164:167], a[212:215], a[188:191], v[164:167]
 v_mul_f32 v5, v5, v41
 v_cvt_pk_bf16_f32 v8, v6, v5
 v_mfma_f32_16x16x32_bf16 v[160:163], a[212:215], a[180:183], v[160:163]
 v_accvgpr_read_b32 v5, a25
 v_lshlrev_b32 v6, 16, v5
 v_mfma_f32_16x16x32_bf16 v[160:163], a[208:211], a[176:179], v[160:163]
 v_and_b32 v5, s26, v5
 v_mul_f32 v6, v6, v42
 v_mfma_f32_16x16x32_bf16 v[156:159], a[208:211], a[168:171], v[156:159]
 v_mul_f32 v5, v5, v43
 v_cvt_pk_bf16_f32 v9, v6, v5
 s_waitcnt lgkmcnt(1)
 s_add_u32 s3, s28, 163840
 v_mfma_f32_16x16x32_bf16 v[156:159], a[212:215], a[172:175], v[156:159]
 buffer_store_dwordx4 v[48:51], v16, s[16:19], s3 offen nt
 s_waitcnt lgkmcnt(0)
 s_add_u32 s3, s28, 180224
 buffer_store_dwordx4 v[80:83], v16, s[16:19], s3 offen nt
 v_accvgpr_read_b32 v5, a26
 v_lshlrev_b32 v6, 16, v5
 v_and_b32 v5, s26, v5
 v_mfma_f32_16x16x32_bf16 v[152:155], a[212:215], a[164:167], v[152:155]
 v_mul_f32 v6, v6, v72
 v_mul_f32 v5, v5, v73
 v_mfma_f32_16x16x32_bf16 v[152:155], a[208:211], a[160:163], v[152:155]
 v_cvt_pk_bf16_f32 v10, v6, v5
 v_accvgpr_read_b32 v5, a27
 v_mfma_f32_16x16x32_bf16 v[148:151], a[208:211], a[152:155], v[148:151]
 v_lshlrev_b32 v6, 16, v5
 v_and_b32 v5, s26, v5
 v_mfma_f32_16x16x32_bf16 v[148:151], a[212:215], a[156:159], v[148:151]
 v_mul_f32 v6, v6, v74
 v_mul_f32 v5, v5, v75
 v_mfma_f32_16x16x32_bf16 v[144:147], a[212:215], a[148:151], v[144:147]
 v_cvt_pk_bf16_f32 v11, v6, v5
 v_mfma_f32_16x16x32_bf16 v[144:147], a[208:211], a[144:147], v[144:147]
 ds_write_b128 v17, v[8:11] offset:24576
 v_mfma_f32_16x16x32_bf16 v[140:143], a[208:211], a[136:139], v[140:143]
 v_accvgpr_read_b32 v5, a56
 v_lshlrev_b32 v6, 16, v5
 v_mfma_f32_16x16x32_bf16 v[140:143], a[212:215], a[140:143], v[140:143]
 v_and_b32 v5, s26, v5
 v_mul_f32 v6, v6, v104
 v_mfma_f32_16x16x32_bf16 v[136:139], a[212:215], a[132:135], v[136:139]
 v_mul_f32 v5, v5, v105
 v_cvt_pk_bf16_f32 v12, v6, v5
 v_mfma_f32_16x16x32_bf16 v[136:139], a[208:211], a[128:131], v[136:139]
 v_accvgpr_read_b32 v5, a57
 v_lshlrev_b32 v6, 16, v5
 s_waitcnt vmcnt(10)
 v_mfma_f32_16x16x32_bf16 v[168:171], a[216:219], a[128:131], v[168:171]
 v_and_b32 v5, s26, v5
 v_mul_f32 v6, v6, v106
 v_mfma_f32_16x16x32_bf16 v[168:171], a[220:223], a[132:135], v[168:171]
 v_mul_f32 v5, v5, v107
 v_cvt_pk_bf16_f32 v13, v6, v5
 v_mfma_f32_16x16x32_bf16 v[172:175], a[220:223], a[140:143], v[172:175]
 v_accvgpr_read_b32 v5, a58
 v_accvgpr_read_b32 v7, a240
 v_mfma_f32_16x16x32_bf16 v[172:175], a[216:219], a[136:139], v[172:175]
 v_lshlrev_b32 v6, 16, v5
 v_and_b32 v5, s26, v5
 v_mfma_f32_16x16x32_bf16 v[176:179], a[216:219], a[144:147], v[176:179]
 v_mul_f32 v6, v6, v7
 v_accvgpr_read_b32 v7, a241
 v_mfma_f32_16x16x32_bf16 v[176:179], a[220:223], a[148:151], v[176:179]
 v_mul_f32 v5, v5, v7
 v_cvt_pk_bf16_f32 v14, v6, v5
 v_mfma_f32_16x16x32_bf16 v[180:183], a[220:223], a[156:159], v[180:183]
 v_accvgpr_read_b32 v5, a59
 v_accvgpr_read_b32 v7, a242
 v_mfma_f32_16x16x32_bf16 v[180:183], a[216:219], a[152:155], v[180:183]
 v_lshlrev_b32 v6, 16, v5
 v_and_b32 v5, s26, v5
 v_mfma_f32_16x16x32_bf16 v[184:187], a[216:219], a[160:163], v[184:187]
 v_mul_f32 v6, v6, v7
 v_accvgpr_read_b32 v7, a243
 v_mfma_f32_16x16x32_bf16 v[184:187], a[220:223], a[164:167], v[184:187]
 v_mul_f32 v5, v5, v7
 v_cvt_pk_bf16_f32 v15, v6, v5
 v_mfma_f32_16x16x32_bf16 v[188:191], a[220:223], a[172:175], v[188:191]
 ds_write_b128 v18, v[12:15] offset:24576
 v_mfma_f32_16x16x32_bf16 v[188:191], a[216:219], a[168:171], v[188:191]
 ds_read_b128 v[48:51], v3 offset:24576
 ds_read_b128 v[80:83], v3 offset:25600
 v_mfma_f32_16x16x32_bf16 v[192:195], a[216:219], a[176:179], v[192:195]
 v_accvgpr_read_b32 v5, a28
 v_lshlrev_b32 v6, 16, v5
 v_mfma_f32_16x16x32_bf16 v[192:195], a[220:223], a[180:183], v[192:195]
 v_and_b32 v5, s26, v5
 v_mul_f32 v6, v6, v44
 v_mfma_f32_16x16x32_bf16 v[196:199], a[220:223], a[188:191], v[196:199]
 v_mul_f32 v5, v5, v45
 v_cvt_pk_bf16_f32 v8, v6, v5
 v_mfma_f32_16x16x32_bf16 v[196:199], a[216:219], a[184:187], v[196:199]
 v_accvgpr_read_b32 v5, a29
 v_lshlrev_b32 v6, 16, v5
 s_waitcnt vmcnt(6)
 v_mfma_f32_16x16x32_bf16 v[228:231], a[224:227], a[184:187], v[228:231]
 v_and_b32 v5, s26, v5
 v_mul_f32 v6, v6, v46
 v_mfma_f32_16x16x32_bf16 v[228:231], a[228:231], a[188:191], v[228:231]
 v_mul_f32 v5, v5, v47
 v_cvt_pk_bf16_f32 v9, v6, v5
 s_waitcnt lgkmcnt(1)
 v_mfma_f32_16x16x32_bf16 v[224:227], a[228:231], a[180:183], v[224:227]
 s_add_u32 s3, s28, 196608
 buffer_store_dwordx4 v[48:51], v16, s[16:19], s3 offen nt
 v_mfma_f32_16x16x32_bf16 v[224:227], a[224:227], a[176:179], v[224:227]
 s_waitcnt lgkmcnt(0)
 s_add_u32 s3, s28, 212992
 v_mfma_f32_16x16x32_bf16 v[220:223], a[224:227], a[168:171], v[220:223]
 buffer_store_dwordx4 v[80:83], v16, s[16:19], s3 offen nt
 v_accvgpr_read_b32 v5, a30
 v_mfma_f32_16x16x32_bf16 v[220:223], a[228:231], a[172:175], v[220:223]
 v_lshlrev_b32 v6, 16, v5
 v_mfma_f32_16x16x32_bf16 v[216:219], a[228:231], a[164:167], v[216:219]
 v_and_b32 v5, s26, v5
 v_mul_f32 v6, v6, v76
 v_mfma_f32_16x16x32_bf16 v[216:219], a[224:227], a[160:163], v[216:219]
 v_mul_f32 v5, v5, v77
 v_cvt_pk_bf16_f32 v10, v6, v5
 v_mfma_f32_16x16x32_bf16 v[212:215], a[224:227], a[152:155], v[212:215]
 v_accvgpr_read_b32 v5, a31
 v_lshlrev_b32 v6, 16, v5
 v_mfma_f32_16x16x32_bf16 v[212:215], a[228:231], a[156:159], v[212:215]
 v_and_b32 v5, s26, v5
 v_mul_f32 v6, v6, v78
 v_mfma_f32_16x16x32_bf16 v[208:211], a[228:231], a[148:151], v[208:211]
 v_mul_f32 v5, v5, v79
 v_cvt_pk_bf16_f32 v11, v6, v5
 v_mfma_f32_16x16x32_bf16 v[208:211], a[224:227], a[144:147], v[208:211]
 ds_write_b128 v17, v[8:11] offset:28672
 v_mfma_f32_16x16x32_bf16 v[204:207], a[224:227], a[136:139], v[204:207]
 v_accvgpr_read_b32 v5, a60
 v_lshlrev_b32 v6, 16, v5
 v_mfma_f32_16x16x32_bf16 v[204:207], a[228:231], a[140:143], v[204:207]
 v_and_b32 v5, s26, v5
 v_mul_f32 v6, v6, v108
 v_mfma_f32_16x16x32_bf16 v[200:203], a[228:231], a[132:135], v[200:203]
 v_mul_f32 v5, v5, v109
 v_cvt_pk_bf16_f32 v12, v6, v5
 v_mfma_f32_16x16x32_bf16 v[200:203], a[224:227], a[128:131], v[200:203]
 v_accvgpr_read_b32 v5, a61
 v_lshlrev_b32 v6, 16, v5
 s_waitcnt vmcnt(6)
 v_mfma_f32_16x16x32_bf16 v[232:235], a[232:235], a[128:131], v[232:235]
 v_and_b32 v5, s26, v5
 v_mul_f32 v6, v6, v110
 v_mfma_f32_16x16x32_bf16 v[232:235], a[236:239], a[132:135], v[232:235]
 v_mul_f32 v5, v5, v111
 v_cvt_pk_bf16_f32 v13, v6, v5
 v_mfma_f32_16x16x32_bf16 v[236:239], a[236:239], a[140:143], v[236:239]
 v_accvgpr_read_b32 v5, a62
 v_accvgpr_read_b32 v7, a244
 v_mfma_f32_16x16x32_bf16 v[236:239], a[232:235], a[136:139], v[236:239]
 v_lshlrev_b32 v6, 16, v5
 v_and_b32 v5, s26, v5
 v_mfma_f32_16x16x32_bf16 v[240:243], a[232:235], a[144:147], v[240:243]
 v_mul_f32 v6, v6, v7
 v_accvgpr_read_b32 v7, a245
 v_mfma_f32_16x16x32_bf16 v[240:243], a[236:239], a[148:151], v[240:243]
 v_mul_f32 v5, v5, v7
 v_cvt_pk_bf16_f32 v14, v6, v5
 v_mfma_f32_16x16x32_bf16 v[244:247], a[236:239], a[156:159], v[244:247]
 v_accvgpr_read_b32 v5, a63
 v_accvgpr_read_b32 v7, a246
 v_mfma_f32_16x16x32_bf16 v[244:247], a[232:235], a[152:155], v[244:247]
 v_lshlrev_b32 v6, 16, v5
 v_and_b32 v5, s26, v5
 v_mfma_f32_16x16x32_bf16 v[248:251], a[232:235], a[160:163], v[248:251]
 v_mul_f32 v6, v6, v7
 v_accvgpr_read_b32 v7, a247
 v_mfma_f32_16x16x32_bf16 v[248:251], a[236:239], a[164:167], v[248:251]
 v_mul_f32 v5, v5, v7
 v_cvt_pk_bf16_f32 v15, v6, v5
 v_mfma_f32_16x16x32_bf16 v[252:255], a[236:239], a[172:175], v[252:255]
 ds_write_b128 v18, v[12:15] offset:28672
 v_mfma_f32_16x16x32_bf16 v[252:255], a[232:235], a[168:171], v[252:255]
 ds_read_b128 v[48:51], v3 offset:28672
 ds_read_b128 v[80:83], v3 offset:29696
 v_mfma_f32_16x16x32_bf16 a[248:251], a[232:235], a[176:179], a[248:251]
 s_waitcnt lgkmcnt(1)
 s_add_u32 s3, s28, 229376
 v_mfma_f32_16x16x32_bf16 a[248:251], a[236:239], a[180:183], a[248:251]
 buffer_store_dwordx4 v[48:51], v16, s[16:19], s3 offen nt
 s_waitcnt lgkmcnt(0)
 v_mfma_f32_16x16x32_bf16 a[252:255], a[236:239], a[188:191], a[252:255]
 s_add_u32 s3, s28, 245760
 buffer_store_dwordx4 v[80:83], v16, s[16:19], s3 offen nt
 v_mfma_f32_16x16x32_bf16 a[252:255], a[232:235], a[184:187], a[252:255]
 s_nop 7
 v_accvgpr_read_b32 v7, a64
 v_lshlrev_b32 v6, 16, v7
 v_and_b32 v7, s26, v7
 v_pk_mul_f32 v[6:7], v[6:7], v[136:137]
 v_cvt_pk_bf16_f32 v8, v6, v7
 v_accvgpr_read_b32 v7, a65
 v_lshlrev_b32 v6, 16, v7
 v_and_b32 v7, s26, v7
 v_pk_mul_f32 v[6:7], v[6:7], v[138:139]
 v_cvt_pk_bf16_f32 v9, v6, v7
 v_accvgpr_read_b32 v7, a66
 v_lshlrev_b32 v6, 16, v7
 v_and_b32 v7, s26, v7
 v_pk_mul_f32 v[6:7], v[6:7], v[168:169]
 v_cvt_pk_bf16_f32 v10, v6, v7
 v_accvgpr_read_b32 v7, a67
 v_lshlrev_b32 v6, 16, v7
 v_and_b32 v7, s26, v7
 v_pk_mul_f32 v[6:7], v[6:7], v[170:171]
 v_cvt_pk_bf16_f32 v11, v6, v7
 ds_write_b128 v17, v[8:11]
 v_accvgpr_read_b32 v7, a96
 v_lshlrev_b32 v6, 16, v7
 v_and_b32 v7, s26, v7
 v_pk_mul_f32 v[6:7], v[6:7], v[200:201]
 v_cvt_pk_bf16_f32 v12, v6, v7
 v_accvgpr_read_b32 v7, a97
 v_lshlrev_b32 v6, 16, v7
 v_and_b32 v7, s26, v7
 v_pk_mul_f32 v[6:7], v[6:7], v[202:203]
 v_cvt_pk_bf16_f32 v13, v6, v7
 v_accvgpr_read_b32 v7, a98
 v_lshlrev_b32 v6, 16, v7
 v_and_b32 v7, s26, v7
 v_pk_mul_f32 v[6:7], v[6:7], v[232:233]
 v_cvt_pk_bf16_f32 v14, v6, v7
 v_accvgpr_read_b32 v7, a99
 v_lshlrev_b32 v6, 16, v7
 v_and_b32 v7, s26, v7
 v_pk_mul_f32 v[6:7], v[6:7], v[234:235]
 v_cvt_pk_bf16_f32 v15, v6, v7
 ds_write_b128 v18, v[12:15]
 ds_read_b128 v[48:51], v3
 ds_read_b128 v[80:83], v3 offset:1024
 v_accvgpr_read_b32 v7, a68
 v_lshlrev_b32 v6, 16, v7
 v_and_b32 v7, s26, v7
 v_pk_mul_f32 v[6:7], v[6:7], v[140:141]
 v_cvt_pk_bf16_f32 v8, v6, v7
 v_accvgpr_read_b32 v7, a69
 v_lshlrev_b32 v6, 16, v7
 v_and_b32 v7, s26, v7
 v_pk_mul_f32 v[6:7], v[6:7], v[142:143]
 v_cvt_pk_bf16_f32 v9, v6, v7
 v_accvgpr_read_b32 v7, a70
 v_lshlrev_b32 v6, 16, v7
 s_waitcnt lgkmcnt(1)
 s_add_u32 s3, s28, 0
 buffer_store_dwordx4 v[48:51], v16, s[16:19], s3 offen offset:128 nt
 s_waitcnt lgkmcnt(0)
 s_add_u32 s3, s28, 16384
 buffer_store_dwordx4 v[80:83], v16, s[16:19], s3 offen offset:128 nt
 v_and_b32 v7, s26, v7
 v_pk_mul_f32 v[6:7], v[6:7], v[172:173]
 v_cvt_pk_bf16_f32 v10, v6, v7
 v_accvgpr_read_b32 v7, a71
 v_lshlrev_b32 v6, 16, v7
 v_and_b32 v7, s26, v7
 v_pk_mul_f32 v[6:7], v[6:7], v[174:175]
 v_cvt_pk_bf16_f32 v11, v6, v7
 ds_write_b128 v17, v[8:11] offset:4096
 v_accvgpr_read_b32 v7, a100
 v_lshlrev_b32 v6, 16, v7
 v_and_b32 v7, s26, v7
 v_pk_mul_f32 v[6:7], v[6:7], v[204:205]
 v_cvt_pk_bf16_f32 v12, v6, v7
 v_accvgpr_read_b32 v7, a101
 v_lshlrev_b32 v6, 16, v7
 v_and_b32 v7, s26, v7
 v_pk_mul_f32 v[6:7], v[6:7], v[206:207]
 v_cvt_pk_bf16_f32 v13, v6, v7
 v_accvgpr_read_b32 v7, a102
 v_lshlrev_b32 v6, 16, v7
 v_and_b32 v7, s26, v7
 v_pk_mul_f32 v[6:7], v[6:7], v[236:237]
 v_cvt_pk_bf16_f32 v14, v6, v7
 v_accvgpr_read_b32 v7, a103
 v_lshlrev_b32 v6, 16, v7
 v_and_b32 v7, s26, v7
 v_pk_mul_f32 v[6:7], v[6:7], v[238:239]
 v_cvt_pk_bf16_f32 v15, v6, v7
 ds_write_b128 v18, v[12:15] offset:4096
 ds_read_b128 v[48:51], v3 offset:4096
 ds_read_b128 v[80:83], v3 offset:5120
 v_accvgpr_read_b32 v7, a72
 v_lshlrev_b32 v6, 16, v7
 v_and_b32 v7, s26, v7
 v_pk_mul_f32 v[6:7], v[6:7], v[144:145]
 v_cvt_pk_bf16_f32 v8, v6, v7
 v_accvgpr_read_b32 v7, a73
 v_lshlrev_b32 v6, 16, v7
 v_and_b32 v7, s26, v7
 v_pk_mul_f32 v[6:7], v[6:7], v[146:147]
 v_cvt_pk_bf16_f32 v9, v6, v7
 v_accvgpr_read_b32 v7, a74
 v_lshlrev_b32 v6, 16, v7
 s_waitcnt lgkmcnt(1)
 s_add_u32 s3, s28, 32768
 buffer_store_dwordx4 v[48:51], v16, s[16:19], s3 offen offset:128 nt
 s_waitcnt lgkmcnt(0)
 s_add_u32 s3, s28, 49152
 buffer_store_dwordx4 v[80:83], v16, s[16:19], s3 offen offset:128 nt
 v_and_b32 v7, s26, v7
 v_pk_mul_f32 v[6:7], v[6:7], v[176:177]
 v_cvt_pk_bf16_f32 v10, v6, v7
 v_accvgpr_read_b32 v7, a75
 v_lshlrev_b32 v6, 16, v7
 v_and_b32 v7, s26, v7
 v_pk_mul_f32 v[6:7], v[6:7], v[178:179]
 v_cvt_pk_bf16_f32 v11, v6, v7
 ds_write_b128 v17, v[8:11] offset:8192
 v_accvgpr_read_b32 v7, a104
 v_lshlrev_b32 v6, 16, v7
 v_and_b32 v7, s26, v7
 v_pk_mul_f32 v[6:7], v[6:7], v[208:209]
 v_cvt_pk_bf16_f32 v12, v6, v7
 v_accvgpr_read_b32 v7, a105
 v_lshlrev_b32 v6, 16, v7
 v_and_b32 v7, s26, v7
 v_pk_mul_f32 v[6:7], v[6:7], v[210:211]
 v_cvt_pk_bf16_f32 v13, v6, v7
 v_accvgpr_read_b32 v7, a106
 v_lshlrev_b32 v6, 16, v7
 v_and_b32 v7, s26, v7
 v_pk_mul_f32 v[6:7], v[6:7], v[240:241]
 v_cvt_pk_bf16_f32 v14, v6, v7
 v_accvgpr_read_b32 v7, a107
 v_lshlrev_b32 v6, 16, v7
 v_and_b32 v7, s26, v7
 v_pk_mul_f32 v[6:7], v[6:7], v[242:243]
 v_cvt_pk_bf16_f32 v15, v6, v7
 ds_write_b128 v18, v[12:15] offset:8192
 ds_read_b128 v[48:51], v3 offset:8192
 ds_read_b128 v[80:83], v3 offset:9216
 v_accvgpr_read_b32 v7, a76
 v_lshlrev_b32 v6, 16, v7
 v_and_b32 v7, s26, v7
 v_pk_mul_f32 v[6:7], v[6:7], v[148:149]
 v_cvt_pk_bf16_f32 v8, v6, v7
 v_accvgpr_read_b32 v7, a77
 v_lshlrev_b32 v6, 16, v7
 v_and_b32 v7, s26, v7
 v_pk_mul_f32 v[6:7], v[6:7], v[150:151]
 v_cvt_pk_bf16_f32 v9, v6, v7
 v_accvgpr_read_b32 v7, a78
 v_lshlrev_b32 v6, 16, v7
 s_waitcnt lgkmcnt(1)
 s_add_u32 s3, s28, 65536
 buffer_store_dwordx4 v[48:51], v16, s[16:19], s3 offen offset:128 nt
 s_waitcnt lgkmcnt(0)
 s_add_u32 s3, s28, 81920
 buffer_store_dwordx4 v[80:83], v16, s[16:19], s3 offen offset:128 nt
 v_and_b32 v7, s26, v7
 v_pk_mul_f32 v[6:7], v[6:7], v[180:181]
 v_cvt_pk_bf16_f32 v10, v6, v7
 v_accvgpr_read_b32 v7, a79
 v_lshlrev_b32 v6, 16, v7
 v_and_b32 v7, s26, v7
 v_pk_mul_f32 v[6:7], v[6:7], v[182:183]
 v_cvt_pk_bf16_f32 v11, v6, v7
 ds_write_b128 v17, v[8:11] offset:12288
 v_accvgpr_read_b32 v7, a108
 v_lshlrev_b32 v6, 16, v7
 v_and_b32 v7, s26, v7
 v_pk_mul_f32 v[6:7], v[6:7], v[212:213]
 v_cvt_pk_bf16_f32 v12, v6, v7
 v_accvgpr_read_b32 v7, a109
 v_lshlrev_b32 v6, 16, v7
 v_and_b32 v7, s26, v7
 v_pk_mul_f32 v[6:7], v[6:7], v[214:215]
 v_cvt_pk_bf16_f32 v13, v6, v7
 v_accvgpr_read_b32 v7, a110
 v_lshlrev_b32 v6, 16, v7
 v_and_b32 v7, s26, v7
 v_pk_mul_f32 v[6:7], v[6:7], v[244:245]
 v_cvt_pk_bf16_f32 v14, v6, v7
 v_accvgpr_read_b32 v7, a111
 v_lshlrev_b32 v6, 16, v7
 v_and_b32 v7, s26, v7
 v_pk_mul_f32 v[6:7], v[6:7], v[246:247]
 v_cvt_pk_bf16_f32 v15, v6, v7
 ds_write_b128 v18, v[12:15] offset:12288
 ds_read_b128 v[48:51], v3 offset:12288
 ds_read_b128 v[80:83], v3 offset:13312
 v_accvgpr_read_b32 v7, a80
 v_lshlrev_b32 v6, 16, v7
 v_and_b32 v7, s26, v7
 v_pk_mul_f32 v[6:7], v[6:7], v[152:153]
 v_cvt_pk_bf16_f32 v8, v6, v7
 v_accvgpr_read_b32 v7, a81
 v_lshlrev_b32 v6, 16, v7
 v_and_b32 v7, s26, v7
 v_pk_mul_f32 v[6:7], v[6:7], v[154:155]
 v_cvt_pk_bf16_f32 v9, v6, v7
 v_accvgpr_read_b32 v7, a82
 v_lshlrev_b32 v6, 16, v7
 s_waitcnt lgkmcnt(1)
 s_add_u32 s3, s28, 98304
 buffer_store_dwordx4 v[48:51], v16, s[16:19], s3 offen offset:128 nt
 s_waitcnt lgkmcnt(0)
 s_add_u32 s3, s28, 114688
 buffer_store_dwordx4 v[80:83], v16, s[16:19], s3 offen offset:128 nt
 v_and_b32 v7, s26, v7
 v_pk_mul_f32 v[6:7], v[6:7], v[184:185]
 v_cvt_pk_bf16_f32 v10, v6, v7
 v_accvgpr_read_b32 v7, a83
 v_lshlrev_b32 v6, 16, v7
 v_and_b32 v7, s26, v7
 v_pk_mul_f32 v[6:7], v[6:7], v[186:187]
 v_cvt_pk_bf16_f32 v11, v6, v7
 ds_write_b128 v17, v[8:11] offset:16384
 v_accvgpr_read_b32 v7, a112
 v_lshlrev_b32 v6, 16, v7
 v_and_b32 v7, s26, v7
 v_pk_mul_f32 v[6:7], v[6:7], v[216:217]
 v_cvt_pk_bf16_f32 v12, v6, v7
 v_accvgpr_read_b32 v7, a113
 v_lshlrev_b32 v6, 16, v7
 v_and_b32 v7, s26, v7
 v_pk_mul_f32 v[6:7], v[6:7], v[218:219]
 v_cvt_pk_bf16_f32 v13, v6, v7
 v_accvgpr_read_b32 v7, a114
 v_lshlrev_b32 v6, 16, v7
 v_and_b32 v7, s26, v7
 v_pk_mul_f32 v[6:7], v[6:7], v[248:249]
 v_cvt_pk_bf16_f32 v14, v6, v7
 v_accvgpr_read_b32 v7, a115
 v_lshlrev_b32 v6, 16, v7
 v_and_b32 v7, s26, v7
 v_pk_mul_f32 v[6:7], v[6:7], v[250:251]
 v_cvt_pk_bf16_f32 v15, v6, v7
 ds_write_b128 v18, v[12:15] offset:16384
 ds_read_b128 v[48:51], v3 offset:16384
 ds_read_b128 v[80:83], v3 offset:17408
 v_accvgpr_read_b32 v7, a84
 v_lshlrev_b32 v6, 16, v7
 v_and_b32 v7, s26, v7
 v_pk_mul_f32 v[6:7], v[6:7], v[156:157]
 v_cvt_pk_bf16_f32 v8, v6, v7
 v_accvgpr_read_b32 v7, a85
 v_lshlrev_b32 v6, 16, v7
 v_and_b32 v7, s26, v7
 v_pk_mul_f32 v[6:7], v[6:7], v[158:159]
 v_cvt_pk_bf16_f32 v9, v6, v7
 v_accvgpr_read_b32 v7, a86
 v_lshlrev_b32 v6, 16, v7
 s_waitcnt lgkmcnt(1)
 s_add_u32 s3, s28, 131072
 buffer_store_dwordx4 v[48:51], v16, s[16:19], s3 offen offset:128 nt
 s_waitcnt lgkmcnt(0)
 s_add_u32 s3, s28, 147456
 buffer_store_dwordx4 v[80:83], v16, s[16:19], s3 offen offset:128 nt
 v_and_b32 v7, s26, v7
 v_pk_mul_f32 v[6:7], v[6:7], v[188:189]
 v_cvt_pk_bf16_f32 v10, v6, v7
 v_accvgpr_read_b32 v7, a87
 v_lshlrev_b32 v6, 16, v7
 v_and_b32 v7, s26, v7
 v_pk_mul_f32 v[6:7], v[6:7], v[190:191]
 v_cvt_pk_bf16_f32 v11, v6, v7
 ds_write_b128 v17, v[8:11] offset:20480
 v_accvgpr_read_b32 v7, a116
 v_lshlrev_b32 v6, 16, v7
 v_and_b32 v7, s26, v7
 v_pk_mul_f32 v[6:7], v[6:7], v[220:221]
 v_cvt_pk_bf16_f32 v12, v6, v7
 v_accvgpr_read_b32 v7, a117
 v_lshlrev_b32 v6, 16, v7
 v_and_b32 v7, s26, v7
 v_pk_mul_f32 v[6:7], v[6:7], v[222:223]
 v_cvt_pk_bf16_f32 v13, v6, v7
 v_accvgpr_read_b32 v7, a118
 v_lshlrev_b32 v6, 16, v7
 v_and_b32 v7, s26, v7
 v_pk_mul_f32 v[6:7], v[6:7], v[252:253]
 v_cvt_pk_bf16_f32 v14, v6, v7
 v_accvgpr_read_b32 v7, a119
 v_lshlrev_b32 v6, 16, v7
 v_and_b32 v7, s26, v7
 v_pk_mul_f32 v[6:7], v[6:7], v[254:255]
 v_cvt_pk_bf16_f32 v15, v6, v7
 ds_write_b128 v18, v[12:15] offset:20480
 ds_read_b128 v[48:51], v3 offset:20480
 ds_read_b128 v[80:83], v3 offset:21504
 v_accvgpr_read_b32 v7, a88
 v_lshlrev_b32 v6, 16, v7
 v_and_b32 v7, s26, v7
 v_pk_mul_f32 v[6:7], v[6:7], v[160:161]
 v_cvt_pk_bf16_f32 v8, v6, v7
 v_accvgpr_read_b32 v7, a89
 v_lshlrev_b32 v6, 16, v7
 v_and_b32 v7, s26, v7
 v_pk_mul_f32 v[6:7], v[6:7], v[162:163]
 v_cvt_pk_bf16_f32 v9, v6, v7
 v_accvgpr_read_b32 v7, a90
 v_lshlrev_b32 v6, 16, v7
 s_waitcnt lgkmcnt(1)
 s_add_u32 s3, s28, 163840
 buffer_store_dwordx4 v[48:51], v16, s[16:19], s3 offen offset:128 nt
 s_waitcnt lgkmcnt(0)
 s_add_u32 s3, s28, 180224
 buffer_store_dwordx4 v[80:83], v16, s[16:19], s3 offen offset:128 nt
 v_and_b32 v7, s26, v7
 v_pk_mul_f32 v[6:7], v[6:7], v[192:193]
 v_cvt_pk_bf16_f32 v10, v6, v7
 v_accvgpr_read_b32 v7, a91
 v_lshlrev_b32 v6, 16, v7
 v_and_b32 v7, s26, v7
 v_pk_mul_f32 v[6:7], v[6:7], v[194:195]
 v_cvt_pk_bf16_f32 v11, v6, v7
 ds_write_b128 v17, v[8:11] offset:24576
 v_accvgpr_read_b32 v7, a120
 v_lshlrev_b32 v6, 16, v7
 v_and_b32 v7, s26, v7
 v_pk_mul_f32 v[6:7], v[6:7], v[224:225]
 v_cvt_pk_bf16_f32 v12, v6, v7
 v_accvgpr_read_b32 v7, a121
 v_lshlrev_b32 v6, 16, v7
 v_and_b32 v7, s26, v7
 v_pk_mul_f32 v[6:7], v[6:7], v[226:227]
 v_cvt_pk_bf16_f32 v13, v6, v7
 v_accvgpr_read_b32 v7, a122
 v_accvgpr_read_b32 v112, a248
 v_accvgpr_read_b32 v113, a249
 v_lshlrev_b32 v6, 16, v7
 v_and_b32 v7, s26, v7
 v_pk_mul_f32 v[6:7], v[6:7], v[112:113]
 v_cvt_pk_bf16_f32 v14, v6, v7
 v_accvgpr_read_b32 v7, a123
 v_accvgpr_read_b32 v112, a250
 v_accvgpr_read_b32 v113, a251
 v_lshlrev_b32 v6, 16, v7
 v_and_b32 v7, s26, v7
 v_pk_mul_f32 v[6:7], v[6:7], v[112:113]
 v_cvt_pk_bf16_f32 v15, v6, v7
 ds_write_b128 v18, v[12:15] offset:24576
 ds_read_b128 v[48:51], v3 offset:24576
 ds_read_b128 v[80:83], v3 offset:25600
 v_accvgpr_read_b32 v7, a92
 v_lshlrev_b32 v6, 16, v7
 v_and_b32 v7, s26, v7
 v_pk_mul_f32 v[6:7], v[6:7], v[164:165]
 v_cvt_pk_bf16_f32 v8, v6, v7
 v_accvgpr_read_b32 v7, a93
 v_lshlrev_b32 v6, 16, v7
 v_and_b32 v7, s26, v7
 v_pk_mul_f32 v[6:7], v[6:7], v[166:167]
 v_cvt_pk_bf16_f32 v9, v6, v7
 v_accvgpr_read_b32 v7, a94
 v_lshlrev_b32 v6, 16, v7
 s_waitcnt lgkmcnt(1)
 s_add_u32 s3, s28, 196608
 buffer_store_dwordx4 v[48:51], v16, s[16:19], s3 offen offset:128 nt
 s_waitcnt lgkmcnt(0)
 s_add_u32 s3, s28, 212992
 buffer_store_dwordx4 v[80:83], v16, s[16:19], s3 offen offset:128 nt
 v_and_b32 v7, s26, v7
 v_pk_mul_f32 v[6:7], v[6:7], v[196:197]
 v_cvt_pk_bf16_f32 v10, v6, v7
 v_accvgpr_read_b32 v7, a95
 v_lshlrev_b32 v6, 16, v7
 v_and_b32 v7, s26, v7
 v_pk_mul_f32 v[6:7], v[6:7], v[198:199]
 v_cvt_pk_bf16_f32 v11, v6, v7
 ds_write_b128 v17, v[8:11] offset:28672
 v_accvgpr_read_b32 v7, a124
 v_lshlrev_b32 v6, 16, v7
 v_and_b32 v7, s26, v7
 v_pk_mul_f32 v[6:7], v[6:7], v[228:229]
 v_cvt_pk_bf16_f32 v12, v6, v7
 v_accvgpr_read_b32 v7, a125
 v_lshlrev_b32 v6, 16, v7
 v_and_b32 v7, s26, v7
 v_pk_mul_f32 v[6:7], v[6:7], v[230:231]
 v_cvt_pk_bf16_f32 v13, v6, v7
 v_accvgpr_read_b32 v7, a126
 v_accvgpr_read_b32 v112, a252
 v_accvgpr_read_b32 v113, a253
 v_lshlrev_b32 v6, 16, v7
 v_and_b32 v7, s26, v7
 v_pk_mul_f32 v[6:7], v[6:7], v[112:113]
 v_cvt_pk_bf16_f32 v14, v6, v7
 v_accvgpr_read_b32 v7, a127
 v_accvgpr_read_b32 v112, a254
 v_accvgpr_read_b32 v113, a255
 v_lshlrev_b32 v6, 16, v7
 v_and_b32 v7, s26, v7
 v_pk_mul_f32 v[6:7], v[6:7], v[112:113]
 v_cvt_pk_bf16_f32 v15, v6, v7
 ds_write_b128 v18, v[12:15] offset:28672
 ds_read_b128 v[48:51], v3 offset:28672
 ds_read_b128 v[80:83], v3 offset:29696
 s_waitcnt lgkmcnt(1)
 s_add_u32 s3, s28, 229376
 buffer_store_dwordx4 v[48:51], v16, s[16:19], s3 offen offset:128 nt
 s_waitcnt lgkmcnt(0)
 s_add_u32 s3, s28, 245760
 buffer_store_dwordx4 v[80:83], v16, s[16:19], s3 offen offset:128 nt
Lend:
 s_endpgm
Lspin_pro:
 s_add_u32 s53, s53, 1
 v_lshlrev_b32 v4, 2, v3
 v_and_b32 v4, 192, v4
 buffer_load_dword v4, v4, s[44:47], 0 offen sc1
 s_cmp_ge_u32 s53, 0x100000
 s_cbranch_scc1 Lgiveup_pro
 s_waitcnt vmcnt(0)
 v_cmp_gt_i32 vcc, s27, v4
 s_and_b64 vcc, exec, vcc
 s_cbranch_vccnz Lspin_pro
Lgiveup_pro:
 s_waitcnt vmcnt(0)
 s_branch Lok_pro
Lspin_pa:
 s_add_u32 s53, s53, 1
 buffer_load_dword v4, off, s[64:67], 0 sc1
 s_cmp_ge_u32 s53, 0x100000
 s_cbranch_scc1 Lgiveup_pa
 s_waitcnt vmcnt(0)
 v_cmp_gt_i32 vcc, s55, v4
 s_and_b64 vcc, exec, vcc
 s_cbranch_vccnz Lspin_pa
Lgiveup_pa:
 s_waitcnt vmcnt(0)
 s_branch Lok_pa
Lgat0:
 v_lshrrev_b32 v5, 4, v3
 v_and_b32 v5, 0x20, v5
 v_xor_b32 v5, v5, v3
 v_and_b32 v5, 0x30, v5
 v_bfe_u32 v6, v3, 6, 4
 v_lshl_add_u32 v6, v6, 11, v5
 s_branch Lgatr0
Lxrg:
 v_lshrrev_b32 v5, 2, v3
 v_and_b32 v5, 0x20, v5
 v_lshrrev_b32 v2, 4, v3
 v_xor_b32 v5, v5, v2
 v_and_b32 v5, 0x30, v5
 v_bfe_u32 v1, v3, 4, 4
 v_lshl_add_u32 v1, v1, 6, v5
 v_add_u32 v2, 0x10000, v1
 s_branch Lxrgr
Lspin_pb:
 s_add_u32 s53, s53, 1
 buffer_load_dword v4, off, s[64:67], 0 sc1
 s_cmp_ge_u32 s53, 0x100000
 s_cbranch_scc1 Lgiveup_pb
 s_waitcnt vmcnt(0)
 v_cmp_gt_i32 vcc, s55, v4
 s_and_b64 vcc, exec, vcc
 s_cbranch_vccnz Lspin_pb
Lgiveup_pb:
 s_waitcnt vmcnt(0)
 s_branch Lok_pb
Lgat1:
 v_lshrrev_b32 v5, 4, v3
 v_and_b32 v5, 0x20, v5
 v_xor_b32 v5, v5, v3
 v_and_b32 v5, 0x30, v5
 v_bfe_u32 v6, v3, 6, 4
 v_lshl_add_u32 v6, v6, 11, v5
 s_branch Lgatr1
Lspin_w:
 s_add_u32 s53, s53, 1
 v_lshlrev_b32 v4, 2, v3
 v_and_b32 v4, 192, v4
 buffer_load_dword v4, v4, s[44:47], 0 offen sc1
 s_cmp_ge_u32 s53, 0x100000
 s_cbranch_scc1 Lgiveup_w
 s_waitcnt vmcnt(0)
 v_cmp_gt_i32 vcc, s27, v4
 s_and_b64 vcc, exec, vcc
 s_cbranch_vccnz Lspin_w
Lgiveup_w:
 s_waitcnt vmcnt(0)
 s_branch Lok_w
.section .rodata,"a"
.p2align 6
.amdhsa_kernel standalone__cross_network_dcn__recsys_kernel
  .amdhsa_next_free_vgpr 512
  .amdhsa_next_free_sgpr 102
  .amdhsa_accum_offset 256
  .amdhsa_group_segment_fixed_size 0
  .amdhsa_kernarg_size 48
  .amdhsa_user_sgpr_count 2
  .amdhsa_user_sgpr_kernarg_segment_ptr 1
  .amdhsa_system_sgpr_workgroup_id_x 1
  .amdhsa_float_denorm_mode_32 3
.end_amdhsa_kernel
```

```asm
; @launch grid=(256,1,1) block=(256,1,1) lds=151552
.amdgcn_target "amdgcn-amd-amdhsa--gfx950"
.text
.globl standalone__cross_network_dcn__recsys_kernel
.p2align 8
.type standalone__cross_network_dcn__recsys_kernel,@function
standalone__cross_network_dcn__recsys_kernel:
 s_cmp_ge_u32 s2, 256
 s_cbranch_scc1 Lend
 s_load_dwordx4 s[56:59], s[0:1], 0
 s_load_dwordx4 s[60:63], s[0:1], 16
 s_load_dwordx4 s[64:67], s[0:1], 32
 v_lshrrev_b32 v9, 6, v0
 v_and_b32 v10, 63, v0
 v_readfirstlane_b32 s54, v9
 v_lshlrev_b32 v1, 4, v10
 s_getpc_b64 s[4:5]
Lpc:
 v_lshlrev_b32 v11, 6, v0
 s_bfe_u32 s3, s2, 0x20003
 s_lshl_b32 s3, s3, 14
 v_add_u32 v11, s3, v11
 v_min_u32 v12, Lcend-4-Lpc, v11
 global_load_dword v60, v12, s[4:5]
 v_add_u32 v11, 16384, v11
 s_and_b32 s7, s2, 1
 s_lshr_b32 s28, s2, 1
 s_lshl_b32 s28, s28, 18
 s_lshl_b32 s6, s7, 10
 s_add_u32 s28, s28, s6
 s_lshl_b32 s6, s54, 8
 s_add_u32 s28, s28, s6
 s_lshl_b32 s50, s54, 15
 s_lshr_b32 s4, s2, 3
 s_and_b32 s5, s2, 7
 s_lshl_b32 s48, s4, 16
 s_lshl_b32 s6, s5, 8
 s_add_u32 s48, s48, s6
 s_lshl_b32 s6, s54, 6
 s_add_u32 s48, s48, s6
 s_lshl_b32 s52, s54, 11
 s_add_u32 s52, s52, 143360
 v_lshrrev_b32 v5, 2, v1
 v_and_b32 v5, 64, v5
 v_xor_b32 v5, v5, v1
 v_and_b32 v5, 112, v5
 v_lshrrev_b32 v6, 7, v1
 v_lshl_add_u32 v23, v6, 11, v5
 s_and_b32 s69, s28, 2047
 s_lshl_b32 s3, s7, 20
 s_add_u32 s69, s69, s3
 v_lshrrev_b32 v5, 6, v1
 v_and_b32 v6, 48, v1
 v_lshl_add_u32 v5, v5, 11, v6
 s_mov_b32 m0, s52
 s_add_u32 s3, s48, 31744
 s_mov_b32 s42, 0xc00000
 s_mov_b32 s43, 0x20000
 s_waitcnt lgkmcnt(0)
 s_mov_b32 s40, s58
 s_mov_b32 s41, s59
 buffer_load_dwordx4 v5, s[40:43], s48 offen lds
 buffer_load_dwordx4 v5, s[40:43], s3 offen offset:1024 lds
 s_add_u32 s48, s48, 2097152
 s_add_u32 m0, s50, 0
 s_add_u32 s3, s69, 0
 buffer_load_dwordx4 v23, s[40:43], s3 offen lds
 s_add_u32 m0, s50, 1024
 s_add_u32 s3, s69, 16384
 buffer_load_dwordx4 v23, s[40:43], s3 offen lds
 s_add_u32 m0, s50, 4096
 s_add_u32 s3, s69, 32768
 buffer_load_dwordx4 v23, s[40:43], s3 offen lds
 s_add_u32 m0, s50, 5120
 s_add_u32 s3, s69, 49152
 buffer_load_dwordx4 v23, s[40:43], s3 offen lds
 s_add_u32 m0, s50, 8192
 s_add_u32 s3, s69, 65536
 buffer_load_dwordx4 v23, s[40:43], s3 offen lds
 s_add_u32 m0, s50, 9216
 s_add_u32 s3, s69, 81920
 buffer_load_dwordx4 v23, s[40:43], s3 offen lds
 s_add_u32 m0, s50, 12288
 s_add_u32 s3, s69, 98304
 buffer_load_dwordx4 v23, s[40:43], s3 offen lds
 s_add_u32 m0, s50, 13312
 s_add_u32 s3, s69, 114688
 buffer_load_dwordx4 v23, s[40:43], s3 offen lds
 s_add_u32 m0, s50, 16384
 s_add_u32 s3, s69, 262144
 buffer_load_dwordx4 v23, s[40:43], s3 offen lds
 s_add_u32 m0, s50, 17408
 s_add_u32 s3, s69, 278528
 buffer_load_dwordx4 v23, s[40:43], s3 offen lds
 s_add_u32 m0, s50, 20480
 s_add_u32 s3, s69, 294912
 buffer_load_dwordx4 v23, s[40:43], s3 offen lds
 s_add_u32 m0, s50, 21504
 s_add_u32 s3, s69, 311296
 buffer_load_dwordx4 v23, s[40:43], s3 offen lds
 s_add_u32 m0, s50, 24576
 s_add_u32 s3, s69, 327680
 buffer_load_dwordx4 v23, s[40:43], s3 offen lds
 s_add_u32 m0, s50, 25600
 s_add_u32 s3, s69, 344064
 buffer_load_dwordx4 v23, s[40:43], s3 offen lds
 s_add_u32 m0, s50, 28672
 s_add_u32 s3, s69, 360448
 buffer_load_dwordx4 v23, s[40:43], s3 offen lds
 s_add_u32 m0, s50, 29696
 s_add_u32 s3, s69, 376832
 buffer_load_dwordx4 v23, s[40:43], s3 offen lds
 v_lshrrev_b32 v11, 7, v0
 v_and_b32 v12, 127, v0
 v_lshlrev_b32 v12, 3, v12
 v_lshl_add_u32 v30, v11, 11, v12
 v_lshlrev_b32 v31, 4, v0
 v_add_u32 v31, 131072, v31
 v_add_u32 v2, 65536, v1
 v_lshl_add_u32 v3, v9, 15, v1
 v_lshl_add_u32 v0, v9, 18, v1
 s_and_b32 s7, s2, 1
 s_lshl_b32 s6, s7, 10
 s_lshl_b32 s6, s54, 8
 s_mov_b32 s26, 0xffff0000
 s_lshl_b32 s24, s7, 20
 s_mov_b32 s25, 0
 s_mov_b32 s53, 0
 s_mov_b32 s31, -1
 s_mov_b32 s27, 64
 s_mov_b32 s55, -1
 s_lshl_b32 s29, s2, 17
 s_add_u32 s29, s29, 33554432
 s_xor_b32 s30, s29, 131072
 s_lshr_b32 s4, s2, 3
 s_and_b32 s5, s2, 7
 s_lshl_b32 s6, s5, 8
 s_lshl_b32 s6, s54, 6
 s_lshl_b32 s49, s5, 18
 s_and_b32 s6, s4, 1
 s_lshl_b32 s6, s6, 10
 s_add_u32 s49, s49, s6
 s_lshr_b32 s6, s4, 4
 s_lshr_b32 s5, s5, 2
 s_xor_b32 s5, s5, s6
 s_bfe_u32 s6, s4, 0x10001
 s_lshl_b32 s3, s5, 1
 s_add_u32 s3, s3, s6
 s_lshl_b32 s3, s3, 16
 s_add_u32 s49, s49, s3
 s_bfe_u32 s4, s4, 0x20002
 s_xor_b32 s5, s5, s6
 s_lshr_b32 s3, s54, 1
 s_lshl_b32 s3, s3, 4
 s_lshr_b32 s6, s54, 1
 s_mul_i32 s6, s6, 3
 s_xor_b32 s6, s6, s4
 s_lshl_b32 s6, s6, 2
 s_add_u32 s3, s3, s6
 s_and_b32 s6, s54, 1
 s_lshl_b32 s6, s6, 1
 s_add_u32 s3, s3, s6
 s_lshl_b32 s4, s4, 3
 s_lshl_b32 s6, s54, 1
 s_add_u32 s4, s4, s6
 s_cmp_eq_u32 s5, 0
 s_cselect_b32 s3, s3, s4
 s_lshl_b32 s3, s3, 11
 s_add_u32 s49, s49, s3
 s_lshl_b32 s51, s54, 9
 s_add_u32 s51, s51, 131072
 s_mov_b32 s20, s60
 s_mov_b32 s21, s61
 s_mov_b32 s22, 0x3000
 s_mov_b32 s23, 0x20000
 s_lshl_b32 s3, s7, 10
 buffer_load_dwordx2 v[32:33], v30, s[20:23], s3 offen
 s_add_u32 s3, s3, 4096
 buffer_load_dwordx2 v[34:35], v30, s[20:23], s3 offen
 s_add_u32 s3, s3, 4096
 buffer_load_dwordx2 v[36:37], v30, s[20:23], s3 offen
 s_add_u32 s3, s3, 4096
 s_mov_b32 s8, s56
 s_mov_b32 s9, s57
 s_mov_b32 s10, 0x2000000
 s_mov_b32 s11, 0x20000
 s_mov_b32 s16, s62
 s_mov_b32 s17, s63
 s_mov_b32 s18, 0x2000000
 s_mov_b32 s19, 0x20000
 s_mov_b32 s12, s66
 s_mov_b32 s13, s67
 s_mov_b32 s14, 0xc00000
 s_mov_b32 s15, 0x20000
 s_mov_b32 s32, s66
 s_mov_b32 s33, s67
 s_mov_b32 s34, 0x0
 s_mov_b32 s35, 0x20000
 s_mov_b32 s44, s64
 s_mov_b32 s45, s65
 s_mov_b32 s46, 0x100
 s_mov_b32 s47, 0x20000
 s_add_u32 s24, s24, 4096
 s_add_u32 s70, s66, s24
 s_addc_u32 s71, s67, 0
 s_sub_u32 s24, s24, 4096
 s_and_b32 s3, s2, 3
 s_lshl_b32 s3, s3, 6
 s_add_u32 s56, s44, s3
 s_addc_u32 s57, s45, 0
 s_mov_b32 s58, 0x4
 s_mov_b32 s59, 0x20000
 s_lshl_b32 s3, s2, 2
 s_add_u32 s3, s3, s54
 s_lshl_b32 s3, s3, 7
 s_add_u32 s3, s3, 15728640
 s_add_u32 s60, s32, s3
 s_addc_u32 s61, s33, 0
 s_mov_b32 s62, 0x4
 s_mov_b32 s63, 0x20000
 s_xor_b32 s3, s3, 512
 s_add_u32 s64, s32, s3
 s_addc_u32 s65, s33, 0
 s_mov_b32 s66, 0x4
 s_mov_b32 s67, 0x20000
 v_mov_b32 v7, 0
 buffer_store_dword v7, v1, s[60:63], 0 offen sc1
 v_lshrrev_b32 v5, 7, v1
 v_lshlrev_b32 v6, 4, v5
 v_xor_b32 v6, v6, v1
 v_and_b32 v6, 112, v6
 v_lshl_add_u32 v20, v5, 11, v6
 v_lshrrev_b32 v5, 4, v1
 v_and_b32 v5, 48, v5
 v_xor_b32 v5, v5, v1
 v_and_b32 v5, 112, v5
 v_and_b32 v6, 240, v1
 v_lshl_add_u32 v5, v6, 3, v5
 v_add_u32 v21, s50, v5
 v_xor_b32 v22, 64, v21
 v_lshrrev_b32 v5, 1, v1
 v_and_b32 v5, 64, v5
 v_and_b32 v6, 48, v1
 v_or_b32 v5, v5, v6
 v_and_b32 v6, 192, v1
 v_lshl_add_u32 v5, v6, 1, v5
 v_and_b32 v6, 256, v1
 v_lshl_add_u32 v5, v6, 2, v5
 v_and_b32 v6, 512, v1
 v_lshl_add_u32 v5, v6, 3, v5
 v_add_u32 v24, s50, v5
 v_xor_b32 v25, 64, v24
 v_mov_b32 v64, 1.0
 v_mov_b32 v65, 1.0
 v_mov_b32 v66, 1.0
 v_mov_b32 v67, 1.0
 v_mov_b32 v68, 1.0
 v_mov_b32 v69, 1.0
 v_mov_b32 v70, 1.0
 v_mov_b32 v71, 1.0
 v_mov_b32 v72, 1.0
 v_mov_b32 v73, 1.0
 v_mov_b32 v74, 1.0
 v_mov_b32 v75, 1.0
 v_mov_b32 v76, 1.0
 v_mov_b32 v77, 1.0
 v_mov_b32 v78, 1.0
 v_mov_b32 v79, 1.0
 v_mov_b32 v80, 1.0
 v_mov_b32 v81, 1.0
 v_mov_b32 v82, 1.0
 v_mov_b32 v83, 1.0
 v_mov_b32 v84, 1.0
 v_mov_b32 v85, 1.0
 v_mov_b32 v86, 1.0
 v_mov_b32 v87, 1.0
 v_mov_b32 v88, 1.0
 v_mov_b32 v89, 1.0
 v_mov_b32 v90, 1.0
 v_mov_b32 v91, 1.0
 v_mov_b32 v92, 1.0
 v_mov_b32 v93, 1.0
 v_mov_b32 v94, 1.0
 v_mov_b32 v95, 1.0
 v_mov_b32 v96, 1.0
 v_mov_b32 v97, 1.0
 v_mov_b32 v98, 1.0
 v_mov_b32 v99, 1.0
 v_mov_b32 v100, 1.0
 v_mov_b32 v101, 1.0
 v_mov_b32 v102, 1.0
 v_mov_b32 v103, 1.0
 v_mov_b32 v104, 1.0
 v_mov_b32 v105, 1.0
 v_mov_b32 v106, 1.0
 v_mov_b32 v107, 1.0
 v_mov_b32 v108, 1.0
 v_mov_b32 v109, 1.0
 v_mov_b32 v110, 1.0
 v_mov_b32 v111, 1.0
 v_mov_b32 v112, 1.0
 v_mov_b32 v113, 1.0
 v_mov_b32 v114, 1.0
 v_mov_b32 v115, 1.0
 v_mov_b32 v116, 1.0
 v_mov_b32 v117, 1.0
 v_mov_b32 v118, 1.0
 v_mov_b32 v119, 1.0
 v_mov_b32 v120, 1.0
 v_mov_b32 v121, 1.0
 v_mov_b32 v122, 1.0
 v_mov_b32 v123, 1.0
 v_mov_b32 v124, 1.0
 v_mov_b32 v125, 1.0
 v_mov_b32 v126, 1.0
 v_mov_b32 v127, 1.0
 v_mov_b32 v128, 1.0
 v_mov_b32 v129, 1.0
 v_mov_b32 v130, 1.0
 v_mov_b32 v131, 1.0
 v_mov_b32 v132, 1.0
 v_mov_b32 v133, 1.0
 v_mov_b32 v134, 1.0
 v_mov_b32 v135, 1.0
 v_accvgpr_write_b32 a240, 1.0
 v_accvgpr_write_b32 a241, 1.0
 v_accvgpr_write_b32 a242, 1.0
 v_accvgpr_write_b32 a243, 1.0
 v_accvgpr_write_b32 a244, 1.0
 v_accvgpr_write_b32 a245, 1.0
 v_accvgpr_write_b32 a246, 1.0
 v_accvgpr_write_b32 a247, 1.0
 v_mov_b32 v216, 1.0
 v_mov_b32 v217, 1.0
 v_mov_b32 v218, 1.0
 v_mov_b32 v219, 1.0
 v_mov_b32 v220, 1.0
 v_mov_b32 v221, 1.0
 v_mov_b32 v222, 1.0
 v_mov_b32 v223, 1.0
 v_mov_b32 v224, 1.0
 v_mov_b32 v225, 1.0
 v_mov_b32 v226, 1.0
 v_mov_b32 v227, 1.0
 v_mov_b32 v228, 1.0
 v_mov_b32 v229, 1.0
 v_mov_b32 v230, 1.0
 v_mov_b32 v231, 1.0
 v_mov_b32 v232, 1.0
 v_mov_b32 v233, 1.0
 v_mov_b32 v234, 1.0
 v_mov_b32 v235, 1.0
 v_mov_b32 v236, 1.0
 v_mov_b32 v237, 1.0
 v_mov_b32 v238, 1.0
 v_mov_b32 v239, 1.0
 v_mov_b32 v240, 1.0
 v_mov_b32 v241, 1.0
 v_mov_b32 v242, 1.0
 v_mov_b32 v243, 1.0
 v_mov_b32 v244, 1.0
 v_mov_b32 v245, 1.0
 v_mov_b32 v246, 1.0
 v_mov_b32 v247, 1.0
 v_mov_b32 v248, 1.0
 v_mov_b32 v249, 1.0
 v_mov_b32 v250, 1.0
 v_mov_b32 v251, 1.0
 v_mov_b32 v252, 1.0
 v_mov_b32 v253, 1.0
 v_mov_b32 v254, 1.0
 v_mov_b32 v255, 1.0
 v_accvgpr_write_b32 a248, 1.0
 v_accvgpr_write_b32 a249, 1.0
 v_accvgpr_write_b32 a250, 1.0
 v_accvgpr_write_b32 a251, 1.0
 v_accvgpr_write_b32 a252, 1.0
 v_accvgpr_write_b32 a253, 1.0
 v_accvgpr_write_b32 a254, 1.0
 v_accvgpr_write_b32 a255, 1.0
 v_and_b32 v5, 768, v3
 v_and_b32 v7, 1023, v3
 v_add3_u32 v5, v5, v7, s52
 s_waitcnt vmcnt(20)
 ds_read_b64_tr_b16 v[8:9], v5 offset:0
 ds_read_b64_tr_b16 v[10:11], v5 offset:256
 ds_read_b64_tr_b16 v[12:13], v5 offset:8
 ds_read_b64_tr_b16 v[14:15], v5 offset:264
 s_waitcnt lgkmcnt(2)
 buffer_store_dwordx4 v[8:11], v7, s[12:15], s49 offen sc1
 s_waitcnt lgkmcnt(0)
 buffer_store_dwordx4 v[12:15], v7, s[12:15], s49 offen offset:2048 sc1
 s_add_u32 s49, s49, 2097152
 s_add_u32 m0, s50, 2048
 s_add_u32 s3, s69, 524288
 buffer_load_dwordx4 v23, s[40:43], s3 offen lds
 s_add_u32 m0, s50, 3072
 s_add_u32 s3, s69, 540672
 buffer_load_dwordx4 v23, s[40:43], s3 offen lds
 s_add_u32 m0, s50, 6144
 s_add_u32 s3, s69, 557056
 buffer_load_dwordx4 v23, s[40:43], s3 offen lds
 s_add_u32 m0, s50, 7168
 s_add_u32 s3, s69, 573440
 buffer_load_dwordx4 v23, s[40:43], s3 offen lds
 s_add_u32 m0, s50, 10240
 s_add_u32 s3, s69, 589824
 buffer_load_dwordx4 v23, s[40:43], s3 offen lds
 s_add_u32 m0, s50, 11264
 s_add_u32 s3, s69, 606208
 buffer_load_dwordx4 v23, s[40:43], s3 offen lds
 s_add_u32 m0, s50, 14336
 s_add_u32 s3, s69, 622592
 buffer_load_dwordx4 v23, s[40:43], s3 offen lds
 s_add_u32 m0, s50, 15360
 s_add_u32 s3, s69, 638976
 buffer_load_dwordx4 v23, s[40:43], s3 offen lds
 s_waitcnt vmcnt(13)
 v_lshlrev_b32 v40, 16, v32
 v_and_b32 v41, s26, v32
 v_lshlrev_b32 v42, 16, v33
 v_and_b32 v43, s26, v33
 ds_write_b128 v31, v[40:43]
 s_waitcnt vmcnt(12)
 v_lshlrev_b32 v44, 16, v34
 v_and_b32 v45, s26, v34
 v_lshlrev_b32 v46, 16, v35
 v_and_b32 v47, s26, v35
 ds_write_b128 v31, v[44:47] offset:4096
 s_waitcnt vmcnt(11)
 v_lshlrev_b32 v48, 16, v36
 v_and_b32 v49, s26, v36
 v_lshlrev_b32 v50, 16, v37
 v_and_b32 v51, s26, v37
 ds_write_b128 v31, v[48:51] offset:8192
 s_waitcnt lgkmcnt(0)
 v_mov_b32 v32, 1.0
 v_mov_b32 v33, 1.0
 v_mov_b32 v34, 1.0
 v_mov_b32 v35, 1.0
 v_mov_b32 v36, 1.0
 v_mov_b32 v37, 1.0
 v_mov_b32 v38, 1.0
 v_mov_b32 v39, 1.0
 v_mov_b32 v40, 1.0
 v_mov_b32 v41, 1.0
 v_mov_b32 v42, 1.0
 v_mov_b32 v43, 1.0
 v_mov_b32 v44, 1.0
 v_mov_b32 v45, 1.0
 v_mov_b32 v46, 1.0
 v_mov_b32 v47, 1.0
 v_mov_b32 v48, 1.0
 v_mov_b32 v49, 1.0
 v_mov_b32 v50, 1.0
 v_mov_b32 v51, 1.0
 v_mov_b32 v52, 1.0
 v_mov_b32 v53, 1.0
 v_mov_b32 v54, 1.0
 v_mov_b32 v55, 1.0
 v_mov_b32 v56, 1.0
 v_mov_b32 v57, 1.0
 v_mov_b32 v58, 1.0
 v_mov_b32 v59, 1.0
 v_mov_b32 v60, 1.0
 v_mov_b32 v61, 1.0
 v_mov_b32 v62, 1.0
 v_mov_b32 v63, 1.0
 ds_read_b64_tr_b16 v[136:137], v24 offset:0
 ds_read_b64_tr_b16 v[138:139], v24 offset:512
 ds_read_b64_tr_b16 v[144:145], v24 offset:8
 ds_read_b64_tr_b16 v[146:147], v24 offset:520
 ds_read_b64_tr_b16 v[152:153], v25 offset:0
 ds_read_b64_tr_b16 v[154:155], v25 offset:512
 ds_read_b64_tr_b16 v[160:161], v25 offset:8
 ds_read_b64_tr_b16 v[162:163], v25 offset:520
 ds_read_b64_tr_b16 v[140:141], v24 offset:8192
 ds_read_b64_tr_b16 v[142:143], v24 offset:8704
 ds_read_b64_tr_b16 v[148:149], v24 offset:8200
 ds_read_b64_tr_b16 v[150:151], v24 offset:8712
 ds_read_b64_tr_b16 v[156:157], v25 offset:8192
 ds_read_b64_tr_b16 v[158:159], v25 offset:8704
 ds_read_b64_tr_b16 v[164:165], v25 offset:8200
 ds_read_b64_tr_b16 v[166:167], v25 offset:8712
 s_waitcnt lgkmcnt(8)
 s_add_u32 m0, s50, 0
 s_add_u32 s3, s28, 0
 buffer_load_dwordx4 v20, s[8:11], s3 offen lds
 s_add_u32 m0, s50, 1024
 s_add_u32 s3, s28, 16384
 buffer_load_dwordx4 v20, s[8:11], s3 offen lds
 s_add_u32 m0, s50, 4096
 s_add_u32 s3, s28, 32768
 buffer_load_dwordx4 v20, s[8:11], s3 offen lds
 s_add_u32 m0, s50, 5120
 s_add_u32 s3, s28, 49152
 buffer_load_dwordx4 v20, s[8:11], s3 offen lds
 ds_read_b64_tr_b16 v[168:169], v24 offset:16384
 ds_read_b64_tr_b16 v[170:171], v24 offset:16896
 ds_read_b64_tr_b16 v[176:177], v24 offset:16392
 ds_read_b64_tr_b16 v[178:179], v24 offset:16904
 ds_read_b64_tr_b16 v[184:185], v25 offset:16384
 ds_read_b64_tr_b16 v[186:187], v25 offset:16896
 ds_read_b64_tr_b16 v[192:193], v25 offset:16392
 ds_read_b64_tr_b16 v[194:195], v25 offset:16904
 s_waitcnt lgkmcnt(8)
 s_add_u32 m0, s50, 8192
 s_add_u32 s3, s28, 65536
 buffer_load_dwordx4 v20, s[8:11], s3 offen lds
 s_add_u32 m0, s50, 9216
 s_add_u32 s3, s28, 81920
 buffer_load_dwordx4 v20, s[8:11], s3 offen lds
 s_add_u32 m0, s50, 12288
 s_add_u32 s3, s28, 98304
 buffer_load_dwordx4 v20, s[8:11], s3 offen lds
 s_add_u32 m0, s50, 13312
 s_add_u32 s3, s28, 114688
 buffer_load_dwordx4 v20, s[8:11], s3 offen lds
 ds_read_b64_tr_b16 v[172:173], v24 offset:24576
 ds_read_b64_tr_b16 v[174:175], v24 offset:25088
 ds_read_b64_tr_b16 v[180:181], v24 offset:24584
 ds_read_b64_tr_b16 v[182:183], v24 offset:25096
 ds_read_b64_tr_b16 v[188:189], v25 offset:24576
 ds_read_b64_tr_b16 v[190:191], v25 offset:25088
 ds_read_b64_tr_b16 v[196:197], v25 offset:24584
 ds_read_b64_tr_b16 v[198:199], v25 offset:25096
 s_waitcnt vmcnt(16)
 s_barrier
 v_mov_b32 v7, 1
 buffer_atomic_add v7, v0, s[56:59], 0 offen sc1
 s_add_u32 m0, s50, 18432
 s_add_u32 s3, s69, 786432
 buffer_load_dwordx4 v23, s[40:43], s3 offen lds
 s_add_u32 m0, s50, 19456
 s_add_u32 s3, s69, 802816
 buffer_load_dwordx4 v23, s[40:43], s3 offen lds
 s_add_u32 m0, s50, 22528
 s_add_u32 s3, s69, 819200
 buffer_load_dwordx4 v23, s[40:43], s3 offen lds
 s_add_u32 m0, s50, 23552
 s_add_u32 s3, s69, 835584
 buffer_load_dwordx4 v23, s[40:43], s3 offen lds
 s_add_u32 m0, s50, 26624
 s_add_u32 s3, s69, 851968
 buffer_load_dwordx4 v23, s[40:43], s3 offen lds
 s_add_u32 m0, s50, 27648
 s_add_u32 s3, s69, 868352
 buffer_load_dwordx4 v23, s[40:43], s3 offen lds
 s_add_u32 m0, s50, 30720
 s_add_u32 s3, s69, 884736
 buffer_load_dwordx4 v23, s[40:43], s3 offen lds
 s_add_u32 m0, s50, 31744
 s_add_u32 s3, s69, 901120
 buffer_load_dwordx4 v23, s[40:43], s3 offen lds
 s_waitcnt lgkmcnt(0)
 s_add_u32 m0, s50, 16384
 s_add_u32 s3, s28, 131072
 buffer_load_dwordx4 v20, s[8:11], s3 offen lds
 s_add_u32 m0, s50, 17408
 s_add_u32 s3, s28, 147456
 buffer_load_dwordx4 v20, s[8:11], s3 offen lds
 s_add_u32 m0, s50, 20480
 s_add_u32 s3, s28, 163840
 buffer_load_dwordx4 v20, s[8:11], s3 offen lds
 s_add_u32 m0, s50, 21504
 s_add_u32 s3, s28, 180224
 buffer_load_dwordx4 v20, s[8:11], s3 offen lds
 s_add_u32 m0, s50, 24576
 s_add_u32 s3, s28, 196608
 buffer_load_dwordx4 v20, s[8:11], s3 offen lds
 s_add_u32 m0, s50, 25600
 s_add_u32 s3, s28, 212992
 buffer_load_dwordx4 v20, s[8:11], s3 offen lds
 s_add_u32 m0, s50, 28672
 s_add_u32 s3, s28, 229376
 buffer_load_dwordx4 v20, s[8:11], s3 offen lds
 s_add_u32 m0, s50, 29696
 s_add_u32 s3, s28, 245760
 buffer_load_dwordx4 v20, s[8:11], s3 offen lds
 s_waitcnt vmcnt(29)
 ds_read_b64_tr_b16 v[200:201], v24 offset:2048
 ds_read_b64_tr_b16 v[202:203], v24 offset:2560
 ds_read_b64_tr_b16 v[208:209], v24 offset:2056
 ds_read_b64_tr_b16 v[210:211], v24 offset:2568
 ds_read_b64_tr_b16 a[224:225], v25 offset:2048
 ds_read_b64_tr_b16 a[226:227], v25 offset:2560
 ds_read_b64_tr_b16 a[232:233], v25 offset:2056
 ds_read_b64_tr_b16 a[234:235], v25 offset:2568
 s_waitcnt vmcnt(25)
 ds_read_b64_tr_b16 v[204:205], v24 offset:10240
 ds_read_b64_tr_b16 v[206:207], v24 offset:10752
 ds_read_b64_tr_b16 v[212:213], v24 offset:10248
 ds_read_b64_tr_b16 v[214:215], v24 offset:10760
 ds_read_b64_tr_b16 a[228:229], v25 offset:10240
 ds_read_b64_tr_b16 a[230:231], v25 offset:10752
 ds_read_b64_tr_b16 a[236:237], v25 offset:10248
 ds_read_b64_tr_b16 a[238:239], v25 offset:10760
 s_waitcnt vmcnt(12)
 ds_read_b64_tr_b16 a[192:193], v24 offset:18432
 ds_read_b64_tr_b16 a[194:195], v24 offset:18944
 ds_read_b64_tr_b16 a[200:201], v24 offset:18440
 ds_read_b64_tr_b16 a[202:203], v24 offset:18952
 ds_read_b64_tr_b16 a[208:209], v25 offset:18432
 ds_read_b64_tr_b16 a[210:211], v25 offset:18944
 ds_read_b64_tr_b16 a[216:217], v25 offset:18440
 ds_read_b64_tr_b16 a[218:219], v25 offset:18952
 s_waitcnt vmcnt(8)
 ds_read_b64_tr_b16 a[196:197], v24 offset:26624
 ds_read_b64_tr_b16 a[198:199], v24 offset:27136
 ds_read_b64_tr_b16 a[204:205], v24 offset:26632
 ds_read_b64_tr_b16 a[206:207], v24 offset:27144
 ds_read_b64_tr_b16 a[212:213], v25 offset:26624
 ds_read_b64_tr_b16 a[214:215], v25 offset:27136
 ds_read_b64_tr_b16 a[220:221], v25 offset:26632
 ds_read_b64_tr_b16 a[222:223], v25 offset:27144
 ds_read_b128 a[0:3], v21
 ds_read_b128 a[32:35], v22
 ds_read_b128 a[4:7], v21 offset:4096
 ds_read_b128 a[36:39], v22 offset:4096
 s_waitcnt lgkmcnt(2)
 ds_write_b128 v3, a[0:3]
 ds_write_b128 v3, a[32:35] offset:1024
 ds_read_b128 a[8:11], v21 offset:8192
 ds_read_b128 a[40:43], v22 offset:8192
 s_waitcnt lgkmcnt(4)
 ds_write_b128 v3, a[4:7] offset:4096
 ds_write_b128 v3, a[36:39] offset:5120
 ds_read_b128 a[12:15], v21 offset:12288
 ds_read_b128 a[44:47], v22 offset:12288
 s_waitcnt lgkmcnt(4)
 ds_write_b128 v3, a[8:11] offset:8192
 ds_write_b128 v3, a[40:43] offset:9216
 s_waitcnt vmcnt(6)
 ds_read_b128 a[16:19], v21 offset:16384
 ds_read_b128 a[48:51], v22 offset:16384
 s_waitcnt lgkmcnt(4)
 ds_write_b128 v3, a[12:15] offset:12288
 ds_write_b128 v3, a[44:47] offset:13312
 s_waitcnt vmcnt(4)
 ds_read_b128 a[20:23], v21 offset:20480
 ds_read_b128 a[52:55], v22 offset:20480
 s_waitcnt lgkmcnt(4)
 ds_write_b128 v3, a[16:19] offset:16384
 ds_write_b128 v3, a[48:51] offset:17408
 s_waitcnt vmcnt(2)
 ds_read_b128 a[24:27], v21 offset:24576
 ds_read_b128 a[56:59], v22 offset:24576
 s_waitcnt lgkmcnt(4)
 ds_write_b128 v3, a[20:23] offset:20480
 ds_write_b128 v3, a[52:55] offset:21504
 s_waitcnt lgkmcnt(0)
 v_lshlrev_b32 v4, 2, v3
 v_and_b32 v4, 192, v4
 buffer_load_dword v4, v4, s[44:47], 0 offen sc1
 s_add_u32 m0, s50, 2048
 s_add_u32 s3, s28, 128
 buffer_load_dwordx4 v20, s[8:11], s3 offen lds
 s_add_u32 m0, s50, 3072
 s_add_u32 s3, s28, 16512
 buffer_load_dwordx4 v20, s[8:11], s3 offen lds
 s_waitcnt vmcnt(3)
 ds_read_b128 a[28:31], v21 offset:28672
 ds_read_b128 a[60:63], v22 offset:28672
 ds_write_b128 v3, a[24:27] offset:24576
 ds_write_b128 v3, a[56:59] offset:25600
 s_waitcnt lgkmcnt(2)
 ds_write_b128 v3, a[28:31] offset:28672
 ds_write_b128 v3, a[60:63] offset:29696
 s_add_u32 m0, s50, 6144
 s_add_u32 s3, s28, 32896
 buffer_load_dwordx4 v20, s[8:11], s3 offen lds
 s_add_u32 m0, s50, 7168
 s_add_u32 s3, s28, 49280
 buffer_load_dwordx4 v20, s[8:11], s3 offen lds
 s_add_u32 m0, s50, 10240
 s_add_u32 s3, s28, 65664
 buffer_load_dwordx4 v20, s[8:11], s3 offen lds
 s_add_u32 m0, s50, 11264
 s_add_u32 s3, s28, 82048
 buffer_load_dwordx4 v20, s[8:11], s3 offen lds
 v_mov_b32 v8, v20
 v_mov_b32 v16, 1.0
 v_mov_b32 v17, 1.0
 v_mov_b32 v18, 1.0
 v_mov_b32 v19, 1.0
 v_mov_b32 v20, 1.0
 v_mov_b32 v21, 1.0
 v_mov_b32 v22, 1.0
 v_mov_b32 v23, 1.0
 v_mov_b32 v24, 1.0
 v_mov_b32 v25, 1.0
 v_mov_b32 v26, 1.0
 v_mov_b32 v27, 1.0
 v_mov_b32 v28, 1.0
 v_mov_b32 v29, 1.0
 v_mov_b32 v30, 1.0
 v_mov_b32 v31, 1.0
 s_add_u32 s70, s70, 32768
 s_addc_u32 s71, s71, 0
 s_xor_b32 s30, s28, 1024
 s_mov_b32 s20, 64
 s_mov_b32 s21, 32704
 s_mov_b32 s22, 0xfffc8040
 s_waitcnt lgkmcnt(0)
 s_barrier
 ds_read_b128 a[128:131], v1
 ds_read_b128 a[132:135], v1 offset:1024
 ds_read_b128 a[140:143], v1 offset:5120
 ds_read_b128 a[136:139], v1 offset:4096
 ds_read_b128 a[144:147], v1 offset:8192
 ds_read_b128 a[148:151], v1 offset:9216
 ds_read_b128 a[156:159], v1 offset:13312
 ds_read_b128 a[152:155], v1 offset:12288
 ds_read_b128 a[160:163], v1 offset:16384
 ds_read_b128 a[164:167], v1 offset:17408
 ds_read_b128 a[172:175], v1 offset:21504
 ds_read_b128 a[168:171], v1 offset:20480
 ds_read_b128 a[176:179], v1 offset:24576
 ds_read_b128 a[180:183], v1 offset:25600
 ds_read_b128 a[188:191], v1 offset:29696
 ds_read_b128 a[184:187], v1 offset:28672
 s_waitcnt lgkmcnt(8)
 v_mfma_f32_16x16x32_bf16 v[16:19], v[136:139], a[128:131], v[16:19]
 s_add_u32 m0, s50, 14336
 v_mfma_f32_16x16x32_bf16 v[16:19], v[140:143], a[132:135], v[16:19]
 v_mfma_f32_16x16x32_bf16 v[20:23], v[140:143], a[140:143], v[20:23]
 s_add_u32 s3, s28, 98432
 v_mfma_f32_16x16x32_bf16 v[20:23], v[136:139], a[136:139], v[20:23]
 buffer_load_dwordx4 v8, s[8:11], s3 offen lds
 v_mfma_f32_16x16x32_bf16 v[24:27], v[136:139], a[144:147], v[24:27]
 s_add_u32 m0, s50, 15360
 v_mfma_f32_16x16x32_bf16 v[24:27], v[140:143], a[148:151], v[24:27]
 v_mfma_f32_16x16x32_bf16 v[28:31], v[140:143], a[156:159], v[28:31]
 s_add_u32 s3, s28, 114816
 v_mfma_f32_16x16x32_bf16 v[28:31], v[136:139], a[152:155], v[28:31]
 buffer_load_dwordx4 v8, s[8:11], s3 offen lds
 s_waitcnt lgkmcnt(0)
 v_mfma_f32_16x16x32_bf16 v[32:35], v[136:139], a[160:163], v[32:35]
 s_add_u32 m0, s50, 18432
 v_mfma_f32_16x16x32_bf16 v[32:35], v[140:143], a[164:167], v[32:35]
 s_add_u32 s3, s28, 131200
 v_mfma_f32_16x16x32_bf16 v[36:39], v[140:143], a[172:175], v[36:39]
 v_mfma_f32_16x16x32_bf16 v[36:39], v[136:139], a[168:171], v[36:39]
 buffer_load_dwordx4 v8, s[8:11], s3 offen lds
 v_mfma_f32_16x16x32_bf16 v[40:43], v[136:139], a[176:179], v[40:43]
 s_add_u32 m0, s50, 19456
 v_mfma_f32_16x16x32_bf16 v[40:43], v[140:143], a[180:183], v[40:43]
 s_add_u32 s3, s28, 147584
 v_mfma_f32_16x16x32_bf16 v[44:47], v[140:143], a[188:191], v[44:47]
 v_mfma_f32_16x16x32_bf16 v[44:47], v[136:139], a[184:187], v[44:47]
 buffer_load_dwordx4 v8, s[8:11], s3 offen lds
 v_mfma_f32_16x16x32_bf16 v[76:79], v[144:147], a[184:187], v[76:79]
 s_add_u32 m0, s50, 22528
 v_mfma_f32_16x16x32_bf16 v[76:79], v[148:151], a[188:191], v[76:79]
 s_add_u32 s3, s28, 163968
 v_mfma_f32_16x16x32_bf16 v[72:75], v[148:151], a[180:183], v[72:75]
 v_mov_b32 v136, 1.0
 v_mfma_f32_16x16x32_bf16 v[72:75], v[144:147], a[176:179], v[72:75]
 buffer_load_dwordx4 v8, s[8:11], s3 offen lds
 v_mfma_f32_16x16x32_bf16 v[68:71], v[144:147], a[168:171], v[68:71]
 s_add_u32 m0, s50, 23552
 v_mov_b32 v137, 1.0
 v_mfma_f32_16x16x32_bf16 v[68:71], v[148:151], a[172:175], v[68:71]
 s_add_u32 s3, s28, 180352
 v_mov_b32 v138, 1.0
 v_mfma_f32_16x16x32_bf16 v[64:67], v[148:151], a[164:167], v[64:67]
 buffer_load_dwordx4 v8, s[8:11], s3 offen lds
 v_mfma_f32_16x16x32_bf16 v[64:67], v[144:147], a[160:163], v[64:67]
 v_mov_b32 v139, 1.0
 v_mfma_f32_16x16x32_bf16 v[60:63], v[144:147], a[152:155], v[60:63]
 s_add_u32 m0, s50, 26624
 v_mov_b32 v140, 1.0
 v_mfma_f32_16x16x32_bf16 v[60:63], v[148:151], a[156:159], v[60:63]
 v_mfma_f32_16x16x32_bf16 v[56:59], v[148:151], a[148:151], v[56:59]
 s_add_u32 s3, s28, 196736
 v_mov_b32 v141, 1.0
 v_mfma_f32_16x16x32_bf16 v[56:59], v[144:147], a[144:147], v[56:59]
 v_mov_b32 v142, 1.0
 v_mfma_f32_16x16x32_bf16 v[52:55], v[144:147], a[136:139], v[52:55]
 buffer_load_dwordx4 v8, s[8:11], s3 offen lds
 s_add_u32 m0, s50, 27648
 v_mfma_f32_16x16x32_bf16 v[52:55], v[148:151], a[140:143], v[52:55]
 v_mov_b32 v143, 1.0
 v_mfma_f32_16x16x32_bf16 v[48:51], v[148:151], a[132:135], v[48:51]
 s_add_u32 s3, s28, 213120
 v_mfma_f32_16x16x32_bf16 v[48:51], v[144:147], a[128:131], v[48:51]
 buffer_load_dwordx4 v8, s[8:11], s3 offen lds
 v_mfma_f32_16x16x32_bf16 v[80:83], v[152:155], a[128:131], v[80:83]
 s_add_u32 m0, s50, 30720
 v_mfma_f32_16x16x32_bf16 v[80:83], v[156:159], a[132:135], v[80:83]
 v_mfma_f32_16x16x32_bf16 v[84:87], v[156:159], a[140:143], v[84:87]
 s_add_u32 s3, s28, 229504
 v_mov_b32 v144, 1.0
 v_mfma_f32_16x16x32_bf16 v[84:87], v[152:155], a[136:139], v[84:87]
 buffer_load_dwordx4 v8, s[8:11], s3 offen lds
 v_mfma_f32_16x16x32_bf16 v[88:91], v[152:155], a[144:147], v[88:91]
 s_add_u32 m0, s50, 31744
 v_mov_b32 v145, 1.0
 v_mfma_f32_16x16x32_bf16 v[88:91], v[156:159], a[148:151], v[88:91]
 s_add_u32 s3, s28, 245888
 v_mov_b32 v146, 1.0
 v_mfma_f32_16x16x32_bf16 v[92:95], v[156:159], a[156:159], v[92:95]
 buffer_load_dwordx4 v8, s[8:11], s3 offen lds
 v_mfma_f32_16x16x32_bf16 v[92:95], v[152:155], a[152:155], v[92:95]
 v_mov_b32 v147, 1.0
 v_mfma_f32_16x16x32_bf16 v[96:99], v[152:155], a[160:163], v[96:99]
 v_mov_b32 v148, 1.0
 v_mfma_f32_16x16x32_bf16 v[96:99], v[156:159], a[164:167], v[96:99]
 v_mfma_f32_16x16x32_bf16 v[100:103], v[156:159], a[172:175], v[100:103]
 v_mov_b32 v149, 1.0
 v_mfma_f32_16x16x32_bf16 v[100:103], v[152:155], a[168:171], v[100:103]
 v_mov_b32 v150, 1.0
 v_mfma_f32_16x16x32_bf16 v[104:107], v[152:155], a[176:179], v[104:107]
 v_mfma_f32_16x16x32_bf16 v[104:107], v[156:159], a[180:183], v[104:107]
 v_mov_b32 v151, 1.0
 v_mfma_f32_16x16x32_bf16 v[108:111], v[156:159], a[188:191], v[108:111]
 v_mfma_f32_16x16x32_bf16 v[108:111], v[152:155], a[184:187], v[108:111]
 v_mfma_f32_16x16x32_bf16 a[244:247], v[160:163], a[184:187], a[244:247]
 ds_read_b128 a[184:187], v1 offset:61440
 v_mfma_f32_16x16x32_bf16 a[244:247], v[164:167], a[188:191], a[244:247]
 ds_read_b128 a[188:191], v1 offset:62464
 v_mfma_f32_16x16x32_bf16 a[240:243], v[164:167], a[180:183], a[240:243]
 ds_read_b128 a[180:183], v1 offset:58368
 v_mov_b32 v152, 1.0
 v_mfma_f32_16x16x32_bf16 a[240:243], v[160:163], a[176:179], a[240:243]
 ds_read_b128 a[176:179], v1 offset:57344
 v_mfma_f32_16x16x32_bf16 v[132:135], v[160:163], a[168:171], v[132:135]
 ds_read_b128 a[168:171], v1 offset:53248
 v_mov_b32 v153, 1.0
 v_mfma_f32_16x16x32_bf16 v[132:135], v[164:167], a[172:175], v[132:135]
 ds_read_b128 a[172:175], v1 offset:54272
 v_mov_b32 v154, 1.0
 v_mfma_f32_16x16x32_bf16 v[128:131], v[164:167], a[164:167], v[128:131]
 ds_read_b128 a[164:167], v1 offset:50176
 v_mfma_f32_16x16x32_bf16 v[128:131], v[160:163], a[160:163], v[128:131]
 ds_read_b128 a[160:163], v1 offset:49152
 v_mov_b32 v155, 1.0
 v_mfma_f32_16x16x32_bf16 v[124:127], v[160:163], a[152:155], v[124:127]
 ds_read_b128 a[152:155], v1 offset:45056
 v_mov_b32 v156, 1.0
 v_mfma_f32_16x16x32_bf16 v[124:127], v[164:167], a[156:159], v[124:127]
 ds_read_b128 a[156:159], v1 offset:46080
 v_mfma_f32_16x16x32_bf16 v[120:123], v[164:167], a[148:151], v[120:123]
 ds_read_b128 a[148:151], v1 offset:41984
 v_mov_b32 v157, 1.0
 v_mfma_f32_16x16x32_bf16 v[120:123], v[160:163], a[144:147], v[120:123]
 ds_read_b128 a[144:147], v1 offset:40960
 v_mov_b32 v158, 1.0
 v_mfma_f32_16x16x32_bf16 v[116:119], v[160:163], a[136:139], v[116:119]
 ds_read_b128 a[136:139], v1 offset:36864
 v_mfma_f32_16x16x32_bf16 v[116:119], v[164:167], a[140:143], v[116:119]
 ds_read_b128 a[140:143], v1 offset:37888
 v_mov_b32 v159, 1.0
 v_mfma_f32_16x16x32_bf16 v[112:115], v[164:167], a[132:135], v[112:115]
 ds_read_b128 a[132:135], v1 offset:33792
 v_mfma_f32_16x16x32_bf16 v[112:115], v[160:163], a[128:131], v[112:115]
 ds_read_b128 a[128:131], v1 offset:32768
 s_waitcnt lgkmcnt(8)
 v_mfma_f32_16x16x32_bf16 v[44:47], v[168:171], a[184:187], v[44:47]
 v_mfma_f32_16x16x32_bf16 v[44:47], v[172:175], a[188:191], v[44:47]
 v_mfma_f32_16x16x32_bf16 v[40:43], v[172:175], a[180:183], v[40:43]
 v_mov_b32 v160, 1.0
 v_mfma_f32_16x16x32_bf16 v[40:43], v[168:171], a[176:179], v[40:43]
 v_mfma_f32_16x16x32_bf16 v[36:39], v[168:171], a[168:171], v[36:39]
 v_mov_b32 v161, 1.0
 v_mfma_f32_16x16x32_bf16 v[36:39], v[172:175], a[172:175], v[36:39]
 v_mov_b32 v162, 1.0
 v_mfma_f32_16x16x32_bf16 v[32:35], v[172:175], a[164:167], v[32:35]
 v_mfma_f32_16x16x32_bf16 v[32:35], v[168:171], a[160:163], v[32:35]
 v_mov_b32 v163, 1.0
 s_waitcnt lgkmcnt(0)
 v_mfma_f32_16x16x32_bf16 v[28:31], v[168:171], a[152:155], v[28:31]
 v_mov_b32 v164, 1.0
 v_mfma_f32_16x16x32_bf16 v[28:31], v[172:175], a[156:159], v[28:31]
 v_mfma_f32_16x16x32_bf16 v[24:27], v[172:175], a[148:151], v[24:27]
 v_mov_b32 v165, 1.0
 v_mfma_f32_16x16x32_bf16 v[24:27], v[168:171], a[144:147], v[24:27]
 v_mov_b32 v166, 1.0
 v_mfma_f32_16x16x32_bf16 v[20:23], v[168:171], a[136:139], v[20:23]
 v_mfma_f32_16x16x32_bf16 v[20:23], v[172:175], a[140:143], v[20:23]
 v_mov_b32 v167, 1.0
 v_mfma_f32_16x16x32_bf16 v[16:19], v[172:175], a[132:135], v[16:19]
 v_mfma_f32_16x16x32_bf16 v[16:19], v[168:171], a[128:131], v[16:19]
 v_mfma_f32_16x16x32_bf16 v[48:51], v[176:179], a[128:131], v[48:51]
 v_mfma_f32_16x16x32_bf16 v[48:51], v[180:183], a[132:135], v[48:51]
 v_mfma_f32_16x16x32_bf16 v[52:55], v[180:183], a[140:143], v[52:55]
 v_mov_b32 v168, 1.0
 v_mfma_f32_16x16x32_bf16 v[52:55], v[176:179], a[136:139], v[52:55]
 v_mfma_f32_16x16x32_bf16 v[56:59], v[176:179], a[144:147], v[56:59]
 v_mov_b32 v169, 1.0
 v_mfma_f32_16x16x32_bf16 v[56:59], v[180:183], a[148:151], v[56:59]
 v_mov_b32 v170, 1.0
 v_mfma_f32_16x16x32_bf16 v[60:63], v[180:183], a[156:159], v[60:63]
 v_mfma_f32_16x16x32_bf16 v[60:63], v[176:179], a[152:155], v[60:63]
 v_mov_b32 v171, 1.0
 v_mfma_f32_16x16x32_bf16 v[64:67], v[176:179], a[160:163], v[64:67]
 v_mov_b32 v172, 1.0
 v_mfma_f32_16x16x32_bf16 v[64:67], v[180:183], a[164:167], v[64:67]
 v_mfma_f32_16x16x32_bf16 v[68:71], v[180:183], a[172:175], v[68:71]
 v_mov_b32 v173, 1.0
 v_mfma_f32_16x16x32_bf16 v[68:71], v[176:179], a[168:171], v[68:71]
 v_mov_b32 v174, 1.0
 v_mfma_f32_16x16x32_bf16 v[72:75], v[176:179], a[176:179], v[72:75]
 v_mfma_f32_16x16x32_bf16 v[72:75], v[180:183], a[180:183], v[72:75]
 v_mov_b32 v175, 1.0
 v_mfma_f32_16x16x32_bf16 v[76:79], v[180:183], a[188:191], v[76:79]
 v_mfma_f32_16x16x32_bf16 v[76:79], v[176:179], a[184:187], v[76:79]
 v_mfma_f32_16x16x32_bf16 v[108:111], v[184:187], a[184:187], v[108:111]
 v_mfma_f32_16x16x32_bf16 v[108:111], v[188:191], a[188:191], v[108:111]
 v_mfma_f32_16x16x32_bf16 v[104:107], v[188:191], a[180:183], v[104:107]
 v_mov_b32 v176, 1.0
 v_mfma_f32_16x16x32_bf16 v[104:107], v[184:187], a[176:179], v[104:107]
 v_mfma_f32_16x16x32_bf16 v[100:103], v[184:187], a[168:171], v[100:103]
 v_mov_b32 v177, 1.0
 v_mfma_f32_16x16x32_bf16 v[100:103], v[188:191], a[172:175], v[100:103]
 v_mov_b32 v178, 1.0
 v_mfma_f32_16x16x32_bf16 v[96:99], v[188:191], a[164:167], v[96:99]
 v_mfma_f32_16x16x32_bf16 v[96:99], v[184:187], a[160:163], v[96:99]
 v_mov_b32 v179, 1.0
 v_mfma_f32_16x16x32_bf16 v[92:95], v[184:187], a[152:155], v[92:95]
 v_mov_b32 v180, 1.0
 v_mfma_f32_16x16x32_bf16 v[92:95], v[188:191], a[156:159], v[92:95]
 v_mfma_f32_16x16x32_bf16 v[88:91], v[188:191], a[148:151], v[88:91]
 v_mov_b32 v181, 1.0
 v_mfma_f32_16x16x32_bf16 v[88:91], v[184:187], a[144:147], v[88:91]
 v_mov_b32 v182, 1.0
 v_mfma_f32_16x16x32_bf16 v[84:87], v[184:187], a[136:139], v[84:87]
 v_mfma_f32_16x16x32_bf16 v[84:87], v[188:191], a[140:143], v[84:87]
 v_mov_b32 v183, 1.0
 v_mfma_f32_16x16x32_bf16 v[80:83], v[188:191], a[132:135], v[80:83]
 v_mfma_f32_16x16x32_bf16 v[80:83], v[184:187], a[128:131], v[80:83]
 v_mfma_f32_16x16x32_bf16 v[112:115], v[192:195], a[128:131], v[112:115]
 ds_read_b128 a[128:131], v2
 v_mfma_f32_16x16x32_bf16 v[112:115], v[196:199], a[132:135], v[112:115]
 ds_read_b128 a[132:135], v2 offset:1024
 v_mfma_f32_16x16x32_bf16 v[116:119], v[196:199], a[140:143], v[116:119]
 ds_read_b128 a[140:143], v2 offset:5120
 v_mov_b32 v184, 1.0
 v_mfma_f32_16x16x32_bf16 v[116:119], v[192:195], a[136:139], v[116:119]
 ds_read_b128 a[136:139], v2 offset:4096
 v_mfma_f32_16x16x32_bf16 v[120:123], v[192:195], a[144:147], v[120:123]
 ds_read_b128 a[144:147], v2 offset:8192
 v_mov_b32 v185, 1.0
 v_mfma_f32_16x16x32_bf16 v[120:123], v[196:199], a[148:151], v[120:123]
 ds_read_b128 a[148:151], v2 offset:9216
 v_mov_b32 v186, 1.0
 v_mfma_f32_16x16x32_bf16 v[124:127], v[196:199], a[156:159], v[124:127]
 ds_read_b128 a[156:159], v2 offset:13312
 v_mfma_f32_16x16x32_bf16 v[124:127], v[192:195], a[152:155], v[124:127]
 ds_read_b128 a[152:155], v2 offset:12288
 v_mov_b32 v187, 1.0
 v_mfma_f32_16x16x32_bf16 v[128:131], v[192:195], a[160:163], v[128:131]
 ds_read_b128 a[160:163], v2 offset:16384
 v_mov_b32 v188, 1.0
 v_mfma_f32_16x16x32_bf16 v[128:131], v[196:199], a[164:167], v[128:131]
 ds_read_b128 a[164:167], v2 offset:17408
 v_mfma_f32_16x16x32_bf16 v[132:135], v[196:199], a[172:175], v[132:135]
 ds_read_b128 a[172:175], v2 offset:21504
 v_mov_b32 v189, 1.0
 v_mfma_f32_16x16x32_bf16 v[132:135], v[192:195], a[168:171], v[132:135]
 ds_read_b128 a[168:171], v2 offset:20480
 v_mov_b32 v190, 1.0
 v_mfma_f32_16x16x32_bf16 a[240:243], v[192:195], a[176:179], a[240:243]
 ds_read_b128 a[176:179], v2 offset:24576
 v_mfma_f32_16x16x32_bf16 a[240:243], v[196:199], a[180:183], a[240:243]
 ds_read_b128 a[180:183], v2 offset:25600
 v_mov_b32 v191, 1.0
 v_mfma_f32_16x16x32_bf16 a[244:247], v[196:199], a[188:191], a[244:247]
 ds_read_b128 a[188:191], v2 offset:29696
 v_mfma_f32_16x16x32_bf16 a[244:247], v[192:195], a[184:187], a[244:247]
 ds_read_b128 a[184:187], v2 offset:28672
 s_waitcnt lgkmcnt(8)
 v_mfma_f32_16x16x32_bf16 v[16:19], v[200:203], a[128:131], v[16:19]
 v_mfma_f32_16x16x32_bf16 v[16:19], v[204:207], a[132:135], v[16:19]
 v_mfma_f32_16x16x32_bf16 v[20:23], v[204:207], a[140:143], v[20:23]
 v_mov_b32 v192, 1.0
 v_mfma_f32_16x16x32_bf16 v[20:23], v[200:203], a[136:139], v[20:23]
 v_mfma_f32_16x16x32_bf16 v[24:27], v[200:203], a[144:147], v[24:27]
 v_mov_b32 v193, 1.0
 v_mfma_f32_16x16x32_bf16 v[24:27], v[204:207], a[148:151], v[24:27]
 v_mov_b32 v194, 1.0
 v_mfma_f32_16x16x32_bf16 v[28:31], v[204:207], a[156:159], v[28:31]
 v_mfma_f32_16x16x32_bf16 v[28:31], v[200:203], a[152:155], v[28:31]
 v_mov_b32 v195, 1.0
 s_waitcnt lgkmcnt(0)
 v_mfma_f32_16x16x32_bf16 v[32:35], v[200:203], a[160:163], v[32:35]
 v_mov_b32 v196, 1.0
 v_mfma_f32_16x16x32_bf16 v[32:35], v[204:207], a[164:167], v[32:35]
 v_mfma_f32_16x16x32_bf16 v[36:39], v[204:207], a[172:175], v[36:39]
 v_mov_b32 v197, 1.0
 v_mfma_f32_16x16x32_bf16 v[36:39], v[200:203], a[168:171], v[36:39]
 v_mov_b32 v198, 1.0
 v_mfma_f32_16x16x32_bf16 v[40:43], v[200:203], a[176:179], v[40:43]
 v_mfma_f32_16x16x32_bf16 v[40:43], v[204:207], a[180:183], v[40:43]
 v_mov_b32 v199, 1.0
 v_mfma_f32_16x16x32_bf16 v[44:47], v[204:207], a[188:191], v[44:47]
 v_mfma_f32_16x16x32_bf16 v[44:47], v[200:203], a[184:187], v[44:47]
 v_mfma_f32_16x16x32_bf16 v[76:79], v[208:211], a[184:187], v[76:79]
 v_mfma_f32_16x16x32_bf16 v[76:79], v[212:215], a[188:191], v[76:79]
 v_mfma_f32_16x16x32_bf16 v[72:75], v[212:215], a[180:183], v[72:75]
 v_mov_b32 v200, 1.0
 v_mfma_f32_16x16x32_bf16 v[72:75], v[208:211], a[176:179], v[72:75]
 v_mfma_f32_16x16x32_bf16 v[68:71], v[208:211], a[168:171], v[68:71]
 v_mov_b32 v201, 1.0
 v_mfma_f32_16x16x32_bf16 v[68:71], v[212:215], a[172:175], v[68:71]
 v_mov_b32 v202, 1.0
 v_mfma_f32_16x16x32_bf16 v[64:67], v[212:215], a[164:167], v[64:67]
 v_mfma_f32_16x16x32_bf16 v[64:67], v[208:211], a[160:163], v[64:67]
 v_mov_b32 v203, 1.0
 v_mfma_f32_16x16x32_bf16 v[60:63], v[208:211], a[152:155], v[60:63]
 v_mov_b32 v204, 1.0
 v_mfma_f32_16x16x32_bf16 v[60:63], v[212:215], a[156:159], v[60:63]
 v_mfma_f32_16x16x32_bf16 v[56:59], v[212:215], a[148:151], v[56:59]
 v_mov_b32 v205, 1.0
 v_mfma_f32_16x16x32_bf16 v[56:59], v[208:211], a[144:147], v[56:59]
 v_mov_b32 v206, 1.0
 v_mfma_f32_16x16x32_bf16 v[52:55], v[208:211], a[136:139], v[52:55]
 v_mfma_f32_16x16x32_bf16 v[52:55], v[212:215], a[140:143], v[52:55]
 v_mov_b32 v207, 1.0
 v_mfma_f32_16x16x32_bf16 v[48:51], v[212:215], a[132:135], v[48:51]
 v_mfma_f32_16x16x32_bf16 v[48:51], v[208:211], a[128:131], v[48:51]
 v_mfma_f32_16x16x32_bf16 v[80:83], a[224:227], a[128:131], v[80:83]
 v_mfma_f32_16x16x32_bf16 v[80:83], a[228:231], a[132:135], v[80:83]
 v_mfma_f32_16x16x32_bf16 v[84:87], a[228:231], a[140:143], v[84:87]
 v_mov_b32 v208, 1.0
 s_waitcnt vmcnt(16)
 v_cmp_gt_i32 vcc, s27, v4
 s_and_b64 vcc, exec, vcc
 s_cbranch_vccnz Lspin_pro
Lok_pro:
 s_add_u32 s27, s27, 64
 v_mfma_f32_16x16x32_bf16 v[84:87], a[224:227], a[136:139], v[84:87]
 v_mfma_f32_16x16x32_bf16 v[88:91], a[224:227], a[144:147], v[88:91]
 v_mov_b32 v209, 1.0
 v_mfma_f32_16x16x32_bf16 v[88:91], a[228:231], a[148:151], v[88:91]
 v_mov_b32 v210, 1.0
 v_mfma_f32_16x16x32_bf16 v[92:95], a[228:231], a[156:159], v[92:95]
 v_mfma_f32_16x16x32_bf16 v[92:95], a[224:227], a[152:155], v[92:95]
 v_mov_b32 v211, 1.0
 v_mfma_f32_16x16x32_bf16 v[96:99], a[224:227], a[160:163], v[96:99]
 v_mov_b32 v212, 1.0
 v_mfma_f32_16x16x32_bf16 v[96:99], a[228:231], a[164:167], v[96:99]
 v_mfma_f32_16x16x32_bf16 v[100:103], a[228:231], a[172:175], v[100:103]
 v_mov_b32 v213, 1.0
 v_mfma_f32_16x16x32_bf16 v[100:103], a[224:227], a[168:171], v[100:103]
 v_mov_b32 v214, 1.0
 v_mfma_f32_16x16x32_bf16 v[104:107], a[224:227], a[176:179], v[104:107]
 v_mfma_f32_16x16x32_bf16 v[104:107], a[228:231], a[180:183], v[104:107]
 v_mov_b32 v215, 1.0
 v_mfma_f32_16x16x32_bf16 v[108:111], a[228:231], a[188:191], v[108:111]
 v_mfma_f32_16x16x32_bf16 v[108:111], a[224:227], a[184:187], v[108:111]
 v_mfma_f32_16x16x32_bf16 a[244:247], a[232:235], a[184:187], a[244:247]
 ds_read_b128 a[184:187], v2 offset:61440
 v_mfma_f32_16x16x32_bf16 a[244:247], a[236:239], a[188:191], a[244:247]
 global_load_dwordx4 a[228:231], v0, s[70:71] offset:-3072 sc1
 ds_read_b128 a[188:191], v2 offset:62464
 v_mfma_f32_16x16x32_bf16 a[240:243], a[236:239], a[180:183], a[240:243]
 ds_read_b128 a[180:183], v2 offset:58368
 v_mfma_f32_16x16x32_bf16 a[240:243], a[232:235], a[176:179], a[240:243]
 global_load_dwordx4 a[224:227], v0, s[70:71] offset:-4096 sc1
 ds_read_b128 a[176:179], v2 offset:57344
 v_mfma_f32_16x16x32_bf16 v[132:135], a[232:235], a[168:171], v[132:135]
 ds_read_b128 a[168:171], v2 offset:53248
 v_mfma_f32_16x16x32_bf16 v[132:135], a[236:239], a[172:175], v[132:135]
 ds_read_b128 a[172:175], v2 offset:54272
 v_mfma_f32_16x16x32_bf16 v[128:131], a[236:239], a[164:167], v[128:131]
 ds_read_b128 a[164:167], v2 offset:50176
 v_mfma_f32_16x16x32_bf16 v[128:131], a[232:235], a[160:163], v[128:131]
 ds_read_b128 a[160:163], v2 offset:49152
 v_mfma_f32_16x16x32_bf16 v[124:127], a[232:235], a[152:155], v[124:127]
 ds_read_b128 a[152:155], v2 offset:45056
 v_mfma_f32_16x16x32_bf16 v[124:127], a[236:239], a[156:159], v[124:127]
 ds_read_b128 a[156:159], v2 offset:46080
 v_mfma_f32_16x16x32_bf16 v[120:123], a[236:239], a[148:151], v[120:123]
 ds_read_b128 a[148:151], v2 offset:41984
 v_mfma_f32_16x16x32_bf16 v[120:123], a[232:235], a[144:147], v[120:123]
 ds_read_b128 a[144:147], v2 offset:40960
 v_mfma_f32_16x16x32_bf16 v[116:119], a[232:235], a[136:139], v[116:119]
 ds_read_b128 a[136:139], v2 offset:36864
 v_mfma_f32_16x16x32_bf16 v[116:119], a[236:239], a[140:143], v[116:119]
 ds_read_b128 a[140:143], v2 offset:37888
 v_mfma_f32_16x16x32_bf16 v[112:115], a[236:239], a[132:135], v[112:115]
 ds_read_b128 a[132:135], v2 offset:33792
 v_mfma_f32_16x16x32_bf16 v[112:115], a[232:235], a[128:131], v[112:115]
 ds_read_b128 a[128:131], v2 offset:32768
 s_waitcnt lgkmcnt(8)
 v_mfma_f32_16x16x32_bf16 v[44:47], a[192:195], a[184:187], v[44:47]
 v_mfma_f32_16x16x32_bf16 v[44:47], a[196:199], a[188:191], v[44:47]
 global_load_dwordx4 a[236:239], v0, s[70:71] offset:-1024 sc1
 v_mfma_f32_16x16x32_bf16 v[40:43], a[196:199], a[180:183], v[40:43]
 v_mfma_f32_16x16x32_bf16 v[40:43], a[192:195], a[176:179], v[40:43]
 global_load_dwordx4 a[232:235], v0, s[70:71] offset:-2048 sc1
 v_mfma_f32_16x16x32_bf16 v[36:39], a[192:195], a[168:171], v[36:39]
 v_mfma_f32_16x16x32_bf16 v[36:39], a[196:199], a[172:175], v[36:39]
 v_mfma_f32_16x16x32_bf16 v[32:35], a[196:199], a[164:167], v[32:35]
 v_mfma_f32_16x16x32_bf16 v[32:35], a[192:195], a[160:163], v[32:35]
 s_waitcnt lgkmcnt(0)
 v_mfma_f32_16x16x32_bf16 v[28:31], a[192:195], a[152:155], v[28:31]
 v_mfma_f32_16x16x32_bf16 v[28:31], a[196:199], a[156:159], v[28:31]
 v_mfma_f32_16x16x32_bf16 v[24:27], a[196:199], a[148:151], v[24:27]
 v_mfma_f32_16x16x32_bf16 v[24:27], a[192:195], a[144:147], v[24:27]
 v_mfma_f32_16x16x32_bf16 v[20:23], a[192:195], a[136:139], v[20:23]
 v_mfma_f32_16x16x32_bf16 v[20:23], a[196:199], a[140:143], v[20:23]
 v_mfma_f32_16x16x32_bf16 v[16:19], a[196:199], a[132:135], v[16:19]
 v_mfma_f32_16x16x32_bf16 v[16:19], a[192:195], a[128:131], v[16:19]
 v_mfma_f32_16x16x32_bf16 v[48:51], a[200:203], a[128:131], v[48:51]
 v_mfma_f32_16x16x32_bf16 v[48:51], a[204:207], a[132:135], v[48:51]
 global_load_dwordx4 a[196:199], v0, s[70:71] offset:1024 sc1
 v_mfma_f32_16x16x32_bf16 v[52:55], a[204:207], a[140:143], v[52:55]
 v_mfma_f32_16x16x32_bf16 v[52:55], a[200:203], a[136:139], v[52:55]
 global_load_dwordx4 a[192:195], v0, s[70:71] offset:0 sc1
 v_mfma_f32_16x16x32_bf16 v[56:59], a[200:203], a[144:147], v[56:59]
 v_mfma_f32_16x16x32_bf16 v[56:59], a[204:207], a[148:151], v[56:59]
 v_mfma_f32_16x16x32_bf16 v[60:63], a[204:207], a[156:159], v[60:63]
 v_mfma_f32_16x16x32_bf16 v[60:63], a[200:203], a[152:155], v[60:63]
 v_mfma_f32_16x16x32_bf16 v[64:67], a[200:203], a[160:163], v[64:67]
 v_mfma_f32_16x16x32_bf16 v[64:67], a[204:207], a[164:167], v[64:67]
 v_mfma_f32_16x16x32_bf16 v[68:71], a[204:207], a[172:175], v[68:71]
 v_mfma_f32_16x16x32_bf16 v[68:71], a[200:203], a[168:171], v[68:71]
 v_mfma_f32_16x16x32_bf16 v[72:75], a[200:203], a[176:179], v[72:75]
 v_mfma_f32_16x16x32_bf16 v[72:75], a[204:207], a[180:183], v[72:75]
 v_mfma_f32_16x16x32_bf16 v[76:79], a[204:207], a[188:191], v[76:79]
 v_mfma_f32_16x16x32_bf16 v[76:79], a[200:203], a[184:187], v[76:79]
 v_mfma_f32_16x16x32_bf16 v[108:111], a[208:211], a[184:187], v[108:111]
 v_mfma_f32_16x16x32_bf16 v[108:111], a[212:215], a[188:191], v[108:111]
 global_load_dwordx4 a[204:207], v0, s[70:71] offset:3072 sc1
 v_mfma_f32_16x16x32_bf16 v[104:107], a[212:215], a[180:183], v[104:107]
 v_mfma_f32_16x16x32_bf16 v[104:107], a[208:211], a[176:179], v[104:107]
 global_load_dwordx4 a[200:203], v0, s[70:71] offset:2048 sc1
 v_mfma_f32_16x16x32_bf16 v[100:103], a[208:211], a[168:171], v[100:103]
 s_add_u32 s70, s70, 8192
 s_addc_u32 s71, s71, 0
 v_mfma_f32_16x16x32_bf16 v[100:103], a[212:215], a[172:175], v[100:103]
 v_mfma_f32_16x16x32_bf16 v[96:99], a[212:215], a[164:167], v[96:99]
 v_mfma_f32_16x16x32_bf16 v[96:99], a[208:211], a[160:163], v[96:99]
 v_mfma_f32_16x16x32_bf16 v[92:95], a[208:211], a[152:155], v[92:95]
 v_mfma_f32_16x16x32_bf16 v[92:95], a[212:215], a[156:159], v[92:95]
 v_mfma_f32_16x16x32_bf16 v[88:91], a[212:215], a[148:151], v[88:91]
 v_mfma_f32_16x16x32_bf16 v[88:91], a[208:211], a[144:147], v[88:91]
 v_mfma_f32_16x16x32_bf16 v[84:87], a[208:211], a[136:139], v[84:87]
 v_mfma_f32_16x16x32_bf16 v[84:87], a[212:215], a[140:143], v[84:87]
 v_mfma_f32_16x16x32_bf16 v[80:83], a[212:215], a[132:135], v[80:83]
 v_mfma_f32_16x16x32_bf16 v[80:83], a[208:211], a[128:131], v[80:83]
 v_mfma_f32_16x16x32_bf16 v[112:115], a[216:219], a[128:131], v[112:115]
 v_mfma_f32_16x16x32_bf16 v[112:115], a[220:223], a[132:135], v[112:115]
 global_load_dwordx4 a[212:215], v0, s[70:71] offset:-3072 sc1
 v_mfma_f32_16x16x32_bf16 v[116:119], a[220:223], a[140:143], v[116:119]
 v_mfma_f32_16x16x32_bf16 v[116:119], a[216:219], a[136:139], v[116:119]
 global_load_dwordx4 a[208:211], v0, s[70:71] offset:-4096 sc1
 v_mfma_f32_16x16x32_bf16 v[120:123], a[216:219], a[144:147], v[120:123]
 v_mfma_f32_16x16x32_bf16 v[120:123], a[220:223], a[148:151], v[120:123]
 v_mfma_f32_16x16x32_bf16 v[124:127], a[220:223], a[156:159], v[124:127]
 v_mfma_f32_16x16x32_bf16 v[124:127], a[216:219], a[152:155], v[124:127]
 v_mfma_f32_16x16x32_bf16 v[128:131], a[216:219], a[160:163], v[128:131]
 v_mfma_f32_16x16x32_bf16 v[128:131], a[220:223], a[164:167], v[128:131]
 v_mfma_f32_16x16x32_bf16 v[132:135], a[220:223], a[172:175], v[132:135]
 v_mfma_f32_16x16x32_bf16 v[132:135], a[216:219], a[168:171], v[132:135]
 v_mfma_f32_16x16x32_bf16 a[240:243], a[216:219], a[176:179], a[240:243]
 v_mfma_f32_16x16x32_bf16 a[240:243], a[220:223], a[180:183], a[240:243]
 v_mfma_f32_16x16x32_bf16 a[244:247], a[220:223], a[188:191], a[244:247]
 global_load_dwordx4 a[220:223], v0, s[70:71] offset:-1024 sc1
 v_mfma_f32_16x16x32_bf16 a[244:247], a[216:219], a[184:187], a[244:247]
 global_load_dwordx4 a[216:219], v0, s[70:71] offset:-2048 sc1
 s_waitcnt vmcnt(10)
 v_mfma_f32_16x16x32_bf16 v[164:167], a[224:227], a[184:187], v[164:167]
 v_lshrrev_b32 v5, 4, v1
 v_mfma_f32_16x16x32_bf16 v[164:167], a[228:231], a[188:191], v[164:167]
 v_and_b32 v5, 48, v5
 v_mfma_f32_16x16x32_bf16 v[160:163], a[228:231], a[180:183], v[160:163]
 v_xor_b32 v5, v5, v1
 v_mfma_f32_16x16x32_bf16 v[160:163], a[224:227], a[176:179], v[160:163]
 v_and_b32 v5, 112, v5
 v_mfma_f32_16x16x32_bf16 v[156:159], a[224:227], a[168:171], v[156:159]
 v_and_b32 v6, 240, v1
 v_mfma_f32_16x16x32_bf16 v[156:159], a[228:231], a[172:175], v[156:159]
 v_lshl_add_u32 v5, v6, 3, v5
 v_mfma_f32_16x16x32_bf16 v[152:155], a[228:231], a[164:167], v[152:155]
 v_add_u32 v8, s50, v5
 v_mfma_f32_16x16x32_bf16 v[152:155], a[224:227], a[160:163], v[152:155]
 v_xor_b32 v9, 64, v8
 v_mfma_f32_16x16x32_bf16 v[148:151], a[224:227], a[152:155], v[148:151]
 v_mfma_f32_16x16x32_bf16 v[148:151], a[228:231], a[156:159], v[148:151]
 ds_read_b128 a[64:67], v8 offset:2048
 ds_read_b128 a[96:99], v9 offset:2048
 v_mfma_f32_16x16x32_bf16 v[144:147], a[228:231], a[148:151], v[144:147]
 v_mfma_f32_16x16x32_bf16 v[144:147], a[224:227], a[144:147], v[144:147]
 v_mfma_f32_16x16x32_bf16 v[140:143], a[224:227], a[136:139], v[140:143]
 v_mfma_f32_16x16x32_bf16 v[140:143], a[228:231], a[140:143], v[140:143]
 v_mfma_f32_16x16x32_bf16 v[136:139], a[228:231], a[132:135], v[136:139]
 ds_read_b128 a[68:71], v8 offset:6144
 v_mfma_f32_16x16x32_bf16 v[136:139], a[224:227], a[128:131], v[136:139]
 ds_read_b128 a[100:103], v9 offset:6144
 s_waitcnt vmcnt(8)
 v_mfma_f32_16x16x32_bf16 v[168:171], a[232:235], a[128:131], v[168:171]
 v_mfma_f32_16x16x32_bf16 v[168:171], a[236:239], a[132:135], v[168:171]
 global_load_dwordx4 a[228:231], v0, s[70:71] offset:1024 sc1
 v_mfma_f32_16x16x32_bf16 v[172:175], a[236:239], a[140:143], v[172:175]
 v_mfma_f32_16x16x32_bf16 v[172:175], a[232:235], a[136:139], v[172:175]
 global_load_dwordx4 a[224:227], v0, s[70:71] offset:0 sc1
 s_waitcnt lgkmcnt(2)
 v_mfma_f32_16x16x32_bf16 v[176:179], a[232:235], a[144:147], v[176:179]
 ds_write_b128 v3, a[64:67] offset:2048
 v_mfma_f32_16x16x32_bf16 v[176:179], a[236:239], a[148:151], v[176:179]
 ds_write_b128 v3, a[96:99] offset:3072
 v_mfma_f32_16x16x32_bf16 v[180:183], a[236:239], a[156:159], v[180:183]
 v_mfma_f32_16x16x32_bf16 v[180:183], a[232:235], a[152:155], v[180:183]
 ds_read_b128 a[72:75], v8 offset:10240
 v_mfma_f32_16x16x32_bf16 v[184:187], a[232:235], a[160:163], v[184:187]
 ds_read_b128 a[104:107], v9 offset:10240
 v_mfma_f32_16x16x32_bf16 v[184:187], a[236:239], a[164:167], v[184:187]
 v_mfma_f32_16x16x32_bf16 v[188:191], a[236:239], a[172:175], v[188:191]
 v_mfma_f32_16x16x32_bf16 v[188:191], a[232:235], a[168:171], v[188:191]
 v_mfma_f32_16x16x32_bf16 v[192:195], a[232:235], a[176:179], v[192:195]
 s_waitcnt lgkmcnt(4)
 v_mfma_f32_16x16x32_bf16 v[192:195], a[236:239], a[180:183], v[192:195]
 ds_write_b128 v3, a[68:71] offset:6144
 ds_write_b128 v3, a[100:103] offset:7168
 v_mfma_f32_16x16x32_bf16 v[196:199], a[236:239], a[188:191], v[196:199]
 v_mfma_f32_16x16x32_bf16 v[196:199], a[232:235], a[184:187], v[196:199]
 ds_read_b128 a[76:79], v8 offset:14336
 s_waitcnt vmcnt(8)
 v_mfma_f32_16x16x32_bf16 v[228:231], a[192:195], a[184:187], v[228:231]
 ds_read_b128 a[108:111], v9 offset:14336
 v_mfma_f32_16x16x32_bf16 v[228:231], a[196:199], a[188:191], v[228:231]
 global_load_dwordx4 a[236:239], v0, s[70:71] offset:3072 sc1
 v_mfma_f32_16x16x32_bf16 v[224:227], a[196:199], a[180:183], v[224:227]
 v_mfma_f32_16x16x32_bf16 v[224:227], a[192:195], a[176:179], v[224:227]
 global_load_dwordx4 a[232:235], v0, s[70:71] offset:2048 sc1
 v_mfma_f32_16x16x32_bf16 v[220:223], a[192:195], a[168:171], v[220:223]
 s_waitcnt lgkmcnt(4)
 s_add_u32 s70, s70, 8192
 s_addc_u32 s71, s71, 0
 v_mfma_f32_16x16x32_bf16 v[220:223], a[196:199], a[172:175], v[220:223]
 ds_write_b128 v3, a[72:75] offset:10240
 v_mfma_f32_16x16x32_bf16 v[216:219], a[196:199], a[164:167], v[216:219]
 ds_write_b128 v3, a[104:107] offset:11264
 v_mfma_f32_16x16x32_bf16 v[216:219], a[192:195], a[160:163], v[216:219]
 v_mfma_f32_16x16x32_bf16 v[212:215], a[192:195], a[152:155], v[212:215]
 ds_read_b128 a[80:83], v8 offset:18432
 v_mfma_f32_16x16x32_bf16 v[212:215], a[196:199], a[156:159], v[212:215]
 ds_read_b128 a[112:115], v9 offset:18432
 v_mfma_f32_16x16x32_bf16 v[208:211], a[196:199], a[148:151], v[208:211]
 v_mfma_f32_16x16x32_bf16 v[208:211], a[192:195], a[144:147], v[208:211]
 v_mfma_f32_16x16x32_bf16 v[204:207], a[192:195], a[136:139], v[204:207]
 s_waitcnt lgkmcnt(4)
 ds_write_b128 v3, a[76:79] offset:14336
 ds_write_b128 v3, a[108:111] offset:15360
 v_mfma_f32_16x16x32_bf16 v[204:207], a[196:199], a[140:143], v[204:207]
 v_mfma_f32_16x16x32_bf16 v[200:203], a[196:199], a[132:135], v[200:203]
 v_mfma_f32_16x16x32_bf16 v[200:203], a[192:195], a[128:131], v[200:203]
 s_waitcnt vmcnt(8)
 v_mfma_f32_16x16x32_bf16 v[232:235], a[200:203], a[128:131], v[232:235]
 ds_read_b128 a[128:131], v2
 ds_read_b128 a[84:87], v8 offset:22528
 v_mfma_f32_16x16x32_bf16 v[232:235], a[204:207], a[132:135], v[232:235]
 global_load_dwordx4 a[196:199], v0, s[70:71] offset:-3072 sc1
 ds_read_b128 a[132:135], v2 offset:1024
 v_mfma_f32_16x16x32_bf16 v[236:239], a[204:207], a[140:143], v[236:239]
 ds_read_b128 a[140:143], v2 offset:5120
 ds_read_b128 a[116:119], v9 offset:22528
 v_mfma_f32_16x16x32_bf16 v[236:239], a[200:203], a[136:139], v[236:239]
 global_load_dwordx4 a[192:195], v0, s[70:71] offset:-4096 sc1
 ds_read_b128 a[136:139], v2 offset:4096
 v_mfma_f32_16x16x32_bf16 v[240:243], a[200:203], a[144:147], v[240:243]
 ds_read_b128 a[144:147], v2 offset:8192
 v_mfma_f32_16x16x32_bf16 v[240:243], a[204:207], a[148:151], v[240:243]
 ds_read_b128 a[148:151], v2 offset:9216
 s_waitcnt lgkmcnt(10)
 v_mfma_f32_16x16x32_bf16 v[244:247], a[204:207], a[156:159], v[244:247]
 ds_read_b128 a[156:159], v2 offset:13312
 v_mfma_f32_16x16x32_bf16 v[244:247], a[200:203], a[152:155], v[244:247]
 ds_read_b128 a[152:155], v2 offset:12288
 v_mfma_f32_16x16x32_bf16 v[248:251], a[200:203], a[160:163], v[248:251]
 ds_read_b128 a[160:163], v2 offset:16384
 v_mfma_f32_16x16x32_bf16 v[248:251], a[204:207], a[164:167], v[248:251]
 ds_read_b128 a[164:167], v2 offset:17408
 v_mfma_f32_16x16x32_bf16 v[252:255], a[204:207], a[172:175], v[252:255]
 ds_read_b128 a[172:175], v2 offset:21504
 v_mfma_f32_16x16x32_bf16 v[252:255], a[200:203], a[168:171], v[252:255]
 ds_read_b128 a[168:171], v2 offset:20480
 v_mfma_f32_16x16x32_bf16 a[248:251], a[200:203], a[176:179], a[248:251]
 ds_read_b128 a[176:179], v2 offset:24576
 v_mfma_f32_16x16x32_bf16 a[248:251], a[204:207], a[180:183], a[248:251]
 ds_read_b128 a[180:183], v2 offset:25600
 v_mfma_f32_16x16x32_bf16 a[252:255], a[204:207], a[188:191], a[252:255]
 ds_read_b128 a[188:191], v2 offset:29696
 v_mfma_f32_16x16x32_bf16 a[252:255], a[200:203], a[184:187], a[252:255]
 ds_read_b128 a[184:187], v2 offset:28672
 ds_write_b128 v3, a[80:83] offset:18432
 ds_write_b128 v3, a[112:115] offset:19456
 ds_read_b128 a[88:91], v8 offset:26624
 ds_read_b128 a[120:123], v9 offset:26624
 s_waitcnt vmcnt(8) lgkmcnt(12)
 v_mfma_f32_16x16x32_bf16 v[136:139], a[208:211], a[128:131], v[136:139]
 v_mfma_f32_16x16x32_bf16 v[136:139], a[212:215], a[132:135], v[136:139]
 global_load_dwordx4 a[204:207], v0, s[70:71] offset:-1024 sc1
 v_mfma_f32_16x16x32_bf16 v[140:143], a[212:215], a[140:143], v[140:143]
 ds_write_b128 v3, a[84:87] offset:22528
 ds_write_b128 v3, a[116:119] offset:23552
 v_mfma_f32_16x16x32_bf16 v[140:143], a[208:211], a[136:139], v[140:143]
 global_load_dwordx4 a[200:203], v0, s[70:71] offset:-2048 sc1
 ds_read_b128 a[92:95], v8 offset:30720
 v_mfma_f32_16x16x32_bf16 v[144:147], a[208:211], a[144:147], v[144:147]
 ds_read_b128 a[124:127], v9 offset:30720
 v_mfma_f32_16x16x32_bf16 v[144:147], a[212:215], a[148:151], v[144:147]
 v_mfma_f32_16x16x32_bf16 v[148:151], a[212:215], a[156:159], v[148:151]
 v_mfma_f32_16x16x32_bf16 v[148:151], a[208:211], a[152:155], v[148:151]
 s_waitcnt lgkmcnt(4)
 ds_write_b128 v3, a[88:91] offset:26624
 v_mfma_f32_16x16x32_bf16 v[152:155], a[208:211], a[160:163], v[152:155]
 ds_write_b128 v3, a[120:123] offset:27648
 v_mfma_f32_16x16x32_bf16 v[152:155], a[212:215], a[164:167], v[152:155]
 v_mfma_f32_16x16x32_bf16 v[156:159], a[212:215], a[172:175], v[156:159]
 v_mfma_f32_16x16x32_bf16 v[156:159], a[208:211], a[168:171], v[156:159]
 v_mfma_f32_16x16x32_bf16 v[160:163], a[208:211], a[176:179], v[160:163]
 v_mfma_f32_16x16x32_bf16 v[160:163], a[212:215], a[180:183], v[160:163]
 s_waitcnt lgkmcnt(2)
 v_mfma_f32_16x16x32_bf16 v[164:167], a[212:215], a[188:191], v[164:167]
 ds_write_b128 v3, a[92:95] offset:30720
 v_mfma_f32_16x16x32_bf16 v[164:167], a[208:211], a[184:187], v[164:167]
 ds_write_b128 v3, a[124:127] offset:31744
 s_waitcnt vmcnt(8)
 v_mfma_f32_16x16x32_bf16 v[196:199], a[216:219], a[184:187], v[196:199]
 v_bfe_u32 v4, v3, 8, 2
 v_mfma_f32_16x16x32_bf16 v[196:199], a[220:223], a[188:191], v[196:199]
 global_load_dwordx4 a[212:215], v0, s[70:71] offset:1024 sc1
 v_lshl_add_u32 v4, v4, 5, s51
 v_mfma_f32_16x16x32_bf16 v[192:195], a[220:223], a[180:183], v[192:195]
 ds_read_b128 v[8:11], v4
 v_mfma_f32_16x16x32_bf16 v[192:195], a[216:219], a[176:179], v[192:195]
 global_load_dwordx4 a[208:211], v0, s[70:71] offset:0 sc1
 v_mfma_f32_16x16x32_bf16 v[188:191], a[216:219], a[168:171], v[188:191]
 v_mfma_f32_16x16x32_bf16 v[188:191], a[220:223], a[172:175], v[188:191]
 v_mfma_f32_16x16x32_bf16 v[184:187], a[220:223], a[164:167], v[184:187]
 v_mfma_f32_16x16x32_bf16 v[184:187], a[216:219], a[160:163], v[184:187]
 v_mfma_f32_16x16x32_bf16 v[180:183], a[216:219], a[152:155], v[180:183]
 v_mfma_f32_16x16x32_bf16 v[180:183], a[220:223], a[156:159], v[180:183]
 v_mfma_f32_16x16x32_bf16 v[176:179], a[220:223], a[148:151], v[176:179]
 v_mfma_f32_16x16x32_bf16 v[176:179], a[216:219], a[144:147], v[176:179]
 s_waitcnt lgkmcnt(0)
 v_add_f32 v16, v16, v8
 v_mfma_f32_16x16x32_bf16 v[172:175], a[216:219], a[136:139], v[172:175]
 ds_read_b128 v[12:15], v4 offset:16
 v_mfma_f32_16x16x32_bf16 v[172:175], a[220:223], a[140:143], v[172:175]
 v_add_f32 v17, v17, v9
 v_mfma_f32_16x16x32_bf16 v[168:171], a[220:223], a[132:135], v[168:171]
 v_add_f32 v18, v18, v10
 v_mfma_f32_16x16x32_bf16 v[168:171], a[216:219], a[128:131], v[168:171]
 v_add_f32 v19, v19, v11
 s_waitcnt vmcnt(8)
 v_mfma_f32_16x16x32_bf16 v[200:203], a[224:227], a[128:131], v[200:203]
 v_add_f32 v20, v20, v8
 v_mfma_f32_16x16x32_bf16 v[200:203], a[228:231], a[132:135], v[200:203]
 global_load_dwordx4 a[220:223], v0, s[70:71] offset:3072 sc1
 v_add_f32 v21, v21, v9
 v_mfma_f32_16x16x32_bf16 v[204:207], a[228:231], a[140:143], v[204:207]
 v_add_f32 v22, v22, v10
 v_mfma_f32_16x16x32_bf16 v[204:207], a[224:227], a[136:139], v[204:207]
 global_load_dwordx4 a[216:219], v0, s[70:71] offset:2048 sc1
 v_add_f32 v23, v23, v11
 v_mfma_f32_16x16x32_bf16 v[208:211], a[224:227], a[144:147], v[208:211]
 v_add_f32 v24, v24, v8
 s_add_u32 s70, s70, 8192
 s_addc_u32 s71, s71, 0
 v_mfma_f32_16x16x32_bf16 v[208:211], a[228:231], a[148:151], v[208:211]
 v_add_f32 v25, v25, v9
 v_mfma_f32_16x16x32_bf16 v[212:215], a[228:231], a[156:159], v[212:215]
 v_add_f32 v26, v26, v10
 v_mfma_f32_16x16x32_bf16 v[212:215], a[224:227], a[152:155], v[212:215]
 v_add_f32 v27, v27, v11
 v_mfma_f32_16x16x32_bf16 v[216:219], a[224:227], a[160:163], v[216:219]
 v_add_f32 v28, v28, v8
 v_mfma_f32_16x16x32_bf16 v[216:219], a[228:231], a[164:167], v[216:219]
 v_add_f32 v29, v29, v9
 v_mfma_f32_16x16x32_bf16 v[220:223], a[228:231], a[172:175], v[220:223]
 v_add_f32 v30, v30, v10
 v_mfma_f32_16x16x32_bf16 v[220:223], a[224:227], a[168:171], v[220:223]
 v_add_f32 v31, v31, v11
 v_add_f32 v32, v32, v8
 v_mfma_f32_16x16x32_bf16 v[224:227], a[224:227], a[176:179], v[224:227]
 v_add_f32 v33, v33, v9
 v_mfma_f32_16x16x32_bf16 v[224:227], a[228:231], a[180:183], v[224:227]
 v_add_f32 v34, v34, v10
 v_mfma_f32_16x16x32_bf16 v[228:231], a[228:231], a[188:191], v[228:231]
 v_add_f32 v35, v35, v11
 v_mfma_f32_16x16x32_bf16 v[228:231], a[224:227], a[184:187], v[228:231]
 v_add_f32 v36, v36, v8
 v_add_f32 v37, v37, v9
 s_waitcnt vmcnt(8)
 v_mfma_f32_16x16x32_bf16 a[252:255], a[232:235], a[184:187], a[252:255]
 ds_read_b128 a[184:187], v1 offset:61440
 v_add_f32 v38, v38, v10
 v_mfma_f32_16x16x32_bf16 a[252:255], a[236:239], a[188:191], a[252:255]
 global_load_dwordx4 a[228:231], v0, s[70:71] offset:-3072 sc1
 ds_read_b128 a[188:191], v1 offset:62464
 v_mfma_f32_16x16x32_bf16 a[248:251], a[236:239], a[180:183], a[248:251]
 ds_read_b128 a[180:183], v1 offset:58368
 v_add_f32 v39, v39, v11
 v_mfma_f32_16x16x32_bf16 a[248:251], a[232:235], a[176:179], a[248:251]
 global_load_dwordx4 a[224:227], v0, s[70:71] offset:-4096 sc1
 ds_read_b128 a[176:179], v1 offset:57344
 v_mfma_f32_16x16x32_bf16 v[252:255], a[232:235], a[168:171], v[252:255]
 ds_read_b128 a[168:171], v1 offset:53248
 v_add_f32 v40, v40, v8
 v_mfma_f32_16x16x32_bf16 v[252:255], a[236:239], a[172:175], v[252:255]
 ds_read_b128 a[172:175], v1 offset:54272
 v_add_f32 v41, v41, v9
 v_mfma_f32_16x16x32_bf16 v[248:251], a[236:239], a[164:167], v[248:251]
 ds_read_b128 a[164:167], v1 offset:50176
 v_add_f32 v42, v42, v10
 v_mfma_f32_16x16x32_bf16 v[248:251], a[232:235], a[160:163], v[248:251]
 ds_read_b128 a[160:163], v1 offset:49152
 v_add_f32 v43, v43, v11
 v_mfma_f32_16x16x32_bf16 v[244:247], a[232:235], a[152:155], v[244:247]
 ds_read_b128 a[152:155], v1 offset:45056
 v_add_f32 v44, v44, v8
 v_mfma_f32_16x16x32_bf16 v[244:247], a[236:239], a[156:159], v[244:247]
 ds_read_b128 a[156:159], v1 offset:46080
 v_add_f32 v45, v45, v9
 v_mfma_f32_16x16x32_bf16 v[240:243], a[236:239], a[148:151], v[240:243]
 ds_read_b128 a[148:151], v1 offset:41984
 v_add_f32 v46, v46, v10
 v_mfma_f32_16x16x32_bf16 v[240:243], a[232:235], a[144:147], v[240:243]
 ds_read_b128 a[144:147], v1 offset:40960
 v_add_f32 v47, v47, v11
 s_waitcnt lgkmcnt(12)
 v_mfma_f32_16x16x32_bf16 v[236:239], a[232:235], a[136:139], v[236:239]
 ds_read_b128 a[136:139], v1 offset:36864
 v_add_f32 v48, v48, v12
 v_mfma_f32_16x16x32_bf16 v[236:239], a[236:239], a[140:143], v[236:239]
 ds_read_b128 a[140:143], v1 offset:37888
 ds_read_b128 v[8:11], v4 offset:128
 v_mfma_f32_16x16x32_bf16 v[232:235], a[236:239], a[132:135], v[232:235]
 ds_read_b128 a[132:135], v1 offset:33792
 v_add_f32 v49, v49, v13
 v_mfma_f32_16x16x32_bf16 v[232:235], a[232:235], a[128:131], v[232:235]
 ds_read_b128 a[128:131], v1 offset:32768
 v_add_f32 v50, v50, v14
 s_waitcnt vmcnt(8) lgkmcnt(9)
 v_mfma_f32_16x16x32_bf16 v[164:167], a[192:195], a[184:187], v[164:167]
 v_add_f32 v51, v51, v15
 v_add_f32 v52, v52, v12
 v_mfma_f32_16x16x32_bf16 v[164:167], a[196:199], a[188:191], v[164:167]
 global_load_dwordx4 a[236:239], v0, s[70:71] offset:-1024 sc1
 v_add_f32 v53, v53, v13
 v_mfma_f32_16x16x32_bf16 v[160:163], a[196:199], a[180:183], v[160:163]
 v_add_f32 v54, v54, v14
 v_mfma_f32_16x16x32_bf16 v[160:163], a[192:195], a[176:179], v[160:163]
 global_load_dwordx4 a[232:235], v0, s[70:71] offset:-2048 sc1
 v_add_f32 v55, v55, v15
 v_mfma_f32_16x16x32_bf16 v[156:159], a[192:195], a[168:171], v[156:159]
 v_add_f32 v56, v56, v12
 v_mfma_f32_16x16x32_bf16 v[156:159], a[196:199], a[172:175], v[156:159]
 v_add_f32 v57, v57, v13
 v_mfma_f32_16x16x32_bf16 v[152:155], a[196:199], a[164:167], v[152:155]
 v_add_f32 v58, v58, v14
 v_mfma_f32_16x16x32_bf16 v[152:155], a[192:195], a[160:163], v[152:155]
 v_add_f32 v59, v59, v15
 s_waitcnt lgkmcnt(0)
 v_mfma_f32_16x16x32_bf16 v[148:151], a[192:195], a[152:155], v[148:151]
 v_add_f32 v60, v60, v12
 v_mfma_f32_16x16x32_bf16 v[148:151], a[196:199], a[156:159], v[148:151]
 v_add_f32 v61, v61, v13
 v_mfma_f32_16x16x32_bf16 v[144:147], a[196:199], a[148:151], v[144:147]
 v_add_f32 v62, v62, v14
 v_mfma_f32_16x16x32_bf16 v[144:147], a[192:195], a[144:147], v[144:147]
 v_add_f32 v63, v63, v15
 v_mfma_f32_16x16x32_bf16 v[140:143], a[192:195], a[136:139], v[140:143]
 v_add_f32 v64, v64, v12
 v_mfma_f32_16x16x32_bf16 v[140:143], a[196:199], a[140:143], v[140:143]
 v_add_f32 v65, v65, v13
 v_mfma_f32_16x16x32_bf16 v[136:139], a[196:199], a[132:135], v[136:139]
 v_add_f32 v66, v66, v14
 v_mfma_f32_16x16x32_bf16 v[136:139], a[192:195], a[128:131], v[136:139]
 v_add_f32 v67, v67, v15
 s_waitcnt vmcnt(8)
 v_mfma_f32_16x16x32_bf16 v[168:171], a[200:203], a[128:131], v[168:171]
 v_add_f32 v68, v68, v12
 v_mfma_f32_16x16x32_bf16 v[168:171], a[204:207], a[132:135], v[168:171]
 global_load_dwordx4 a[196:199], v0, s[70:71] offset:1024 sc1
 v_add_f32 v69, v69, v13
 v_mfma_f32_16x16x32_bf16 v[172:175], a[204:207], a[140:143], v[172:175]
 v_add_f32 v70, v70, v14
 v_add_f32 v71, v71, v15
 v_mfma_f32_16x16x32_bf16 v[172:175], a[200:203], a[136:139], v[172:175]
 global_load_dwordx4 a[192:195], v0, s[70:71] offset:0 sc1
 v_add_f32 v72, v72, v12
 v_mfma_f32_16x16x32_bf16 v[176:179], a[200:203], a[144:147], v[176:179]
 v_add_f32 v73, v73, v13
 v_mfma_f32_16x16x32_bf16 v[176:179], a[204:207], a[148:151], v[176:179]
 v_add_f32 v74, v74, v14
 v_mfma_f32_16x16x32_bf16 v[180:183], a[204:207], a[156:159], v[180:183]
 v_add_f32 v75, v75, v15
 v_mfma_f32_16x16x32_bf16 v[180:183], a[200:203], a[152:155], v[180:183]
 v_add_f32 v76, v76, v12
 v_mfma_f32_16x16x32_bf16 v[184:187], a[200:203], a[160:163], v[184:187]
 v_add_f32 v77, v77, v13
 v_mfma_f32_16x16x32_bf16 v[184:187], a[204:207], a[164:167], v[184:187]
 v_add_f32 v78, v78, v14
 v_mfma_f32_16x16x32_bf16 v[188:191], a[204:207], a[172:175], v[188:191]
 v_add_f32 v79, v79, v15
 v_mfma_f32_16x16x32_bf16 v[188:191], a[200:203], a[168:171], v[188:191]
 v_mfma_f32_16x16x32_bf16 v[192:195], a[200:203], a[176:179], v[192:195]
 v_add_f32 v80, v80, v8
 v_mfma_f32_16x16x32_bf16 v[192:195], a[204:207], a[180:183], v[192:195]
 ds_read_b128 v[12:15], v4 offset:144
 v_mfma_f32_16x16x32_bf16 v[196:199], a[204:207], a[188:191], v[196:199]
 v_add_f32 v81, v81, v9
 v_mfma_f32_16x16x32_bf16 v[196:199], a[200:203], a[184:187], v[196:199]
 v_add_f32 v82, v82, v10
 s_waitcnt vmcnt(8)
 v_mfma_f32_16x16x32_bf16 v[228:231], a[208:211], a[184:187], v[228:231]
 v_add_f32 v83, v83, v11
 v_mfma_f32_16x16x32_bf16 v[228:231], a[212:215], a[188:191], v[228:231]
 global_load_dwordx4 a[204:207], v0, s[70:71] offset:3072 sc1
 v_add_f32 v84, v84, v8
 v_mfma_f32_16x16x32_bf16 v[224:227], a[212:215], a[180:183], v[224:227]
 v_add_f32 v85, v85, v9
 v_mfma_f32_16x16x32_bf16 v[224:227], a[208:211], a[176:179], v[224:227]
 global_load_dwordx4 a[200:203], v0, s[70:71] offset:2048 sc1
 v_add_f32 v86, v86, v10
 v_mfma_f32_16x16x32_bf16 v[220:223], a[208:211], a[168:171], v[220:223]
 v_add_f32 v87, v87, v11
 s_add_u32 s70, s70, 8192
 s_addc_u32 s71, s71, 0
 v_mfma_f32_16x16x32_bf16 v[220:223], a[212:215], a[172:175], v[220:223]
 v_add_f32 v88, v88, v8
 v_add_f32 v89, v89, v9
 v_mfma_f32_16x16x32_bf16 v[216:219], a[212:215], a[164:167], v[216:219]
 v_add_f32 v90, v90, v10
 v_mfma_f32_16x16x32_bf16 v[216:219], a[208:211], a[160:163], v[216:219]
 v_add_f32 v91, v91, v11
 v_mfma_f32_16x16x32_bf16 v[212:215], a[208:211], a[152:155], v[212:215]
 v_add_f32 v92, v92, v8
 v_mfma_f32_16x16x32_bf16 v[212:215], a[212:215], a[156:159], v[212:215]
 v_add_f32 v93, v93, v9
 v_mfma_f32_16x16x32_bf16 v[208:211], a[212:215], a[148:151], v[208:211]
 v_add_f32 v94, v94, v10
 v_mfma_f32_16x16x32_bf16 v[208:211], a[208:211], a[144:147], v[208:211]
 v_add_f32 v95, v95, v11
 v_mfma_f32_16x16x32_bf16 v[204:207], a[208:211], a[136:139], v[204:207]
 v_add_f32 v96, v96, v8
 v_mfma_f32_16x16x32_bf16 v[204:207], a[212:215], a[140:143], v[204:207]
 v_add_f32 v97, v97, v9
 v_mfma_f32_16x16x32_bf16 v[200:203], a[212:215], a[132:135], v[200:203]
 v_add_f32 v98, v98, v10
 v_add_f32 v99, v99, v11
 v_mfma_f32_16x16x32_bf16 v[200:203], a[208:211], a[128:131], v[200:203]
 v_add_f32 v100, v100, v8
 v_add_f32 v101, v101, v9
 s_waitcnt vmcnt(8)
 v_mfma_f32_16x16x32_bf16 v[232:235], a[216:219], a[128:131], v[232:235]
 ds_read_b128 a[128:131], v1
 v_add_f32 v102, v102, v10
 v_mfma_f32_16x16x32_bf16 v[232:235], a[220:223], a[132:135], v[232:235]
 global_load_dwordx4 a[212:215], v0, s[70:71] offset:-3072 sc1
 ds_read_b128 a[132:135], v1 offset:1024
 v_mfma_f32_16x16x32_bf16 v[236:239], a[220:223], a[140:143], v[236:239]
 ds_read_b128 a[140:143], v1 offset:5120
 v_add_f32 v103, v103, v11
 v_mfma_f32_16x16x32_bf16 v[236:239], a[216:219], a[136:139], v[236:239]
 global_load_dwordx4 a[208:211], v0, s[70:71] offset:-4096 sc1
 ds_read_b128 a[136:139], v1 offset:4096
 v_mfma_f32_16x16x32_bf16 v[240:243], a[216:219], a[144:147], v[240:243]
 ds_read_b128 a[144:147], v1 offset:8192
 v_add_f32 v104, v104, v8
 v_mfma_f32_16x16x32_bf16 v[240:243], a[220:223], a[148:151], v[240:243]
 ds_read_b128 a[148:151], v1 offset:9216
 v_add_f32 v105, v105, v9
 v_mfma_f32_16x16x32_bf16 v[244:247], a[220:223], a[156:159], v[244:247]
 ds_read_b128 a[156:159], v1 offset:13312
 v_add_f32 v106, v106, v10
 v_mfma_f32_16x16x32_bf16 v[244:247], a[216:219], a[152:155], v[244:247]
 ds_read_b128 a[152:155], v1 offset:12288
 v_add_f32 v107, v107, v11
 v_mfma_f32_16x16x32_bf16 v[248:251], a[216:219], a[160:163], v[248:251]
 ds_read_b128 a[160:163], v1 offset:16384
 v_add_f32 v108, v108, v8
 v_mfma_f32_16x16x32_bf16 v[248:251], a[220:223], a[164:167], v[248:251]
 ds_read_b128 a[164:167], v1 offset:17408
 v_add_f32 v109, v109, v9
 v_mfma_f32_16x16x32_bf16 v[252:255], a[220:223], a[172:175], v[252:255]
 ds_read_b128 a[172:175], v1 offset:21504
 v_add_f32 v110, v110, v10
 v_mfma_f32_16x16x32_bf16 v[252:255], a[216:219], a[168:171], v[252:255]
 ds_read_b128 a[168:171], v1 offset:20480
 v_add_f32 v111, v111, v11
 s_waitcnt lgkmcnt(12)
 v_mfma_f32_16x16x32_bf16 a[248:251], a[216:219], a[176:179], a[248:251]
 ds_read_b128 a[176:179], v1 offset:24576
 v_add_f32 v112, v112, v12
 v_mfma_f32_16x16x32_bf16 a[248:251], a[220:223], a[180:183], a[248:251]
 ds_read_b128 a[180:183], v1 offset:25600
 v_add_f32 v113, v113, v13
 v_mfma_f32_16x16x32_bf16 a[252:255], a[220:223], a[188:191], a[252:255]
 ds_read_b128 a[188:191], v1 offset:29696
 v_add_f32 v114, v114, v14
 v_mfma_f32_16x16x32_bf16 a[252:255], a[216:219], a[184:187], a[252:255]
 ds_read_b128 a[184:187], v1 offset:28672
 v_add_f32 v115, v115, v15
 s_waitcnt vmcnt(8) lgkmcnt(8)
 v_mfma_f32_16x16x32_bf16 v[136:139], a[224:227], a[128:131], v[136:139]
 v_add_f32 v116, v116, v12
 v_mfma_f32_16x16x32_bf16 v[136:139], a[228:231], a[132:135], v[136:139]
 global_load_dwordx4 a[220:223], v0, s[70:71] offset:-1024 sc1
 v_add_f32 v117, v117, v13
 v_mfma_f32_16x16x32_bf16 v[140:143], a[228:231], a[140:143], v[140:143]
 v_add_f32 v118, v118, v14
 v_mfma_f32_16x16x32_bf16 v[140:143], a[224:227], a[136:139], v[140:143]
 global_load_dwordx4 a[216:219], v0, s[70:71] offset:-2048 sc1
 v_add_f32 v119, v119, v15
 v_mfma_f32_16x16x32_bf16 v[144:147], a[224:227], a[144:147], v[144:147]
 v_add_f32 v120, v120, v12
 v_mfma_f32_16x16x32_bf16 v[144:147], a[228:231], a[148:151], v[144:147]
 v_add_f32 v121, v121, v13
 v_mfma_f32_16x16x32_bf16 v[148:151], a[228:231], a[156:159], v[148:151]
 v_add_f32 v122, v122, v14
 v_mfma_f32_16x16x32_bf16 v[148:151], a[224:227], a[152:155], v[148:151]
 v_add_f32 v123, v123, v15
 s_waitcnt lgkmcnt(0)
 v_mfma_f32_16x16x32_bf16 v[152:155], a[224:227], a[160:163], v[152:155]
 v_add_f32 v124, v124, v12
 v_mfma_f32_16x16x32_bf16 v[152:155], a[228:231], a[164:167], v[152:155]
 v_add_f32 v125, v125, v13
 v_mfma_f32_16x16x32_bf16 v[156:159], a[228:231], a[172:175], v[156:159]
 v_add_f32 v126, v126, v14
 v_mfma_f32_16x16x32_bf16 v[156:159], a[224:227], a[168:171], v[156:159]
 v_add_f32 v127, v127, v15
 v_mfma_f32_16x16x32_bf16 v[160:163], a[224:227], a[176:179], v[160:163]
 v_add_f32 v128, v128, v12
 v_add_f32 v129, v129, v13
 v_mfma_f32_16x16x32_bf16 v[160:163], a[228:231], a[180:183], v[160:163]
 v_add_f32 v130, v130, v14
 v_mfma_f32_16x16x32_bf16 v[164:167], a[228:231], a[188:191], v[164:167]
 v_add_f32 v131, v131, v15
 v_mfma_f32_16x16x32_bf16 v[164:167], a[224:227], a[184:187], v[164:167]
 v_add_f32 v132, v132, v12
 s_waitcnt vmcnt(8)
 v_mfma_f32_16x16x32_bf16 v[196:199], a[232:235], a[184:187], v[196:199]
 v_add_f32 v133, v133, v13
 v_mfma_f32_16x16x32_bf16 v[196:199], a[236:239], a[188:191], v[196:199]
 global_load_dwordx4 a[228:231], v0, s[70:71] offset:1024 sc1
 v_add_f32 v134, v134, v14
 v_mfma_f32_16x16x32_bf16 v[192:195], a[236:239], a[180:183], v[192:195]
 v_add_f32 v135, v135, v15
 v_mfma_f32_16x16x32_bf16 v[192:195], a[232:235], a[176:179], v[192:195]
 global_load_dwordx4 a[224:227], v0, s[70:71] offset:0 sc1
 v_accvgpr_read_b32 v5, a240
 v_mfma_f32_16x16x32_bf16 v[188:191], a[232:235], a[168:171], v[188:191]
 v_add_f32 v5, v5, v12
 v_mfma_f32_16x16x32_bf16 v[188:191], a[236:239], a[172:175], v[188:191]
 v_accvgpr_write_b32 a240, v5
 v_mfma_f32_16x16x32_bf16 v[184:187], a[236:239], a[164:167], v[184:187]
 v_accvgpr_read_b32 v6, a241
 v_mfma_f32_16x16x32_bf16 v[184:187], a[232:235], a[160:163], v[184:187]
 v_add_f32 v6, v6, v13
 v_mfma_f32_16x16x32_bf16 v[180:183], a[232:235], a[152:155], v[180:183]
 v_accvgpr_write_b32 a241, v6
 v_mfma_f32_16x16x32_bf16 v[180:183], a[236:239], a[156:159], v[180:183]
 v_accvgpr_read_b32 v5, a242
 v_mfma_f32_16x16x32_bf16 v[176:179], a[236:239], a[148:151], v[176:179]
 v_add_f32 v5, v5, v14
 v_mfma_f32_16x16x32_bf16 v[176:179], a[232:235], a[144:147], v[176:179]
 v_accvgpr_write_b32 a242, v5
 v_mfma_f32_16x16x32_bf16 v[172:175], a[232:235], a[136:139], v[172:175]
 v_accvgpr_read_b32 v6, a243
 v_mfma_f32_16x16x32_bf16 v[172:175], a[236:239], a[140:143], v[172:175]
 v_add_f32 v6, v6, v15
 v_mfma_f32_16x16x32_bf16 v[168:171], a[236:239], a[132:135], v[168:171]
 v_accvgpr_write_b32 a243, v6
 v_mfma_f32_16x16x32_bf16 v[168:171], a[232:235], a[128:131], v[168:171]
 v_accvgpr_read_b32 v5, a244
 s_waitcnt vmcnt(8)
 v_mfma_f32_16x16x32_bf16 v[200:203], a[192:195], a[128:131], v[200:203]
 v_add_f32 v5, v5, v12
 v_accvgpr_write_b32 a244, v5
 v_mfma_f32_16x16x32_bf16 v[200:203], a[196:199], a[132:135], v[200:203]
 global_load_dwordx4 a[236:239], v0, s[70:71] offset:3072 sc1
 v_accvgpr_read_b32 v6, a245
 v_mfma_f32_16x16x32_bf16 v[204:207], a[196:199], a[140:143], v[204:207]
 v_add_f32 v6, v6, v13
 v_mfma_f32_16x16x32_bf16 v[204:207], a[192:195], a[136:139], v[204:207]
 global_load_dwordx4 a[232:235], v0, s[70:71] offset:2048 sc1
 v_accvgpr_write_b32 a245, v6
 v_mfma_f32_16x16x32_bf16 v[208:211], a[192:195], a[144:147], v[208:211]
 v_accvgpr_read_b32 v5, a246
 s_add_u32 s70, s70, 8192
 s_addc_u32 s71, s71, 0
 v_mfma_f32_16x16x32_bf16 v[208:211], a[196:199], a[148:151], v[208:211]
 v_add_f32 v5, v5, v14
 v_mfma_f32_16x16x32_bf16 v[212:215], a[196:199], a[156:159], v[212:215]
 v_accvgpr_write_b32 a246, v5
 v_mfma_f32_16x16x32_bf16 v[212:215], a[192:195], a[152:155], v[212:215]
 v_accvgpr_read_b32 v6, a247
 v_mfma_f32_16x16x32_bf16 v[216:219], a[192:195], a[160:163], v[216:219]
 v_add_f32 v6, v6, v15
 v_mfma_f32_16x16x32_bf16 v[216:219], a[196:199], a[164:167], v[216:219]
 v_accvgpr_write_b32 a247, v6
 v_mfma_f32_16x16x32_bf16 v[220:223], a[196:199], a[172:175], v[220:223]
 s_add_u32 s55, s55, 1
 s_waitcnt lgkmcnt(0)
 s_barrier
 v_mfma_f32_16x16x32_bf16 v[220:223], a[192:195], a[168:171], v[220:223]
 v_mfma_f32_16x16x32_bf16 v[224:227], a[192:195], a[176:179], v[224:227]
 v_mfma_f32_16x16x32_bf16 v[224:227], a[196:199], a[180:183], v[224:227]
 v_mfma_f32_16x16x32_bf16 v[228:231], a[196:199], a[188:191], v[228:231]
 v_mfma_f32_16x16x32_bf16 v[228:231], a[192:195], a[184:187], v[228:231]
 s_waitcnt vmcnt(8)
 v_mfma_f32_16x16x32_bf16 a[252:255], a[200:203], a[184:187], a[252:255]
 ds_read_b128 a[184:187], v1 offset:30720
 v_mfma_f32_16x16x32_bf16 a[252:255], a[204:207], a[188:191], a[252:255]
 global_load_dwordx4 a[196:199], v0, s[70:71] offset:-3072 sc1
 ds_read_b128 a[188:191], v1 offset:31744
 v_mfma_f32_16x16x32_bf16 a[248:251], a[204:207], a[180:183], a[248:251]
 ds_read_b128 a[180:183], v1 offset:27648
 v_mfma_f32_16x16x32_bf16 a[248:251], a[200:203], a[176:179], a[248:251]
 global_load_dwordx4 a[192:195], v0, s[70:71] offset:-4096 sc1
 ds_read_b128 a[176:179], v1 offset:26624
 v_mfma_f32_16x16x32_bf16 v[252:255], a[200:203], a[168:171], v[252:255]
 ds_read_b128 a[168:171], v1 offset:22528
 v_mfma_f32_16x16x32_bf16 v[252:255], a[204:207], a[172:175], v[252:255]
 ds_read_b128 a[172:175], v1 offset:23552
 v_mfma_f32_16x16x32_bf16 v[248:251], a[204:207], a[164:167], v[248:251]
 ds_read_b128 a[164:167], v1 offset:19456
 v_mfma_f32_16x16x32_bf16 v[248:251], a[200:203], a[160:163], v[248:251]
 ds_read_b128 a[160:163], v1 offset:18432
 v_mfma_f32_16x16x32_bf16 v[244:247], a[200:203], a[152:155], v[244:247]
 ds_read_b128 a[152:155], v1 offset:14336
 v_mfma_f32_16x16x32_bf16 v[244:247], a[204:207], a[156:159], v[244:247]
 ds_read_b128 a[156:159], v1 offset:15360
 v_mfma_f32_16x16x32_bf16 v[240:243], a[204:207], a[148:151], v[240:243]
 ds_read_b128 a[148:151], v1 offset:11264
 v_mfma_f32_16x16x32_bf16 v[240:243], a[200:203], a[144:147], v[240:243]
 ds_read_b128 a[144:147], v1 offset:10240
 v_mfma_f32_16x16x32_bf16 v[236:239], a[200:203], a[136:139], v[236:239]
 ds_read_b128 a[136:139], v1 offset:6144
 v_mfma_f32_16x16x32_bf16 v[236:239], a[204:207], a[140:143], v[236:239]
 ds_read_b128 a[140:143], v1 offset:7168
 v_mfma_f32_16x16x32_bf16 v[232:235], a[204:207], a[132:135], v[232:235]
 global_load_dwordx4 a[204:207], v0, s[70:71] offset:-1024 sc1
 ds_read_b128 a[132:135], v1 offset:3072
 v_mfma_f32_16x16x32_bf16 v[232:235], a[200:203], a[128:131], v[232:235]
 global_load_dwordx4 a[200:203], v0, s[70:71] offset:-2048 sc1
 ds_read_b128 a[128:131], v1 offset:2048
 s_waitcnt vmcnt(10) lgkmcnt(8)
Lloop:
 v_mfma_f32_16x16x32_bf16 v[44:47], a[208:211], a[184:187], v[44:47]
 v_mfma_f32_16x16x32_bf16 v[44:47], a[212:215], a[188:191], v[44:47]
 v_mov_b32 v6, v3
 s_cmp_eq_u32 s25, 0
 s_cbranch_scc1 Lgat0
Lgatr0:
 v_mfma_f32_16x16x32_bf16 v[40:43], a[212:215], a[180:183], v[40:43]
 v_mfma_f32_16x16x32_bf16 v[40:43], a[208:211], a[176:179], v[40:43]
 ds_read_b128 v[12:15], v3 offset:26624
 v_mfma_f32_16x16x32_bf16 v[36:39], a[208:211], a[168:171], v[36:39]
 s_add_u32 m0, s50, 0
 v_mfma_f32_16x16x32_bf16 v[36:39], a[212:215], a[172:175], v[36:39]
 v_mfma_f32_16x16x32_bf16 v[32:35], a[212:215], a[164:167], v[32:35]
 v_mfma_f32_16x16x32_bf16 v[32:35], a[208:211], a[160:163], v[32:35]
 s_waitcnt lgkmcnt(1)
 v_mfma_f32_16x16x32_bf16 v[28:31], a[208:211], a[152:155], v[28:31]
 v_mfma_f32_16x16x32_bf16 v[28:31], a[212:215], a[156:159], v[28:31]
 v_mfma_f32_16x16x32_bf16 v[24:27], a[212:215], a[148:151], v[24:27]
 v_mfma_f32_16x16x32_bf16 v[24:27], a[208:211], a[144:147], v[24:27]
 buffer_load_dwordx4 v6, s[8:11], s30 offen lds
 v_mfma_f32_16x16x32_bf16 v[20:23], a[208:211], a[136:139], v[20:23]
 v_mfma_f32_16x16x32_bf16 v[20:23], a[212:215], a[140:143], v[20:23]
 v_mfma_f32_16x16x32_bf16 v[16:19], a[212:215], a[132:135], v[16:19]
 s_add_u32 m0, m0, 1024
 v_mfma_f32_16x16x32_bf16 v[16:19], a[208:211], a[128:131], v[16:19]
 s_waitcnt vmcnt(9)
 v_mfma_f32_16x16x32_bf16 v[48:51], a[216:219], a[128:131], v[48:51]
 v_mfma_f32_16x16x32_bf16 v[48:51], a[220:223], a[132:135], v[48:51]
 global_load_dwordx4 a[212:215], v0, s[70:71] offset:1024 sc1
 s_add_u32 s30, s30, s20
 v_mfma_f32_16x16x32_bf16 v[52:55], a[220:223], a[140:143], v[52:55]
 v_mfma_f32_16x16x32_bf16 v[52:55], a[216:219], a[136:139], v[52:55]
 global_load_dwordx4 a[208:211], v0, s[70:71] offset:0 sc1
 v_mfma_f32_16x16x32_bf16 v[56:59], a[216:219], a[144:147], v[56:59]
 buffer_load_dwordx4 v6, s[8:11], s30 offen lds
 s_waitcnt lgkmcnt(0)
 v_mfma_f32_16x16x32_bf16 v[56:59], a[220:223], a[148:151], v[56:59]
 v_mfma_f32_16x16x32_bf16 v[60:63], a[220:223], a[156:159], v[60:63]
 s_add_u32 s69, s29, 28672
 v_mfma_f32_16x16x32_bf16 v[60:63], a[216:219], a[152:155], v[60:63]
 v_mfma_f32_16x16x32_bf16 v[64:67], a[216:219], a[160:163], v[64:67]
 s_add_u32 m0, m0, 3072
 v_mfma_f32_16x16x32_bf16 v[64:67], a[220:223], a[164:167], v[64:67]
 buffer_store_dwordx4 v[12:15], v3, s[32:35], s69 offen sc1
 v_mfma_f32_16x16x32_bf16 v[68:71], a[220:223], a[172:175], v[68:71]
 v_mfma_f32_16x16x32_bf16 v[68:71], a[216:219], a[168:171], v[68:71]
 s_add_u32 s30, s30, s21
 v_mfma_f32_16x16x32_bf16 v[72:75], a[216:219], a[176:179], v[72:75]
 v_mfma_f32_16x16x32_bf16 v[72:75], a[220:223], a[180:183], v[72:75]
 v_mfma_f32_16x16x32_bf16 v[76:79], a[220:223], a[188:191], v[76:79]
 v_mfma_f32_16x16x32_bf16 v[76:79], a[216:219], a[184:187], v[76:79]
 ds_read_b128 v[12:15], v3 offset:27648
 s_waitcnt vmcnt(11)
 v_mfma_f32_16x16x32_bf16 v[108:111], a[224:227], a[184:187], v[108:111]
 v_mfma_f32_16x16x32_bf16 v[108:111], a[228:231], a[188:191], v[108:111]
 global_load_dwordx4 a[220:223], v0, s[70:71] offset:3072 sc1
 v_mfma_f32_16x16x32_bf16 v[104:107], a[228:231], a[180:183], v[104:107]
 v_mfma_f32_16x16x32_bf16 v[104:107], a[224:227], a[176:179], v[104:107]
 global_load_dwordx4 a[216:219], v0, s[70:71] offset:2048 sc1
 v_mfma_f32_16x16x32_bf16 v[100:103], a[224:227], a[168:171], v[100:103]
 s_add_u32 s70, s70, 8192
 s_addc_u32 s71, s71, 0
 v_mfma_f32_16x16x32_bf16 v[100:103], a[228:231], a[172:175], v[100:103]
 v_mfma_f32_16x16x32_bf16 v[96:99], a[228:231], a[164:167], v[96:99]
 v_mfma_f32_16x16x32_bf16 v[96:99], a[224:227], a[160:163], v[96:99]
 v_mfma_f32_16x16x32_bf16 v[92:95], a[224:227], a[152:155], v[92:95]
 v_mfma_f32_16x16x32_bf16 v[92:95], a[228:231], a[156:159], v[92:95]
 v_mfma_f32_16x16x32_bf16 v[88:91], a[228:231], a[148:151], v[88:91]
 v_mfma_f32_16x16x32_bf16 v[88:91], a[224:227], a[144:147], v[88:91]
 v_mfma_f32_16x16x32_bf16 v[84:87], a[224:227], a[136:139], v[84:87]
 v_mfma_f32_16x16x32_bf16 v[84:87], a[228:231], a[140:143], v[84:87]
 v_mfma_f32_16x16x32_bf16 v[80:83], a[228:231], a[132:135], v[80:83]
 v_mfma_f32_16x16x32_bf16 v[80:83], a[224:227], a[128:131], v[80:83]
 s_waitcnt vmcnt(11)
 v_mfma_f32_16x16x32_bf16 v[112:115], a[232:235], a[128:131], v[112:115]
 v_mfma_f32_16x16x32_bf16 v[112:115], a[236:239], a[132:135], v[112:115]
 global_load_dwordx4 a[228:231], v0, s[70:71] offset:-3072 sc1
 s_waitcnt lgkmcnt(0)
 v_mfma_f32_16x16x32_bf16 v[116:119], a[236:239], a[140:143], v[116:119]
 v_mfma_f32_16x16x32_bf16 v[116:119], a[232:235], a[136:139], v[116:119]
 global_load_dwordx4 a[224:227], v0, s[70:71] offset:-4096 sc1
 v_mfma_f32_16x16x32_bf16 v[120:123], a[232:235], a[144:147], v[120:123]
 buffer_store_dwordx4 v[12:15], v3, s[32:35], s69 offen offset:1024 sc1
 v_mfma_f32_16x16x32_bf16 v[120:123], a[236:239], a[148:151], v[120:123]
 v_mfma_f32_16x16x32_bf16 v[124:127], a[236:239], a[156:159], v[124:127]
 v_mfma_f32_16x16x32_bf16 v[124:127], a[232:235], a[152:155], v[124:127]
 v_mfma_f32_16x16x32_bf16 v[128:131], a[232:235], a[160:163], v[128:131]
 v_mfma_f32_16x16x32_bf16 v[128:131], a[236:239], a[164:167], v[128:131]
 v_mfma_f32_16x16x32_bf16 v[132:135], a[236:239], a[172:175], v[132:135]
 ds_read_b128 v[12:15], v3 offset:30720
 v_mfma_f32_16x16x32_bf16 v[132:135], a[232:235], a[168:171], v[132:135]
 v_mfma_f32_16x16x32_bf16 a[240:243], a[232:235], a[176:179], a[240:243]
 v_mfma_f32_16x16x32_bf16 a[240:243], a[236:239], a[180:183], a[240:243]
 v_mfma_f32_16x16x32_bf16 a[244:247], a[236:239], a[188:191], a[244:247]
 buffer_load_dwordx4 v6, s[8:11], s30 offen lds
 v_mfma_f32_16x16x32_bf16 a[244:247], a[232:235], a[184:187], a[244:247]
 s_waitcnt vmcnt(13)
 v_mfma_f32_16x16x32_bf16 v[164:167], a[192:195], a[184:187], v[164:167]
 v_mfma_f32_16x16x32_bf16 v[164:167], a[196:199], a[188:191], v[164:167]
 global_load_dwordx4 a[236:239], v0, s[70:71] offset:-1024 sc1
 v_mfma_f32_16x16x32_bf16 v[160:163], a[196:199], a[180:183], v[160:163]
 s_add_u32 m0, m0, 1024
 v_mfma_f32_16x16x32_bf16 v[160:163], a[192:195], a[176:179], v[160:163]
 global_load_dwordx4 a[232:235], v0, s[70:71] offset:-2048 sc1
 v_mfma_f32_16x16x32_bf16 v[156:159], a[192:195], a[168:171], v[156:159]
 v_mfma_f32_16x16x32_bf16 v[156:159], a[196:199], a[172:175], v[156:159]
 s_add_u32 s30, s30, s20
 v_mfma_f32_16x16x32_bf16 v[152:155], a[196:199], a[164:167], v[152:155]
 v_mfma_f32_16x16x32_bf16 v[152:155], a[192:195], a[160:163], v[152:155]
 v_mfma_f32_16x16x32_bf16 v[148:151], a[192:195], a[152:155], v[148:151]
 buffer_load_dwordx4 v6, s[8:11], s30 offen lds
 v_mfma_f32_16x16x32_bf16 v[148:151], a[196:199], a[156:159], v[148:151]
 v_mfma_f32_16x16x32_bf16 v[144:147], a[196:199], a[148:151], v[144:147]
 v_mfma_f32_16x16x32_bf16 v[144:147], a[192:195], a[144:147], v[144:147]
 s_add_u32 m0, m0, 3072
 s_waitcnt lgkmcnt(0)
 v_mfma_f32_16x16x32_bf16 v[140:143], a[192:195], a[136:139], v[140:143]
 v_mfma_f32_16x16x32_bf16 v[140:143], a[196:199], a[140:143], v[140:143]
 v_mfma_f32_16x16x32_bf16 v[136:139], a[196:199], a[132:135], v[136:139]
 s_add_u32 s30, s30, s21
 buffer_store_dwordx4 v[12:15], v3, s[32:35], s69 offen offset:2048 sc1
 v_mfma_f32_16x16x32_bf16 v[136:139], a[192:195], a[128:131], v[136:139]
 s_waitcnt vmcnt(15)
 v_mfma_f32_16x16x32_bf16 v[168:171], a[200:203], a[128:131], v[168:171]
 v_mfma_f32_16x16x32_bf16 v[168:171], a[204:207], a[132:135], v[168:171]
 global_load_dwordx4 a[196:199], v0, s[70:71] offset:1024 sc1
 v_mfma_f32_16x16x32_bf16 v[172:175], a[204:207], a[140:143], v[172:175]
 v_mfma_f32_16x16x32_bf16 v[172:175], a[200:203], a[136:139], v[172:175]
 global_load_dwordx4 a[192:195], v0, s[70:71] offset:0 sc1
 v_mfma_f32_16x16x32_bf16 v[176:179], a[200:203], a[144:147], v[176:179]
 ds_read_b128 v[12:15], v3 offset:31744
 v_mfma_f32_16x16x32_bf16 v[176:179], a[204:207], a[148:151], v[176:179]
 v_mfma_f32_16x16x32_bf16 v[180:183], a[204:207], a[156:159], v[180:183]
 v_mfma_f32_16x16x32_bf16 v[180:183], a[200:203], a[152:155], v[180:183]
 v_mfma_f32_16x16x32_bf16 v[184:187], a[200:203], a[160:163], v[184:187]
 v_mfma_f32_16x16x32_bf16 v[184:187], a[204:207], a[164:167], v[184:187]
 v_mfma_f32_16x16x32_bf16 v[188:191], a[204:207], a[172:175], v[188:191]
 v_mfma_f32_16x16x32_bf16 v[188:191], a[200:203], a[168:171], v[188:191]
 v_mfma_f32_16x16x32_bf16 v[192:195], a[200:203], a[176:179], v[192:195]
 v_mfma_f32_16x16x32_bf16 v[192:195], a[204:207], a[180:183], v[192:195]
 v_mfma_f32_16x16x32_bf16 v[196:199], a[204:207], a[188:191], v[196:199]
 v_mfma_f32_16x16x32_bf16 v[196:199], a[200:203], a[184:187], v[196:199]
 s_waitcnt vmcnt(14)
 v_mfma_f32_16x16x32_bf16 v[228:231], a[208:211], a[184:187], v[228:231]
 v_mfma_f32_16x16x32_bf16 v[228:231], a[212:215], a[188:191], v[228:231]
 global_load_dwordx4 a[204:207], v0, s[70:71] offset:3072 sc1
 v_mfma_f32_16x16x32_bf16 v[224:227], a[212:215], a[180:183], v[224:227]
 v_mfma_f32_16x16x32_bf16 v[224:227], a[208:211], a[176:179], v[224:227]
 global_load_dwordx4 a[200:203], v0, s[70:71] offset:2048 sc1
 v_mfma_f32_16x16x32_bf16 v[220:223], a[208:211], a[168:171], v[220:223]
 s_add_u32 s70, s70, 8192
 s_addc_u32 s71, s71, 0
 v_mfma_f32_16x16x32_bf16 v[220:223], a[212:215], a[172:175], v[220:223]
 v_mfma_f32_16x16x32_bf16 v[216:219], a[212:215], a[164:167], v[216:219]
 s_waitcnt lgkmcnt(0)
 v_mfma_f32_16x16x32_bf16 v[216:219], a[208:211], a[160:163], v[216:219]
 v_mfma_f32_16x16x32_bf16 v[212:215], a[208:211], a[152:155], v[212:215]
 buffer_store_dwordx4 v[12:15], v3, s[32:35], s69 offen offset:3072 sc1
 v_mfma_f32_16x16x32_bf16 v[212:215], a[212:215], a[156:159], v[212:215]
 v_mfma_f32_16x16x32_bf16 v[208:211], a[212:215], a[148:151], v[208:211]
 v_mfma_f32_16x16x32_bf16 v[208:211], a[208:211], a[144:147], v[208:211]
 v_mfma_f32_16x16x32_bf16 v[204:207], a[208:211], a[136:139], v[204:207]
 v_mfma_f32_16x16x32_bf16 v[204:207], a[212:215], a[140:143], v[204:207]
 v_mfma_f32_16x16x32_bf16 v[200:203], a[212:215], a[132:135], v[200:203]
 v_mfma_f32_16x16x32_bf16 v[200:203], a[208:211], a[128:131], v[200:203]
 buffer_load_dwordx4 v6, s[8:11], s30 offen lds
 s_waitcnt vmcnt(14)
 v_mfma_f32_16x16x32_bf16 v[232:235], a[216:219], a[128:131], v[232:235]
 ds_read_b128 a[128:131], v1 offset:34816
 v_mfma_f32_16x16x32_bf16 v[232:235], a[220:223], a[132:135], v[232:235]
 global_load_dwordx4 a[212:215], v0, s[70:71] offset:-3072 sc1
 ds_read_b128 a[132:135], v1 offset:35840
 v_mfma_f32_16x16x32_bf16 v[236:239], a[220:223], a[140:143], v[236:239]
 ds_read_b128 a[140:143], v1 offset:39936
 v_mfma_f32_16x16x32_bf16 v[236:239], a[216:219], a[136:139], v[236:239]
 global_load_dwordx4 a[208:211], v0, s[70:71] offset:-4096 sc1
 ds_read_b128 a[136:139], v1 offset:38912
 v_mfma_f32_16x16x32_bf16 v[240:243], a[216:219], a[144:147], v[240:243]
 ds_read_b128 a[144:147], v1 offset:43008
 v_mfma_f32_16x16x32_bf16 v[240:243], a[220:223], a[148:151], v[240:243]
 ds_read_b128 a[148:151], v1 offset:44032
 s_add_u32 m0, m0, 1024
 v_mfma_f32_16x16x32_bf16 v[244:247], a[220:223], a[156:159], v[244:247]
 ds_read_b128 a[156:159], v1 offset:48128
 v_mfma_f32_16x16x32_bf16 v[244:247], a[216:219], a[152:155], v[244:247]
 ds_read_b128 a[152:155], v1 offset:47104
 v_mfma_f32_16x16x32_bf16 v[248:251], a[216:219], a[160:163], v[248:251]
 ds_read_b128 a[160:163], v1 offset:51200
 s_add_u32 s30, s30, s20
 v_mfma_f32_16x16x32_bf16 v[248:251], a[220:223], a[164:167], v[248:251]
 ds_read_b128 a[164:167], v1 offset:52224
 v_mfma_f32_16x16x32_bf16 v[252:255], a[220:223], a[172:175], v[252:255]
 ds_read_b128 a[172:175], v1 offset:56320
 v_mfma_f32_16x16x32_bf16 v[252:255], a[216:219], a[168:171], v[252:255]
 ds_read_b128 a[168:171], v1 offset:55296
 v_mfma_f32_16x16x32_bf16 a[248:251], a[216:219], a[176:179], a[248:251]
 ds_read_b128 a[176:179], v1 offset:59392
 v_mfma_f32_16x16x32_bf16 a[248:251], a[220:223], a[180:183], a[248:251]
 ds_read_b128 a[180:183], v1 offset:60416
 v_mfma_f32_16x16x32_bf16 a[252:255], a[220:223], a[188:191], a[252:255]
 ds_read_b128 a[188:191], v1 offset:64512
 v_mfma_f32_16x16x32_bf16 a[252:255], a[216:219], a[184:187], a[252:255]
 ds_read_b128 a[184:187], v1 offset:63488
 s_waitcnt vmcnt(14) lgkmcnt(8)
 v_mfma_f32_16x16x32_bf16 v[16:19], a[224:227], a[128:131], v[16:19]
 buffer_load_dwordx4 v6, s[8:11], s30 offen lds
 s_add_u32 m0, m0, 3072
 v_mfma_f32_16x16x32_bf16 v[16:19], a[228:231], a[132:135], v[16:19]
 global_load_dwordx4 a[220:223], v0, s[70:71] offset:-1024 sc1
 v_mfma_f32_16x16x32_bf16 v[20:23], a[228:231], a[140:143], v[20:23]
 s_add_u32 s30, s30, s21
 v_mfma_f32_16x16x32_bf16 v[20:23], a[224:227], a[136:139], v[20:23]
 global_load_dwordx4 a[216:219], v0, s[70:71] offset:-2048 sc1
 v_mfma_f32_16x16x32_bf16 v[24:27], a[224:227], a[144:147], v[24:27]
 v_mfma_f32_16x16x32_bf16 v[24:27], a[228:231], a[148:151], v[24:27]
 v_mfma_f32_16x16x32_bf16 v[28:31], a[228:231], a[156:159], v[28:31]
 v_mfma_f32_16x16x32_bf16 v[28:31], a[224:227], a[152:155], v[28:31]
 s_waitcnt lgkmcnt(0)
 v_mfma_f32_16x16x32_bf16 v[32:35], a[224:227], a[160:163], v[32:35]
 v_mfma_f32_16x16x32_bf16 v[32:35], a[228:231], a[164:167], v[32:35]
 v_mfma_f32_16x16x32_bf16 v[36:39], a[228:231], a[172:175], v[36:39]
 v_mfma_f32_16x16x32_bf16 v[36:39], a[224:227], a[168:171], v[36:39]
 v_mfma_f32_16x16x32_bf16 v[40:43], a[224:227], a[176:179], v[40:43]
 v_mfma_f32_16x16x32_bf16 v[40:43], a[228:231], a[180:183], v[40:43]
 v_mfma_f32_16x16x32_bf16 v[44:47], a[228:231], a[188:191], v[44:47]
 v_mfma_f32_16x16x32_bf16 v[44:47], a[224:227], a[184:187], v[44:47]
 s_waitcnt vmcnt(13)
 v_mfma_f32_16x16x32_bf16 v[76:79], a[232:235], a[184:187], v[76:79]
 v_mfma_f32_16x16x32_bf16 v[76:79], a[236:239], a[188:191], v[76:79]
 global_load_dwordx4 a[228:231], v0, s[70:71] offset:1024 sc1
 v_mfma_f32_16x16x32_bf16 v[72:75], a[236:239], a[180:183], v[72:75]
 v_mfma_f32_16x16x32_bf16 v[72:75], a[232:235], a[176:179], v[72:75]
 global_load_dwordx4 a[224:227], v0, s[70:71] offset:0 sc1
 v_mfma_f32_16x16x32_bf16 v[68:71], a[232:235], a[168:171], v[68:71]
 v_mfma_f32_16x16x32_bf16 v[68:71], a[236:239], a[172:175], v[68:71]
 v_mfma_f32_16x16x32_bf16 v[64:67], a[236:239], a[164:167], v[64:67]
 s_add_u32 s31, s31, 1
 s_waitcnt vmcnt(8)
 v_mov_b32 v7, s31
 buffer_store_dword v7, v1, s[60:63], 0 offen sc1
 v_mfma_f32_16x16x32_bf16 v[64:67], a[232:235], a[160:163], v[64:67]
 s_add_u32 s29, s29, 0x2000000
 v_mfma_f32_16x16x32_bf16 v[60:63], a[232:235], a[152:155], v[60:63]
 v_mfma_f32_16x16x32_bf16 v[60:63], a[236:239], a[156:159], v[60:63]
 v_mfma_f32_16x16x32_bf16 v[56:59], a[236:239], a[148:151], v[56:59]
 v_mfma_f32_16x16x32_bf16 v[56:59], a[232:235], a[144:147], v[56:59]
 v_mfma_f32_16x16x32_bf16 v[52:55], a[232:235], a[136:139], v[52:55]
 v_mfma_f32_16x16x32_bf16 v[52:55], a[236:239], a[140:143], v[52:55]
 v_mfma_f32_16x16x32_bf16 v[48:51], a[236:239], a[132:135], v[48:51]
 v_mfma_f32_16x16x32_bf16 v[48:51], a[232:235], a[128:131], v[48:51]
 v_mfma_f32_16x16x32_bf16 v[80:83], a[192:195], a[128:131], v[80:83]
 v_mfma_f32_16x16x32_bf16 v[80:83], a[196:199], a[132:135], v[80:83]
 global_load_dwordx4 a[236:239], v0, s[70:71] offset:3072 sc1
 v_mfma_f32_16x16x32_bf16 v[84:87], a[196:199], a[140:143], v[84:87]
 v_mfma_f32_16x16x32_bf16 v[84:87], a[192:195], a[136:139], v[84:87]
 global_load_dwordx4 a[232:235], v0, s[70:71] offset:2048 sc1
 v_mfma_f32_16x16x32_bf16 v[88:91], a[192:195], a[144:147], v[88:91]
 s_add_u32 s70, s70, 8192
 s_addc_u32 s71, s71, 0
 v_mfma_f32_16x16x32_bf16 v[88:91], a[196:199], a[148:151], v[88:91]
 buffer_load_dwordx4 v6, s[8:11], s30 offen lds
 v_mfma_f32_16x16x32_bf16 v[92:95], a[196:199], a[156:159], v[92:95]
 v_mfma_f32_16x16x32_bf16 v[92:95], a[192:195], a[152:155], v[92:95]
 v_mfma_f32_16x16x32_bf16 v[96:99], a[192:195], a[160:163], v[96:99]
 v_mfma_f32_16x16x32_bf16 v[96:99], a[196:199], a[164:167], v[96:99]
 s_add_u32 m0, m0, 1024
 v_mfma_f32_16x16x32_bf16 v[100:103], a[196:199], a[172:175], v[100:103]
 v_mfma_f32_16x16x32_bf16 v[100:103], a[192:195], a[168:171], v[100:103]
 v_mfma_f32_16x16x32_bf16 v[104:107], a[192:195], a[176:179], v[104:107]
 s_add_u32 s30, s30, s20
 v_mfma_f32_16x16x32_bf16 v[104:107], a[196:199], a[180:183], v[104:107]
 v_mfma_f32_16x16x32_bf16 v[108:111], a[196:199], a[188:191], v[108:111]
 v_mfma_f32_16x16x32_bf16 v[108:111], a[192:195], a[184:187], v[108:111]
 buffer_load_dwordx4 v6, s[8:11], s30 offen lds
 v_mfma_f32_16x16x32_bf16 a[244:247], a[200:203], a[184:187], a[244:247]
 v_mfma_f32_16x16x32_bf16 a[244:247], a[204:207], a[188:191], a[244:247]
 global_load_dwordx4 a[196:199], v0, s[70:71] offset:-3072 sc1
 v_mfma_f32_16x16x32_bf16 a[240:243], a[204:207], a[180:183], a[240:243]
 s_add_u32 m0, m0, 3072
 v_mfma_f32_16x16x32_bf16 a[240:243], a[200:203], a[176:179], a[240:243]
 global_load_dwordx4 a[192:195], v0, s[70:71] offset:-4096 sc1
 v_mfma_f32_16x16x32_bf16 v[132:135], a[200:203], a[168:171], v[132:135]
 v_mfma_f32_16x16x32_bf16 v[132:135], a[204:207], a[172:175], v[132:135]
 v_mfma_f32_16x16x32_bf16 v[128:131], a[204:207], a[164:167], v[128:131]
 s_add_u32 s30, s30, s21
 v_mfma_f32_16x16x32_bf16 v[128:131], a[200:203], a[160:163], v[128:131]
 v_mfma_f32_16x16x32_bf16 v[124:127], a[200:203], a[152:155], v[124:127]
 v_mfma_f32_16x16x32_bf16 v[124:127], a[204:207], a[156:159], v[124:127]
 v_mfma_f32_16x16x32_bf16 v[120:123], a[204:207], a[148:151], v[120:123]
 v_mfma_f32_16x16x32_bf16 v[120:123], a[200:203], a[144:147], v[120:123]
 v_mfma_f32_16x16x32_bf16 v[116:119], a[200:203], a[136:139], v[116:119]
 v_mfma_f32_16x16x32_bf16 v[116:119], a[204:207], a[140:143], v[116:119]
 v_mfma_f32_16x16x32_bf16 v[112:115], a[204:207], a[132:135], v[112:115]
 v_mfma_f32_16x16x32_bf16 v[112:115], a[200:203], a[128:131], v[112:115]
 s_waitcnt vmcnt(12)
 v_mfma_f32_16x16x32_bf16 v[136:139], a[208:211], a[128:131], v[136:139]
 v_mfma_f32_16x16x32_bf16 v[136:139], a[212:215], a[132:135], v[136:139]
 global_load_dwordx4 a[204:207], v0, s[70:71] offset:-1024 sc1
 v_mfma_f32_16x16x32_bf16 v[140:143], a[212:215], a[140:143], v[140:143]
 v_mfma_f32_16x16x32_bf16 v[140:143], a[208:211], a[136:139], v[140:143]
 global_load_dwordx4 a[200:203], v0, s[70:71] offset:-2048 sc1
 v_mfma_f32_16x16x32_bf16 v[144:147], a[208:211], a[144:147], v[144:147]
 v_mfma_f32_16x16x32_bf16 v[144:147], a[212:215], a[148:151], v[144:147]
 v_mfma_f32_16x16x32_bf16 v[148:151], a[212:215], a[156:159], v[148:151]
 v_mfma_f32_16x16x32_bf16 v[148:151], a[208:211], a[152:155], v[148:151]
 v_mfma_f32_16x16x32_bf16 v[152:155], a[208:211], a[160:163], v[152:155]
 v_mfma_f32_16x16x32_bf16 v[152:155], a[212:215], a[164:167], v[152:155]
 v_mfma_f32_16x16x32_bf16 v[156:159], a[212:215], a[172:175], v[156:159]
 v_mfma_f32_16x16x32_bf16 v[156:159], a[208:211], a[168:171], v[156:159]
 v_mfma_f32_16x16x32_bf16 v[160:163], a[208:211], a[176:179], v[160:163]
 v_mfma_f32_16x16x32_bf16 v[160:163], a[212:215], a[180:183], v[160:163]
 v_mfma_f32_16x16x32_bf16 v[164:167], a[212:215], a[188:191], v[164:167]
 v_mfma_f32_16x16x32_bf16 v[164:167], a[208:211], a[184:187], v[164:167]
 s_waitcnt vmcnt(11)
 v_mfma_f32_16x16x32_bf16 v[196:199], a[216:219], a[184:187], v[196:199]
 v_mfma_f32_16x16x32_bf16 v[196:199], a[220:223], a[188:191], v[196:199]
 global_load_dwordx4 a[212:215], v0, s[70:71] offset:1024 sc1
 v_mfma_f32_16x16x32_bf16 v[192:195], a[220:223], a[180:183], v[192:195]
 v_mfma_f32_16x16x32_bf16 v[192:195], a[216:219], a[176:179], v[192:195]
 global_load_dwordx4 a[208:211], v0, s[70:71] offset:0 sc1
 v_mfma_f32_16x16x32_bf16 v[188:191], a[216:219], a[168:171], v[188:191]
 v_mfma_f32_16x16x32_bf16 v[188:191], a[220:223], a[172:175], v[188:191]
 v_mfma_f32_16x16x32_bf16 v[184:187], a[220:223], a[164:167], v[184:187]
 v_mfma_f32_16x16x32_bf16 v[184:187], a[216:219], a[160:163], v[184:187]
 v_mfma_f32_16x16x32_bf16 v[180:183], a[216:219], a[152:155], v[180:183]
 v_mfma_f32_16x16x32_bf16 v[180:183], a[220:223], a[156:159], v[180:183]
 buffer_load_dwordx4 v6, s[8:11], s30 offen lds
 v_mfma_f32_16x16x32_bf16 v[176:179], a[220:223], a[148:151], v[176:179]
 v_mfma_f32_16x16x32_bf16 v[176:179], a[216:219], a[144:147], v[176:179]
 v_mfma_f32_16x16x32_bf16 v[172:175], a[216:219], a[136:139], v[172:175]
 s_add_u32 m0, m0, 1024
 v_mfma_f32_16x16x32_bf16 v[172:175], a[220:223], a[140:143], v[172:175]
 v_mfma_f32_16x16x32_bf16 v[168:171], a[220:223], a[132:135], v[168:171]
 v_mfma_f32_16x16x32_bf16 v[168:171], a[216:219], a[128:131], v[168:171]
 s_waitcnt vmcnt(12)
 v_mfma_f32_16x16x32_bf16 v[200:203], a[224:227], a[128:131], v[200:203]
 s_add_u32 s30, s30, s20
 v_mfma_f32_16x16x32_bf16 v[200:203], a[228:231], a[132:135], v[200:203]
 global_load_dwordx4 a[220:223], v0, s[70:71] offset:3072 sc1
 v_mfma_f32_16x16x32_bf16 v[204:207], a[228:231], a[140:143], v[204:207]
 buffer_load_dwordx4 v6, s[8:11], s30 offen lds
 v_mfma_f32_16x16x32_bf16 v[204:207], a[224:227], a[136:139], v[204:207]
 global_load_dwordx4 a[216:219], v0, s[70:71] offset:2048 sc1
 v_mfma_f32_16x16x32_bf16 v[208:211], a[224:227], a[144:147], v[208:211]
 s_add_u32 s70, s70, 8192
 s_addc_u32 s71, s71, 0
 v_mfma_f32_16x16x32_bf16 v[208:211], a[228:231], a[148:151], v[208:211]
 v_mfma_f32_16x16x32_bf16 v[212:215], a[228:231], a[156:159], v[212:215]
 s_add_u32 m0, m0, 3072
 v_mfma_f32_16x16x32_bf16 v[212:215], a[224:227], a[152:155], v[212:215]
 v_mfma_f32_16x16x32_bf16 v[216:219], a[224:227], a[160:163], v[216:219]
 v_mfma_f32_16x16x32_bf16 v[216:219], a[228:231], a[164:167], v[216:219]
 s_add_u32 s30, s30, s21
 v_mfma_f32_16x16x32_bf16 v[220:223], a[228:231], a[172:175], v[220:223]
 v_mfma_f32_16x16x32_bf16 v[220:223], a[224:227], a[168:171], v[220:223]
 v_mfma_f32_16x16x32_bf16 v[224:227], a[224:227], a[176:179], v[224:227]
 v_mfma_f32_16x16x32_bf16 v[224:227], a[228:231], a[180:183], v[224:227]
 v_mfma_f32_16x16x32_bf16 v[228:231], a[228:231], a[188:191], v[228:231]
 v_mfma_f32_16x16x32_bf16 v[228:231], a[224:227], a[184:187], v[228:231]
 s_waitcnt vmcnt(12)
 v_mfma_f32_16x16x32_bf16 a[252:255], a[232:235], a[184:187], a[252:255]
 ds_read_b128 a[184:187], v2 offset:30720
 v_mfma_f32_16x16x32_bf16 a[252:255], a[236:239], a[188:191], a[252:255]
 global_load_dwordx4 a[228:231], v0, s[70:71] offset:-3072 sc1
 ds_read_b128 a[188:191], v2 offset:31744
 v_mfma_f32_16x16x32_bf16 a[248:251], a[236:239], a[180:183], a[248:251]
 ds_read_b128 a[180:183], v2 offset:27648
 v_mfma_f32_16x16x32_bf16 a[248:251], a[232:235], a[176:179], a[248:251]
 global_load_dwordx4 a[224:227], v0, s[70:71] offset:-4096 sc1
 ds_read_b128 a[176:179], v2 offset:26624
 v_mfma_f32_16x16x32_bf16 v[252:255], a[232:235], a[168:171], v[252:255]
 ds_read_b128 a[168:171], v2 offset:22528
 v_mfma_f32_16x16x32_bf16 v[252:255], a[236:239], a[172:175], v[252:255]
 ds_read_b128 a[172:175], v2 offset:23552
 v_mfma_f32_16x16x32_bf16 v[248:251], a[236:239], a[164:167], v[248:251]
 ds_read_b128 a[164:167], v2 offset:19456
 v_mfma_f32_16x16x32_bf16 v[248:251], a[232:235], a[160:163], v[248:251]
 ds_read_b128 a[160:163], v2 offset:18432
 v_mfma_f32_16x16x32_bf16 v[244:247], a[232:235], a[152:155], v[244:247]
 ds_read_b128 a[152:155], v2 offset:14336
 v_mfma_f32_16x16x32_bf16 v[244:247], a[236:239], a[156:159], v[244:247]
 ds_read_b128 a[156:159], v2 offset:15360
 v_mfma_f32_16x16x32_bf16 v[240:243], a[236:239], a[148:151], v[240:243]
 ds_read_b128 a[148:151], v2 offset:11264
 v_mfma_f32_16x16x32_bf16 v[240:243], a[232:235], a[144:147], v[240:243]
 ds_read_b128 a[144:147], v2 offset:10240
 v_mfma_f32_16x16x32_bf16 v[236:239], a[232:235], a[136:139], v[236:239]
 ds_read_b128 a[136:139], v2 offset:6144
 v_mfma_f32_16x16x32_bf16 v[236:239], a[236:239], a[140:143], v[236:239]
 ds_read_b128 a[140:143], v2 offset:7168
 v_mfma_f32_16x16x32_bf16 v[232:235], a[236:239], a[132:135], v[232:235]
 ds_read_b128 a[132:135], v2 offset:3072
 v_mfma_f32_16x16x32_bf16 v[232:235], a[232:235], a[128:131], v[232:235]
 ds_read_b128 a[128:131], v2 offset:2048
 s_waitcnt vmcnt(10) lgkmcnt(8)
 v_mfma_f32_16x16x32_bf16 v[44:47], a[192:195], a[184:187], v[44:47]
 v_mfma_f32_16x16x32_bf16 v[44:47], a[196:199], a[188:191], v[44:47]
 global_load_dwordx4 a[236:239], v0, s[70:71] offset:-1024 sc1
 v_mfma_f32_16x16x32_bf16 v[40:43], a[196:199], a[180:183], v[40:43]
 v_mfma_f32_16x16x32_bf16 v[40:43], a[192:195], a[176:179], v[40:43]
 global_load_dwordx4 a[232:235], v0, s[70:71] offset:-2048 sc1
 v_mfma_f32_16x16x32_bf16 v[36:39], a[192:195], a[168:171], v[36:39]
 v_mfma_f32_16x16x32_bf16 v[36:39], a[196:199], a[172:175], v[36:39]
 v_mfma_f32_16x16x32_bf16 v[32:35], a[196:199], a[164:167], v[32:35]
 v_mfma_f32_16x16x32_bf16 v[32:35], a[192:195], a[160:163], v[32:35]
 s_waitcnt lgkmcnt(0)
 v_mfma_f32_16x16x32_bf16 v[28:31], a[192:195], a[152:155], v[28:31]
 v_mfma_f32_16x16x32_bf16 v[28:31], a[196:199], a[156:159], v[28:31]
 v_mfma_f32_16x16x32_bf16 v[24:27], a[196:199], a[148:151], v[24:27]
 v_mfma_f32_16x16x32_bf16 v[24:27], a[192:195], a[144:147], v[24:27]
 v_mfma_f32_16x16x32_bf16 v[20:23], a[192:195], a[136:139], v[20:23]
 v_mfma_f32_16x16x32_bf16 v[20:23], a[196:199], a[140:143], v[20:23]
 buffer_load_dwordx4 v6, s[8:11], s30 offen lds
 v_mfma_f32_16x16x32_bf16 v[16:19], a[196:199], a[132:135], v[16:19]
 v_mfma_f32_16x16x32_bf16 v[16:19], a[192:195], a[128:131], v[16:19]
 s_waitcnt vmcnt(11)
 v_mfma_f32_16x16x32_bf16 v[48:51], a[200:203], a[128:131], v[48:51]
 s_add_u32 m0, m0, 1024
 v_mfma_f32_16x16x32_bf16 v[48:51], a[204:207], a[132:135], v[48:51]
 global_load_dwordx4 a[196:199], v0, s[70:71] offset:1024 sc1
 v_mfma_f32_16x16x32_bf16 v[52:55], a[204:207], a[140:143], v[52:55]
 v_mfma_f32_16x16x32_bf16 v[52:55], a[200:203], a[136:139], v[52:55]
 global_load_dwordx4 a[192:195], v0, s[70:71] offset:0 sc1
 s_add_u32 s30, s30, s20
 v_mfma_f32_16x16x32_bf16 v[56:59], a[200:203], a[144:147], v[56:59]
 v_mfma_f32_16x16x32_bf16 v[56:59], a[204:207], a[148:151], v[56:59]
 v_mfma_f32_16x16x32_bf16 v[60:63], a[204:207], a[156:159], v[60:63]
 buffer_load_dwordx4 v6, s[8:11], s30 offen lds
 v_mfma_f32_16x16x32_bf16 v[60:63], a[200:203], a[152:155], v[60:63]
 v_mfma_f32_16x16x32_bf16 v[64:67], a[200:203], a[160:163], v[64:67]
 v_mfma_f32_16x16x32_bf16 v[64:67], a[204:207], a[164:167], v[64:67]
 v_mfma_f32_16x16x32_bf16 v[68:71], a[204:207], a[172:175], v[68:71]
 s_add_u32 m0, m0, 3072
 v_mfma_f32_16x16x32_bf16 v[68:71], a[200:203], a[168:171], v[68:71]
 v_mfma_f32_16x16x32_bf16 v[72:75], a[200:203], a[176:179], v[72:75]
 v_mfma_f32_16x16x32_bf16 v[72:75], a[204:207], a[180:183], v[72:75]
 s_add_u32 s30, s30, s21
 v_mfma_f32_16x16x32_bf16 v[76:79], a[204:207], a[188:191], v[76:79]
 v_mfma_f32_16x16x32_bf16 v[76:79], a[200:203], a[184:187], v[76:79]
 s_waitcnt vmcnt(12)
 v_mfma_f32_16x16x32_bf16 v[108:111], a[208:211], a[184:187], v[108:111]
 v_mfma_f32_16x16x32_bf16 v[108:111], a[212:215], a[188:191], v[108:111]
 global_load_dwordx4 a[204:207], v0, s[70:71] offset:3072 sc1
 v_mfma_f32_16x16x32_bf16 v[104:107], a[212:215], a[180:183], v[104:107]
 v_mfma_f32_16x16x32_bf16 v[104:107], a[208:211], a[176:179], v[104:107]
 global_load_dwordx4 a[200:203], v0, s[70:71] offset:2048 sc1
 v_mfma_f32_16x16x32_bf16 v[100:103], a[208:211], a[168:171], v[100:103]
 s_add_u32 s70, s70, 8192
 s_addc_u32 s71, s71, 0
 v_mfma_f32_16x16x32_bf16 v[100:103], a[212:215], a[172:175], v[100:103]
 v_mfma_f32_16x16x32_bf16 v[96:99], a[212:215], a[164:167], v[96:99]
 v_mfma_f32_16x16x32_bf16 v[96:99], a[208:211], a[160:163], v[96:99]
 v_mfma_f32_16x16x32_bf16 v[92:95], a[208:211], a[152:155], v[92:95]
 v_mfma_f32_16x16x32_bf16 v[92:95], a[212:215], a[156:159], v[92:95]
 v_mfma_f32_16x16x32_bf16 v[88:91], a[212:215], a[148:151], v[88:91]
 v_mfma_f32_16x16x32_bf16 v[88:91], a[208:211], a[144:147], v[88:91]
 v_mfma_f32_16x16x32_bf16 v[84:87], a[208:211], a[136:139], v[84:87]
 v_mfma_f32_16x16x32_bf16 v[84:87], a[212:215], a[140:143], v[84:87]
 v_mfma_f32_16x16x32_bf16 v[80:83], a[212:215], a[132:135], v[80:83]
 v_mfma_f32_16x16x32_bf16 v[80:83], a[208:211], a[128:131], v[80:83]
 s_waitcnt vmcnt(10)
 v_mfma_f32_16x16x32_bf16 v[112:115], a[216:219], a[128:131], v[112:115]
 v_mfma_f32_16x16x32_bf16 v[112:115], a[220:223], a[132:135], v[112:115]
 global_load_dwordx4 a[212:215], v0, s[70:71] offset:-3072 sc1
 v_mfma_f32_16x16x32_bf16 v[116:119], a[220:223], a[140:143], v[116:119]
 v_mfma_f32_16x16x32_bf16 v[116:119], a[216:219], a[136:139], v[116:119]
 global_load_dwordx4 a[208:211], v0, s[70:71] offset:-4096 sc1
 v_mfma_f32_16x16x32_bf16 v[120:123], a[216:219], a[144:147], v[120:123]
 v_mfma_f32_16x16x32_bf16 v[120:123], a[220:223], a[148:151], v[120:123]
 v_mfma_f32_16x16x32_bf16 v[124:127], a[220:223], a[156:159], v[124:127]
 v_mfma_f32_16x16x32_bf16 v[124:127], a[216:219], a[152:155], v[124:127]
 v_mfma_f32_16x16x32_bf16 v[128:131], a[216:219], a[160:163], v[128:131]
 v_mfma_f32_16x16x32_bf16 v[128:131], a[220:223], a[164:167], v[128:131]
 v_mfma_f32_16x16x32_bf16 v[132:135], a[220:223], a[172:175], v[132:135]
 v_mfma_f32_16x16x32_bf16 v[132:135], a[216:219], a[168:171], v[132:135]
 v_mfma_f32_16x16x32_bf16 a[240:243], a[216:219], a[176:179], a[240:243]
 v_mfma_f32_16x16x32_bf16 a[240:243], a[220:223], a[180:183], a[240:243]
 v_mfma_f32_16x16x32_bf16 a[244:247], a[220:223], a[188:191], a[244:247]
 v_mfma_f32_16x16x32_bf16 a[244:247], a[216:219], a[184:187], a[244:247]
 s_waitcnt vmcnt(10)
 v_mfma_f32_16x16x32_bf16 v[164:167], a[224:227], a[184:187], v[164:167]
 buffer_load_dwordx4 v6, s[8:11], s30 offen lds
 v_mfma_f32_16x16x32_bf16 v[164:167], a[228:231], a[188:191], v[164:167]
 global_load_dwordx4 a[220:223], v0, s[70:71] offset:-1024 sc1
 v_mfma_f32_16x16x32_bf16 v[160:163], a[228:231], a[180:183], v[160:163]
 v_mfma_f32_16x16x32_bf16 v[160:163], a[224:227], a[176:179], v[160:163]
 global_load_dwordx4 a[216:219], v0, s[70:71] offset:-2048 sc1
 s_add_u32 m0, m0, 1024
 v_mfma_f32_16x16x32_bf16 v[156:159], a[224:227], a[168:171], v[156:159]
 v_mfma_f32_16x16x32_bf16 v[156:159], a[228:231], a[172:175], v[156:159]
 v_mfma_f32_16x16x32_bf16 v[152:155], a[228:231], a[164:167], v[152:155]
 v_mfma_f32_16x16x32_bf16 v[152:155], a[224:227], a[160:163], v[152:155]
 s_add_u32 s30, s30, s20
 v_mfma_f32_16x16x32_bf16 v[148:151], a[224:227], a[152:155], v[148:151]
 v_mfma_f32_16x16x32_bf16 v[148:151], a[228:231], a[156:159], v[148:151]
 v_mfma_f32_16x16x32_bf16 v[144:147], a[228:231], a[148:151], v[144:147]
 buffer_load_dwordx4 v6, s[8:11], s30 offen lds
 v_mfma_f32_16x16x32_bf16 v[144:147], a[224:227], a[144:147], v[144:147]
 v_mfma_f32_16x16x32_bf16 v[140:143], a[224:227], a[136:139], v[140:143]
 v_mfma_f32_16x16x32_bf16 v[140:143], a[228:231], a[140:143], v[140:143]
 s_add_u32 m0, m0, 3072
 v_mfma_f32_16x16x32_bf16 v[136:139], a[228:231], a[132:135], v[136:139]
 v_mfma_f32_16x16x32_bf16 v[136:139], a[224:227], a[128:131], v[136:139]
 s_waitcnt vmcnt(12)
 v_mfma_f32_16x16x32_bf16 v[168:171], a[232:235], a[128:131], v[168:171]
 s_add_u32 s30, s30, s21
 v_mfma_f32_16x16x32_bf16 v[168:171], a[236:239], a[132:135], v[168:171]
 global_load_dwordx4 a[228:231], v0, s[70:71] offset:1024 sc1
 v_mfma_f32_16x16x32_bf16 v[172:175], a[236:239], a[140:143], v[172:175]
 v_mfma_f32_16x16x32_bf16 v[172:175], a[232:235], a[136:139], v[172:175]
 global_load_dwordx4 a[224:227], v0, s[70:71] offset:0 sc1
 v_mfma_f32_16x16x32_bf16 v[176:179], a[232:235], a[144:147], v[176:179]
 v_mfma_f32_16x16x32_bf16 v[176:179], a[236:239], a[148:151], v[176:179]
 v_mfma_f32_16x16x32_bf16 v[180:183], a[236:239], a[156:159], v[180:183]
 v_mfma_f32_16x16x32_bf16 v[180:183], a[232:235], a[152:155], v[180:183]
 v_mfma_f32_16x16x32_bf16 v[184:187], a[232:235], a[160:163], v[184:187]
 v_mfma_f32_16x16x32_bf16 v[184:187], a[236:239], a[164:167], v[184:187]
 v_mfma_f32_16x16x32_bf16 v[188:191], a[236:239], a[172:175], v[188:191]
 v_mfma_f32_16x16x32_bf16 v[188:191], a[232:235], a[168:171], v[188:191]
 v_mfma_f32_16x16x32_bf16 v[192:195], a[232:235], a[176:179], v[192:195]
 v_mfma_f32_16x16x32_bf16 v[192:195], a[236:239], a[180:183], v[192:195]
 v_mfma_f32_16x16x32_bf16 v[196:199], a[236:239], a[188:191], v[196:199]
 v_mfma_f32_16x16x32_bf16 v[196:199], a[232:235], a[184:187], v[196:199]
 s_waitcnt vmcnt(11)
 v_mfma_f32_16x16x32_bf16 v[228:231], a[192:195], a[184:187], v[228:231]
 v_mfma_f32_16x16x32_bf16 v[228:231], a[196:199], a[188:191], v[228:231]
 global_load_dwordx4 a[236:239], v0, s[70:71] offset:3072 sc1
 v_mfma_f32_16x16x32_bf16 v[224:227], a[196:199], a[180:183], v[224:227]
 v_mfma_f32_16x16x32_bf16 v[224:227], a[192:195], a[176:179], v[224:227]
 global_load_dwordx4 a[232:235], v0, s[70:71] offset:2048 sc1
 v_mfma_f32_16x16x32_bf16 v[220:223], a[192:195], a[168:171], v[220:223]
 s_add_u32 s70, s70, 8192
 s_addc_u32 s71, s71, 0
 v_mfma_f32_16x16x32_bf16 v[220:223], a[196:199], a[172:175], v[220:223]
 v_mfma_f32_16x16x32_bf16 v[216:219], a[196:199], a[164:167], v[216:219]
 v_mfma_f32_16x16x32_bf16 v[216:219], a[192:195], a[160:163], v[216:219]
 v_mfma_f32_16x16x32_bf16 v[212:215], a[192:195], a[152:155], v[212:215]
 v_mfma_f32_16x16x32_bf16 v[212:215], a[196:199], a[156:159], v[212:215]
 v_mfma_f32_16x16x32_bf16 v[208:211], a[196:199], a[148:151], v[208:211]
 v_mfma_f32_16x16x32_bf16 v[208:211], a[192:195], a[144:147], v[208:211]
 v_mfma_f32_16x16x32_bf16 v[204:207], a[192:195], a[136:139], v[204:207]
 v_mfma_f32_16x16x32_bf16 v[204:207], a[196:199], a[140:143], v[204:207]
 v_mfma_f32_16x16x32_bf16 v[200:203], a[196:199], a[132:135], v[200:203]
 v_mfma_f32_16x16x32_bf16 v[200:203], a[192:195], a[128:131], v[200:203]
 buffer_load_dwordx4 v6, s[8:11], s30 offen lds
 s_waitcnt vmcnt(11)
 v_mfma_f32_16x16x32_bf16 v[232:235], a[200:203], a[128:131], v[232:235]
 ds_read_b128 a[128:131], v2 offset:34816
 v_mfma_f32_16x16x32_bf16 v[232:235], a[204:207], a[132:135], v[232:235]
 global_load_dwordx4 a[196:199], v0, s[70:71] offset:-3072 sc1
 ds_read_b128 a[132:135], v2 offset:35840
 v_mfma_f32_16x16x32_bf16 v[236:239], a[204:207], a[140:143], v[236:239]
 ds_read_b128 a[140:143], v2 offset:39936
 v_mfma_f32_16x16x32_bf16 v[236:239], a[200:203], a[136:139], v[236:239]
 global_load_dwordx4 a[192:195], v0, s[70:71] offset:-4096 sc1
 ds_read_b128 a[136:139], v2 offset:38912
 v_mfma_f32_16x16x32_bf16 v[240:243], a[200:203], a[144:147], v[240:243]
 ds_read_b128 a[144:147], v2 offset:43008
 v_mfma_f32_16x16x32_bf16 v[240:243], a[204:207], a[148:151], v[240:243]
 ds_read_b128 a[148:151], v2 offset:44032
 v_mfma_f32_16x16x32_bf16 v[244:247], a[204:207], a[156:159], v[244:247]
 ds_read_b128 a[156:159], v2 offset:48128
 v_mfma_f32_16x16x32_bf16 v[244:247], a[200:203], a[152:155], v[244:247]
 ds_read_b128 a[152:155], v2 offset:47104
 s_add_u32 m0, m0, 1024
 v_mfma_f32_16x16x32_bf16 v[248:251], a[200:203], a[160:163], v[248:251]
 ds_read_b128 a[160:163], v2 offset:51200
 v_mfma_f32_16x16x32_bf16 v[248:251], a[204:207], a[164:167], v[248:251]
 ds_read_b128 a[164:167], v2 offset:52224
 v_mfma_f32_16x16x32_bf16 v[252:255], a[204:207], a[172:175], v[252:255]
 ds_read_b128 a[172:175], v2 offset:56320
 s_add_u32 s30, s30, s20
 v_mfma_f32_16x16x32_bf16 v[252:255], a[200:203], a[168:171], v[252:255]
 ds_read_b128 a[168:171], v2 offset:55296
 v_mfma_f32_16x16x32_bf16 a[248:251], a[200:203], a[176:179], a[248:251]
 ds_read_b128 a[176:179], v2 offset:59392
 v_mfma_f32_16x16x32_bf16 a[248:251], a[204:207], a[180:183], a[248:251]
 ds_read_b128 a[180:183], v2 offset:60416
 v_mfma_f32_16x16x32_bf16 a[252:255], a[204:207], a[188:191], a[252:255]
 ds_read_b128 a[188:191], v2 offset:64512
 v_mfma_f32_16x16x32_bf16 a[252:255], a[200:203], a[184:187], a[252:255]
 ds_read_b128 a[184:187], v2 offset:63488
 s_waitcnt vmcnt(11) lgkmcnt(8)
 v_mfma_f32_16x16x32_bf16 v[16:19], a[208:211], a[128:131], v[16:19]
 buffer_load_dwordx4 v6, s[8:11], s30 offen lds
 v_mfma_f32_16x16x32_bf16 v[16:19], a[212:215], a[132:135], v[16:19]
 global_load_dwordx4 a[204:207], v0, s[70:71] offset:-1024 sc1
 s_add_u32 m0, m0, 3072
 v_mfma_f32_16x16x32_bf16 v[20:23], a[212:215], a[140:143], v[20:23]
 buffer_load_dword v4, off, s[64:67], 0 sc1
 v_mfma_f32_16x16x32_bf16 v[20:23], a[208:211], a[136:139], v[20:23]
 global_load_dwordx4 a[200:203], v0, s[70:71] offset:-2048 sc1
 v_mfma_f32_16x16x32_bf16 v[24:27], a[208:211], a[144:147], v[24:27]
 s_add_u32 s30, s30, s22
 v_mfma_f32_16x16x32_bf16 v[24:27], a[212:215], a[148:151], v[24:27]
 v_mfma_f32_16x16x32_bf16 v[28:31], a[212:215], a[156:159], v[28:31]
 v_mfma_f32_16x16x32_bf16 v[28:31], a[208:211], a[152:155], v[28:31]
 s_waitcnt lgkmcnt(0)
 v_mfma_f32_16x16x32_bf16 v[32:35], a[208:211], a[160:163], v[32:35]
 v_mfma_f32_16x16x32_bf16 v[32:35], a[212:215], a[164:167], v[32:35]
 v_mfma_f32_16x16x32_bf16 v[36:39], a[212:215], a[172:175], v[36:39]
 v_mfma_f32_16x16x32_bf16 v[36:39], a[208:211], a[168:171], v[36:39]
 v_mfma_f32_16x16x32_bf16 v[40:43], a[208:211], a[176:179], v[40:43]
 v_mfma_f32_16x16x32_bf16 v[40:43], a[212:215], a[180:183], v[40:43]
 v_mfma_f32_16x16x32_bf16 v[44:47], a[212:215], a[188:191], v[44:47]
 v_mfma_f32_16x16x32_bf16 v[44:47], a[208:211], a[184:187], v[44:47]
 s_waitcnt vmcnt(12)
 v_mfma_f32_16x16x32_bf16 v[76:79], a[216:219], a[184:187], v[76:79]
 v_lshrrev_b32 v5, 6, v1
 v_mfma_f32_16x16x32_bf16 v[76:79], a[220:223], a[188:191], v[76:79]
 global_load_dwordx4 a[212:215], v0, s[70:71] offset:1024 sc1
 v_mfma_f32_16x16x32_bf16 v[72:75], a[220:223], a[180:183], v[72:75]
 v_and_b32 v6, 48, v1
 v_mfma_f32_16x16x32_bf16 v[72:75], a[216:219], a[176:179], v[72:75]
 global_load_dwordx4 a[208:211], v0, s[70:71] offset:0 sc1
 v_lshl_add_u32 v5, v5, 11, v6
 v_mfma_f32_16x16x32_bf16 v[68:71], a[216:219], a[168:171], v[68:71]
 v_mfma_f32_16x16x32_bf16 v[68:71], a[220:223], a[172:175], v[68:71]
 s_mov_b32 m0, s52
 v_mfma_f32_16x16x32_bf16 v[64:67], a[220:223], a[164:167], v[64:67]
 s_add_u32 s3, s48, 31744
 v_mfma_f32_16x16x32_bf16 v[64:67], a[216:219], a[160:163], v[64:67]
 v_mfma_f32_16x16x32_bf16 v[60:63], a[216:219], a[152:155], v[60:63]
 buffer_load_dwordx4 v5, s[40:43], s48 offen lds
 v_mfma_f32_16x16x32_bf16 v[60:63], a[220:223], a[156:159], v[60:63]
 buffer_load_dwordx4 v5, s[40:43], s3 offen offset:1024 lds
 v_mfma_f32_16x16x32_bf16 v[56:59], a[220:223], a[148:151], v[56:59]
 v_mfma_f32_16x16x32_bf16 v[56:59], a[216:219], a[144:147], v[56:59]
 s_add_u32 s48, s48, 2097152
 v_mfma_f32_16x16x32_bf16 v[52:55], a[216:219], a[136:139], v[52:55]
 v_mfma_f32_16x16x32_bf16 v[52:55], a[220:223], a[140:143], v[52:55]
 v_mfma_f32_16x16x32_bf16 v[48:51], a[220:223], a[132:135], v[48:51]
 v_mfma_f32_16x16x32_bf16 v[48:51], a[216:219], a[128:131], v[48:51]
 s_waitcnt vmcnt(13)
 v_mfma_f32_16x16x32_bf16 v[80:83], a[224:227], a[128:131], v[80:83]
 v_mfma_f32_16x16x32_bf16 v[80:83], a[228:231], a[132:135], v[80:83]
 global_load_dwordx4 a[220:223], v0, s[70:71] offset:3072 sc1
 v_mfma_f32_16x16x32_bf16 v[84:87], a[228:231], a[140:143], v[84:87]
 v_mfma_f32_16x16x32_bf16 v[84:87], a[224:227], a[136:139], v[84:87]
 global_load_dwordx4 a[216:219], v0, s[70:71] offset:2048 sc1
 v_mfma_f32_16x16x32_bf16 v[88:91], a[224:227], a[144:147], v[88:91]
 s_add_u32 s70, s70, 8192
 s_addc_u32 s71, s71, 0
 v_mfma_f32_16x16x32_bf16 v[88:91], a[228:231], a[148:151], v[88:91]
 v_mfma_f32_16x16x32_bf16 v[92:95], a[228:231], a[156:159], v[92:95]
 v_mfma_f32_16x16x32_bf16 v[92:95], a[224:227], a[152:155], v[92:95]
 v_mfma_f32_16x16x32_bf16 v[96:99], a[224:227], a[160:163], v[96:99]
 v_mfma_f32_16x16x32_bf16 v[96:99], a[228:231], a[164:167], v[96:99]
 v_mfma_f32_16x16x32_bf16 v[100:103], a[228:231], a[172:175], v[100:103]
 v_mfma_f32_16x16x32_bf16 v[100:103], a[224:227], a[168:171], v[100:103]
 v_mfma_f32_16x16x32_bf16 v[104:107], a[224:227], a[176:179], v[104:107]
 v_mfma_f32_16x16x32_bf16 v[104:107], a[228:231], a[180:183], v[104:107]
 v_mfma_f32_16x16x32_bf16 v[108:111], a[228:231], a[188:191], v[108:111]
 v_mfma_f32_16x16x32_bf16 v[108:111], a[224:227], a[184:187], v[108:111]
 s_waitcnt vmcnt(13)
 v_mfma_f32_16x16x32_bf16 a[244:247], a[232:235], a[184:187], a[244:247]
 v_mfma_f32_16x16x32_bf16 a[244:247], a[236:239], a[188:191], a[244:247]
 global_load_dwordx4 a[228:231], v0, s[70:71] offset:-3072 sc1
 v_mfma_f32_16x16x32_bf16 a[240:243], a[236:239], a[180:183], a[240:243]
 v_mfma_f32_16x16x32_bf16 a[240:243], a[232:235], a[176:179], a[240:243]
 global_load_dwordx4 a[224:227], v0, s[70:71] offset:-4096 sc1
 v_mfma_f32_16x16x32_bf16 v[132:135], a[232:235], a[168:171], v[132:135]
 v_mfma_f32_16x16x32_bf16 v[132:135], a[236:239], a[172:175], v[132:135]
 v_mfma_f32_16x16x32_bf16 v[128:131], a[236:239], a[164:167], v[128:131]
 v_mfma_f32_16x16x32_bf16 v[128:131], a[232:235], a[160:163], v[128:131]
 v_mfma_f32_16x16x32_bf16 v[124:127], a[232:235], a[152:155], v[124:127]
 v_mfma_f32_16x16x32_bf16 v[124:127], a[236:239], a[156:159], v[124:127]
 v_mfma_f32_16x16x32_bf16 v[120:123], a[236:239], a[148:151], v[120:123]
 v_mfma_f32_16x16x32_bf16 v[120:123], a[232:235], a[144:147], v[120:123]
 v_mfma_f32_16x16x32_bf16 v[116:119], a[232:235], a[136:139], v[116:119]
 v_mfma_f32_16x16x32_bf16 v[116:119], a[236:239], a[140:143], v[116:119]
 v_mfma_f32_16x16x32_bf16 v[112:115], a[236:239], a[132:135], v[112:115]
 v_mfma_f32_16x16x32_bf16 v[112:115], a[232:235], a[128:131], v[112:115]
 s_waitcnt vmcnt(12)
 v_mfma_f32_16x16x32_bf16 v[136:139], a[192:195], a[128:131], v[136:139]
 v_mfma_f32_16x16x32_bf16 v[136:139], a[196:199], a[132:135], v[136:139]
 global_load_dwordx4 a[236:239], v0, s[70:71] offset:-1024 sc1
 v_mfma_f32_16x16x32_bf16 v[140:143], a[196:199], a[140:143], v[140:143]
 v_mfma_f32_16x16x32_bf16 v[140:143], a[192:195], a[136:139], v[140:143]
 global_load_dwordx4 a[232:235], v0, s[70:71] offset:-2048 sc1
 v_mfma_f32_16x16x32_bf16 v[144:147], a[192:195], a[144:147], v[144:147]
 v_mfma_f32_16x16x32_bf16 v[144:147], a[196:199], a[148:151], v[144:147]
 v_mfma_f32_16x16x32_bf16 v[148:151], a[196:199], a[156:159], v[148:151]
 v_mfma_f32_16x16x32_bf16 v[148:151], a[192:195], a[152:155], v[148:151]
 v_mfma_f32_16x16x32_bf16 v[152:155], a[192:195], a[160:163], v[152:155]
 v_mfma_f32_16x16x32_bf16 v[152:155], a[196:199], a[164:167], v[152:155]
 v_mfma_f32_16x16x32_bf16 v[156:159], a[196:199], a[172:175], v[156:159]
 v_mfma_f32_16x16x32_bf16 v[156:159], a[192:195], a[168:171], v[156:159]
 v_mfma_f32_16x16x32_bf16 v[160:163], a[192:195], a[176:179], v[160:163]
 v_mfma_f32_16x16x32_bf16 v[160:163], a[196:199], a[180:183], v[160:163]
 v_mfma_f32_16x16x32_bf16 v[164:167], a[196:199], a[188:191], v[164:167]
 v_mfma_f32_16x16x32_bf16 v[164:167], a[192:195], a[184:187], v[164:167]
 s_waitcnt vmcnt(10)
 v_mfma_f32_16x16x32_bf16 v[196:199], a[200:203], a[184:187], v[196:199]
 v_mfma_f32_16x16x32_bf16 v[196:199], a[204:207], a[188:191], v[196:199]
 global_load_dwordx4 a[196:199], v0, s[70:71] offset:1024 sc1
 v_mfma_f32_16x16x32_bf16 v[192:195], a[204:207], a[180:183], v[192:195]
 v_mfma_f32_16x16x32_bf16 v[192:195], a[200:203], a[176:179], v[192:195]
 global_load_dwordx4 a[192:195], v0, s[70:71] offset:0 sc1
 v_mfma_f32_16x16x32_bf16 v[188:191], a[200:203], a[168:171], v[188:191]
 v_mfma_f32_16x16x32_bf16 v[188:191], a[204:207], a[172:175], v[188:191]
 v_mfma_f32_16x16x32_bf16 v[184:187], a[204:207], a[164:167], v[184:187]
 v_mfma_f32_16x16x32_bf16 v[184:187], a[200:203], a[160:163], v[184:187]
 v_mfma_f32_16x16x32_bf16 v[180:183], a[200:203], a[152:155], v[180:183]
 v_mfma_f32_16x16x32_bf16 v[180:183], a[204:207], a[156:159], v[180:183]
 v_mfma_f32_16x16x32_bf16 v[176:179], a[204:207], a[148:151], v[176:179]
 v_mfma_f32_16x16x32_bf16 v[176:179], a[200:203], a[144:147], v[176:179]
 v_mfma_f32_16x16x32_bf16 v[172:175], a[200:203], a[136:139], v[172:175]
 v_mfma_f32_16x16x32_bf16 v[172:175], a[204:207], a[140:143], v[172:175]
 v_mfma_f32_16x16x32_bf16 v[168:171], a[204:207], a[132:135], v[168:171]
 v_mfma_f32_16x16x32_bf16 v[168:171], a[200:203], a[128:131], v[168:171]
 s_waitcnt vmcnt(10)
 v_mfma_f32_16x16x32_bf16 v[200:203], a[208:211], a[128:131], v[200:203]
 v_mfma_f32_16x16x32_bf16 v[200:203], a[212:215], a[132:135], v[200:203]
 global_load_dwordx4 a[204:207], v0, s[70:71] offset:3072 sc1
 v_mfma_f32_16x16x32_bf16 v[204:207], a[212:215], a[140:143], v[204:207]
 v_mfma_f32_16x16x32_bf16 v[204:207], a[208:211], a[136:139], v[204:207]
 global_load_dwordx4 a[200:203], v0, s[70:71] offset:2048 sc1
 v_mfma_f32_16x16x32_bf16 v[208:211], a[208:211], a[144:147], v[208:211]
 s_add_u32 s70, s70, 8192
 s_addc_u32 s71, s71, 0
 v_mfma_f32_16x16x32_bf16 v[208:211], a[212:215], a[148:151], v[208:211]
 v_mfma_f32_16x16x32_bf16 v[212:215], a[212:215], a[156:159], v[212:215]
 v_mfma_f32_16x16x32_bf16 v[212:215], a[208:211], a[152:155], v[212:215]
 v_mfma_f32_16x16x32_bf16 v[216:219], a[208:211], a[160:163], v[216:219]
 v_mfma_f32_16x16x32_bf16 v[216:219], a[212:215], a[164:167], v[216:219]
 v_mfma_f32_16x16x32_bf16 v[220:223], a[212:215], a[172:175], v[220:223]
 v_cmp_gt_i32 vcc, s55, v4
 s_and_b64 vcc, exec, vcc
 s_cbranch_vccnz Lspin_pb
Lok_pb:
 s_add_u32 s55, s55, 1
 s_waitcnt lgkmcnt(0)
 s_barrier
 v_mfma_f32_16x16x32_bf16 v[220:223], a[208:211], a[168:171], v[220:223]
 s_cmp_eq_u32 s25, 0
 s_cbranch_scc1 Lxrg
Lxrgr:
 v_mfma_f32_16x16x32_bf16 v[224:227], a[208:211], a[176:179], v[224:227]
 v_mfma_f32_16x16x32_bf16 v[224:227], a[212:215], a[180:183], v[224:227]
 v_mfma_f32_16x16x32_bf16 v[228:231], a[212:215], a[188:191], v[228:231]
 v_mfma_f32_16x16x32_bf16 v[228:231], a[208:211], a[184:187], v[228:231]
 s_waitcnt vmcnt(8)
 v_mfma_f32_16x16x32_bf16 a[252:255], a[216:219], a[184:187], a[252:255]
 ds_read_b128 a[184:187], v1 offset:28672
 v_mfma_f32_16x16x32_bf16 a[252:255], a[220:223], a[188:191], a[252:255]
 global_load_dwordx4 a[212:215], v0, s[70:71] offset:-3072 sc1
 ds_read_b128 a[188:191], v1 offset:29696
 v_mfma_f32_16x16x32_bf16 a[248:251], a[220:223], a[180:183], a[248:251]
 ds_read_b128 a[180:183], v1 offset:25600
 v_mfma_f32_16x16x32_bf16 a[248:251], a[216:219], a[176:179], a[248:251]
 global_load_dwordx4 a[208:211], v0, s[70:71] offset:-4096 sc1
 ds_read_b128 a[176:179], v1 offset:24576
 v_mfma_f32_16x16x32_bf16 v[252:255], a[216:219], a[168:171], v[252:255]
 ds_read_b128 a[168:171], v1 offset:20480
 v_mfma_f32_16x16x32_bf16 v[252:255], a[220:223], a[172:175], v[252:255]
 ds_read_b128 a[172:175], v1 offset:21504
 v_mfma_f32_16x16x32_bf16 v[248:251], a[220:223], a[164:167], v[248:251]
 ds_read_b128 a[164:167], v1 offset:17408
 v_mfma_f32_16x16x32_bf16 v[248:251], a[216:219], a[160:163], v[248:251]
 ds_read_b128 a[160:163], v1 offset:16384
 v_mfma_f32_16x16x32_bf16 v[244:247], a[216:219], a[152:155], v[244:247]
 ds_read_b128 a[152:155], v1 offset:12288
 v_mfma_f32_16x16x32_bf16 v[244:247], a[220:223], a[156:159], v[244:247]
 ds_read_b128 a[156:159], v1 offset:13312
 v_mfma_f32_16x16x32_bf16 v[240:243], a[220:223], a[148:151], v[240:243]
 ds_read_b128 a[148:151], v1 offset:9216
 v_mfma_f32_16x16x32_bf16 v[240:243], a[216:219], a[144:147], v[240:243]
 ds_read_b128 a[144:147], v1 offset:8192
 v_mfma_f32_16x16x32_bf16 v[236:239], a[216:219], a[136:139], v[236:239]
 ds_read_b128 a[136:139], v1 offset:4096
 v_mfma_f32_16x16x32_bf16 v[236:239], a[220:223], a[140:143], v[236:239]
 ds_read_b128 a[140:143], v1 offset:5120
 v_mfma_f32_16x16x32_bf16 v[232:235], a[220:223], a[132:135], v[232:235]
 global_load_dwordx4 a[220:223], v0, s[70:71] offset:-1024 sc1
 ds_read_b128 a[132:135], v1 offset:1024
 v_mfma_f32_16x16x32_bf16 v[232:235], a[216:219], a[128:131], v[232:235]
 global_load_dwordx4 a[216:219], v0, s[70:71] offset:-2048 sc1
 ds_read_b128 a[128:131], v1
 s_waitcnt vmcnt(10) lgkmcnt(8)
 v_mfma_f32_16x16x32_bf16 v[44:47], a[224:227], a[184:187], v[44:47]
 v_mfma_f32_16x16x32_bf16 v[44:47], a[228:231], a[188:191], v[44:47]
 v_mov_b32 v6, v3
 s_cmp_eq_u32 s25, 0
 s_cbranch_scc1 Lgat1
Lgatr1:
 v_mfma_f32_16x16x32_bf16 v[40:43], a[228:231], a[180:183], v[40:43]
 v_mfma_f32_16x16x32_bf16 v[40:43], a[224:227], a[176:179], v[40:43]
 v_mfma_f32_16x16x32_bf16 v[36:39], a[224:227], a[168:171], v[36:39]
 v_mfma_f32_16x16x32_bf16 v[36:39], a[228:231], a[172:175], v[36:39]
 s_add_u32 m0, s50, 2048
 v_mfma_f32_16x16x32_bf16 v[32:35], a[228:231], a[164:167], v[32:35]
 v_mfma_f32_16x16x32_bf16 v[32:35], a[224:227], a[160:163], v[32:35]
 s_waitcnt lgkmcnt(0)
 v_mfma_f32_16x16x32_bf16 v[28:31], a[224:227], a[152:155], v[28:31]
 v_mfma_f32_16x16x32_bf16 v[28:31], a[228:231], a[156:159], v[28:31]
 v_mfma_f32_16x16x32_bf16 v[24:27], a[228:231], a[148:151], v[24:27]
 v_mfma_f32_16x16x32_bf16 v[24:27], a[224:227], a[144:147], v[24:27]
 v_mfma_f32_16x16x32_bf16 v[20:23], a[224:227], a[136:139], v[20:23]
 buffer_load_dwordx4 v6, s[8:11], s30 offen lds
 v_mfma_f32_16x16x32_bf16 v[20:23], a[228:231], a[140:143], v[20:23]
 v_mfma_f32_16x16x32_bf16 v[16:19], a[228:231], a[132:135], v[16:19]
 v_mfma_f32_16x16x32_bf16 v[16:19], a[224:227], a[128:131], v[16:19]
 s_waitcnt vmcnt(9)
 v_mfma_f32_16x16x32_bf16 v[48:51], a[232:235], a[128:131], v[48:51]
 s_add_u32 m0, m0, 1024
 v_mfma_f32_16x16x32_bf16 v[48:51], a[236:239], a[132:135], v[48:51]
 global_load_dwordx4 a[228:231], v0, s[70:71] offset:1024 sc1
 v_mfma_f32_16x16x32_bf16 v[52:55], a[236:239], a[140:143], v[52:55]
 v_mfma_f32_16x16x32_bf16 v[52:55], a[232:235], a[136:139], v[52:55]
 global_load_dwordx4 a[224:227], v0, s[70:71] offset:0 sc1
 s_add_u32 s30, s30, s20
 v_mfma_f32_16x16x32_bf16 v[56:59], a[232:235], a[144:147], v[56:59]
 v_mfma_f32_16x16x32_bf16 v[56:59], a[236:239], a[148:151], v[56:59]
 v_mfma_f32_16x16x32_bf16 v[60:63], a[236:239], a[156:159], v[60:63]
 v_mfma_f32_16x16x32_bf16 v[60:63], a[232:235], a[152:155], v[60:63]
 buffer_load_dwordx4 v6, s[8:11], s30 offen lds
 v_mfma_f32_16x16x32_bf16 v[64:67], a[232:235], a[160:163], v[64:67]
 v_mfma_f32_16x16x32_bf16 v[64:67], a[236:239], a[164:167], v[64:67]
 v_mfma_f32_16x16x32_bf16 v[68:71], a[236:239], a[172:175], v[68:71]
 v_mfma_f32_16x16x32_bf16 v[68:71], a[232:235], a[168:171], v[68:71]
 s_add_u32 m0, m0, 3072
 v_mfma_f32_16x16x32_bf16 v[72:75], a[232:235], a[176:179], v[72:75]
 v_mfma_f32_16x16x32_bf16 v[72:75], a[236:239], a[180:183], v[72:75]
 v_mfma_f32_16x16x32_bf16 v[76:79], a[236:239], a[188:191], v[76:79]
 s_add_u32 s30, s30, s21
 v_mfma_f32_16x16x32_bf16 v[76:79], a[232:235], a[184:187], v[76:79]
 s_waitcnt vmcnt(10)
 v_mfma_f32_16x16x32_bf16 v[108:111], a[192:195], a[184:187], v[108:111]
 v_mfma_f32_16x16x32_bf16 v[108:111], a[196:199], a[188:191], v[108:111]
 global_load_dwordx4 a[236:239], v0, s[70:71] offset:3072 sc1
 v_mfma_f32_16x16x32_bf16 v[104:107], a[196:199], a[180:183], v[104:107]
 v_mfma_f32_16x16x32_bf16 v[104:107], a[192:195], a[176:179], v[104:107]
 global_load_dwordx4 a[232:235], v0, s[70:71] offset:2048 sc1
 v_mfma_f32_16x16x32_bf16 v[100:103], a[192:195], a[168:171], v[100:103]
 s_add_u32 s70, s70, 8192
 s_addc_u32 s71, s71, 0
 v_mfma_f32_16x16x32_bf16 v[100:103], a[196:199], a[172:175], v[100:103]
 v_mfma_f32_16x16x32_bf16 v[96:99], a[196:199], a[164:167], v[96:99]
 v_mfma_f32_16x16x32_bf16 v[96:99], a[192:195], a[160:163], v[96:99]
 v_mfma_f32_16x16x32_bf16 v[92:95], a[192:195], a[152:155], v[92:95]
 v_mfma_f32_16x16x32_bf16 v[92:95], a[196:199], a[156:159], v[92:95]
 v_mfma_f32_16x16x32_bf16 v[88:91], a[196:199], a[148:151], v[88:91]
 v_mfma_f32_16x16x32_bf16 v[88:91], a[192:195], a[144:147], v[88:91]
 v_mfma_f32_16x16x32_bf16 v[84:87], a[192:195], a[136:139], v[84:87]
 v_mfma_f32_16x16x32_bf16 v[84:87], a[196:199], a[140:143], v[84:87]
 v_mfma_f32_16x16x32_bf16 v[80:83], a[196:199], a[132:135], v[80:83]
 v_mfma_f32_16x16x32_bf16 v[80:83], a[192:195], a[128:131], v[80:83]
 s_waitcnt vmcnt(10)
 v_mfma_f32_16x16x32_bf16 v[112:115], a[200:203], a[128:131], v[112:115]
 v_mfma_f32_16x16x32_bf16 v[112:115], a[204:207], a[132:135], v[112:115]
 global_load_dwordx4 a[196:199], v0, s[70:71] offset:-3072 sc1
 v_mfma_f32_16x16x32_bf16 v[116:119], a[204:207], a[140:143], v[116:119]
 v_mfma_f32_16x16x32_bf16 v[116:119], a[200:203], a[136:139], v[116:119]
 global_load_dwordx4 a[192:195], v0, s[70:71] offset:-4096 sc1
 v_mfma_f32_16x16x32_bf16 v[120:123], a[200:203], a[144:147], v[120:123]
 v_mfma_f32_16x16x32_bf16 v[120:123], a[204:207], a[148:151], v[120:123]
 v_mfma_f32_16x16x32_bf16 v[124:127], a[204:207], a[156:159], v[124:127]
 v_mfma_f32_16x16x32_bf16 v[124:127], a[200:203], a[152:155], v[124:127]
 v_mfma_f32_16x16x32_bf16 v[128:131], a[200:203], a[160:163], v[128:131]
 v_mfma_f32_16x16x32_bf16 v[128:131], a[204:207], a[164:167], v[128:131]
 v_mfma_f32_16x16x32_bf16 v[132:135], a[204:207], a[172:175], v[132:135]
 v_mfma_f32_16x16x32_bf16 v[132:135], a[200:203], a[168:171], v[132:135]
 v_mfma_f32_16x16x32_bf16 a[240:243], a[200:203], a[176:179], a[240:243]
 v_mfma_f32_16x16x32_bf16 a[240:243], a[204:207], a[180:183], a[240:243]
 v_mfma_f32_16x16x32_bf16 a[244:247], a[204:207], a[188:191], a[244:247]
 v_mfma_f32_16x16x32_bf16 a[244:247], a[200:203], a[184:187], a[244:247]
 s_waitcnt vmcnt(10)
 v_mfma_f32_16x16x32_bf16 v[164:167], a[208:211], a[184:187], v[164:167]
 v_mfma_f32_16x16x32_bf16 v[164:167], a[212:215], a[188:191], v[164:167]
 global_load_dwordx4 a[204:207], v0, s[70:71] offset:-1024 sc1
 v_mfma_f32_16x16x32_bf16 v[160:163], a[212:215], a[180:183], v[160:163]
 v_mfma_f32_16x16x32_bf16 v[160:163], a[208:211], a[176:179], v[160:163]
 global_load_dwordx4 a[200:203], v0, s[70:71] offset:-2048 sc1
 v_mfma_f32_16x16x32_bf16 v[156:159], a[208:211], a[168:171], v[156:159]
 v_mfma_f32_16x16x32_bf16 v[156:159], a[212:215], a[172:175], v[156:159]
 v_mfma_f32_16x16x32_bf16 v[152:155], a[212:215], a[164:167], v[152:155]
 buffer_load_dwordx4 v6, s[8:11], s30 offen lds
 v_mfma_f32_16x16x32_bf16 v[152:155], a[208:211], a[160:163], v[152:155]
 v_mfma_f32_16x16x32_bf16 v[148:151], a[208:211], a[152:155], v[148:151]
 v_mfma_f32_16x16x32_bf16 v[148:151], a[212:215], a[156:159], v[148:151]
 v_mfma_f32_16x16x32_bf16 v[144:147], a[212:215], a[148:151], v[144:147]
 s_add_u32 m0, m0, 1024
 v_mfma_f32_16x16x32_bf16 v[144:147], a[208:211], a[144:147], v[144:147]
 v_mfma_f32_16x16x32_bf16 v[140:143], a[208:211], a[136:139], v[140:143]
 v_mfma_f32_16x16x32_bf16 v[140:143], a[212:215], a[140:143], v[140:143]
 v_mfma_f32_16x16x32_bf16 v[136:139], a[212:215], a[132:135], v[136:139]
 s_add_u32 s30, s30, s20
 v_mfma_f32_16x16x32_bf16 v[136:139], a[208:211], a[128:131], v[136:139]
 s_waitcnt vmcnt(11)
 v_mfma_f32_16x16x32_bf16 v[168:171], a[216:219], a[128:131], v[168:171]
 v_mfma_f32_16x16x32_bf16 v[168:171], a[220:223], a[132:135], v[168:171]
 global_load_dwordx4 a[212:215], v0, s[70:71] offset:1024 sc1
 v_mfma_f32_16x16x32_bf16 v[172:175], a[220:223], a[140:143], v[172:175]
 buffer_load_dwordx4 v6, s[8:11], s30 offen lds
 v_mfma_f32_16x16x32_bf16 v[172:175], a[216:219], a[136:139], v[172:175]
 global_load_dwordx4 a[208:211], v0, s[70:71] offset:0 sc1
 v_mfma_f32_16x16x32_bf16 v[176:179], a[216:219], a[144:147], v[176:179]
 v_mfma_f32_16x16x32_bf16 v[176:179], a[220:223], a[148:151], v[176:179]
 s_add_u32 m0, m0, 3072
 v_mfma_f32_16x16x32_bf16 v[180:183], a[220:223], a[156:159], v[180:183]
 v_mfma_f32_16x16x32_bf16 v[180:183], a[216:219], a[152:155], v[180:183]
 v_mfma_f32_16x16x32_bf16 v[184:187], a[216:219], a[160:163], v[184:187]
 v_mfma_f32_16x16x32_bf16 v[184:187], a[220:223], a[164:167], v[184:187]
 s_add_u32 s30, s30, s21
 v_mfma_f32_16x16x32_bf16 v[188:191], a[220:223], a[172:175], v[188:191]
 v_mfma_f32_16x16x32_bf16 v[188:191], a[216:219], a[168:171], v[188:191]
 v_mfma_f32_16x16x32_bf16 v[192:195], a[216:219], a[176:179], v[192:195]
 v_mfma_f32_16x16x32_bf16 v[192:195], a[220:223], a[180:183], v[192:195]
 v_mfma_f32_16x16x32_bf16 v[196:199], a[220:223], a[188:191], v[196:199]
 v_mfma_f32_16x16x32_bf16 v[196:199], a[216:219], a[184:187], v[196:199]
 s_waitcnt vmcnt(11)
 v_mfma_f32_16x16x32_bf16 v[228:231], a[224:227], a[184:187], v[228:231]
 v_mfma_f32_16x16x32_bf16 v[228:231], a[228:231], a[188:191], v[228:231]
 global_load_dwordx4 a[220:223], v0, s[70:71] offset:3072 sc1
 v_mfma_f32_16x16x32_bf16 v[224:227], a[228:231], a[180:183], v[224:227]
 v_mfma_f32_16x16x32_bf16 v[224:227], a[224:227], a[176:179], v[224:227]
 global_load_dwordx4 a[216:219], v0, s[70:71] offset:2048 sc1
 v_mfma_f32_16x16x32_bf16 v[220:223], a[224:227], a[168:171], v[220:223]
 s_add_u32 s70, s70, 8192
 s_addc_u32 s71, s71, 0
 v_mfma_f32_16x16x32_bf16 v[220:223], a[228:231], a[172:175], v[220:223]
 v_mfma_f32_16x16x32_bf16 v[216:219], a[228:231], a[164:167], v[216:219]
 v_mfma_f32_16x16x32_bf16 v[216:219], a[224:227], a[160:163], v[216:219]
 v_mfma_f32_16x16x32_bf16 v[212:215], a[224:227], a[152:155], v[212:215]
 v_mfma_f32_16x16x32_bf16 v[212:215], a[228:231], a[156:159], v[212:215]
 v_mfma_f32_16x16x32_bf16 v[208:211], a[228:231], a[148:151], v[208:211]
 v_mfma_f32_16x16x32_bf16 v[208:211], a[224:227], a[144:147], v[208:211]
 v_mfma_f32_16x16x32_bf16 v[204:207], a[224:227], a[136:139], v[204:207]
 v_mfma_f32_16x16x32_bf16 v[204:207], a[228:231], a[140:143], v[204:207]
 v_mfma_f32_16x16x32_bf16 v[200:203], a[228:231], a[132:135], v[200:203]
 v_mfma_f32_16x16x32_bf16 v[200:203], a[224:227], a[128:131], v[200:203]
 s_waitcnt vmcnt(10)
 v_mfma_f32_16x16x32_bf16 v[232:235], a[232:235], a[128:131], v[232:235]
 ds_read_b128 a[128:131], v1 offset:32768
 v_mfma_f32_16x16x32_bf16 v[232:235], a[236:239], a[132:135], v[232:235]
 global_load_dwordx4 a[228:231], v0, s[70:71] offset:-3072 sc1
 ds_read_b128 a[132:135], v1 offset:33792
 v_mfma_f32_16x16x32_bf16 v[236:239], a[236:239], a[140:143], v[236:239]
 ds_read_b128 a[140:143], v1 offset:37888
 v_mfma_f32_16x16x32_bf16 v[236:239], a[232:235], a[136:139], v[236:239]
 global_load_dwordx4 a[224:227], v0, s[70:71] offset:-4096 sc1
 ds_read_b128 a[136:139], v1 offset:36864
 v_mfma_f32_16x16x32_bf16 v[240:243], a[232:235], a[144:147], v[240:243]
 ds_read_b128 a[144:147], v1 offset:40960
 v_mfma_f32_16x16x32_bf16 v[240:243], a[236:239], a[148:151], v[240:243]
 ds_read_b128 a[148:151], v1 offset:41984
 v_mfma_f32_16x16x32_bf16 v[244:247], a[236:239], a[156:159], v[244:247]
 ds_read_b128 a[156:159], v1 offset:46080
 v_mfma_f32_16x16x32_bf16 v[244:247], a[232:235], a[152:155], v[244:247]
 ds_read_b128 a[152:155], v1 offset:45056
 v_mfma_f32_16x16x32_bf16 v[248:251], a[232:235], a[160:163], v[248:251]
 ds_read_b128 a[160:163], v1 offset:49152
 v_mfma_f32_16x16x32_bf16 v[248:251], a[236:239], a[164:167], v[248:251]
 ds_read_b128 a[164:167], v1 offset:50176
 v_mfma_f32_16x16x32_bf16 v[252:255], a[236:239], a[172:175], v[252:255]
 ds_read_b128 a[172:175], v1 offset:54272
 v_mfma_f32_16x16x32_bf16 v[252:255], a[232:235], a[168:171], v[252:255]
 ds_read_b128 a[168:171], v1 offset:53248
 v_mfma_f32_16x16x32_bf16 a[248:251], a[232:235], a[176:179], a[248:251]
 ds_read_b128 a[176:179], v1 offset:57344
 v_mfma_f32_16x16x32_bf16 a[248:251], a[236:239], a[180:183], a[248:251]
 ds_read_b128 a[180:183], v1 offset:58368
 v_mfma_f32_16x16x32_bf16 a[252:255], a[236:239], a[188:191], a[252:255]
 ds_read_b128 a[188:191], v1 offset:62464
 v_mfma_f32_16x16x32_bf16 a[252:255], a[232:235], a[184:187], a[252:255]
 ds_read_b128 a[184:187], v1 offset:61440
 s_waitcnt vmcnt(10) lgkmcnt(8)
 v_mfma_f32_16x16x32_bf16 v[16:19], a[192:195], a[128:131], v[16:19]
 v_mfma_f32_16x16x32_bf16 v[16:19], a[196:199], a[132:135], v[16:19]
 buffer_load_dwordx4 v6, s[8:11], s30 offen lds
 v_mfma_f32_16x16x32_bf16 v[20:23], a[196:199], a[140:143], v[20:23]
 v_mfma_f32_16x16x32_bf16 v[20:23], a[192:195], a[136:139], v[20:23]
 v_mfma_f32_16x16x32_bf16 v[24:27], a[192:195], a[144:147], v[24:27]
 s_add_u32 m0, m0, 1024
 v_mfma_f32_16x16x32_bf16 v[24:27], a[196:199], a[148:151], v[24:27]
 v_mfma_f32_16x16x32_bf16 v[28:31], a[196:199], a[156:159], v[28:31]
 v_mfma_f32_16x16x32_bf16 v[28:31], a[192:195], a[152:155], v[28:31]
 s_waitcnt lgkmcnt(0)
 v_mfma_f32_16x16x32_bf16 v[32:35], a[192:195], a[160:163], v[32:35]
 s_add_u32 s30, s30, s20
 v_mfma_f32_16x16x32_bf16 v[32:35], a[196:199], a[164:167], v[32:35]
 v_mfma_f32_16x16x32_bf16 v[36:39], a[196:199], a[172:175], v[36:39]
 v_mfma_f32_16x16x32_bf16 v[36:39], a[192:195], a[168:171], v[36:39]
 v_mfma_f32_16x16x32_bf16 v[40:43], a[192:195], a[176:179], v[40:43]
 buffer_load_dwordx4 v6, s[8:11], s30 offen lds
 v_mfma_f32_16x16x32_bf16 v[40:43], a[196:199], a[180:183], v[40:43]
 v_mfma_f32_16x16x32_bf16 v[44:47], a[196:199], a[188:191], v[44:47]
 v_mfma_f32_16x16x32_bf16 v[44:47], a[192:195], a[184:187], v[44:47]
 s_add_u32 m0, m0, 3072
 s_waitcnt vmcnt(10)
 v_mfma_f32_16x16x32_bf16 v[76:79], a[200:203], a[184:187], v[76:79]
 v_mfma_f32_16x16x32_bf16 v[76:79], a[204:207], a[188:191], v[76:79]
 global_load_dwordx4 a[196:199], v0, s[70:71] offset:-1024 sc1
 v_mfma_f32_16x16x32_bf16 v[72:75], a[204:207], a[180:183], v[72:75]
 v_mfma_f32_16x16x32_bf16 v[72:75], a[200:203], a[176:179], v[72:75]
 global_load_dwordx4 a[192:195], v0, s[70:71] offset:-2048 sc1
 s_add_u32 s30, s30, s21
 v_mfma_f32_16x16x32_bf16 v[68:71], a[200:203], a[168:171], v[68:71]
 v_mfma_f32_16x16x32_bf16 v[68:71], a[204:207], a[172:175], v[68:71]
 v_mfma_f32_16x16x32_bf16 v[64:67], a[204:207], a[164:167], v[64:67]
 v_mfma_f32_16x16x32_bf16 v[64:67], a[200:203], a[160:163], v[64:67]
 v_mfma_f32_16x16x32_bf16 v[60:63], a[200:203], a[152:155], v[60:63]
 v_mfma_f32_16x16x32_bf16 v[60:63], a[204:207], a[156:159], v[60:63]
 v_mfma_f32_16x16x32_bf16 v[56:59], a[204:207], a[148:151], v[56:59]
 v_mfma_f32_16x16x32_bf16 v[56:59], a[200:203], a[144:147], v[56:59]
 v_mfma_f32_16x16x32_bf16 v[52:55], a[200:203], a[136:139], v[52:55]
 v_mfma_f32_16x16x32_bf16 v[52:55], a[204:207], a[140:143], v[52:55]
 v_mfma_f32_16x16x32_bf16 v[48:51], a[204:207], a[132:135], v[48:51]
 v_mfma_f32_16x16x32_bf16 v[48:51], a[200:203], a[128:131], v[48:51]
 s_waitcnt vmcnt(8)
 v_mfma_f32_16x16x32_bf16 v[80:83], a[208:211], a[128:131], v[80:83]
 v_mfma_f32_16x16x32_bf16 v[80:83], a[212:215], a[132:135], v[80:83]
 global_load_dwordx4 a[204:207], v0, s[70:71] offset:1024 sc1
 v_mfma_f32_16x16x32_bf16 v[84:87], a[212:215], a[140:143], v[84:87]
 v_mfma_f32_16x16x32_bf16 v[84:87], a[208:211], a[136:139], v[84:87]
 global_load_dwordx4 a[200:203], v0, s[70:71] offset:0 sc1
 v_mfma_f32_16x16x32_bf16 v[88:91], a[208:211], a[144:147], v[88:91]
 v_mfma_f32_16x16x32_bf16 v[88:91], a[212:215], a[148:151], v[88:91]
 v_mfma_f32_16x16x32_bf16 v[92:95], a[212:215], a[156:159], v[92:95]
 v_mfma_f32_16x16x32_bf16 v[92:95], a[208:211], a[152:155], v[92:95]
 v_mfma_f32_16x16x32_bf16 v[96:99], a[208:211], a[160:163], v[96:99]
 v_mfma_f32_16x16x32_bf16 v[96:99], a[212:215], a[164:167], v[96:99]
 v_mfma_f32_16x16x32_bf16 v[100:103], a[212:215], a[172:175], v[100:103]
 v_mfma_f32_16x16x32_bf16 v[100:103], a[208:211], a[168:171], v[100:103]
 v_mfma_f32_16x16x32_bf16 v[104:107], a[208:211], a[176:179], v[104:107]
 v_mfma_f32_16x16x32_bf16 v[104:107], a[212:215], a[180:183], v[104:107]
 v_mfma_f32_16x16x32_bf16 v[108:111], a[212:215], a[188:191], v[108:111]
 v_mfma_f32_16x16x32_bf16 v[108:111], a[208:211], a[184:187], v[108:111]
 s_waitcnt vmcnt(8)
 v_mfma_f32_16x16x32_bf16 a[244:247], a[216:219], a[184:187], a[244:247]
 v_mfma_f32_16x16x32_bf16 a[244:247], a[220:223], a[188:191], a[244:247]
 global_load_dwordx4 a[212:215], v0, s[70:71] offset:3072 sc1
 v_mfma_f32_16x16x32_bf16 a[240:243], a[220:223], a[180:183], a[240:243]
 v_mfma_f32_16x16x32_bf16 a[240:243], a[216:219], a[176:179], a[240:243]
 global_load_dwordx4 a[208:211], v0, s[70:71] offset:2048 sc1
 v_mfma_f32_16x16x32_bf16 v[132:135], a[216:219], a[168:171], v[132:135]
 s_add_u32 s70, s70, 8192
 s_addc_u32 s71, s71, 0
 v_mfma_f32_16x16x32_bf16 v[132:135], a[220:223], a[172:175], v[132:135]
 v_mfma_f32_16x16x32_bf16 v[128:131], a[220:223], a[164:167], v[128:131]
 v_mfma_f32_16x16x32_bf16 v[128:131], a[216:219], a[160:163], v[128:131]
 v_mfma_f32_16x16x32_bf16 v[124:127], a[216:219], a[152:155], v[124:127]
 v_mfma_f32_16x16x32_bf16 v[124:127], a[220:223], a[156:159], v[124:127]
 v_mfma_f32_16x16x32_bf16 v[120:123], a[220:223], a[148:151], v[120:123]
 v_mfma_f32_16x16x32_bf16 v[120:123], a[216:219], a[144:147], v[120:123]
 buffer_load_dwordx4 v6, s[8:11], s30 offen lds
 v_mfma_f32_16x16x32_bf16 v[116:119], a[216:219], a[136:139], v[116:119]
 v_mfma_f32_16x16x32_bf16 v[116:119], a[220:223], a[140:143], v[116:119]
 v_mfma_f32_16x16x32_bf16 v[112:115], a[220:223], a[132:135], v[112:115]
 s_add_u32 m0, m0, 1024
 v_mfma_f32_16x16x32_bf16 v[112:115], a[216:219], a[128:131], v[112:115]
 s_waitcnt vmcnt(9)
 v_mfma_f32_16x16x32_bf16 v[136:139], a[224:227], a[128:131], v[136:139]
 v_mfma_f32_16x16x32_bf16 v[136:139], a[228:231], a[132:135], v[136:139]
 global_load_dwordx4 a[220:223], v0, s[70:71] offset:-3072 sc1
 v_mfma_f32_16x16x32_bf16 v[140:143], a[228:231], a[140:143], v[140:143]
 s_add_u32 s30, s30, s20
 v_mfma_f32_16x16x32_bf16 v[140:143], a[224:227], a[136:139], v[140:143]
 global_load_dwordx4 a[216:219], v0, s[70:71] offset:-4096 sc1
 v_mfma_f32_16x16x32_bf16 v[144:147], a[224:227], a[144:147], v[144:147]
 v_mfma_f32_16x16x32_bf16 v[144:147], a[228:231], a[148:151], v[144:147]
 v_mfma_f32_16x16x32_bf16 v[148:151], a[228:231], a[156:159], v[148:151]
 buffer_load_dwordx4 v6, s[8:11], s30 offen lds
 v_mfma_f32_16x16x32_bf16 v[148:151], a[224:227], a[152:155], v[148:151]
 v_mfma_f32_16x16x32_bf16 v[152:155], a[224:227], a[160:163], v[152:155]
 v_mfma_f32_16x16x32_bf16 v[152:155], a[228:231], a[164:167], v[152:155]
 s_add_u32 m0, m0, 3072
 v_mfma_f32_16x16x32_bf16 v[156:159], a[228:231], a[172:175], v[156:159]
 v_mfma_f32_16x16x32_bf16 v[156:159], a[224:227], a[168:171], v[156:159]
 v_mfma_f32_16x16x32_bf16 v[160:163], a[224:227], a[176:179], v[160:163]
 v_mfma_f32_16x16x32_bf16 v[160:163], a[228:231], a[180:183], v[160:163]
 s_add_u32 s30, s30, s21
 v_mfma_f32_16x16x32_bf16 v[164:167], a[228:231], a[188:191], v[164:167]
 v_mfma_f32_16x16x32_bf16 v[164:167], a[224:227], a[184:187], v[164:167]
 s_waitcnt vmcnt(8)
 v_mfma_f32_16x16x32_bf16 v[196:199], a[192:195], a[184:187], v[196:199]
 v_mfma_f32_16x16x32_bf16 v[196:199], a[196:199], a[188:191], v[196:199]
 global_load_dwordx4 a[228:231], v0, s[70:71] offset:-1024 sc1
 v_mfma_f32_16x16x32_bf16 v[192:195], a[196:199], a[180:183], v[192:195]
 v_mfma_f32_16x16x32_bf16 v[192:195], a[192:195], a[176:179], v[192:195]
 global_load_dwordx4 a[224:227], v0, s[70:71] offset:-2048 sc1
 v_mfma_f32_16x16x32_bf16 v[188:191], a[192:195], a[168:171], v[188:191]
 v_mfma_f32_16x16x32_bf16 v[188:191], a[196:199], a[172:175], v[188:191]
 v_mfma_f32_16x16x32_bf16 v[184:187], a[196:199], a[164:167], v[184:187]
 v_mfma_f32_16x16x32_bf16 v[184:187], a[192:195], a[160:163], v[184:187]
 v_mfma_f32_16x16x32_bf16 v[180:183], a[192:195], a[152:155], v[180:183]
 v_mfma_f32_16x16x32_bf16 v[180:183], a[196:199], a[156:159], v[180:183]
 v_mfma_f32_16x16x32_bf16 v[176:179], a[196:199], a[148:151], v[176:179]
 v_mfma_f32_16x16x32_bf16 v[176:179], a[192:195], a[144:147], v[176:179]
 v_mfma_f32_16x16x32_bf16 v[172:175], a[192:195], a[136:139], v[172:175]
 v_mfma_f32_16x16x32_bf16 v[172:175], a[196:199], a[140:143], v[172:175]
 v_mfma_f32_16x16x32_bf16 v[168:171], a[196:199], a[132:135], v[168:171]
 v_mfma_f32_16x16x32_bf16 v[168:171], a[192:195], a[128:131], v[168:171]
 s_waitcnt vmcnt(8)
 v_mfma_f32_16x16x32_bf16 v[200:203], a[200:203], a[128:131], v[200:203]
 v_mfma_f32_16x16x32_bf16 v[200:203], a[204:207], a[132:135], v[200:203]
 global_load_dwordx4 a[196:199], v0, s[70:71] offset:1024 sc1
 v_mfma_f32_16x16x32_bf16 v[204:207], a[204:207], a[140:143], v[204:207]
 v_mfma_f32_16x16x32_bf16 v[204:207], a[200:203], a[136:139], v[204:207]
 global_load_dwordx4 a[192:195], v0, s[70:71] offset:0 sc1
 v_mfma_f32_16x16x32_bf16 v[208:211], a[200:203], a[144:147], v[208:211]
 v_mfma_f32_16x16x32_bf16 v[208:211], a[204:207], a[148:151], v[208:211]
 v_mfma_f32_16x16x32_bf16 v[212:215], a[204:207], a[156:159], v[212:215]
 v_mfma_f32_16x16x32_bf16 v[212:215], a[200:203], a[152:155], v[212:215]
 v_mfma_f32_16x16x32_bf16 v[216:219], a[200:203], a[160:163], v[216:219]
 v_mfma_f32_16x16x32_bf16 v[216:219], a[204:207], a[164:167], v[216:219]
 v_mfma_f32_16x16x32_bf16 v[220:223], a[204:207], a[172:175], v[220:223]
 v_mfma_f32_16x16x32_bf16 v[220:223], a[200:203], a[168:171], v[220:223]
 v_mfma_f32_16x16x32_bf16 v[224:227], a[200:203], a[176:179], v[224:227]
 v_mfma_f32_16x16x32_bf16 v[224:227], a[204:207], a[180:183], v[224:227]
 v_mfma_f32_16x16x32_bf16 v[228:231], a[204:207], a[188:191], v[228:231]
 v_mfma_f32_16x16x32_bf16 v[228:231], a[200:203], a[184:187], v[228:231]
 buffer_load_dwordx4 v6, s[8:11], s30 offen lds
 s_waitcnt vmcnt(9)
 v_mfma_f32_16x16x32_bf16 a[252:255], a[208:211], a[184:187], a[252:255]
 ds_read_b128 a[184:187], v2 offset:28672
 v_mfma_f32_16x16x32_bf16 a[252:255], a[212:215], a[188:191], a[252:255]
 global_load_dwordx4 a[204:207], v0, s[70:71] offset:3072 sc1
 ds_read_b128 a[188:191], v2 offset:29696
 v_mfma_f32_16x16x32_bf16 a[248:251], a[212:215], a[180:183], a[248:251]
 ds_read_b128 a[180:183], v2 offset:25600
 v_mfma_f32_16x16x32_bf16 a[248:251], a[208:211], a[176:179], a[248:251]
 global_load_dwordx4 a[200:203], v0, s[70:71] offset:2048 sc1
 ds_read_b128 a[176:179], v2 offset:24576
 v_mfma_f32_16x16x32_bf16 v[252:255], a[208:211], a[168:171], v[252:255]
 s_add_u32 s70, s70, 8192
 s_addc_u32 s71, s71, 0
 ds_read_b128 a[168:171], v2 offset:20480
 v_mfma_f32_16x16x32_bf16 v[252:255], a[212:215], a[172:175], v[252:255]
 ds_read_b128 a[172:175], v2 offset:21504
 v_mfma_f32_16x16x32_bf16 v[248:251], a[212:215], a[164:167], v[248:251]
 ds_read_b128 a[164:167], v2 offset:17408
 v_mfma_f32_16x16x32_bf16 v[248:251], a[208:211], a[160:163], v[248:251]
 ds_read_b128 a[160:163], v2 offset:16384
 v_mfma_f32_16x16x32_bf16 v[244:247], a[208:211], a[152:155], v[244:247]
 ds_read_b128 a[152:155], v2 offset:12288
 v_mfma_f32_16x16x32_bf16 v[244:247], a[212:215], a[156:159], v[244:247]
 ds_read_b128 a[156:159], v2 offset:13312
 s_add_u32 m0, m0, 1024
 v_mfma_f32_16x16x32_bf16 v[240:243], a[212:215], a[148:151], v[240:243]
 ds_read_b128 a[148:151], v2 offset:9216
 v_mfma_f32_16x16x32_bf16 v[240:243], a[208:211], a[144:147], v[240:243]
 ds_read_b128 a[144:147], v2 offset:8192
 v_mfma_f32_16x16x32_bf16 v[236:239], a[208:211], a[136:139], v[236:239]
 ds_read_b128 a[136:139], v2 offset:4096
 s_add_u32 s30, s30, s20
 v_mfma_f32_16x16x32_bf16 v[236:239], a[212:215], a[140:143], v[236:239]
 ds_read_b128 a[140:143], v2 offset:5120
 v_mfma_f32_16x16x32_bf16 v[232:235], a[212:215], a[132:135], v[232:235]
 ds_read_b128 a[132:135], v2 offset:1024
 v_mfma_f32_16x16x32_bf16 v[232:235], a[208:211], a[128:131], v[232:235]
 ds_read_b128 a[128:131], v2
 s_waitcnt vmcnt(8) lgkmcnt(8)
 v_mfma_f32_16x16x32_bf16 v[44:47], a[216:219], a[184:187], v[44:47]
 buffer_load_dwordx4 v6, s[8:11], s30 offen lds
 v_mfma_f32_16x16x32_bf16 v[44:47], a[220:223], a[188:191], v[44:47]
 global_load_dwordx4 a[212:215], v0, s[70:71] offset:-3072 sc1
 v_mfma_f32_16x16x32_bf16 v[40:43], a[220:223], a[180:183], v[40:43]
 v_mfma_f32_16x16x32_bf16 v[40:43], a[216:219], a[176:179], v[40:43]
 global_load_dwordx4 a[208:211], v0, s[70:71] offset:-4096 sc1
 s_add_u32 m0, m0, 3072
 v_mfma_f32_16x16x32_bf16 v[36:39], a[216:219], a[168:171], v[36:39]
 v_mfma_f32_16x16x32_bf16 v[36:39], a[220:223], a[172:175], v[36:39]
 v_mfma_f32_16x16x32_bf16 v[32:35], a[220:223], a[164:167], v[32:35]
 v_mfma_f32_16x16x32_bf16 v[32:35], a[216:219], a[160:163], v[32:35]
 s_add_u32 s30, s30, s21
 s_waitcnt lgkmcnt(0)
 v_mfma_f32_16x16x32_bf16 v[28:31], a[216:219], a[152:155], v[28:31]
 v_mfma_f32_16x16x32_bf16 v[28:31], a[220:223], a[156:159], v[28:31]
 v_mfma_f32_16x16x32_bf16 v[24:27], a[220:223], a[148:151], v[24:27]
 v_mfma_f32_16x16x32_bf16 v[24:27], a[216:219], a[144:147], v[24:27]
 v_mfma_f32_16x16x32_bf16 v[20:23], a[216:219], a[136:139], v[20:23]
 v_mfma_f32_16x16x32_bf16 v[20:23], a[220:223], a[140:143], v[20:23]
 v_mfma_f32_16x16x32_bf16 v[16:19], a[220:223], a[132:135], v[16:19]
 v_mfma_f32_16x16x32_bf16 v[16:19], a[216:219], a[128:131], v[16:19]
 s_waitcnt vmcnt(8)
 v_mfma_f32_16x16x32_bf16 v[48:51], a[224:227], a[128:131], v[48:51]
 v_mfma_f32_16x16x32_bf16 v[48:51], a[228:231], a[132:135], v[48:51]
 global_load_dwordx4 a[220:223], v0, s[70:71] offset:-1024 sc1
 v_mfma_f32_16x16x32_bf16 v[52:55], a[228:231], a[140:143], v[52:55]
 v_mfma_f32_16x16x32_bf16 v[52:55], a[224:227], a[136:139], v[52:55]
 global_load_dwordx4 a[216:219], v0, s[70:71] offset:-2048 sc1
 v_mfma_f32_16x16x32_bf16 v[56:59], a[224:227], a[144:147], v[56:59]
 v_mfma_f32_16x16x32_bf16 v[56:59], a[228:231], a[148:151], v[56:59]
 v_mfma_f32_16x16x32_bf16 v[60:63], a[228:231], a[156:159], v[60:63]
 v_mfma_f32_16x16x32_bf16 v[60:63], a[224:227], a[152:155], v[60:63]
 v_mfma_f32_16x16x32_bf16 v[64:67], a[224:227], a[160:163], v[64:67]
 v_mfma_f32_16x16x32_bf16 v[64:67], a[228:231], a[164:167], v[64:67]
 v_mfma_f32_16x16x32_bf16 v[68:71], a[228:231], a[172:175], v[68:71]
 v_mfma_f32_16x16x32_bf16 v[68:71], a[224:227], a[168:171], v[68:71]
 v_mfma_f32_16x16x32_bf16 v[72:75], a[224:227], a[176:179], v[72:75]
 v_mfma_f32_16x16x32_bf16 v[72:75], a[228:231], a[180:183], v[72:75]
 v_mfma_f32_16x16x32_bf16 v[76:79], a[228:231], a[188:191], v[76:79]
 v_mfma_f32_16x16x32_bf16 v[76:79], a[224:227], a[184:187], v[76:79]
 s_waitcnt vmcnt(8)
 v_mfma_f32_16x16x32_bf16 v[108:111], a[192:195], a[184:187], v[108:111]
 v_mfma_f32_16x16x32_bf16 v[108:111], a[196:199], a[188:191], v[108:111]
 global_load_dwordx4 a[228:231], v0, s[70:71] offset:1024 sc1
 v_mfma_f32_16x16x32_bf16 v[104:107], a[196:199], a[180:183], v[104:107]
 v_mfma_f32_16x16x32_bf16 v[104:107], a[192:195], a[176:179], v[104:107]
 global_load_dwordx4 a[224:227], v0, s[70:71] offset:0 sc1
 v_mfma_f32_16x16x32_bf16 v[100:103], a[192:195], a[168:171], v[100:103]
 v_mfma_f32_16x16x32_bf16 v[100:103], a[196:199], a[172:175], v[100:103]
 v_mfma_f32_16x16x32_bf16 v[96:99], a[196:199], a[164:167], v[96:99]
 v_mfma_f32_16x16x32_bf16 v[96:99], a[192:195], a[160:163], v[96:99]
 v_mfma_f32_16x16x32_bf16 v[92:95], a[192:195], a[152:155], v[92:95]
 v_mfma_f32_16x16x32_bf16 v[92:95], a[196:199], a[156:159], v[92:95]
 v_mfma_f32_16x16x32_bf16 v[88:91], a[196:199], a[148:151], v[88:91]
 v_mfma_f32_16x16x32_bf16 v[88:91], a[192:195], a[144:147], v[88:91]
 v_mfma_f32_16x16x32_bf16 v[84:87], a[192:195], a[136:139], v[84:87]
 v_mfma_f32_16x16x32_bf16 v[84:87], a[196:199], a[140:143], v[84:87]
 v_mfma_f32_16x16x32_bf16 v[80:83], a[196:199], a[132:135], v[80:83]
 v_mfma_f32_16x16x32_bf16 v[80:83], a[192:195], a[128:131], v[80:83]
 buffer_load_dwordx4 v6, s[8:11], s30 offen lds
 s_waitcnt vmcnt(8)
 v_mfma_f32_16x16x32_bf16 v[112:115], a[200:203], a[128:131], v[112:115]
 v_mfma_f32_16x16x32_bf16 v[112:115], a[204:207], a[132:135], v[112:115]
 global_load_dwordx4 a[196:199], v0, s[70:71] offset:3072 sc1
 v_mfma_f32_16x16x32_bf16 v[116:119], a[204:207], a[140:143], v[116:119]
 v_mfma_f32_16x16x32_bf16 v[116:119], a[200:203], a[136:139], v[116:119]
 global_load_dwordx4 a[192:195], v0, s[70:71] offset:2048 sc1
 s_add_u32 m0, m0, 1024
 v_mfma_f32_16x16x32_bf16 v[120:123], a[200:203], a[144:147], v[120:123]
 s_add_u32 s70, s70, 8192
 s_addc_u32 s71, s71, 0
 v_mfma_f32_16x16x32_bf16 v[120:123], a[204:207], a[148:151], v[120:123]
 v_mfma_f32_16x16x32_bf16 v[124:127], a[204:207], a[156:159], v[124:127]
 s_add_u32 s30, s30, s20
 v_mfma_f32_16x16x32_bf16 v[124:127], a[200:203], a[152:155], v[124:127]
 v_mfma_f32_16x16x32_bf16 v[128:131], a[200:203], a[160:163], v[128:131]
 v_mfma_f32_16x16x32_bf16 v[128:131], a[204:207], a[164:167], v[128:131]
 v_mfma_f32_16x16x32_bf16 v[132:135], a[204:207], a[172:175], v[132:135]
 buffer_load_dwordx4 v6, s[8:11], s30 offen lds
 v_mfma_f32_16x16x32_bf16 v[132:135], a[200:203], a[168:171], v[132:135]
 v_mfma_f32_16x16x32_bf16 a[240:243], a[200:203], a[176:179], a[240:243]
 v_mfma_f32_16x16x32_bf16 a[240:243], a[204:207], a[180:183], a[240:243]
 v_mfma_f32_16x16x32_bf16 a[244:247], a[204:207], a[188:191], a[244:247]
 s_add_u32 m0, m0, 3072
 v_mfma_f32_16x16x32_bf16 a[244:247], a[200:203], a[184:187], a[244:247]
 s_waitcnt vmcnt(8)
 v_mfma_f32_16x16x32_bf16 v[164:167], a[208:211], a[184:187], v[164:167]
 v_mfma_f32_16x16x32_bf16 v[164:167], a[212:215], a[188:191], v[164:167]
 global_load_dwordx4 a[204:207], v0, s[70:71] offset:-3072 sc1
 s_add_u32 s30, s30, s21
 v_mfma_f32_16x16x32_bf16 v[160:163], a[212:215], a[180:183], v[160:163]
 v_mfma_f32_16x16x32_bf16 v[160:163], a[208:211], a[176:179], v[160:163]
 global_load_dwordx4 a[200:203], v0, s[70:71] offset:-4096 sc1
 v_mfma_f32_16x16x32_bf16 v[156:159], a[208:211], a[168:171], v[156:159]
 v_mfma_f32_16x16x32_bf16 v[156:159], a[212:215], a[172:175], v[156:159]
 v_mfma_f32_16x16x32_bf16 v[152:155], a[212:215], a[164:167], v[152:155]
 v_mfma_f32_16x16x32_bf16 v[152:155], a[208:211], a[160:163], v[152:155]
 v_mfma_f32_16x16x32_bf16 v[148:151], a[208:211], a[152:155], v[148:151]
 v_mfma_f32_16x16x32_bf16 v[148:151], a[212:215], a[156:159], v[148:151]
 v_mfma_f32_16x16x32_bf16 v[144:147], a[212:215], a[148:151], v[144:147]
 v_and_b32 v5, 768, v3
 v_mfma_f32_16x16x32_bf16 v[144:147], a[208:211], a[144:147], v[144:147]
 v_and_b32 v7, 1023, v3
 v_mfma_f32_16x16x32_bf16 v[140:143], a[208:211], a[136:139], v[140:143]
 v_mfma_f32_16x16x32_bf16 v[140:143], a[212:215], a[140:143], v[140:143]
 v_add3_u32 v5, v5, v7, s52
 v_mfma_f32_16x16x32_bf16 v[136:139], a[212:215], a[132:135], v[136:139]
 v_mfma_f32_16x16x32_bf16 v[136:139], a[208:211], a[128:131], v[136:139]
 ds_read_b64_tr_b16 v[8:9], v5 offset:0
 s_waitcnt vmcnt(8)
 v_mfma_f32_16x16x32_bf16 v[168:171], a[216:219], a[128:131], v[168:171]
 v_mfma_f32_16x16x32_bf16 v[168:171], a[220:223], a[132:135], v[168:171]
 global_load_dwordx4 a[212:215], v0, s[70:71] offset:-1024 sc1
 ds_read_b64_tr_b16 v[10:11], v5 offset:256
 v_mfma_f32_16x16x32_bf16 v[172:175], a[220:223], a[140:143], v[172:175]
 ds_read_b64_tr_b16 v[12:13], v5 offset:8
 v_mfma_f32_16x16x32_bf16 v[172:175], a[216:219], a[136:139], v[172:175]
 global_load_dwordx4 a[208:211], v0, s[70:71] offset:-2048 sc1
 ds_read_b64_tr_b16 v[14:15], v5 offset:264
 v_mfma_f32_16x16x32_bf16 v[176:179], a[216:219], a[144:147], v[176:179]
 v_mfma_f32_16x16x32_bf16 v[176:179], a[220:223], a[148:151], v[176:179]
 v_mfma_f32_16x16x32_bf16 v[180:183], a[220:223], a[156:159], v[180:183]
 v_mfma_f32_16x16x32_bf16 v[180:183], a[216:219], a[152:155], v[180:183]
 v_mfma_f32_16x16x32_bf16 v[184:187], a[216:219], a[160:163], v[184:187]
 v_mfma_f32_16x16x32_bf16 v[184:187], a[220:223], a[164:167], v[184:187]
 v_mfma_f32_16x16x32_bf16 v[188:191], a[220:223], a[172:175], v[188:191]
 v_mfma_f32_16x16x32_bf16 v[188:191], a[216:219], a[168:171], v[188:191]
 v_mfma_f32_16x16x32_bf16 v[192:195], a[216:219], a[176:179], v[192:195]
 v_mfma_f32_16x16x32_bf16 v[192:195], a[220:223], a[180:183], v[192:195]
 v_mfma_f32_16x16x32_bf16 v[196:199], a[220:223], a[188:191], v[196:199]
 v_mfma_f32_16x16x32_bf16 v[196:199], a[216:219], a[184:187], v[196:199]
 s_waitcnt vmcnt(8)
 v_mfma_f32_16x16x32_bf16 v[228:231], a[224:227], a[184:187], v[228:231]
 v_mfma_f32_16x16x32_bf16 v[228:231], a[228:231], a[188:191], v[228:231]
 global_load_dwordx4 a[220:223], v0, s[70:71] offset:1024 sc1
 v_mfma_f32_16x16x32_bf16 v[224:227], a[228:231], a[180:183], v[224:227]
 s_waitcnt lgkmcnt(2)
 v_mfma_f32_16x16x32_bf16 v[224:227], a[224:227], a[176:179], v[224:227]
 global_load_dwordx4 a[216:219], v0, s[70:71] offset:0 sc1
 v_mfma_f32_16x16x32_bf16 v[220:223], a[224:227], a[168:171], v[220:223]
 buffer_store_dwordx4 v[8:11], v7, s[12:15], s49 offen sc1
 v_mfma_f32_16x16x32_bf16 v[220:223], a[228:231], a[172:175], v[220:223]
 s_waitcnt lgkmcnt(0)
 v_mfma_f32_16x16x32_bf16 v[216:219], a[228:231], a[164:167], v[216:219]
 buffer_store_dwordx4 v[12:15], v7, s[12:15], s49 offen offset:2048 sc1
 v_mfma_f32_16x16x32_bf16 v[216:219], a[224:227], a[160:163], v[216:219]
 s_add_u32 s49, s49, 2097152
 v_mfma_f32_16x16x32_bf16 v[212:215], a[224:227], a[152:155], v[212:215]
 v_mfma_f32_16x16x32_bf16 v[212:215], a[228:231], a[156:159], v[212:215]
 buffer_load_dwordx4 v6, s[8:11], s30 offen lds
 v_mfma_f32_16x16x32_bf16 v[208:211], a[228:231], a[148:151], v[208:211]
 v_mfma_f32_16x16x32_bf16 v[208:211], a[224:227], a[144:147], v[208:211]
 v_mfma_f32_16x16x32_bf16 v[204:207], a[224:227], a[136:139], v[204:207]
 v_mfma_f32_16x16x32_bf16 v[204:207], a[228:231], a[140:143], v[204:207]
 s_add_u32 m0, m0, 1024
 v_mfma_f32_16x16x32_bf16 v[200:203], a[228:231], a[132:135], v[200:203]
 v_mfma_f32_16x16x32_bf16 v[200:203], a[224:227], a[128:131], v[200:203]
 s_add_u32 s30, s30, s20
 buffer_load_dwordx4 v6, s[8:11], s30 offen lds
 s_waitcnt vmcnt(11)
 v_mfma_f32_16x16x32_bf16 v[232:235], a[192:195], a[128:131], v[232:235]
 ds_read_b128 a[128:131], v2 offset:32768
 v_mfma_f32_16x16x32_bf16 v[232:235], a[196:199], a[132:135], v[232:235]
 global_load_dwordx4 a[228:231], v0, s[70:71] offset:3072 sc1
 ds_read_b128 a[132:135], v2 offset:33792
 v_mfma_f32_16x16x32_bf16 v[236:239], a[196:199], a[140:143], v[236:239]
 ds_read_b128 a[140:143], v2 offset:37888
 v_mfma_f32_16x16x32_bf16 v[236:239], a[192:195], a[136:139], v[236:239]
 global_load_dwordx4 a[224:227], v0, s[70:71] offset:2048 sc1
 ds_read_b128 a[136:139], v2 offset:36864
 v_mfma_f32_16x16x32_bf16 v[240:243], a[192:195], a[144:147], v[240:243]
 s_add_u32 s70, s70, 8192
 s_addc_u32 s71, s71, 0
 ds_read_b128 a[144:147], v2 offset:40960
 v_mfma_f32_16x16x32_bf16 v[240:243], a[196:199], a[148:151], v[240:243]
 ds_read_b128 a[148:151], v2 offset:41984
 v_mfma_f32_16x16x32_bf16 v[244:247], a[196:199], a[156:159], v[244:247]
 ds_read_b128 a[156:159], v2 offset:46080
 v_mfma_f32_16x16x32_bf16 v[244:247], a[192:195], a[152:155], v[244:247]
 ds_read_b128 a[152:155], v2 offset:45056
 v_mfma_f32_16x16x32_bf16 v[248:251], a[192:195], a[160:163], v[248:251]
 ds_read_b128 a[160:163], v2 offset:49152
 s_add_u32 m0, m0, 3072
 v_mfma_f32_16x16x32_bf16 v[248:251], a[196:199], a[164:167], v[248:251]
 ds_read_b128 a[164:167], v2 offset:50176
 v_mfma_f32_16x16x32_bf16 v[252:255], a[196:199], a[172:175], v[252:255]
 ds_read_b128 a[172:175], v2 offset:54272
 v_mfma_f32_16x16x32_bf16 v[252:255], a[192:195], a[168:171], v[252:255]
 ds_read_b128 a[168:171], v2 offset:53248
 s_add_u32 s30, s30, s21
 v_mfma_f32_16x16x32_bf16 a[248:251], a[192:195], a[176:179], a[248:251]
 ds_read_b128 a[176:179], v2 offset:57344
 v_mfma_f32_16x16x32_bf16 a[248:251], a[196:199], a[180:183], a[248:251]
 ds_read_b128 a[180:183], v2 offset:58368
 v_mfma_f32_16x16x32_bf16 a[252:255], a[196:199], a[188:191], a[252:255]
 ds_read_b128 a[188:191], v2 offset:62464
 v_mfma_f32_16x16x32_bf16 a[252:255], a[192:195], a[184:187], a[252:255]
 ds_read_b128 a[184:187], v2 offset:61440
 s_waitcnt vmcnt(10) lgkmcnt(8)
 v_mfma_f32_16x16x32_bf16 v[16:19], a[200:203], a[128:131], v[16:19]
 v_mfma_f32_16x16x32_bf16 v[16:19], a[204:207], a[132:135], v[16:19]
 global_load_dwordx4 a[196:199], v0, s[70:71] offset:-3072 sc1
 v_mfma_f32_16x16x32_bf16 v[20:23], a[204:207], a[140:143], v[20:23]
 v_mfma_f32_16x16x32_bf16 v[20:23], a[200:203], a[136:139], v[20:23]
 global_load_dwordx4 a[192:195], v0, s[70:71] offset:-4096 sc1
 v_mfma_f32_16x16x32_bf16 v[24:27], a[200:203], a[144:147], v[24:27]
 v_mfma_f32_16x16x32_bf16 v[24:27], a[204:207], a[148:151], v[24:27]
 v_mfma_f32_16x16x32_bf16 v[28:31], a[204:207], a[156:159], v[28:31]
 v_mfma_f32_16x16x32_bf16 v[28:31], a[200:203], a[152:155], v[28:31]
 s_waitcnt lgkmcnt(0)
 v_mfma_f32_16x16x32_bf16 v[32:35], a[200:203], a[160:163], v[32:35]
 v_mfma_f32_16x16x32_bf16 v[32:35], a[204:207], a[164:167], v[32:35]
 v_mfma_f32_16x16x32_bf16 v[36:39], a[204:207], a[172:175], v[36:39]
 v_mfma_f32_16x16x32_bf16 v[36:39], a[200:203], a[168:171], v[36:39]
 v_mfma_f32_16x16x32_bf16 v[40:43], a[200:203], a[176:179], v[40:43]
 v_mfma_f32_16x16x32_bf16 v[40:43], a[204:207], a[180:183], v[40:43]
 v_mfma_f32_16x16x32_bf16 v[44:47], a[204:207], a[188:191], v[44:47]
 v_mfma_f32_16x16x32_bf16 v[44:47], a[200:203], a[184:187], v[44:47]
 s_waitcnt vmcnt(10)
 v_mfma_f32_16x16x32_bf16 v[76:79], a[208:211], a[184:187], v[76:79]
 v_mfma_f32_16x16x32_bf16 v[76:79], a[212:215], a[188:191], v[76:79]
 global_load_dwordx4 a[204:207], v0, s[70:71] offset:-1024 sc1
 v_mfma_f32_16x16x32_bf16 v[72:75], a[212:215], a[180:183], v[72:75]
 v_mfma_f32_16x16x32_bf16 v[72:75], a[208:211], a[176:179], v[72:75]
 global_load_dwordx4 a[200:203], v0, s[70:71] offset:-2048 sc1
 v_mfma_f32_16x16x32_bf16 v[68:71], a[208:211], a[168:171], v[68:71]
 v_mfma_f32_16x16x32_bf16 v[68:71], a[212:215], a[172:175], v[68:71]
 v_mfma_f32_16x16x32_bf16 v[64:67], a[212:215], a[164:167], v[64:67]
 v_mfma_f32_16x16x32_bf16 v[64:67], a[208:211], a[160:163], v[64:67]
 v_mfma_f32_16x16x32_bf16 v[60:63], a[208:211], a[152:155], v[60:63]
 v_mfma_f32_16x16x32_bf16 v[60:63], a[212:215], a[156:159], v[60:63]
 v_mfma_f32_16x16x32_bf16 v[56:59], a[212:215], a[148:151], v[56:59]
 v_mfma_f32_16x16x32_bf16 v[56:59], a[208:211], a[144:147], v[56:59]
 v_mfma_f32_16x16x32_bf16 v[52:55], a[208:211], a[136:139], v[52:55]
 v_mfma_f32_16x16x32_bf16 v[52:55], a[212:215], a[140:143], v[52:55]
 v_mfma_f32_16x16x32_bf16 v[48:51], a[212:215], a[132:135], v[48:51]
 v_mfma_f32_16x16x32_bf16 v[48:51], a[208:211], a[128:131], v[48:51]
 s_waitcnt vmcnt(10)
 v_mfma_f32_16x16x32_bf16 v[80:83], a[216:219], a[128:131], v[80:83]
 v_mfma_f32_16x16x32_bf16 v[80:83], a[220:223], a[132:135], v[80:83]
 global_load_dwordx4 a[212:215], v0, s[70:71] offset:1024 sc1
 v_mfma_f32_16x16x32_bf16 v[84:87], a[220:223], a[140:143], v[84:87]
 v_mfma_f32_16x16x32_bf16 v[84:87], a[216:219], a[136:139], v[84:87]
 global_load_dwordx4 a[208:211], v0, s[70:71] offset:0 sc1
 v_mfma_f32_16x16x32_bf16 v[88:91], a[216:219], a[144:147], v[88:91]
 buffer_load_dwordx4 v6, s[8:11], s30 offen lds
 v_mfma_f32_16x16x32_bf16 v[88:91], a[220:223], a[148:151], v[88:91]
 v_mfma_f32_16x16x32_bf16 v[92:95], a[220:223], a[156:159], v[92:95]
 v_mfma_f32_16x16x32_bf16 v[92:95], a[216:219], a[152:155], v[92:95]
 s_add_u32 m0, m0, 1024
 v_mfma_f32_16x16x32_bf16 v[96:99], a[216:219], a[160:163], v[96:99]
 v_mfma_f32_16x16x32_bf16 v[96:99], a[220:223], a[164:167], v[96:99]
 v_mfma_f32_16x16x32_bf16 v[100:103], a[220:223], a[172:175], v[100:103]
 v_mfma_f32_16x16x32_bf16 v[100:103], a[216:219], a[168:171], v[100:103]
 s_add_u32 s30, s30, s20
 v_mfma_f32_16x16x32_bf16 v[104:107], a[216:219], a[176:179], v[104:107]
 v_mfma_f32_16x16x32_bf16 v[104:107], a[220:223], a[180:183], v[104:107]
 v_mfma_f32_16x16x32_bf16 v[108:111], a[220:223], a[188:191], v[108:111]
 buffer_load_dwordx4 v6, s[8:11], s30 offen lds
 v_mfma_f32_16x16x32_bf16 v[108:111], a[216:219], a[184:187], v[108:111]
 s_waitcnt vmcnt(8)
 v_mfma_f32_16x16x32_bf16 a[244:247], a[224:227], a[184:187], a[244:247]
 v_mfma_f32_16x16x32_bf16 a[244:247], a[228:231], a[188:191], a[244:247]
 global_load_dwordx4 a[220:223], v0, s[70:71] offset:3072 sc1
 v_mfma_f32_16x16x32_bf16 a[240:243], a[228:231], a[180:183], a[240:243]
 s_add_u32 m0, m0, 3072
 v_mfma_f32_16x16x32_bf16 a[240:243], a[224:227], a[176:179], a[240:243]
 global_load_dwordx4 a[216:219], v0, s[70:71] offset:2048 sc1
 v_mfma_f32_16x16x32_bf16 v[132:135], a[224:227], a[168:171], v[132:135]
 s_add_u32 s70, s70, 8192
 s_addc_u32 s71, s71, 0
 v_mfma_f32_16x16x32_bf16 v[132:135], a[228:231], a[172:175], v[132:135]
 v_mfma_f32_16x16x32_bf16 v[128:131], a[228:231], a[164:167], v[128:131]
 s_add_u32 s30, s30, s22
 v_mfma_f32_16x16x32_bf16 v[128:131], a[224:227], a[160:163], v[128:131]
 v_mfma_f32_16x16x32_bf16 v[124:127], a[224:227], a[152:155], v[124:127]
 v_mfma_f32_16x16x32_bf16 v[124:127], a[228:231], a[156:159], v[124:127]
 v_mfma_f32_16x16x32_bf16 v[120:123], a[228:231], a[148:151], v[120:123]
 v_mfma_f32_16x16x32_bf16 v[120:123], a[224:227], a[144:147], v[120:123]
 v_mfma_f32_16x16x32_bf16 v[116:119], a[224:227], a[136:139], v[116:119]
 v_mfma_f32_16x16x32_bf16 v[116:119], a[228:231], a[140:143], v[116:119]
 v_mfma_f32_16x16x32_bf16 v[112:115], a[228:231], a[132:135], v[112:115]
 v_mfma_f32_16x16x32_bf16 v[112:115], a[224:227], a[128:131], v[112:115]
 s_waitcnt vmcnt(8)
 v_mfma_f32_16x16x32_bf16 v[136:139], a[192:195], a[128:131], v[136:139]
 v_mfma_f32_16x16x32_bf16 v[136:139], a[196:199], a[132:135], v[136:139]
 global_load_dwordx4 a[228:231], v0, s[70:71] offset:-3072 sc1
 v_mfma_f32_16x16x32_bf16 v[140:143], a[196:199], a[140:143], v[140:143]
 v_mfma_f32_16x16x32_bf16 v[140:143], a[192:195], a[136:139], v[140:143]
 global_load_dwordx4 a[224:227], v0, s[70:71] offset:-4096 sc1
 v_mfma_f32_16x16x32_bf16 v[144:147], a[192:195], a[144:147], v[144:147]
 v_mfma_f32_16x16x32_bf16 v[144:147], a[196:199], a[148:151], v[144:147]
 global_load_dwordx4 a[236:239], v0, s[70:71] offset:-1024 sc1
 v_mfma_f32_16x16x32_bf16 v[148:151], a[196:199], a[156:159], v[148:151]
 v_mfma_f32_16x16x32_bf16 v[148:151], a[192:195], a[152:155], v[148:151]
 global_load_dwordx4 a[232:235], v0, s[70:71] offset:-2048 sc1
 v_mfma_f32_16x16x32_bf16 v[152:155], a[192:195], a[160:163], v[152:155]
 v_mfma_f32_16x16x32_bf16 v[152:155], a[196:199], a[164:167], v[152:155]
 v_mfma_f32_16x16x32_bf16 v[156:159], a[196:199], a[172:175], v[156:159]
 v_mfma_f32_16x16x32_bf16 v[156:159], a[192:195], a[168:171], v[156:159]
 v_mfma_f32_16x16x32_bf16 v[160:163], a[192:195], a[176:179], v[160:163]
 v_mfma_f32_16x16x32_bf16 v[160:163], a[196:199], a[180:183], v[160:163]
 v_mfma_f32_16x16x32_bf16 v[164:167], a[196:199], a[188:191], v[164:167]
 v_mfma_f32_16x16x32_bf16 v[164:167], a[192:195], a[184:187], v[164:167]
 s_waitcnt vmcnt(10)
 v_mfma_f32_16x16x32_bf16 v[196:199], a[200:203], a[184:187], v[196:199]
 v_mfma_f32_16x16x32_bf16 v[196:199], a[204:207], a[188:191], v[196:199]
 global_load_dwordx4 a[196:199], v0, s[70:71] offset:1024 sc1
 v_mfma_f32_16x16x32_bf16 v[192:195], a[204:207], a[180:183], v[192:195]
 v_mfma_f32_16x16x32_bf16 v[192:195], a[200:203], a[176:179], v[192:195]
 global_load_dwordx4 a[192:195], v0, s[70:71] offset:0 sc1
 v_mfma_f32_16x16x32_bf16 v[188:191], a[200:203], a[168:171], v[188:191]
 v_mfma_f32_16x16x32_bf16 v[188:191], a[204:207], a[172:175], v[188:191]
 v_mfma_f32_16x16x32_bf16 v[184:187], a[204:207], a[164:167], v[184:187]
 v_mfma_f32_16x16x32_bf16 v[184:187], a[200:203], a[160:163], v[184:187]
 v_mfma_f32_16x16x32_bf16 v[180:183], a[200:203], a[152:155], v[180:183]
 v_mfma_f32_16x16x32_bf16 v[180:183], a[204:207], a[156:159], v[180:183]
 v_mfma_f32_16x16x32_bf16 v[176:179], a[204:207], a[148:151], v[176:179]
 v_mfma_f32_16x16x32_bf16 v[176:179], a[200:203], a[144:147], v[176:179]
 v_mfma_f32_16x16x32_bf16 v[172:175], a[200:203], a[136:139], v[172:175]
 v_mfma_f32_16x16x32_bf16 v[172:175], a[204:207], a[140:143], v[172:175]
 v_mfma_f32_16x16x32_bf16 v[168:171], a[204:207], a[132:135], v[168:171]
 v_mfma_f32_16x16x32_bf16 v[168:171], a[200:203], a[128:131], v[168:171]
 s_waitcnt vmcnt(10)
 v_mfma_f32_16x16x32_bf16 v[200:203], a[208:211], a[128:131], v[200:203]
 v_mfma_f32_16x16x32_bf16 v[200:203], a[212:215], a[132:135], v[200:203]
 global_load_dwordx4 a[204:207], v0, s[70:71] offset:3072 sc1
 v_mfma_f32_16x16x32_bf16 v[204:207], a[212:215], a[140:143], v[204:207]
 v_mfma_f32_16x16x32_bf16 v[204:207], a[208:211], a[136:139], v[204:207]
 global_load_dwordx4 a[200:203], v0, s[70:71] offset:2048 sc1
 v_mfma_f32_16x16x32_bf16 v[208:211], a[208:211], a[144:147], v[208:211]
 s_add_u32 s70, s70, 8192
 s_addc_u32 s71, s71, 0
 v_mfma_f32_16x16x32_bf16 v[208:211], a[212:215], a[148:151], v[208:211]
 v_mfma_f32_16x16x32_bf16 v[212:215], a[212:215], a[156:159], v[212:215]
 v_mfma_f32_16x16x32_bf16 v[212:215], a[208:211], a[152:155], v[212:215]
 v_mfma_f32_16x16x32_bf16 v[216:219], a[208:211], a[160:163], v[216:219]
 v_mfma_f32_16x16x32_bf16 v[216:219], a[212:215], a[164:167], v[216:219]
 v_mfma_f32_16x16x32_bf16 v[220:223], a[212:215], a[172:175], v[220:223]
 s_waitcnt vmcnt(10)
 s_waitcnt lgkmcnt(0)
 s_barrier
 v_mfma_f32_16x16x32_bf16 v[220:223], a[208:211], a[168:171], v[220:223]
 v_mfma_f32_16x16x32_bf16 v[224:227], a[208:211], a[176:179], v[224:227]
 v_mfma_f32_16x16x32_bf16 v[224:227], a[212:215], a[180:183], v[224:227]
 v_mfma_f32_16x16x32_bf16 v[228:231], a[212:215], a[188:191], v[228:231]
 v_mfma_f32_16x16x32_bf16 v[228:231], a[208:211], a[184:187], v[228:231]
 s_waitcnt vmcnt(8)
 v_mfma_f32_16x16x32_bf16 a[252:255], a[216:219], a[184:187], a[252:255]
 ds_read_b128 a[184:187], v1 offset:30720
 v_mfma_f32_16x16x32_bf16 a[252:255], a[220:223], a[188:191], a[252:255]
 global_load_dwordx4 a[212:215], v0, s[70:71] offset:-3072 sc1
 ds_read_b128 a[188:191], v1 offset:31744
 v_mfma_f32_16x16x32_bf16 a[248:251], a[220:223], a[180:183], a[248:251]
 ds_read_b128 a[180:183], v1 offset:27648
 v_mfma_f32_16x16x32_bf16 a[248:251], a[216:219], a[176:179], a[248:251]
 global_load_dwordx4 a[208:211], v0, s[70:71] offset:-4096 sc1
 ds_read_b128 a[176:179], v1 offset:26624
 v_mfma_f32_16x16x32_bf16 v[252:255], a[216:219], a[168:171], v[252:255]
 ds_read_b128 a[168:171], v1 offset:22528
 v_mfma_f32_16x16x32_bf16 v[252:255], a[220:223], a[172:175], v[252:255]
 ds_read_b128 a[172:175], v1 offset:23552
 v_mfma_f32_16x16x32_bf16 v[248:251], a[220:223], a[164:167], v[248:251]
 ds_read_b128 a[164:167], v1 offset:19456
 v_mfma_f32_16x16x32_bf16 v[248:251], a[216:219], a[160:163], v[248:251]
 ds_read_b128 a[160:163], v1 offset:18432
 v_mfma_f32_16x16x32_bf16 v[244:247], a[216:219], a[152:155], v[244:247]
 ds_read_b128 a[152:155], v1 offset:14336
 v_mfma_f32_16x16x32_bf16 v[244:247], a[220:223], a[156:159], v[244:247]
 ds_read_b128 a[156:159], v1 offset:15360
 v_mfma_f32_16x16x32_bf16 v[240:243], a[220:223], a[148:151], v[240:243]
 ds_read_b128 a[148:151], v1 offset:11264
 v_mfma_f32_16x16x32_bf16 v[240:243], a[216:219], a[144:147], v[240:243]
 ds_read_b128 a[144:147], v1 offset:10240
 v_mfma_f32_16x16x32_bf16 v[236:239], a[216:219], a[136:139], v[236:239]
 ds_read_b128 a[136:139], v1 offset:6144
 v_mfma_f32_16x16x32_bf16 v[236:239], a[220:223], a[140:143], v[236:239]
 ds_read_b128 a[140:143], v1 offset:7168
 v_mfma_f32_16x16x32_bf16 v[232:235], a[220:223], a[132:135], v[232:235]
 global_load_dwordx4 a[220:223], v0, s[70:71] offset:-1024 sc1
 ds_read_b128 a[132:135], v1 offset:3072
 v_mfma_f32_16x16x32_bf16 v[232:235], a[216:219], a[128:131], v[232:235]
 global_load_dwordx4 a[216:219], v0, s[70:71] offset:-2048 sc1
 ds_read_b128 a[128:131], v1 offset:2048
 s_waitcnt vmcnt(10) lgkmcnt(8)
 v_mfma_f32_16x16x32_bf16 v[44:47], a[224:227], a[184:187], v[44:47]
 v_mov_b32 v7, 1
 v_mfma_f32_16x16x32_bf16 v[44:47], a[228:231], a[188:191], v[44:47]
 v_mfma_f32_16x16x32_bf16 v[40:43], a[228:231], a[180:183], v[40:43]
 buffer_atomic_add v7, v0, s[56:59], 0 offen sc1
 v_mfma_f32_16x16x32_bf16 v[40:43], a[224:227], a[176:179], v[40:43]
 v_bfe_u32 v4, v3, 8, 2
 v_mfma_f32_16x16x32_bf16 v[36:39], a[224:227], a[168:171], v[36:39]
 v_mfma_f32_16x16x32_bf16 v[36:39], a[228:231], a[172:175], v[36:39]
 v_lshl_add_u32 v4, v4, 5, s51
 v_mfma_f32_16x16x32_bf16 v[32:35], a[228:231], a[164:167], v[32:35]
 ds_read_b128 v[8:11], v4 offset:256
 v_mfma_f32_16x16x32_bf16 v[32:35], a[224:227], a[160:163], v[32:35]
 s_waitcnt lgkmcnt(1)
 v_mfma_f32_16x16x32_bf16 v[28:31], a[224:227], a[152:155], v[28:31]
 v_mfma_f32_16x16x32_bf16 v[28:31], a[228:231], a[156:159], v[28:31]
 v_mfma_f32_16x16x32_bf16 v[24:27], a[228:231], a[148:151], v[24:27]
 v_mfma_f32_16x16x32_bf16 v[24:27], a[224:227], a[144:147], v[24:27]
 v_mfma_f32_16x16x32_bf16 v[20:23], a[224:227], a[136:139], v[20:23]
 v_mfma_f32_16x16x32_bf16 v[20:23], a[228:231], a[140:143], v[20:23]
 v_mfma_f32_16x16x32_bf16 v[16:19], a[228:231], a[132:135], v[16:19]
 v_mfma_f32_16x16x32_bf16 v[16:19], a[224:227], a[128:131], v[16:19]
 s_waitcnt vmcnt(9)
 v_mfma_f32_16x16x32_bf16 v[48:51], a[232:235], a[128:131], v[48:51]
 v_mfma_f32_16x16x32_bf16 v[48:51], a[236:239], a[132:135], v[48:51]
 global_load_dwordx4 a[228:231], v0, s[70:71] offset:1024 sc1
 v_mfma_f32_16x16x32_bf16 v[52:55], a[236:239], a[140:143], v[52:55]
 v_mfma_f32_16x16x32_bf16 v[52:55], a[232:235], a[136:139], v[52:55]
 global_load_dwordx4 a[224:227], v0, s[70:71] offset:0 sc1
 v_mfma_f32_16x16x32_bf16 v[56:59], a[232:235], a[144:147], v[56:59]
 s_waitcnt lgkmcnt(0)
 v_mfma_f32_16x16x32_bf16 v[56:59], a[236:239], a[148:151], v[56:59]
 v_mfma_f32_16x16x32_bf16 v[60:63], a[236:239], a[156:159], v[60:63]
 v_add_f32 v136, v136, v8
 v_mfma_f32_16x16x32_bf16 v[60:63], a[232:235], a[152:155], v[60:63]
 v_mfma_f32_16x16x32_bf16 v[64:67], a[232:235], a[160:163], v[64:67]
 ds_read_b128 v[12:15], v4 offset:272
 v_mfma_f32_16x16x32_bf16 v[64:67], a[236:239], a[164:167], v[64:67]
 v_add_f32 v137, v137, v9
 v_mfma_f32_16x16x32_bf16 v[68:71], a[236:239], a[172:175], v[68:71]
 v_mfma_f32_16x16x32_bf16 v[68:71], a[232:235], a[168:171], v[68:71]
 v_add_f32 v138, v138, v10
 v_mfma_f32_16x16x32_bf16 v[72:75], a[232:235], a[176:179], v[72:75]
 v_add_f32 v139, v139, v11
 v_mfma_f32_16x16x32_bf16 v[72:75], a[236:239], a[180:183], v[72:75]
 v_mfma_f32_16x16x32_bf16 v[76:79], a[236:239], a[188:191], v[76:79]
 v_add_f32 v140, v140, v8
 v_mfma_f32_16x16x32_bf16 v[76:79], a[232:235], a[184:187], v[76:79]
 v_add_f32 v141, v141, v9
 s_waitcnt vmcnt(9)
 v_mfma_f32_16x16x32_bf16 v[108:111], a[192:195], a[184:187], v[108:111]
 v_mfma_f32_16x16x32_bf16 v[108:111], a[196:199], a[188:191], v[108:111]
 global_load_dwordx4 a[236:239], v0, s[70:71] offset:3072 sc1
 v_add_f32 v142, v142, v10
 v_mfma_f32_16x16x32_bf16 v[104:107], a[196:199], a[180:183], v[104:107]
 v_add_f32 v143, v143, v11
 v_mfma_f32_16x16x32_bf16 v[104:107], a[192:195], a[176:179], v[104:107]
 global_load_dwordx4 a[232:235], v0, s[70:71] offset:2048 sc1
 v_mfma_f32_16x16x32_bf16 v[100:103], a[192:195], a[168:171], v[100:103]
 v_add_f32 v144, v144, v8
 s_add_u32 s70, s70, 8192
 s_addc_u32 s71, s71, 0
 v_mfma_f32_16x16x32_bf16 v[100:103], a[196:199], a[172:175], v[100:103]
 v_mfma_f32_16x16x32_bf16 v[96:99], a[196:199], a[164:167], v[96:99]
 v_add_f32 v145, v145, v9
 v_mfma_f32_16x16x32_bf16 v[96:99], a[192:195], a[160:163], v[96:99]
 v_add_f32 v146, v146, v10
 v_mfma_f32_16x16x32_bf16 v[92:95], a[192:195], a[152:155], v[92:95]
 v_mfma_f32_16x16x32_bf16 v[92:95], a[196:199], a[156:159], v[92:95]
 v_add_f32 v147, v147, v11
 v_mfma_f32_16x16x32_bf16 v[88:91], a[196:199], a[148:151], v[88:91]
 v_add_f32 v148, v148, v8
 v_mfma_f32_16x16x32_bf16 v[88:91], a[192:195], a[144:147], v[88:91]
 v_mfma_f32_16x16x32_bf16 v[84:87], a[192:195], a[136:139], v[84:87]
 v_add_f32 v149, v149, v9
 v_mfma_f32_16x16x32_bf16 v[84:87], a[196:199], a[140:143], v[84:87]
 v_add_f32 v150, v150, v10
 v_mfma_f32_16x16x32_bf16 v[80:83], a[196:199], a[132:135], v[80:83]
 v_mfma_f32_16x16x32_bf16 v[80:83], a[192:195], a[128:131], v[80:83]
 v_add_f32 v151, v151, v11
 s_waitcnt vmcnt(9)
 v_mfma_f32_16x16x32_bf16 v[112:115], a[200:203], a[128:131], v[112:115]
 ds_read_b128 a[128:131], v1 offset:34816
 v_add_f32 v152, v152, v8
 v_mfma_f32_16x16x32_bf16 v[112:115], a[204:207], a[132:135], v[112:115]
 global_load_dwordx4 a[196:199], v0, s[70:71] offset:-3072 sc1
 ds_read_b128 a[132:135], v1 offset:35840
 v_mfma_f32_16x16x32_bf16 v[116:119], a[204:207], a[140:143], v[116:119]
 ds_read_b128 a[140:143], v1 offset:39936
 v_add_f32 v153, v153, v9
 v_mfma_f32_16x16x32_bf16 v[116:119], a[200:203], a[136:139], v[116:119]
 global_load_dwordx4 a[192:195], v0, s[70:71] offset:-4096 sc1
 ds_read_b128 a[136:139], v1 offset:38912
 v_mfma_f32_16x16x32_bf16 v[120:123], a[200:203], a[144:147], v[120:123]
 ds_read_b128 a[144:147], v1 offset:43008
 v_add_f32 v154, v154, v10
 v_mfma_f32_16x16x32_bf16 v[120:123], a[204:207], a[148:151], v[120:123]
 ds_read_b128 a[148:151], v1 offset:44032
 v_add_f32 v155, v155, v11
 v_mfma_f32_16x16x32_bf16 v[124:127], a[204:207], a[156:159], v[124:127]
 ds_read_b128 a[156:159], v1 offset:48128
 v_mfma_f32_16x16x32_bf16 v[124:127], a[200:203], a[152:155], v[124:127]
 ds_read_b128 a[152:155], v1 offset:47104
 v_add_f32 v156, v156, v8
 v_mfma_f32_16x16x32_bf16 v[128:131], a[200:203], a[160:163], v[128:131]
 ds_read_b128 a[160:163], v1 offset:51200
 v_add_f32 v157, v157, v9
 v_mfma_f32_16x16x32_bf16 v[128:131], a[204:207], a[164:167], v[128:131]
 ds_read_b128 a[164:167], v1 offset:52224
 v_mfma_f32_16x16x32_bf16 v[132:135], a[204:207], a[172:175], v[132:135]
 ds_read_b128 a[172:175], v1 offset:56320
 v_add_f32 v158, v158, v10
 v_mfma_f32_16x16x32_bf16 v[132:135], a[200:203], a[168:171], v[132:135]
 ds_read_b128 a[168:171], v1 offset:55296
 v_add_f32 v159, v159, v11
 v_mfma_f32_16x16x32_bf16 a[240:243], a[200:203], a[176:179], a[240:243]
 ds_read_b128 a[176:179], v1 offset:59392
 v_mfma_f32_16x16x32_bf16 a[240:243], a[204:207], a[180:183], a[240:243]
 ds_read_b128 a[180:183], v1 offset:60416
 v_add_f32 v160, v160, v8
 v_mfma_f32_16x16x32_bf16 a[244:247], a[204:207], a[188:191], a[244:247]
 ds_read_b128 a[188:191], v1 offset:64512
 v_add_f32 v161, v161, v9
 v_mfma_f32_16x16x32_bf16 a[244:247], a[200:203], a[184:187], a[244:247]
 ds_read_b128 a[184:187], v1 offset:63488
 s_waitcnt vmcnt(9) lgkmcnt(8)
 v_mfma_f32_16x16x32_bf16 v[16:19], a[208:211], a[128:131], v[16:19]
 v_add_f32 v162, v162, v10
 v_mfma_f32_16x16x32_bf16 v[16:19], a[212:215], a[132:135], v[16:19]
 global_load_dwordx4 a[204:207], v0, s[70:71] offset:-1024 sc1
 v_mfma_f32_16x16x32_bf16 v[20:23], a[212:215], a[140:143], v[20:23]
 v_add_f32 v163, v163, v11
 v_mfma_f32_16x16x32_bf16 v[20:23], a[208:211], a[136:139], v[20:23]
 global_load_dwordx4 a[200:203], v0, s[70:71] offset:-2048 sc1
 v_add_f32 v164, v164, v8
 v_mfma_f32_16x16x32_bf16 v[24:27], a[208:211], a[144:147], v[24:27]
 v_mfma_f32_16x16x32_bf16 v[24:27], a[212:215], a[148:151], v[24:27]
 v_add_f32 v165, v165, v9
 v_mfma_f32_16x16x32_bf16 v[28:31], a[212:215], a[156:159], v[28:31]
 v_add_f32 v166, v166, v10
 v_mfma_f32_16x16x32_bf16 v[28:31], a[208:211], a[152:155], v[28:31]
 s_waitcnt lgkmcnt(0)
 v_mfma_f32_16x16x32_bf16 v[32:35], a[208:211], a[160:163], v[32:35]
 v_add_f32 v167, v167, v11
 v_mfma_f32_16x16x32_bf16 v[32:35], a[212:215], a[164:167], v[32:35]
 v_mfma_f32_16x16x32_bf16 v[36:39], a[212:215], a[172:175], v[36:39]
 v_mfma_f32_16x16x32_bf16 v[36:39], a[208:211], a[168:171], v[36:39]
 v_add_f32 v168, v168, v12
 v_mfma_f32_16x16x32_bf16 v[40:43], a[208:211], a[176:179], v[40:43]
 ds_read_b128 v[8:11], v4 offset:384
 v_mfma_f32_16x16x32_bf16 v[40:43], a[212:215], a[180:183], v[40:43]
 v_mfma_f32_16x16x32_bf16 v[44:47], a[212:215], a[188:191], v[44:47]
 v_add_f32 v169, v169, v13
 v_mfma_f32_16x16x32_bf16 v[44:47], a[208:211], a[184:187], v[44:47]
 s_waitcnt vmcnt(9)
 v_mfma_f32_16x16x32_bf16 v[76:79], a[216:219], a[184:187], v[76:79]
 v_add_f32 v170, v170, v14
 v_mfma_f32_16x16x32_bf16 v[76:79], a[220:223], a[188:191], v[76:79]
 global_load_dwordx4 a[212:215], v0, s[70:71] offset:1024 sc1
 v_add_f32 v171, v171, v15
 v_mfma_f32_16x16x32_bf16 v[72:75], a[220:223], a[180:183], v[72:75]
 v_mfma_f32_16x16x32_bf16 v[72:75], a[216:219], a[176:179], v[72:75]
 global_load_dwordx4 a[208:211], v0, s[70:71] offset:0 sc1
 v_add_f32 v172, v172, v12
 v_mfma_f32_16x16x32_bf16 v[68:71], a[216:219], a[168:171], v[68:71]
 v_add_f32 v173, v173, v13
 v_mfma_f32_16x16x32_bf16 v[68:71], a[220:223], a[172:175], v[68:71]
 v_mfma_f32_16x16x32_bf16 v[64:67], a[220:223], a[164:167], v[64:67]
 v_add_f32 v174, v174, v14
 v_mfma_f32_16x16x32_bf16 v[64:67], a[216:219], a[160:163], v[64:67]
 v_add_f32 v175, v175, v15
 v_mfma_f32_16x16x32_bf16 v[60:63], a[216:219], a[152:155], v[60:63]
 v_mfma_f32_16x16x32_bf16 v[60:63], a[220:223], a[156:159], v[60:63]
 v_add_f32 v176, v176, v12
 v_mfma_f32_16x16x32_bf16 v[56:59], a[220:223], a[148:151], v[56:59]
 v_add_f32 v177, v177, v13
 v_mfma_f32_16x16x32_bf16 v[56:59], a[216:219], a[144:147], v[56:59]
 v_mfma_f32_16x16x32_bf16 v[52:55], a[216:219], a[136:139], v[52:55]
 v_add_f32 v178, v178, v14
 v_mfma_f32_16x16x32_bf16 v[52:55], a[220:223], a[140:143], v[52:55]
 v_mfma_f32_16x16x32_bf16 v[48:51], a[220:223], a[132:135], v[48:51]
 v_add_f32 v179, v179, v15
 v_mfma_f32_16x16x32_bf16 v[48:51], a[216:219], a[128:131], v[48:51]
 v_add_f32 v180, v180, v12
 s_waitcnt vmcnt(8)
 v_mfma_f32_16x16x32_bf16 v[80:83], a[224:227], a[128:131], v[80:83]
 v_mfma_f32_16x16x32_bf16 v[80:83], a[228:231], a[132:135], v[80:83]
 global_load_dwordx4 a[220:223], v0, s[70:71] offset:3072 sc1
 v_add_f32 v181, v181, v13
 v_mfma_f32_16x16x32_bf16 v[84:87], a[228:231], a[140:143], v[84:87]
 v_add_f32 v182, v182, v14
 v_mfma_f32_16x16x32_bf16 v[84:87], a[224:227], a[136:139], v[84:87]
 global_load_dwordx4 a[216:219], v0, s[70:71] offset:2048 sc1
 v_mfma_f32_16x16x32_bf16 v[88:91], a[224:227], a[144:147], v[88:91]
 v_add_f32 v183, v183, v15
 s_add_u32 s70, s70, 8192
 s_addc_u32 s71, s71, 0
 v_mfma_f32_16x16x32_bf16 v[88:91], a[228:231], a[148:151], v[88:91]
 v_add_f32 v184, v184, v12
 v_mfma_f32_16x16x32_bf16 v[92:95], a[228:231], a[156:159], v[92:95]
 v_mfma_f32_16x16x32_bf16 v[92:95], a[224:227], a[152:155], v[92:95]
 v_add_f32 v185, v185, v13
 v_mfma_f32_16x16x32_bf16 v[96:99], a[224:227], a[160:163], v[96:99]
 v_add_f32 v186, v186, v14
 v_mfma_f32_16x16x32_bf16 v[96:99], a[228:231], a[164:167], v[96:99]
 v_mfma_f32_16x16x32_bf16 v[100:103], a[228:231], a[172:175], v[100:103]
 v_add_f32 v187, v187, v15
 v_mfma_f32_16x16x32_bf16 v[100:103], a[224:227], a[168:171], v[100:103]
 v_mfma_f32_16x16x32_bf16 v[104:107], a[224:227], a[176:179], v[104:107]
 v_add_f32 v188, v188, v12
 v_mfma_f32_16x16x32_bf16 v[104:107], a[228:231], a[180:183], v[104:107]
 v_add_f32 v189, v189, v13
 v_mfma_f32_16x16x32_bf16 v[108:111], a[228:231], a[188:191], v[108:111]
 v_mfma_f32_16x16x32_bf16 v[108:111], a[224:227], a[184:187], v[108:111]
 v_add_f32 v190, v190, v14
 s_waitcnt vmcnt(8)
 v_mfma_f32_16x16x32_bf16 a[244:247], a[232:235], a[184:187], a[244:247]
 ds_read_b128 a[184:187], v2 offset:30720
 v_add_f32 v191, v191, v15
 v_mfma_f32_16x16x32_bf16 a[244:247], a[236:239], a[188:191], a[244:247]
 global_load_dwordx4 a[228:231], v0, s[70:71] offset:-3072 sc1
 ds_read_b128 a[188:191], v2 offset:31744
 v_mfma_f32_16x16x32_bf16 a[240:243], a[236:239], a[180:183], a[240:243]
 ds_read_b128 a[180:183], v2 offset:27648
 v_add_f32 v192, v192, v12
 v_mfma_f32_16x16x32_bf16 a[240:243], a[232:235], a[176:179], a[240:243]
 global_load_dwordx4 a[224:227], v0, s[70:71] offset:-4096 sc1
 ds_read_b128 a[176:179], v2 offset:26624
 v_mfma_f32_16x16x32_bf16 v[132:135], a[232:235], a[168:171], v[132:135]
 ds_read_b128 a[168:171], v2 offset:22528
 v_add_f32 v193, v193, v13
 v_mfma_f32_16x16x32_bf16 v[132:135], a[236:239], a[172:175], v[132:135]
 ds_read_b128 a[172:175], v2 offset:23552
 v_add_f32 v194, v194, v14
 v_mfma_f32_16x16x32_bf16 v[128:131], a[236:239], a[164:167], v[128:131]
 ds_read_b128 a[164:167], v2 offset:19456
 v_add_f32 v195, v195, v15
 v_mfma_f32_16x16x32_bf16 v[128:131], a[232:235], a[160:163], v[128:131]
 ds_read_b128 a[160:163], v2 offset:18432
 v_mfma_f32_16x16x32_bf16 v[124:127], a[232:235], a[152:155], v[124:127]
 ds_read_b128 a[152:155], v2 offset:14336
 v_add_f32 v196, v196, v12
 v_mfma_f32_16x16x32_bf16 v[124:127], a[236:239], a[156:159], v[124:127]
 ds_read_b128 a[156:159], v2 offset:15360
 v_mfma_f32_16x16x32_bf16 v[120:123], a[236:239], a[148:151], v[120:123]
 ds_read_b128 a[148:151], v2 offset:11264
 v_add_f32 v197, v197, v13
 v_mfma_f32_16x16x32_bf16 v[120:123], a[232:235], a[144:147], v[120:123]
 ds_read_b128 a[144:147], v2 offset:10240
 v_add_f32 v198, v198, v14
 v_mfma_f32_16x16x32_bf16 v[116:119], a[232:235], a[136:139], v[116:119]
 ds_read_b128 a[136:139], v2 offset:6144
 v_mfma_f32_16x16x32_bf16 v[116:119], a[236:239], a[140:143], v[116:119]
 ds_read_b128 a[140:143], v2 offset:7168
 v_add_f32 v199, v199, v15
 v_mfma_f32_16x16x32_bf16 v[112:115], a[236:239], a[132:135], v[112:115]
 ds_read_b128 a[132:135], v2 offset:3072
 s_waitcnt lgkmcnt(15)
 v_mfma_f32_16x16x32_bf16 v[112:115], a[232:235], a[128:131], v[112:115]
 ds_read_b128 a[128:131], v2 offset:2048
 s_waitcnt vmcnt(8) lgkmcnt(8)
 v_mfma_f32_16x16x32_bf16 v[44:47], a[192:195], a[184:187], v[44:47]
 v_add_f32 v200, v200, v8
 v_mfma_f32_16x16x32_bf16 v[44:47], a[196:199], a[188:191], v[44:47]
 global_load_dwordx4 a[236:239], v0, s[70:71] offset:-1024 sc1
 ds_read_b128 v[12:15], v4 offset:400
 v_mfma_f32_16x16x32_bf16 v[40:43], a[196:199], a[180:183], v[40:43]
 v_mfma_f32_16x16x32_bf16 v[40:43], a[192:195], a[176:179], v[40:43]
 global_load_dwordx4 a[232:235], v0, s[70:71] offset:-2048 sc1
 v_add_f32 v201, v201, v9
 v_mfma_f32_16x16x32_bf16 v[36:39], a[192:195], a[168:171], v[36:39]
 v_add_f32 v202, v202, v10
 v_mfma_f32_16x16x32_bf16 v[36:39], a[196:199], a[172:175], v[36:39]
 v_mfma_f32_16x16x32_bf16 v[32:35], a[196:199], a[164:167], v[32:35]
 v_add_f32 v203, v203, v11
 v_mfma_f32_16x16x32_bf16 v[32:35], a[192:195], a[160:163], v[32:35]
 s_waitcnt lgkmcnt(1)
 v_mfma_f32_16x16x32_bf16 v[28:31], a[192:195], a[152:155], v[28:31]
 v_add_f32 v204, v204, v8
 v_mfma_f32_16x16x32_bf16 v[28:31], a[196:199], a[156:159], v[28:31]
 v_add_f32 v205, v205, v9
 v_mfma_f32_16x16x32_bf16 v[24:27], a[196:199], a[148:151], v[24:27]
 v_mfma_f32_16x16x32_bf16 v[24:27], a[192:195], a[144:147], v[24:27]
 v_add_f32 v206, v206, v10
 v_mfma_f32_16x16x32_bf16 v[20:23], a[192:195], a[136:139], v[20:23]
 v_add_f32 v207, v207, v11
 v_mfma_f32_16x16x32_bf16 v[20:23], a[196:199], a[140:143], v[20:23]
 v_mfma_f32_16x16x32_bf16 v[16:19], a[196:199], a[132:135], v[16:19]
 v_add_f32 v208, v208, v8
 v_mfma_f32_16x16x32_bf16 v[16:19], a[192:195], a[128:131], v[16:19]
 v_add_f32 v209, v209, v9
 s_waitcnt vmcnt(8)
 v_mfma_f32_16x16x32_bf16 v[48:51], a[200:203], a[128:131], v[48:51]
 v_mfma_f32_16x16x32_bf16 v[48:51], a[204:207], a[132:135], v[48:51]
 global_load_dwordx4 a[196:199], v0, s[70:71] offset:1024 sc1
 v_add_f32 v210, v210, v10
 v_mfma_f32_16x16x32_bf16 v[52:55], a[204:207], a[140:143], v[52:55]
 v_add_f32 v211, v211, v11
 v_mfma_f32_16x16x32_bf16 v[52:55], a[200:203], a[136:139], v[52:55]
 global_load_dwordx4 a[192:195], v0, s[70:71] offset:0 sc1
 v_mfma_f32_16x16x32_bf16 v[56:59], a[200:203], a[144:147], v[56:59]
 v_add_f32 v212, v212, v8
 v_mfma_f32_16x16x32_bf16 v[56:59], a[204:207], a[148:151], v[56:59]
 v_mfma_f32_16x16x32_bf16 v[60:63], a[204:207], a[156:159], v[60:63]
 v_add_f32 v213, v213, v9
 v_mfma_f32_16x16x32_bf16 v[60:63], a[200:203], a[152:155], v[60:63]
 v_add_f32 v214, v214, v10
 v_mfma_f32_16x16x32_bf16 v[64:67], a[200:203], a[160:163], v[64:67]
 v_mfma_f32_16x16x32_bf16 v[64:67], a[204:207], a[164:167], v[64:67]
 v_add_f32 v215, v215, v11
 v_mfma_f32_16x16x32_bf16 v[68:71], a[204:207], a[172:175], v[68:71]
 v_add_f32 v216, v216, v8
 v_mfma_f32_16x16x32_bf16 v[68:71], a[200:203], a[168:171], v[68:71]
 v_mfma_f32_16x16x32_bf16 v[72:75], a[200:203], a[176:179], v[72:75]
 v_add_f32 v217, v217, v9
 v_mfma_f32_16x16x32_bf16 v[72:75], a[204:207], a[180:183], v[72:75]
 v_add_f32 v218, v218, v10
 v_mfma_f32_16x16x32_bf16 v[76:79], a[204:207], a[188:191], v[76:79]
 v_mfma_f32_16x16x32_bf16 v[76:79], a[200:203], a[184:187], v[76:79]
 v_add_f32 v219, v219, v11
 s_waitcnt vmcnt(8)
 v_mfma_f32_16x16x32_bf16 v[108:111], a[208:211], a[184:187], v[108:111]
 v_add_f32 v220, v220, v8
 v_mfma_f32_16x16x32_bf16 v[108:111], a[212:215], a[188:191], v[108:111]
 global_load_dwordx4 a[204:207], v0, s[70:71] offset:3072 sc1
 v_mfma_f32_16x16x32_bf16 v[104:107], a[212:215], a[180:183], v[104:107]
 v_add_f32 v221, v221, v9
 v_mfma_f32_16x16x32_bf16 v[104:107], a[208:211], a[176:179], v[104:107]
 global_load_dwordx4 a[200:203], v0, s[70:71] offset:2048 sc1
 v_mfma_f32_16x16x32_bf16 v[100:103], a[208:211], a[168:171], v[100:103]
 v_add_f32 v222, v222, v10
 s_add_u32 s70, s70, 8192
 s_addc_u32 s71, s71, 0
 v_mfma_f32_16x16x32_bf16 v[100:103], a[212:215], a[172:175], v[100:103]
 v_add_f32 v223, v223, v11
 v_mfma_f32_16x16x32_bf16 v[96:99], a[212:215], a[164:167], v[96:99]
 v_mfma_f32_16x16x32_bf16 v[96:99], a[208:211], a[160:163], v[96:99]
 v_add_f32 v224, v224, v8
 v_mfma_f32_16x16x32_bf16 v[92:95], a[208:211], a[152:155], v[92:95]
 v_add_f32 v225, v225, v9
 v_mfma_f32_16x16x32_bf16 v[92:95], a[212:215], a[156:159], v[92:95]
 v_mfma_f32_16x16x32_bf16 v[88:91], a[212:215], a[148:151], v[88:91]
 v_add_f32 v226, v226, v10
 v_mfma_f32_16x16x32_bf16 v[88:91], a[208:211], a[144:147], v[88:91]
 v_add_f32 v227, v227, v11
 v_mfma_f32_16x16x32_bf16 v[84:87], a[208:211], a[136:139], v[84:87]
 v_mfma_f32_16x16x32_bf16 v[84:87], a[212:215], a[140:143], v[84:87]
 v_add_f32 v228, v228, v8
 v_mfma_f32_16x16x32_bf16 v[80:83], a[212:215], a[132:135], v[80:83]
 v_add_f32 v229, v229, v9
 v_mfma_f32_16x16x32_bf16 v[80:83], a[208:211], a[128:131], v[80:83]
 s_waitcnt vmcnt(8)
 v_mfma_f32_16x16x32_bf16 v[112:115], a[216:219], a[128:131], v[112:115]
 ds_read_b128 a[128:131], v2 offset:34816
 v_add_f32 v230, v230, v10
 v_mfma_f32_16x16x32_bf16 v[112:115], a[220:223], a[132:135], v[112:115]
 global_load_dwordx4 a[212:215], v0, s[70:71] offset:-3072 sc1
 ds_read_b128 a[132:135], v2 offset:35840
 v_mfma_f32_16x16x32_bf16 v[116:119], a[220:223], a[140:143], v[116:119]
 ds_read_b128 a[140:143], v2 offset:39936
 v_add_f32 v231, v231, v11
 v_mfma_f32_16x16x32_bf16 v[116:119], a[216:219], a[136:139], v[116:119]
 global_load_dwordx4 a[208:211], v0, s[70:71] offset:-4096 sc1
 ds_read_b128 a[136:139], v2 offset:38912
 s_waitcnt lgkmcnt(4)
 v_mfma_f32_16x16x32_bf16 v[120:123], a[216:219], a[144:147], v[120:123]
 ds_read_b128 a[144:147], v2 offset:43008
 v_mfma_f32_16x16x32_bf16 v[120:123], a[220:223], a[148:151], v[120:123]
 ds_read_b128 a[148:151], v2 offset:44032
 v_add_f32 v232, v232, v12
 v_mfma_f32_16x16x32_bf16 v[124:127], a[220:223], a[156:159], v[124:127]
 ds_read_b128 a[156:159], v2 offset:48128
 v_add_f32 v233, v233, v13
 v_mfma_f32_16x16x32_bf16 v[124:127], a[216:219], a[152:155], v[124:127]
 ds_read_b128 a[152:155], v2 offset:47104
 v_mfma_f32_16x16x32_bf16 v[128:131], a[216:219], a[160:163], v[128:131]
 ds_read_b128 a[160:163], v2 offset:51200
 v_add_f32 v234, v234, v14
 v_mfma_f32_16x16x32_bf16 v[128:131], a[220:223], a[164:167], v[128:131]
 ds_read_b128 a[164:167], v2 offset:52224
 v_add_f32 v235, v235, v15
 v_mfma_f32_16x16x32_bf16 v[132:135], a[220:223], a[172:175], v[132:135]
 ds_read_b128 a[172:175], v2 offset:56320
 v_mfma_f32_16x16x32_bf16 v[132:135], a[216:219], a[168:171], v[132:135]
 ds_read_b128 a[168:171], v2 offset:55296
 v_add_f32 v236, v236, v12
 v_mfma_f32_16x16x32_bf16 a[240:243], a[216:219], a[176:179], a[240:243]
 ds_read_b128 a[176:179], v2 offset:59392
 v_add_f32 v237, v237, v13
 v_mfma_f32_16x16x32_bf16 a[240:243], a[220:223], a[180:183], a[240:243]
 ds_read_b128 a[180:183], v2 offset:60416
 v_mfma_f32_16x16x32_bf16 a[244:247], a[220:223], a[188:191], a[244:247]
 ds_read_b128 a[188:191], v2 offset:64512
 v_add_f32 v238, v238, v14
 v_mfma_f32_16x16x32_bf16 a[244:247], a[216:219], a[184:187], a[244:247]
 ds_read_b128 a[184:187], v2 offset:63488
 s_waitcnt vmcnt(8) lgkmcnt(8)
 v_mfma_f32_16x16x32_bf16 v[16:19], a[224:227], a[128:131], v[16:19]
 v_add_f32 v239, v239, v15
 v_mfma_f32_16x16x32_bf16 v[16:19], a[228:231], a[132:135], v[16:19]
 global_load_dwordx4 a[220:223], v0, s[70:71] offset:-1024 sc1
 v_add_f32 v240, v240, v12
 v_mfma_f32_16x16x32_bf16 v[20:23], a[228:231], a[140:143], v[20:23]
 v_mfma_f32_16x16x32_bf16 v[20:23], a[224:227], a[136:139], v[20:23]
 global_load_dwordx4 a[216:219], v0, s[70:71] offset:-2048 sc1
 v_add_f32 v241, v241, v13
 v_mfma_f32_16x16x32_bf16 v[24:27], a[224:227], a[144:147], v[24:27]
 v_add_f32 v242, v242, v14
 v_mfma_f32_16x16x32_bf16 v[24:27], a[228:231], a[148:151], v[24:27]
 v_mfma_f32_16x16x32_bf16 v[28:31], a[228:231], a[156:159], v[28:31]
 v_add_f32 v243, v243, v15
 v_mfma_f32_16x16x32_bf16 v[28:31], a[224:227], a[152:155], v[28:31]
 v_add_f32 v244, v244, v12
 s_waitcnt lgkmcnt(0)
 v_mfma_f32_16x16x32_bf16 v[32:35], a[224:227], a[160:163], v[32:35]
 v_mfma_f32_16x16x32_bf16 v[32:35], a[228:231], a[164:167], v[32:35]
 v_add_f32 v245, v245, v13
 v_mfma_f32_16x16x32_bf16 v[36:39], a[228:231], a[172:175], v[36:39]
 v_add_f32 v246, v246, v14
 v_mfma_f32_16x16x32_bf16 v[36:39], a[224:227], a[168:171], v[36:39]
 v_mfma_f32_16x16x32_bf16 v[40:43], a[224:227], a[176:179], v[40:43]
 v_add_f32 v247, v247, v15
 v_mfma_f32_16x16x32_bf16 v[40:43], a[228:231], a[180:183], v[40:43]
 v_mfma_f32_16x16x32_bf16 v[44:47], a[228:231], a[188:191], v[44:47]
 v_add_f32 v248, v248, v12
 v_mfma_f32_16x16x32_bf16 v[44:47], a[224:227], a[184:187], v[44:47]
 v_add_f32 v249, v249, v13
 s_waitcnt vmcnt(8)
 v_mfma_f32_16x16x32_bf16 v[76:79], a[232:235], a[184:187], v[76:79]
 v_mfma_f32_16x16x32_bf16 v[76:79], a[236:239], a[188:191], v[76:79]
 global_load_dwordx4 a[228:231], v0, s[70:71] offset:1024 sc1
 v_add_f32 v250, v250, v14
 v_mfma_f32_16x16x32_bf16 v[72:75], a[236:239], a[180:183], v[72:75]
 v_add_f32 v251, v251, v15
 v_mfma_f32_16x16x32_bf16 v[72:75], a[232:235], a[176:179], v[72:75]
 global_load_dwordx4 a[224:227], v0, s[70:71] offset:0 sc1
 v_mfma_f32_16x16x32_bf16 v[68:71], a[232:235], a[168:171], v[68:71]
 v_add_f32 v252, v252, v12
 v_mfma_f32_16x16x32_bf16 v[68:71], a[236:239], a[172:175], v[68:71]
 v_add_f32 v253, v253, v13
 v_mfma_f32_16x16x32_bf16 v[64:67], a[236:239], a[164:167], v[64:67]
 v_mfma_f32_16x16x32_bf16 v[64:67], a[232:235], a[160:163], v[64:67]
 v_add_f32 v254, v254, v14
 v_mfma_f32_16x16x32_bf16 v[60:63], a[232:235], a[152:155], v[60:63]
 v_add_f32 v255, v255, v15
 v_mfma_f32_16x16x32_bf16 v[60:63], a[236:239], a[156:159], v[60:63]
 v_mfma_f32_16x16x32_bf16 v[56:59], a[236:239], a[148:151], v[56:59]
 v_accvgpr_read_b32 v5, a248
 v_mfma_f32_16x16x32_bf16 v[56:59], a[232:235], a[144:147], v[56:59]
 v_mfma_f32_16x16x32_bf16 v[52:55], a[232:235], a[136:139], v[52:55]
 v_add_f32 v5, v5, v12
 v_mfma_f32_16x16x32_bf16 v[52:55], a[236:239], a[140:143], v[52:55]
 v_accvgpr_write_b32 a248, v5
 v_mfma_f32_16x16x32_bf16 v[48:51], a[236:239], a[132:135], v[48:51]
 v_mfma_f32_16x16x32_bf16 v[48:51], a[232:235], a[128:131], v[48:51]
 v_accvgpr_read_b32 v6, a249
 s_waitcnt vmcnt(8)
 v_mfma_f32_16x16x32_bf16 v[80:83], a[192:195], a[128:131], v[80:83]
 v_add_f32 v6, v6, v13
 v_mfma_f32_16x16x32_bf16 v[80:83], a[196:199], a[132:135], v[80:83]
 global_load_dwordx4 a[236:239], v0, s[70:71] offset:3072 sc1
 v_mfma_f32_16x16x32_bf16 v[84:87], a[196:199], a[140:143], v[84:87]
 v_accvgpr_write_b32 a249, v6
 v_mfma_f32_16x16x32_bf16 v[84:87], a[192:195], a[136:139], v[84:87]
 global_load_dwordx4 a[232:235], v0, s[70:71] offset:2048 sc1
 v_accvgpr_read_b32 v5, a250
 v_mfma_f32_16x16x32_bf16 v[88:91], a[192:195], a[144:147], v[88:91]
 s_add_u32 s70, s70, 8192
 s_addc_u32 s71, s71, 0
 v_mfma_f32_16x16x32_bf16 v[88:91], a[196:199], a[148:151], v[88:91]
 v_add_f32 v5, v5, v14
 v_mfma_f32_16x16x32_bf16 v[92:95], a[196:199], a[156:159], v[92:95]
 v_accvgpr_write_b32 a250, v5
 v_mfma_f32_16x16x32_bf16 v[92:95], a[192:195], a[152:155], v[92:95]
 v_mfma_f32_16x16x32_bf16 v[96:99], a[192:195], a[160:163], v[96:99]
 v_accvgpr_read_b32 v6, a251
 v_mfma_f32_16x16x32_bf16 v[96:99], a[196:199], a[164:167], v[96:99]
 v_mfma_f32_16x16x32_bf16 v[100:103], a[196:199], a[172:175], v[100:103]
 v_add_f32 v6, v6, v15
 v_mfma_f32_16x16x32_bf16 v[100:103], a[192:195], a[168:171], v[100:103]
 v_accvgpr_write_b32 a251, v6
 v_mfma_f32_16x16x32_bf16 v[104:107], a[192:195], a[176:179], v[104:107]
 v_mfma_f32_16x16x32_bf16 v[104:107], a[196:199], a[180:183], v[104:107]
 v_accvgpr_read_b32 v5, a252
 v_mfma_f32_16x16x32_bf16 v[108:111], a[196:199], a[188:191], v[108:111]
 v_add_f32 v5, v5, v12
 v_mfma_f32_16x16x32_bf16 v[108:111], a[192:195], a[184:187], v[108:111]
 s_waitcnt vmcnt(8)
 v_mfma_f32_16x16x32_bf16 a[244:247], a[200:203], a[184:187], a[244:247]
 v_accvgpr_write_b32 a252, v5
 v_mfma_f32_16x16x32_bf16 a[244:247], a[204:207], a[188:191], a[244:247]
 global_load_dwordx4 a[196:199], v0, s[70:71] offset:-3072 sc1
 v_accvgpr_read_b32 v6, a253
 v_mfma_f32_16x16x32_bf16 a[240:243], a[204:207], a[180:183], a[240:243]
 v_mfma_f32_16x16x32_bf16 a[240:243], a[200:203], a[176:179], a[240:243]
 global_load_dwordx4 a[192:195], v0, s[70:71] offset:-4096 sc1
 v_add_f32 v6, v6, v13
 v_mfma_f32_16x16x32_bf16 v[132:135], a[200:203], a[168:171], v[132:135]
 v_accvgpr_write_b32 a253, v6
 v_mfma_f32_16x16x32_bf16 v[132:135], a[204:207], a[172:175], v[132:135]
 v_mfma_f32_16x16x32_bf16 v[128:131], a[204:207], a[164:167], v[128:131]
 v_accvgpr_read_b32 v5, a254
 v_mfma_f32_16x16x32_bf16 v[128:131], a[200:203], a[160:163], v[128:131]
 v_mfma_f32_16x16x32_bf16 v[124:127], a[200:203], a[152:155], v[124:127]
 v_add_f32 v5, v5, v14
 v_mfma_f32_16x16x32_bf16 v[124:127], a[204:207], a[156:159], v[124:127]
 v_accvgpr_write_b32 a254, v5
 v_mfma_f32_16x16x32_bf16 v[120:123], a[204:207], a[148:151], v[120:123]
 v_mfma_f32_16x16x32_bf16 v[120:123], a[200:203], a[144:147], v[120:123]
 v_accvgpr_read_b32 v6, a255
 v_mfma_f32_16x16x32_bf16 v[116:119], a[200:203], a[136:139], v[116:119]
 v_add_f32 v6, v6, v15
 v_mfma_f32_16x16x32_bf16 v[116:119], a[204:207], a[140:143], v[116:119]
 v_mfma_f32_16x16x32_bf16 v[112:115], a[204:207], a[132:135], v[112:115]
 global_load_dwordx4 a[204:207], v0, s[70:71] offset:-1024 sc1
 v_accvgpr_write_b32 a255, v6
 v_mfma_f32_16x16x32_bf16 v[112:115], a[200:203], a[128:131], v[112:115]
 global_load_dwordx4 a[200:203], v0, s[70:71] offset:-2048 sc1
 s_waitcnt vmcnt(10)
 s_mov_b32 s34, 0x10000000
 s_mov_b32 s8, s32
 s_mov_b32 s9, s33
 s_mov_b32 s10, s34
 s_mov_b32 s20, 1024
 s_mov_b32 s21, 1024
 s_mov_b32 s22, 1024
 s_xor_b32 s30, s29, 131072
 s_add_u32 s51, s51, 2048
 s_add_u32 s25, s25, 1
 s_cmp_eq_u32 s25, 6
 s_cbranch_scc1 Llast
 v_mfma_f32_16x16x32_bf16 v[136:139], a[208:211], a[128:131], v[136:139]
 v_accvgpr_read_b32 v5, a0
 v_lshlrev_b32 v6, 16, v5
 v_mfma_f32_16x16x32_bf16 v[136:139], a[212:215], a[132:135], v[136:139]
 v_and_b32 v5, s26, v5
 v_mul_f32 v6, v6, v16
 v_mfma_f32_16x16x32_bf16 v[140:143], a[212:215], a[140:143], v[140:143]
 v_mul_f32 v5, v5, v17
 v_mfma_f32_16x16x32_bf16 v[140:143], a[208:211], a[136:139], v[140:143]
 v_cvt_pk_bf16_f32 v8, v6, v5
 v_accvgpr_read_b32 v5, a1
 v_mfma_f32_16x16x32_bf16 v[144:147], a[208:211], a[144:147], v[144:147]
 v_lshlrev_b32 v6, 16, v5
 v_and_b32 v5, s26, v5
 v_mfma_f32_16x16x32_bf16 v[144:147], a[212:215], a[148:151], v[144:147]
 v_mul_f32 v6, v6, v18
 v_mul_f32 v5, v5, v19
 v_mfma_f32_16x16x32_bf16 v[148:151], a[212:215], a[156:159], v[148:151]
 v_cvt_pk_bf16_f32 v9, v6, v5
 v_accvgpr_read_b32 v5, a2
 v_mfma_f32_16x16x32_bf16 v[148:151], a[208:211], a[152:155], v[148:151]
 v_lshlrev_b32 v6, 16, v5
 v_and_b32 v5, s26, v5
 v_mfma_f32_16x16x32_bf16 v[152:155], a[208:211], a[160:163], v[152:155]
 v_mul_f32 v6, v6, v48
 v_mfma_f32_16x16x32_bf16 v[152:155], a[212:215], a[164:167], v[152:155]
 v_mul_f32 v5, v5, v49
 v_cvt_pk_bf16_f32 v10, v6, v5
 v_mfma_f32_16x16x32_bf16 v[156:159], a[212:215], a[172:175], v[156:159]
 v_accvgpr_read_b32 v5, a3
 v_lshlrev_b32 v6, 16, v5
 v_mfma_f32_16x16x32_bf16 v[156:159], a[208:211], a[168:171], v[156:159]
 v_and_b32 v5, s26, v5
 v_mul_f32 v6, v6, v50
 v_mfma_f32_16x16x32_bf16 v[160:163], a[208:211], a[176:179], v[160:163]
 v_mul_f32 v5, v5, v51
 v_cvt_pk_bf16_f32 v11, v6, v5
 v_mfma_f32_16x16x32_bf16 v[160:163], a[212:215], a[180:183], v[160:163]
 ds_write_b128 v3, v[8:11]
 s_add_u32 s68, s29, 0
 v_mfma_f32_16x16x32_bf16 v[164:167], a[212:215], a[188:191], v[164:167]
 buffer_store_dwordx4 v[8:11], v3, s[32:35], s68 offen sc1
 v_accvgpr_read_b32 v5, a32
 v_lshlrev_b32 v6, 16, v5
 v_mfma_f32_16x16x32_bf16 v[164:167], a[208:211], a[184:187], v[164:167]
 v_and_b32 v5, s26, v5
 v_mul_f32 v6, v6, v80
 s_waitcnt vmcnt(9)
 v_mfma_f32_16x16x32_bf16 v[196:199], a[216:219], a[184:187], v[196:199]
 v_mul_f32 v5, v5, v81
 v_cvt_pk_bf16_f32 v12, v6, v5
 v_mfma_f32_16x16x32_bf16 v[196:199], a[220:223], a[188:191], v[196:199]
 global_load_dwordx4 a[212:215], v0, s[70:71] offset:1024 sc1
 v_accvgpr_read_b32 v5, a33
 v_mfma_f32_16x16x32_bf16 v[192:195], a[220:223], a[180:183], v[192:195]
 v_lshlrev_b32 v6, 16, v5
 v_and_b32 v5, s26, v5
 v_mfma_f32_16x16x32_bf16 v[192:195], a[216:219], a[176:179], v[192:195]
 global_load_dwordx4 a[208:211], v0, s[70:71] offset:0 sc1
 v_mul_f32 v6, v6, v82
 v_mfma_f32_16x16x32_bf16 v[188:191], a[216:219], a[168:171], v[188:191]
 v_mul_f32 v5, v5, v83
 v_cvt_pk_bf16_f32 v13, v6, v5
 v_mfma_f32_16x16x32_bf16 v[188:191], a[220:223], a[172:175], v[188:191]
 v_accvgpr_read_b32 v5, a34
 v_lshlrev_b32 v6, 16, v5
 v_mfma_f32_16x16x32_bf16 v[184:187], a[220:223], a[164:167], v[184:187]
 v_and_b32 v5, s26, v5
 v_mul_f32 v6, v6, v112
 v_mfma_f32_16x16x32_bf16 v[184:187], a[216:219], a[160:163], v[184:187]
 v_mul_f32 v5, v5, v113
 v_cvt_pk_bf16_f32 v14, v6, v5
 v_mfma_f32_16x16x32_bf16 v[180:183], a[216:219], a[152:155], v[180:183]
 v_accvgpr_read_b32 v5, a35
 v_lshlrev_b32 v6, 16, v5
 v_mfma_f32_16x16x32_bf16 v[180:183], a[220:223], a[156:159], v[180:183]
 v_and_b32 v5, s26, v5
 v_mul_f32 v6, v6, v114
 v_mfma_f32_16x16x32_bf16 v[176:179], a[220:223], a[148:151], v[176:179]
 v_mul_f32 v5, v5, v115
 v_cvt_pk_bf16_f32 v15, v6, v5
 v_mfma_f32_16x16x32_bf16 v[176:179], a[216:219], a[144:147], v[176:179]
 ds_write_b128 v3, v[12:15] offset:1024
 v_mfma_f32_16x16x32_bf16 v[172:175], a[216:219], a[136:139], v[172:175]
 buffer_store_dwordx4 v[12:15], v3, s[32:35], s68 offen offset:1024 sc1
 v_accvgpr_read_b32 v5, a4
 v_lshlrev_b32 v6, 16, v5
 v_mfma_f32_16x16x32_bf16 v[172:175], a[220:223], a[140:143], v[172:175]
 v_and_b32 v5, s26, v5
 v_mul_f32 v6, v6, v20
 v_mfma_f32_16x16x32_bf16 v[168:171], a[220:223], a[132:135], v[168:171]
 v_mul_f32 v5, v5, v21
 v_cvt_pk_bf16_f32 v8, v6, v5
 v_mfma_f32_16x16x32_bf16 v[168:171], a[216:219], a[128:131], v[168:171]
 v_accvgpr_read_b32 v5, a5
 v_lshlrev_b32 v6, 16, v5
 s_waitcnt vmcnt(10)
 v_mfma_f32_16x16x32_bf16 v[200:203], a[224:227], a[128:131], v[200:203]
 v_and_b32 v5, s26, v5
 v_mul_f32 v6, v6, v22
 v_mfma_f32_16x16x32_bf16 v[200:203], a[228:231], a[132:135], v[200:203]
 global_load_dwordx4 a[220:223], v0, s[70:71] offset:3072 sc1
 v_mul_f32 v5, v5, v23
 v_mfma_f32_16x16x32_bf16 v[204:207], a[228:231], a[140:143], v[204:207]
 v_cvt_pk_bf16_f32 v9, v6, v5
 v_accvgpr_read_b32 v5, a6
 v_mfma_f32_16x16x32_bf16 v[204:207], a[224:227], a[136:139], v[204:207]
 global_load_dwordx4 a[216:219], v0, s[70:71] offset:2048 sc1
 v_lshlrev_b32 v6, 16, v5
 v_mfma_f32_16x16x32_bf16 v[208:211], a[224:227], a[144:147], v[208:211]
 v_and_b32 v5, s26, v5
 v_mul_f32 v6, v6, v52
 s_add_u32 s70, s70, 8192
 s_addc_u32 s71, s71, 0
 v_mfma_f32_16x16x32_bf16 v[208:211], a[228:231], a[148:151], v[208:211]
 v_mul_f32 v5, v5, v53
 v_cvt_pk_bf16_f32 v10, v6, v5
 v_mfma_f32_16x16x32_bf16 v[212:215], a[228:231], a[156:159], v[212:215]
 v_accvgpr_read_b32 v5, a7
 v_lshlrev_b32 v6, 16, v5
 v_mfma_f32_16x16x32_bf16 v[212:215], a[224:227], a[152:155], v[212:215]
 v_and_b32 v5, s26, v5
 v_mul_f32 v6, v6, v54
 v_mfma_f32_16x16x32_bf16 v[216:219], a[224:227], a[160:163], v[216:219]
 v_mul_f32 v5, v5, v55
 v_cvt_pk_bf16_f32 v11, v6, v5
 v_mfma_f32_16x16x32_bf16 v[216:219], a[228:231], a[164:167], v[216:219]
 ds_write_b128 v3, v[8:11] offset:4096
 v_mfma_f32_16x16x32_bf16 v[220:223], a[228:231], a[172:175], v[220:223]
 buffer_store_dwordx4 v[8:11], v3, s[32:35], s68 offen offset:2048 sc1
 v_accvgpr_read_b32 v5, a36
 v_lshlrev_b32 v6, 16, v5
 v_and_b32 v5, s26, v5
 v_mfma_f32_16x16x32_bf16 v[220:223], a[224:227], a[168:171], v[220:223]
 v_mul_f32 v6, v6, v84
 v_mul_f32 v5, v5, v85
 v_mfma_f32_16x16x32_bf16 v[224:227], a[224:227], a[176:179], v[224:227]
 v_cvt_pk_bf16_f32 v12, v6, v5
 v_accvgpr_read_b32 v5, a37
 v_mfma_f32_16x16x32_bf16 v[224:227], a[228:231], a[180:183], v[224:227]
 v_lshlrev_b32 v6, 16, v5
 v_and_b32 v5, s26, v5
 v_mfma_f32_16x16x32_bf16 v[228:231], a[228:231], a[188:191], v[228:231]
 v_mul_f32 v6, v6, v86
 v_mul_f32 v5, v5, v87
 v_mfma_f32_16x16x32_bf16 v[228:231], a[224:227], a[184:187], v[228:231]
 v_cvt_pk_bf16_f32 v13, v6, v5
 v_accvgpr_read_b32 v5, a38
 s_waitcnt vmcnt(11)
 v_mfma_f32_16x16x32_bf16 a[252:255], a[232:235], a[184:187], a[252:255]
 ds_read_b128 a[184:187], v2 offset:30720
 v_lshlrev_b32 v6, 16, v5
 v_mfma_f32_16x16x32_bf16 a[252:255], a[236:239], a[188:191], a[252:255]
 global_load_dwordx4 a[228:231], v0, s[70:71] offset:-3072 sc1
 ds_read_b128 a[188:191], v2 offset:31744
 v_mfma_f32_16x16x32_bf16 a[248:251], a[236:239], a[180:183], a[248:251]
 ds_read_b128 a[180:183], v2 offset:27648
 v_and_b32 v5, s26, v5
 v_mfma_f32_16x16x32_bf16 a[248:251], a[232:235], a[176:179], a[248:251]
 global_load_dwordx4 a[224:227], v0, s[70:71] offset:-4096 sc1
 ds_read_b128 a[176:179], v2 offset:26624
 v_mul_f32 v6, v6, v116
 v_mfma_f32_16x16x32_bf16 v[252:255], a[232:235], a[168:171], v[252:255]
 ds_read_b128 a[168:171], v2 offset:22528
 v_mul_f32 v5, v5, v117
 v_mfma_f32_16x16x32_bf16 v[252:255], a[236:239], a[172:175], v[252:255]
 ds_read_b128 a[172:175], v2 offset:23552
 v_cvt_pk_bf16_f32 v14, v6, v5
 v_accvgpr_read_b32 v5, a39
 v_mfma_f32_16x16x32_bf16 v[248:251], a[236:239], a[164:167], v[248:251]
 ds_read_b128 a[164:167], v2 offset:19456
 v_lshlrev_b32 v6, 16, v5
 v_and_b32 v5, s26, v5
 v_mfma_f32_16x16x32_bf16 v[248:251], a[232:235], a[160:163], v[248:251]
 ds_read_b128 a[160:163], v2 offset:18432
 v_mul_f32 v6, v6, v118
 v_mul_f32 v5, v5, v119
 v_mfma_f32_16x16x32_bf16 v[244:247], a[232:235], a[152:155], v[244:247]
 ds_read_b128 a[152:155], v2 offset:14336
 v_cvt_pk_bf16_f32 v15, v6, v5
 v_mfma_f32_16x16x32_bf16 v[244:247], a[236:239], a[156:159], v[244:247]
 ds_read_b128 a[156:159], v2 offset:15360
 ds_write_b128 v3, v[12:15] offset:5120
 v_mfma_f32_16x16x32_bf16 v[240:243], a[236:239], a[148:151], v[240:243]
 buffer_store_dwordx4 v[12:15], v3, s[32:35], s68 offen offset:3072 sc1
 ds_read_b128 a[148:151], v2 offset:11264
 v_accvgpr_read_b32 v5, a8
 v_lshlrev_b32 v6, 16, v5
 v_mfma_f32_16x16x32_bf16 v[240:243], a[232:235], a[144:147], v[240:243]
 ds_read_b128 a[144:147], v2 offset:10240
 v_and_b32 v5, s26, v5
 v_mul_f32 v6, v6, v24
 v_mfma_f32_16x16x32_bf16 v[236:239], a[232:235], a[136:139], v[236:239]
 ds_read_b128 a[136:139], v2 offset:6144
 v_mul_f32 v5, v5, v25
 v_cvt_pk_bf16_f32 v8, v6, v5
 v_mfma_f32_16x16x32_bf16 v[236:239], a[236:239], a[140:143], v[236:239]
 ds_read_b128 a[140:143], v2 offset:7168
 v_accvgpr_read_b32 v5, a9
 v_lshlrev_b32 v6, 16, v5
 v_mfma_f32_16x16x32_bf16 v[232:235], a[236:239], a[132:135], v[232:235]
 ds_read_b128 a[132:135], v2 offset:3072
 v_and_b32 v5, s26, v5
 v_mfma_f32_16x16x32_bf16 v[232:235], a[232:235], a[128:131], v[232:235]
 ds_read_b128 a[128:131], v2 offset:2048
 v_mul_f32 v6, v6, v26
 s_waitcnt vmcnt(12) lgkmcnt(9)
 v_mfma_f32_16x16x32_bf16 v[164:167], a[192:195], a[184:187], v[164:167]
 v_mul_f32 v5, v5, v27
 v_cvt_pk_bf16_f32 v9, v6, v5
 v_mfma_f32_16x16x32_bf16 v[164:167], a[196:199], a[188:191], v[164:167]
 global_load_dwordx4 a[236:239], v0, s[70:71] offset:-1024 sc1
 v_accvgpr_read_b32 v5, a10
 v_mfma_f32_16x16x32_bf16 v[160:163], a[196:199], a[180:183], v[160:163]
 v_lshlrev_b32 v6, 16, v5
 v_and_b32 v5, s26, v5
 v_mfma_f32_16x16x32_bf16 v[160:163], a[192:195], a[176:179], v[160:163]
 global_load_dwordx4 a[232:235], v0, s[70:71] offset:-2048 sc1
 v_mul_f32 v6, v6, v56
 v_mfma_f32_16x16x32_bf16 v[156:159], a[192:195], a[168:171], v[156:159]
 v_mul_f32 v5, v5, v57
 v_cvt_pk_bf16_f32 v10, v6, v5
 v_mfma_f32_16x16x32_bf16 v[156:159], a[196:199], a[172:175], v[156:159]
 v_accvgpr_read_b32 v5, a11
 v_lshlrev_b32 v6, 16, v5
 v_mfma_f32_16x16x32_bf16 v[152:155], a[196:199], a[164:167], v[152:155]
 v_and_b32 v5, s26, v5
 v_mul_f32 v6, v6, v58
 v_mfma_f32_16x16x32_bf16 v[152:155], a[192:195], a[160:163], v[152:155]
 v_mul_f32 v5, v5, v59
 v_cvt_pk_bf16_f32 v11, v6, v5
 s_waitcnt lgkmcnt(0)
 v_mfma_f32_16x16x32_bf16 v[148:151], a[192:195], a[152:155], v[148:151]
 ds_write_b128 v3, v[8:11] offset:8192
 v_mfma_f32_16x16x32_bf16 v[148:151], a[196:199], a[156:159], v[148:151]
 v_lshlrev_b32 v4, 2, v3
 v_and_b32 v4, 192, v4
 v_mfma_f32_16x16x32_bf16 v[144:147], a[196:199], a[148:151], v[144:147]
 buffer_load_dword v4, v4, s[44:47], 0 offen sc1
 s_add_u32 s68, s29, 4096
 v_mfma_f32_16x16x32_bf16 v[144:147], a[192:195], a[144:147], v[144:147]
 buffer_store_dwordx4 v[8:11], v3, s[32:35], s68 offen sc1
 v_accvgpr_read_b32 v5, a40
 v_lshlrev_b32 v6, 16, v5
 v_and_b32 v5, s26, v5
 v_mfma_f32_16x16x32_bf16 v[140:143], a[192:195], a[136:139], v[140:143]
 v_mul_f32 v6, v6, v88
 v_mul_f32 v5, v5, v89
 v_mfma_f32_16x16x32_bf16 v[140:143], a[196:199], a[140:143], v[140:143]
 v_cvt_pk_bf16_f32 v12, v6, v5
 v_accvgpr_read_b32 v5, a41
 v_mfma_f32_16x16x32_bf16 v[136:139], a[196:199], a[132:135], v[136:139]
 v_lshlrev_b32 v6, 16, v5
 v_and_b32 v5, s26, v5
 v_mfma_f32_16x16x32_bf16 v[136:139], a[192:195], a[128:131], v[136:139]
 v_mul_f32 v6, v6, v90
 v_mul_f32 v5, v5, v91
 s_waitcnt vmcnt(14)
 v_mfma_f32_16x16x32_bf16 v[168:171], a[200:203], a[128:131], v[168:171]
 v_cvt_pk_bf16_f32 v13, v6, v5
 v_accvgpr_read_b32 v5, a42
 v_mfma_f32_16x16x32_bf16 v[168:171], a[204:207], a[132:135], v[168:171]
 global_load_dwordx4 a[196:199], v0, s[70:71] offset:1024 sc1
 v_lshlrev_b32 v6, 16, v5
 v_mfma_f32_16x16x32_bf16 v[172:175], a[204:207], a[140:143], v[172:175]
 v_and_b32 v5, s26, v5
 v_mul_f32 v6, v6, v120
 v_mfma_f32_16x16x32_bf16 v[172:175], a[200:203], a[136:139], v[172:175]
 global_load_dwordx4 a[192:195], v0, s[70:71] offset:0 sc1
 v_mul_f32 v5, v5, v121
 v_mfma_f32_16x16x32_bf16 v[176:179], a[200:203], a[144:147], v[176:179]
 v_cvt_pk_bf16_f32 v14, v6, v5
 v_accvgpr_read_b32 v5, a43
 v_mfma_f32_16x16x32_bf16 v[176:179], a[204:207], a[148:151], v[176:179]
 v_lshlrev_b32 v6, 16, v5
 v_and_b32 v5, s26, v5
 v_mfma_f32_16x16x32_bf16 v[180:183], a[204:207], a[156:159], v[180:183]
 v_mul_f32 v6, v6, v122
 v_mul_f32 v5, v5, v123
 v_mfma_f32_16x16x32_bf16 v[180:183], a[200:203], a[152:155], v[180:183]
 v_cvt_pk_bf16_f32 v15, v6, v5
 v_mfma_f32_16x16x32_bf16 v[184:187], a[200:203], a[160:163], v[184:187]
 ds_write_b128 v3, v[12:15] offset:9216
 v_mfma_f32_16x16x32_bf16 v[184:187], a[204:207], a[164:167], v[184:187]
 buffer_store_dwordx4 v[12:15], v3, s[32:35], s68 offen offset:1024 sc1
 v_accvgpr_read_b32 v5, a12
 v_lshlrev_b32 v6, 16, v5
 v_and_b32 v5, s26, v5
 v_mfma_f32_16x16x32_bf16 v[188:191], a[204:207], a[172:175], v[188:191]
 v_mul_f32 v6, v6, v28
 v_mul_f32 v5, v5, v29
 v_mfma_f32_16x16x32_bf16 v[188:191], a[200:203], a[168:171], v[188:191]
 v_cvt_pk_bf16_f32 v8, v6, v5
 v_accvgpr_read_b32 v5, a13
 v_mfma_f32_16x16x32_bf16 v[192:195], a[200:203], a[176:179], v[192:195]
 v_lshlrev_b32 v6, 16, v5
 v_and_b32 v5, s26, v5
 v_mfma_f32_16x16x32_bf16 v[192:195], a[204:207], a[180:183], v[192:195]
 v_mul_f32 v6, v6, v30
 v_mul_f32 v5, v5, v31
 v_mfma_f32_16x16x32_bf16 v[196:199], a[204:207], a[188:191], v[196:199]
 v_cvt_pk_bf16_f32 v9, v6, v5
 v_accvgpr_read_b32 v5, a14
 v_mfma_f32_16x16x32_bf16 v[196:199], a[200:203], a[184:187], v[196:199]
 v_lshlrev_b32 v6, 16, v5
 v_and_b32 v5, s26, v5
 s_waitcnt vmcnt(14)
 v_mfma_f32_16x16x32_bf16 v[228:231], a[208:211], a[184:187], v[228:231]
 v_mul_f32 v6, v6, v60
 v_mul_f32 v5, v5, v61
 v_mfma_f32_16x16x32_bf16 v[228:231], a[212:215], a[188:191], v[228:231]
 global_load_dwordx4 a[204:207], v0, s[70:71] offset:3072 sc1
 v_cvt_pk_bf16_f32 v10, v6, v5
 v_mfma_f32_16x16x32_bf16 v[224:227], a[212:215], a[180:183], v[224:227]
 v_accvgpr_read_b32 v5, a15
 v_lshlrev_b32 v6, 16, v5
 v_mfma_f32_16x16x32_bf16 v[224:227], a[208:211], a[176:179], v[224:227]
 global_load_dwordx4 a[200:203], v0, s[70:71] offset:2048 sc1
 v_and_b32 v5, s26, v5
 v_mul_f32 v6, v6, v62
 v_mfma_f32_16x16x32_bf16 v[220:223], a[208:211], a[168:171], v[220:223]
 v_mul_f32 v5, v5, v63
 v_cvt_pk_bf16_f32 v11, v6, v5
 s_add_u32 s70, s70, 8192
 s_addc_u32 s71, s71, 0
 v_mfma_f32_16x16x32_bf16 v[220:223], a[212:215], a[172:175], v[220:223]
 ds_write_b128 v3, v[8:11] offset:12288
 v_mfma_f32_16x16x32_bf16 v[216:219], a[212:215], a[164:167], v[216:219]
 buffer_store_dwordx4 v[8:11], v3, s[32:35], s68 offen offset:2048 sc1
 v_accvgpr_read_b32 v5, a44
 v_lshlrev_b32 v6, 16, v5
 v_and_b32 v5, s26, v5
 v_mfma_f32_16x16x32_bf16 v[216:219], a[208:211], a[160:163], v[216:219]
 v_mul_f32 v6, v6, v92
 v_mul_f32 v5, v5, v93
 v_mfma_f32_16x16x32_bf16 v[212:215], a[208:211], a[152:155], v[212:215]
 v_cvt_pk_bf16_f32 v12, v6, v5
 v_accvgpr_read_b32 v5, a45
 v_mfma_f32_16x16x32_bf16 v[212:215], a[212:215], a[156:159], v[212:215]
 v_lshlrev_b32 v6, 16, v5
 v_and_b32 v5, s26, v5
 v_mfma_f32_16x16x32_bf16 v[208:211], a[212:215], a[148:151], v[208:211]
 v_mul_f32 v6, v6, v94
 v_mul_f32 v5, v5, v95
 v_mfma_f32_16x16x32_bf16 v[208:211], a[208:211], a[144:147], v[208:211]
 v_cvt_pk_bf16_f32 v13, v6, v5
 v_accvgpr_read_b32 v5, a46
 v_mfma_f32_16x16x32_bf16 v[204:207], a[208:211], a[136:139], v[204:207]
 v_lshlrev_b32 v6, 16, v5
 v_and_b32 v5, s26, v5
 v_mfma_f32_16x16x32_bf16 v[204:207], a[212:215], a[140:143], v[204:207]
 v_mul_f32 v6, v6, v124
 v_mul_f32 v5, v5, v125
 v_mfma_f32_16x16x32_bf16 v[200:203], a[212:215], a[132:135], v[200:203]
 v_cvt_pk_bf16_f32 v14, v6, v5
 v_accvgpr_read_b32 v5, a47
 v_mfma_f32_16x16x32_bf16 v[200:203], a[208:211], a[128:131], v[200:203]
 v_lshlrev_b32 v6, 16, v5
 v_and_b32 v5, s26, v5
 s_waitcnt vmcnt(14)
 v_mfma_f32_16x16x32_bf16 v[232:235], a[216:219], a[128:131], v[232:235]
 ds_read_b128 a[128:131], v1 offset:34816
 v_mul_f32 v6, v6, v126
 v_mfma_f32_16x16x32_bf16 v[232:235], a[220:223], a[132:135], v[232:235]
 global_load_dwordx4 a[212:215], v0, s[70:71] offset:-3072 sc1
 ds_read_b128 a[132:135], v1 offset:35840
 v_mfma_f32_16x16x32_bf16 v[236:239], a[220:223], a[140:143], v[236:239]
 ds_read_b128 a[140:143], v1 offset:39936
 v_mul_f32 v5, v5, v127
 v_mfma_f32_16x16x32_bf16 v[236:239], a[216:219], a[136:139], v[236:239]
 global_load_dwordx4 a[208:211], v0, s[70:71] offset:-4096 sc1
 ds_read_b128 a[136:139], v1 offset:38912
 v_cvt_pk_bf16_f32 v15, v6, v5
 v_mfma_f32_16x16x32_bf16 v[240:243], a[216:219], a[144:147], v[240:243]
 ds_read_b128 a[144:147], v1 offset:43008
 ds_write_b128 v3, v[12:15] offset:13312
 v_mfma_f32_16x16x32_bf16 v[240:243], a[220:223], a[148:151], v[240:243]
 buffer_store_dwordx4 v[12:15], v3, s[32:35], s68 offen offset:3072 sc1
 ds_read_b128 a[148:151], v1 offset:44032
 v_accvgpr_read_b32 v5, a16
 v_lshlrev_b32 v6, 16, v5
 v_mfma_f32_16x16x32_bf16 v[244:247], a[220:223], a[156:159], v[244:247]
 ds_read_b128 a[156:159], v1 offset:48128
 v_and_b32 v5, s26, v5
 v_mul_f32 v6, v6, v32
 v_mfma_f32_16x16x32_bf16 v[244:247], a[216:219], a[152:155], v[244:247]
 ds_read_b128 a[152:155], v1 offset:47104
 v_mul_f32 v5, v5, v33
 v_mfma_f32_16x16x32_bf16 v[248:251], a[216:219], a[160:163], v[248:251]
 ds_read_b128 a[160:163], v1 offset:51200
 v_cvt_pk_bf16_f32 v8, v6, v5
 v_accvgpr_read_b32 v5, a17
 v_mfma_f32_16x16x32_bf16 v[248:251], a[220:223], a[164:167], v[248:251]
 ds_read_b128 a[164:167], v1 offset:52224
 v_lshlrev_b32 v6, 16, v5
 v_and_b32 v5, s26, v5
 v_mfma_f32_16x16x32_bf16 v[252:255], a[220:223], a[172:175], v[252:255]
 ds_read_b128 a[172:175], v1 offset:56320
 v_mul_f32 v6, v6, v34
 v_mul_f32 v5, v5, v35
 v_mfma_f32_16x16x32_bf16 v[252:255], a[216:219], a[168:171], v[252:255]
 ds_read_b128 a[168:171], v1 offset:55296
 v_cvt_pk_bf16_f32 v9, v6, v5
 v_mfma_f32_16x16x32_bf16 a[248:251], a[216:219], a[176:179], a[248:251]
 ds_read_b128 a[176:179], v1 offset:59392
 v_accvgpr_read_b32 v5, a18
 v_mfma_f32_16x16x32_bf16 a[248:251], a[220:223], a[180:183], a[248:251]
 ds_read_b128 a[180:183], v1 offset:60416
 v_lshlrev_b32 v6, 16, v5
 v_mfma_f32_16x16x32_bf16 a[252:255], a[220:223], a[188:191], a[252:255]
 ds_read_b128 a[188:191], v1 offset:64512
 v_and_b32 v5, s26, v5
 v_mfma_f32_16x16x32_bf16 a[252:255], a[216:219], a[184:187], a[252:255]
 ds_read_b128 a[184:187], v1 offset:63488
 v_mul_f32 v6, v6, v64
 s_waitcnt vmcnt(14) lgkmcnt(8)
 v_mfma_f32_16x16x32_bf16 v[136:139], a[224:227], a[128:131], v[136:139]
 v_mul_f32 v5, v5, v65
 v_cvt_pk_bf16_f32 v10, v6, v5
 v_mfma_f32_16x16x32_bf16 v[136:139], a[228:231], a[132:135], v[136:139]
 global_load_dwordx4 a[220:223], v0, s[70:71] offset:-1024 sc1
 v_accvgpr_read_b32 v5, a19
 v_mfma_f32_16x16x32_bf16 v[140:143], a[228:231], a[140:143], v[140:143]
 v_lshlrev_b32 v6, 16, v5
 v_and_b32 v5, s26, v5
 v_mfma_f32_16x16x32_bf16 v[140:143], a[224:227], a[136:139], v[140:143]
 global_load_dwordx4 a[216:219], v0, s[70:71] offset:-2048 sc1
 v_mul_f32 v6, v6, v66
 v_mfma_f32_16x16x32_bf16 v[144:147], a[224:227], a[144:147], v[144:147]
 v_mul_f32 v5, v5, v67
 v_cvt_pk_bf16_f32 v11, v6, v5
 v_mfma_f32_16x16x32_bf16 v[144:147], a[228:231], a[148:151], v[144:147]
 ds_write_b128 v3, v[8:11] offset:16384
 s_add_u32 s68, s29, 8192
 v_mfma_f32_16x16x32_bf16 v[148:151], a[228:231], a[156:159], v[148:151]
 buffer_store_dwordx4 v[8:11], v3, s[32:35], s68 offen sc1
 v_accvgpr_read_b32 v5, a48
 v_lshlrev_b32 v6, 16, v5
 v_and_b32 v5, s26, v5
 v_mfma_f32_16x16x32_bf16 v[148:151], a[224:227], a[152:155], v[148:151]
 v_mul_f32 v6, v6, v96
 v_mul_f32 v5, v5, v97
 s_waitcnt lgkmcnt(1)
 v_mfma_f32_16x16x32_bf16 v[152:155], a[224:227], a[160:163], v[152:155]
 v_cvt_pk_bf16_f32 v12, v6, v5
 v_accvgpr_read_b32 v5, a49
 v_mfma_f32_16x16x32_bf16 v[152:155], a[228:231], a[164:167], v[152:155]
 v_lshlrev_b32 v6, 16, v5
 v_and_b32 v5, s26, v5
 v_mfma_f32_16x16x32_bf16 v[156:159], a[228:231], a[172:175], v[156:159]
 v_mul_f32 v6, v6, v98
 v_mul_f32 v5, v5, v99
 v_mfma_f32_16x16x32_bf16 v[156:159], a[224:227], a[168:171], v[156:159]
 v_cvt_pk_bf16_f32 v13, v6, v5
 v_accvgpr_read_b32 v5, a50
 v_mfma_f32_16x16x32_bf16 v[160:163], a[224:227], a[176:179], v[160:163]
 v_lshlrev_b32 v6, 16, v5
 v_and_b32 v5, s26, v5
 v_mfma_f32_16x16x32_bf16 v[160:163], a[228:231], a[180:183], v[160:163]
 v_mul_f32 v6, v6, v128
 v_mul_f32 v5, v5, v129
 v_mfma_f32_16x16x32_bf16 v[164:167], a[228:231], a[188:191], v[164:167]
 v_cvt_pk_bf16_f32 v14, v6, v5
 v_accvgpr_read_b32 v5, a51
 v_mfma_f32_16x16x32_bf16 v[164:167], a[224:227], a[184:187], v[164:167]
 v_lshlrev_b32 v6, 16, v5
 v_and_b32 v5, s26, v5
 s_waitcnt vmcnt(14)
 v_mfma_f32_16x16x32_bf16 v[196:199], a[232:235], a[184:187], v[196:199]
 v_mul_f32 v6, v6, v130
 v_mul_f32 v5, v5, v131
 v_mfma_f32_16x16x32_bf16 v[196:199], a[236:239], a[188:191], v[196:199]
 global_load_dwordx4 a[228:231], v0, s[70:71] offset:1024 sc1
 v_cvt_pk_bf16_f32 v15, v6, v5
 v_mfma_f32_16x16x32_bf16 v[192:195], a[236:239], a[180:183], v[192:195]
 ds_write_b128 v3, v[12:15] offset:17408
 v_mfma_f32_16x16x32_bf16 v[192:195], a[232:235], a[176:179], v[192:195]
 global_load_dwordx4 a[224:227], v0, s[70:71] offset:0 sc1
 v_mfma_f32_16x16x32_bf16 v[188:191], a[232:235], a[168:171], v[188:191]
 buffer_store_dwordx4 v[12:15], v3, s[32:35], s68 offen offset:1024 sc1
 v_accvgpr_read_b32 v5, a20
 v_lshlrev_b32 v6, 16, v5
 v_and_b32 v5, s26, v5
 v_mul_f32 v6, v6, v36
 v_mfma_f32_16x16x32_bf16 v[188:191], a[236:239], a[172:175], v[188:191]
 v_mul_f32 v5, v5, v37
 v_cvt_pk_bf16_f32 v8, v6, v5
 v_mfma_f32_16x16x32_bf16 v[184:187], a[236:239], a[164:167], v[184:187]
 v_accvgpr_read_b32 v5, a21
 v_lshlrev_b32 v6, 16, v5
 v_mfma_f32_16x16x32_bf16 v[184:187], a[232:235], a[160:163], v[184:187]
 v_and_b32 v5, s26, v5
 v_mul_f32 v6, v6, v38
 v_mfma_f32_16x16x32_bf16 v[180:183], a[232:235], a[152:155], v[180:183]
 v_mul_f32 v5, v5, v39
 v_cvt_pk_bf16_f32 v9, v6, v5
 v_mfma_f32_16x16x32_bf16 v[180:183], a[236:239], a[156:159], v[180:183]
 v_accvgpr_read_b32 v5, a22
 v_lshlrev_b32 v6, 16, v5
 v_mfma_f32_16x16x32_bf16 v[176:179], a[236:239], a[148:151], v[176:179]
 v_and_b32 v5, s26, v5
 v_mul_f32 v6, v6, v68
 v_mfma_f32_16x16x32_bf16 v[176:179], a[232:235], a[144:147], v[176:179]
 v_mul_f32 v5, v5, v69
 v_cvt_pk_bf16_f32 v10, v6, v5
 v_mfma_f32_16x16x32_bf16 v[172:175], a[232:235], a[136:139], v[172:175]
 v_accvgpr_read_b32 v5, a23
 v_lshlrev_b32 v6, 16, v5
 v_mfma_f32_16x16x32_bf16 v[172:175], a[236:239], a[140:143], v[172:175]
 v_and_b32 v5, s26, v5
 v_mul_f32 v6, v6, v70
 v_mfma_f32_16x16x32_bf16 v[168:171], a[236:239], a[132:135], v[168:171]
 v_mul_f32 v5, v5, v71
 v_cvt_pk_bf16_f32 v11, v6, v5
 v_mfma_f32_16x16x32_bf16 v[168:171], a[232:235], a[128:131], v[168:171]
 ds_write_b128 v3, v[8:11] offset:20480
 buffer_store_dwordx4 v[8:11], v3, s[32:35], s68 offen offset:2048 sc1
 v_accvgpr_read_b32 v5, a52
 v_lshlrev_b32 v6, 16, v5
 v_and_b32 v5, s26, v5
 s_waitcnt vmcnt(14)
 v_mfma_f32_16x16x32_bf16 v[200:203], a[192:195], a[128:131], v[200:203]
 v_mul_f32 v6, v6, v100
 v_mul_f32 v5, v5, v101
 v_mfma_f32_16x16x32_bf16 v[200:203], a[196:199], a[132:135], v[200:203]
 global_load_dwordx4 a[236:239], v0, s[70:71] offset:3072 sc1
 v_cvt_pk_bf16_f32 v12, v6, v5
 v_mfma_f32_16x16x32_bf16 v[204:207], a[196:199], a[140:143], v[204:207]
 v_accvgpr_read_b32 v5, a53
 v_cmp_gt_i32 vcc, s27, v4
 s_and_b64 vcc, exec, vcc
 s_cbranch_vccnz Lspin_w
Lok_w:
 s_add_u32 s27, s27, 64
 v_mfma_f32_16x16x32_bf16 v[204:207], a[192:195], a[136:139], v[204:207]
 global_load_dwordx4 a[232:235], v0, s[70:71] offset:2048 sc1
 v_lshlrev_b32 v6, 16, v5
 v_mfma_f32_16x16x32_bf16 v[208:211], a[192:195], a[144:147], v[208:211]
 v_and_b32 v5, s26, v5
 v_mul_f32 v6, v6, v102
 s_add_u32 s70, s70, 1843200
 s_addc_u32 s71, s71, 0
 v_mfma_f32_16x16x32_bf16 v[208:211], a[196:199], a[148:151], v[208:211]
 v_mul_f32 v5, v5, v103
 v_cvt_pk_bf16_f32 v13, v6, v5
 v_mfma_f32_16x16x32_bf16 v[212:215], a[196:199], a[156:159], v[212:215]
 v_accvgpr_read_b32 v5, a54
 v_lshlrev_b32 v6, 16, v5
 v_mfma_f32_16x16x32_bf16 v[212:215], a[192:195], a[152:155], v[212:215]
 v_and_b32 v5, s26, v5
 v_mul_f32 v6, v6, v132
 v_mfma_f32_16x16x32_bf16 v[216:219], a[192:195], a[160:163], v[216:219]
 v_mul_f32 v5, v5, v133
 v_cvt_pk_bf16_f32 v14, v6, v5
 v_mfma_f32_16x16x32_bf16 v[216:219], a[196:199], a[164:167], v[216:219]
 v_accvgpr_read_b32 v5, a55
 v_lshlrev_b32 v6, 16, v5
 v_mfma_f32_16x16x32_bf16 v[220:223], a[196:199], a[172:175], v[220:223]
 v_and_b32 v5, s26, v5
 v_mul_f32 v6, v6, v134
 v_mfma_f32_16x16x32_bf16 v[220:223], a[192:195], a[168:171], v[220:223]
 v_mul_f32 v5, v5, v135
 v_cvt_pk_bf16_f32 v15, v6, v5
 v_mfma_f32_16x16x32_bf16 v[224:227], a[192:195], a[176:179], v[224:227]
 ds_write_b128 v3, v[12:15] offset:21504
 v_mfma_f32_16x16x32_bf16 v[224:227], a[196:199], a[180:183], v[224:227]
 buffer_store_dwordx4 v[12:15], v3, s[32:35], s68 offen offset:3072 sc1
 v_accvgpr_read_b32 v5, a24
 v_lshlrev_b32 v6, 16, v5
 v_and_b32 v5, s26, v5
 v_mfma_f32_16x16x32_bf16 v[228:231], a[196:199], a[188:191], v[228:231]
 v_mul_f32 v6, v6, v40
 v_mul_f32 v5, v5, v41
 v_mfma_f32_16x16x32_bf16 v[228:231], a[192:195], a[184:187], v[228:231]
 v_cvt_pk_bf16_f32 v8, v6, v5
 v_accvgpr_read_b32 v5, a25
 s_waitcnt vmcnt(14)
 v_mfma_f32_16x16x32_bf16 a[252:255], a[200:203], a[184:187], a[252:255]
 ds_read_b128 a[184:187], v1 offset:30720
 v_lshlrev_b32 v6, 16, v5
 v_mfma_f32_16x16x32_bf16 a[252:255], a[204:207], a[188:191], a[252:255]
 global_load_dwordx4 a[196:199], v0, s[70:71] offset:-3072 sc1
 ds_read_b128 a[188:191], v1 offset:31744
 v_mfma_f32_16x16x32_bf16 a[248:251], a[204:207], a[180:183], a[248:251]
 ds_read_b128 a[180:183], v1 offset:27648
 v_and_b32 v5, s26, v5
 v_mfma_f32_16x16x32_bf16 a[248:251], a[200:203], a[176:179], a[248:251]
 global_load_dwordx4 a[192:195], v0, s[70:71] offset:-4096 sc1
 ds_read_b128 a[176:179], v1 offset:26624
 v_mul_f32 v6, v6, v42
 v_mfma_f32_16x16x32_bf16 v[252:255], a[200:203], a[168:171], v[252:255]
 ds_read_b128 a[168:171], v1 offset:22528
 v_mul_f32 v5, v5, v43
 v_cvt_pk_bf16_f32 v9, v6, v5
 v_mfma_f32_16x16x32_bf16 v[252:255], a[204:207], a[172:175], v[252:255]
 ds_read_b128 a[172:175], v1 offset:23552
 v_accvgpr_read_b32 v5, a26
 v_mfma_f32_16x16x32_bf16 v[248:251], a[204:207], a[164:167], v[248:251]
 ds_read_b128 a[164:167], v1 offset:19456
 v_lshlrev_b32 v6, 16, v5
 v_and_b32 v5, s26, v5
 v_mfma_f32_16x16x32_bf16 v[248:251], a[200:203], a[160:163], v[248:251]
 ds_read_b128 a[160:163], v1 offset:18432
 v_mul_f32 v6, v6, v72
 v_mfma_f32_16x16x32_bf16 v[244:247], a[200:203], a[152:155], v[244:247]
 ds_read_b128 a[152:155], v1 offset:14336
 v_mul_f32 v5, v5, v73
 v_mfma_f32_16x16x32_bf16 v[244:247], a[204:207], a[156:159], v[244:247]
 ds_read_b128 a[156:159], v1 offset:15360
 v_cvt_pk_bf16_f32 v10, v6, v5
 v_mfma_f32_16x16x32_bf16 v[240:243], a[204:207], a[148:151], v[240:243]
 ds_read_b128 a[148:151], v1 offset:11264
 v_accvgpr_read_b32 v5, a27
 v_mfma_f32_16x16x32_bf16 v[240:243], a[200:203], a[144:147], v[240:243]
 ds_read_b128 a[144:147], v1 offset:10240
 v_lshlrev_b32 v6, 16, v5
 v_mfma_f32_16x16x32_bf16 v[236:239], a[200:203], a[136:139], v[236:239]
 ds_read_b128 a[136:139], v1 offset:6144
 v_and_b32 v5, s26, v5
 v_mfma_f32_16x16x32_bf16 v[236:239], a[204:207], a[140:143], v[236:239]
 ds_read_b128 a[140:143], v1 offset:7168
 v_mul_f32 v6, v6, v74
 v_mfma_f32_16x16x32_bf16 v[232:235], a[204:207], a[132:135], v[232:235]
 ds_read_b128 a[132:135], v1 offset:3072
 v_mul_f32 v5, v5, v75
 v_mfma_f32_16x16x32_bf16 v[232:235], a[200:203], a[128:131], v[232:235]
 ds_read_b128 a[128:131], v1 offset:2048
 v_cvt_pk_bf16_f32 v11, v6, v5
 s_waitcnt vmcnt(13) lgkmcnt(8)
 v_mfma_f32_16x16x32_bf16 v[164:167], a[208:211], a[184:187], v[164:167]
 ds_write_b128 v3, v[8:11] offset:24576
 v_accvgpr_read_b32 v5, a56
 v_lshlrev_b32 v6, 16, v5
 v_and_b32 v5, s26, v5
 v_mul_f32 v6, v6, v104
 v_mul_f32 v5, v5, v105
 v_cvt_pk_bf16_f32 v12, v6, v5
 v_mfma_f32_16x16x32_bf16 v[164:167], a[212:215], a[188:191], v[164:167]
 global_load_dwordx4 a[204:207], v0, s[70:71] offset:-1024 sc1
 v_accvgpr_read_b32 v5, a57
 v_lshlrev_b32 v6, 16, v5
 v_and_b32 v5, s26, v5
 v_mfma_f32_16x16x32_bf16 v[160:163], a[212:215], a[180:183], v[160:163]
 v_mul_f32 v6, v6, v106
 v_mul_f32 v5, v5, v107
 v_mfma_f32_16x16x32_bf16 v[160:163], a[208:211], a[176:179], v[160:163]
 global_load_dwordx4 a[200:203], v0, s[70:71] offset:-2048 sc1
 v_cvt_pk_bf16_f32 v13, v6, v5
 v_mfma_f32_16x16x32_bf16 v[156:159], a[208:211], a[168:171], v[156:159]
 v_accvgpr_read_b32 v5, a58
 v_accvgpr_read_b32 v7, a240
 v_mfma_f32_16x16x32_bf16 v[156:159], a[212:215], a[172:175], v[156:159]
 v_lshlrev_b32 v6, 16, v5
 v_and_b32 v5, s26, v5
 v_mfma_f32_16x16x32_bf16 v[152:155], a[212:215], a[164:167], v[152:155]
 v_mul_f32 v6, v6, v7
 v_accvgpr_read_b32 v7, a241
 v_mfma_f32_16x16x32_bf16 v[152:155], a[208:211], a[160:163], v[152:155]
 v_mul_f32 v5, v5, v7
 v_cvt_pk_bf16_f32 v14, v6, v5
 s_waitcnt lgkmcnt(1)
 v_mfma_f32_16x16x32_bf16 v[148:151], a[208:211], a[152:155], v[148:151]
 v_accvgpr_read_b32 v5, a59
 v_accvgpr_read_b32 v7, a242
 v_mfma_f32_16x16x32_bf16 v[148:151], a[212:215], a[156:159], v[148:151]
 v_lshlrev_b32 v6, 16, v5
 v_and_b32 v5, s26, v5
 v_mfma_f32_16x16x32_bf16 v[144:147], a[212:215], a[148:151], v[144:147]
 v_mul_f32 v6, v6, v7
 v_accvgpr_read_b32 v7, a243
 v_mfma_f32_16x16x32_bf16 v[144:147], a[208:211], a[144:147], v[144:147]
 v_mul_f32 v5, v5, v7
 v_cvt_pk_bf16_f32 v15, v6, v5
 v_mfma_f32_16x16x32_bf16 v[140:143], a[208:211], a[136:139], v[140:143]
 ds_write_b128 v3, v[12:15] offset:25600
 v_accvgpr_read_b32 v5, a28
 v_mfma_f32_16x16x32_bf16 v[140:143], a[212:215], a[140:143], v[140:143]
 v_lshlrev_b32 v6, 16, v5
 v_and_b32 v5, s26, v5
 v_mfma_f32_16x16x32_bf16 v[136:139], a[212:215], a[132:135], v[136:139]
 v_mul_f32 v6, v6, v44
 v_mul_f32 v5, v5, v45
 v_mfma_f32_16x16x32_bf16 v[136:139], a[208:211], a[128:131], v[136:139]
 v_cvt_pk_bf16_f32 v8, v6, v5
 v_accvgpr_read_b32 v5, a29
 s_waitcnt vmcnt(12)
 v_mfma_f32_16x16x32_bf16 v[168:171], a[216:219], a[128:131], v[168:171]
 v_lshlrev_b32 v6, 16, v5
 v_and_b32 v5, s26, v5
 v_mfma_f32_16x16x32_bf16 v[168:171], a[220:223], a[132:135], v[168:171]
 global_load_dwordx4 a[212:215], v0, s[70:71] offset:1024 sc1
 v_mul_f32 v6, v6, v46
 v_mfma_f32_16x16x32_bf16 v[172:175], a[220:223], a[140:143], v[172:175]
 v_mul_f32 v5, v5, v47
 v_cvt_pk_bf16_f32 v9, v6, v5
 v_mfma_f32_16x16x32_bf16 v[172:175], a[216:219], a[136:139], v[172:175]
 global_load_dwordx4 a[208:211], v0, s[70:71] offset:0 sc1
 v_accvgpr_read_b32 v5, a30
 v_lshlrev_b32 v6, 16, v5
 v_mfma_f32_16x16x32_bf16 v[176:179], a[216:219], a[144:147], v[176:179]
 v_and_b32 v5, s26, v5
 v_mul_f32 v6, v6, v76
 v_mfma_f32_16x16x32_bf16 v[176:179], a[220:223], a[148:151], v[176:179]
 v_mul_f32 v5, v5, v77
 v_cvt_pk_bf16_f32 v10, v6, v5
 v_mfma_f32_16x16x32_bf16 v[180:183], a[220:223], a[156:159], v[180:183]
 v_accvgpr_read_b32 v5, a31
 v_lshlrev_b32 v6, 16, v5
 v_mfma_f32_16x16x32_bf16 v[180:183], a[216:219], a[152:155], v[180:183]
 v_and_b32 v5, s26, v5
 v_mul_f32 v6, v6, v78
 v_mfma_f32_16x16x32_bf16 v[184:187], a[216:219], a[160:163], v[184:187]
 v_mul_f32 v5, v5, v79
 v_cvt_pk_bf16_f32 v11, v6, v5
 v_mfma_f32_16x16x32_bf16 v[184:187], a[220:223], a[164:167], v[184:187]
 ds_write_b128 v3, v[8:11] offset:28672
 v_mfma_f32_16x16x32_bf16 v[188:191], a[220:223], a[172:175], v[188:191]
 v_accvgpr_read_b32 v5, a60
 v_lshlrev_b32 v6, 16, v5
 v_mfma_f32_16x16x32_bf16 v[188:191], a[216:219], a[168:171], v[188:191]
 v_and_b32 v5, s26, v5
 v_mul_f32 v6, v6, v108
 v_mfma_f32_16x16x32_bf16 v[192:195], a[216:219], a[176:179], v[192:195]
 v_mul_f32 v5, v5, v109
 v_cvt_pk_bf16_f32 v12, v6, v5
 v_mfma_f32_16x16x32_bf16 v[192:195], a[220:223], a[180:183], v[192:195]
 v_accvgpr_read_b32 v5, a61
 v_lshlrev_b32 v6, 16, v5
 v_mfma_f32_16x16x32_bf16 v[196:199], a[220:223], a[188:191], v[196:199]
 v_and_b32 v5, s26, v5
 v_mul_f32 v6, v6, v110
 v_mfma_f32_16x16x32_bf16 v[196:199], a[216:219], a[184:187], v[196:199]
 v_mul_f32 v5, v5, v111
 v_cvt_pk_bf16_f32 v13, v6, v5
 s_waitcnt vmcnt(11)
 v_mfma_f32_16x16x32_bf16 v[228:231], a[224:227], a[184:187], v[228:231]
 v_accvgpr_read_b32 v5, a62
 v_accvgpr_read_b32 v7, a244
 v_mfma_f32_16x16x32_bf16 v[228:231], a[228:231], a[188:191], v[228:231]
 global_load_dwordx4 a[220:223], v0, s[70:71] offset:3072 sc1
 v_lshlrev_b32 v6, 16, v5
 v_mfma_f32_16x16x32_bf16 v[224:227], a[228:231], a[180:183], v[224:227]
 v_and_b32 v5, s26, v5
 v_mul_f32 v6, v6, v7
 v_mfma_f32_16x16x32_bf16 v[224:227], a[224:227], a[176:179], v[224:227]
 global_load_dwordx4 a[216:219], v0, s[70:71] offset:2048 sc1
 v_accvgpr_read_b32 v7, a245
 v_mfma_f32_16x16x32_bf16 v[220:223], a[224:227], a[168:171], v[220:223]
 v_mul_f32 v5, v5, v7
 v_cvt_pk_bf16_f32 v14, v6, v5
 s_add_u32 s70, s70, 8192
 s_addc_u32 s71, s71, 0
 v_mfma_f32_16x16x32_bf16 v[220:223], a[228:231], a[172:175], v[220:223]
 v_accvgpr_read_b32 v5, a63
 v_accvgpr_read_b32 v7, a246
 v_mfma_f32_16x16x32_bf16 v[216:219], a[228:231], a[164:167], v[216:219]
 v_lshlrev_b32 v6, 16, v5
 v_and_b32 v5, s26, v5
 v_mfma_f32_16x16x32_bf16 v[216:219], a[224:227], a[160:163], v[216:219]
 v_mul_f32 v6, v6, v7
 v_accvgpr_read_b32 v7, a247
 v_mfma_f32_16x16x32_bf16 v[212:215], a[224:227], a[152:155], v[212:215]
 v_mul_f32 v5, v5, v7
 v_cvt_pk_bf16_f32 v15, v6, v5
 v_mfma_f32_16x16x32_bf16 v[212:215], a[228:231], a[156:159], v[212:215]
 ds_write_b128 v3, v[12:15] offset:29696
 v_mfma_f32_16x16x32_bf16 v[208:211], a[228:231], a[148:151], v[208:211]
 s_waitcnt lgkmcnt(0)
 s_barrier
 v_mfma_f32_16x16x32_bf16 v[208:211], a[224:227], a[144:147], v[208:211]
 v_and_b32 v1, 1023, v3
 v_add_u32 v2, 65536, v1
 v_mfma_f32_16x16x32_bf16 v[204:207], a[224:227], a[136:139], v[204:207]
 v_mfma_f32_16x16x32_bf16 v[204:207], a[228:231], a[140:143], v[204:207]
 v_mfma_f32_16x16x32_bf16 v[200:203], a[228:231], a[132:135], v[200:203]
 v_mfma_f32_16x16x32_bf16 v[200:203], a[224:227], a[128:131], v[200:203]
 s_waitcnt vmcnt(9)
 v_mfma_f32_16x16x32_bf16 v[232:235], a[232:235], a[128:131], v[232:235]
 ds_read_b128 a[128:131], v1
 v_mfma_f32_16x16x32_bf16 v[232:235], a[236:239], a[132:135], v[232:235]
 global_load_dwordx4 a[228:231], v0, s[70:71] offset:-3072 sc1
 ds_read_b128 a[132:135], v1 offset:1024
 v_mfma_f32_16x16x32_bf16 v[236:239], a[236:239], a[140:143], v[236:239]
 ds_read_b128 a[140:143], v1 offset:5120
 v_mfma_f32_16x16x32_bf16 v[236:239], a[232:235], a[136:139], v[236:239]
 global_load_dwordx4 a[224:227], v0, s[70:71] offset:-4096 sc1
 ds_read_b128 a[136:139], v1 offset:4096
 v_mfma_f32_16x16x32_bf16 v[240:243], a[232:235], a[144:147], v[240:243]
 ds_read_b128 a[144:147], v1 offset:8192
 v_mfma_f32_16x16x32_bf16 v[240:243], a[236:239], a[148:151], v[240:243]
 ds_read_b128 a[148:151], v1 offset:9216
 v_mfma_f32_16x16x32_bf16 v[244:247], a[236:239], a[156:159], v[244:247]
 ds_read_b128 a[156:159], v1 offset:13312
 v_mfma_f32_16x16x32_bf16 v[244:247], a[232:235], a[152:155], v[244:247]
 ds_read_b128 a[152:155], v1 offset:12288
 v_mfma_f32_16x16x32_bf16 v[248:251], a[232:235], a[160:163], v[248:251]
 ds_read_b128 a[160:163], v1 offset:16384
 v_mfma_f32_16x16x32_bf16 v[248:251], a[236:239], a[164:167], v[248:251]
 ds_read_b128 a[164:167], v1 offset:17408
 v_mfma_f32_16x16x32_bf16 v[252:255], a[236:239], a[172:175], v[252:255]
 ds_read_b128 a[172:175], v1 offset:21504
 v_mfma_f32_16x16x32_bf16 v[252:255], a[232:235], a[168:171], v[252:255]
 ds_read_b128 a[168:171], v1 offset:20480
 v_mfma_f32_16x16x32_bf16 a[248:251], a[232:235], a[176:179], a[248:251]
 ds_read_b128 a[176:179], v1 offset:24576
 v_mfma_f32_16x16x32_bf16 a[248:251], a[236:239], a[180:183], a[248:251]
 ds_read_b128 a[180:183], v1 offset:25600
 v_mfma_f32_16x16x32_bf16 a[252:255], a[236:239], a[188:191], a[252:255]
 global_load_dwordx4 a[236:239], v0, s[70:71] offset:-1024 sc1
 ds_read_b128 a[188:191], v1 offset:29696
 v_mfma_f32_16x16x32_bf16 a[252:255], a[232:235], a[184:187], a[252:255]
 global_load_dwordx4 a[232:235], v0, s[70:71] offset:-2048 sc1
 ds_read_b128 a[184:187], v1 offset:28672
 s_waitcnt vmcnt(10) lgkmcnt(8)
 v_mfma_f32_16x16x32_bf16 v[16:19], a[192:195], a[128:131], v[16:19]
 v_accvgpr_read_b32 v5, a64
 v_lshlrev_b32 v6, 16, v5
 v_mfma_f32_16x16x32_bf16 v[16:19], a[196:199], a[132:135], v[16:19]
 ds_read_b128 v[12:15], v3 offset:24576
 v_mfma_f32_16x16x32_bf16 v[20:23], a[196:199], a[140:143], v[20:23]
 v_and_b32 v5, s26, v5
 v_mul_f32 v6, v6, v136
 v_mfma_f32_16x16x32_bf16 v[20:23], a[192:195], a[136:139], v[20:23]
 v_mul_f32 v5, v5, v137
 v_cvt_pk_bf16_f32 v8, v6, v5
 v_mfma_f32_16x16x32_bf16 v[24:27], a[192:195], a[144:147], v[24:27]
 v_accvgpr_read_b32 v5, a65
 v_lshlrev_b32 v6, 16, v5
 v_mfma_f32_16x16x32_bf16 v[24:27], a[196:199], a[148:151], v[24:27]
 v_and_b32 v5, s26, v5
 v_mul_f32 v6, v6, v138
 v_mfma_f32_16x16x32_bf16 v[28:31], a[196:199], a[156:159], v[28:31]
 v_mul_f32 v5, v5, v139
 v_cvt_pk_bf16_f32 v9, v6, v5
 v_mfma_f32_16x16x32_bf16 v[28:31], a[192:195], a[152:155], v[28:31]
 v_accvgpr_read_b32 v5, a66
 v_lshlrev_b32 v6, 16, v5
 s_waitcnt lgkmcnt(1)
 v_mfma_f32_16x16x32_bf16 v[32:35], a[192:195], a[160:163], v[32:35]
 v_and_b32 v5, s26, v5
 v_mul_f32 v6, v6, v168
 v_mfma_f32_16x16x32_bf16 v[32:35], a[196:199], a[164:167], v[32:35]
 v_mul_f32 v5, v5, v169
 v_cvt_pk_bf16_f32 v10, v6, v5
 v_mfma_f32_16x16x32_bf16 v[36:39], a[196:199], a[172:175], v[36:39]
 v_accvgpr_read_b32 v5, a67
 v_lshlrev_b32 v6, 16, v5
 v_mfma_f32_16x16x32_bf16 v[36:39], a[192:195], a[168:171], v[36:39]
 v_and_b32 v5, s26, v5
 v_mul_f32 v6, v6, v170
 v_mfma_f32_16x16x32_bf16 v[40:43], a[192:195], a[176:179], v[40:43]
 v_mul_f32 v5, v5, v171
 v_cvt_pk_bf16_f32 v11, v6, v5
 v_mfma_f32_16x16x32_bf16 v[40:43], a[196:199], a[180:183], v[40:43]
 ds_write_b128 v3, v[8:11] offset:2048
 v_mfma_f32_16x16x32_bf16 v[44:47], a[196:199], a[188:191], v[44:47]
 s_add_u32 s68, s29, 16384
 buffer_store_dwordx4 v[8:11], v3, s[32:35], s68 offen sc1
 v_mfma_f32_16x16x32_bf16 v[44:47], a[192:195], a[184:187], v[44:47]
 s_waitcnt vmcnt(9)
 v_mfma_f32_16x16x32_bf16 v[76:79], a[200:203], a[184:187], v[76:79]
 v_accvgpr_read_b32 v5, a96
 v_lshlrev_b32 v6, 16, v5
 v_mfma_f32_16x16x32_bf16 v[76:79], a[204:207], a[188:191], v[76:79]
 global_load_dwordx4 a[196:199], v0, s[70:71] offset:1024 sc1
 v_and_b32 v5, s26, v5
 v_mfma_f32_16x16x32_bf16 v[72:75], a[204:207], a[180:183], v[72:75]
 v_mul_f32 v6, v6, v200
 v_mul_f32 v5, v5, v201
 v_mfma_f32_16x16x32_bf16 v[72:75], a[200:203], a[176:179], v[72:75]
 global_load_dwordx4 a[192:195], v0, s[70:71] offset:0 sc1
 v_cvt_pk_bf16_f32 v8, v6, v5
 v_mfma_f32_16x16x32_bf16 v[68:71], a[200:203], a[168:171], v[68:71]
 v_accvgpr_read_b32 v5, a97
 v_lshlrev_b32 v6, 16, v5
 v_mfma_f32_16x16x32_bf16 v[68:71], a[204:207], a[172:175], v[68:71]
 v_and_b32 v5, s26, v5
 v_mul_f32 v6, v6, v202
 v_mfma_f32_16x16x32_bf16 v[64:67], a[204:207], a[164:167], v[64:67]
 v_mul_f32 v5, v5, v203
 v_cvt_pk_bf16_f32 v9, v6, v5
 v_mfma_f32_16x16x32_bf16 v[64:67], a[200:203], a[160:163], v[64:67]
 v_accvgpr_read_b32 v5, a98
 v_lshlrev_b32 v6, 16, v5
 v_mfma_f32_16x16x32_bf16 v[60:63], a[200:203], a[152:155], v[60:63]
 v_and_b32 v5, s26, v5
 v_mul_f32 v6, v6, v232
 v_mfma_f32_16x16x32_bf16 v[60:63], a[204:207], a[156:159], v[60:63]
 v_mul_f32 v5, v5, v233
 v_cvt_pk_bf16_f32 v10, v6, v5
 v_mfma_f32_16x16x32_bf16 v[56:59], a[204:207], a[148:151], v[56:59]
 v_accvgpr_read_b32 v5, a99
 v_lshlrev_b32 v6, 16, v5
 v_mfma_f32_16x16x32_bf16 v[56:59], a[200:203], a[144:147], v[56:59]
 v_and_b32 v5, s26, v5
 v_mul_f32 v6, v6, v234
 s_waitcnt lgkmcnt(1)
 v_mfma_f32_16x16x32_bf16 v[52:55], a[200:203], a[136:139], v[52:55]
 v_mul_f32 v5, v5, v235
 v_cvt_pk_bf16_f32 v11, v6, v5
 v_mfma_f32_16x16x32_bf16 v[52:55], a[204:207], a[140:143], v[52:55]
 ds_write_b128 v3, v[8:11] offset:3072
 v_mfma_f32_16x16x32_bf16 v[48:51], a[204:207], a[132:135], v[48:51]
 buffer_store_dwordx4 v[8:11], v3, s[32:35], s68 offen offset:1024 sc1
 v_accvgpr_read_b32 v5, a68
 v_mfma_f32_16x16x32_bf16 v[48:51], a[200:203], a[128:131], v[48:51]
 v_lshlrev_b32 v6, 16, v5
 v_and_b32 v5, s26, v5
 s_add_u32 s69, s29, 12288
 s_waitcnt vmcnt(10)
 v_mfma_f32_16x16x32_bf16 v[80:83], a[208:211], a[128:131], v[80:83]
 v_mul_f32 v6, v6, v140
 v_mul_f32 v5, v5, v141
 v_mfma_f32_16x16x32_bf16 v[80:83], a[212:215], a[132:135], v[80:83]
 global_load_dwordx4 a[204:207], v0, s[70:71] offset:3072 sc1
 v_cvt_pk_bf16_f32 v8, v6, v5
 v_mfma_f32_16x16x32_bf16 v[84:87], a[212:215], a[140:143], v[84:87]
 v_accvgpr_read_b32 v5, a69
 v_lshlrev_b32 v6, 16, v5
 v_mfma_f32_16x16x32_bf16 v[84:87], a[208:211], a[136:139], v[84:87]
 global_load_dwordx4 a[200:203], v0, s[70:71] offset:2048 sc1
 v_and_b32 v5, s26, v5
 v_mfma_f32_16x16x32_bf16 v[88:91], a[208:211], a[144:147], v[88:91]
 buffer_store_dwordx4 v[12:15], v3, s[32:35], s69 offen sc1
 s_add_u32 s70, s70, 8192
 s_addc_u32 s71, s71, 0
 v_mfma_f32_16x16x32_bf16 v[88:91], a[212:215], a[148:151], v[88:91]
 v_mul_f32 v6, v6, v142
 v_mul_f32 v5, v5, v143
 v_mfma_f32_16x16x32_bf16 v[92:95], a[212:215], a[156:159], v[92:95]
 v_cvt_pk_bf16_f32 v9, v6, v5
 v_accvgpr_read_b32 v5, a70
 v_mfma_f32_16x16x32_bf16 v[92:95], a[208:211], a[152:155], v[92:95]
 v_lshlrev_b32 v6, 16, v5
 v_and_b32 v5, s26, v5
 v_mfma_f32_16x16x32_bf16 v[96:99], a[208:211], a[160:163], v[96:99]
 v_mul_f32 v6, v6, v172
 v_mul_f32 v5, v5, v173
 v_mfma_f32_16x16x32_bf16 v[96:99], a[212:215], a[164:167], v[96:99]
 v_cvt_pk_bf16_f32 v10, v6, v5
 v_accvgpr_read_b32 v5, a71
 v_mfma_f32_16x16x32_bf16 v[100:103], a[212:215], a[172:175], v[100:103]
 v_lshlrev_b32 v6, 16, v5
 v_and_b32 v5, s26, v5
 v_mfma_f32_16x16x32_bf16 v[100:103], a[208:211], a[168:171], v[100:103]
 v_mul_f32 v6, v6, v174
 v_mul_f32 v5, v5, v175
 v_cvt_pk_bf16_f32 v11, v6, v5
 v_mfma_f32_16x16x32_bf16 v[104:107], a[208:211], a[176:179], v[104:107]
 ds_read_b128 v[12:15], v3 offset:25600
 v_mfma_f32_16x16x32_bf16 v[104:107], a[212:215], a[180:183], v[104:107]
 ds_write_b128 v3, v[8:11] offset:6144
 v_mfma_f32_16x16x32_bf16 v[108:111], a[212:215], a[188:191], v[108:111]
 buffer_store_dwordx4 v[8:11], v3, s[32:35], s68 offen offset:2048 sc1
 v_accvgpr_read_b32 v5, a100
 v_lshlrev_b32 v6, 16, v5
 v_and_b32 v5, s26, v5
 v_mfma_f32_16x16x32_bf16 v[108:111], a[208:211], a[184:187], v[108:111]
 v_mul_f32 v6, v6, v204
 v_mul_f32 v5, v5, v205
 s_waitcnt vmcnt(12)
 v_mfma_f32_16x16x32_bf16 a[244:247], a[216:219], a[184:187], a[244:247]
 ds_read_b128 a[184:187], v1 offset:61440
 v_cvt_pk_bf16_f32 v8, v6, v5
 v_mfma_f32_16x16x32_bf16 a[244:247], a[220:223], a[188:191], a[244:247]
 global_load_dwordx4 a[212:215], v0, s[70:71] offset:-3072 sc1
 ds_read_b128 a[188:191], v1 offset:62464
 v_mfma_f32_16x16x32_bf16 a[240:243], a[220:223], a[180:183], a[240:243]
 ds_read_b128 a[180:183], v1 offset:58368
 v_accvgpr_read_b32 v5, a101
 v_mfma_f32_16x16x32_bf16 a[240:243], a[216:219], a[176:179], a[240:243]
 global_load_dwordx4 a[208:211], v0, s[70:71] offset:-4096 sc1
 ds_read_b128 a[176:179], v1 offset:57344
 v_mfma_f32_16x16x32_bf16 v[132:135], a[216:219], a[168:171], v[132:135]
 ds_read_b128 a[168:171], v1 offset:53248
 v_lshlrev_b32 v6, 16, v5
 v_mfma_f32_16x16x32_bf16 v[132:135], a[220:223], a[172:175], v[132:135]
 ds_read_b128 a[172:175], v1 offset:54272
 v_and_b32 v5, s26, v5
 v_mfma_f32_16x16x32_bf16 v[128:131], a[220:223], a[164:167], v[128:131]
 ds_read_b128 a[164:167], v1 offset:50176
 v_mul_f32 v6, v6, v206
 v_mfma_f32_16x16x32_bf16 v[128:131], a[216:219], a[160:163], v[128:131]
 ds_read_b128 a[160:163], v1 offset:49152
 v_mul_f32 v5, v5, v207
 v_cvt_pk_bf16_f32 v9, v6, v5
 v_mfma_f32_16x16x32_bf16 v[124:127], a[216:219], a[152:155], v[124:127]
 ds_read_b128 a[152:155], v1 offset:45056
 v_accvgpr_read_b32 v5, a102
 v_mfma_f32_16x16x32_bf16 v[124:127], a[220:223], a[156:159], v[124:127]
 ds_read_b128 a[156:159], v1 offset:46080
 v_lshlrev_b32 v6, 16, v5
 v_and_b32 v5, s26, v5
 v_mfma_f32_16x16x32_bf16 v[120:123], a[220:223], a[148:151], v[120:123]
 ds_read_b128 a[148:151], v1 offset:41984
 v_mul_f32 v6, v6, v236
 v_mfma_f32_16x16x32_bf16 v[120:123], a[216:219], a[144:147], v[120:123]
 ds_read_b128 a[144:147], v1 offset:40960
 v_mul_f32 v5, v5, v237
 v_mfma_f32_16x16x32_bf16 v[116:119], a[216:219], a[136:139], v[116:119]
 ds_read_b128 a[136:139], v1 offset:36864
 v_cvt_pk_bf16_f32 v10, v6, v5
 v_mfma_f32_16x16x32_bf16 v[116:119], a[220:223], a[140:143], v[116:119]
 ds_read_b128 a[140:143], v1 offset:37888
 v_accvgpr_read_b32 v5, a103
 v_mfma_f32_16x16x32_bf16 v[112:115], a[220:223], a[132:135], v[112:115]
 ds_read_b128 a[132:135], v1 offset:33792
 v_lshlrev_b32 v6, 16, v5
 v_mfma_f32_16x16x32_bf16 v[112:115], a[216:219], a[128:131], v[112:115]
 ds_read_b128 a[128:131], v1 offset:32768
 v_and_b32 v5, s26, v5
 s_waitcnt vmcnt(12) lgkmcnt(8)
 v_mfma_f32_16x16x32_bf16 v[44:47], a[224:227], a[184:187], v[44:47]
 v_mul_f32 v6, v6, v238
 v_mul_f32 v5, v5, v239
 v_mfma_f32_16x16x32_bf16 v[44:47], a[228:231], a[188:191], v[44:47]
 global_load_dwordx4 a[220:223], v0, s[70:71] offset:-1024 sc1
 v_cvt_pk_bf16_f32 v11, v6, v5
 v_mfma_f32_16x16x32_bf16 v[40:43], a[228:231], a[180:183], v[40:43]
 ds_write_b128 v3, v[8:11] offset:7168
 v_mfma_f32_16x16x32_bf16 v[40:43], a[224:227], a[176:179], v[40:43]
 global_load_dwordx4 a[216:219], v0, s[70:71] offset:-2048 sc1
 v_mfma_f32_16x16x32_bf16 v[36:39], a[224:227], a[168:171], v[36:39]
 buffer_store_dwordx4 v[8:11], v3, s[32:35], s68 offen offset:3072 sc1
 v_accvgpr_read_b32 v5, a72
 v_lshlrev_b32 v6, 16, v5
 v_and_b32 v5, s26, v5
 v_mul_f32 v6, v6, v144
 v_mul_f32 v5, v5, v145
 v_mfma_f32_16x16x32_bf16 v[36:39], a[228:231], a[172:175], v[36:39]
 v_cvt_pk_bf16_f32 v8, v6, v5
 v_accvgpr_read_b32 v5, a73
 v_lshlrev_b32 v6, 16, v5
 v_mfma_f32_16x16x32_bf16 v[32:35], a[228:231], a[164:167], v[32:35]
 v_and_b32 v5, s26, v5
 v_mul_f32 v6, v6, v146
 v_mfma_f32_16x16x32_bf16 v[32:35], a[224:227], a[160:163], v[32:35]
 v_mul_f32 v5, v5, v147
 v_cvt_pk_bf16_f32 v9, v6, v5
 s_waitcnt lgkmcnt(1)
 v_mfma_f32_16x16x32_bf16 v[28:31], a[224:227], a[152:155], v[28:31]
 v_accvgpr_read_b32 v5, a74
 v_lshlrev_b32 v6, 16, v5
 v_mfma_f32_16x16x32_bf16 v[28:31], a[228:231], a[156:159], v[28:31]
 buffer_store_dwordx4 v[12:15], v3, s[32:35], s69 offen offset:1024 sc1
 v_mfma_f32_16x16x32_bf16 v[24:27], a[228:231], a[148:151], v[24:27]
 v_and_b32 v5, s26, v5
 v_mul_f32 v6, v6, v176
 v_mfma_f32_16x16x32_bf16 v[24:27], a[224:227], a[144:147], v[24:27]
 v_mul_f32 v5, v5, v177
 v_cvt_pk_bf16_f32 v10, v6, v5
 v_mfma_f32_16x16x32_bf16 v[20:23], a[224:227], a[136:139], v[20:23]
 v_accvgpr_read_b32 v5, a75
 v_lshlrev_b32 v6, 16, v5
 v_mfma_f32_16x16x32_bf16 v[20:23], a[228:231], a[140:143], v[20:23]
 v_and_b32 v5, s26, v5
 v_mul_f32 v6, v6, v178
 v_mfma_f32_16x16x32_bf16 v[16:19], a[228:231], a[132:135], v[16:19]
 v_mul_f32 v5, v5, v179
 v_cvt_pk_bf16_f32 v11, v6, v5
 v_mfma_f32_16x16x32_bf16 v[16:19], a[224:227], a[128:131], v[16:19]
 ds_write_b128 v3, v[8:11] offset:10240
 s_waitcnt vmcnt(14)
 v_mfma_f32_16x16x32_bf16 v[48:51], a[232:235], a[128:131], v[48:51]
 v_accvgpr_read_b32 v5, a104
 v_lshlrev_b32 v6, 16, v5
 v_mfma_f32_16x16x32_bf16 v[48:51], a[236:239], a[132:135], v[48:51]
 global_load_dwordx4 a[228:231], v0, s[70:71] offset:1024 sc1
 v_and_b32 v5, s26, v5
 v_mfma_f32_16x16x32_bf16 v[52:55], a[236:239], a[140:143], v[52:55]
 v_mul_f32 v6, v6, v208
 v_mul_f32 v5, v5, v209
 v_mfma_f32_16x16x32_bf16 v[52:55], a[232:235], a[136:139], v[52:55]
 global_load_dwordx4 a[224:227], v0, s[70:71] offset:0 sc1
 ds_read_b128 v[12:15], v3 offset:28672
 v_mfma_f32_16x16x32_bf16 v[56:59], a[232:235], a[144:147], v[56:59]
 v_cvt_pk_bf16_f32 v8, v6, v5
 v_accvgpr_read_b32 v5, a105
 v_mfma_f32_16x16x32_bf16 v[56:59], a[236:239], a[148:151], v[56:59]
 v_lshlrev_b32 v6, 16, v5
 v_and_b32 v5, s26, v5
 v_mfma_f32_16x16x32_bf16 v[60:63], a[236:239], a[156:159], v[60:63]
 v_mul_f32 v6, v6, v210
 v_mul_f32 v5, v5, v211
 v_mfma_f32_16x16x32_bf16 v[60:63], a[232:235], a[152:155], v[60:63]
 v_cvt_pk_bf16_f32 v9, v6, v5
 v_accvgpr_read_b32 v5, a106
 v_mfma_f32_16x16x32_bf16 v[64:67], a[232:235], a[160:163], v[64:67]
 v_lshlrev_b32 v6, 16, v5
 v_mfma_f32_16x16x32_bf16 v[64:67], a[236:239], a[164:167], v[64:67]
 v_and_b32 v5, s26, v5
 v_mul_f32 v6, v6, v240
 v_mfma_f32_16x16x32_bf16 v[68:71], a[236:239], a[172:175], v[68:71]
 v_mul_f32 v5, v5, v241
 v_cvt_pk_bf16_f32 v10, v6, v5
 v_mfma_f32_16x16x32_bf16 v[68:71], a[232:235], a[168:171], v[68:71]
 v_accvgpr_read_b32 v5, a107
 v_lshlrev_b32 v6, 16, v5
 v_mfma_f32_16x16x32_bf16 v[72:75], a[232:235], a[176:179], v[72:75]
 v_and_b32 v5, s26, v5
 v_mul_f32 v6, v6, v242
 v_mfma_f32_16x16x32_bf16 v[72:75], a[236:239], a[180:183], v[72:75]
 v_mul_f32 v5, v5, v243
 v_cvt_pk_bf16_f32 v11, v6, v5
 v_mfma_f32_16x16x32_bf16 v[76:79], a[236:239], a[188:191], v[76:79]
 ds_write_b128 v3, v[8:11] offset:11264
 v_mfma_f32_16x16x32_bf16 v[76:79], a[232:235], a[184:187], v[76:79]
 v_accvgpr_read_b32 v5, a76
 v_lshlrev_b32 v6, 16, v5
 s_waitcnt vmcnt(13)
 v_mfma_f32_16x16x32_bf16 v[108:111], a[192:195], a[184:187], v[108:111]
 v_and_b32 v5, s26, v5
 v_mul_f32 v6, v6, v148
 v_mfma_f32_16x16x32_bf16 v[108:111], a[196:199], a[188:191], v[108:111]
 global_load_dwordx4 a[236:239], v0, s[70:71] offset:3072 sc1
 v_mul_f32 v5, v5, v149
 v_mfma_f32_16x16x32_bf16 v[104:107], a[196:199], a[180:183], v[104:107]
 v_cvt_pk_bf16_f32 v8, v6, v5
 v_accvgpr_read_b32 v5, a77
 v_mfma_f32_16x16x32_bf16 v[104:107], a[192:195], a[176:179], v[104:107]
 global_load_dwordx4 a[232:235], v0, s[70:71] offset:2048 sc1
 v_lshlrev_b32 v6, 16, v5
 v_mfma_f32_16x16x32_bf16 v[100:103], a[192:195], a[168:171], v[100:103]
 v_and_b32 v5, s26, v5
 v_mul_f32 v6, v6, v150
 s_add_u32 s70, s70, 8192
 s_addc_u32 s71, s71, 0
 v_mfma_f32_16x16x32_bf16 v[100:103], a[196:199], a[172:175], v[100:103]
 v_mul_f32 v5, v5, v151
 v_cvt_pk_bf16_f32 v9, v6, v5
 v_mfma_f32_16x16x32_bf16 v[96:99], a[196:199], a[164:167], v[96:99]
 v_accvgpr_read_b32 v5, a78
 v_lshlrev_b32 v6, 16, v5
 v_mfma_f32_16x16x32_bf16 v[96:99], a[192:195], a[160:163], v[96:99]
 v_and_b32 v5, s26, v5
 v_mul_f32 v6, v6, v180
 v_mfma_f32_16x16x32_bf16 v[92:95], a[192:195], a[152:155], v[92:95]
 v_mul_f32 v5, v5, v181
 v_cvt_pk_bf16_f32 v10, v6, v5
 v_mfma_f32_16x16x32_bf16 v[92:95], a[196:199], a[156:159], v[92:95]
 v_accvgpr_read_b32 v5, a79
 v_lshlrev_b32 v6, 16, v5
 v_mfma_f32_16x16x32_bf16 v[88:91], a[196:199], a[148:151], v[88:91]
 v_and_b32 v5, s26, v5
 v_mul_f32 v6, v6, v182
 v_mfma_f32_16x16x32_bf16 v[88:91], a[192:195], a[144:147], v[88:91]
 v_mul_f32 v5, v5, v183
 v_cvt_pk_bf16_f32 v11, v6, v5
 v_mfma_f32_16x16x32_bf16 v[84:87], a[192:195], a[136:139], v[84:87]
 ds_write_b128 v3, v[8:11] offset:14336
 v_mfma_f32_16x16x32_bf16 v[84:87], a[196:199], a[140:143], v[84:87]
 v_accvgpr_read_b32 v5, a108
 v_lshlrev_b32 v6, 16, v5
 s_waitcnt lgkmcnt(2)
 v_mfma_f32_16x16x32_bf16 v[80:83], a[196:199], a[132:135], v[80:83]
 buffer_store_dwordx4 v[12:15], v3, s[32:35], s69 offen offset:2048 sc1
 v_mfma_f32_16x16x32_bf16 v[80:83], a[192:195], a[128:131], v[80:83]
 v_and_b32 v5, s26, v5
 v_mul_f32 v6, v6, v212
 s_waitcnt vmcnt(13)
 v_mfma_f32_16x16x32_bf16 v[112:115], a[200:203], a[128:131], v[112:115]
 ds_read_b128 a[128:131], v2
 v_mul_f32 v5, v5, v213
 v_mfma_f32_16x16x32_bf16 v[112:115], a[204:207], a[132:135], v[112:115]
 global_load_dwordx4 a[196:199], v0, s[70:71] offset:-3072 sc1
 ds_read_b128 a[132:135], v2 offset:1024
 v_mfma_f32_16x16x32_bf16 v[116:119], a[204:207], a[140:143], v[116:119]
 ds_read_b128 a[140:143], v2 offset:5120
 v_cvt_pk_bf16_f32 v8, v6, v5
 v_mfma_f32_16x16x32_bf16 v[116:119], a[200:203], a[136:139], v[116:119]
 global_load_dwordx4 a[192:195], v0, s[70:71] offset:-4096 sc1
 ds_read_b128 a[136:139], v2 offset:4096
 v_accvgpr_read_b32 v5, a109
 v_lshlrev_b32 v6, 16, v5
 v_mfma_f32_16x16x32_bf16 v[120:123], a[200:203], a[144:147], v[120:123]
 ds_read_b128 a[144:147], v2 offset:8192
 v_and_b32 v5, s26, v5
 v_mfma_f32_16x16x32_bf16 v[120:123], a[204:207], a[148:151], v[120:123]
 ds_read_b128 a[148:151], v2 offset:9216
 v_mul_f32 v6, v6, v214
 v_mul_f32 v5, v5, v215
 v_mfma_f32_16x16x32_bf16 v[124:127], a[204:207], a[156:159], v[124:127]
 ds_read_b128 a[156:159], v2 offset:13312
 v_cvt_pk_bf16_f32 v9, v6, v5
 v_accvgpr_read_b32 v5, a110
 v_mfma_f32_16x16x32_bf16 v[124:127], a[200:203], a[152:155], v[124:127]
 ds_read_b128 a[152:155], v2 offset:12288
 v_lshlrev_b32 v6, 16, v5
 v_mfma_f32_16x16x32_bf16 v[128:131], a[200:203], a[160:163], v[128:131]
 ds_read_b128 a[160:163], v2 offset:16384
 v_and_b32 v5, s26, v5
 v_mul_f32 v6, v6, v244
 v_mfma_f32_16x16x32_bf16 v[128:131], a[204:207], a[164:167], v[128:131]
 ds_read_b128 a[164:167], v2 offset:17408
 v_mul_f32 v5, v5, v245
 v_cvt_pk_bf16_f32 v10, v6, v5
 v_mfma_f32_16x16x32_bf16 v[132:135], a[204:207], a[172:175], v[132:135]
 ds_read_b128 a[172:175], v2 offset:21504
 ds_read_b128 v[12:15], v3 offset:29696
 v_mfma_f32_16x16x32_bf16 v[132:135], a[200:203], a[168:171], v[132:135]
 ds_read_b128 a[168:171], v2 offset:20480
 v_accvgpr_read_b32 v5, a111
 v_lshlrev_b32 v6, 16, v5
 v_mfma_f32_16x16x32_bf16 a[240:243], a[200:203], a[176:179], a[240:243]
 ds_read_b128 a[176:179], v2 offset:24576
 v_and_b32 v5, s26, v5
 v_mfma_f32_16x16x32_bf16 a[240:243], a[204:207], a[180:183], a[240:243]
 ds_read_b128 a[180:183], v2 offset:25600
 v_mul_f32 v6, v6, v246
 v_mfma_f32_16x16x32_bf16 a[244:247], a[204:207], a[188:191], a[244:247]
 ds_read_b128 a[188:191], v2 offset:29696
 v_mul_f32 v5, v5, v247
 v_mfma_f32_16x16x32_bf16 a[244:247], a[200:203], a[184:187], a[244:247]
 ds_read_b128 a[184:187], v2 offset:28672
 v_cvt_pk_bf16_f32 v11, v6, v5
 s_waitcnt vmcnt(11) lgkmcnt(9)
 v_mfma_f32_16x16x32_bf16 v[16:19], a[208:211], a[128:131], v[16:19]
 ds_write_b128 v3, v[8:11] offset:15360
 v_mfma_f32_16x16x32_bf16 v[16:19], a[212:215], a[132:135], v[16:19]
 global_load_dwordx4 a[204:207], v0, s[70:71] offset:-1024 sc1
 v_accvgpr_read_b32 v5, a80
 v_mfma_f32_16x16x32_bf16 v[20:23], a[212:215], a[140:143], v[20:23]
 v_lshlrev_b32 v6, 16, v5
 v_and_b32 v5, s26, v5
 v_mfma_f32_16x16x32_bf16 v[20:23], a[208:211], a[136:139], v[20:23]
 global_load_dwordx4 a[200:203], v0, s[70:71] offset:-2048 sc1
 v_mul_f32 v6, v6, v152
 v_mfma_f32_16x16x32_bf16 v[24:27], a[208:211], a[144:147], v[24:27]
 v_mul_f32 v5, v5, v153
 v_cvt_pk_bf16_f32 v8, v6, v5
 v_mfma_f32_16x16x32_bf16 v[24:27], a[212:215], a[148:151], v[24:27]
 v_accvgpr_read_b32 v5, a81
 v_lshlrev_b32 v6, 16, v5
 v_mfma_f32_16x16x32_bf16 v[28:31], a[212:215], a[156:159], v[28:31]
 v_and_b32 v5, s26, v5
 v_mul_f32 v6, v6, v154
 v_mfma_f32_16x16x32_bf16 v[28:31], a[208:211], a[152:155], v[28:31]
 v_mul_f32 v5, v5, v155
 v_cvt_pk_bf16_f32 v9, v6, v5
 s_waitcnt lgkmcnt(1)
 v_mfma_f32_16x16x32_bf16 v[32:35], a[208:211], a[160:163], v[32:35]
 v_accvgpr_read_b32 v5, a82
 v_lshlrev_b32 v6, 16, v5
 v_mfma_f32_16x16x32_bf16 v[32:35], a[212:215], a[164:167], v[32:35]
 v_and_b32 v5, s26, v5
 v_mul_f32 v6, v6, v184
 v_mfma_f32_16x16x32_bf16 v[36:39], a[212:215], a[172:175], v[36:39]
 v_mul_f32 v5, v5, v185
 v_cvt_pk_bf16_f32 v10, v6, v5
 v_mfma_f32_16x16x32_bf16 v[36:39], a[208:211], a[168:171], v[36:39]
 v_accvgpr_read_b32 v5, a83
 v_lshlrev_b32 v6, 16, v5
 v_mfma_f32_16x16x32_bf16 v[40:43], a[208:211], a[176:179], v[40:43]
 v_and_b32 v5, s26, v5
 v_mul_f32 v6, v6, v186
 v_mfma_f32_16x16x32_bf16 v[40:43], a[212:215], a[180:183], v[40:43]
 v_mul_f32 v5, v5, v187
 v_cvt_pk_bf16_f32 v11, v6, v5
 v_mfma_f32_16x16x32_bf16 v[44:47], a[212:215], a[188:191], v[44:47]
 ds_write_b128 v3, v[8:11] offset:18432
 v_mfma_f32_16x16x32_bf16 v[44:47], a[208:211], a[184:187], v[44:47]
 v_accvgpr_read_b32 v5, a112
 v_lshlrev_b32 v6, 16, v5
 s_waitcnt vmcnt(11)
 v_mfma_f32_16x16x32_bf16 v[76:79], a[216:219], a[184:187], v[76:79]
 v_and_b32 v5, s26, v5
 v_mul_f32 v6, v6, v216
 v_mfma_f32_16x16x32_bf16 v[76:79], a[220:223], a[188:191], v[76:79]
 global_load_dwordx4 a[212:215], v0, s[70:71] offset:1024 sc1
 v_mul_f32 v5, v5, v217
 v_mfma_f32_16x16x32_bf16 v[72:75], a[220:223], a[180:183], v[72:75]
 v_cvt_pk_bf16_f32 v8, v6, v5
 v_accvgpr_read_b32 v5, a113
 v_mfma_f32_16x16x32_bf16 v[72:75], a[216:219], a[176:179], v[72:75]
 global_load_dwordx4 a[208:211], v0, s[70:71] offset:0 sc1
 v_lshlrev_b32 v6, 16, v5
 v_mfma_f32_16x16x32_bf16 v[68:71], a[216:219], a[168:171], v[68:71]
 v_and_b32 v5, s26, v5
 v_mul_f32 v6, v6, v218
 v_mfma_f32_16x16x32_bf16 v[68:71], a[220:223], a[172:175], v[68:71]
 v_mul_f32 v5, v5, v219
 v_cvt_pk_bf16_f32 v9, v6, v5
 v_mfma_f32_16x16x32_bf16 v[64:67], a[220:223], a[164:167], v[64:67]
 v_accvgpr_read_b32 v5, a114
 v_lshlrev_b32 v6, 16, v5
 v_mfma_f32_16x16x32_bf16 v[64:67], a[216:219], a[160:163], v[64:67]
 buffer_store_dwordx4 v[12:15], v3, s[32:35], s69 offen offset:3072 sc1
 v_mfma_f32_16x16x32_bf16 v[60:63], a[216:219], a[152:155], v[60:63]
 v_and_b32 v5, s26, v5
 v_mul_f32 v6, v6, v248
 v_mfma_f32_16x16x32_bf16 v[60:63], a[220:223], a[156:159], v[60:63]
 v_mul_f32 v5, v5, v249
 v_cvt_pk_bf16_f32 v10, v6, v5
 v_mfma_f32_16x16x32_bf16 v[56:59], a[220:223], a[148:151], v[56:59]
 v_accvgpr_read_b32 v5, a115
 v_lshlrev_b32 v6, 16, v5
 v_mfma_f32_16x16x32_bf16 v[56:59], a[216:219], a[144:147], v[56:59]
 v_and_b32 v5, s26, v5
 v_mul_f32 v6, v6, v250
 v_mfma_f32_16x16x32_bf16 v[52:55], a[216:219], a[136:139], v[52:55]
 v_mul_f32 v5, v5, v251
 v_cvt_pk_bf16_f32 v11, v6, v5
 v_mfma_f32_16x16x32_bf16 v[52:55], a[220:223], a[140:143], v[52:55]
 ds_write_b128 v3, v[8:11] offset:19456
 v_mfma_f32_16x16x32_bf16 v[48:51], a[220:223], a[132:135], v[48:51]
 v_accvgpr_read_b32 v5, a84
 v_lshlrev_b32 v6, 16, v5
 v_mfma_f32_16x16x32_bf16 v[48:51], a[216:219], a[128:131], v[48:51]
 v_and_b32 v5, s26, v5
 v_mul_f32 v6, v6, v156
 s_waitcnt vmcnt(10)
 v_mfma_f32_16x16x32_bf16 v[80:83], a[224:227], a[128:131], v[80:83]
 v_mul_f32 v5, v5, v157
 v_cvt_pk_bf16_f32 v8, v6, v5
 v_mfma_f32_16x16x32_bf16 v[80:83], a[228:231], a[132:135], v[80:83]
 global_load_dwordx4 a[220:223], v0, s[70:71] offset:3072 sc1
 v_accvgpr_read_b32 v5, a85
 v_mfma_f32_16x16x32_bf16 v[84:87], a[228:231], a[140:143], v[84:87]
 v_lshlrev_b32 v6, 16, v5
 v_and_b32 v5, s26, v5
 v_mfma_f32_16x16x32_bf16 v[84:87], a[224:227], a[136:139], v[84:87]
 global_load_dwordx4 a[216:219], v0, s[70:71] offset:2048 sc1
 v_mul_f32 v6, v6, v158
 v_mfma_f32_16x16x32_bf16 v[88:91], a[224:227], a[144:147], v[88:91]
 v_mul_f32 v5, v5, v159
 v_cvt_pk_bf16_f32 v9, v6, v5
 s_add_u32 s70, s70, 8192
 s_addc_u32 s71, s71, 0
 v_mfma_f32_16x16x32_bf16 v[88:91], a[228:231], a[148:151], v[88:91]
 v_accvgpr_read_b32 v5, a86
 v_lshlrev_b32 v6, 16, v5
 v_mfma_f32_16x16x32_bf16 v[92:95], a[228:231], a[156:159], v[92:95]
 v_and_b32 v5, s26, v5
 v_mul_f32 v6, v6, v188
 v_mfma_f32_16x16x32_bf16 v[92:95], a[224:227], a[152:155], v[92:95]
 v_mul_f32 v5, v5, v189
 v_cvt_pk_bf16_f32 v10, v6, v5
 v_mfma_f32_16x16x32_bf16 v[96:99], a[224:227], a[160:163], v[96:99]
 v_accvgpr_read_b32 v5, a87
 v_lshlrev_b32 v6, 16, v5
 v_mfma_f32_16x16x32_bf16 v[96:99], a[228:231], a[164:167], v[96:99]
 v_and_b32 v5, s26, v5
 v_mul_f32 v6, v6, v190
 v_mfma_f32_16x16x32_bf16 v[100:103], a[228:231], a[172:175], v[100:103]
 v_mul_f32 v5, v5, v191
 v_cvt_pk_bf16_f32 v11, v6, v5
 v_mfma_f32_16x16x32_bf16 v[100:103], a[224:227], a[168:171], v[100:103]
 ds_write_b128 v3, v[8:11] offset:22528
 v_mfma_f32_16x16x32_bf16 v[104:107], a[224:227], a[176:179], v[104:107]
 v_accvgpr_read_b32 v5, a116
 v_lshlrev_b32 v6, 16, v5
 v_mfma_f32_16x16x32_bf16 v[104:107], a[228:231], a[180:183], v[104:107]
 v_and_b32 v5, s26, v5
 v_mul_f32 v6, v6, v220
 v_mfma_f32_16x16x32_bf16 v[108:111], a[228:231], a[188:191], v[108:111]
 v_mul_f32 v5, v5, v221
 v_cvt_pk_bf16_f32 v8, v6, v5
 v_mfma_f32_16x16x32_bf16 v[108:111], a[224:227], a[184:187], v[108:111]
 v_accvgpr_read_b32 v5, a117
 v_lshlrev_b32 v6, 16, v5
 s_waitcnt vmcnt(10)
 v_mfma_f32_16x16x32_bf16 a[244:247], a[232:235], a[184:187], a[244:247]
 ds_read_b128 a[184:187], v2 offset:61440
 v_and_b32 v5, s26, v5
 v_mfma_f32_16x16x32_bf16 a[244:247], a[236:239], a[188:191], a[244:247]
 global_load_dwordx4 a[228:231], v0, s[70:71] offset:-3072 sc1
 ds_read_b128 a[188:191], v2 offset:62464
 v_mfma_f32_16x16x32_bf16 a[240:243], a[236:239], a[180:183], a[240:243]
 ds_read_b128 a[180:183], v2 offset:58368
 v_mul_f32 v6, v6, v222
 v_mfma_f32_16x16x32_bf16 a[240:243], a[232:235], a[176:179], a[240:243]
 global_load_dwordx4 a[224:227], v0, s[70:71] offset:-4096 sc1
 ds_read_b128 a[176:179], v2 offset:57344
 v_mul_f32 v5, v5, v223
 v_cvt_pk_bf16_f32 v9, v6, v5
 v_mfma_f32_16x16x32_bf16 v[132:135], a[232:235], a[168:171], v[132:135]
 ds_read_b128 a[168:171], v2 offset:53248
 v_accvgpr_read_b32 v5, a118
 v_mfma_f32_16x16x32_bf16 v[132:135], a[236:239], a[172:175], v[132:135]
 ds_read_b128 a[172:175], v2 offset:54272
 v_lshlrev_b32 v6, 16, v5
 v_mfma_f32_16x16x32_bf16 v[128:131], a[236:239], a[164:167], v[128:131]
 ds_read_b128 a[164:167], v2 offset:50176
 v_and_b32 v5, s26, v5
 v_mfma_f32_16x16x32_bf16 v[128:131], a[232:235], a[160:163], v[128:131]
 ds_read_b128 a[160:163], v2 offset:49152
 v_mul_f32 v6, v6, v252
 v_mfma_f32_16x16x32_bf16 v[124:127], a[232:235], a[152:155], v[124:127]
 ds_read_b128 a[152:155], v2 offset:45056
 v_mul_f32 v5, v5, v253
 v_mfma_f32_16x16x32_bf16 v[124:127], a[236:239], a[156:159], v[124:127]
 ds_read_b128 a[156:159], v2 offset:46080
 v_cvt_pk_bf16_f32 v10, v6, v5
 v_mfma_f32_16x16x32_bf16 v[120:123], a[236:239], a[148:151], v[120:123]
 ds_read_b128 a[148:151], v2 offset:41984
 v_accvgpr_read_b32 v5, a119
 v_mfma_f32_16x16x32_bf16 v[120:123], a[232:235], a[144:147], v[120:123]
 ds_read_b128 a[144:147], v2 offset:40960
 v_lshlrev_b32 v6, 16, v5
 v_mfma_f32_16x16x32_bf16 v[116:119], a[232:235], a[136:139], v[116:119]
 ds_read_b128 a[136:139], v2 offset:36864
 v_and_b32 v5, s26, v5
 v_mfma_f32_16x16x32_bf16 v[116:119], a[236:239], a[140:143], v[116:119]
 ds_read_b128 a[140:143], v2 offset:37888
 v_mul_f32 v6, v6, v254
 v_mfma_f32_16x16x32_bf16 v[112:115], a[236:239], a[132:135], v[112:115]
 ds_read_b128 a[132:135], v2 offset:33792
 v_mul_f32 v5, v5, v255
 v_mfma_f32_16x16x32_bf16 v[112:115], a[232:235], a[128:131], v[112:115]
 ds_read_b128 a[128:131], v2 offset:32768
 v_cvt_pk_bf16_f32 v11, v6, v5
 s_waitcnt vmcnt(9) lgkmcnt(8)
 v_mfma_f32_16x16x32_bf16 v[44:47], a[192:195], a[184:187], v[44:47]
 ds_write_b128 v3, v[8:11] offset:23552
 v_accvgpr_read_b32 v5, a88
 v_lshlrev_b32 v6, 16, v5
 v_and_b32 v5, s26, v5
 v_mul_f32 v6, v6, v160
 v_mfma_f32_16x16x32_bf16 v[44:47], a[196:199], a[188:191], v[44:47]
 global_load_dwordx4 a[236:239], v0, s[70:71] offset:-1024 sc1
 v_mul_f32 v5, v5, v161
 v_mfma_f32_16x16x32_bf16 v[40:43], a[196:199], a[180:183], v[40:43]
 v_cvt_pk_bf16_f32 v8, v6, v5
 v_accvgpr_read_b32 v5, a89
 v_mfma_f32_16x16x32_bf16 v[40:43], a[192:195], a[176:179], v[40:43]
 global_load_dwordx4 a[232:235], v0, s[70:71] offset:-2048 sc1
 v_lshlrev_b32 v6, 16, v5
 v_mfma_f32_16x16x32_bf16 v[36:39], a[192:195], a[168:171], v[36:39]
 v_and_b32 v5, s26, v5
 v_mul_f32 v6, v6, v162
 v_mfma_f32_16x16x32_bf16 v[36:39], a[196:199], a[172:175], v[36:39]
 v_mul_f32 v5, v5, v163
 v_cvt_pk_bf16_f32 v9, v6, v5
 v_mfma_f32_16x16x32_bf16 v[32:35], a[196:199], a[164:167], v[32:35]
 v_accvgpr_read_b32 v5, a90
 v_lshlrev_b32 v6, 16, v5
 v_mfma_f32_16x16x32_bf16 v[32:35], a[192:195], a[160:163], v[32:35]
 v_and_b32 v5, s26, v5
 v_mul_f32 v6, v6, v192
 s_waitcnt lgkmcnt(1)
 v_mfma_f32_16x16x32_bf16 v[28:31], a[192:195], a[152:155], v[28:31]
 v_mul_f32 v5, v5, v193
 v_cvt_pk_bf16_f32 v10, v6, v5
 v_mfma_f32_16x16x32_bf16 v[28:31], a[196:199], a[156:159], v[28:31]
 v_accvgpr_read_b32 v5, a91
 v_lshlrev_b32 v6, 16, v5
 v_mfma_f32_16x16x32_bf16 v[24:27], a[196:199], a[148:151], v[24:27]
 v_and_b32 v5, s26, v5
 v_mul_f32 v6, v6, v194
 v_mfma_f32_16x16x32_bf16 v[24:27], a[192:195], a[144:147], v[24:27]
 v_mul_f32 v5, v5, v195
 v_cvt_pk_bf16_f32 v11, v6, v5
 v_mfma_f32_16x16x32_bf16 v[20:23], a[192:195], a[136:139], v[20:23]
 ds_write_b128 v3, v[8:11] offset:26624
 v_mfma_f32_16x16x32_bf16 v[20:23], a[196:199], a[140:143], v[20:23]
 v_accvgpr_read_b32 v5, a120
 v_lshlrev_b32 v6, 16, v5
 v_mfma_f32_16x16x32_bf16 v[16:19], a[196:199], a[132:135], v[16:19]
 v_and_b32 v5, s26, v5
 v_mul_f32 v6, v6, v224
 v_mfma_f32_16x16x32_bf16 v[16:19], a[192:195], a[128:131], v[16:19]
 v_mul_f32 v5, v5, v225
 v_cvt_pk_bf16_f32 v8, v6, v5
 s_waitcnt vmcnt(9)
 v_mfma_f32_16x16x32_bf16 v[48:51], a[200:203], a[128:131], v[48:51]
 v_accvgpr_read_b32 v5, a121
 v_lshlrev_b32 v6, 16, v5
 v_mfma_f32_16x16x32_bf16 v[48:51], a[204:207], a[132:135], v[48:51]
 global_load_dwordx4 a[196:199], v0, s[70:71] offset:1024 sc1
 v_and_b32 v5, s26, v5
 v_mfma_f32_16x16x32_bf16 v[52:55], a[204:207], a[140:143], v[52:55]
 v_mul_f32 v6, v6, v226
 v_mul_f32 v5, v5, v227
 v_mfma_f32_16x16x32_bf16 v[52:55], a[200:203], a[136:139], v[52:55]
 global_load_dwordx4 a[192:195], v0, s[70:71] offset:0 sc1
 v_cvt_pk_bf16_f32 v9, v6, v5
 v_mfma_f32_16x16x32_bf16 v[56:59], a[200:203], a[144:147], v[56:59]
 v_accvgpr_read_b32 v5, a122
 v_accvgpr_read_b32 v7, a248
 v_mfma_f32_16x16x32_bf16 v[56:59], a[204:207], a[148:151], v[56:59]
 v_lshlrev_b32 v6, 16, v5
 v_and_b32 v5, s26, v5
 v_mfma_f32_16x16x32_bf16 v[60:63], a[204:207], a[156:159], v[60:63]
 v_mul_f32 v6, v6, v7
 v_accvgpr_read_b32 v7, a249
 v_mfma_f32_16x16x32_bf16 v[60:63], a[200:203], a[152:155], v[60:63]
 v_mul_f32 v5, v5, v7
 v_cvt_pk_bf16_f32 v10, v6, v5
 v_mfma_f32_16x16x32_bf16 v[64:67], a[200:203], a[160:163], v[64:67]
 v_accvgpr_read_b32 v5, a123
 v_mfma_f32_16x16x32_bf16 v[64:67], a[204:207], a[164:167], v[64:67]
 v_accvgpr_read_b32 v7, a250
 v_lshlrev_b32 v6, 16, v5
 v_mfma_f32_16x16x32_bf16 v[68:71], a[204:207], a[172:175], v[68:71]
 v_and_b32 v5, s26, v5
 v_mul_f32 v6, v6, v7
 v_mfma_f32_16x16x32_bf16 v[68:71], a[200:203], a[168:171], v[68:71]
 v_accvgpr_read_b32 v7, a251
 v_mfma_f32_16x16x32_bf16 v[72:75], a[200:203], a[176:179], v[72:75]
 v_mul_f32 v5, v5, v7
 v_cvt_pk_bf16_f32 v11, v6, v5
 v_mfma_f32_16x16x32_bf16 v[72:75], a[204:207], a[180:183], v[72:75]
 ds_write_b128 v3, v[8:11] offset:27648
 v_mfma_f32_16x16x32_bf16 v[76:79], a[204:207], a[188:191], v[76:79]
 v_accvgpr_read_b32 v5, a92
 v_lshlrev_b32 v6, 16, v5
 v_mfma_f32_16x16x32_bf16 v[76:79], a[200:203], a[184:187], v[76:79]
 v_and_b32 v5, s26, v5
 v_mul_f32 v6, v6, v164
 s_waitcnt vmcnt(9)
 v_mfma_f32_16x16x32_bf16 v[108:111], a[208:211], a[184:187], v[108:111]
 v_mul_f32 v5, v5, v165
 v_cvt_pk_bf16_f32 v8, v6, v5
 v_mfma_f32_16x16x32_bf16 v[108:111], a[212:215], a[188:191], v[108:111]
 global_load_dwordx4 a[204:207], v0, s[70:71] offset:3072 sc1
 v_accvgpr_read_b32 v5, a93
 v_mfma_f32_16x16x32_bf16 v[104:107], a[212:215], a[180:183], v[104:107]
 v_lshlrev_b32 v6, 16, v5
 v_and_b32 v5, s26, v5
 v_mfma_f32_16x16x32_bf16 v[104:107], a[208:211], a[176:179], v[104:107]
 global_load_dwordx4 a[200:203], v0, s[70:71] offset:2048 sc1
 v_mul_f32 v6, v6, v166
 v_mfma_f32_16x16x32_bf16 v[100:103], a[208:211], a[168:171], v[100:103]
 v_mul_f32 v5, v5, v167
 v_cvt_pk_bf16_f32 v9, v6, v5
 s_add_u32 s70, s70, 8192
 s_addc_u32 s71, s71, 0
 v_mfma_f32_16x16x32_bf16 v[100:103], a[212:215], a[172:175], v[100:103]
 v_accvgpr_read_b32 v5, a94
 v_lshlrev_b32 v6, 16, v5
 v_mfma_f32_16x16x32_bf16 v[96:99], a[212:215], a[164:167], v[96:99]
 v_and_b32 v5, s26, v5
 v_mfma_f32_16x16x32_bf16 v[96:99], a[208:211], a[160:163], v[96:99]
 v_mul_f32 v6, v6, v196
 v_mul_f32 v5, v5, v197
 v_mfma_f32_16x16x32_bf16 v[92:95], a[208:211], a[152:155], v[92:95]
 v_cvt_pk_bf16_f32 v10, v6, v5
 v_mfma_f32_16x16x32_bf16 v[92:95], a[212:215], a[156:159], v[92:95]
 v_accvgpr_read_b32 v5, a95
 v_lshlrev_b32 v6, 16, v5
 v_mfma_f32_16x16x32_bf16 v[88:91], a[212:215], a[148:151], v[88:91]
 v_and_b32 v5, s26, v5
 v_mul_f32 v6, v6, v198
 v_mfma_f32_16x16x32_bf16 v[88:91], a[208:211], a[144:147], v[88:91]
 v_mul_f32 v5, v5, v199
 v_cvt_pk_bf16_f32 v11, v6, v5
 v_mfma_f32_16x16x32_bf16 v[84:87], a[208:211], a[136:139], v[84:87]
 ds_write_b128 v3, v[8:11] offset:30720
 v_mfma_f32_16x16x32_bf16 v[84:87], a[212:215], a[140:143], v[84:87]
 v_accvgpr_read_b32 v5, a124
 v_mfma_f32_16x16x32_bf16 v[80:83], a[212:215], a[132:135], v[80:83]
 v_lshlrev_b32 v6, 16, v5
 v_and_b32 v5, s26, v5
 v_mfma_f32_16x16x32_bf16 v[80:83], a[208:211], a[128:131], v[80:83]
 v_mul_f32 v6, v6, v228
 v_mul_f32 v5, v5, v229
 s_waitcnt vmcnt(8)
 v_mfma_f32_16x16x32_bf16 v[112:115], a[216:219], a[128:131], v[112:115]
 v_cvt_pk_bf16_f32 v8, v6, v5
 v_accvgpr_read_b32 v5, a125
 v_mfma_f32_16x16x32_bf16 v[112:115], a[220:223], a[132:135], v[112:115]
 global_load_dwordx4 a[212:215], v0, s[70:71] offset:-3072 sc1
 v_lshlrev_b32 v6, 16, v5
 v_mfma_f32_16x16x32_bf16 v[116:119], a[220:223], a[140:143], v[116:119]
 v_and_b32 v5, s26, v5
 v_mul_f32 v6, v6, v230
 v_mfma_f32_16x16x32_bf16 v[116:119], a[216:219], a[136:139], v[116:119]
 global_load_dwordx4 a[208:211], v0, s[70:71] offset:-4096 sc1
 v_mul_f32 v5, v5, v231
 v_mfma_f32_16x16x32_bf16 v[120:123], a[216:219], a[144:147], v[120:123]
 v_cvt_pk_bf16_f32 v9, v6, v5
 v_accvgpr_read_b32 v5, a126
 v_mfma_f32_16x16x32_bf16 v[120:123], a[220:223], a[148:151], v[120:123]
 v_accvgpr_read_b32 v7, a252
 v_mfma_f32_16x16x32_bf16 v[124:127], a[220:223], a[156:159], v[124:127]
 v_lshlrev_b32 v6, 16, v5
 v_and_b32 v5, s26, v5
 v_mfma_f32_16x16x32_bf16 v[124:127], a[216:219], a[152:155], v[124:127]
 v_mul_f32 v6, v6, v7
 v_accvgpr_read_b32 v7, a253
 v_mfma_f32_16x16x32_bf16 v[128:131], a[216:219], a[160:163], v[128:131]
 v_mul_f32 v5, v5, v7
 v_cvt_pk_bf16_f32 v10, v6, v5
 v_mfma_f32_16x16x32_bf16 v[128:131], a[220:223], a[164:167], v[128:131]
 v_accvgpr_read_b32 v5, a127
 v_accvgpr_read_b32 v7, a254
 v_mfma_f32_16x16x32_bf16 v[132:135], a[220:223], a[172:175], v[132:135]
 v_lshlrev_b32 v6, 16, v5
 v_and_b32 v5, s26, v5
 v_mfma_f32_16x16x32_bf16 v[132:135], a[216:219], a[168:171], v[132:135]
 v_mul_f32 v6, v6, v7
 v_accvgpr_read_b32 v7, a255
 v_mfma_f32_16x16x32_bf16 a[240:243], a[216:219], a[176:179], a[240:243]
 v_mul_f32 v5, v5, v7
 v_cvt_pk_bf16_f32 v11, v6, v5
 v_mfma_f32_16x16x32_bf16 a[240:243], a[220:223], a[180:183], a[240:243]
 ds_write_b128 v3, v[8:11] offset:31744
 v_mfma_f32_16x16x32_bf16 a[244:247], a[220:223], a[188:191], a[244:247]
 global_load_dwordx4 a[220:223], v0, s[70:71] offset:-1024 sc1
 v_mfma_f32_16x16x32_bf16 a[244:247], a[216:219], a[184:187], a[244:247]
 global_load_dwordx4 a[216:219], v0, s[70:71] offset:-2048 sc1
 s_waitcnt vmcnt(10)
Ls1b:
 v_mfma_f32_16x16x32_bf16 v[164:167], a[224:227], a[184:187], v[164:167]
 v_bfe_u32 v4, v3, 8, 2
 v_mfma_f32_16x16x32_bf16 v[164:167], a[228:231], a[188:191], v[164:167]
 ds_read_b128 v[12:15], v3 offset:10240
 v_mfma_f32_16x16x32_bf16 v[160:163], a[228:231], a[180:183], v[160:163]
 v_lshl_add_u32 v4, v4, 5, s51
 v_mfma_f32_16x16x32_bf16 v[160:163], a[224:227], a[176:179], v[160:163]
 ds_read_b128 v[8:11], v4
 v_mfma_f32_16x16x32_bf16 v[156:159], a[224:227], a[168:171], v[156:159]
 v_mfma_f32_16x16x32_bf16 v[156:159], a[228:231], a[172:175], v[156:159]
 v_mfma_f32_16x16x32_bf16 v[152:155], a[228:231], a[164:167], v[152:155]
 v_mfma_f32_16x16x32_bf16 v[152:155], a[224:227], a[160:163], v[152:155]
 v_mfma_f32_16x16x32_bf16 v[148:151], a[224:227], a[152:155], v[148:151]
 v_mfma_f32_16x16x32_bf16 v[148:151], a[228:231], a[156:159], v[148:151]
 v_mfma_f32_16x16x32_bf16 v[144:147], a[228:231], a[148:151], v[144:147]
 v_mfma_f32_16x16x32_bf16 v[144:147], a[224:227], a[144:147], v[144:147]
 v_mfma_f32_16x16x32_bf16 v[140:143], a[224:227], a[136:139], v[140:143]
 v_mfma_f32_16x16x32_bf16 v[140:143], a[228:231], a[140:143], v[140:143]
 s_waitcnt lgkmcnt(0)
 v_mfma_f32_16x16x32_bf16 v[136:139], a[228:231], a[132:135], v[136:139]
 v_add_f32 v16, v16, v8
 v_mfma_f32_16x16x32_bf16 v[136:139], a[224:227], a[128:131], v[136:139]
 v_add_f32 v17, v17, v9
 s_waitcnt vmcnt(8)
 v_mfma_f32_16x16x32_bf16 v[168:171], a[232:235], a[128:131], v[168:171]
 v_add_f32 v18, v18, v10
 v_mfma_f32_16x16x32_bf16 v[168:171], a[236:239], a[132:135], v[168:171]
 global_load_dwordx4 a[228:231], v0, s[70:71] offset:1024 sc1
 v_mfma_f32_16x16x32_bf16 v[172:175], a[236:239], a[140:143], v[172:175]
 s_add_u32 s31, s31, 1
 v_mfma_f32_16x16x32_bf16 v[172:175], a[232:235], a[136:139], v[172:175]
 global_load_dwordx4 a[224:227], v0, s[70:71] offset:0 sc1
 v_mfma_f32_16x16x32_bf16 v[176:179], a[232:235], a[144:147], v[176:179]
 v_mov_b32 v7, s31
 v_mfma_f32_16x16x32_bf16 v[176:179], a[236:239], a[148:151], v[176:179]
 buffer_store_dword v7, v1, s[60:63], 0 offen sc1
 v_mfma_f32_16x16x32_bf16 v[180:183], a[236:239], a[156:159], v[180:183]
 v_add_f32 v19, v19, v11
 s_add_u32 s69, s29, 20480
 v_mfma_f32_16x16x32_bf16 v[180:183], a[232:235], a[152:155], v[180:183]
 v_add_f32 v20, v20, v8
 v_mfma_f32_16x16x32_bf16 v[184:187], a[232:235], a[160:163], v[184:187]
 buffer_store_dwordx4 v[12:15], v3, s[32:35], s69 offen sc1
 v_mfma_f32_16x16x32_bf16 v[184:187], a[236:239], a[164:167], v[184:187]
 v_add_f32 v21, v21, v9
 v_mfma_f32_16x16x32_bf16 v[188:191], a[236:239], a[172:175], v[188:191]
 v_add_f32 v22, v22, v10
 v_mfma_f32_16x16x32_bf16 v[188:191], a[232:235], a[168:171], v[188:191]
 v_mfma_f32_16x16x32_bf16 v[192:195], a[232:235], a[176:179], v[192:195]
 v_add_f32 v23, v23, v11
 v_mfma_f32_16x16x32_bf16 v[192:195], a[236:239], a[180:183], v[192:195]
 v_add_f32 v24, v24, v8
 v_mfma_f32_16x16x32_bf16 v[196:199], a[236:239], a[188:191], v[196:199]
 v_add_f32 v25, v25, v9
 v_mfma_f32_16x16x32_bf16 v[196:199], a[232:235], a[184:187], v[196:199]
 ds_read_b128 v[12:15], v3 offset:11264
 s_waitcnt vmcnt(10)
 v_mfma_f32_16x16x32_bf16 v[228:231], a[192:195], a[184:187], v[228:231]
 v_add_f32 v26, v26, v10
 v_mfma_f32_16x16x32_bf16 v[228:231], a[196:199], a[188:191], v[228:231]
 global_load_dwordx4 a[236:239], v0, s[70:71] offset:3072 sc1
 v_add_f32 v27, v27, v11
 v_mfma_f32_16x16x32_bf16 v[224:227], a[196:199], a[180:183], v[224:227]
 v_add_f32 v28, v28, v8
 v_mfma_f32_16x16x32_bf16 v[224:227], a[192:195], a[176:179], v[224:227]
 global_load_dwordx4 a[232:235], v0, s[70:71] offset:2048 sc1
 v_add_f32 v29, v29, v9
 v_mfma_f32_16x16x32_bf16 v[220:223], a[192:195], a[168:171], v[220:223]
 v_add_f32 v30, v30, v10
 s_add_u32 s70, s70, 8192
 s_addc_u32 s71, s71, 0
 v_mfma_f32_16x16x32_bf16 v[220:223], a[196:199], a[172:175], v[220:223]
 v_mfma_f32_16x16x32_bf16 v[216:219], a[196:199], a[164:167], v[216:219]
 v_add_f32 v31, v31, v11
 v_mfma_f32_16x16x32_bf16 v[216:219], a[192:195], a[160:163], v[216:219]
 v_add_f32 v32, v32, v8
 v_mfma_f32_16x16x32_bf16 v[212:215], a[192:195], a[152:155], v[212:215]
 v_add_f32 v33, v33, v9
 v_mfma_f32_16x16x32_bf16 v[212:215], a[196:199], a[156:159], v[212:215]
 v_add_f32 v34, v34, v10
 v_mfma_f32_16x16x32_bf16 v[208:211], a[196:199], a[148:151], v[208:211]
 v_mfma_f32_16x16x32_bf16 v[208:211], a[192:195], a[144:147], v[208:211]
 v_add_f32 v35, v35, v11
 v_mfma_f32_16x16x32_bf16 v[204:207], a[192:195], a[136:139], v[204:207]
 v_add_f32 v36, v36, v8
 v_mfma_f32_16x16x32_bf16 v[204:207], a[196:199], a[140:143], v[204:207]
 v_add_f32 v37, v37, v9
 v_mfma_f32_16x16x32_bf16 v[200:203], a[196:199], a[132:135], v[200:203]
 v_add_f32 v38, v38, v10
 v_mfma_f32_16x16x32_bf16 v[200:203], a[192:195], a[128:131], v[200:203]
 v_add_f32 v39, v39, v11
 s_waitcnt vmcnt(10)
 v_mfma_f32_16x16x32_bf16 v[232:235], a[200:203], a[128:131], v[232:235]
 ds_read_b128 a[128:131], v2
 v_add_f32 v40, v40, v8
 v_mfma_f32_16x16x32_bf16 v[232:235], a[204:207], a[132:135], v[232:235]
 global_load_dwordx4 a[196:199], v0, s[70:71] offset:-3072 sc1
 ds_read_b128 a[132:135], v2 offset:1024
 v_mfma_f32_16x16x32_bf16 v[236:239], a[204:207], a[140:143], v[236:239]
 ds_read_b128 a[140:143], v2 offset:5120
 v_add_f32 v41, v41, v9
 s_waitcnt lgkmcnt(3)
 v_mfma_f32_16x16x32_bf16 v[236:239], a[200:203], a[136:139], v[236:239]
 global_load_dwordx4 a[192:195], v0, s[70:71] offset:-4096 sc1
 ds_read_b128 a[136:139], v2 offset:4096
 v_mfma_f32_16x16x32_bf16 v[240:243], a[200:203], a[144:147], v[240:243]
 ds_read_b128 a[144:147], v2 offset:8192
 v_add_f32 v42, v42, v10
 v_mfma_f32_16x16x32_bf16 v[240:243], a[204:207], a[148:151], v[240:243]
 buffer_store_dwordx4 v[12:15], v3, s[32:35], s69 offen offset:1024 sc1
 ds_read_b128 a[148:151], v2 offset:9216
 v_mfma_f32_16x16x32_bf16 v[244:247], a[204:207], a[156:159], v[244:247]
 ds_read_b128 a[156:159], v2 offset:13312
 v_add_f32 v43, v43, v11
 v_mfma_f32_16x16x32_bf16 v[244:247], a[200:203], a[152:155], v[244:247]
 ds_read_b128 a[152:155], v2 offset:12288
 v_add_f32 v44, v44, v8
 v_mfma_f32_16x16x32_bf16 v[248:251], a[200:203], a[160:163], v[248:251]
 ds_read_b128 a[160:163], v2 offset:16384
 v_add_f32 v45, v45, v9
 v_mfma_f32_16x16x32_bf16 v[248:251], a[204:207], a[164:167], v[248:251]
 ds_read_b128 a[164:167], v2 offset:17408
 v_add_f32 v46, v46, v10
 v_mfma_f32_16x16x32_bf16 v[252:255], a[204:207], a[172:175], v[252:255]
 ds_read_b128 a[172:175], v2 offset:21504
 v_add_f32 v47, v47, v11
 v_mfma_f32_16x16x32_bf16 v[252:255], a[200:203], a[168:171], v[252:255]
 ds_read_b128 a[168:171], v2 offset:20480
 ds_read_b128 v[8:11], v4 offset:16
 v_mfma_f32_16x16x32_bf16 a[248:251], a[200:203], a[176:179], a[248:251]
 ds_read_b128 a[176:179], v2 offset:24576
 ds_read_b128 v[12:15], v3 offset:14336
 v_mfma_f32_16x16x32_bf16 a[248:251], a[204:207], a[180:183], a[248:251]
 ds_read_b128 a[180:183], v2 offset:25600
 v_mfma_f32_16x16x32_bf16 a[252:255], a[204:207], a[188:191], a[252:255]
 ds_read_b128 a[188:191], v2 offset:29696
 v_mfma_f32_16x16x32_bf16 a[252:255], a[200:203], a[184:187], a[252:255]
 ds_read_b128 a[184:187], v2 offset:28672
 s_waitcnt vmcnt(11) lgkmcnt(10)
 v_mfma_f32_16x16x32_bf16 v[136:139], a[208:211], a[128:131], v[136:139]
 v_mfma_f32_16x16x32_bf16 v[136:139], a[212:215], a[132:135], v[136:139]
 global_load_dwordx4 a[204:207], v0, s[70:71] offset:-1024 sc1
 v_mfma_f32_16x16x32_bf16 v[140:143], a[212:215], a[140:143], v[140:143]
 v_mfma_f32_16x16x32_bf16 v[140:143], a[208:211], a[136:139], v[140:143]
 global_load_dwordx4 a[200:203], v0, s[70:71] offset:-2048 sc1
 v_mfma_f32_16x16x32_bf16 v[144:147], a[208:211], a[144:147], v[144:147]
 v_mfma_f32_16x16x32_bf16 v[144:147], a[212:215], a[148:151], v[144:147]
 s_waitcnt lgkmcnt(5)
 v_mfma_f32_16x16x32_bf16 v[148:151], a[212:215], a[156:159], v[148:151]
 v_add_f32 v48, v48, v8
 v_mfma_f32_16x16x32_bf16 v[148:151], a[208:211], a[152:155], v[148:151]
 v_add_f32 v49, v49, v9
 s_waitcnt lgkmcnt(0)
 v_mfma_f32_16x16x32_bf16 v[152:155], a[208:211], a[160:163], v[152:155]
 v_mfma_f32_16x16x32_bf16 v[152:155], a[212:215], a[164:167], v[152:155]
 v_add_f32 v50, v50, v10
 v_mfma_f32_16x16x32_bf16 v[156:159], a[212:215], a[172:175], v[156:159]
 v_add_f32 v51, v51, v11
 v_mfma_f32_16x16x32_bf16 v[156:159], a[208:211], a[168:171], v[156:159]
 v_add_f32 v52, v52, v8
 v_mfma_f32_16x16x32_bf16 v[160:163], a[208:211], a[176:179], v[160:163]
 v_add_f32 v53, v53, v9
 v_mfma_f32_16x16x32_bf16 v[160:163], a[212:215], a[180:183], v[160:163]
 v_mfma_f32_16x16x32_bf16 v[164:167], a[212:215], a[188:191], v[164:167]
 v_add_f32 v54, v54, v10
 v_mfma_f32_16x16x32_bf16 v[164:167], a[208:211], a[184:187], v[164:167]
 v_add_f32 v55, v55, v11
 s_waitcnt vmcnt(11)
 v_mfma_f32_16x16x32_bf16 v[196:199], a[216:219], a[184:187], v[196:199]
 v_add_f32 v56, v56, v8
 v_mfma_f32_16x16x32_bf16 v[196:199], a[220:223], a[188:191], v[196:199]
 global_load_dwordx4 a[212:215], v0, s[70:71] offset:1024 sc1
 v_add_f32 v57, v57, v9
 v_mfma_f32_16x16x32_bf16 v[192:195], a[220:223], a[180:183], v[192:195]
 v_add_f32 v58, v58, v10
 v_mfma_f32_16x16x32_bf16 v[192:195], a[216:219], a[176:179], v[192:195]
 global_load_dwordx4 a[208:211], v0, s[70:71] offset:0 sc1
 v_add_f32 v59, v59, v11
 v_mfma_f32_16x16x32_bf16 v[188:191], a[216:219], a[168:171], v[188:191]
 buffer_store_dwordx4 v[12:15], v3, s[32:35], s69 offen offset:2048 sc1
 v_mfma_f32_16x16x32_bf16 v[188:191], a[220:223], a[172:175], v[188:191]
 v_add_f32 v60, v60, v8
 v_mfma_f32_16x16x32_bf16 v[184:187], a[220:223], a[164:167], v[184:187]
 v_add_f32 v61, v61, v9
 v_mfma_f32_16x16x32_bf16 v[184:187], a[216:219], a[160:163], v[184:187]
 v_add_f32 v62, v62, v10
 v_mfma_f32_16x16x32_bf16 v[180:183], a[216:219], a[152:155], v[180:183]
 ds_read_b128 v[12:15], v3 offset:15360
 v_mfma_f32_16x16x32_bf16 v[180:183], a[220:223], a[156:159], v[180:183]
 v_add_f32 v63, v63, v11
 v_mfma_f32_16x16x32_bf16 v[176:179], a[220:223], a[148:151], v[176:179]
 v_add_f32 v64, v64, v8
 v_mfma_f32_16x16x32_bf16 v[176:179], a[216:219], a[144:147], v[176:179]
 v_add_f32 v65, v65, v9
 v_mfma_f32_16x16x32_bf16 v[172:175], a[216:219], a[136:139], v[172:175]
 v_mfma_f32_16x16x32_bf16 v[172:175], a[220:223], a[140:143], v[172:175]
 v_add_f32 v66, v66, v10
 v_mfma_f32_16x16x32_bf16 v[168:171], a[220:223], a[132:135], v[168:171]
 v_add_f32 v67, v67, v11
 v_mfma_f32_16x16x32_bf16 v[168:171], a[216:219], a[128:131], v[168:171]
 v_add_f32 v68, v68, v8
 s_waitcnt vmcnt(12)
 v_mfma_f32_16x16x32_bf16 v[200:203], a[224:227], a[128:131], v[200:203]
 v_add_f32 v69, v69, v9
 v_mfma_f32_16x16x32_bf16 v[200:203], a[228:231], a[132:135], v[200:203]
 global_load_dwordx4 a[220:223], v0, s[70:71] offset:3072 sc1
 v_mfma_f32_16x16x32_bf16 v[204:207], a[228:231], a[140:143], v[204:207]
 v_add_f32 v70, v70, v10
 v_mfma_f32_16x16x32_bf16 v[204:207], a[224:227], a[136:139], v[204:207]
 global_load_dwordx4 a[216:219], v0, s[70:71] offset:2048 sc1
 v_add_f32 v71, v71, v11
 v_mfma_f32_16x16x32_bf16 v[208:211], a[224:227], a[144:147], v[208:211]
 v_add_f32 v72, v72, v8
 s_add_u32 s70, s70, 8192
 s_addc_u32 s71, s71, 0
 v_mfma_f32_16x16x32_bf16 v[208:211], a[228:231], a[148:151], v[208:211]
 v_add_f32 v73, v73, v9
 v_mfma_f32_16x16x32_bf16 v[212:215], a[228:231], a[156:159], v[212:215]
 v_mfma_f32_16x16x32_bf16 v[212:215], a[224:227], a[152:155], v[212:215]
 v_add_f32 v74, v74, v10
 v_mfma_f32_16x16x32_bf16 v[216:219], a[224:227], a[160:163], v[216:219]
 v_add_f32 v75, v75, v11
 v_mfma_f32_16x16x32_bf16 v[216:219], a[228:231], a[164:167], v[216:219]
 v_add_f32 v76, v76, v8
 v_mfma_f32_16x16x32_bf16 v[220:223], a[228:231], a[172:175], v[220:223]
 v_add_f32 v77, v77, v9
 v_mfma_f32_16x16x32_bf16 v[220:223], a[224:227], a[168:171], v[220:223]
 s_waitcnt lgkmcnt(0)
 v_mfma_f32_16x16x32_bf16 v[224:227], a[224:227], a[176:179], v[224:227]
 v_add_f32 v78, v78, v10
 v_mfma_f32_16x16x32_bf16 v[224:227], a[228:231], a[180:183], v[224:227]
 v_add_f32 v79, v79, v11
 v_mfma_f32_16x16x32_bf16 v[228:231], a[228:231], a[188:191], v[228:231]
 buffer_store_dwordx4 v[12:15], v3, s[32:35], s69 offen offset:3072 sc1
 v_mfma_f32_16x16x32_bf16 v[228:231], a[224:227], a[184:187], v[228:231]
 ds_read_b128 v[8:11], v4 offset:128
 s_waitcnt vmcnt(11)
 v_mfma_f32_16x16x32_bf16 a[252:255], a[232:235], a[184:187], a[252:255]
 ds_read_b128 a[184:187], v1 offset:61440
 v_mfma_f32_16x16x32_bf16 a[252:255], a[236:239], a[188:191], a[252:255]
 global_load_dwordx4 a[228:231], v0, s[70:71] offset:-3072 sc1
 ds_read_b128 a[188:191], v1 offset:62464
 v_mfma_f32_16x16x32_bf16 a[248:251], a[236:239], a[180:183], a[248:251]
 ds_read_b128 a[180:183], v1 offset:58368
 v_mfma_f32_16x16x32_bf16 a[248:251], a[232:235], a[176:179], a[248:251]
 global_load_dwordx4 a[224:227], v0, s[70:71] offset:-4096 sc1
 ds_read_b128 a[176:179], v1 offset:57344
 v_mfma_f32_16x16x32_bf16 v[252:255], a[232:235], a[168:171], v[252:255]
 ds_read_b128 a[168:171], v1 offset:53248
 v_mfma_f32_16x16x32_bf16 v[252:255], a[236:239], a[172:175], v[252:255]
 ds_read_b128 a[172:175], v1 offset:54272
 ds_read_b128 v[12:15], v3 offset:18432
 v_mfma_f32_16x16x32_bf16 v[248:251], a[236:239], a[164:167], v[248:251]
 ds_read_b128 a[164:167], v1 offset:50176
 v_mfma_f32_16x16x32_bf16 v[248:251], a[232:235], a[160:163], v[248:251]
 ds_read_b128 a[160:163], v1 offset:49152
 v_mfma_f32_16x16x32_bf16 v[244:247], a[232:235], a[152:155], v[244:247]
 ds_read_b128 a[152:155], v1 offset:45056
 s_waitcnt lgkmcnt(10)
 v_mfma_f32_16x16x32_bf16 v[244:247], a[236:239], a[156:159], v[244:247]
 ds_read_b128 a[156:159], v1 offset:46080
 v_mfma_f32_16x16x32_bf16 v[240:243], a[236:239], a[148:151], v[240:243]
 ds_read_b128 a[148:151], v1 offset:41984
 v_add_f32 v80, v80, v8
 v_mfma_f32_16x16x32_bf16 v[240:243], a[232:235], a[144:147], v[240:243]
 ds_read_b128 a[144:147], v1 offset:40960
 v_add_f32 v81, v81, v9
 v_mfma_f32_16x16x32_bf16 v[236:239], a[232:235], a[136:139], v[236:239]
 ds_read_b128 a[136:139], v1 offset:36864
 v_add_f32 v82, v82, v10
 v_mfma_f32_16x16x32_bf16 v[236:239], a[236:239], a[140:143], v[236:239]
 ds_read_b128 a[140:143], v1 offset:37888
 v_add_f32 v83, v83, v11
 v_mfma_f32_16x16x32_bf16 v[232:235], a[236:239], a[132:135], v[232:235]
 ds_read_b128 a[132:135], v1 offset:33792
 v_mfma_f32_16x16x32_bf16 v[232:235], a[232:235], a[128:131], v[232:235]
 ds_read_b128 a[128:131], v1 offset:32768
 v_add_f32 v84, v84, v8
 s_waitcnt vmcnt(11) lgkmcnt(8)
 v_mfma_f32_16x16x32_bf16 v[164:167], a[192:195], a[184:187], v[164:167]
 v_add_f32 v85, v85, v9
 v_mfma_f32_16x16x32_bf16 v[164:167], a[196:199], a[188:191], v[164:167]
 global_load_dwordx4 a[236:239], v0, s[70:71] offset:-1024 sc1
 v_add_f32 v86, v86, v10
 v_mfma_f32_16x16x32_bf16 v[160:163], a[196:199], a[180:183], v[160:163]
 v_add_f32 v87, v87, v11
 v_mfma_f32_16x16x32_bf16 v[160:163], a[192:195], a[176:179], v[160:163]
 global_load_dwordx4 a[232:235], v0, s[70:71] offset:-2048 sc1
 v_mfma_f32_16x16x32_bf16 v[156:159], a[192:195], a[168:171], v[156:159]
 v_add_f32 v88, v88, v8
 v_mfma_f32_16x16x32_bf16 v[156:159], a[196:199], a[172:175], v[156:159]
 v_add_f32 v89, v89, v9
 v_mfma_f32_16x16x32_bf16 v[152:155], a[196:199], a[164:167], v[152:155]
 v_add_f32 v90, v90, v10
 v_mfma_f32_16x16x32_bf16 v[152:155], a[192:195], a[160:163], v[152:155]
 v_add_f32 v91, v91, v11
 s_waitcnt lgkmcnt(0)
 v_mfma_f32_16x16x32_bf16 v[148:151], a[192:195], a[152:155], v[148:151]
 v_mfma_f32_16x16x32_bf16 v[148:151], a[196:199], a[156:159], v[148:151]
 v_add_f32 v92, v92, v8
 v_mfma_f32_16x16x32_bf16 v[144:147], a[196:199], a[148:151], v[144:147]
 v_add_f32 v93, v93, v9
 s_add_u32 s69, s29, 24576
 v_mfma_f32_16x16x32_bf16 v[144:147], a[192:195], a[144:147], v[144:147]
 v_add_f32 v94, v94, v10
 v_mfma_f32_16x16x32_bf16 v[140:143], a[192:195], a[136:139], v[140:143]
 buffer_store_dwordx4 v[12:15], v3, s[32:35], s69 offen sc1
 v_mfma_f32_16x16x32_bf16 v[140:143], a[196:199], a[140:143], v[140:143]
 v_add_f32 v95, v95, v11
 v_mfma_f32_16x16x32_bf16 v[136:139], a[196:199], a[132:135], v[136:139]
 v_add_f32 v96, v96, v8
 v_mfma_f32_16x16x32_bf16 v[136:139], a[192:195], a[128:131], v[136:139]
 v_add_f32 v97, v97, v9
 s_waitcnt vmcnt(11)
 v_mfma_f32_16x16x32_bf16 v[168:171], a[200:203], a[128:131], v[168:171]
 v_add_f32 v98, v98, v10
 v_mfma_f32_16x16x32_bf16 v[168:171], a[204:207], a[132:135], v[168:171]
 global_load_dwordx4 a[196:199], v0, s[70:71] offset:1024 sc1
 v_add_f32 v99, v99, v11
 v_mfma_f32_16x16x32_bf16 v[172:175], a[204:207], a[140:143], v[172:175]
 v_add_f32 v100, v100, v8
 v_mfma_f32_16x16x32_bf16 v[172:175], a[200:203], a[136:139], v[172:175]
 global_load_dwordx4 a[192:195], v0, s[70:71] offset:0 sc1
 ds_read_b128 v[12:15], v3 offset:19456
 v_mfma_f32_16x16x32_bf16 v[176:179], a[200:203], a[144:147], v[176:179]
 v_add_f32 v101, v101, v9
 v_mfma_f32_16x16x32_bf16 v[176:179], a[204:207], a[148:151], v[176:179]
 v_add_f32 v102, v102, v10
 v_mfma_f32_16x16x32_bf16 v[180:183], a[204:207], a[156:159], v[180:183]
 v_add_f32 v103, v103, v11
 v_mfma_f32_16x16x32_bf16 v[180:183], a[200:203], a[152:155], v[180:183]
 v_mfma_f32_16x16x32_bf16 v[184:187], a[200:203], a[160:163], v[184:187]
 v_add_f32 v104, v104, v8
 v_mfma_f32_16x16x32_bf16 v[184:187], a[204:207], a[164:167], v[184:187]
 v_add_f32 v105, v105, v9
 v_mfma_f32_16x16x32_bf16 v[188:191], a[204:207], a[172:175], v[188:191]
 v_add_f32 v106, v106, v10
 v_mfma_f32_16x16x32_bf16 v[188:191], a[200:203], a[168:171], v[188:191]
 v_add_f32 v107, v107, v11
 v_mfma_f32_16x16x32_bf16 v[192:195], a[200:203], a[176:179], v[192:195]
 v_mfma_f32_16x16x32_bf16 v[192:195], a[204:207], a[180:183], v[192:195]
 v_add_f32 v108, v108, v8
 v_mfma_f32_16x16x32_bf16 v[196:199], a[204:207], a[188:191], v[196:199]
 v_add_f32 v109, v109, v9
 v_mfma_f32_16x16x32_bf16 v[196:199], a[200:203], a[184:187], v[196:199]
 v_add_f32 v110, v110, v10
 s_waitcnt vmcnt(11)
 v_mfma_f32_16x16x32_bf16 v[228:231], a[208:211], a[184:187], v[228:231]
 v_add_f32 v111, v111, v11
 v_mfma_f32_16x16x32_bf16 v[228:231], a[212:215], a[188:191], v[228:231]
 global_load_dwordx4 a[204:207], v0, s[70:71] offset:3072 sc1
 v_mfma_f32_16x16x32_bf16 v[224:227], a[212:215], a[180:183], v[224:227]
 ds_read_b128 v[8:11], v4 offset:144
 v_mfma_f32_16x16x32_bf16 v[224:227], a[208:211], a[176:179], v[224:227]
 global_load_dwordx4 a[200:203], v0, s[70:71] offset:2048 sc1
 v_mfma_f32_16x16x32_bf16 v[220:223], a[208:211], a[168:171], v[220:223]
 s_add_u32 s70, s70, 8192
 s_addc_u32 s71, s71, 0
 v_mfma_f32_16x16x32_bf16 v[220:223], a[212:215], a[172:175], v[220:223]
 v_mfma_f32_16x16x32_bf16 v[216:219], a[212:215], a[164:167], v[216:219]
 s_waitcnt lgkmcnt(1)
 v_mfma_f32_16x16x32_bf16 v[216:219], a[208:211], a[160:163], v[216:219]
 v_mfma_f32_16x16x32_bf16 v[212:215], a[208:211], a[152:155], v[212:215]
 v_mfma_f32_16x16x32_bf16 v[212:215], a[212:215], a[156:159], v[212:215]
 buffer_store_dwordx4 v[12:15], v3, s[32:35], s69 offen offset:1024 sc1
 v_mfma_f32_16x16x32_bf16 v[208:211], a[212:215], a[148:151], v[208:211]
 v_mfma_f32_16x16x32_bf16 v[208:211], a[208:211], a[144:147], v[208:211]
 v_mfma_f32_16x16x32_bf16 v[204:207], a[208:211], a[136:139], v[204:207]
 s_waitcnt lgkmcnt(0)
 v_mfma_f32_16x16x32_bf16 v[204:207], a[212:215], a[140:143], v[204:207]
 v_add_f32 v112, v112, v8
 v_mfma_f32_16x16x32_bf16 v[200:203], a[212:215], a[132:135], v[200:203]
 v_add_f32 v113, v113, v9
 v_mfma_f32_16x16x32_bf16 v[200:203], a[208:211], a[128:131], v[200:203]
 v_add_f32 v114, v114, v10
 v_add_f32 v115, v115, v11
 s_waitcnt vmcnt(11)
 v_mfma_f32_16x16x32_bf16 v[232:235], a[216:219], a[128:131], v[232:235]
 ds_read_b128 a[128:131], v1
 ds_read_b128 v[12:15], v3 offset:22528
 v_mfma_f32_16x16x32_bf16 v[232:235], a[220:223], a[132:135], v[232:235]
 global_load_dwordx4 a[212:215], v0, s[70:71] offset:-3072 sc1
 ds_read_b128 a[132:135], v1 offset:1024
 v_mfma_f32_16x16x32_bf16 v[236:239], a[220:223], a[140:143], v[236:239]
 ds_read_b128 a[140:143], v1 offset:5120
 v_add_f32 v116, v116, v8
 v_mfma_f32_16x16x32_bf16 v[236:239], a[216:219], a[136:139], v[236:239]
 global_load_dwordx4 a[208:211], v0, s[70:71] offset:-4096 sc1
 ds_read_b128 a[136:139], v1 offset:4096
 v_mfma_f32_16x16x32_bf16 v[240:243], a[216:219], a[144:147], v[240:243]
 ds_read_b128 a[144:147], v1 offset:8192
 v_add_f32 v117, v117, v9
 v_mfma_f32_16x16x32_bf16 v[240:243], a[220:223], a[148:151], v[240:243]
 ds_read_b128 a[148:151], v1 offset:9216
 v_add_f32 v118, v118, v10
 v_mfma_f32_16x16x32_bf16 v[244:247], a[220:223], a[156:159], v[244:247]
 ds_read_b128 a[156:159], v1 offset:13312
 v_add_f32 v119, v119, v11
 v_mfma_f32_16x16x32_bf16 v[244:247], a[216:219], a[152:155], v[244:247]
 ds_read_b128 a[152:155], v1 offset:12288
 v_add_f32 v120, v120, v8
 v_mfma_f32_16x16x32_bf16 v[248:251], a[216:219], a[160:163], v[248:251]
 ds_read_b128 a[160:163], v1 offset:16384
 v_add_f32 v121, v121, v9
 v_mfma_f32_16x16x32_bf16 v[248:251], a[220:223], a[164:167], v[248:251]
 ds_read_b128 a[164:167], v1 offset:17408
 v_add_f32 v122, v122, v10
 v_mfma_f32_16x16x32_bf16 v[252:255], a[220:223], a[172:175], v[252:255]
 ds_read_b128 a[172:175], v1 offset:21504
 v_mfma_f32_16x16x32_bf16 v[252:255], a[216:219], a[168:171], v[252:255]
 ds_read_b128 a[168:171], v1 offset:20480
 v_add_f32 v123, v123, v11
 v_mfma_f32_16x16x32_bf16 a[248:251], a[216:219], a[176:179], a[248:251]
 ds_read_b128 a[176:179], v1 offset:24576
 v_add_f32 v124, v124, v8
 v_mfma_f32_16x16x32_bf16 a[248:251], a[220:223], a[180:183], a[248:251]
 ds_read_b128 a[180:183], v1 offset:25600
 v_add_f32 v125, v125, v9
 v_mfma_f32_16x16x32_bf16 a[252:255], a[220:223], a[188:191], a[252:255]
 ds_read_b128 a[188:191], v1 offset:29696
 v_add_f32 v126, v126, v10
 v_mfma_f32_16x16x32_bf16 a[252:255], a[216:219], a[184:187], a[252:255]
 ds_read_b128 a[184:187], v1 offset:28672
 s_waitcnt vmcnt(10) lgkmcnt(8)
 v_mfma_f32_16x16x32_bf16 v[136:139], a[224:227], a[128:131], v[136:139]
 v_add_f32 v127, v127, v11
 v_mfma_f32_16x16x32_bf16 v[136:139], a[228:231], a[132:135], v[136:139]
 global_load_dwordx4 a[220:223], v0, s[70:71] offset:-1024 sc1
 v_add_f32 v128, v128, v8
 v_mfma_f32_16x16x32_bf16 v[140:143], a[228:231], a[140:143], v[140:143]
 v_add_f32 v129, v129, v9
 v_mfma_f32_16x16x32_bf16 v[140:143], a[224:227], a[136:139], v[140:143]
 global_load_dwordx4 a[216:219], v0, s[70:71] offset:-2048 sc1
 v_add_f32 v130, v130, v10
 v_mfma_f32_16x16x32_bf16 v[144:147], a[224:227], a[144:147], v[144:147]
 v_add_f32 v131, v131, v11
 v_mfma_f32_16x16x32_bf16 v[144:147], a[228:231], a[148:151], v[144:147]
 buffer_store_dwordx4 v[12:15], v3, s[32:35], s69 offen offset:2048 sc1
 v_mfma_f32_16x16x32_bf16 v[148:151], a[228:231], a[156:159], v[148:151]
 buffer_load_dword v4, off, s[64:67], 0 sc1
 v_mfma_f32_16x16x32_bf16 v[148:151], a[224:227], a[152:155], v[148:151]
 v_add_f32 v132, v132, v8
 s_waitcnt lgkmcnt(0)
 v_mfma_f32_16x16x32_bf16 v[152:155], a[224:227], a[160:163], v[152:155]
 v_add_f32 v133, v133, v9
 v_mfma_f32_16x16x32_bf16 v[152:155], a[228:231], a[164:167], v[152:155]
 v_mfma_f32_16x16x32_bf16 v[156:159], a[228:231], a[172:175], v[156:159]
 v_add_f32 v134, v134, v10
 v_mfma_f32_16x16x32_bf16 v[156:159], a[224:227], a[168:171], v[156:159]
 v_add_f32 v135, v135, v11
 v_mfma_f32_16x16x32_bf16 v[160:163], a[224:227], a[176:179], v[160:163]
 ds_read_b128 v[12:15], v3 offset:23552
 v_mfma_f32_16x16x32_bf16 v[160:163], a[228:231], a[180:183], v[160:163]
 v_accvgpr_read_b32 v5, a240
 v_mfma_f32_16x16x32_bf16 v[164:167], a[228:231], a[188:191], v[164:167]
 v_add_f32 v5, v5, v8
 v_mfma_f32_16x16x32_bf16 v[164:167], a[224:227], a[184:187], v[164:167]
 v_accvgpr_write_b32 a240, v5
 s_waitcnt vmcnt(12)
 v_mfma_f32_16x16x32_bf16 v[196:199], a[232:235], a[184:187], v[196:199]
 v_accvgpr_read_b32 v6, a241
 v_mfma_f32_16x16x32_bf16 v[196:199], a[236:239], a[188:191], v[196:199]
 global_load_dwordx4 a[228:231], v0, s[70:71] offset:1024 sc1
 v_add_f32 v6, v6, v9
 v_mfma_f32_16x16x32_bf16 v[192:195], a[236:239], a[180:183], v[192:195]
 v_accvgpr_write_b32 a241, v6
 v_mfma_f32_16x16x32_bf16 v[192:195], a[232:235], a[176:179], v[192:195]
 global_load_dwordx4 a[224:227], v0, s[70:71] offset:0 sc1
 v_mfma_f32_16x16x32_bf16 v[188:191], a[232:235], a[168:171], v[188:191]
 v_accvgpr_read_b32 v5, a242
 v_mfma_f32_16x16x32_bf16 v[188:191], a[236:239], a[172:175], v[188:191]
 v_add_f32 v5, v5, v10
 v_mfma_f32_16x16x32_bf16 v[184:187], a[236:239], a[164:167], v[184:187]
 v_accvgpr_write_b32 a242, v5
 v_mfma_f32_16x16x32_bf16 v[184:187], a[232:235], a[160:163], v[184:187]
 v_accvgpr_read_b32 v6, a243
 v_mfma_f32_16x16x32_bf16 v[180:183], a[232:235], a[152:155], v[180:183]
 v_mfma_f32_16x16x32_bf16 v[180:183], a[236:239], a[156:159], v[180:183]
 v_add_f32 v6, v6, v11
 v_mfma_f32_16x16x32_bf16 v[176:179], a[236:239], a[148:151], v[176:179]
 v_accvgpr_write_b32 a243, v6
 v_mfma_f32_16x16x32_bf16 v[176:179], a[232:235], a[144:147], v[176:179]
 v_accvgpr_read_b32 v5, a244
 v_mfma_f32_16x16x32_bf16 v[172:175], a[232:235], a[136:139], v[172:175]
 v_add_f32 v5, v5, v8
 v_mfma_f32_16x16x32_bf16 v[172:175], a[236:239], a[140:143], v[172:175]
 v_mfma_f32_16x16x32_bf16 v[168:171], a[236:239], a[132:135], v[168:171]
 v_accvgpr_write_b32 a244, v5
 v_mfma_f32_16x16x32_bf16 v[168:171], a[232:235], a[128:131], v[168:171]
 v_accvgpr_read_b32 v6, a245
 s_waitcnt lgkmcnt(0)
 s_waitcnt vmcnt(11)
 v_mfma_f32_16x16x32_bf16 v[200:203], a[192:195], a[128:131], v[200:203]
 v_add_f32 v6, v6, v9
 v_mfma_f32_16x16x32_bf16 v[200:203], a[196:199], a[132:135], v[200:203]
 global_load_dwordx4 a[236:239], v0, s[70:71] offset:3072 sc1
 v_accvgpr_write_b32 a245, v6
 v_mfma_f32_16x16x32_bf16 v[204:207], a[196:199], a[140:143], v[204:207]
 v_accvgpr_read_b32 v5, a246
 v_mfma_f32_16x16x32_bf16 v[204:207], a[192:195], a[136:139], v[204:207]
 global_load_dwordx4 a[232:235], v0, s[70:71] offset:2048 sc1
 v_add_f32 v5, v5, v10
 v_mfma_f32_16x16x32_bf16 v[208:211], a[192:195], a[144:147], v[208:211]
 buffer_store_dwordx4 v[12:15], v3, s[32:35], s69 offen offset:3072 sc1
 s_add_u32 s70, s70, 8192
 s_addc_u32 s71, s71, 0
 v_mfma_f32_16x16x32_bf16 v[208:211], a[196:199], a[148:151], v[208:211]
 v_accvgpr_write_b32 a246, v5
 v_mfma_f32_16x16x32_bf16 v[212:215], a[196:199], a[156:159], v[212:215]
 v_accvgpr_read_b32 v6, a247
 v_mfma_f32_16x16x32_bf16 v[212:215], a[192:195], a[152:155], v[212:215]
 v_mfma_f32_16x16x32_bf16 v[216:219], a[192:195], a[160:163], v[216:219]
 v_add_f32 v6, v6, v11
 v_mfma_f32_16x16x32_bf16 v[216:219], a[196:199], a[164:167], v[216:219]
 v_accvgpr_write_b32 a247, v6
 v_mfma_f32_16x16x32_bf16 v[220:223], a[196:199], a[172:175], v[220:223]
 s_waitcnt vmcnt(5)
 v_cmp_gt_i32 vcc, s55, v4
 s_and_b64 vcc, exec, vcc
 s_cbranch_vccnz Lspin_pa
Lok_pa:
 s_add_u32 s55, s55, 1
 s_waitcnt lgkmcnt(0)
 s_barrier
 v_mfma_f32_16x16x32_bf16 v[220:223], a[192:195], a[168:171], v[220:223]
 v_mfma_f32_16x16x32_bf16 v[224:227], a[192:195], a[176:179], v[224:227]
 v_mfma_f32_16x16x32_bf16 v[224:227], a[196:199], a[180:183], v[224:227]
 v_mfma_f32_16x16x32_bf16 v[228:231], a[196:199], a[188:191], v[228:231]
 v_mfma_f32_16x16x32_bf16 v[228:231], a[192:195], a[184:187], v[228:231]
 v_mfma_f32_16x16x32_bf16 a[252:255], a[200:203], a[184:187], a[252:255]
 ds_read_b128 a[184:187], v1 offset:30720
 v_mfma_f32_16x16x32_bf16 a[252:255], a[204:207], a[188:191], a[252:255]
 global_load_dwordx4 a[196:199], v0, s[70:71] offset:-3072 sc1
 ds_read_b128 a[188:191], v1 offset:31744
 v_mfma_f32_16x16x32_bf16 a[248:251], a[204:207], a[180:183], a[248:251]
 ds_read_b128 a[180:183], v1 offset:27648
 v_mfma_f32_16x16x32_bf16 a[248:251], a[200:203], a[176:179], a[248:251]
 global_load_dwordx4 a[192:195], v0, s[70:71] offset:-4096 sc1
 ds_read_b128 a[176:179], v1 offset:26624
 v_mfma_f32_16x16x32_bf16 v[252:255], a[200:203], a[168:171], v[252:255]
 ds_read_b128 a[168:171], v1 offset:22528
 v_mfma_f32_16x16x32_bf16 v[252:255], a[204:207], a[172:175], v[252:255]
 ds_read_b128 a[172:175], v1 offset:23552
 v_mfma_f32_16x16x32_bf16 v[248:251], a[204:207], a[164:167], v[248:251]
 ds_read_b128 a[164:167], v1 offset:19456
 v_mfma_f32_16x16x32_bf16 v[248:251], a[200:203], a[160:163], v[248:251]
 ds_read_b128 a[160:163], v1 offset:18432
 v_mfma_f32_16x16x32_bf16 v[244:247], a[200:203], a[152:155], v[244:247]
 ds_read_b128 a[152:155], v1 offset:14336
 v_mfma_f32_16x16x32_bf16 v[244:247], a[204:207], a[156:159], v[244:247]
 ds_read_b128 a[156:159], v1 offset:15360
 v_mfma_f32_16x16x32_bf16 v[240:243], a[204:207], a[148:151], v[240:243]
 ds_read_b128 a[148:151], v1 offset:11264
 v_mfma_f32_16x16x32_bf16 v[240:243], a[200:203], a[144:147], v[240:243]
 ds_read_b128 a[144:147], v1 offset:10240
 v_mfma_f32_16x16x32_bf16 v[236:239], a[200:203], a[136:139], v[236:239]
 ds_read_b128 a[136:139], v1 offset:6144
 v_mfma_f32_16x16x32_bf16 v[236:239], a[204:207], a[140:143], v[236:239]
 ds_read_b128 a[140:143], v1 offset:7168
 v_mfma_f32_16x16x32_bf16 v[232:235], a[204:207], a[132:135], v[232:235]
 global_load_dwordx4 a[204:207], v0, s[70:71] offset:-1024 sc1
 ds_read_b128 a[132:135], v1 offset:3072
 v_mfma_f32_16x16x32_bf16 v[232:235], a[200:203], a[128:131], v[232:235]
 global_load_dwordx4 a[200:203], v0, s[70:71] offset:-2048 sc1
 ds_read_b128 a[128:131], v1 offset:2048
 s_waitcnt lgkmcnt(8)
 s_branch Lloop
Llast:
 v_mfma_f32_16x16x32_bf16 v[136:139], a[208:211], a[128:131], v[136:139]
 v_accvgpr_read_b32 v5, a0
 v_lshlrev_b32 v6, 16, v5
 v_mfma_f32_16x16x32_bf16 v[136:139], a[212:215], a[132:135], v[136:139]
 v_and_b32 v5, s26, v5
 v_mul_f32 v6, v6, v16
 v_mfma_f32_16x16x32_bf16 v[140:143], a[212:215], a[140:143], v[140:143]
 v_mul_f32 v5, v5, v17
 v_cvt_pk_bf16_f32 v8, v6, v5
 v_mfma_f32_16x16x32_bf16 v[140:143], a[208:211], a[136:139], v[140:143]
 v_accvgpr_read_b32 v5, a1
 v_lshlrev_b32 v6, 16, v5
 v_mfma_f32_16x16x32_bf16 v[144:147], a[208:211], a[144:147], v[144:147]
 v_and_b32 v5, s26, v5
 v_mul_f32 v6, v6, v18
 v_mfma_f32_16x16x32_bf16 v[144:147], a[212:215], a[148:151], v[144:147]
 v_mul_f32 v5, v5, v19
 v_cvt_pk_bf16_f32 v9, v6, v5
 v_mfma_f32_16x16x32_bf16 v[148:151], a[212:215], a[156:159], v[148:151]
 v_accvgpr_read_b32 v5, a2
 v_lshlrev_b32 v6, 16, v5
 v_mfma_f32_16x16x32_bf16 v[148:151], a[208:211], a[152:155], v[148:151]
 v_and_b32 v5, s26, v5
 v_mul_f32 v6, v6, v48
 v_mfma_f32_16x16x32_bf16 v[152:155], a[208:211], a[160:163], v[152:155]
 v_mul_f32 v5, v5, v49
 v_cvt_pk_bf16_f32 v10, v6, v5
 v_mfma_f32_16x16x32_bf16 v[152:155], a[212:215], a[164:167], v[152:155]
 v_accvgpr_read_b32 v5, a3
 v_lshlrev_b32 v6, 16, v5
 v_mfma_f32_16x16x32_bf16 v[156:159], a[212:215], a[172:175], v[156:159]
 v_and_b32 v5, s26, v5
 v_mul_f32 v6, v6, v50
 v_mfma_f32_16x16x32_bf16 v[156:159], a[208:211], a[168:171], v[156:159]
 v_mul_f32 v5, v5, v51
 v_cvt_pk_bf16_f32 v11, v6, v5
 v_mfma_f32_16x16x32_bf16 v[160:163], a[208:211], a[176:179], v[160:163]
 v_lshrrev_b32 v5, 7, v1
 v_lshlrev_b32 v6, 4, v5
 v_mfma_f32_16x16x32_bf16 v[160:163], a[212:215], a[180:183], v[160:163]
 v_xor_b32 v6, v6, v1
 v_and_b32 v6, 112, v6
 v_mfma_f32_16x16x32_bf16 v[164:167], a[212:215], a[188:191], v[164:167]
 v_lshl_add_u32 v16, v5, 11, v6
 v_lshrrev_b32 v5, 4, v1
 v_mfma_f32_16x16x32_bf16 v[164:167], a[208:211], a[184:187], v[164:167]
 v_and_b32 v5, 48, v5
 v_xor_b32 v5, v5, v1
 s_waitcnt vmcnt(8)
 v_mfma_f32_16x16x32_bf16 v[196:199], a[216:219], a[184:187], v[196:199]
 v_and_b32 v5, 112, v5
 v_and_b32 v6, 240, v1
 v_mfma_f32_16x16x32_bf16 v[196:199], a[220:223], a[188:191], v[196:199]
 global_load_dwordx4 a[212:215], v0, s[70:71] offset:1024 sc1
 v_lshl_add_u32 v5, v6, 3, v5
 v_mfma_f32_16x16x32_bf16 v[192:195], a[220:223], a[180:183], v[192:195]
 v_add_u32 v17, s50, v5
 v_xor_b32 v18, 64, v17
 v_mfma_f32_16x16x32_bf16 v[192:195], a[216:219], a[176:179], v[192:195]
 global_load_dwordx4 a[208:211], v0, s[70:71] offset:0 sc1
 ds_write_b128 v17, v[8:11]
 v_mfma_f32_16x16x32_bf16 v[188:191], a[216:219], a[168:171], v[188:191]
 v_accvgpr_read_b32 v5, a32
 v_lshlrev_b32 v6, 16, v5
 v_mfma_f32_16x16x32_bf16 v[188:191], a[220:223], a[172:175], v[188:191]
 v_and_b32 v5, s26, v5
 v_mul_f32 v6, v6, v80
 v_mfma_f32_16x16x32_bf16 v[184:187], a[220:223], a[164:167], v[184:187]
 v_mul_f32 v5, v5, v81
 v_cvt_pk_bf16_f32 v12, v6, v5
 v_mfma_f32_16x16x32_bf16 v[184:187], a[216:219], a[160:163], v[184:187]
 v_accvgpr_read_b32 v5, a33
 v_lshlrev_b32 v6, 16, v5
 v_mfma_f32_16x16x32_bf16 v[180:183], a[216:219], a[152:155], v[180:183]
 v_and_b32 v5, s26, v5
 v_mul_f32 v6, v6, v82
 v_mfma_f32_16x16x32_bf16 v[180:183], a[220:223], a[156:159], v[180:183]
 v_mul_f32 v5, v5, v83
 v_cvt_pk_bf16_f32 v13, v6, v5
 v_mfma_f32_16x16x32_bf16 v[176:179], a[220:223], a[148:151], v[176:179]
 v_accvgpr_read_b32 v5, a34
 v_lshlrev_b32 v6, 16, v5
 v_mfma_f32_16x16x32_bf16 v[176:179], a[216:219], a[144:147], v[176:179]
 v_and_b32 v5, s26, v5
 v_mul_f32 v6, v6, v112
 v_mfma_f32_16x16x32_bf16 v[172:175], a[216:219], a[136:139], v[172:175]
 v_mul_f32 v5, v5, v113
 v_cvt_pk_bf16_f32 v14, v6, v5
 v_mfma_f32_16x16x32_bf16 v[172:175], a[220:223], a[140:143], v[172:175]
 v_accvgpr_read_b32 v5, a35
 v_lshlrev_b32 v6, 16, v5
 v_mfma_f32_16x16x32_bf16 v[168:171], a[220:223], a[132:135], v[168:171]
 v_and_b32 v5, s26, v5
 v_mul_f32 v6, v6, v114
 v_mfma_f32_16x16x32_bf16 v[168:171], a[216:219], a[128:131], v[168:171]
 v_mul_f32 v5, v5, v115
 v_cvt_pk_bf16_f32 v15, v6, v5
 s_waitcnt vmcnt(8)
 v_mfma_f32_16x16x32_bf16 v[200:203], a[224:227], a[128:131], v[200:203]
 ds_write_b128 v18, v[12:15]
 v_mfma_f32_16x16x32_bf16 v[200:203], a[228:231], a[132:135], v[200:203]
 global_load_dwordx4 a[220:223], v0, s[70:71] offset:3072 sc1
 ds_read_b128 v[48:51], v3
 v_mfma_f32_16x16x32_bf16 v[204:207], a[228:231], a[140:143], v[204:207]
 ds_read_b128 v[80:83], v3 offset:1024
 v_accvgpr_read_b32 v5, a4
 v_mfma_f32_16x16x32_bf16 v[204:207], a[224:227], a[136:139], v[204:207]
 global_load_dwordx4 a[216:219], v0, s[70:71] offset:2048 sc1
 v_lshlrev_b32 v6, 16, v5
 v_mfma_f32_16x16x32_bf16 v[208:211], a[224:227], a[144:147], v[208:211]
 v_and_b32 v5, s26, v5
 v_mul_f32 v6, v6, v20
 s_add_u32 s70, s70, 8192
 s_addc_u32 s71, s71, 0
 v_mfma_f32_16x16x32_bf16 v[208:211], a[228:231], a[148:151], v[208:211]
 v_mul_f32 v5, v5, v21
 v_cvt_pk_bf16_f32 v8, v6, v5
 v_mfma_f32_16x16x32_bf16 v[212:215], a[228:231], a[156:159], v[212:215]
 v_accvgpr_read_b32 v5, a5
 v_lshlrev_b32 v6, 16, v5
 v_mfma_f32_16x16x32_bf16 v[212:215], a[224:227], a[152:155], v[212:215]
 v_and_b32 v5, s26, v5
 v_mul_f32 v6, v6, v22
 v_mfma_f32_16x16x32_bf16 v[216:219], a[224:227], a[160:163], v[216:219]
 v_mul_f32 v5, v5, v23
 v_cvt_pk_bf16_f32 v9, v6, v5
 s_waitcnt lgkmcnt(1)
 s_add_u32 s3, s28, 0
 v_mfma_f32_16x16x32_bf16 v[216:219], a[228:231], a[164:167], v[216:219]
 buffer_store_dwordx4 v[48:51], v16, s[16:19], s3 offen nt
 s_waitcnt lgkmcnt(0)
 s_add_u32 s3, s28, 16384
 buffer_store_dwordx4 v[80:83], v16, s[16:19], s3 offen nt
 v_accvgpr_read_b32 v5, a6
 v_lshlrev_b32 v6, 16, v5
 v_and_b32 v5, s26, v5
 v_mfma_f32_16x16x32_bf16 v[220:223], a[228:231], a[172:175], v[220:223]
 v_mul_f32 v6, v6, v52
 v_mul_f32 v5, v5, v53
 v_mfma_f32_16x16x32_bf16 v[220:223], a[224:227], a[168:171], v[220:223]
 v_cvt_pk_bf16_f32 v10, v6, v5
 v_accvgpr_read_b32 v5, a7
 v_mfma_f32_16x16x32_bf16 v[224:227], a[224:227], a[176:179], v[224:227]
 v_lshlrev_b32 v6, 16, v5
 v_and_b32 v5, s26, v5
 v_mul_f32 v6, v6, v54
 v_mul_f32 v5, v5, v55
 v_cvt_pk_bf16_f32 v11, v6, v5
 v_mfma_f32_16x16x32_bf16 v[224:227], a[228:231], a[180:183], v[224:227]
 ds_write_b128 v17, v[8:11] offset:4096
 v_mfma_f32_16x16x32_bf16 v[228:231], a[228:231], a[188:191], v[228:231]
 v_accvgpr_read_b32 v5, a36
 v_lshlrev_b32 v6, 16, v5
 v_mfma_f32_16x16x32_bf16 v[228:231], a[224:227], a[184:187], v[228:231]
 v_and_b32 v5, s26, v5
 v_mul_f32 v6, v6, v84
 s_waitcnt vmcnt(10)
 v_mfma_f32_16x16x32_bf16 a[252:255], a[232:235], a[184:187], a[252:255]
 ds_read_b128 a[184:187], v2 offset:30720
 v_mul_f32 v5, v5, v85
 v_mfma_f32_16x16x32_bf16 a[252:255], a[236:239], a[188:191], a[252:255]
 global_load_dwordx4 a[228:231], v0, s[70:71] offset:-3072 sc1
 ds_read_b128 a[188:191], v2 offset:31744
 v_mfma_f32_16x16x32_bf16 a[248:251], a[236:239], a[180:183], a[248:251]
 ds_read_b128 a[180:183], v2 offset:27648
 v_cvt_pk_bf16_f32 v12, v6, v5
 v_mfma_f32_16x16x32_bf16 a[248:251], a[232:235], a[176:179], a[248:251]
 global_load_dwordx4 a[224:227], v0, s[70:71] offset:-4096 sc1
 ds_read_b128 a[176:179], v2 offset:26624
 v_mfma_f32_16x16x32_bf16 v[252:255], a[232:235], a[168:171], v[252:255]
 ds_read_b128 a[168:171], v2 offset:22528
 v_accvgpr_read_b32 v5, a37
 v_mfma_f32_16x16x32_bf16 v[252:255], a[236:239], a[172:175], v[252:255]
 ds_read_b128 a[172:175], v2 offset:23552
 v_lshlrev_b32 v6, 16, v5
 v_mfma_f32_16x16x32_bf16 v[248:251], a[236:239], a[164:167], v[248:251]
 ds_read_b128 a[164:167], v2 offset:19456
 v_and_b32 v5, s26, v5
 v_mfma_f32_16x16x32_bf16 v[248:251], a[232:235], a[160:163], v[248:251]
 ds_read_b128 a[160:163], v2 offset:18432
 v_mul_f32 v6, v6, v86
 v_mul_f32 v5, v5, v87
 v_mfma_f32_16x16x32_bf16 v[244:247], a[232:235], a[152:155], v[244:247]
 ds_read_b128 a[152:155], v2 offset:14336
 v_cvt_pk_bf16_f32 v13, v6, v5
 v_mfma_f32_16x16x32_bf16 v[244:247], a[236:239], a[156:159], v[244:247]
 ds_read_b128 a[156:159], v2 offset:15360
 v_accvgpr_read_b32 v5, a38
 v_lshlrev_b32 v6, 16, v5
 v_mfma_f32_16x16x32_bf16 v[240:243], a[236:239], a[148:151], v[240:243]
 ds_read_b128 a[148:151], v2 offset:11264
 v_and_b32 v5, s26, v5
 v_mul_f32 v6, v6, v116
 v_mfma_f32_16x16x32_bf16 v[240:243], a[232:235], a[144:147], v[240:243]
 ds_read_b128 a[144:147], v2 offset:10240
 v_mul_f32 v5, v5, v117
 v_cvt_pk_bf16_f32 v14, v6, v5
 v_mfma_f32_16x16x32_bf16 v[236:239], a[232:235], a[136:139], v[236:239]
 ds_read_b128 a[136:139], v2 offset:6144
 v_accvgpr_read_b32 v5, a39
 v_lshlrev_b32 v6, 16, v5
 v_mfma_f32_16x16x32_bf16 v[236:239], a[236:239], a[140:143], v[236:239]
 ds_read_b128 a[140:143], v2 offset:7168
 v_and_b32 v5, s26, v5
 v_mul_f32 v6, v6, v118
 v_mfma_f32_16x16x32_bf16 v[232:235], a[236:239], a[132:135], v[232:235]
 ds_read_b128 a[132:135], v2 offset:3072
 v_mul_f32 v5, v5, v119
 v_mfma_f32_16x16x32_bf16 v[232:235], a[232:235], a[128:131], v[232:235]
 ds_read_b128 a[128:131], v2 offset:2048
 v_cvt_pk_bf16_f32 v15, v6, v5
 s_waitcnt vmcnt(10) lgkmcnt(8)
 v_mfma_f32_16x16x32_bf16 v[164:167], a[192:195], a[184:187], v[164:167]
 ds_write_b128 v18, v[12:15] offset:4096
 v_mfma_f32_16x16x32_bf16 v[164:167], a[196:199], a[188:191], v[164:167]
 global_load_dwordx4 a[236:239], v0, s[70:71] offset:-1024 sc1
 ds_read_b128 v[48:51], v3 offset:4096
 v_mfma_f32_16x16x32_bf16 v[160:163], a[196:199], a[180:183], v[160:163]
 ds_read_b128 v[80:83], v3 offset:5120
 v_accvgpr_read_b32 v5, a8
 v_mfma_f32_16x16x32_bf16 v[160:163], a[192:195], a[176:179], v[160:163]
 global_load_dwordx4 a[232:235], v0, s[70:71] offset:-2048 sc1
 v_lshlrev_b32 v6, 16, v5
 v_mfma_f32_16x16x32_bf16 v[156:159], a[192:195], a[168:171], v[156:159]
 v_and_b32 v5, s26, v5
 v_mul_f32 v6, v6, v24
 v_mfma_f32_16x16x32_bf16 v[156:159], a[196:199], a[172:175], v[156:159]
 v_mul_f32 v5, v5, v25
 v_cvt_pk_bf16_f32 v8, v6, v5
 v_mfma_f32_16x16x32_bf16 v[152:155], a[196:199], a[164:167], v[152:155]
 v_accvgpr_read_b32 v5, a9
 v_lshlrev_b32 v6, 16, v5
 v_mfma_f32_16x16x32_bf16 v[152:155], a[192:195], a[160:163], v[152:155]
 v_and_b32 v5, s26, v5
 v_mul_f32 v6, v6, v26
 s_waitcnt lgkmcnt(3)
 v_mfma_f32_16x16x32_bf16 v[148:151], a[192:195], a[152:155], v[148:151]
 v_mul_f32 v5, v5, v27
 v_cvt_pk_bf16_f32 v9, v6, v5
 s_waitcnt lgkmcnt(1)
 s_add_u32 s3, s28, 32768
 v_mfma_f32_16x16x32_bf16 v[148:151], a[196:199], a[156:159], v[148:151]
 buffer_store_dwordx4 v[48:51], v16, s[16:19], s3 offen nt
 s_waitcnt lgkmcnt(0)
 s_add_u32 s3, s28, 49152
 buffer_store_dwordx4 v[80:83], v16, s[16:19], s3 offen nt
 v_accvgpr_read_b32 v5, a10
 v_lshlrev_b32 v6, 16, v5
 v_mfma_f32_16x16x32_bf16 v[144:147], a[196:199], a[148:151], v[144:147]
 v_and_b32 v5, s26, v5
 v_mul_f32 v6, v6, v56
 v_mfma_f32_16x16x32_bf16 v[144:147], a[192:195], a[144:147], v[144:147]
 v_mul_f32 v5, v5, v57
 v_cvt_pk_bf16_f32 v10, v6, v5
 v_mfma_f32_16x16x32_bf16 v[140:143], a[192:195], a[136:139], v[140:143]
 v_accvgpr_read_b32 v5, a11
 v_lshlrev_b32 v6, 16, v5
 v_mfma_f32_16x16x32_bf16 v[140:143], a[196:199], a[140:143], v[140:143]
 v_and_b32 v5, s26, v5
 v_mul_f32 v6, v6, v58
 v_mfma_f32_16x16x32_bf16 v[136:139], a[196:199], a[132:135], v[136:139]
 v_mul_f32 v5, v5, v59
 v_cvt_pk_bf16_f32 v11, v6, v5
 v_mfma_f32_16x16x32_bf16 v[136:139], a[192:195], a[128:131], v[136:139]
 ds_write_b128 v17, v[8:11] offset:8192
 s_waitcnt vmcnt(12)
 v_mfma_f32_16x16x32_bf16 v[168:171], a[200:203], a[128:131], v[168:171]
 v_accvgpr_read_b32 v5, a40
 v_lshlrev_b32 v6, 16, v5
 v_mfma_f32_16x16x32_bf16 v[168:171], a[204:207], a[132:135], v[168:171]
 global_load_dwordx4 a[196:199], v0, s[70:71] offset:1024 sc1
 v_and_b32 v5, s26, v5
 v_mfma_f32_16x16x32_bf16 v[172:175], a[204:207], a[140:143], v[172:175]
 v_mul_f32 v6, v6, v88
 v_mul_f32 v5, v5, v89
 v_mfma_f32_16x16x32_bf16 v[172:175], a[200:203], a[136:139], v[172:175]
 global_load_dwordx4 a[192:195], v0, s[70:71] offset:0 sc1
 v_cvt_pk_bf16_f32 v12, v6, v5
 v_mfma_f32_16x16x32_bf16 v[176:179], a[200:203], a[144:147], v[176:179]
 v_accvgpr_read_b32 v5, a41
 v_lshlrev_b32 v6, 16, v5
 v_mfma_f32_16x16x32_bf16 v[176:179], a[204:207], a[148:151], v[176:179]
 v_and_b32 v5, s26, v5
 v_mul_f32 v6, v6, v90
 v_mfma_f32_16x16x32_bf16 v[180:183], a[204:207], a[156:159], v[180:183]
 v_mul_f32 v5, v5, v91
 v_cvt_pk_bf16_f32 v13, v6, v5
 v_mfma_f32_16x16x32_bf16 v[180:183], a[200:203], a[152:155], v[180:183]
 v_accvgpr_read_b32 v5, a42
 v_lshlrev_b32 v6, 16, v5
 v_mfma_f32_16x16x32_bf16 v[184:187], a[200:203], a[160:163], v[184:187]
 v_and_b32 v5, s26, v5
 v_mul_f32 v6, v6, v120
 v_mfma_f32_16x16x32_bf16 v[184:187], a[204:207], a[164:167], v[184:187]
 v_mul_f32 v5, v5, v121
 v_cvt_pk_bf16_f32 v14, v6, v5
 v_mfma_f32_16x16x32_bf16 v[188:191], a[204:207], a[172:175], v[188:191]
 v_accvgpr_read_b32 v5, a43
 v_lshlrev_b32 v6, 16, v5
 v_mfma_f32_16x16x32_bf16 v[188:191], a[200:203], a[168:171], v[188:191]
 v_and_b32 v5, s26, v5
 v_mul_f32 v6, v6, v122
 v_mfma_f32_16x16x32_bf16 v[192:195], a[200:203], a[176:179], v[192:195]
 v_mul_f32 v5, v5, v123
 v_cvt_pk_bf16_f32 v15, v6, v5
 v_mfma_f32_16x16x32_bf16 v[192:195], a[204:207], a[180:183], v[192:195]
 ds_write_b128 v18, v[12:15] offset:8192
 v_mfma_f32_16x16x32_bf16 v[196:199], a[204:207], a[188:191], v[196:199]
 ds_read_b128 v[48:51], v3 offset:8192
 ds_read_b128 v[80:83], v3 offset:9216
 v_mfma_f32_16x16x32_bf16 v[196:199], a[200:203], a[184:187], v[196:199]
 v_accvgpr_read_b32 v5, a12
 v_lshlrev_b32 v6, 16, v5
 s_waitcnt vmcnt(12)
 v_mfma_f32_16x16x32_bf16 v[228:231], a[208:211], a[184:187], v[228:231]
 v_and_b32 v5, s26, v5
 v_mul_f32 v6, v6, v28
 v_mfma_f32_16x16x32_bf16 v[228:231], a[212:215], a[188:191], v[228:231]
 global_load_dwordx4 a[204:207], v0, s[70:71] offset:3072 sc1
 v_mul_f32 v5, v5, v29
 v_mfma_f32_16x16x32_bf16 v[224:227], a[212:215], a[180:183], v[224:227]
 v_cvt_pk_bf16_f32 v8, v6, v5
 v_accvgpr_read_b32 v5, a13
 v_mfma_f32_16x16x32_bf16 v[224:227], a[208:211], a[176:179], v[224:227]
 global_load_dwordx4 a[200:203], v0, s[70:71] offset:2048 sc1
 v_lshlrev_b32 v6, 16, v5
 v_mfma_f32_16x16x32_bf16 v[220:223], a[208:211], a[168:171], v[220:223]
 v_and_b32 v5, s26, v5
 v_mul_f32 v6, v6, v30
 s_add_u32 s70, s70, 8192
 s_addc_u32 s71, s71, 0
 v_mfma_f32_16x16x32_bf16 v[220:223], a[212:215], a[172:175], v[220:223]
 v_mul_f32 v5, v5, v31
 v_cvt_pk_bf16_f32 v9, v6, v5
 s_waitcnt lgkmcnt(1)
 s_add_u32 s3, s28, 65536
 v_mfma_f32_16x16x32_bf16 v[216:219], a[212:215], a[164:167], v[216:219]
 buffer_store_dwordx4 v[48:51], v16, s[16:19], s3 offen nt
 s_waitcnt lgkmcnt(0)
 s_add_u32 s3, s28, 81920
 buffer_store_dwordx4 v[80:83], v16, s[16:19], s3 offen nt
 v_accvgpr_read_b32 v5, a14
 v_lshlrev_b32 v6, 16, v5
 v_mfma_f32_16x16x32_bf16 v[216:219], a[208:211], a[160:163], v[216:219]
 v_and_b32 v5, s26, v5
 v_mul_f32 v6, v6, v60
 v_mfma_f32_16x16x32_bf16 v[212:215], a[208:211], a[152:155], v[212:215]
 v_mul_f32 v5, v5, v61
 v_cvt_pk_bf16_f32 v10, v6, v5
 v_mfma_f32_16x16x32_bf16 v[212:215], a[212:215], a[156:159], v[212:215]
 v_accvgpr_read_b32 v5, a15
 v_lshlrev_b32 v6, 16, v5
 v_mfma_f32_16x16x32_bf16 v[208:211], a[212:215], a[148:151], v[208:211]
 v_and_b32 v5, s26, v5
 v_mul_f32 v6, v6, v62
 v_mfma_f32_16x16x32_bf16 v[208:211], a[208:211], a[144:147], v[208:211]
 v_mul_f32 v5, v5, v63
 v_cvt_pk_bf16_f32 v11, v6, v5
 v_mfma_f32_16x16x32_bf16 v[204:207], a[208:211], a[136:139], v[204:207]
 ds_write_b128 v17, v[8:11] offset:12288
 v_mfma_f32_16x16x32_bf16 v[204:207], a[212:215], a[140:143], v[204:207]
 v_accvgpr_read_b32 v5, a44
 v_lshlrev_b32 v6, 16, v5
 v_mfma_f32_16x16x32_bf16 v[200:203], a[212:215], a[132:135], v[200:203]
 v_and_b32 v5, s26, v5
 v_mul_f32 v6, v6, v92
 v_mfma_f32_16x16x32_bf16 v[200:203], a[208:211], a[128:131], v[200:203]
 v_mul_f32 v5, v5, v93
 v_cvt_pk_bf16_f32 v12, v6, v5
 s_waitcnt vmcnt(14)
 v_mfma_f32_16x16x32_bf16 v[232:235], a[216:219], a[128:131], v[232:235]
 ds_read_b128 a[128:131], v1 offset:34816
 v_accvgpr_read_b32 v5, a45
 v_mfma_f32_16x16x32_bf16 v[232:235], a[220:223], a[132:135], v[232:235]
 global_load_dwordx4 a[212:215], v0, s[70:71] offset:-3072 sc1
 ds_read_b128 a[132:135], v1 offset:35840
 v_mfma_f32_16x16x32_bf16 v[236:239], a[220:223], a[140:143], v[236:239]
 ds_read_b128 a[140:143], v1 offset:39936
 v_lshlrev_b32 v6, 16, v5
 v_mfma_f32_16x16x32_bf16 v[236:239], a[216:219], a[136:139], v[236:239]
 global_load_dwordx4 a[208:211], v0, s[70:71] offset:-4096 sc1
 ds_read_b128 a[136:139], v1 offset:38912
 v_and_b32 v5, s26, v5
 v_mfma_f32_16x16x32_bf16 v[240:243], a[216:219], a[144:147], v[240:243]
 ds_read_b128 a[144:147], v1 offset:43008
 v_mul_f32 v6, v6, v94
 v_mul_f32 v5, v5, v95
 v_mfma_f32_16x16x32_bf16 v[240:243], a[220:223], a[148:151], v[240:243]
 ds_read_b128 a[148:151], v1 offset:44032
 v_cvt_pk_bf16_f32 v13, v6, v5
 v_mfma_f32_16x16x32_bf16 v[244:247], a[220:223], a[156:159], v[244:247]
 ds_read_b128 a[156:159], v1 offset:48128
 v_accvgpr_read_b32 v5, a46
 v_lshlrev_b32 v6, 16, v5
 v_mfma_f32_16x16x32_bf16 v[244:247], a[216:219], a[152:155], v[244:247]
 ds_read_b128 a[152:155], v1 offset:47104
 v_and_b32 v5, s26, v5
 v_mul_f32 v6, v6, v124
 v_mfma_f32_16x16x32_bf16 v[248:251], a[216:219], a[160:163], v[248:251]
 ds_read_b128 a[160:163], v1 offset:51200
 v_mul_f32 v5, v5, v125
 v_mfma_f32_16x16x32_bf16 v[248:251], a[220:223], a[164:167], v[248:251]
 ds_read_b128 a[164:167], v1 offset:52224
 v_cvt_pk_bf16_f32 v14, v6, v5
 v_mfma_f32_16x16x32_bf16 v[252:255], a[220:223], a[172:175], v[252:255]
 ds_read_b128 a[172:175], v1 offset:56320
 v_accvgpr_read_b32 v5, a47
 v_mfma_f32_16x16x32_bf16 v[252:255], a[216:219], a[168:171], v[252:255]
 ds_read_b128 a[168:171], v1 offset:55296
 v_lshlrev_b32 v6, 16, v5
 v_mfma_f32_16x16x32_bf16 a[248:251], a[216:219], a[176:179], a[248:251]
 ds_read_b128 a[176:179], v1 offset:59392
 v_and_b32 v5, s26, v5
 v_mfma_f32_16x16x32_bf16 a[248:251], a[220:223], a[180:183], a[248:251]
 ds_read_b128 a[180:183], v1 offset:60416
 v_mul_f32 v6, v6, v126
 v_mfma_f32_16x16x32_bf16 a[252:255], a[220:223], a[188:191], a[252:255]
 ds_read_b128 a[188:191], v1 offset:64512
 v_mul_f32 v5, v5, v127
 v_mfma_f32_16x16x32_bf16 a[252:255], a[216:219], a[184:187], a[252:255]
 ds_read_b128 a[184:187], v1 offset:63488
 v_cvt_pk_bf16_f32 v15, v6, v5
 s_waitcnt vmcnt(12) lgkmcnt(8)
 v_mfma_f32_16x16x32_bf16 v[136:139], a[224:227], a[128:131], v[136:139]
 ds_write_b128 v18, v[12:15] offset:12288
 ds_read_b128 v[48:51], v3 offset:12288
 ds_read_b128 v[80:83], v3 offset:13312
 v_accvgpr_read_b32 v5, a16
 v_lshlrev_b32 v6, 16, v5
 v_mfma_f32_16x16x32_bf16 v[136:139], a[228:231], a[132:135], v[136:139]
 global_load_dwordx4 a[220:223], v0, s[70:71] offset:-1024 sc1
 v_and_b32 v5, s26, v5
 v_mfma_f32_16x16x32_bf16 v[140:143], a[228:231], a[140:143], v[140:143]
 v_mul_f32 v6, v6, v32
 v_mul_f32 v5, v5, v33
 v_mfma_f32_16x16x32_bf16 v[140:143], a[224:227], a[136:139], v[140:143]
 global_load_dwordx4 a[216:219], v0, s[70:71] offset:-2048 sc1
 v_cvt_pk_bf16_f32 v8, v6, v5
 v_mfma_f32_16x16x32_bf16 v[144:147], a[224:227], a[144:147], v[144:147]
 v_accvgpr_read_b32 v5, a17
 v_lshlrev_b32 v6, 16, v5
 v_mfma_f32_16x16x32_bf16 v[144:147], a[228:231], a[148:151], v[144:147]
 v_and_b32 v5, s26, v5
 v_mul_f32 v6, v6, v34
 v_mfma_f32_16x16x32_bf16 v[148:151], a[228:231], a[156:159], v[148:151]
 v_mul_f32 v5, v5, v35
 v_cvt_pk_bf16_f32 v9, v6, v5
 s_waitcnt lgkmcnt(1)
 s_add_u32 s3, s28, 98304
 v_mfma_f32_16x16x32_bf16 v[148:151], a[224:227], a[152:155], v[148:151]
 buffer_store_dwordx4 v[48:51], v16, s[16:19], s3 offen nt
 s_waitcnt lgkmcnt(0)
 s_add_u32 s3, s28, 114688
 buffer_store_dwordx4 v[80:83], v16, s[16:19], s3 offen nt
 v_accvgpr_read_b32 v5, a18
 v_lshlrev_b32 v6, 16, v5
 v_mfma_f32_16x16x32_bf16 v[152:155], a[224:227], a[160:163], v[152:155]
 v_and_b32 v5, s26, v5
 v_mul_f32 v6, v6, v64
 v_mfma_f32_16x16x32_bf16 v[152:155], a[228:231], a[164:167], v[152:155]
 v_mul_f32 v5, v5, v65
 v_cvt_pk_bf16_f32 v10, v6, v5
 v_mfma_f32_16x16x32_bf16 v[156:159], a[228:231], a[172:175], v[156:159]
 v_accvgpr_read_b32 v5, a19
 v_lshlrev_b32 v6, 16, v5
 v_mfma_f32_16x16x32_bf16 v[156:159], a[224:227], a[168:171], v[156:159]
 v_and_b32 v5, s26, v5
 v_mul_f32 v6, v6, v66
 v_mfma_f32_16x16x32_bf16 v[160:163], a[224:227], a[176:179], v[160:163]
 v_mul_f32 v5, v5, v67
 v_cvt_pk_bf16_f32 v11, v6, v5
 v_mfma_f32_16x16x32_bf16 v[160:163], a[228:231], a[180:183], v[160:163]
 ds_write_b128 v17, v[8:11] offset:16384
 v_mfma_f32_16x16x32_bf16 v[164:167], a[228:231], a[188:191], v[164:167]
 v_accvgpr_read_b32 v5, a48
 v_lshlrev_b32 v6, 16, v5
 v_mfma_f32_16x16x32_bf16 v[164:167], a[224:227], a[184:187], v[164:167]
 v_and_b32 v5, s26, v5
 v_mul_f32 v6, v6, v96
 s_waitcnt vmcnt(14)
 v_mfma_f32_16x16x32_bf16 v[196:199], a[232:235], a[184:187], v[196:199]
 v_mul_f32 v5, v5, v97
 v_cvt_pk_bf16_f32 v12, v6, v5
 v_mfma_f32_16x16x32_bf16 v[196:199], a[236:239], a[188:191], v[196:199]
 global_load_dwordx4 a[228:231], v0, s[70:71] offset:1024 sc1
 v_accvgpr_read_b32 v5, a49
 v_mfma_f32_16x16x32_bf16 v[192:195], a[236:239], a[180:183], v[192:195]
 v_lshlrev_b32 v6, 16, v5
 v_and_b32 v5, s26, v5
 v_mfma_f32_16x16x32_bf16 v[192:195], a[232:235], a[176:179], v[192:195]
 global_load_dwordx4 a[224:227], v0, s[70:71] offset:0 sc1
 v_mul_f32 v6, v6, v98
 v_mfma_f32_16x16x32_bf16 v[188:191], a[232:235], a[168:171], v[188:191]
 v_mul_f32 v5, v5, v99
 v_cvt_pk_bf16_f32 v13, v6, v5
 v_mfma_f32_16x16x32_bf16 v[188:191], a[236:239], a[172:175], v[188:191]
 v_accvgpr_read_b32 v5, a50
 v_lshlrev_b32 v6, 16, v5
 v_mfma_f32_16x16x32_bf16 v[184:187], a[236:239], a[164:167], v[184:187]
 v_and_b32 v5, s26, v5
 v_mul_f32 v6, v6, v128
 v_mfma_f32_16x16x32_bf16 v[184:187], a[232:235], a[160:163], v[184:187]
 v_mul_f32 v5, v5, v129
 v_cvt_pk_bf16_f32 v14, v6, v5
 v_mfma_f32_16x16x32_bf16 v[180:183], a[232:235], a[152:155], v[180:183]
 v_accvgpr_read_b32 v5, a51
 v_lshlrev_b32 v6, 16, v5
 v_mfma_f32_16x16x32_bf16 v[180:183], a[236:239], a[156:159], v[180:183]
 v_and_b32 v5, s26, v5
 v_mul_f32 v6, v6, v130
 v_mfma_f32_16x16x32_bf16 v[176:179], a[236:239], a[148:151], v[176:179]
 v_mul_f32 v5, v5, v131
 v_cvt_pk_bf16_f32 v15, v6, v5
 v_mfma_f32_16x16x32_bf16 v[176:179], a[232:235], a[144:147], v[176:179]
 ds_write_b128 v18, v[12:15] offset:16384
 v_mfma_f32_16x16x32_bf16 v[172:175], a[232:235], a[136:139], v[172:175]
 ds_read_b128 v[48:51], v3 offset:16384
 ds_read_b128 v[80:83], v3 offset:17408
 v_mfma_f32_16x16x32_bf16 v[172:175], a[236:239], a[140:143], v[172:175]
 v_accvgpr_read_b32 v5, a20
 v_lshlrev_b32 v6, 16, v5
 v_mfma_f32_16x16x32_bf16 v[168:171], a[236:239], a[132:135], v[168:171]
 v_and_b32 v5, s26, v5
 v_mul_f32 v6, v6, v36
 v_mfma_f32_16x16x32_bf16 v[168:171], a[232:235], a[128:131], v[168:171]
 v_mul_f32 v5, v5, v37
 v_cvt_pk_bf16_f32 v8, v6, v5
 s_waitcnt vmcnt(12)
 v_mfma_f32_16x16x32_bf16 v[200:203], a[192:195], a[128:131], v[200:203]
 v_accvgpr_read_b32 v5, a21
 v_lshlrev_b32 v6, 16, v5
 v_mfma_f32_16x16x32_bf16 v[200:203], a[196:199], a[132:135], v[200:203]
 global_load_dwordx4 a[236:239], v0, s[70:71] offset:3072 sc1
 v_and_b32 v5, s26, v5
 v_mfma_f32_16x16x32_bf16 v[204:207], a[196:199], a[140:143], v[204:207]
 v_mul_f32 v6, v6, v38
 v_mul_f32 v5, v5, v39
 v_mfma_f32_16x16x32_bf16 v[204:207], a[192:195], a[136:139], v[204:207]
 global_load_dwordx4 a[232:235], v0, s[70:71] offset:2048 sc1
 v_cvt_pk_bf16_f32 v9, v6, v5
 s_waitcnt lgkmcnt(1)
 s_add_u32 s3, s28, 131072
 v_mfma_f32_16x16x32_bf16 v[208:211], a[192:195], a[144:147], v[208:211]
 buffer_store_dwordx4 v[48:51], v16, s[16:19], s3 offen nt
 s_waitcnt lgkmcnt(0)
 s_add_u32 s3, s28, 147456
 buffer_store_dwordx4 v[80:83], v16, s[16:19], s3 offen nt
 v_accvgpr_read_b32 v5, a22
 v_lshlrev_b32 v6, 16, v5
 s_add_u32 s70, s70, 1843200
 s_addc_u32 s71, s71, 0
 v_mfma_f32_16x16x32_bf16 v[208:211], a[196:199], a[148:151], v[208:211]
 v_and_b32 v5, s26, v5
 v_mul_f32 v6, v6, v68
 v_mfma_f32_16x16x32_bf16 v[212:215], a[196:199], a[156:159], v[212:215]
 v_mul_f32 v5, v5, v69
 v_cvt_pk_bf16_f32 v10, v6, v5
 v_mfma_f32_16x16x32_bf16 v[212:215], a[192:195], a[152:155], v[212:215]
 v_accvgpr_read_b32 v5, a23
 v_lshlrev_b32 v6, 16, v5
 v_mfma_f32_16x16x32_bf16 v[216:219], a[192:195], a[160:163], v[216:219]
 v_and_b32 v5, s26, v5
 v_mul_f32 v6, v6, v70
 v_mfma_f32_16x16x32_bf16 v[216:219], a[196:199], a[164:167], v[216:219]
 v_mul_f32 v5, v5, v71
 v_cvt_pk_bf16_f32 v11, v6, v5
 v_mfma_f32_16x16x32_bf16 v[220:223], a[196:199], a[172:175], v[220:223]
 ds_write_b128 v17, v[8:11] offset:20480
 v_mfma_f32_16x16x32_bf16 v[220:223], a[192:195], a[168:171], v[220:223]
 v_accvgpr_read_b32 v5, a52
 v_lshlrev_b32 v6, 16, v5
 v_mfma_f32_16x16x32_bf16 v[224:227], a[192:195], a[176:179], v[224:227]
 v_and_b32 v5, s26, v5
 v_mul_f32 v6, v6, v100
 v_mfma_f32_16x16x32_bf16 v[224:227], a[196:199], a[180:183], v[224:227]
 v_mul_f32 v5, v5, v101
 v_cvt_pk_bf16_f32 v12, v6, v5
 v_mfma_f32_16x16x32_bf16 v[228:231], a[196:199], a[188:191], v[228:231]
 v_accvgpr_read_b32 v5, a53
 v_lshlrev_b32 v6, 16, v5
 v_mfma_f32_16x16x32_bf16 v[228:231], a[192:195], a[184:187], v[228:231]
 v_and_b32 v5, s26, v5
 v_mul_f32 v6, v6, v102
 s_waitcnt vmcnt(14)
 v_mfma_f32_16x16x32_bf16 a[252:255], a[200:203], a[184:187], a[252:255]
 ds_read_b128 a[184:187], v1 offset:30720
 v_mul_f32 v5, v5, v103
 v_mfma_f32_16x16x32_bf16 a[252:255], a[204:207], a[188:191], a[252:255]
 ds_read_b128 a[188:191], v1 offset:31744
 v_cvt_pk_bf16_f32 v13, v6, v5
 v_mfma_f32_16x16x32_bf16 a[248:251], a[204:207], a[180:183], a[248:251]
 ds_read_b128 a[180:183], v1 offset:27648
 v_accvgpr_read_b32 v5, a54
 v_mfma_f32_16x16x32_bf16 a[248:251], a[200:203], a[176:179], a[248:251]
 ds_read_b128 a[176:179], v1 offset:26624
 v_lshlrev_b32 v6, 16, v5
 v_mfma_f32_16x16x32_bf16 v[252:255], a[200:203], a[168:171], v[252:255]
 ds_read_b128 a[168:171], v1 offset:22528
 v_and_b32 v5, s26, v5
 v_mfma_f32_16x16x32_bf16 v[252:255], a[204:207], a[172:175], v[252:255]
 ds_read_b128 a[172:175], v1 offset:23552
 v_mul_f32 v6, v6, v132
 v_mfma_f32_16x16x32_bf16 v[248:251], a[204:207], a[164:167], v[248:251]
 ds_read_b128 a[164:167], v1 offset:19456
 v_mul_f32 v5, v5, v133
 v_mfma_f32_16x16x32_bf16 v[248:251], a[200:203], a[160:163], v[248:251]
 ds_read_b128 a[160:163], v1 offset:18432
 v_cvt_pk_bf16_f32 v14, v6, v5
 v_mfma_f32_16x16x32_bf16 v[244:247], a[200:203], a[152:155], v[244:247]
 ds_read_b128 a[152:155], v1 offset:14336
 v_accvgpr_read_b32 v5, a55
 v_mfma_f32_16x16x32_bf16 v[244:247], a[204:207], a[156:159], v[244:247]
 ds_read_b128 a[156:159], v1 offset:15360
 v_lshlrev_b32 v6, 16, v5
 v_mfma_f32_16x16x32_bf16 v[240:243], a[204:207], a[148:151], v[240:243]
 ds_read_b128 a[148:151], v1 offset:11264
 v_and_b32 v5, s26, v5
 v_mfma_f32_16x16x32_bf16 v[240:243], a[200:203], a[144:147], v[240:243]
 ds_read_b128 a[144:147], v1 offset:10240
 v_mul_f32 v6, v6, v134
 v_mfma_f32_16x16x32_bf16 v[236:239], a[200:203], a[136:139], v[236:239]
 ds_read_b128 a[136:139], v1 offset:6144
 v_mul_f32 v5, v5, v135
 v_mfma_f32_16x16x32_bf16 v[236:239], a[204:207], a[140:143], v[236:239]
 ds_read_b128 a[140:143], v1 offset:7168
 v_cvt_pk_bf16_f32 v15, v6, v5
 v_mfma_f32_16x16x32_bf16 v[232:235], a[204:207], a[132:135], v[232:235]
 ds_read_b128 a[132:135], v1 offset:3072
 v_mfma_f32_16x16x32_bf16 v[232:235], a[200:203], a[128:131], v[232:235]
 ds_read_b128 a[128:131], v1 offset:2048
 ds_write_b128 v18, v[12:15] offset:20480
 ds_read_b128 v[48:51], v3 offset:20480
 ds_read_b128 v[80:83], v3 offset:21504
 v_accvgpr_read_b32 v5, a24
 v_lshlrev_b32 v6, 16, v5
 s_waitcnt vmcnt(10) lgkmcnt(11)
 v_mfma_f32_16x16x32_bf16 v[164:167], a[208:211], a[184:187], v[164:167]
 v_and_b32 v5, s26, v5
 v_mul_f32 v6, v6, v40
 v_mfma_f32_16x16x32_bf16 v[164:167], a[212:215], a[188:191], v[164:167]
 v_mul_f32 v5, v5, v41
 v_cvt_pk_bf16_f32 v8, v6, v5
 v_mfma_f32_16x16x32_bf16 v[160:163], a[212:215], a[180:183], v[160:163]
 v_accvgpr_read_b32 v5, a25
 v_lshlrev_b32 v6, 16, v5
 v_mfma_f32_16x16x32_bf16 v[160:163], a[208:211], a[176:179], v[160:163]
 v_and_b32 v5, s26, v5
 v_mul_f32 v6, v6, v42
 v_mfma_f32_16x16x32_bf16 v[156:159], a[208:211], a[168:171], v[156:159]
 v_mul_f32 v5, v5, v43
 v_cvt_pk_bf16_f32 v9, v6, v5
 s_waitcnt lgkmcnt(1)
 s_add_u32 s3, s28, 163840
 v_mfma_f32_16x16x32_bf16 v[156:159], a[212:215], a[172:175], v[156:159]
 buffer_store_dwordx4 v[48:51], v16, s[16:19], s3 offen nt
 s_waitcnt lgkmcnt(0)
 s_add_u32 s3, s28, 180224
 buffer_store_dwordx4 v[80:83], v16, s[16:19], s3 offen nt
 v_accvgpr_read_b32 v5, a26
 v_lshlrev_b32 v6, 16, v5
 v_and_b32 v5, s26, v5
 v_mfma_f32_16x16x32_bf16 v[152:155], a[212:215], a[164:167], v[152:155]
 v_mul_f32 v6, v6, v72
 v_mul_f32 v5, v5, v73
 v_mfma_f32_16x16x32_bf16 v[152:155], a[208:211], a[160:163], v[152:155]
 v_cvt_pk_bf16_f32 v10, v6, v5
 v_accvgpr_read_b32 v5, a27
 v_mfma_f32_16x16x32_bf16 v[148:151], a[208:211], a[152:155], v[148:151]
 v_lshlrev_b32 v6, 16, v5
 v_and_b32 v5, s26, v5
 v_mfma_f32_16x16x32_bf16 v[148:151], a[212:215], a[156:159], v[148:151]
 v_mul_f32 v6, v6, v74
 v_mul_f32 v5, v5, v75
 v_mfma_f32_16x16x32_bf16 v[144:147], a[212:215], a[148:151], v[144:147]
 v_cvt_pk_bf16_f32 v11, v6, v5
 v_mfma_f32_16x16x32_bf16 v[144:147], a[208:211], a[144:147], v[144:147]
 ds_write_b128 v17, v[8:11] offset:24576
 v_mfma_f32_16x16x32_bf16 v[140:143], a[208:211], a[136:139], v[140:143]
 v_accvgpr_read_b32 v5, a56
 v_lshlrev_b32 v6, 16, v5
 v_mfma_f32_16x16x32_bf16 v[140:143], a[212:215], a[140:143], v[140:143]
 v_and_b32 v5, s26, v5
 v_mul_f32 v6, v6, v104
 v_mfma_f32_16x16x32_bf16 v[136:139], a[212:215], a[132:135], v[136:139]
 v_mul_f32 v5, v5, v105
 v_cvt_pk_bf16_f32 v12, v6, v5
 v_mfma_f32_16x16x32_bf16 v[136:139], a[208:211], a[128:131], v[136:139]
 v_accvgpr_read_b32 v5, a57
 v_lshlrev_b32 v6, 16, v5
 s_waitcnt vmcnt(10)
 v_mfma_f32_16x16x32_bf16 v[168:171], a[216:219], a[128:131], v[168:171]
 v_and_b32 v5, s26, v5
 v_mul_f32 v6, v6, v106
 v_mfma_f32_16x16x32_bf16 v[168:171], a[220:223], a[132:135], v[168:171]
 v_mul_f32 v5, v5, v107
 v_cvt_pk_bf16_f32 v13, v6, v5
 v_mfma_f32_16x16x32_bf16 v[172:175], a[220:223], a[140:143], v[172:175]
 v_accvgpr_read_b32 v5, a58
 v_accvgpr_read_b32 v7, a240
 v_mfma_f32_16x16x32_bf16 v[172:175], a[216:219], a[136:139], v[172:175]
 v_lshlrev_b32 v6, 16, v5
 v_and_b32 v5, s26, v5
 v_mfma_f32_16x16x32_bf16 v[176:179], a[216:219], a[144:147], v[176:179]
 v_mul_f32 v6, v6, v7
 v_accvgpr_read_b32 v7, a241
 v_mfma_f32_16x16x32_bf16 v[176:179], a[220:223], a[148:151], v[176:179]
 v_mul_f32 v5, v5, v7
 v_cvt_pk_bf16_f32 v14, v6, v5
 v_mfma_f32_16x16x32_bf16 v[180:183], a[220:223], a[156:159], v[180:183]
 v_accvgpr_read_b32 v5, a59
 v_accvgpr_read_b32 v7, a242
 v_mfma_f32_16x16x32_bf16 v[180:183], a[216:219], a[152:155], v[180:183]
 v_lshlrev_b32 v6, 16, v5
 v_and_b32 v5, s26, v5
 v_mfma_f32_16x16x32_bf16 v[184:187], a[216:219], a[160:163], v[184:187]
 v_mul_f32 v6, v6, v7
 v_accvgpr_read_b32 v7, a243
 v_mfma_f32_16x16x32_bf16 v[184:187], a[220:223], a[164:167], v[184:187]
 v_mul_f32 v5, v5, v7
 v_cvt_pk_bf16_f32 v15, v6, v5
 v_mfma_f32_16x16x32_bf16 v[188:191], a[220:223], a[172:175], v[188:191]
 ds_write_b128 v18, v[12:15] offset:24576
 v_mfma_f32_16x16x32_bf16 v[188:191], a[216:219], a[168:171], v[188:191]
 ds_read_b128 v[48:51], v3 offset:24576
 ds_read_b128 v[80:83], v3 offset:25600
 v_mfma_f32_16x16x32_bf16 v[192:195], a[216:219], a[176:179], v[192:195]
 v_accvgpr_read_b32 v5, a28
 v_lshlrev_b32 v6, 16, v5
 v_mfma_f32_16x16x32_bf16 v[192:195], a[220:223], a[180:183], v[192:195]
 v_and_b32 v5, s26, v5
 v_mul_f32 v6, v6, v44
 v_mfma_f32_16x16x32_bf16 v[196:199], a[220:223], a[188:191], v[196:199]
 v_mul_f32 v5, v5, v45
 v_cvt_pk_bf16_f32 v8, v6, v5
 v_mfma_f32_16x16x32_bf16 v[196:199], a[216:219], a[184:187], v[196:199]
 v_accvgpr_read_b32 v5, a29
 v_lshlrev_b32 v6, 16, v5
 s_waitcnt vmcnt(6)
 v_mfma_f32_16x16x32_bf16 v[228:231], a[224:227], a[184:187], v[228:231]
 v_and_b32 v5, s26, v5
 v_mul_f32 v6, v6, v46
 v_mfma_f32_16x16x32_bf16 v[228:231], a[228:231], a[188:191], v[228:231]
 v_mul_f32 v5, v5, v47
 v_cvt_pk_bf16_f32 v9, v6, v5
 s_waitcnt lgkmcnt(1)
 v_mfma_f32_16x16x32_bf16 v[224:227], a[228:231], a[180:183], v[224:227]
 s_add_u32 s3, s28, 196608
 buffer_store_dwordx4 v[48:51], v16, s[16:19], s3 offen nt
 v_mfma_f32_16x16x32_bf16 v[224:227], a[224:227], a[176:179], v[224:227]
 s_waitcnt lgkmcnt(0)
 s_add_u32 s3, s28, 212992
 v_mfma_f32_16x16x32_bf16 v[220:223], a[224:227], a[168:171], v[220:223]
 buffer_store_dwordx4 v[80:83], v16, s[16:19], s3 offen nt
 v_accvgpr_read_b32 v5, a30
 v_mfma_f32_16x16x32_bf16 v[220:223], a[228:231], a[172:175], v[220:223]
 v_lshlrev_b32 v6, 16, v5
 v_mfma_f32_16x16x32_bf16 v[216:219], a[228:231], a[164:167], v[216:219]
 v_and_b32 v5, s26, v5
 v_mul_f32 v6, v6, v76
 v_mfma_f32_16x16x32_bf16 v[216:219], a[224:227], a[160:163], v[216:219]
 v_mul_f32 v5, v5, v77
 v_cvt_pk_bf16_f32 v10, v6, v5
 v_mfma_f32_16x16x32_bf16 v[212:215], a[224:227], a[152:155], v[212:215]
 v_accvgpr_read_b32 v5, a31
 v_lshlrev_b32 v6, 16, v5
 v_mfma_f32_16x16x32_bf16 v[212:215], a[228:231], a[156:159], v[212:215]
 v_and_b32 v5, s26, v5
 v_mul_f32 v6, v6, v78
 v_mfma_f32_16x16x32_bf16 v[208:211], a[228:231], a[148:151], v[208:211]
 v_mul_f32 v5, v5, v79
 v_cvt_pk_bf16_f32 v11, v6, v5
 v_mfma_f32_16x16x32_bf16 v[208:211], a[224:227], a[144:147], v[208:211]
 ds_write_b128 v17, v[8:11] offset:28672
 v_mfma_f32_16x16x32_bf16 v[204:207], a[224:227], a[136:139], v[204:207]
 v_accvgpr_read_b32 v5, a60
 v_lshlrev_b32 v6, 16, v5
 v_mfma_f32_16x16x32_bf16 v[204:207], a[228:231], a[140:143], v[204:207]
 v_and_b32 v5, s26, v5
 v_mul_f32 v6, v6, v108
 v_mfma_f32_16x16x32_bf16 v[200:203], a[228:231], a[132:135], v[200:203]
 v_mul_f32 v5, v5, v109
 v_cvt_pk_bf16_f32 v12, v6, v5
 v_mfma_f32_16x16x32_bf16 v[200:203], a[224:227], a[128:131], v[200:203]
 v_accvgpr_read_b32 v5, a61
 v_lshlrev_b32 v6, 16, v5
 s_waitcnt vmcnt(6)
 v_mfma_f32_16x16x32_bf16 v[232:235], a[232:235], a[128:131], v[232:235]
 v_and_b32 v5, s26, v5
 v_mul_f32 v6, v6, v110
 v_mfma_f32_16x16x32_bf16 v[232:235], a[236:239], a[132:135], v[232:235]
 v_mul_f32 v5, v5, v111
 v_cvt_pk_bf16_f32 v13, v6, v5
 v_mfma_f32_16x16x32_bf16 v[236:239], a[236:239], a[140:143], v[236:239]
 v_accvgpr_read_b32 v5, a62
 v_accvgpr_read_b32 v7, a244
 v_mfma_f32_16x16x32_bf16 v[236:239], a[232:235], a[136:139], v[236:239]
 v_lshlrev_b32 v6, 16, v5
 v_and_b32 v5, s26, v5
 v_mfma_f32_16x16x32_bf16 v[240:243], a[232:235], a[144:147], v[240:243]
 v_mul_f32 v6, v6, v7
 v_accvgpr_read_b32 v7, a245
 v_mfma_f32_16x16x32_bf16 v[240:243], a[236:239], a[148:151], v[240:243]
 v_mul_f32 v5, v5, v7
 v_cvt_pk_bf16_f32 v14, v6, v5
 v_mfma_f32_16x16x32_bf16 v[244:247], a[236:239], a[156:159], v[244:247]
 v_accvgpr_read_b32 v5, a63
 v_accvgpr_read_b32 v7, a246
 v_mfma_f32_16x16x32_bf16 v[244:247], a[232:235], a[152:155], v[244:247]
 v_lshlrev_b32 v6, 16, v5
 v_and_b32 v5, s26, v5
 v_mfma_f32_16x16x32_bf16 v[248:251], a[232:235], a[160:163], v[248:251]
 v_mul_f32 v6, v6, v7
 v_accvgpr_read_b32 v7, a247
 v_mfma_f32_16x16x32_bf16 v[248:251], a[236:239], a[164:167], v[248:251]
 v_mul_f32 v5, v5, v7
 v_cvt_pk_bf16_f32 v15, v6, v5
 v_mfma_f32_16x16x32_bf16 v[252:255], a[236:239], a[172:175], v[252:255]
 ds_write_b128 v18, v[12:15] offset:28672
 v_mfma_f32_16x16x32_bf16 v[252:255], a[232:235], a[168:171], v[252:255]
 ds_read_b128 v[48:51], v3 offset:28672
 ds_read_b128 v[80:83], v3 offset:29696
 v_mfma_f32_16x16x32_bf16 a[248:251], a[232:235], a[176:179], a[248:251]
 s_waitcnt lgkmcnt(1)
 s_add_u32 s3, s28, 229376
 v_mfma_f32_16x16x32_bf16 a[248:251], a[236:239], a[180:183], a[248:251]
 buffer_store_dwordx4 v[48:51], v16, s[16:19], s3 offen nt
 s_waitcnt lgkmcnt(0)
 v_mfma_f32_16x16x32_bf16 a[252:255], a[236:239], a[188:191], a[252:255]
 s_add_u32 s3, s28, 245760
 buffer_store_dwordx4 v[80:83], v16, s[16:19], s3 offen nt
 v_mfma_f32_16x16x32_bf16 a[252:255], a[232:235], a[184:187], a[252:255]
 s_nop 7
 v_accvgpr_read_b32 v7, a64
 v_lshlrev_b32 v6, 16, v7
 v_and_b32 v7, s26, v7
 v_pk_mul_f32 v[6:7], v[6:7], v[136:137]
 v_cvt_pk_bf16_f32 v8, v6, v7
 v_accvgpr_read_b32 v7, a65
 v_lshlrev_b32 v6, 16, v7
 v_and_b32 v7, s26, v7
 v_pk_mul_f32 v[6:7], v[6:7], v[138:139]
 v_cvt_pk_bf16_f32 v9, v6, v7
 v_accvgpr_read_b32 v7, a66
 v_lshlrev_b32 v6, 16, v7
 v_and_b32 v7, s26, v7
 v_pk_mul_f32 v[6:7], v[6:7], v[168:169]
 v_cvt_pk_bf16_f32 v10, v6, v7
 v_accvgpr_read_b32 v7, a67
 v_lshlrev_b32 v6, 16, v7
 v_and_b32 v7, s26, v7
 v_pk_mul_f32 v[6:7], v[6:7], v[170:171]
 v_cvt_pk_bf16_f32 v11, v6, v7
 ds_write_b128 v17, v[8:11]
 v_accvgpr_read_b32 v7, a96
 v_lshlrev_b32 v6, 16, v7
 v_and_b32 v7, s26, v7
 v_pk_mul_f32 v[6:7], v[6:7], v[200:201]
 v_cvt_pk_bf16_f32 v12, v6, v7
 v_accvgpr_read_b32 v7, a97
 v_lshlrev_b32 v6, 16, v7
 v_and_b32 v7, s26, v7
 v_pk_mul_f32 v[6:7], v[6:7], v[202:203]
 v_cvt_pk_bf16_f32 v13, v6, v7
 v_accvgpr_read_b32 v7, a98
 v_lshlrev_b32 v6, 16, v7
 v_and_b32 v7, s26, v7
 v_pk_mul_f32 v[6:7], v[6:7], v[232:233]
 v_cvt_pk_bf16_f32 v14, v6, v7
 v_accvgpr_read_b32 v7, a99
 v_lshlrev_b32 v6, 16, v7
 v_and_b32 v7, s26, v7
 v_pk_mul_f32 v[6:7], v[6:7], v[234:235]
 v_cvt_pk_bf16_f32 v15, v6, v7
 ds_write_b128 v18, v[12:15]
 ds_read_b128 v[48:51], v3
 ds_read_b128 v[80:83], v3 offset:1024
 v_accvgpr_read_b32 v7, a68
 v_lshlrev_b32 v6, 16, v7
 v_and_b32 v7, s26, v7
 v_pk_mul_f32 v[6:7], v[6:7], v[140:141]
 v_cvt_pk_bf16_f32 v8, v6, v7
 v_accvgpr_read_b32 v7, a69
 v_lshlrev_b32 v6, 16, v7
 v_and_b32 v7, s26, v7
 v_pk_mul_f32 v[6:7], v[6:7], v[142:143]
 v_cvt_pk_bf16_f32 v9, v6, v7
 v_accvgpr_read_b32 v7, a70
 v_lshlrev_b32 v6, 16, v7
 s_waitcnt lgkmcnt(1)
 s_add_u32 s3, s28, 0
 buffer_store_dwordx4 v[48:51], v16, s[16:19], s3 offen offset:128 nt
 s_waitcnt lgkmcnt(0)
 s_add_u32 s3, s28, 16384
 buffer_store_dwordx4 v[80:83], v16, s[16:19], s3 offen offset:128 nt
 v_and_b32 v7, s26, v7
 v_pk_mul_f32 v[6:7], v[6:7], v[172:173]
 v_cvt_pk_bf16_f32 v10, v6, v7
 v_accvgpr_read_b32 v7, a71
 v_lshlrev_b32 v6, 16, v7
 v_and_b32 v7, s26, v7
 v_pk_mul_f32 v[6:7], v[6:7], v[174:175]
 v_cvt_pk_bf16_f32 v11, v6, v7
 ds_write_b128 v17, v[8:11] offset:4096
 v_accvgpr_read_b32 v7, a100
 v_lshlrev_b32 v6, 16, v7
 v_and_b32 v7, s26, v7
 v_pk_mul_f32 v[6:7], v[6:7], v[204:205]
 v_cvt_pk_bf16_f32 v12, v6, v7
 v_accvgpr_read_b32 v7, a101
 v_lshlrev_b32 v6, 16, v7
 v_and_b32 v7, s26, v7
 v_pk_mul_f32 v[6:7], v[6:7], v[206:207]
 v_cvt_pk_bf16_f32 v13, v6, v7
 v_accvgpr_read_b32 v7, a102
 v_lshlrev_b32 v6, 16, v7
 v_and_b32 v7, s26, v7
 v_pk_mul_f32 v[6:7], v[6:7], v[236:237]
 v_cvt_pk_bf16_f32 v14, v6, v7
 v_accvgpr_read_b32 v7, a103
 v_lshlrev_b32 v6, 16, v7
 v_and_b32 v7, s26, v7
 v_pk_mul_f32 v[6:7], v[6:7], v[238:239]
 v_cvt_pk_bf16_f32 v15, v6, v7
 ds_write_b128 v18, v[12:15] offset:4096
 ds_read_b128 v[48:51], v3 offset:4096
 ds_read_b128 v[80:83], v3 offset:5120
 v_accvgpr_read_b32 v7, a72
 v_lshlrev_b32 v6, 16, v7
 v_and_b32 v7, s26, v7
 v_pk_mul_f32 v[6:7], v[6:7], v[144:145]
 v_cvt_pk_bf16_f32 v8, v6, v7
 v_accvgpr_read_b32 v7, a73
 v_lshlrev_b32 v6, 16, v7
 v_and_b32 v7, s26, v7
 v_pk_mul_f32 v[6:7], v[6:7], v[146:147]
 v_cvt_pk_bf16_f32 v9, v6, v7
 v_accvgpr_read_b32 v7, a74
 v_lshlrev_b32 v6, 16, v7
 s_waitcnt lgkmcnt(1)
 s_add_u32 s3, s28, 32768
 buffer_store_dwordx4 v[48:51], v16, s[16:19], s3 offen offset:128 nt
 s_waitcnt lgkmcnt(0)
 s_add_u32 s3, s28, 49152
 buffer_store_dwordx4 v[80:83], v16, s[16:19], s3 offen offset:128 nt
 v_and_b32 v7, s26, v7
 v_pk_mul_f32 v[6:7], v[6:7], v[176:177]
 v_cvt_pk_bf16_f32 v10, v6, v7
 v_accvgpr_read_b32 v7, a75
 v_lshlrev_b32 v6, 16, v7
 v_and_b32 v7, s26, v7
 v_pk_mul_f32 v[6:7], v[6:7], v[178:179]
 v_cvt_pk_bf16_f32 v11, v6, v7
 ds_write_b128 v17, v[8:11] offset:8192
 v_accvgpr_read_b32 v7, a104
 v_lshlrev_b32 v6, 16, v7
 v_and_b32 v7, s26, v7
 v_pk_mul_f32 v[6:7], v[6:7], v[208:209]
 v_cvt_pk_bf16_f32 v12, v6, v7
 v_accvgpr_read_b32 v7, a105
 v_lshlrev_b32 v6, 16, v7
 v_and_b32 v7, s26, v7
 v_pk_mul_f32 v[6:7], v[6:7], v[210:211]
 v_cvt_pk_bf16_f32 v13, v6, v7
 v_accvgpr_read_b32 v7, a106
 v_lshlrev_b32 v6, 16, v7
 v_and_b32 v7, s26, v7
 v_pk_mul_f32 v[6:7], v[6:7], v[240:241]
 v_cvt_pk_bf16_f32 v14, v6, v7
 v_accvgpr_read_b32 v7, a107
 v_lshlrev_b32 v6, 16, v7
 v_and_b32 v7, s26, v7
 v_pk_mul_f32 v[6:7], v[6:7], v[242:243]
 v_cvt_pk_bf16_f32 v15, v6, v7
 ds_write_b128 v18, v[12:15] offset:8192
 ds_read_b128 v[48:51], v3 offset:8192
 ds_read_b128 v[80:83], v3 offset:9216
 v_accvgpr_read_b32 v7, a76
 v_lshlrev_b32 v6, 16, v7
 v_and_b32 v7, s26, v7
 v_pk_mul_f32 v[6:7], v[6:7], v[148:149]
 v_cvt_pk_bf16_f32 v8, v6, v7
 v_accvgpr_read_b32 v7, a77
 v_lshlrev_b32 v6, 16, v7
 v_and_b32 v7, s26, v7
 v_pk_mul_f32 v[6:7], v[6:7], v[150:151]
 v_cvt_pk_bf16_f32 v9, v6, v7
 v_accvgpr_read_b32 v7, a78
 v_lshlrev_b32 v6, 16, v7
 s_waitcnt lgkmcnt(1)
 s_add_u32 s3, s28, 65536
 buffer_store_dwordx4 v[48:51], v16, s[16:19], s3 offen offset:128 nt
 s_waitcnt lgkmcnt(0)
 s_add_u32 s3, s28, 81920
 buffer_store_dwordx4 v[80:83], v16, s[16:19], s3 offen offset:128 nt
 v_and_b32 v7, s26, v7
 v_pk_mul_f32 v[6:7], v[6:7], v[180:181]
 v_cvt_pk_bf16_f32 v10, v6, v7
 v_accvgpr_read_b32 v7, a79
 v_lshlrev_b32 v6, 16, v7
 v_and_b32 v7, s26, v7
 v_pk_mul_f32 v[6:7], v[6:7], v[182:183]
 v_cvt_pk_bf16_f32 v11, v6, v7
 ds_write_b128 v17, v[8:11] offset:12288
 v_accvgpr_read_b32 v7, a108
 v_lshlrev_b32 v6, 16, v7
 v_and_b32 v7, s26, v7
 v_pk_mul_f32 v[6:7], v[6:7], v[212:213]
 v_cvt_pk_bf16_f32 v12, v6, v7
 v_accvgpr_read_b32 v7, a109
 v_lshlrev_b32 v6, 16, v7
 v_and_b32 v7, s26, v7
 v_pk_mul_f32 v[6:7], v[6:7], v[214:215]
 v_cvt_pk_bf16_f32 v13, v6, v7
 v_accvgpr_read_b32 v7, a110
 v_lshlrev_b32 v6, 16, v7
 v_and_b32 v7, s26, v7
 v_pk_mul_f32 v[6:7], v[6:7], v[244:245]
 v_cvt_pk_bf16_f32 v14, v6, v7
 v_accvgpr_read_b32 v7, a111
 v_lshlrev_b32 v6, 16, v7
 v_and_b32 v7, s26, v7
 v_pk_mul_f32 v[6:7], v[6:7], v[246:247]
 v_cvt_pk_bf16_f32 v15, v6, v7
 ds_write_b128 v18, v[12:15] offset:12288
 ds_read_b128 v[48:51], v3 offset:12288
 ds_read_b128 v[80:83], v3 offset:13312
 v_accvgpr_read_b32 v7, a80
 v_lshlrev_b32 v6, 16, v7
 v_and_b32 v7, s26, v7
 v_pk_mul_f32 v[6:7], v[6:7], v[152:153]
 v_cvt_pk_bf16_f32 v8, v6, v7
 v_accvgpr_read_b32 v7, a81
 v_lshlrev_b32 v6, 16, v7
 v_and_b32 v7, s26, v7
 v_pk_mul_f32 v[6:7], v[6:7], v[154:155]
 v_cvt_pk_bf16_f32 v9, v6, v7
 v_accvgpr_read_b32 v7, a82
 v_lshlrev_b32 v6, 16, v7
 s_waitcnt lgkmcnt(1)
 s_add_u32 s3, s28, 98304
 buffer_store_dwordx4 v[48:51], v16, s[16:19], s3 offen offset:128 nt
 s_waitcnt lgkmcnt(0)
 s_add_u32 s3, s28, 114688
 buffer_store_dwordx4 v[80:83], v16, s[16:19], s3 offen offset:128 nt
 v_and_b32 v7, s26, v7
 v_pk_mul_f32 v[6:7], v[6:7], v[184:185]
 v_cvt_pk_bf16_f32 v10, v6, v7
 v_accvgpr_read_b32 v7, a83
 v_lshlrev_b32 v6, 16, v7
 v_and_b32 v7, s26, v7
 v_pk_mul_f32 v[6:7], v[6:7], v[186:187]
 v_cvt_pk_bf16_f32 v11, v6, v7
 ds_write_b128 v17, v[8:11] offset:16384
 v_accvgpr_read_b32 v7, a112
 v_lshlrev_b32 v6, 16, v7
 v_and_b32 v7, s26, v7
 v_pk_mul_f32 v[6:7], v[6:7], v[216:217]
 v_cvt_pk_bf16_f32 v12, v6, v7
 v_accvgpr_read_b32 v7, a113
 v_lshlrev_b32 v6, 16, v7
 v_and_b32 v7, s26, v7
 v_pk_mul_f32 v[6:7], v[6:7], v[218:219]
 v_cvt_pk_bf16_f32 v13, v6, v7
 v_accvgpr_read_b32 v7, a114
 v_lshlrev_b32 v6, 16, v7
 v_and_b32 v7, s26, v7
 v_pk_mul_f32 v[6:7], v[6:7], v[248:249]
 v_cvt_pk_bf16_f32 v14, v6, v7
 v_accvgpr_read_b32 v7, a115
 v_lshlrev_b32 v6, 16, v7
 v_and_b32 v7, s26, v7
 v_pk_mul_f32 v[6:7], v[6:7], v[250:251]
 v_cvt_pk_bf16_f32 v15, v6, v7
 ds_write_b128 v18, v[12:15] offset:16384
 ds_read_b128 v[48:51], v3 offset:16384
 ds_read_b128 v[80:83], v3 offset:17408
 v_accvgpr_read_b32 v7, a84
 v_lshlrev_b32 v6, 16, v7
 v_and_b32 v7, s26, v7
 v_pk_mul_f32 v[6:7], v[6:7], v[156:157]
 v_cvt_pk_bf16_f32 v8, v6, v7
 v_accvgpr_read_b32 v7, a85
 v_lshlrev_b32 v6, 16, v7
 v_and_b32 v7, s26, v7
 v_pk_mul_f32 v[6:7], v[6:7], v[158:159]
 v_cvt_pk_bf16_f32 v9, v6, v7
 v_accvgpr_read_b32 v7, a86
 v_lshlrev_b32 v6, 16, v7
 s_waitcnt lgkmcnt(1)
 s_add_u32 s3, s28, 131072
 buffer_store_dwordx4 v[48:51], v16, s[16:19], s3 offen offset:128 nt
 s_waitcnt lgkmcnt(0)
 s_add_u32 s3, s28, 147456
 buffer_store_dwordx4 v[80:83], v16, s[16:19], s3 offen offset:128 nt
 v_and_b32 v7, s26, v7
 v_pk_mul_f32 v[6:7], v[6:7], v[188:189]
 v_cvt_pk_bf16_f32 v10, v6, v7
 v_accvgpr_read_b32 v7, a87
 v_lshlrev_b32 v6, 16, v7
 v_and_b32 v7, s26, v7
 v_pk_mul_f32 v[6:7], v[6:7], v[190:191]
 v_cvt_pk_bf16_f32 v11, v6, v7
 ds_write_b128 v17, v[8:11] offset:20480
 v_accvgpr_read_b32 v7, a116
 v_lshlrev_b32 v6, 16, v7
 v_and_b32 v7, s26, v7
 v_pk_mul_f32 v[6:7], v[6:7], v[220:221]
 v_cvt_pk_bf16_f32 v12, v6, v7
 v_accvgpr_read_b32 v7, a117
 v_lshlrev_b32 v6, 16, v7
 v_and_b32 v7, s26, v7
 v_pk_mul_f32 v[6:7], v[6:7], v[222:223]
 v_cvt_pk_bf16_f32 v13, v6, v7
 v_accvgpr_read_b32 v7, a118
 v_lshlrev_b32 v6, 16, v7
 v_and_b32 v7, s26, v7
 v_pk_mul_f32 v[6:7], v[6:7], v[252:253]
 v_cvt_pk_bf16_f32 v14, v6, v7
 v_accvgpr_read_b32 v7, a119
 v_lshlrev_b32 v6, 16, v7
 v_and_b32 v7, s26, v7
 v_pk_mul_f32 v[6:7], v[6:7], v[254:255]
 v_cvt_pk_bf16_f32 v15, v6, v7
 ds_write_b128 v18, v[12:15] offset:20480
 ds_read_b128 v[48:51], v3 offset:20480
 ds_read_b128 v[80:83], v3 offset:21504
 v_accvgpr_read_b32 v7, a88
 v_lshlrev_b32 v6, 16, v7
 v_and_b32 v7, s26, v7
 v_pk_mul_f32 v[6:7], v[6:7], v[160:161]
 v_cvt_pk_bf16_f32 v8, v6, v7
 v_accvgpr_read_b32 v7, a89
 v_lshlrev_b32 v6, 16, v7
 v_and_b32 v7, s26, v7
 v_pk_mul_f32 v[6:7], v[6:7], v[162:163]
 v_cvt_pk_bf16_f32 v9, v6, v7
 v_accvgpr_read_b32 v7, a90
 v_lshlrev_b32 v6, 16, v7
 s_waitcnt lgkmcnt(1)
 s_add_u32 s3, s28, 163840
 buffer_store_dwordx4 v[48:51], v16, s[16:19], s3 offen offset:128 nt
 s_waitcnt lgkmcnt(0)
 s_add_u32 s3, s28, 180224
 buffer_store_dwordx4 v[80:83], v16, s[16:19], s3 offen offset:128 nt
 v_and_b32 v7, s26, v7
 v_pk_mul_f32 v[6:7], v[6:7], v[192:193]
 v_cvt_pk_bf16_f32 v10, v6, v7
 v_accvgpr_read_b32 v7, a91
 v_lshlrev_b32 v6, 16, v7
 v_and_b32 v7, s26, v7
 v_pk_mul_f32 v[6:7], v[6:7], v[194:195]
 v_cvt_pk_bf16_f32 v11, v6, v7
 ds_write_b128 v17, v[8:11] offset:24576
 v_accvgpr_read_b32 v7, a120
 v_lshlrev_b32 v6, 16, v7
 v_and_b32 v7, s26, v7
 v_pk_mul_f32 v[6:7], v[6:7], v[224:225]
 v_cvt_pk_bf16_f32 v12, v6, v7
 v_accvgpr_read_b32 v7, a121
 v_lshlrev_b32 v6, 16, v7
 v_and_b32 v7, s26, v7
 v_pk_mul_f32 v[6:7], v[6:7], v[226:227]
 v_cvt_pk_bf16_f32 v13, v6, v7
 v_accvgpr_read_b32 v7, a122
 v_accvgpr_read_b32 v112, a248
 v_accvgpr_read_b32 v113, a249
 v_lshlrev_b32 v6, 16, v7
 v_and_b32 v7, s26, v7
 v_pk_mul_f32 v[6:7], v[6:7], v[112:113]
 v_cvt_pk_bf16_f32 v14, v6, v7
 v_accvgpr_read_b32 v7, a123
 v_accvgpr_read_b32 v112, a250
 v_accvgpr_read_b32 v113, a251
 v_lshlrev_b32 v6, 16, v7
 v_and_b32 v7, s26, v7
 v_pk_mul_f32 v[6:7], v[6:7], v[112:113]
 v_cvt_pk_bf16_f32 v15, v6, v7
 ds_write_b128 v18, v[12:15] offset:24576
 ds_read_b128 v[48:51], v3 offset:24576
 ds_read_b128 v[80:83], v3 offset:25600
 v_accvgpr_read_b32 v7, a92
 v_lshlrev_b32 v6, 16, v7
 v_and_b32 v7, s26, v7
 v_pk_mul_f32 v[6:7], v[6:7], v[164:165]
 v_cvt_pk_bf16_f32 v8, v6, v7
 v_accvgpr_read_b32 v7, a93
 v_lshlrev_b32 v6, 16, v7
 v_and_b32 v7, s26, v7
 v_pk_mul_f32 v[6:7], v[6:7], v[166:167]
 v_cvt_pk_bf16_f32 v9, v6, v7
 v_accvgpr_read_b32 v7, a94
 v_lshlrev_b32 v6, 16, v7
 s_waitcnt lgkmcnt(1)
 s_add_u32 s3, s28, 196608
 buffer_store_dwordx4 v[48:51], v16, s[16:19], s3 offen offset:128 nt
 s_waitcnt lgkmcnt(0)
 s_add_u32 s3, s28, 212992
 buffer_store_dwordx4 v[80:83], v16, s[16:19], s3 offen offset:128 nt
 v_and_b32 v7, s26, v7
 v_pk_mul_f32 v[6:7], v[6:7], v[196:197]
 v_cvt_pk_bf16_f32 v10, v6, v7
 v_accvgpr_read_b32 v7, a95
 v_lshlrev_b32 v6, 16, v7
 v_and_b32 v7, s26, v7
 v_pk_mul_f32 v[6:7], v[6:7], v[198:199]
 v_cvt_pk_bf16_f32 v11, v6, v7
 ds_write_b128 v17, v[8:11] offset:28672
 v_accvgpr_read_b32 v7, a124
 v_lshlrev_b32 v6, 16, v7
 v_and_b32 v7, s26, v7
 v_pk_mul_f32 v[6:7], v[6:7], v[228:229]
 v_cvt_pk_bf16_f32 v12, v6, v7
 v_accvgpr_read_b32 v7, a125
 v_lshlrev_b32 v6, 16, v7
 v_and_b32 v7, s26, v7
 v_pk_mul_f32 v[6:7], v[6:7], v[230:231]
 v_cvt_pk_bf16_f32 v13, v6, v7
 v_accvgpr_read_b32 v7, a126
 v_accvgpr_read_b32 v112, a252
 v_accvgpr_read_b32 v113, a253
 v_lshlrev_b32 v6, 16, v7
 v_and_b32 v7, s26, v7
 v_pk_mul_f32 v[6:7], v[6:7], v[112:113]
 v_cvt_pk_bf16_f32 v14, v6, v7
 v_accvgpr_read_b32 v7, a127
 v_accvgpr_read_b32 v112, a254
 v_accvgpr_read_b32 v113, a255
 v_lshlrev_b32 v6, 16, v7
 v_and_b32 v7, s26, v7
 v_pk_mul_f32 v[6:7], v[6:7], v[112:113]
 v_cvt_pk_bf16_f32 v15, v6, v7
 ds_write_b128 v18, v[12:15] offset:28672
 ds_read_b128 v[48:51], v3 offset:28672
 ds_read_b128 v[80:83], v3 offset:29696
 s_waitcnt lgkmcnt(1)
 s_add_u32 s3, s28, 229376
 buffer_store_dwordx4 v[48:51], v16, s[16:19], s3 offen offset:128 nt
 s_waitcnt lgkmcnt(0)
 s_add_u32 s3, s28, 245760
 buffer_store_dwordx4 v[80:83], v16, s[16:19], s3 offen offset:128 nt
Lend:
 s_endpgm
Lspin_pro:
 s_add_u32 s53, s53, 1
 v_lshlrev_b32 v4, 2, v3
 v_and_b32 v4, 192, v4
 buffer_load_dword v4, v4, s[44:47], 0 offen sc1
 s_cmp_ge_u32 s53, 0x100000
 s_cbranch_scc1 Lgiveup_pro
 s_waitcnt vmcnt(0)
 v_cmp_gt_i32 vcc, s27, v4
 s_and_b64 vcc, exec, vcc
 s_cbranch_vccnz Lspin_pro
Lgiveup_pro:
 s_waitcnt vmcnt(0)
 s_branch Lok_pro
Lspin_pa:
 s_add_u32 s53, s53, 1
 buffer_load_dword v4, off, s[64:67], 0 sc1
 s_cmp_ge_u32 s53, 0x100000
 s_cbranch_scc1 Lgiveup_pa
 s_waitcnt vmcnt(0)
 v_cmp_gt_i32 vcc, s55, v4
 s_and_b64 vcc, exec, vcc
 s_cbranch_vccnz Lspin_pa
Lgiveup_pa:
 s_waitcnt vmcnt(0)
 s_branch Lok_pa
Lgat0:
 v_lshrrev_b32 v5, 4, v3
 v_and_b32 v5, 0x20, v5
 v_xor_b32 v5, v5, v3
 v_and_b32 v5, 0x30, v5
 v_bfe_u32 v6, v3, 6, 4
 v_lshl_add_u32 v6, v6, 11, v5
 s_branch Lgatr0
Lxrg:
 v_lshrrev_b32 v5, 2, v3
 v_and_b32 v5, 0x20, v5
 v_lshrrev_b32 v2, 4, v3
 v_xor_b32 v5, v5, v2
 v_and_b32 v5, 0x30, v5
 v_bfe_u32 v1, v3, 4, 4
 v_lshl_add_u32 v1, v1, 6, v5
 v_add_u32 v2, 0x10000, v1
 s_branch Lxrgr
Lspin_pb:
 s_add_u32 s53, s53, 1
 buffer_load_dword v4, off, s[64:67], 0 sc1
 s_cmp_ge_u32 s53, 0x100000
 s_cbranch_scc1 Lgiveup_pb
 s_waitcnt vmcnt(0)
 v_cmp_gt_i32 vcc, s55, v4
 s_and_b64 vcc, exec, vcc
 s_cbranch_vccnz Lspin_pb
Lgiveup_pb:
 s_waitcnt vmcnt(0)
 s_branch Lok_pb
Lgat1:
 v_lshrrev_b32 v5, 4, v3
 v_and_b32 v5, 0x20, v5
 v_xor_b32 v5, v5, v3
 v_and_b32 v5, 0x30, v5
 v_bfe_u32 v6, v3, 6, 4
 v_lshl_add_u32 v6, v6, 11, v5
 s_branch Lgatr1
Lspin_w:
 s_add_u32 s53, s53, 1
 v_lshlrev_b32 v4, 2, v3
 v_and_b32 v4, 192, v4
 buffer_load_dword v4, v4, s[44:47], 0 offen sc1
 s_cmp_ge_u32 s53, 0x100000
 s_cbranch_scc1 Lgiveup_w
 s_waitcnt vmcnt(0)
 v_cmp_gt_i32 vcc, s27, v4
 s_and_b64 vcc, exec, vcc
 s_cbranch_vccnz Lspin_w
Lgiveup_w:
 s_waitcnt vmcnt(0)
 s_branch Lok_w
Lcend:
.section .rodata,"a"
.p2align 6
.amdhsa_kernel standalone__cross_network_dcn__recsys_kernel
  .amdhsa_next_free_vgpr 512
  .amdhsa_next_free_sgpr 102
  .amdhsa_accum_offset 256
  .amdhsa_group_segment_fixed_size 0
  .amdhsa_kernarg_size 48
  .amdhsa_user_sgpr_count 2
  .amdhsa_user_sgpr_kernarg_segment_ptr 1
  .amdhsa_system_sgpr_workgroup_id_x 1
  .amdhsa_float_denorm_mode_32 3
.end_amdhsa_kernel
```
